```python
import torch

def _softmax(x, axis=-1):
    return torch.softmax(x, dim=axis)
def _gelu(x):
    return torch.nn.functional.gelu(x, approximate="tanh")
def _silu(x):
    return torch.nn.functional.silu(x)
def _sigmoid(x):
    return torch.sigmoid(x)
def _layernorm(x, axis=-1, eps=1e-5):
    m = x.mean(dim=axis, keepdim=True)
    v = x.var(dim=axis, keepdim=True, unbiased=False)
    return (x - m) / torch.sqrt(v + eps)
def _scatter_add(tgt, idx, src, axis=0):
    return tgt.clone().index_add_(axis, idx, src)
def _segment_sum(src, seg, n):
    out = torch.zeros((n,) + src.shape[1:], dtype=src.dtype)
    return out.index_add_(0, seg, src)
def _pad(x, pw):
    flat = tuple(v for pair in reversed(pw) for v in pair)
    return torch.nn.functional.pad(x, flat)

kernel_name = 'interleave_layers__sliding_local_dilated__swiglu_ffn__prompt'

def setup_inputs():

    _w = (lambda a: (lambda t: t.to(torch.bfloat16) if t.is_floating_point() else t)(torch.as_tensor(a)))
    def _A_setup():
        B, S, D = 1, 2048, 1024
        return {
            "x": _w((lambda *s: torch.randn(*s, dtype=torch.bfloat16) * 0.05)(B, S, D)),
            "wqkv": _w((lambda *s: torch.randn(*s, dtype=torch.bfloat16) * 0.05)(D, 3 * D)),
            "wo": _w((lambda *s: torch.randn(*s, dtype=torch.bfloat16) * 0.05)(D, D)),
        }
    _A_in = _A_setup()

    def _B_setup():
        B, S, D, F = 1, 2048, 1024, 3584
        return {
            "x": _w((lambda *s: torch.randn(*s, dtype=torch.bfloat16) * 0.05)(B, S, D)),
            "w_gate": _w((lambda *s: torch.randn(*s, dtype=torch.bfloat16) * 0.05)(D, F)),
            "w_up": _w((lambda *s: torch.randn(*s, dtype=torch.bfloat16) * 0.05)(D, F)),
            "w_down": _w((lambda *s: torch.randn(*s, dtype=torch.bfloat16) * 0.05)(F, D)),
        }
    _B_in = _B_setup()

    return {
        "A_x": _A_in["x"],
        "A_wqkv": _A_in["wqkv"],
        "A_wo": _A_in["wo"],
        "B_x": _B_in["x"],
        "B_w_gate": _B_in["w_gate"],
        "B_w_up": _B_in["w_up"],
        "B_w_down": _B_in["w_down"],
    }

def reference(A_x, A_wqkv, A_wo, B_x, B_w_gate, B_w_up, B_w_down):
    def _A_ref(x, wqkv, wo):
        B, S, D = x.shape
        H = 32; Dh = D // H
        W, dil = 8, 2
        qkv = (lambda x, *d: x.permute(*d))((x @ wqkv).reshape(B, S, 3, H, Dh), 2, 0, 3, 1, 4)
        q, k, v = qkv[0], qkv[1], qkv[2]
        scale = Dh ** -0.5
        pos = torch.arange(S)
        off = torch.arange(W) * dil
        idx = pos[:, None] - off[None, :]
        mask = idx >= 0
        idx_c = torch.where(mask, idx, 0).reshape(-1)
        kg = k[:, :, idx_c, :].reshape(B, H, S, W, Dh)
        vg = v[:, :, idx_c, :].reshape(B, H, S, W, Dh)
        logits = torch.einsum("bhsd,bhswd->bhsw", q, kg) * scale
        logits = torch.where(mask[None, None, :, :], logits, -1e9)
        attn = _softmax(logits, axis=-1)
        o = torch.einsum("bhsw,bhswd->bhsd", attn, vg)
        return (lambda x, *d: x.permute(*d))(o, 0, 2, 1, 3).reshape(B, S, D) @ wo

    def _B_ref(x, w_gate, w_up, w_down):
        g = _silu(x @ w_gate)
        u = x @ w_up
        return (g * u) @ w_down

    x = A_x
    x = x + _A_ref(_layernorm(x, axis=-1), A_wqkv, A_wo)
    x = x + _B_ref(_layernorm(x, axis=-1), B_w_gate, B_w_up, B_w_down)
    x = x + _A_ref(_layernorm(x, axis=-1), A_wqkv, A_wo)
    x = x + _B_ref(_layernorm(x, axis=-1), B_w_gate, B_w_up, B_w_down)
    return x
```

```asm
; @launch kernel=prep_kernel grid=(256,1,1) block=(256,1,1) lds=1024
; @launch kernel=qkv1_kernel grid=(256,1,1) block=(256,1,1) lds=143360
; @launch kernel=o1_kernel grid=(256,1,1) block=(256,1,1) lds=65536
; @launch kernel=gu1_kernel grid=(256,1,1) block=(256,1,1) lds=131072
; @launch kernel=down1_kernel grid=(256,1,1) block=(256,1,1) lds=57344
; @launch kernel=qkv2_kernel grid=(256,1,1) block=(256,1,1) lds=143360
; @launch kernel=o2_kernel grid=(256,1,1) block=(256,1,1) lds=65536
; @launch kernel=gu2_kernel grid=(256,1,1) block=(256,1,1) lds=131072
; @launch kernel=down2_kernel grid=(256,1,1) block=(256,1,1) lds=57344
.amdgcn_target "amdgcn-amd-amdhsa--gfx950"
.text
.globl prep_kernel
.p2align 8
.type prep_kernel,@function
prep_kernel:
  s_cmp_lt_u32 s2, 256
  s_cbranch_scc1 prep_body
  s_endpgm
.p2align 6
prep_body:
  s_load_dwordx2 s[32:33], s[0:1], 72
  s_load_dwordx4 s[36:39], s[0:1], 0
  s_load_dwordx4 s[68:71], s[0:1], 32
  v_lshrrev_b32 v1, 6, v0
  v_and_b32 v47, 63, v0
  v_readfirstlane_b32 s24, v1
  s_lshr_b32 s44, s2, 1
  s_and_b32 s45, s2, 1
  s_lshl_b32 s45, s45, 2
  s_add_u32 s45, s45, s24
  v_and_b32 v2, 15, v47
  v_lshlrev_b32 v2, 12, v2
  v_lshrrev_b32 v3, 4, v47
  v_lshl_add_u32 v2, v3, 3, v2
  v_lshlrev_b32 v4, 4, v47
  s_and_b32 s43, s44, 63
  s_lshl_b32 s43, s43, 16
  s_lshr_b32 s46, s44, 6
  s_lshl_b32 s46, s46, 11
  s_add_u32 s46, s46, s43
  s_lshl_b32 s43, s45, 8
  s_add_u32 s46, s46, s43
  s_waitcnt lgkmcnt(0)
  s_mov_b32 s4, s32
  s_mov_b32 s5, s33
  s_mov_b32 s6, 0x10000000
  s_mov_b32 s7, 0x20000
  s_mov_b32 s8, s36
  s_mov_b32 s9, s37
  s_mov_b32 s10, 0x400000
  s_mov_b32 s11, 0x20000
  buffer_load_dwordx2 v[48:49], v2, s[8:11], s46 offen offset:0
  buffer_load_dwordx2 v[50:51], v2, s[8:11], s46 offen offset:32
  buffer_load_dwordx2 v[52:53], v2, s[8:11], s46 offen offset:64
  buffer_load_dwordx2 v[54:55], v2, s[8:11], s46 offen offset:96
  buffer_load_dwordx2 v[56:57], v2, s[8:11], s46 offen offset:128
  buffer_load_dwordx2 v[58:59], v2, s[8:11], s46 offen offset:160
  buffer_load_dwordx2 v[60:61], v2, s[8:11], s46 offen offset:192
  buffer_load_dwordx2 v[62:63], v2, s[8:11], s46 offen offset:224
  s_mov_b32 s51, 6144
  s_mov_b32 s52, s2
  s_mov_b32 s53, 36700160
  s_mov_b32 s12, s38
  s_mov_b32 s13, s39
  s_mov_b32 s14, 6291456
  s_mov_b32 s15, 0x20000
  s_cmp_lt_u32 s2, 48
  s_cbranch_scc1 Lprep_body_sel
  s_mov_b32 s51, 7168
  s_sub_u32 s52, s2, 48
  s_mov_b32 s53, 36716544
  s_mov_b32 s12, s68
  s_mov_b32 s13, s69
  s_mov_b32 s14, 7340032
  s_cmp_lt_u32 s2, 104
  s_cbranch_scc1 Lprep_body_sel
  s_sub_u32 s52, s2, 104
  s_mov_b32 s53, 36730880
  s_mov_b32 s12, s70
  s_mov_b32 s13, s71
Lprep_body_sel:
  s_lshl_b32 s43, s44, 15
  s_lshl_b32 s47, s45, 12
  s_add_u32 s47, s47, s43
  s_add_u32 s47, s47, 0
  s_lshl_b32 s43, s44, 11
  s_lshl_b32 s50, s45, 8
  s_add_u32 s50, s50, s43
  s_add_u32 s50, s50, 35651584
  s_waitcnt vmcnt(0)
  buffer_store_dwordx4 v[48:51], v4, s[4:7], s47 offen offset:0
  buffer_store_dwordx4 v[52:55], v4, s[4:7], s47 offen offset:1024
  buffer_store_dwordx4 v[56:59], v4, s[4:7], s47 offen offset:2048
  buffer_store_dwordx4 v[60:63], v4, s[4:7], s47 offen offset:3072
  v_mov_b32 v64, 0x3f803f80
  v_mov_b32 v65, 0x3f803f80
  v_mov_b32 v66, 0x3f803f80
  v_mov_b32 v67, 0x3f803f80
  v_and_b32 v84, 15, v47
  v_lshrrev_b32 v85, 4, v47
  v_mfma_f32_16x16x32_bf16 v[68:71], v[64:67], v[48:51], 0
  v_mfma_f32_16x16x32_bf16 v[72:75], v[48:51], v[48:51], 0
  v_mfma_f32_16x16x32_bf16 v[76:79], v[64:67], v[56:59], 0
  v_mfma_f32_16x16x32_bf16 v[80:83], v[56:59], v[56:59], 0
  v_mfma_f32_16x16x32_bf16 v[68:71], v[64:67], v[52:55], v[68:71]
  v_mfma_f32_16x16x32_bf16 v[72:75], v[52:55], v[52:55], v[72:75]
  v_mfma_f32_16x16x32_bf16 v[76:79], v[64:67], v[60:63], v[76:79]
  v_mfma_f32_16x16x32_bf16 v[80:83], v[60:63], v[60:63], v[80:83]
  v_lshrrev_b32 v64, 2, v84
  v_cmp_eq_u32 s[60:61], v64, v85
  v_and_b32 v64, 3, v84
  v_cmp_eq_u32 s[62:63], 1, v64
  v_cmp_eq_u32 s[64:65], 2, v64
  v_cmp_eq_u32 s[66:67], 3, v64
  v_lshlrev_b32 v84, 3, v84
  v_mov_b32 v85, 0x7ffffff0
  s_nop 0
  v_cndmask_b32 v84, v85, v84, s[60:61]
  v_cndmask_b32 v69, v72, v73, s[62:63]
  v_cndmask_b32 v69, v69, v74, s[64:65]
  v_cndmask_b32 v69, v69, v75, s[66:67]
  buffer_store_dwordx2 v[68:69], v84, s[4:7], s50 offen offset:0
  v_cndmask_b32 v77, v80, v81, s[62:63]
  v_cndmask_b32 v77, v77, v82, s[64:65]
  v_cndmask_b32 v77, v77, v83, s[66:67]
  buffer_store_dwordx2 v[76:77], v84, s[4:7], s50 offen offset:128
  s_cmp_ge_u32 s2, 160
  s_cbranch_scc1 Lprep_body_end
  v_lshrrev_b32 v2, 3, v47
  v_mul_u32_u24 v2, s51, v2
  v_and_b32 v3, 7, v47
  v_lshl_add_u32 v2, v3, 4, v2
  s_lshl_b32 s54, s51, 8
  s_mul_i32 s54, s54, s24
  s_lshl_b32 s43, s52, 7
  s_add_u32 s54, s54, s43
  s_lshl_b32 s55, s51, 3
  buffer_load_dwordx4 v[96:99], v2, s[12:15], s54 offen
  s_add_u32 s54, s54, s55
  buffer_load_dwordx4 v[100:103], v2, s[12:15], s54 offen
  s_add_u32 s54, s54, s55
  buffer_load_dwordx4 v[104:107], v2, s[12:15], s54 offen
  s_add_u32 s54, s54, s55
  buffer_load_dwordx4 v[108:111], v2, s[12:15], s54 offen
  s_add_u32 s54, s54, s55
  buffer_load_dwordx4 v[112:115], v2, s[12:15], s54 offen
  s_add_u32 s54, s54, s55
  buffer_load_dwordx4 v[116:119], v2, s[12:15], s54 offen
  s_add_u32 s54, s54, s55
  buffer_load_dwordx4 v[120:123], v2, s[12:15], s54 offen
  s_add_u32 s54, s54, s55
  buffer_load_dwordx4 v[124:127], v2, s[12:15], s54 offen
  s_add_u32 s54, s54, s55
  buffer_load_dwordx4 v[128:131], v2, s[12:15], s54 offen
  s_add_u32 s54, s54, s55
  buffer_load_dwordx4 v[132:135], v2, s[12:15], s54 offen
  s_add_u32 s54, s54, s55
  buffer_load_dwordx4 v[136:139], v2, s[12:15], s54 offen
  s_add_u32 s54, s54, s55
  buffer_load_dwordx4 v[140:143], v2, s[12:15], s54 offen
  s_add_u32 s54, s54, s55
  buffer_load_dwordx4 v[144:147], v2, s[12:15], s54 offen
  s_add_u32 s54, s54, s55
  buffer_load_dwordx4 v[148:151], v2, s[12:15], s54 offen
  s_add_u32 s54, s54, s55
  buffer_load_dwordx4 v[152:155], v2, s[12:15], s54 offen
  s_add_u32 s54, s54, s55
  buffer_load_dwordx4 v[156:159], v2, s[12:15], s54 offen
  s_add_u32 s54, s54, s55
  buffer_load_dwordx4 v[160:163], v2, s[12:15], s54 offen
  s_add_u32 s54, s54, s55
  buffer_load_dwordx4 v[164:167], v2, s[12:15], s54 offen
  s_add_u32 s54, s54, s55
  buffer_load_dwordx4 v[168:171], v2, s[12:15], s54 offen
  s_add_u32 s54, s54, s55
  buffer_load_dwordx4 v[172:175], v2, s[12:15], s54 offen
  s_add_u32 s54, s54, s55
  buffer_load_dwordx4 v[176:179], v2, s[12:15], s54 offen
  s_add_u32 s54, s54, s55
  buffer_load_dwordx4 v[180:183], v2, s[12:15], s54 offen
  s_add_u32 s54, s54, s55
  buffer_load_dwordx4 v[184:187], v2, s[12:15], s54 offen
  s_add_u32 s54, s54, s55
  buffer_load_dwordx4 v[188:191], v2, s[12:15], s54 offen
  s_add_u32 s54, s54, s55
  buffer_load_dwordx4 v[192:195], v2, s[12:15], s54 offen
  s_add_u32 s54, s54, s55
  buffer_load_dwordx4 v[196:199], v2, s[12:15], s54 offen
  s_add_u32 s54, s54, s55
  buffer_load_dwordx4 v[200:203], v2, s[12:15], s54 offen
  s_add_u32 s54, s54, s55
  buffer_load_dwordx4 v[204:207], v2, s[12:15], s54 offen
  s_add_u32 s54, s54, s55
  buffer_load_dwordx4 v[208:211], v2, s[12:15], s54 offen
  s_add_u32 s54, s54, s55
  buffer_load_dwordx4 v[212:215], v2, s[12:15], s54 offen
  s_add_u32 s54, s54, s55
  buffer_load_dwordx4 v[216:219], v2, s[12:15], s54 offen
  s_add_u32 s54, s54, s55
  buffer_load_dwordx4 v[220:223], v2, s[12:15], s54 offen
  s_add_u32 s54, s54, s55
  v_mov_b32 v8, 0
  v_mov_b32 v9, 0
  v_mov_b32 v10, 0
  v_mov_b32 v11, 0
  v_mov_b32 v12, 0
  v_mov_b32 v13, 0
  v_mov_b32 v14, 0
  v_mov_b32 v15, 0
  s_waitcnt vmcnt(31)
  v_lshlrev_b32 v16, 16, v96
  v_and_b32 v17, 0xffff0000, v96
  v_pk_add_f32 v[8:9], v[8:9], v[16:17]
  v_lshlrev_b32 v16, 16, v97
  v_and_b32 v17, 0xffff0000, v97
  v_pk_add_f32 v[10:11], v[10:11], v[16:17]
  v_lshlrev_b32 v16, 16, v98
  v_and_b32 v17, 0xffff0000, v98
  v_pk_add_f32 v[12:13], v[12:13], v[16:17]
  v_lshlrev_b32 v16, 16, v99
  v_and_b32 v17, 0xffff0000, v99
  v_pk_add_f32 v[14:15], v[14:15], v[16:17]
  s_waitcnt vmcnt(30)
  v_lshlrev_b32 v16, 16, v100
  v_and_b32 v17, 0xffff0000, v100
  v_pk_add_f32 v[8:9], v[8:9], v[16:17]
  v_lshlrev_b32 v16, 16, v101
  v_and_b32 v17, 0xffff0000, v101
  v_pk_add_f32 v[10:11], v[10:11], v[16:17]
  v_lshlrev_b32 v16, 16, v102
  v_and_b32 v17, 0xffff0000, v102
  v_pk_add_f32 v[12:13], v[12:13], v[16:17]
  v_lshlrev_b32 v16, 16, v103
  v_and_b32 v17, 0xffff0000, v103
  v_pk_add_f32 v[14:15], v[14:15], v[16:17]
  s_waitcnt vmcnt(29)
  v_lshlrev_b32 v16, 16, v104
  v_and_b32 v17, 0xffff0000, v104
  v_pk_add_f32 v[8:9], v[8:9], v[16:17]
  v_lshlrev_b32 v16, 16, v105
  v_and_b32 v17, 0xffff0000, v105
  v_pk_add_f32 v[10:11], v[10:11], v[16:17]
  v_lshlrev_b32 v16, 16, v106
  v_and_b32 v17, 0xffff0000, v106
  v_pk_add_f32 v[12:13], v[12:13], v[16:17]
  v_lshlrev_b32 v16, 16, v107
  v_and_b32 v17, 0xffff0000, v107
  v_pk_add_f32 v[14:15], v[14:15], v[16:17]
  s_waitcnt vmcnt(28)
  v_lshlrev_b32 v16, 16, v108
  v_and_b32 v17, 0xffff0000, v108
  v_pk_add_f32 v[8:9], v[8:9], v[16:17]
  v_lshlrev_b32 v16, 16, v109
  v_and_b32 v17, 0xffff0000, v109
  v_pk_add_f32 v[10:11], v[10:11], v[16:17]
  v_lshlrev_b32 v16, 16, v110
  v_and_b32 v17, 0xffff0000, v110
  v_pk_add_f32 v[12:13], v[12:13], v[16:17]
  v_lshlrev_b32 v16, 16, v111
  v_and_b32 v17, 0xffff0000, v111
  v_pk_add_f32 v[14:15], v[14:15], v[16:17]
  s_waitcnt vmcnt(27)
  v_lshlrev_b32 v16, 16, v112
  v_and_b32 v17, 0xffff0000, v112
  v_pk_add_f32 v[8:9], v[8:9], v[16:17]
  v_lshlrev_b32 v16, 16, v113
  v_and_b32 v17, 0xffff0000, v113
  v_pk_add_f32 v[10:11], v[10:11], v[16:17]
  v_lshlrev_b32 v16, 16, v114
  v_and_b32 v17, 0xffff0000, v114
  v_pk_add_f32 v[12:13], v[12:13], v[16:17]
  v_lshlrev_b32 v16, 16, v115
  v_and_b32 v17, 0xffff0000, v115
  v_pk_add_f32 v[14:15], v[14:15], v[16:17]
  s_waitcnt vmcnt(26)
  v_lshlrev_b32 v16, 16, v116
  v_and_b32 v17, 0xffff0000, v116
  v_pk_add_f32 v[8:9], v[8:9], v[16:17]
  v_lshlrev_b32 v16, 16, v117
  v_and_b32 v17, 0xffff0000, v117
  v_pk_add_f32 v[10:11], v[10:11], v[16:17]
  v_lshlrev_b32 v16, 16, v118
  v_and_b32 v17, 0xffff0000, v118
  v_pk_add_f32 v[12:13], v[12:13], v[16:17]
  v_lshlrev_b32 v16, 16, v119
  v_and_b32 v17, 0xffff0000, v119
  v_pk_add_f32 v[14:15], v[14:15], v[16:17]
  s_waitcnt vmcnt(25)
  v_lshlrev_b32 v16, 16, v120
  v_and_b32 v17, 0xffff0000, v120
  v_pk_add_f32 v[8:9], v[8:9], v[16:17]
  v_lshlrev_b32 v16, 16, v121
  v_and_b32 v17, 0xffff0000, v121
  v_pk_add_f32 v[10:11], v[10:11], v[16:17]
  v_lshlrev_b32 v16, 16, v122
  v_and_b32 v17, 0xffff0000, v122
  v_pk_add_f32 v[12:13], v[12:13], v[16:17]
  v_lshlrev_b32 v16, 16, v123
  v_and_b32 v17, 0xffff0000, v123
  v_pk_add_f32 v[14:15], v[14:15], v[16:17]
  s_waitcnt vmcnt(24)
  v_lshlrev_b32 v16, 16, v124
  v_and_b32 v17, 0xffff0000, v124
  v_pk_add_f32 v[8:9], v[8:9], v[16:17]
  v_lshlrev_b32 v16, 16, v125
  v_and_b32 v17, 0xffff0000, v125
  v_pk_add_f32 v[10:11], v[10:11], v[16:17]
  v_lshlrev_b32 v16, 16, v126
  v_and_b32 v17, 0xffff0000, v126
  v_pk_add_f32 v[12:13], v[12:13], v[16:17]
  v_lshlrev_b32 v16, 16, v127
  v_and_b32 v17, 0xffff0000, v127
  v_pk_add_f32 v[14:15], v[14:15], v[16:17]
  s_waitcnt vmcnt(23)
  v_lshlrev_b32 v16, 16, v128
  v_and_b32 v17, 0xffff0000, v128
  v_pk_add_f32 v[8:9], v[8:9], v[16:17]
  v_lshlrev_b32 v16, 16, v129
  v_and_b32 v17, 0xffff0000, v129
  v_pk_add_f32 v[10:11], v[10:11], v[16:17]
  v_lshlrev_b32 v16, 16, v130
  v_and_b32 v17, 0xffff0000, v130
  v_pk_add_f32 v[12:13], v[12:13], v[16:17]
  v_lshlrev_b32 v16, 16, v131
  v_and_b32 v17, 0xffff0000, v131
  v_pk_add_f32 v[14:15], v[14:15], v[16:17]
  s_waitcnt vmcnt(22)
  v_lshlrev_b32 v16, 16, v132
  v_and_b32 v17, 0xffff0000, v132
  v_pk_add_f32 v[8:9], v[8:9], v[16:17]
  v_lshlrev_b32 v16, 16, v133
  v_and_b32 v17, 0xffff0000, v133
  v_pk_add_f32 v[10:11], v[10:11], v[16:17]
  v_lshlrev_b32 v16, 16, v134
  v_and_b32 v17, 0xffff0000, v134
  v_pk_add_f32 v[12:13], v[12:13], v[16:17]
  v_lshlrev_b32 v16, 16, v135
  v_and_b32 v17, 0xffff0000, v135
  v_pk_add_f32 v[14:15], v[14:15], v[16:17]
  s_waitcnt vmcnt(21)
  v_lshlrev_b32 v16, 16, v136
  v_and_b32 v17, 0xffff0000, v136
  v_pk_add_f32 v[8:9], v[8:9], v[16:17]
  v_lshlrev_b32 v16, 16, v137
  v_and_b32 v17, 0xffff0000, v137
  v_pk_add_f32 v[10:11], v[10:11], v[16:17]
  v_lshlrev_b32 v16, 16, v138
  v_and_b32 v17, 0xffff0000, v138
  v_pk_add_f32 v[12:13], v[12:13], v[16:17]
  v_lshlrev_b32 v16, 16, v139
  v_and_b32 v17, 0xffff0000, v139
  v_pk_add_f32 v[14:15], v[14:15], v[16:17]
  s_waitcnt vmcnt(20)
  v_lshlrev_b32 v16, 16, v140
  v_and_b32 v17, 0xffff0000, v140
  v_pk_add_f32 v[8:9], v[8:9], v[16:17]
  v_lshlrev_b32 v16, 16, v141
  v_and_b32 v17, 0xffff0000, v141
  v_pk_add_f32 v[10:11], v[10:11], v[16:17]
  v_lshlrev_b32 v16, 16, v142
  v_and_b32 v17, 0xffff0000, v142
  v_pk_add_f32 v[12:13], v[12:13], v[16:17]
  v_lshlrev_b32 v16, 16, v143
  v_and_b32 v17, 0xffff0000, v143
  v_pk_add_f32 v[14:15], v[14:15], v[16:17]
  s_waitcnt vmcnt(19)
  v_lshlrev_b32 v16, 16, v144
  v_and_b32 v17, 0xffff0000, v144
  v_pk_add_f32 v[8:9], v[8:9], v[16:17]
  v_lshlrev_b32 v16, 16, v145
  v_and_b32 v17, 0xffff0000, v145
  v_pk_add_f32 v[10:11], v[10:11], v[16:17]
  v_lshlrev_b32 v16, 16, v146
  v_and_b32 v17, 0xffff0000, v146
  v_pk_add_f32 v[12:13], v[12:13], v[16:17]
  v_lshlrev_b32 v16, 16, v147
  v_and_b32 v17, 0xffff0000, v147
  v_pk_add_f32 v[14:15], v[14:15], v[16:17]
  s_waitcnt vmcnt(18)
  v_lshlrev_b32 v16, 16, v148
  v_and_b32 v17, 0xffff0000, v148
  v_pk_add_f32 v[8:9], v[8:9], v[16:17]
  v_lshlrev_b32 v16, 16, v149
  v_and_b32 v17, 0xffff0000, v149
  v_pk_add_f32 v[10:11], v[10:11], v[16:17]
  v_lshlrev_b32 v16, 16, v150
  v_and_b32 v17, 0xffff0000, v150
  v_pk_add_f32 v[12:13], v[12:13], v[16:17]
  v_lshlrev_b32 v16, 16, v151
  v_and_b32 v17, 0xffff0000, v151
  v_pk_add_f32 v[14:15], v[14:15], v[16:17]
  s_waitcnt vmcnt(17)
  v_lshlrev_b32 v16, 16, v152
  v_and_b32 v17, 0xffff0000, v152
  v_pk_add_f32 v[8:9], v[8:9], v[16:17]
  v_lshlrev_b32 v16, 16, v153
  v_and_b32 v17, 0xffff0000, v153
  v_pk_add_f32 v[10:11], v[10:11], v[16:17]
  v_lshlrev_b32 v16, 16, v154
  v_and_b32 v17, 0xffff0000, v154
  v_pk_add_f32 v[12:13], v[12:13], v[16:17]
  v_lshlrev_b32 v16, 16, v155
  v_and_b32 v17, 0xffff0000, v155
  v_pk_add_f32 v[14:15], v[14:15], v[16:17]
  s_waitcnt vmcnt(16)
  v_lshlrev_b32 v16, 16, v156
  v_and_b32 v17, 0xffff0000, v156
  v_pk_add_f32 v[8:9], v[8:9], v[16:17]
  v_lshlrev_b32 v16, 16, v157
  v_and_b32 v17, 0xffff0000, v157
  v_pk_add_f32 v[10:11], v[10:11], v[16:17]
  v_lshlrev_b32 v16, 16, v158
  v_and_b32 v17, 0xffff0000, v158
  v_pk_add_f32 v[12:13], v[12:13], v[16:17]
  v_lshlrev_b32 v16, 16, v159
  v_and_b32 v17, 0xffff0000, v159
  v_pk_add_f32 v[14:15], v[14:15], v[16:17]
  s_waitcnt vmcnt(15)
  v_lshlrev_b32 v16, 16, v160
  v_and_b32 v17, 0xffff0000, v160
  v_pk_add_f32 v[8:9], v[8:9], v[16:17]
  v_lshlrev_b32 v16, 16, v161
  v_and_b32 v17, 0xffff0000, v161
  v_pk_add_f32 v[10:11], v[10:11], v[16:17]
  v_lshlrev_b32 v16, 16, v162
  v_and_b32 v17, 0xffff0000, v162
  v_pk_add_f32 v[12:13], v[12:13], v[16:17]
  v_lshlrev_b32 v16, 16, v163
  v_and_b32 v17, 0xffff0000, v163
  v_pk_add_f32 v[14:15], v[14:15], v[16:17]
  s_waitcnt vmcnt(14)
  v_lshlrev_b32 v16, 16, v164
  v_and_b32 v17, 0xffff0000, v164
  v_pk_add_f32 v[8:9], v[8:9], v[16:17]
  v_lshlrev_b32 v16, 16, v165
  v_and_b32 v17, 0xffff0000, v165
  v_pk_add_f32 v[10:11], v[10:11], v[16:17]
  v_lshlrev_b32 v16, 16, v166
  v_and_b32 v17, 0xffff0000, v166
  v_pk_add_f32 v[12:13], v[12:13], v[16:17]
  v_lshlrev_b32 v16, 16, v167
  v_and_b32 v17, 0xffff0000, v167
  v_pk_add_f32 v[14:15], v[14:15], v[16:17]
  s_waitcnt vmcnt(13)
  v_lshlrev_b32 v16, 16, v168
  v_and_b32 v17, 0xffff0000, v168
  v_pk_add_f32 v[8:9], v[8:9], v[16:17]
  v_lshlrev_b32 v16, 16, v169
  v_and_b32 v17, 0xffff0000, v169
  v_pk_add_f32 v[10:11], v[10:11], v[16:17]
  v_lshlrev_b32 v16, 16, v170
  v_and_b32 v17, 0xffff0000, v170
  v_pk_add_f32 v[12:13], v[12:13], v[16:17]
  v_lshlrev_b32 v16, 16, v171
  v_and_b32 v17, 0xffff0000, v171
  v_pk_add_f32 v[14:15], v[14:15], v[16:17]
  s_waitcnt vmcnt(12)
  v_lshlrev_b32 v16, 16, v172
  v_and_b32 v17, 0xffff0000, v172
  v_pk_add_f32 v[8:9], v[8:9], v[16:17]
  v_lshlrev_b32 v16, 16, v173
  v_and_b32 v17, 0xffff0000, v173
  v_pk_add_f32 v[10:11], v[10:11], v[16:17]
  v_lshlrev_b32 v16, 16, v174
  v_and_b32 v17, 0xffff0000, v174
  v_pk_add_f32 v[12:13], v[12:13], v[16:17]
  v_lshlrev_b32 v16, 16, v175
  v_and_b32 v17, 0xffff0000, v175
  v_pk_add_f32 v[14:15], v[14:15], v[16:17]
  s_waitcnt vmcnt(11)
  v_lshlrev_b32 v16, 16, v176
  v_and_b32 v17, 0xffff0000, v176
  v_pk_add_f32 v[8:9], v[8:9], v[16:17]
  v_lshlrev_b32 v16, 16, v177
  v_and_b32 v17, 0xffff0000, v177
  v_pk_add_f32 v[10:11], v[10:11], v[16:17]
  v_lshlrev_b32 v16, 16, v178
  v_and_b32 v17, 0xffff0000, v178
  v_pk_add_f32 v[12:13], v[12:13], v[16:17]
  v_lshlrev_b32 v16, 16, v179
  v_and_b32 v17, 0xffff0000, v179
  v_pk_add_f32 v[14:15], v[14:15], v[16:17]
  s_waitcnt vmcnt(10)
  v_lshlrev_b32 v16, 16, v180
  v_and_b32 v17, 0xffff0000, v180
  v_pk_add_f32 v[8:9], v[8:9], v[16:17]
  v_lshlrev_b32 v16, 16, v181
  v_and_b32 v17, 0xffff0000, v181
  v_pk_add_f32 v[10:11], v[10:11], v[16:17]
  v_lshlrev_b32 v16, 16, v182
  v_and_b32 v17, 0xffff0000, v182
  v_pk_add_f32 v[12:13], v[12:13], v[16:17]
  v_lshlrev_b32 v16, 16, v183
  v_and_b32 v17, 0xffff0000, v183
  v_pk_add_f32 v[14:15], v[14:15], v[16:17]
  s_waitcnt vmcnt(9)
  v_lshlrev_b32 v16, 16, v184
  v_and_b32 v17, 0xffff0000, v184
  v_pk_add_f32 v[8:9], v[8:9], v[16:17]
  v_lshlrev_b32 v16, 16, v185
  v_and_b32 v17, 0xffff0000, v185
  v_pk_add_f32 v[10:11], v[10:11], v[16:17]
  v_lshlrev_b32 v16, 16, v186
  v_and_b32 v17, 0xffff0000, v186
  v_pk_add_f32 v[12:13], v[12:13], v[16:17]
  v_lshlrev_b32 v16, 16, v187
  v_and_b32 v17, 0xffff0000, v187
  v_pk_add_f32 v[14:15], v[14:15], v[16:17]
  s_waitcnt vmcnt(8)
  v_lshlrev_b32 v16, 16, v188
  v_and_b32 v17, 0xffff0000, v188
  v_pk_add_f32 v[8:9], v[8:9], v[16:17]
  v_lshlrev_b32 v16, 16, v189
  v_and_b32 v17, 0xffff0000, v189
  v_pk_add_f32 v[10:11], v[10:11], v[16:17]
  v_lshlrev_b32 v16, 16, v190
  v_and_b32 v17, 0xffff0000, v190
  v_pk_add_f32 v[12:13], v[12:13], v[16:17]
  v_lshlrev_b32 v16, 16, v191
  v_and_b32 v17, 0xffff0000, v191
  v_pk_add_f32 v[14:15], v[14:15], v[16:17]
  s_waitcnt vmcnt(7)
  v_lshlrev_b32 v16, 16, v192
  v_and_b32 v17, 0xffff0000, v192
  v_pk_add_f32 v[8:9], v[8:9], v[16:17]
  v_lshlrev_b32 v16, 16, v193
  v_and_b32 v17, 0xffff0000, v193
  v_pk_add_f32 v[10:11], v[10:11], v[16:17]
  v_lshlrev_b32 v16, 16, v194
  v_and_b32 v17, 0xffff0000, v194
  v_pk_add_f32 v[12:13], v[12:13], v[16:17]
  v_lshlrev_b32 v16, 16, v195
  v_and_b32 v17, 0xffff0000, v195
  v_pk_add_f32 v[14:15], v[14:15], v[16:17]
  s_waitcnt vmcnt(6)
  v_lshlrev_b32 v16, 16, v196
  v_and_b32 v17, 0xffff0000, v196
  v_pk_add_f32 v[8:9], v[8:9], v[16:17]
  v_lshlrev_b32 v16, 16, v197
  v_and_b32 v17, 0xffff0000, v197
  v_pk_add_f32 v[10:11], v[10:11], v[16:17]
  v_lshlrev_b32 v16, 16, v198
  v_and_b32 v17, 0xffff0000, v198
  v_pk_add_f32 v[12:13], v[12:13], v[16:17]
  v_lshlrev_b32 v16, 16, v199
  v_and_b32 v17, 0xffff0000, v199
  v_pk_add_f32 v[14:15], v[14:15], v[16:17]
  s_waitcnt vmcnt(5)
  v_lshlrev_b32 v16, 16, v200
  v_and_b32 v17, 0xffff0000, v200
  v_pk_add_f32 v[8:9], v[8:9], v[16:17]
  v_lshlrev_b32 v16, 16, v201
  v_and_b32 v17, 0xffff0000, v201
  v_pk_add_f32 v[10:11], v[10:11], v[16:17]
  v_lshlrev_b32 v16, 16, v202
  v_and_b32 v17, 0xffff0000, v202
  v_pk_add_f32 v[12:13], v[12:13], v[16:17]
  v_lshlrev_b32 v16, 16, v203
  v_and_b32 v17, 0xffff0000, v203
  v_pk_add_f32 v[14:15], v[14:15], v[16:17]
  s_waitcnt vmcnt(4)
  v_lshlrev_b32 v16, 16, v204
  v_and_b32 v17, 0xffff0000, v204
  v_pk_add_f32 v[8:9], v[8:9], v[16:17]
  v_lshlrev_b32 v16, 16, v205
  v_and_b32 v17, 0xffff0000, v205
  v_pk_add_f32 v[10:11], v[10:11], v[16:17]
  v_lshlrev_b32 v16, 16, v206
  v_and_b32 v17, 0xffff0000, v206
  v_pk_add_f32 v[12:13], v[12:13], v[16:17]
  v_lshlrev_b32 v16, 16, v207
  v_and_b32 v17, 0xffff0000, v207
  v_pk_add_f32 v[14:15], v[14:15], v[16:17]
  s_waitcnt vmcnt(3)
  v_lshlrev_b32 v16, 16, v208
  v_and_b32 v17, 0xffff0000, v208
  v_pk_add_f32 v[8:9], v[8:9], v[16:17]
  v_lshlrev_b32 v16, 16, v209
  v_and_b32 v17, 0xffff0000, v209
  v_pk_add_f32 v[10:11], v[10:11], v[16:17]
  v_lshlrev_b32 v16, 16, v210
  v_and_b32 v17, 0xffff0000, v210
  v_pk_add_f32 v[12:13], v[12:13], v[16:17]
  v_lshlrev_b32 v16, 16, v211
  v_and_b32 v17, 0xffff0000, v211
  v_pk_add_f32 v[14:15], v[14:15], v[16:17]
  s_waitcnt vmcnt(2)
  v_lshlrev_b32 v16, 16, v212
  v_and_b32 v17, 0xffff0000, v212
  v_pk_add_f32 v[8:9], v[8:9], v[16:17]
  v_lshlrev_b32 v16, 16, v213
  v_and_b32 v17, 0xffff0000, v213
  v_pk_add_f32 v[10:11], v[10:11], v[16:17]
  v_lshlrev_b32 v16, 16, v214
  v_and_b32 v17, 0xffff0000, v214
  v_pk_add_f32 v[12:13], v[12:13], v[16:17]
  v_lshlrev_b32 v16, 16, v215
  v_and_b32 v17, 0xffff0000, v215
  v_pk_add_f32 v[14:15], v[14:15], v[16:17]
  s_waitcnt vmcnt(1)
  v_lshlrev_b32 v16, 16, v216
  v_and_b32 v17, 0xffff0000, v216
  v_pk_add_f32 v[8:9], v[8:9], v[16:17]
  v_lshlrev_b32 v16, 16, v217
  v_and_b32 v17, 0xffff0000, v217
  v_pk_add_f32 v[10:11], v[10:11], v[16:17]
  v_lshlrev_b32 v16, 16, v218
  v_and_b32 v17, 0xffff0000, v218
  v_pk_add_f32 v[12:13], v[12:13], v[16:17]
  v_lshlrev_b32 v16, 16, v219
  v_and_b32 v17, 0xffff0000, v219
  v_pk_add_f32 v[14:15], v[14:15], v[16:17]
  s_waitcnt vmcnt(0)
  v_lshlrev_b32 v16, 16, v220
  v_and_b32 v17, 0xffff0000, v220
  v_pk_add_f32 v[8:9], v[8:9], v[16:17]
  v_lshlrev_b32 v16, 16, v221
  v_and_b32 v17, 0xffff0000, v221
  v_pk_add_f32 v[10:11], v[10:11], v[16:17]
  v_lshlrev_b32 v16, 16, v222
  v_and_b32 v17, 0xffff0000, v222
  v_pk_add_f32 v[12:13], v[12:13], v[16:17]
  v_lshlrev_b32 v16, 16, v223
  v_and_b32 v17, 0xffff0000, v223
  v_pk_add_f32 v[14:15], v[14:15], v[16:17]
  v_mov_b32 v16, v8
  v_mov_b32 v17, v9
  v_mov_b32 v18, v10
  v_mov_b32 v19, v11
  v_mov_b32 v20, v12
  v_mov_b32 v21, v13
  v_mov_b32 v22, v14
  v_mov_b32 v23, v15
  v_permlane32_swap_b32 v8, v16
  v_permlane32_swap_b32 v9, v17
  v_permlane32_swap_b32 v10, v18
  v_permlane32_swap_b32 v11, v19
  v_permlane32_swap_b32 v12, v20
  v_permlane32_swap_b32 v13, v21
  v_permlane32_swap_b32 v14, v22
  v_permlane32_swap_b32 v15, v23
  v_add_f32 v8, v8, v16
  v_add_f32 v9, v9, v17
  v_add_f32 v10, v10, v18
  v_add_f32 v11, v11, v19
  v_add_f32 v12, v12, v20
  v_add_f32 v13, v13, v21
  v_add_f32 v14, v14, v22
  v_add_f32 v15, v15, v23
  v_mov_b32 v16, v8
  v_mov_b32 v17, v9
  v_mov_b32 v18, v10
  v_mov_b32 v19, v11
  v_mov_b32 v20, v12
  v_mov_b32 v21, v13
  v_mov_b32 v22, v14
  v_mov_b32 v23, v15
  v_permlane16_swap_b32 v8, v16
  v_permlane16_swap_b32 v9, v17
  v_permlane16_swap_b32 v10, v18
  v_permlane16_swap_b32 v11, v19
  v_permlane16_swap_b32 v12, v20
  v_permlane16_swap_b32 v13, v21
  v_permlane16_swap_b32 v14, v22
  v_permlane16_swap_b32 v15, v23
  v_add_f32 v8, v8, v16
  v_add_f32 v9, v9, v17
  v_add_f32 v10, v10, v18
  v_add_f32 v11, v11, v19
  v_add_f32 v12, v12, v20
  v_add_f32 v13, v13, v21
  v_add_f32 v14, v14, v22
  v_add_f32 v15, v15, v23
  s_nop 1
  v_add_f32_dpp v8, v8, v8 row_ror:8 row_mask:0xf bank_mask:0xf
  v_add_f32_dpp v9, v9, v9 row_ror:8 row_mask:0xf bank_mask:0xf
  v_add_f32_dpp v10, v10, v10 row_ror:8 row_mask:0xf bank_mask:0xf
  v_add_f32_dpp v11, v11, v11 row_ror:8 row_mask:0xf bank_mask:0xf
  v_add_f32_dpp v12, v12, v12 row_ror:8 row_mask:0xf bank_mask:0xf
  v_add_f32_dpp v13, v13, v13 row_ror:8 row_mask:0xf bank_mask:0xf
  v_add_f32_dpp v14, v14, v14 row_ror:8 row_mask:0xf bank_mask:0xf
  v_add_f32_dpp v15, v15, v15 row_ror:8 row_mask:0xf bank_mask:0xf
  s_lshl_b32 s43, s24, 8
  v_lshlrev_b32 v3, 5, v3
  v_add_u32 v3, s43, v3
  ds_write_b128 v3, v[8:11]
  ds_write_b128 v3, v[12:15] offset:16
  s_waitcnt lgkmcnt(0)
  s_barrier
  s_cmp_lg_u32 s24, 0
  s_cbranch_scc1 Lprep_body_end
  v_lshlrev_b32 v3, 2, v47
  ds_read_b32 v8, v3 offset:0
  ds_read_b32 v9, v3 offset:256
  ds_read_b32 v10, v3 offset:512
  ds_read_b32 v11, v3 offset:768
  s_lshl_b32 s43, s52, 8
  s_add_u32 s53, s53, s43
  s_waitcnt lgkmcnt(0)
  v_add_f32 v8, v8, v9
  v_add_f32 v10, v10, v11
  v_add_f32 v8, v8, v10
  buffer_store_dword v8, v3, s[4:7], s53 offen
Lprep_body_end:
  s_endpgm
.globl qkv1_kernel
.p2align 8
.type qkv1_kernel,@function
qkv1_kernel:
  s_mov_b32 s40, 0x0
  s_mov_b32 s41, 0x2200000
  s_cmp_lt_u32 s2, 256
  s_cbranch_scc1 qkv_body
  s_endpgm
.globl qkv2_kernel
.p2align 8
.type qkv2_kernel,@function
qkv2_kernel:
  s_mov_b32 s40, 0x800000
  s_mov_b32 s41, 0x2280000
  s_cmp_lt_u32 s2, 256
  s_cbranch_scc1 qkv_body
  s_endpgm
.p2align 6
qkv_body:
  s_load_dwordx2 s[32:33], s[0:1], 72
  s_load_dwordx2 s[36:37], s[0:1], 8
  v_lshrrev_b32 v1, 6, v0
  v_and_b32 v123, 63, v0
  v_readfirstlane_b32 s24, v1
  s_and_b32 s34, s2, 7
  s_lshr_b32 s35, s2, 3
  s_and_b32 s25, s34, 1
  s_lshl_b32 s25, s25, 3
  s_and_b32 s43, s35, 7
  s_add_u32 s25, s25, s43
  s_lshr_b32 s26, s34, 1
  s_lshl_b32 s26, s26, 2
  s_lshr_b32 s43, s35, 3
  s_add_u32 s26, s26, s43
  s_lshr_b32 s27, s24, 1
  s_and_b32 s54, s24, 1
  v_lshlrev_b32 v119, 4, v123
  v_add_u32 v120, 30720, v119
  v_lshrrev_b32 v2, 3, v123
  v_bfe_u32 v3, v123, 1, 2
  v_lshrrev_b32 v4, 4, v123
  v_xor_b32 v3, v3, v4
  v_and_b32 v4, 1, v123
  v_mul_u32_u24 v2, 6144, v2
  v_lshl_add_u32 v2, v3, 5, v2
  v_lshl_add_u32 v121, v4, 4, v2
  v_add_u32 v122, 48128, v121
  v_lshrrev_b32 v2, 3, v123
  v_and_b32 v3, 7, v123
  v_lshlrev_b32 v2, 8, v2
  v_lshl_add_u32 v6, v3, 4, v2
  v_add_u32 v6, 128, v6
  s_lshl_b32 s44, s25, 3
  s_lshl_b32 s43, s24, 1
  s_add_u32 s28, s44, s43
  s_lshl_b32 s28, s28, 15
  s_add_u32 s28, s28, s40
  s_lshl_b32 s29, s26, 7
  s_mul_i32 s43, s24, 98304
  s_add_u32 s29, s29, s43
  s_add_u32 s30, s29, 4096
  s_lshl_b32 s50, s24, 12
  s_mul_i32 s51, s24, 6144
  s_and_b32 s43, s25, 7
  s_cmp_lg_u32 s43, 0
  s_cselect_b32 s43, 1, 0
  s_sub_u32 s45, s44, s43
  s_lshl_b32 s46, s45, 15
  s_add_u32 s46, s46, s40
  s_lshl_b32 s43, s24, 11
  s_add_u32 s46, s46, s43
  s_lshl_b32 s47, s24, 10
  s_add_u32 s47, s47, 122880
  s_waitcnt lgkmcnt(0)
  s_mov_b32 s4, s32
  s_mov_b32 s5, s33
  s_mov_b32 s6, 0x10000000
  s_mov_b32 s7, 0x20000
  s_mov_b32 s8, s36
  s_mov_b32 s9, s37
  s_mov_b32 s10, 0x600000
  s_mov_b32 s11, 0x20000
  s_add_u32 m0, s47, 0
  s_add_u32 s43, s46, 0
  buffer_load_dwordx4 v6, s[4:7], s43 offen lds
  s_add_u32 m0, s50, 0
  s_nop 0
  buffer_load_dwordx4 v119, s[4:7], s28 offen offset:0 lds
  buffer_load_dwordx4 v119, s[4:7], s28 offen offset:1024 lds
  buffer_load_dwordx4 v120, s[4:7], s28 offen offset:2048 lds
  buffer_load_dwordx4 v120, s[4:7], s28 offen offset:3072 lds
  s_add_u32 s28, s28, 2048
  s_add_u32 m0, s51, 49152
  s_nop 0
  buffer_load_dwordx4 v121, s[8:11], s29 offen offset:0 lds
  buffer_load_dwordx4 v122, s[8:11], s29 offen offset:1024 lds
  buffer_load_dwordx4 v121, s[8:11], s29 offen offset:2048 lds
  buffer_load_dwordx4 v122, s[8:11], s29 offen offset:3072 lds
  s_add_u32 s29, s29, 393216
  s_add_u32 m0, s51, 53248
  s_nop 0
  buffer_load_dwordx4 v121, s[8:11], s30 offen offset:0 lds
  buffer_load_dwordx4 v122, s[8:11], s30 offen offset:1024 lds
  s_add_u32 s30, s30, 393216
  s_lshl_b32 s43, s27, 13
  v_lshlrev_b32 v7, 4, v123
  v_add_u32 v112, s43, v7
  v_lshrrev_b32 v2, 4, v123
  v_and_b32 v3, 7, v123
  v_lshlrev_b32 v2, 7, v2
  v_lshl_add_u32 v2, v3, 4, v2
  v_add_u32 v2, 122880, v2
  v_add_u32 v3, 6144, v7
  s_cmp_eq_u32 s27, 0
  s_cselect_b64 vcc, 0, -1
  s_movk_i32 s43, 1024
  s_cselect_b32 s52, s43, 16384
  s_cselect_b32 s53, s43, -32768
  s_cselect_b32 s43, 512, s43
  v_cndmask_b32 v113, v2, v3, vcc
  v_add_u32 v114, s43, v113
  v_lshrrev_b32 v2, 2, v123
  v_bfe_u32 v3, v123, 3, 2
  v_and_b32 v4, 3, v123
  v_lshlrev_b32 v4, 3, v4
  v_lshl_add_u32 v4, v2, 7, v4
  v_add_u32 v4, 49152, v4
  s_lshl_b32 s43, s54, 1
  v_xor_b32 v5, s43, v3
  v_lshl_add_u32 v115, v5, 5, v4
  v_xor_b32 v5, 1, v5
  v_lshl_add_u32 v116, v5, 5, v4
  v_add_u32 v117, 49152, v115
  v_add_u32 v118, 49152, v116
  v_mov_b32 v0, 0
  v_mov_b32 v1, 0
  v_mov_b32 v2, 0
  v_mov_b32 v3, 0
  v_mov_b32 v4, 0
  v_mov_b32 v5, 0
  v_mov_b32 v7, 0
  v_mov_b32 v8, 0
  v_mov_b32 v9, 0
  v_mov_b32 v10, 0
  v_mov_b32 v11, 0
  v_mov_b32 v12, 0
  v_mov_b32 v13, 0
  v_mov_b32 v14, 0
  v_mov_b32 v15, 0
  v_mov_b32 v16, 0
  v_mov_b32 v17, 0
  v_mov_b32 v18, 0
  v_mov_b32 v19, 0
  v_mov_b32 v20, 0
  v_mov_b32 v21, 0
  v_mov_b32 v22, 0
  v_mov_b32 v23, 0
  v_mov_b32 v24, 0
  v_mov_b32 v25, 0
  v_mov_b32 v26, 0
  v_mov_b32 v27, 0
  v_mov_b32 v28, 0
  v_mov_b32 v29, 0
  v_mov_b32 v30, 0
  v_mov_b32 v31, 0
  v_mov_b32 v32, 0
  v_mov_b32 v33, 0
  v_mov_b32 v34, 0
  v_mov_b32 v35, 0
  v_mov_b32 v36, 0
  v_mov_b32 v37, 0
  v_mov_b32 v38, 0
  v_mov_b32 v39, 0
  v_mov_b32 v40, 0
  v_mov_b32 v41, 0
  v_mov_b32 v42, 0
  v_mov_b32 v43, 0
  v_mov_b32 v44, 0
  v_mov_b32 v45, 0
  v_mov_b32 v46, 0
  v_mov_b32 v47, 0
  v_mov_b32 v48, 0
  v_mov_b32 v49, 0
  v_mov_b32 v50, 0
  v_mov_b32 v51, 0
  v_mov_b32 v52, 0
  v_mov_b32 v53, 0
  v_mov_b32 v54, 0
  v_mov_b32 v55, 0
  v_mov_b32 v56, 0
  v_mov_b32 v57, 0
  v_mov_b32 v58, 0
  v_mov_b32 v59, 0
  v_mov_b32 v60, 0
  v_mov_b32 v61, 0
  v_mov_b32 v62, 0
  v_mov_b32 v63, 0
  v_mov_b32 v64, 0
  v_mov_b32 v65, 0
  v_mov_b32 v66, 0
  v_mov_b32 v67, 0
  v_mov_b32 v68, 0
  v_mov_b32 v69, 0
  v_mov_b32 v70, 0
  v_mov_b32 v71, 0
  v_mov_b32 v72, 0
  v_mov_b32 v73, 0
  v_mov_b32 v74, 0
  v_mov_b32 v75, 0
  v_mov_b32 v76, 0
  v_mov_b32 v77, 0
  v_mov_b32 v78, 0
  v_mov_b32 v79, 0
  v_mov_b32 v80, 0
  v_mov_b32 v81, 0
  v_mov_b32 v82, 0
  v_mov_b32 v83, 0
  v_mov_b32 v84, 0
  v_mov_b32 v85, 0
  v_mov_b32 v86, 0
  v_mov_b32 v87, 0
  v_mov_b32 v88, 0
  v_mov_b32 v89, 0
  v_mov_b32 v90, 0
  v_mov_b32 v91, 0
  v_mov_b32 v92, 0
  v_mov_b32 v93, 0
  v_mov_b32 v94, 0
  v_mov_b32 v95, 0
  v_mov_b32 v96, 0
  v_mov_b32 v97, 0
  v_mov_b32 v98, 0
  v_mov_b32 v99, 0
  v_mov_b32 v100, 0
  v_mov_b32 v101, 0
  v_mov_b32 v102, 0
  v_mov_b32 v103, 0
  v_mov_b32 v104, 0
  v_mov_b32 v105, 0
  v_mov_b32 v106, 0
  v_mov_b32 v107, 0
  v_mov_b32 v108, 0
  v_mov_b32 v109, 0
  v_mov_b32 v110, 0
  v_mov_b32 v111, 0
  s_add_u32 m0, s47, 4096
  s_add_u32 s43, s46, 8192
  buffer_load_dwordx4 v6, s[4:7], s43 offen lds
  s_add_u32 m0, s47, 8192
  s_add_u32 s43, s46, 16384
  buffer_load_dwordx4 v6, s[4:7], s43 offen lds
  s_add_u32 m0, s47, 12288
  s_add_u32 s43, s46, 24576
  buffer_load_dwordx4 v6, s[4:7], s43 offen lds
  s_add_u32 m0, s50, 16384
  s_nop 0
  buffer_load_dwordx4 v119, s[4:7], s28 offen offset:0 lds
  buffer_load_dwordx4 v119, s[4:7], s28 offen offset:1024 lds
  buffer_load_dwordx4 v120, s[4:7], s28 offen offset:2048 lds
  buffer_load_dwordx4 v120, s[4:7], s28 offen offset:3072 lds
  s_add_u32 s28, s28, 2048
  s_add_u32 m0, s51, 73728
  s_nop 0
  buffer_load_dwordx4 v121, s[8:11], s29 offen offset:0 lds
  buffer_load_dwordx4 v122, s[8:11], s29 offen offset:1024 lds
  buffer_load_dwordx4 v121, s[8:11], s29 offen offset:2048 lds
  buffer_load_dwordx4 v122, s[8:11], s29 offen offset:3072 lds
  s_add_u32 s29, s29, 393216
  s_add_u32 m0, s51, 77824
  s_nop 0
  buffer_load_dwordx4 v121, s[8:11], s30 offen offset:0 lds
  buffer_load_dwordx4 v122, s[8:11], s30 offen offset:1024 lds
  s_add_u32 s30, s30, 393216
  s_add_u32 m0, s50, 32768
  s_nop 0
  buffer_load_dwordx4 v119, s[4:7], s28 offen offset:0 lds
  buffer_load_dwordx4 v119, s[4:7], s28 offen offset:1024 lds
  buffer_load_dwordx4 v120, s[4:7], s28 offen offset:2048 lds
  buffer_load_dwordx4 v120, s[4:7], s28 offen offset:3072 lds
  s_add_u32 s28, s28, 2048
  s_add_u32 m0, s51, 98304
  s_nop 0
  buffer_load_dwordx4 v121, s[8:11], s29 offen offset:0 lds
  v_mov_b32 v6, 0
  s_waitcnt vmcnt(18)
  s_barrier
  ds_read_b64_tr_b16 a[20:21], v115 offset:0
  ds_read_b64_tr_b16 a[22:23], v115 offset:6144
  ds_read_b128 a[4:7], v112 offset:0
  ds_read_b128 a[8:11], v112 offset:2048
  ds_read_b128 a[12:15], v112 offset:4096
  ds_read_b128 a[16:19], v112 offset:6144
  ds_read_b64_tr_b16 a[24:25], v116 offset:0
  ds_read_b64_tr_b16 a[26:27], v116 offset:6144
  ds_read_b128 a[0:3], v113
  v_add_u32 v113, s52, v113
  ds_read_b64_tr_b16 a[28:29], v115 offset:2048
  ds_read_b64_tr_b16 a[30:31], v115 offset:8192
  ds_read_b64_tr_b16 a[32:33], v116 offset:2048
  ds_read_b64_tr_b16 a[34:35], v116 offset:8192
  ds_read_b64_tr_b16 a[36:37], v115 offset:4096
  ds_read_b64_tr_b16 a[38:39], v115 offset:10240
  ds_read_b64_tr_b16 a[40:41], v116 offset:4096
  ds_read_b64_tr_b16 a[42:43], v116 offset:10240
  s_mov_b32 s31, 4
.p2align 3
Lqkv_body_loop:
  s_waitcnt lgkmcnt(0)
  v_mfma_f32_16x16x32_bf16 v[0:3], a[20:23], a[4:7], v[0:3]
  ds_read_b64_tr_b16 a[64:65], v115 offset:12288
  v_mfma_f32_16x16x32_bf16 v[4:7], a[20:23], a[8:11], v[4:7]
  ds_read_b64_tr_b16 a[66:67], v115 offset:18432
  v_mfma_f32_16x16x32_bf16 v[8:11], a[20:23], a[12:15], v[8:11]
  ds_read_b128 a[48:51], v112 offset:1024
  v_mfma_f32_16x16x32_bf16 v[12:15], a[20:23], a[16:19], v[12:15]
  ds_read_b128 a[52:55], v112 offset:3072
  buffer_load_dwordx4 v122, s[8:11], s29 offen offset:1024 lds
  v_mfma_f32_16x16x32_bf16 v[28:31], a[24:27], a[16:19], v[28:31]
  ds_read_b128 a[56:59], v112 offset:5120
  v_mfma_f32_16x16x32_bf16 v[24:27], a[24:27], a[12:15], v[24:27]
  ds_read_b128 a[60:63], v112 offset:7168
  v_mfma_f32_16x16x32_bf16 v[20:23], a[24:27], a[8:11], v[20:23]
  ds_read_b64_tr_b16 a[68:69], v116 offset:12288
  v_mfma_f32_16x16x32_bf16 v[16:19], a[24:27], a[4:7], v[16:19]
  ds_read_b64_tr_b16 a[70:71], v116 offset:18432
  v_mfma_f32_16x16x32_bf16 v[32:35], a[28:31], a[0:3], v[32:35]
  ds_read_b128 a[44:47], v114
  v_add_u32 v114, s52, v114
  v_mfma_f32_16x16x32_bf16 v[36:39], a[28:31], a[4:7], v[36:39]
  ds_read_b64_tr_b16 a[72:73], v115 offset:14336
  buffer_load_dwordx4 v121, s[8:11], s29 offen offset:2048 lds
  v_mfma_f32_16x16x32_bf16 v[40:43], a[28:31], a[8:11], v[40:43]
  ds_read_b64_tr_b16 a[74:75], v115 offset:20480
  v_mfma_f32_16x16x32_bf16 v[44:47], a[28:31], a[12:15], v[44:47]
  ds_read_b64_tr_b16 a[76:77], v116 offset:14336
  v_mfma_f32_16x16x32_bf16 v[48:51], a[28:31], a[16:19], v[48:51]
  ds_read_b64_tr_b16 a[78:79], v116 offset:20480
  v_mfma_f32_16x16x32_bf16 v[68:71], a[32:35], a[16:19], v[68:71]
  ds_read_b64_tr_b16 a[80:81], v115 offset:16384
  v_mfma_f32_16x16x32_bf16 v[64:67], a[32:35], a[12:15], v[64:67]
  ds_read_b64_tr_b16 a[82:83], v115 offset:22528
  v_mfma_f32_16x16x32_bf16 v[60:63], a[32:35], a[8:11], v[60:63]
  ds_read_b64_tr_b16 a[84:85], v116 offset:16384
  buffer_load_dwordx4 v122, s[8:11], s29 offen offset:3072 lds
  s_add_u32 s29, s29, 393216
  v_mfma_f32_16x16x32_bf16 v[56:59], a[32:35], a[4:7], v[56:59]
  ds_read_b64_tr_b16 a[86:87], v116 offset:22528
  v_mfma_f32_16x16x32_bf16 v[52:55], a[32:35], a[0:3], v[52:55]
  v_mfma_f32_16x16x32_bf16 v[72:75], a[0:3], a[36:39], v[72:75]
  v_mfma_f32_16x16x32_bf16 v[76:79], a[4:7], a[36:39], v[76:79]
  v_mfma_f32_16x16x32_bf16 v[80:83], a[8:11], a[36:39], v[80:83]
  s_add_u32 m0, s51, 102400
  s_nop 0
  buffer_load_dwordx4 v121, s[8:11], s30 offen offset:0 lds
  v_mfma_f32_16x16x32_bf16 v[84:87], a[12:15], a[36:39], v[84:87]
  v_mfma_f32_16x16x32_bf16 v[88:91], a[16:19], a[36:39], v[88:91]
  v_mfma_f32_16x16x32_bf16 v[108:111], a[16:19], a[40:43], v[108:111]
  v_mfma_f32_16x16x32_bf16 v[104:107], a[12:15], a[40:43], v[104:107]
  buffer_load_dwordx4 v122, s[8:11], s30 offen offset:1024 lds
  s_add_u32 s30, s30, 393216
  v_mfma_f32_16x16x32_bf16 v[100:103], a[8:11], a[40:43], v[100:103]
  v_mfma_f32_16x16x32_bf16 v[96:99], a[4:7], a[40:43], v[96:99]
  v_mfma_f32_16x16x32_bf16 v[92:95], a[0:3], a[40:43], v[92:95]
  s_waitcnt lgkmcnt(0)
  v_mfma_f32_16x16x32_bf16 v[0:3], a[64:67], a[48:51], v[0:3]
  s_waitcnt vmcnt(10)
  s_barrier
  ds_read_b64_tr_b16 a[20:21], v115 offset:24576
  v_mfma_f32_16x16x32_bf16 v[4:7], a[64:67], a[52:55], v[4:7]
  ds_read_b64_tr_b16 a[22:23], v115 offset:30720
  v_mfma_f32_16x16x32_bf16 v[8:11], a[64:67], a[56:59], v[8:11]
  ds_read_b128 a[4:7], v112 offset:16384
  v_mfma_f32_16x16x32_bf16 v[12:15], a[64:67], a[60:63], v[12:15]
  ds_read_b128 a[8:11], v112 offset:18432
  s_add_u32 m0, s50, 0
  s_nop 0
  buffer_load_dwordx4 v119, s[4:7], s28 offen offset:0 lds
  v_mfma_f32_16x16x32_bf16 v[28:31], a[68:71], a[60:63], v[28:31]
  ds_read_b128 a[12:15], v112 offset:20480
  v_mfma_f32_16x16x32_bf16 v[24:27], a[68:71], a[56:59], v[24:27]
  ds_read_b128 a[16:19], v112 offset:22528
  v_mfma_f32_16x16x32_bf16 v[20:23], a[68:71], a[52:55], v[20:23]
  ds_read_b64_tr_b16 a[24:25], v116 offset:24576
  v_mfma_f32_16x16x32_bf16 v[16:19], a[68:71], a[48:51], v[16:19]
  ds_read_b64_tr_b16 a[26:27], v116 offset:30720
  v_mfma_f32_16x16x32_bf16 v[32:35], a[72:75], a[44:47], v[32:35]
  ds_read_b128 a[0:3], v113
  v_add_u32 v113, s52, v113
  v_mfma_f32_16x16x32_bf16 v[36:39], a[72:75], a[48:51], v[36:39]
  ds_read_b64_tr_b16 a[28:29], v115 offset:26624
  buffer_load_dwordx4 v119, s[4:7], s28 offen offset:1024 lds
  v_mfma_f32_16x16x32_bf16 v[40:43], a[72:75], a[52:55], v[40:43]
  ds_read_b64_tr_b16 a[30:31], v115 offset:32768
  v_mfma_f32_16x16x32_bf16 v[44:47], a[72:75], a[56:59], v[44:47]
  ds_read_b64_tr_b16 a[32:33], v116 offset:26624
  v_mfma_f32_16x16x32_bf16 v[48:51], a[72:75], a[60:63], v[48:51]
  ds_read_b64_tr_b16 a[34:35], v116 offset:32768
  v_mfma_f32_16x16x32_bf16 v[68:71], a[76:79], a[60:63], v[68:71]
  ds_read_b64_tr_b16 a[36:37], v115 offset:28672
  v_mfma_f32_16x16x32_bf16 v[64:67], a[76:79], a[56:59], v[64:67]
  ds_read_b64_tr_b16 a[38:39], v115 offset:34816
  v_mfma_f32_16x16x32_bf16 v[60:63], a[76:79], a[52:55], v[60:63]
  ds_read_b64_tr_b16 a[40:41], v116 offset:28672
  buffer_load_dwordx4 v120, s[4:7], s28 offen offset:2048 lds
  v_mfma_f32_16x16x32_bf16 v[56:59], a[76:79], a[48:51], v[56:59]
  ds_read_b64_tr_b16 a[42:43], v116 offset:34816
  v_mfma_f32_16x16x32_bf16 v[52:55], a[76:79], a[44:47], v[52:55]
  v_mfma_f32_16x16x32_bf16 v[72:75], a[44:47], a[80:83], v[72:75]
  v_mfma_f32_16x16x32_bf16 v[76:79], a[48:51], a[80:83], v[76:79]
  v_mfma_f32_16x16x32_bf16 v[80:83], a[52:55], a[80:83], v[80:83]
  buffer_load_dwordx4 v120, s[4:7], s28 offen offset:3072 lds
  s_add_u32 s28, s28, 2048
  v_mfma_f32_16x16x32_bf16 v[84:87], a[56:59], a[80:83], v[84:87]
  v_mfma_f32_16x16x32_bf16 v[88:91], a[60:63], a[80:83], v[88:91]
  v_mfma_f32_16x16x32_bf16 v[108:111], a[60:63], a[84:87], v[108:111]
  v_mfma_f32_16x16x32_bf16 v[104:107], a[56:59], a[84:87], v[104:107]
  s_add_u32 m0, s51, 49152
  s_nop 0
  buffer_load_dwordx4 v121, s[8:11], s29 offen offset:0 lds
  v_mfma_f32_16x16x32_bf16 v[100:103], a[52:55], a[84:87], v[100:103]
  v_mfma_f32_16x16x32_bf16 v[96:99], a[48:51], a[84:87], v[96:99]
  v_mfma_f32_16x16x32_bf16 v[92:95], a[44:47], a[84:87], v[92:95]
  s_waitcnt lgkmcnt(0)
  v_mfma_f32_16x16x32_bf16 v[0:3], a[20:23], a[4:7], v[0:3]
  ds_read_b64_tr_b16 a[64:65], v115 offset:36864
  v_mfma_f32_16x16x32_bf16 v[4:7], a[20:23], a[8:11], v[4:7]
  ds_read_b64_tr_b16 a[66:67], v115 offset:43008
  v_mfma_f32_16x16x32_bf16 v[8:11], a[20:23], a[12:15], v[8:11]
  ds_read_b128 a[48:51], v112 offset:17408
  v_mfma_f32_16x16x32_bf16 v[12:15], a[20:23], a[16:19], v[12:15]
  ds_read_b128 a[52:55], v112 offset:19456
  buffer_load_dwordx4 v122, s[8:11], s29 offen offset:1024 lds
  v_mfma_f32_16x16x32_bf16 v[28:31], a[24:27], a[16:19], v[28:31]
  ds_read_b128 a[56:59], v112 offset:21504
  v_mfma_f32_16x16x32_bf16 v[24:27], a[24:27], a[12:15], v[24:27]
  ds_read_b128 a[60:63], v112 offset:23552
  v_mfma_f32_16x16x32_bf16 v[20:23], a[24:27], a[8:11], v[20:23]
  ds_read_b64_tr_b16 a[68:69], v116 offset:36864
  v_mfma_f32_16x16x32_bf16 v[16:19], a[24:27], a[4:7], v[16:19]
  ds_read_b64_tr_b16 a[70:71], v116 offset:43008
  v_mfma_f32_16x16x32_bf16 v[32:35], a[28:31], a[0:3], v[32:35]
  ds_read_b128 a[44:47], v114
  v_add_u32 v114, s52, v114
  v_mfma_f32_16x16x32_bf16 v[36:39], a[28:31], a[4:7], v[36:39]
  ds_read_b64_tr_b16 a[72:73], v115 offset:38912
  buffer_load_dwordx4 v121, s[8:11], s29 offen offset:2048 lds
  v_mfma_f32_16x16x32_bf16 v[40:43], a[28:31], a[8:11], v[40:43]
  ds_read_b64_tr_b16 a[74:75], v115 offset:45056
  v_mfma_f32_16x16x32_bf16 v[44:47], a[28:31], a[12:15], v[44:47]
  ds_read_b64_tr_b16 a[76:77], v116 offset:38912
  v_mfma_f32_16x16x32_bf16 v[48:51], a[28:31], a[16:19], v[48:51]
  ds_read_b64_tr_b16 a[78:79], v116 offset:45056
  v_mfma_f32_16x16x32_bf16 v[68:71], a[32:35], a[16:19], v[68:71]
  ds_read_b64_tr_b16 a[80:81], v115 offset:40960
  v_mfma_f32_16x16x32_bf16 v[64:67], a[32:35], a[12:15], v[64:67]
  ds_read_b64_tr_b16 a[82:83], v115 offset:47104
  v_mfma_f32_16x16x32_bf16 v[60:63], a[32:35], a[8:11], v[60:63]
  ds_read_b64_tr_b16 a[84:85], v116 offset:40960
  buffer_load_dwordx4 v122, s[8:11], s29 offen offset:3072 lds
  s_add_u32 s29, s29, 393216
  v_mfma_f32_16x16x32_bf16 v[56:59], a[32:35], a[4:7], v[56:59]
  ds_read_b64_tr_b16 a[86:87], v116 offset:47104
  v_mfma_f32_16x16x32_bf16 v[52:55], a[32:35], a[0:3], v[52:55]
  v_mfma_f32_16x16x32_bf16 v[72:75], a[0:3], a[36:39], v[72:75]
  v_mfma_f32_16x16x32_bf16 v[76:79], a[4:7], a[36:39], v[76:79]
  v_mfma_f32_16x16x32_bf16 v[80:83], a[8:11], a[36:39], v[80:83]
  s_add_u32 m0, s51, 53248
  s_nop 0
  buffer_load_dwordx4 v121, s[8:11], s30 offen offset:0 lds
  v_mfma_f32_16x16x32_bf16 v[84:87], a[12:15], a[36:39], v[84:87]
  v_mfma_f32_16x16x32_bf16 v[88:91], a[16:19], a[36:39], v[88:91]
  v_mfma_f32_16x16x32_bf16 v[108:111], a[16:19], a[40:43], v[108:111]
  v_mfma_f32_16x16x32_bf16 v[104:107], a[12:15], a[40:43], v[104:107]
  buffer_load_dwordx4 v122, s[8:11], s30 offen offset:1024 lds
  s_add_u32 s30, s30, 393216
  v_mfma_f32_16x16x32_bf16 v[100:103], a[8:11], a[40:43], v[100:103]
  v_mfma_f32_16x16x32_bf16 v[96:99], a[4:7], a[40:43], v[96:99]
  v_mfma_f32_16x16x32_bf16 v[92:95], a[0:3], a[40:43], v[92:95]
  s_waitcnt lgkmcnt(0)
  v_mfma_f32_16x16x32_bf16 v[0:3], a[64:67], a[48:51], v[0:3]
  s_waitcnt vmcnt(10)
  s_barrier
  ds_read_b64_tr_b16 a[20:21], v117 offset:0
  v_mfma_f32_16x16x32_bf16 v[4:7], a[64:67], a[52:55], v[4:7]
  ds_read_b64_tr_b16 a[22:23], v117 offset:6144
  v_mfma_f32_16x16x32_bf16 v[8:11], a[64:67], a[56:59], v[8:11]
  ds_read_b128 a[4:7], v112 offset:32768
  v_mfma_f32_16x16x32_bf16 v[12:15], a[64:67], a[60:63], v[12:15]
  ds_read_b128 a[8:11], v112 offset:34816
  s_add_u32 m0, s50, 16384
  s_nop 0
  buffer_load_dwordx4 v119, s[4:7], s28 offen offset:0 lds
  v_mfma_f32_16x16x32_bf16 v[28:31], a[68:71], a[60:63], v[28:31]
  ds_read_b128 a[12:15], v112 offset:36864
  v_mfma_f32_16x16x32_bf16 v[24:27], a[68:71], a[56:59], v[24:27]
  ds_read_b128 a[16:19], v112 offset:38912
  v_mfma_f32_16x16x32_bf16 v[20:23], a[68:71], a[52:55], v[20:23]
  ds_read_b64_tr_b16 a[24:25], v118 offset:0
  v_mfma_f32_16x16x32_bf16 v[16:19], a[68:71], a[48:51], v[16:19]
  ds_read_b64_tr_b16 a[26:27], v118 offset:6144
  v_mfma_f32_16x16x32_bf16 v[32:35], a[72:75], a[44:47], v[32:35]
  ds_read_b128 a[0:3], v113
  v_add_u32 v113, s53, v113
  v_mfma_f32_16x16x32_bf16 v[36:39], a[72:75], a[48:51], v[36:39]
  ds_read_b64_tr_b16 a[28:29], v117 offset:2048
  buffer_load_dwordx4 v119, s[4:7], s28 offen offset:1024 lds
  v_mfma_f32_16x16x32_bf16 v[40:43], a[72:75], a[52:55], v[40:43]
  ds_read_b64_tr_b16 a[30:31], v117 offset:8192
  v_mfma_f32_16x16x32_bf16 v[44:47], a[72:75], a[56:59], v[44:47]
  ds_read_b64_tr_b16 a[32:33], v118 offset:2048
  v_mfma_f32_16x16x32_bf16 v[48:51], a[72:75], a[60:63], v[48:51]
  ds_read_b64_tr_b16 a[34:35], v118 offset:8192
  v_mfma_f32_16x16x32_bf16 v[68:71], a[76:79], a[60:63], v[68:71]
  ds_read_b64_tr_b16 a[36:37], v117 offset:4096
  v_mfma_f32_16x16x32_bf16 v[64:67], a[76:79], a[56:59], v[64:67]
  ds_read_b64_tr_b16 a[38:39], v117 offset:10240
  v_mfma_f32_16x16x32_bf16 v[60:63], a[76:79], a[52:55], v[60:63]
  ds_read_b64_tr_b16 a[40:41], v118 offset:4096
  buffer_load_dwordx4 v120, s[4:7], s28 offen offset:2048 lds
  v_mfma_f32_16x16x32_bf16 v[56:59], a[76:79], a[48:51], v[56:59]
  ds_read_b64_tr_b16 a[42:43], v118 offset:10240
  v_mfma_f32_16x16x32_bf16 v[52:55], a[76:79], a[44:47], v[52:55]
  v_mfma_f32_16x16x32_bf16 v[72:75], a[44:47], a[80:83], v[72:75]
  v_mfma_f32_16x16x32_bf16 v[76:79], a[48:51], a[80:83], v[76:79]
  v_mfma_f32_16x16x32_bf16 v[80:83], a[52:55], a[80:83], v[80:83]
  buffer_load_dwordx4 v120, s[4:7], s28 offen offset:3072 lds
  s_add_u32 s28, s28, 2048
  v_mfma_f32_16x16x32_bf16 v[84:87], a[56:59], a[80:83], v[84:87]
  v_mfma_f32_16x16x32_bf16 v[88:91], a[60:63], a[80:83], v[88:91]
  v_mfma_f32_16x16x32_bf16 v[108:111], a[60:63], a[84:87], v[108:111]
  v_mfma_f32_16x16x32_bf16 v[104:107], a[56:59], a[84:87], v[104:107]
  s_add_u32 m0, s51, 73728
  s_nop 0
  buffer_load_dwordx4 v121, s[8:11], s29 offen offset:0 lds
  v_mfma_f32_16x16x32_bf16 v[100:103], a[52:55], a[84:87], v[100:103]
  v_mfma_f32_16x16x32_bf16 v[96:99], a[48:51], a[84:87], v[96:99]
  v_mfma_f32_16x16x32_bf16 v[92:95], a[44:47], a[84:87], v[92:95]
  s_waitcnt lgkmcnt(0)
  v_mfma_f32_16x16x32_bf16 v[0:3], a[20:23], a[4:7], v[0:3]
  ds_read_b64_tr_b16 a[64:65], v117 offset:12288
  v_mfma_f32_16x16x32_bf16 v[4:7], a[20:23], a[8:11], v[4:7]
  ds_read_b64_tr_b16 a[66:67], v117 offset:18432
  v_mfma_f32_16x16x32_bf16 v[8:11], a[20:23], a[12:15], v[8:11]
  ds_read_b128 a[48:51], v112 offset:33792
  v_mfma_f32_16x16x32_bf16 v[12:15], a[20:23], a[16:19], v[12:15]
  ds_read_b128 a[52:55], v112 offset:35840
  buffer_load_dwordx4 v122, s[8:11], s29 offen offset:1024 lds
  v_mfma_f32_16x16x32_bf16 v[28:31], a[24:27], a[16:19], v[28:31]
  ds_read_b128 a[56:59], v112 offset:37888
  v_mfma_f32_16x16x32_bf16 v[24:27], a[24:27], a[12:15], v[24:27]
  ds_read_b128 a[60:63], v112 offset:39936
  v_mfma_f32_16x16x32_bf16 v[20:23], a[24:27], a[8:11], v[20:23]
  ds_read_b64_tr_b16 a[68:69], v118 offset:12288
  v_mfma_f32_16x16x32_bf16 v[16:19], a[24:27], a[4:7], v[16:19]
  ds_read_b64_tr_b16 a[70:71], v118 offset:18432
  v_mfma_f32_16x16x32_bf16 v[32:35], a[28:31], a[0:3], v[32:35]
  ds_read_b128 a[44:47], v114
  v_add_u32 v114, s53, v114
  v_mfma_f32_16x16x32_bf16 v[36:39], a[28:31], a[4:7], v[36:39]
  ds_read_b64_tr_b16 a[72:73], v117 offset:14336
  buffer_load_dwordx4 v121, s[8:11], s29 offen offset:2048 lds
  v_mfma_f32_16x16x32_bf16 v[40:43], a[28:31], a[8:11], v[40:43]
  ds_read_b64_tr_b16 a[74:75], v117 offset:20480
  v_mfma_f32_16x16x32_bf16 v[44:47], a[28:31], a[12:15], v[44:47]
  ds_read_b64_tr_b16 a[76:77], v118 offset:14336
  v_mfma_f32_16x16x32_bf16 v[48:51], a[28:31], a[16:19], v[48:51]
  ds_read_b64_tr_b16 a[78:79], v118 offset:20480
  v_mfma_f32_16x16x32_bf16 v[68:71], a[32:35], a[16:19], v[68:71]
  ds_read_b64_tr_b16 a[80:81], v117 offset:16384
  v_mfma_f32_16x16x32_bf16 v[64:67], a[32:35], a[12:15], v[64:67]
  ds_read_b64_tr_b16 a[82:83], v117 offset:22528
  v_mfma_f32_16x16x32_bf16 v[60:63], a[32:35], a[8:11], v[60:63]
  ds_read_b64_tr_b16 a[84:85], v118 offset:16384
  buffer_load_dwordx4 v122, s[8:11], s29 offen offset:3072 lds
  s_add_u32 s29, s29, 393216
  v_mfma_f32_16x16x32_bf16 v[56:59], a[32:35], a[4:7], v[56:59]
  ds_read_b64_tr_b16 a[86:87], v118 offset:22528
  v_mfma_f32_16x16x32_bf16 v[52:55], a[32:35], a[0:3], v[52:55]
  v_mfma_f32_16x16x32_bf16 v[72:75], a[0:3], a[36:39], v[72:75]
  v_mfma_f32_16x16x32_bf16 v[76:79], a[4:7], a[36:39], v[76:79]
  v_mfma_f32_16x16x32_bf16 v[80:83], a[8:11], a[36:39], v[80:83]
  s_add_u32 m0, s51, 77824
  s_nop 0
  buffer_load_dwordx4 v121, s[8:11], s30 offen offset:0 lds
  v_mfma_f32_16x16x32_bf16 v[84:87], a[12:15], a[36:39], v[84:87]
  v_mfma_f32_16x16x32_bf16 v[88:91], a[16:19], a[36:39], v[88:91]
  v_mfma_f32_16x16x32_bf16 v[108:111], a[16:19], a[40:43], v[108:111]
  v_mfma_f32_16x16x32_bf16 v[104:107], a[12:15], a[40:43], v[104:107]
  buffer_load_dwordx4 v122, s[8:11], s30 offen offset:1024 lds
  s_add_u32 s30, s30, 393216
  v_mfma_f32_16x16x32_bf16 v[100:103], a[8:11], a[40:43], v[100:103]
  v_mfma_f32_16x16x32_bf16 v[96:99], a[4:7], a[40:43], v[96:99]
  v_mfma_f32_16x16x32_bf16 v[92:95], a[0:3], a[40:43], v[92:95]
  s_waitcnt lgkmcnt(0)
  v_mfma_f32_16x16x32_bf16 v[0:3], a[64:67], a[48:51], v[0:3]
  s_waitcnt vmcnt(10)
  s_barrier
  ds_read_b64_tr_b16 a[20:21], v115 offset:0
  v_mfma_f32_16x16x32_bf16 v[4:7], a[64:67], a[52:55], v[4:7]
  ds_read_b64_tr_b16 a[22:23], v115 offset:6144
  v_mfma_f32_16x16x32_bf16 v[8:11], a[64:67], a[56:59], v[8:11]
  ds_read_b128 a[4:7], v112 offset:0
  v_mfma_f32_16x16x32_bf16 v[12:15], a[64:67], a[60:63], v[12:15]
  ds_read_b128 a[8:11], v112 offset:2048
  s_add_u32 m0, s50, 32768
  s_nop 0
  buffer_load_dwordx4 v119, s[4:7], s28 offen offset:0 lds
  v_mfma_f32_16x16x32_bf16 v[28:31], a[68:71], a[60:63], v[28:31]
  ds_read_b128 a[12:15], v112 offset:4096
  v_mfma_f32_16x16x32_bf16 v[24:27], a[68:71], a[56:59], v[24:27]
  ds_read_b128 a[16:19], v112 offset:6144
  v_mfma_f32_16x16x32_bf16 v[20:23], a[68:71], a[52:55], v[20:23]
  ds_read_b64_tr_b16 a[24:25], v116 offset:0
  v_mfma_f32_16x16x32_bf16 v[16:19], a[68:71], a[48:51], v[16:19]
  ds_read_b64_tr_b16 a[26:27], v116 offset:6144
  v_mfma_f32_16x16x32_bf16 v[32:35], a[72:75], a[44:47], v[32:35]
  ds_read_b128 a[0:3], v113
  v_add_u32 v113, s52, v113
  v_mfma_f32_16x16x32_bf16 v[36:39], a[72:75], a[48:51], v[36:39]
  ds_read_b64_tr_b16 a[28:29], v115 offset:2048
  buffer_load_dwordx4 v119, s[4:7], s28 offen offset:1024 lds
  v_mfma_f32_16x16x32_bf16 v[40:43], a[72:75], a[52:55], v[40:43]
  ds_read_b64_tr_b16 a[30:31], v115 offset:8192
  v_mfma_f32_16x16x32_bf16 v[44:47], a[72:75], a[56:59], v[44:47]
  ds_read_b64_tr_b16 a[32:33], v116 offset:2048
  v_mfma_f32_16x16x32_bf16 v[48:51], a[72:75], a[60:63], v[48:51]
  ds_read_b64_tr_b16 a[34:35], v116 offset:8192
  v_mfma_f32_16x16x32_bf16 v[68:71], a[76:79], a[60:63], v[68:71]
  ds_read_b64_tr_b16 a[36:37], v115 offset:4096
  v_mfma_f32_16x16x32_bf16 v[64:67], a[76:79], a[56:59], v[64:67]
  ds_read_b64_tr_b16 a[38:39], v115 offset:10240
  v_mfma_f32_16x16x32_bf16 v[60:63], a[76:79], a[52:55], v[60:63]
  ds_read_b64_tr_b16 a[40:41], v116 offset:4096
  buffer_load_dwordx4 v120, s[4:7], s28 offen offset:2048 lds
  v_mfma_f32_16x16x32_bf16 v[56:59], a[76:79], a[48:51], v[56:59]
  ds_read_b64_tr_b16 a[42:43], v116 offset:10240
  v_mfma_f32_16x16x32_bf16 v[52:55], a[76:79], a[44:47], v[52:55]
  v_mfma_f32_16x16x32_bf16 v[72:75], a[44:47], a[80:83], v[72:75]
  v_mfma_f32_16x16x32_bf16 v[76:79], a[48:51], a[80:83], v[76:79]
  v_mfma_f32_16x16x32_bf16 v[80:83], a[52:55], a[80:83], v[80:83]
  buffer_load_dwordx4 v120, s[4:7], s28 offen offset:3072 lds
  s_add_u32 s28, s28, 2048
  v_mfma_f32_16x16x32_bf16 v[84:87], a[56:59], a[80:83], v[84:87]
  v_mfma_f32_16x16x32_bf16 v[88:91], a[60:63], a[80:83], v[88:91]
  v_mfma_f32_16x16x32_bf16 v[108:111], a[60:63], a[84:87], v[108:111]
  v_mfma_f32_16x16x32_bf16 v[104:107], a[56:59], a[84:87], v[104:107]
  s_add_u32 m0, s51, 98304
  s_nop 0
  buffer_load_dwordx4 v121, s[8:11], s29 offen offset:0 lds
  v_mfma_f32_16x16x32_bf16 v[100:103], a[52:55], a[84:87], v[100:103]
  v_mfma_f32_16x16x32_bf16 v[96:99], a[48:51], a[84:87], v[96:99]
  v_mfma_f32_16x16x32_bf16 v[92:95], a[44:47], a[84:87], v[92:95]
  s_sub_u32 s31, s31, 1
  s_cmp_lg_u32 s31, 0
  s_cbranch_scc1 Lqkv_body_loop
  s_waitcnt lgkmcnt(0)
  v_mfma_f32_16x16x32_bf16 v[0:3], a[20:23], a[4:7], v[0:3]
  ds_read_b64_tr_b16 a[64:65], v115 offset:12288
  v_mfma_f32_16x16x32_bf16 v[4:7], a[20:23], a[8:11], v[4:7]
  ds_read_b64_tr_b16 a[66:67], v115 offset:18432
  v_mfma_f32_16x16x32_bf16 v[8:11], a[20:23], a[12:15], v[8:11]
  ds_read_b128 a[48:51], v112 offset:1024
  v_mfma_f32_16x16x32_bf16 v[12:15], a[20:23], a[16:19], v[12:15]
  ds_read_b128 a[52:55], v112 offset:3072
  buffer_load_dwordx4 v122, s[8:11], s29 offen offset:1024 lds
  v_mfma_f32_16x16x32_bf16 v[28:31], a[24:27], a[16:19], v[28:31]
  ds_read_b128 a[56:59], v112 offset:5120
  v_mfma_f32_16x16x32_bf16 v[24:27], a[24:27], a[12:15], v[24:27]
  ds_read_b128 a[60:63], v112 offset:7168
  v_mfma_f32_16x16x32_bf16 v[20:23], a[24:27], a[8:11], v[20:23]
  ds_read_b64_tr_b16 a[68:69], v116 offset:12288
  v_mfma_f32_16x16x32_bf16 v[16:19], a[24:27], a[4:7], v[16:19]
  ds_read_b64_tr_b16 a[70:71], v116 offset:18432
  v_mfma_f32_16x16x32_bf16 v[32:35], a[28:31], a[0:3], v[32:35]
  ds_read_b128 a[44:47], v114
  v_add_u32 v114, s52, v114
  v_mfma_f32_16x16x32_bf16 v[36:39], a[28:31], a[4:7], v[36:39]
  ds_read_b64_tr_b16 a[72:73], v115 offset:14336
  buffer_load_dwordx4 v121, s[8:11], s29 offen offset:2048 lds
  v_mfma_f32_16x16x32_bf16 v[40:43], a[28:31], a[8:11], v[40:43]
  ds_read_b64_tr_b16 a[74:75], v115 offset:20480
  v_mfma_f32_16x16x32_bf16 v[44:47], a[28:31], a[12:15], v[44:47]
  ds_read_b64_tr_b16 a[76:77], v116 offset:14336
  v_mfma_f32_16x16x32_bf16 v[48:51], a[28:31], a[16:19], v[48:51]
  ds_read_b64_tr_b16 a[78:79], v116 offset:20480
  v_mfma_f32_16x16x32_bf16 v[68:71], a[32:35], a[16:19], v[68:71]
  ds_read_b64_tr_b16 a[80:81], v115 offset:16384
  v_mfma_f32_16x16x32_bf16 v[64:67], a[32:35], a[12:15], v[64:67]
  ds_read_b64_tr_b16 a[82:83], v115 offset:22528
  v_mfma_f32_16x16x32_bf16 v[60:63], a[32:35], a[8:11], v[60:63]
  ds_read_b64_tr_b16 a[84:85], v116 offset:16384
  buffer_load_dwordx4 v122, s[8:11], s29 offen offset:3072 lds
  s_add_u32 s29, s29, 393216
  v_mfma_f32_16x16x32_bf16 v[56:59], a[32:35], a[4:7], v[56:59]
  ds_read_b64_tr_b16 a[86:87], v116 offset:22528
  v_mfma_f32_16x16x32_bf16 v[52:55], a[32:35], a[0:3], v[52:55]
  v_mfma_f32_16x16x32_bf16 v[72:75], a[0:3], a[36:39], v[72:75]
  v_mfma_f32_16x16x32_bf16 v[76:79], a[4:7], a[36:39], v[76:79]
  v_mfma_f32_16x16x32_bf16 v[80:83], a[8:11], a[36:39], v[80:83]
  s_add_u32 m0, s51, 102400
  s_nop 0
  buffer_load_dwordx4 v121, s[8:11], s30 offen offset:0 lds
  v_mfma_f32_16x16x32_bf16 v[84:87], a[12:15], a[36:39], v[84:87]
  v_mfma_f32_16x16x32_bf16 v[88:91], a[16:19], a[36:39], v[88:91]
  v_mfma_f32_16x16x32_bf16 v[108:111], a[16:19], a[40:43], v[108:111]
  v_mfma_f32_16x16x32_bf16 v[104:107], a[12:15], a[40:43], v[104:107]
  buffer_load_dwordx4 v122, s[8:11], s30 offen offset:1024 lds
  s_add_u32 s30, s30, 393216
  v_mfma_f32_16x16x32_bf16 v[100:103], a[8:11], a[40:43], v[100:103]
  v_mfma_f32_16x16x32_bf16 v[96:99], a[4:7], a[40:43], v[96:99]
  v_mfma_f32_16x16x32_bf16 v[92:95], a[0:3], a[40:43], v[92:95]
  s_waitcnt lgkmcnt(0)
  v_mfma_f32_16x16x32_bf16 v[0:3], a[64:67], a[48:51], v[0:3]
  s_waitcnt vmcnt(10)
  s_barrier
  ds_read_b64_tr_b16 a[20:21], v115 offset:24576
  v_mfma_f32_16x16x32_bf16 v[4:7], a[64:67], a[52:55], v[4:7]
  ds_read_b64_tr_b16 a[22:23], v115 offset:30720
  v_mfma_f32_16x16x32_bf16 v[8:11], a[64:67], a[56:59], v[8:11]
  ds_read_b128 a[4:7], v112 offset:16384
  v_mfma_f32_16x16x32_bf16 v[12:15], a[64:67], a[60:63], v[12:15]
  ds_read_b128 a[8:11], v112 offset:18432
  s_add_u32 m0, s50, 0
  s_nop 0
  buffer_load_dwordx4 v119, s[4:7], s28 offen offset:0 lds
  v_mfma_f32_16x16x32_bf16 v[28:31], a[68:71], a[60:63], v[28:31]
  ds_read_b128 a[12:15], v112 offset:20480
  v_mfma_f32_16x16x32_bf16 v[24:27], a[68:71], a[56:59], v[24:27]
  ds_read_b128 a[16:19], v112 offset:22528
  v_mfma_f32_16x16x32_bf16 v[20:23], a[68:71], a[52:55], v[20:23]
  ds_read_b64_tr_b16 a[24:25], v116 offset:24576
  v_mfma_f32_16x16x32_bf16 v[16:19], a[68:71], a[48:51], v[16:19]
  ds_read_b64_tr_b16 a[26:27], v116 offset:30720
  v_mfma_f32_16x16x32_bf16 v[32:35], a[72:75], a[44:47], v[32:35]
  ds_read_b128 a[0:3], v113
  v_add_u32 v113, s52, v113
  v_mfma_f32_16x16x32_bf16 v[36:39], a[72:75], a[48:51], v[36:39]
  ds_read_b64_tr_b16 a[28:29], v115 offset:26624
  buffer_load_dwordx4 v119, s[4:7], s28 offen offset:1024 lds
  v_mfma_f32_16x16x32_bf16 v[40:43], a[72:75], a[52:55], v[40:43]
  ds_read_b64_tr_b16 a[30:31], v115 offset:32768
  v_mfma_f32_16x16x32_bf16 v[44:47], a[72:75], a[56:59], v[44:47]
  ds_read_b64_tr_b16 a[32:33], v116 offset:26624
  v_mfma_f32_16x16x32_bf16 v[48:51], a[72:75], a[60:63], v[48:51]
  ds_read_b64_tr_b16 a[34:35], v116 offset:32768
  v_mfma_f32_16x16x32_bf16 v[68:71], a[76:79], a[60:63], v[68:71]
  ds_read_b64_tr_b16 a[36:37], v115 offset:28672
  v_mfma_f32_16x16x32_bf16 v[64:67], a[76:79], a[56:59], v[64:67]
  ds_read_b64_tr_b16 a[38:39], v115 offset:34816
  v_mfma_f32_16x16x32_bf16 v[60:63], a[76:79], a[52:55], v[60:63]
  ds_read_b64_tr_b16 a[40:41], v116 offset:28672
  buffer_load_dwordx4 v120, s[4:7], s28 offen offset:2048 lds
  v_mfma_f32_16x16x32_bf16 v[56:59], a[76:79], a[48:51], v[56:59]
  ds_read_b64_tr_b16 a[42:43], v116 offset:34816
  v_mfma_f32_16x16x32_bf16 v[52:55], a[76:79], a[44:47], v[52:55]
  v_mfma_f32_16x16x32_bf16 v[72:75], a[44:47], a[80:83], v[72:75]
  v_mfma_f32_16x16x32_bf16 v[76:79], a[48:51], a[80:83], v[76:79]
  v_mfma_f32_16x16x32_bf16 v[80:83], a[52:55], a[80:83], v[80:83]
  buffer_load_dwordx4 v120, s[4:7], s28 offen offset:3072 lds
  s_add_u32 s28, s28, 2048
  v_mfma_f32_16x16x32_bf16 v[84:87], a[56:59], a[80:83], v[84:87]
  v_mfma_f32_16x16x32_bf16 v[88:91], a[60:63], a[80:83], v[88:91]
  v_mfma_f32_16x16x32_bf16 v[108:111], a[60:63], a[84:87], v[108:111]
  v_mfma_f32_16x16x32_bf16 v[104:107], a[56:59], a[84:87], v[104:107]
  s_add_u32 m0, s51, 49152
  s_nop 0
  buffer_load_dwordx4 v121, s[8:11], s29 offen offset:0 lds
  v_mfma_f32_16x16x32_bf16 v[100:103], a[52:55], a[84:87], v[100:103]
  v_mfma_f32_16x16x32_bf16 v[96:99], a[48:51], a[84:87], v[96:99]
  v_mfma_f32_16x16x32_bf16 v[92:95], a[44:47], a[84:87], v[92:95]
  s_waitcnt lgkmcnt(0)
  v_mfma_f32_16x16x32_bf16 v[0:3], a[20:23], a[4:7], v[0:3]
  ds_read_b64_tr_b16 a[64:65], v115 offset:36864
  v_mfma_f32_16x16x32_bf16 v[4:7], a[20:23], a[8:11], v[4:7]
  ds_read_b64_tr_b16 a[66:67], v115 offset:43008
  v_mfma_f32_16x16x32_bf16 v[8:11], a[20:23], a[12:15], v[8:11]
  ds_read_b128 a[48:51], v112 offset:17408
  v_mfma_f32_16x16x32_bf16 v[12:15], a[20:23], a[16:19], v[12:15]
  ds_read_b128 a[52:55], v112 offset:19456
  buffer_load_dwordx4 v122, s[8:11], s29 offen offset:1024 lds
  v_mfma_f32_16x16x32_bf16 v[28:31], a[24:27], a[16:19], v[28:31]
  ds_read_b128 a[56:59], v112 offset:21504
  v_mfma_f32_16x16x32_bf16 v[24:27], a[24:27], a[12:15], v[24:27]
  ds_read_b128 a[60:63], v112 offset:23552
  v_mfma_f32_16x16x32_bf16 v[20:23], a[24:27], a[8:11], v[20:23]
  ds_read_b64_tr_b16 a[68:69], v116 offset:36864
  v_mfma_f32_16x16x32_bf16 v[16:19], a[24:27], a[4:7], v[16:19]
  ds_read_b64_tr_b16 a[70:71], v116 offset:43008
  v_mfma_f32_16x16x32_bf16 v[32:35], a[28:31], a[0:3], v[32:35]
  ds_read_b128 a[44:47], v114
  v_add_u32 v114, s52, v114
  v_mfma_f32_16x16x32_bf16 v[36:39], a[28:31], a[4:7], v[36:39]
  ds_read_b64_tr_b16 a[72:73], v115 offset:38912
  buffer_load_dwordx4 v121, s[8:11], s29 offen offset:2048 lds
  v_mfma_f32_16x16x32_bf16 v[40:43], a[28:31], a[8:11], v[40:43]
  ds_read_b64_tr_b16 a[74:75], v115 offset:45056
  v_mfma_f32_16x16x32_bf16 v[44:47], a[28:31], a[12:15], v[44:47]
  ds_read_b64_tr_b16 a[76:77], v116 offset:38912
  v_mfma_f32_16x16x32_bf16 v[48:51], a[28:31], a[16:19], v[48:51]
  ds_read_b64_tr_b16 a[78:79], v116 offset:45056
  v_mfma_f32_16x16x32_bf16 v[68:71], a[32:35], a[16:19], v[68:71]
  ds_read_b64_tr_b16 a[80:81], v115 offset:40960
  v_mfma_f32_16x16x32_bf16 v[64:67], a[32:35], a[12:15], v[64:67]
  ds_read_b64_tr_b16 a[82:83], v115 offset:47104
  v_mfma_f32_16x16x32_bf16 v[60:63], a[32:35], a[8:11], v[60:63]
  ds_read_b64_tr_b16 a[84:85], v116 offset:40960
  buffer_load_dwordx4 v122, s[8:11], s29 offen offset:3072 lds
  s_add_u32 s29, s29, 393216
  v_mfma_f32_16x16x32_bf16 v[56:59], a[32:35], a[4:7], v[56:59]
  ds_read_b64_tr_b16 a[86:87], v116 offset:47104
  v_mfma_f32_16x16x32_bf16 v[52:55], a[32:35], a[0:3], v[52:55]
  v_mfma_f32_16x16x32_bf16 v[72:75], a[0:3], a[36:39], v[72:75]
  v_mfma_f32_16x16x32_bf16 v[76:79], a[4:7], a[36:39], v[76:79]
  v_mfma_f32_16x16x32_bf16 v[80:83], a[8:11], a[36:39], v[80:83]
  s_add_u32 m0, s51, 53248
  s_nop 0
  buffer_load_dwordx4 v121, s[8:11], s30 offen offset:0 lds
  v_mfma_f32_16x16x32_bf16 v[84:87], a[12:15], a[36:39], v[84:87]
  v_mfma_f32_16x16x32_bf16 v[88:91], a[16:19], a[36:39], v[88:91]
  v_mfma_f32_16x16x32_bf16 v[108:111], a[16:19], a[40:43], v[108:111]
  v_mfma_f32_16x16x32_bf16 v[104:107], a[12:15], a[40:43], v[104:107]
  buffer_load_dwordx4 v122, s[8:11], s30 offen offset:1024 lds
  s_add_u32 s30, s30, 393216
  v_mfma_f32_16x16x32_bf16 v[100:103], a[8:11], a[40:43], v[100:103]
  v_mfma_f32_16x16x32_bf16 v[96:99], a[4:7], a[40:43], v[96:99]
  v_mfma_f32_16x16x32_bf16 v[92:95], a[0:3], a[40:43], v[92:95]
  s_waitcnt lgkmcnt(0)
  v_mfma_f32_16x16x32_bf16 v[0:3], a[64:67], a[48:51], v[0:3]
  s_waitcnt vmcnt(10)
  s_barrier
  ds_read_b64_tr_b16 a[20:21], v117 offset:0
  v_mfma_f32_16x16x32_bf16 v[4:7], a[64:67], a[52:55], v[4:7]
  ds_read_b64_tr_b16 a[22:23], v117 offset:6144
  v_mfma_f32_16x16x32_bf16 v[8:11], a[64:67], a[56:59], v[8:11]
  ds_read_b128 a[4:7], v112 offset:32768
  v_mfma_f32_16x16x32_bf16 v[12:15], a[64:67], a[60:63], v[12:15]
  ds_read_b128 a[8:11], v112 offset:34816
  v_mfma_f32_16x16x32_bf16 v[28:31], a[68:71], a[60:63], v[28:31]
  ds_read_b128 a[12:15], v112 offset:36864
  v_mfma_f32_16x16x32_bf16 v[24:27], a[68:71], a[56:59], v[24:27]
  ds_read_b128 a[16:19], v112 offset:38912
  v_mfma_f32_16x16x32_bf16 v[20:23], a[68:71], a[52:55], v[20:23]
  ds_read_b64_tr_b16 a[24:25], v118 offset:0
  v_mfma_f32_16x16x32_bf16 v[16:19], a[68:71], a[48:51], v[16:19]
  ds_read_b64_tr_b16 a[26:27], v118 offset:6144
  v_mfma_f32_16x16x32_bf16 v[32:35], a[72:75], a[44:47], v[32:35]
  ds_read_b128 a[0:3], v113
  v_add_u32 v113, s53, v113
  v_mfma_f32_16x16x32_bf16 v[36:39], a[72:75], a[48:51], v[36:39]
  ds_read_b64_tr_b16 a[28:29], v117 offset:2048
  v_mfma_f32_16x16x32_bf16 v[40:43], a[72:75], a[52:55], v[40:43]
  ds_read_b64_tr_b16 a[30:31], v117 offset:8192
  v_mfma_f32_16x16x32_bf16 v[44:47], a[72:75], a[56:59], v[44:47]
  ds_read_b64_tr_b16 a[32:33], v118 offset:2048
  v_mfma_f32_16x16x32_bf16 v[48:51], a[72:75], a[60:63], v[48:51]
  ds_read_b64_tr_b16 a[34:35], v118 offset:8192
  v_mfma_f32_16x16x32_bf16 v[68:71], a[76:79], a[60:63], v[68:71]
  ds_read_b64_tr_b16 a[36:37], v117 offset:4096
  v_mfma_f32_16x16x32_bf16 v[64:67], a[76:79], a[56:59], v[64:67]
  ds_read_b64_tr_b16 a[38:39], v117 offset:10240
  v_mfma_f32_16x16x32_bf16 v[60:63], a[76:79], a[52:55], v[60:63]
  ds_read_b64_tr_b16 a[40:41], v118 offset:4096
  v_mfma_f32_16x16x32_bf16 v[56:59], a[76:79], a[48:51], v[56:59]
  ds_read_b64_tr_b16 a[42:43], v118 offset:10240
  v_mfma_f32_16x16x32_bf16 v[52:55], a[76:79], a[44:47], v[52:55]
  v_mfma_f32_16x16x32_bf16 v[72:75], a[44:47], a[80:83], v[72:75]
  v_mfma_f32_16x16x32_bf16 v[76:79], a[48:51], a[80:83], v[76:79]
  v_mfma_f32_16x16x32_bf16 v[80:83], a[52:55], a[80:83], v[80:83]
  v_mfma_f32_16x16x32_bf16 v[84:87], a[56:59], a[80:83], v[84:87]
  v_mfma_f32_16x16x32_bf16 v[88:91], a[60:63], a[80:83], v[88:91]
  v_mfma_f32_16x16x32_bf16 v[108:111], a[60:63], a[84:87], v[108:111]
  v_mfma_f32_16x16x32_bf16 v[104:107], a[56:59], a[84:87], v[104:107]
  v_mfma_f32_16x16x32_bf16 v[100:103], a[52:55], a[84:87], v[100:103]
  v_mfma_f32_16x16x32_bf16 v[96:99], a[48:51], a[84:87], v[96:99]
  v_mfma_f32_16x16x32_bf16 v[92:95], a[44:47], a[84:87], v[92:95]
  s_waitcnt lgkmcnt(0)
  v_mfma_f32_16x16x32_bf16 v[0:3], a[20:23], a[4:7], v[0:3]
  ds_read_b64_tr_b16 a[64:65], v117 offset:12288
  v_mfma_f32_16x16x32_bf16 v[4:7], a[20:23], a[8:11], v[4:7]
  ds_read_b64_tr_b16 a[66:67], v117 offset:18432
  v_mfma_f32_16x16x32_bf16 v[8:11], a[20:23], a[12:15], v[8:11]
  ds_read_b128 a[48:51], v112 offset:33792
  v_mfma_f32_16x16x32_bf16 v[12:15], a[20:23], a[16:19], v[12:15]
  ds_read_b128 a[52:55], v112 offset:35840
  s_lshl_b32 s43, s27, 2
  s_add_u32 s48, s44, s43
  s_sub_u32 s49, s48, 1
  s_cmp_eq_u32 s27, 0
  s_cselect_b32 s49, s45, s49
  s_lshl_b32 s49, s49, 11
  s_add_u32 s49, s49, s41
  s_lshl_b32 s55, s48, 11
  s_add_u32 s55, s55, s41
  s_add_u32 s56, s55, 4096
  v_lshlrev_b32 v120, 3, v123
  buffer_load_dwordx2 v[128:129], v120, s[4:7], s49 offen offset:0
  buffer_load_dwordx2 v[130:131], v120, s[4:7], s49 offen offset:512
  buffer_load_dwordx2 v[132:133], v120, s[4:7], s49 offen offset:1024
  buffer_load_dwordx2 v[134:135], v120, s[4:7], s49 offen offset:1536
  v_mfma_f32_16x16x32_bf16 v[28:31], a[24:27], a[16:19], v[28:31]
  ds_read_b128 a[56:59], v112 offset:37888
  v_mfma_f32_16x16x32_bf16 v[24:27], a[24:27], a[12:15], v[24:27]
  ds_read_b128 a[60:63], v112 offset:39936
  v_mfma_f32_16x16x32_bf16 v[20:23], a[24:27], a[8:11], v[20:23]
  ds_read_b64_tr_b16 a[68:69], v118 offset:12288
  v_mfma_f32_16x16x32_bf16 v[16:19], a[24:27], a[4:7], v[16:19]
  ds_read_b64_tr_b16 a[70:71], v118 offset:18432
  v_mfma_f32_16x16x32_bf16 v[32:35], a[28:31], a[0:3], v[32:35]
  ds_read_b128 a[44:47], v114
  v_add_u32 v114, s53, v114
  v_mfma_f32_16x16x32_bf16 v[36:39], a[28:31], a[4:7], v[36:39]
  ds_read_b64_tr_b16 a[72:73], v117 offset:14336
  buffer_load_dwordx2 v[136:137], v120, s[4:7], s55 offen offset:0
  buffer_load_dwordx2 v[138:139], v120, s[4:7], s55 offen offset:512
  buffer_load_dwordx2 v[140:141], v120, s[4:7], s55 offen offset:1024
  buffer_load_dwordx2 v[142:143], v120, s[4:7], s55 offen offset:1536
  v_mfma_f32_16x16x32_bf16 v[40:43], a[28:31], a[8:11], v[40:43]
  ds_read_b64_tr_b16 a[74:75], v117 offset:20480
  v_mfma_f32_16x16x32_bf16 v[44:47], a[28:31], a[12:15], v[44:47]
  ds_read_b64_tr_b16 a[76:77], v118 offset:14336
  v_mfma_f32_16x16x32_bf16 v[48:51], a[28:31], a[16:19], v[48:51]
  ds_read_b64_tr_b16 a[78:79], v118 offset:20480
  v_mfma_f32_16x16x32_bf16 v[68:71], a[32:35], a[16:19], v[68:71]
  ds_read_b64_tr_b16 a[80:81], v117 offset:16384
  v_mfma_f32_16x16x32_bf16 v[64:67], a[32:35], a[12:15], v[64:67]
  ds_read_b64_tr_b16 a[82:83], v117 offset:22528
  v_mfma_f32_16x16x32_bf16 v[60:63], a[32:35], a[8:11], v[60:63]
  ds_read_b64_tr_b16 a[84:85], v118 offset:16384
  buffer_load_dwordx2 v[144:145], v120, s[4:7], s55 offen offset:2048
  buffer_load_dwordx2 v[146:147], v120, s[4:7], s55 offen offset:2560
  buffer_load_dwordx2 v[148:149], v120, s[4:7], s55 offen offset:3072
  buffer_load_dwordx2 v[150:151], v120, s[4:7], s55 offen offset:3584
  v_mfma_f32_16x16x32_bf16 v[56:59], a[32:35], a[4:7], v[56:59]
  ds_read_b64_tr_b16 a[86:87], v118 offset:22528
  v_mfma_f32_16x16x32_bf16 v[52:55], a[32:35], a[0:3], v[52:55]
  v_mfma_f32_16x16x32_bf16 v[72:75], a[0:3], a[36:39], v[72:75]
  v_mfma_f32_16x16x32_bf16 v[76:79], a[4:7], a[36:39], v[76:79]
  v_mfma_f32_16x16x32_bf16 v[80:83], a[8:11], a[36:39], v[80:83]
  buffer_load_dwordx2 v[152:153], v120, s[4:7], s56 offen offset:0
  buffer_load_dwordx2 v[154:155], v120, s[4:7], s56 offen offset:512
  buffer_load_dwordx2 v[156:157], v120, s[4:7], s56 offen offset:1024
  buffer_load_dwordx2 v[158:159], v120, s[4:7], s56 offen offset:1536
  v_mfma_f32_16x16x32_bf16 v[84:87], a[12:15], a[36:39], v[84:87]
  v_mfma_f32_16x16x32_bf16 v[88:91], a[16:19], a[36:39], v[88:91]
  v_mfma_f32_16x16x32_bf16 v[108:111], a[16:19], a[40:43], v[108:111]
  v_mfma_f32_16x16x32_bf16 v[104:107], a[12:15], a[40:43], v[104:107]
  buffer_load_dwordx2 v[160:161], v120, s[4:7], s56 offen offset:2048
  buffer_load_dwordx2 v[162:163], v120, s[4:7], s56 offen offset:2560
  buffer_load_dwordx2 v[164:165], v120, s[4:7], s56 offen offset:3072
  buffer_load_dwordx2 v[166:167], v120, s[4:7], s56 offen offset:3584
  v_mfma_f32_16x16x32_bf16 v[100:103], a[8:11], a[40:43], v[100:103]
  v_mfma_f32_16x16x32_bf16 v[96:99], a[4:7], a[40:43], v[96:99]
  v_mfma_f32_16x16x32_bf16 v[92:95], a[0:3], a[40:43], v[92:95]
  s_waitcnt lgkmcnt(0)
  v_mfma_f32_16x16x32_bf16 v[0:3], a[64:67], a[48:51], v[0:3]
  s_waitcnt vmcnt(20)
  s_barrier
  ds_read_b64_tr_b16 a[20:21], v115 offset:0
  v_mfma_f32_16x16x32_bf16 v[4:7], a[64:67], a[52:55], v[4:7]
  ds_read_b64_tr_b16 a[22:23], v115 offset:6144
  v_mfma_f32_16x16x32_bf16 v[8:11], a[64:67], a[56:59], v[8:11]
  ds_read_b128 a[4:7], v112 offset:0
  v_mfma_f32_16x16x32_bf16 v[12:15], a[64:67], a[60:63], v[12:15]
  ds_read_b128 a[8:11], v112 offset:2048
  s_lshl_b32 s43, s26, 1
  s_add_u32 s57, s43, s54
  s_lshl_b32 s43, s57, 7
  s_add_u32 s58, s43, 36700160
  s_add_u32 s59, s58, 4096
  s_add_u32 s60, s58, 8192
  v_lshrrev_b32 v121, 4, v123
  v_lshlrev_b32 v121, 4, v121
  v_and_b32 v122, 15, v123
  v_lshlrev_b32 v122, 2, v122
  buffer_load_dwordx4 v[168:171], v121, s[4:7], s58 offen offset:0
  buffer_load_dwordx4 v[172:175], v121, s[4:7], s58 offen offset:64
  buffer_load_dwordx4 v[176:179], v121, s[4:7], s59 offen offset:0
  buffer_load_dwordx4 v[180:183], v121, s[4:7], s59 offen offset:64
  buffer_load_dword v184, v122, s[4:7], s60 offen offset:0
  buffer_load_dword v185, v122, s[4:7], s60 offen offset:64
  v_mfma_f32_16x16x32_bf16 v[28:31], a[68:71], a[60:63], v[28:31]
  ds_read_b128 a[12:15], v112 offset:4096
  v_mfma_f32_16x16x32_bf16 v[24:27], a[68:71], a[56:59], v[24:27]
  ds_read_b128 a[16:19], v112 offset:6144
  v_mfma_f32_16x16x32_bf16 v[20:23], a[68:71], a[52:55], v[20:23]
  ds_read_b64_tr_b16 a[24:25], v116 offset:0
  v_mfma_f32_16x16x32_bf16 v[16:19], a[68:71], a[48:51], v[16:19]
  ds_read_b64_tr_b16 a[26:27], v116 offset:6144
  v_mfma_f32_16x16x32_bf16 v[32:35], a[72:75], a[44:47], v[32:35]
  ds_read_b128 a[0:3], v113
  v_add_u32 v113, s52, v113
  v_mfma_f32_16x16x32_bf16 v[36:39], a[72:75], a[48:51], v[36:39]
  ds_read_b64_tr_b16 a[28:29], v115 offset:2048
  v_mfma_f32_16x16x32_bf16 v[40:43], a[72:75], a[52:55], v[40:43]
  ds_read_b64_tr_b16 a[30:31], v115 offset:8192
  v_mfma_f32_16x16x32_bf16 v[44:47], a[72:75], a[56:59], v[44:47]
  ds_read_b64_tr_b16 a[32:33], v116 offset:2048
  v_mfma_f32_16x16x32_bf16 v[48:51], a[72:75], a[60:63], v[48:51]
  ds_read_b64_tr_b16 a[34:35], v116 offset:8192
  v_mfma_f32_16x16x32_bf16 v[68:71], a[76:79], a[60:63], v[68:71]
  ds_read_b64_tr_b16 a[36:37], v115 offset:4096
  v_mfma_f32_16x16x32_bf16 v[64:67], a[76:79], a[56:59], v[64:67]
  ds_read_b64_tr_b16 a[38:39], v115 offset:10240
  v_mfma_f32_16x16x32_bf16 v[60:63], a[76:79], a[52:55], v[60:63]
  ds_read_b64_tr_b16 a[40:41], v116 offset:4096
  v_mfma_f32_16x16x32_bf16 v[56:59], a[76:79], a[48:51], v[56:59]
  ds_read_b64_tr_b16 a[42:43], v116 offset:10240
  v_mfma_f32_16x16x32_bf16 v[52:55], a[76:79], a[44:47], v[52:55]
  v_mfma_f32_16x16x32_bf16 v[72:75], a[44:47], a[80:83], v[72:75]
  v_mfma_f32_16x16x32_bf16 v[76:79], a[48:51], a[80:83], v[76:79]
  v_mfma_f32_16x16x32_bf16 v[80:83], a[52:55], a[80:83], v[80:83]
  v_mfma_f32_16x16x32_bf16 v[84:87], a[56:59], a[80:83], v[84:87]
  v_mfma_f32_16x16x32_bf16 v[88:91], a[60:63], a[80:83], v[88:91]
  v_mfma_f32_16x16x32_bf16 v[108:111], a[60:63], a[84:87], v[108:111]
  v_mfma_f32_16x16x32_bf16 v[104:107], a[56:59], a[84:87], v[104:107]
  v_mfma_f32_16x16x32_bf16 v[100:103], a[52:55], a[84:87], v[100:103]
  v_mfma_f32_16x16x32_bf16 v[96:99], a[48:51], a[84:87], v[96:99]
  v_mfma_f32_16x16x32_bf16 v[92:95], a[44:47], a[84:87], v[92:95]
  s_waitcnt lgkmcnt(0)
  v_mfma_f32_16x16x32_bf16 v[0:3], a[20:23], a[4:7], v[0:3]
  ds_read_b64_tr_b16 a[64:65], v115 offset:12288
  v_mfma_f32_16x16x32_bf16 v[4:7], a[20:23], a[8:11], v[4:7]
  ds_read_b64_tr_b16 a[66:67], v115 offset:18432
  v_mfma_f32_16x16x32_bf16 v[8:11], a[20:23], a[12:15], v[8:11]
  ds_read_b128 a[48:51], v112 offset:1024
  v_mfma_f32_16x16x32_bf16 v[12:15], a[20:23], a[16:19], v[12:15]
  ds_read_b128 a[52:55], v112 offset:3072
  v_mfma_f32_16x16x32_bf16 v[28:31], a[24:27], a[16:19], v[28:31]
  ds_read_b128 a[56:59], v112 offset:5120
  v_mfma_f32_16x16x32_bf16 v[24:27], a[24:27], a[12:15], v[24:27]
  ds_read_b128 a[60:63], v112 offset:7168
  v_mfma_f32_16x16x32_bf16 v[20:23], a[24:27], a[8:11], v[20:23]
  ds_read_b64_tr_b16 a[68:69], v116 offset:12288
  v_mfma_f32_16x16x32_bf16 v[16:19], a[24:27], a[4:7], v[16:19]
  ds_read_b64_tr_b16 a[70:71], v116 offset:18432
  v_mfma_f32_16x16x32_bf16 v[32:35], a[28:31], a[0:3], v[32:35]
  ds_read_b128 a[44:47], v114
  v_add_u32 v114, s52, v114
  v_mfma_f32_16x16x32_bf16 v[36:39], a[28:31], a[4:7], v[36:39]
  ds_read_b64_tr_b16 a[72:73], v115 offset:14336
  v_mfma_f32_16x16x32_bf16 v[40:43], a[28:31], a[8:11], v[40:43]
  ds_read_b64_tr_b16 a[74:75], v115 offset:20480
  v_mfma_f32_16x16x32_bf16 v[44:47], a[28:31], a[12:15], v[44:47]
  ds_read_b64_tr_b16 a[76:77], v116 offset:14336
  v_mfma_f32_16x16x32_bf16 v[48:51], a[28:31], a[16:19], v[48:51]
  ds_read_b64_tr_b16 a[78:79], v116 offset:20480
  v_mfma_f32_16x16x32_bf16 v[68:71], a[32:35], a[16:19], v[68:71]
  ds_read_b64_tr_b16 a[80:81], v115 offset:16384
  v_mfma_f32_16x16x32_bf16 v[64:67], a[32:35], a[12:15], v[64:67]
  ds_read_b64_tr_b16 a[82:83], v115 offset:22528
  v_mfma_f32_16x16x32_bf16 v[60:63], a[32:35], a[8:11], v[60:63]
  ds_read_b64_tr_b16 a[84:85], v116 offset:16384
  v_mfma_f32_16x16x32_bf16 v[56:59], a[32:35], a[4:7], v[56:59]
  ds_read_b64_tr_b16 a[86:87], v116 offset:22528
  v_mfma_f32_16x16x32_bf16 v[52:55], a[32:35], a[0:3], v[52:55]
  v_mfma_f32_16x16x32_bf16 v[72:75], a[0:3], a[36:39], v[72:75]
  v_mfma_f32_16x16x32_bf16 v[76:79], a[4:7], a[36:39], v[76:79]
  v_mfma_f32_16x16x32_bf16 v[80:83], a[8:11], a[36:39], v[80:83]
  v_mfma_f32_16x16x32_bf16 v[84:87], a[12:15], a[36:39], v[84:87]
  v_mfma_f32_16x16x32_bf16 v[88:91], a[16:19], a[36:39], v[88:91]
  v_mfma_f32_16x16x32_bf16 v[108:111], a[16:19], a[40:43], v[108:111]
  v_mfma_f32_16x16x32_bf16 v[104:107], a[12:15], a[40:43], v[104:107]
  v_mfma_f32_16x16x32_bf16 v[100:103], a[8:11], a[40:43], v[100:103]
  v_mfma_f32_16x16x32_bf16 v[96:99], a[4:7], a[40:43], v[96:99]
  v_mfma_f32_16x16x32_bf16 v[92:95], a[0:3], a[40:43], v[92:95]
  s_waitcnt lgkmcnt(0)
  v_mfma_f32_16x16x32_bf16 v[0:3], a[64:67], a[48:51], v[0:3]
  v_mfma_f32_16x16x32_bf16 v[4:7], a[64:67], a[52:55], v[4:7]
  v_mfma_f32_16x16x32_bf16 v[8:11], a[64:67], a[56:59], v[8:11]
  v_mfma_f32_16x16x32_bf16 v[12:15], a[64:67], a[60:63], v[12:15]
  v_mfma_f32_16x16x32_bf16 v[28:31], a[68:71], a[60:63], v[28:31]
  v_mfma_f32_16x16x32_bf16 v[24:27], a[68:71], a[56:59], v[24:27]
  v_mfma_f32_16x16x32_bf16 v[20:23], a[68:71], a[52:55], v[20:23]
  v_mfma_f32_16x16x32_bf16 v[16:19], a[68:71], a[48:51], v[16:19]
  v_mfma_f32_16x16x32_bf16 v[32:35], a[72:75], a[44:47], v[32:35]
  v_mfma_f32_16x16x32_bf16 v[36:39], a[72:75], a[48:51], v[36:39]
  v_mfma_f32_16x16x32_bf16 v[40:43], a[72:75], a[52:55], v[40:43]
  v_mfma_f32_16x16x32_bf16 v[44:47], a[72:75], a[56:59], v[44:47]
  v_mfma_f32_16x16x32_bf16 v[48:51], a[72:75], a[60:63], v[48:51]
  v_mfma_f32_16x16x32_bf16 v[68:71], a[76:79], a[60:63], v[68:71]
  v_mfma_f32_16x16x32_bf16 v[64:67], a[76:79], a[56:59], v[64:67]
  v_mfma_f32_16x16x32_bf16 v[60:63], a[76:79], a[52:55], v[60:63]
  v_mfma_f32_16x16x32_bf16 v[56:59], a[76:79], a[48:51], v[56:59]
  v_mfma_f32_16x16x32_bf16 v[52:55], a[76:79], a[44:47], v[52:55]
  v_mfma_f32_16x16x32_bf16 v[72:75], a[44:47], a[80:83], v[72:75]
  v_mfma_f32_16x16x32_bf16 v[76:79], a[48:51], a[80:83], v[76:79]
  v_mfma_f32_16x16x32_bf16 v[80:83], a[52:55], a[80:83], v[80:83]
  v_mfma_f32_16x16x32_bf16 v[84:87], a[56:59], a[80:83], v[84:87]
  v_mfma_f32_16x16x32_bf16 v[88:91], a[60:63], a[80:83], v[88:91]
  v_mfma_f32_16x16x32_bf16 v[108:111], a[60:63], a[84:87], v[108:111]
  v_mfma_f32_16x16x32_bf16 v[104:107], a[56:59], a[84:87], v[104:107]
  v_mfma_f32_16x16x32_bf16 v[100:103], a[52:55], a[84:87], v[100:103]
  v_mfma_f32_16x16x32_bf16 v[96:99], a[48:51], a[84:87], v[96:99]
  v_mfma_f32_16x16x32_bf16 v[92:95], a[44:47], a[84:87], v[92:95]
  s_waitcnt vmcnt(0)
  v_pk_add_f32 v[128:129], v[128:129], v[130:131]
  v_pk_add_f32 v[132:133], v[132:133], v[134:135]
  v_add_f32 v188, v128, v132
  v_add_f32 v194, v129, v133
  v_pk_add_f32 v[136:137], v[136:137], v[138:139]
  v_pk_add_f32 v[140:141], v[140:141], v[142:143]
  v_add_f32 v189, v136, v140
  v_add_f32 v195, v137, v141
  v_pk_add_f32 v[144:145], v[144:145], v[146:147]
  v_pk_add_f32 v[148:149], v[148:149], v[150:151]
  v_add_f32 v190, v144, v148
  v_add_f32 v196, v145, v149
  v_pk_add_f32 v[152:153], v[152:153], v[154:155]
  v_pk_add_f32 v[156:157], v[156:157], v[158:159]
  v_add_f32 v191, v152, v156
  v_add_f32 v197, v153, v157
  v_pk_add_f32 v[160:161], v[160:161], v[162:163]
  v_pk_add_f32 v[164:165], v[164:165], v[166:167]
  v_add_f32 v192, v160, v164
  v_add_f32 v198, v161, v165
  v_mov_b32 v240, v188
  v_mov_b32 v241, v189
  v_mov_b32 v242, v190
  v_mov_b32 v243, v191
  v_mov_b32 v244, v192
  v_mov_b32 v245, v194
  v_mov_b32 v246, v195
  v_mov_b32 v247, v196
  v_mov_b32 v248, v197
  v_mov_b32 v249, v198
  v_permlane32_swap_b32 v188, v240
  v_permlane32_swap_b32 v189, v241
  v_permlane32_swap_b32 v190, v242
  v_permlane32_swap_b32 v191, v243
  v_permlane32_swap_b32 v192, v244
  v_permlane32_swap_b32 v194, v245
  v_permlane32_swap_b32 v195, v246
  v_permlane32_swap_b32 v196, v247
  v_permlane32_swap_b32 v197, v248
  v_permlane32_swap_b32 v198, v249
  v_add_f32 v188, v188, v240
  v_add_f32 v189, v189, v241
  v_add_f32 v190, v190, v242
  v_add_f32 v191, v191, v243
  v_add_f32 v192, v192, v244
  v_add_f32 v194, v194, v245
  v_add_f32 v195, v195, v246
  v_add_f32 v196, v196, v247
  v_add_f32 v197, v197, v248
  v_add_f32 v198, v198, v249
  v_mov_b32 v240, v188
  v_mov_b32 v241, v189
  v_mov_b32 v242, v190
  v_mov_b32 v243, v191
  v_mov_b32 v244, v192
  v_mov_b32 v245, v194
  v_mov_b32 v246, v195
  v_mov_b32 v247, v196
  v_mov_b32 v248, v197
  v_mov_b32 v249, v198
  v_permlane16_swap_b32 v188, v240
  v_permlane16_swap_b32 v189, v241
  v_permlane16_swap_b32 v190, v242
  v_permlane16_swap_b32 v191, v243
  v_permlane16_swap_b32 v192, v244
  v_permlane16_swap_b32 v194, v245
  v_permlane16_swap_b32 v195, v246
  v_permlane16_swap_b32 v196, v247
  v_permlane16_swap_b32 v197, v248
  v_permlane16_swap_b32 v198, v249
  v_add_f32 v188, v188, v240
  v_add_f32 v189, v189, v241
  v_add_f32 v190, v190, v242
  v_add_f32 v191, v191, v243
  v_add_f32 v192, v192, v244
  v_add_f32 v194, v194, v245
  v_add_f32 v195, v195, v246
  v_add_f32 v196, v196, v247
  v_add_f32 v197, v197, v248
  v_add_f32 v198, v198, v249
  s_mov_b32 s43, 0x3a800000
  v_mov_b32 v240, 0x3727c5ac
  s_lshl_b32 s61, s24, 10
  s_add_u32 s61, s61, 139264
  v_add_u32 v241, s61, v122
  v_add_u32 v242, s61, v121
  v_mul_f32 v188, 0xba800000, v188
  v_fma_f32 v194, v194, s43, v240
  v_fma_f32 v194, -v188, v188, v194
  v_max_f32 v194, v194, v240
  v_rsq_f32 v194, v194
  ds_write_b32 v241, v188 offset:0
  ds_write_b32 v241, v194 offset:64
  v_mul_f32 v189, 0xba800000, v189
  v_fma_f32 v195, v195, s43, v240
  v_fma_f32 v195, -v189, v189, v195
  v_max_f32 v195, v195, v240
  v_rsq_f32 v195, v195
  ds_write_b32 v241, v189 offset:128
  ds_write_b32 v241, v195 offset:192
  v_mul_f32 v190, 0xba800000, v190
  v_fma_f32 v196, v196, s43, v240
  v_fma_f32 v196, -v190, v190, v196
  v_max_f32 v196, v196, v240
  v_rsq_f32 v196, v196
  ds_write_b32 v241, v190 offset:256
  ds_write_b32 v241, v196 offset:320
  v_mul_f32 v191, 0xba800000, v191
  v_fma_f32 v197, v197, s43, v240
  v_fma_f32 v197, -v191, v191, v197
  v_max_f32 v197, v197, v240
  v_rsq_f32 v197, v197
  ds_write_b32 v241, v191 offset:384
  ds_write_b32 v241, v197 offset:448
  v_mul_f32 v192, 0xba800000, v192
  v_fma_f32 v198, v198, s43, v240
  v_fma_f32 v198, -v192, v192, v198
  v_max_f32 v198, v198, v240
  v_rsq_f32 v198, v198
  ds_write_b32 v241, v192 offset:512
  ds_write_b32 v241, v198 offset:576
  ds_read_b128 v[200:203], v242 offset:0
  ds_read_b128 v[220:223], v242 offset:64
  ds_read_b128 v[204:207], v242 offset:128
  ds_read_b128 v[224:227], v242 offset:192
  ds_read_b128 v[208:211], v242 offset:256
  ds_read_b128 v[228:231], v242 offset:320
  ds_read_b128 v[212:215], v242 offset:384
  ds_read_b128 v[232:235], v242 offset:448
  ds_read_b128 v[216:219], v242 offset:512
  ds_read_b128 v[236:239], v242 offset:576
  v_and_b32 v243, 15, v123
  v_lshrrev_b32 v244, 4, v123
  v_lshlrev_b32 v244, 2, v244
  v_sub_u32 v243, v243, v244
  v_mov_b32 v245, 0xf149f2ca
  s_and_b32 s43, s25, 7
  s_or_b32 s43, s43, s27
  s_cmp_eq_u32 s43, 0
  s_cselect_b64 s[62:63], 0, -1
  v_subrev_u32 v246, 0, v243
  v_cmp_gt_u32 vcc, 8, v246
  v_add_u32 v246, 16, v246
  v_cmp_gt_u32 s[64:65], 8, v246
  v_cndmask_b32 v128, v245, 0, vcc
  s_nop 0
  v_cndmask_b32 v132, v245, 0, s[64:65]
  v_cndmask_b32 v136, v245, v132, s[62:63]
  v_subrev_u32 v246, 1, v243
  v_cmp_gt_u32 vcc, 8, v246
  v_add_u32 v246, 16, v246
  v_cmp_gt_u32 s[64:65], 8, v246
  v_cndmask_b32 v129, v245, 0, vcc
  s_nop 0
  v_cndmask_b32 v133, v245, 0, s[64:65]
  v_cndmask_b32 v137, v245, v133, s[62:63]
  v_subrev_u32 v246, 2, v243
  v_cmp_gt_u32 vcc, 8, v246
  v_add_u32 v246, 16, v246
  v_cmp_gt_u32 s[64:65], 8, v246
  v_cndmask_b32 v130, v245, 0, vcc
  s_nop 0
  v_cndmask_b32 v134, v245, 0, s[64:65]
  v_cndmask_b32 v138, v245, v134, s[62:63]
  v_subrev_u32 v246, 3, v243
  v_cmp_gt_u32 vcc, 8, v246
  v_add_u32 v246, 16, v246
  v_cmp_gt_u32 s[64:65], 8, v246
  v_cndmask_b32 v131, v245, 0, vcc
  s_nop 0
  v_cndmask_b32 v135, v245, 0, s[64:65]
  v_cndmask_b32 v139, v245, v135, s[62:63]
  v_pk_fma_f32 v[32:33], v[176:177], v[188:189], v[32:33] op_sel:[0,0,0] op_sel_hi:[1,0,1]
  v_pk_fma_f32 v[34:35], v[178:179], v[188:189], v[34:35] op_sel:[0,0,0] op_sel_hi:[1,0,1]
  v_pk_mul_f32 v[32:33], v[32:33], v[194:195] op_sel:[0,0] op_sel_hi:[1,0]
  v_pk_mul_f32 v[34:35], v[34:35], v[194:195] op_sel:[0,0] op_sel_hi:[1,0]
  v_pk_fma_f32 v[52:53], v[180:181], v[188:189], v[52:53] op_sel:[0,0,0] op_sel_hi:[1,0,1]
  v_pk_fma_f32 v[54:55], v[182:183], v[188:189], v[54:55] op_sel:[0,0,0] op_sel_hi:[1,0,1]
  v_pk_mul_f32 v[52:53], v[52:53], v[194:195] op_sel:[0,0] op_sel_hi:[1,0]
  v_pk_mul_f32 v[54:55], v[54:55], v[194:195] op_sel:[0,0] op_sel_hi:[1,0]
  v_cvt_pk_bf16_f32 v32, v32, v33
  v_cvt_pk_bf16_f32 v33, v34, v35
  v_cvt_pk_bf16_f32 v34, v52, v53
  v_cvt_pk_bf16_f32 v35, v54, v55
  v_pk_fma_f32 v[36:37], v[176:177], v[188:189], v[36:37] op_sel:[0,1,0] op_sel_hi:[1,1,1]
  v_pk_fma_f32 v[38:39], v[178:179], v[188:189], v[38:39] op_sel:[0,1,0] op_sel_hi:[1,1,1]
  v_pk_mul_f32 v[36:37], v[36:37], v[194:195] op_sel:[0,1] op_sel_hi:[1,1]
  v_pk_mul_f32 v[38:39], v[38:39], v[194:195] op_sel:[0,1] op_sel_hi:[1,1]
  v_pk_fma_f32 v[56:57], v[180:181], v[188:189], v[56:57] op_sel:[0,1,0] op_sel_hi:[1,1,1]
  v_pk_fma_f32 v[58:59], v[182:183], v[188:189], v[58:59] op_sel:[0,1,0] op_sel_hi:[1,1,1]
  v_pk_mul_f32 v[56:57], v[56:57], v[194:195] op_sel:[0,1] op_sel_hi:[1,1]
  v_pk_mul_f32 v[58:59], v[58:59], v[194:195] op_sel:[0,1] op_sel_hi:[1,1]
  v_cvt_pk_bf16_f32 v36, v36, v37
  v_cvt_pk_bf16_f32 v37, v38, v39
  v_cvt_pk_bf16_f32 v38, v56, v57
  v_cvt_pk_bf16_f32 v39, v58, v59
  v_pk_fma_f32 v[40:41], v[176:177], v[190:191], v[40:41] op_sel:[0,0,0] op_sel_hi:[1,0,1]
  v_pk_fma_f32 v[42:43], v[178:179], v[190:191], v[42:43] op_sel:[0,0,0] op_sel_hi:[1,0,1]
  v_pk_mul_f32 v[40:41], v[40:41], v[196:197] op_sel:[0,0] op_sel_hi:[1,0]
  v_pk_mul_f32 v[42:43], v[42:43], v[196:197] op_sel:[0,0] op_sel_hi:[1,0]
  v_pk_fma_f32 v[60:61], v[180:181], v[190:191], v[60:61] op_sel:[0,0,0] op_sel_hi:[1,0,1]
  v_pk_fma_f32 v[62:63], v[182:183], v[190:191], v[62:63] op_sel:[0,0,0] op_sel_hi:[1,0,1]
  v_pk_mul_f32 v[60:61], v[60:61], v[196:197] op_sel:[0,0] op_sel_hi:[1,0]
  v_pk_mul_f32 v[62:63], v[62:63], v[196:197] op_sel:[0,0] op_sel_hi:[1,0]
  v_cvt_pk_bf16_f32 v40, v40, v41
  v_cvt_pk_bf16_f32 v41, v42, v43
  v_cvt_pk_bf16_f32 v42, v60, v61
  v_cvt_pk_bf16_f32 v43, v62, v63
  v_pk_fma_f32 v[44:45], v[176:177], v[190:191], v[44:45] op_sel:[0,1,0] op_sel_hi:[1,1,1]
  v_pk_fma_f32 v[46:47], v[178:179], v[190:191], v[46:47] op_sel:[0,1,0] op_sel_hi:[1,1,1]
  v_pk_mul_f32 v[44:45], v[44:45], v[196:197] op_sel:[0,1] op_sel_hi:[1,1]
  v_pk_mul_f32 v[46:47], v[46:47], v[196:197] op_sel:[0,1] op_sel_hi:[1,1]
  v_pk_fma_f32 v[64:65], v[180:181], v[190:191], v[64:65] op_sel:[0,1,0] op_sel_hi:[1,1,1]
  v_pk_fma_f32 v[66:67], v[182:183], v[190:191], v[66:67] op_sel:[0,1,0] op_sel_hi:[1,1,1]
  v_pk_mul_f32 v[64:65], v[64:65], v[196:197] op_sel:[0,1] op_sel_hi:[1,1]
  v_pk_mul_f32 v[66:67], v[66:67], v[196:197] op_sel:[0,1] op_sel_hi:[1,1]
  v_cvt_pk_bf16_f32 v44, v44, v45
  v_cvt_pk_bf16_f32 v45, v46, v47
  v_cvt_pk_bf16_f32 v46, v64, v65
  v_cvt_pk_bf16_f32 v47, v66, v67
  v_pk_fma_f32 v[48:49], v[176:177], v[192:193], v[48:49] op_sel:[0,0,0] op_sel_hi:[1,0,1]
  v_pk_fma_f32 v[50:51], v[178:179], v[192:193], v[50:51] op_sel:[0,0,0] op_sel_hi:[1,0,1]
  v_pk_mul_f32 v[48:49], v[48:49], v[198:199] op_sel:[0,0] op_sel_hi:[1,0]
  v_pk_mul_f32 v[50:51], v[50:51], v[198:199] op_sel:[0,0] op_sel_hi:[1,0]
  v_pk_fma_f32 v[68:69], v[180:181], v[192:193], v[68:69] op_sel:[0,0,0] op_sel_hi:[1,0,1]
  v_pk_fma_f32 v[70:71], v[182:183], v[192:193], v[70:71] op_sel:[0,0,0] op_sel_hi:[1,0,1]
  v_pk_mul_f32 v[68:69], v[68:69], v[198:199] op_sel:[0,0] op_sel_hi:[1,0]
  v_pk_mul_f32 v[70:71], v[70:71], v[198:199] op_sel:[0,0] op_sel_hi:[1,0]
  v_cvt_pk_bf16_f32 v48, v48, v49
  v_cvt_pk_bf16_f32 v49, v50, v51
  v_cvt_pk_bf16_f32 v50, v68, v69
  v_cvt_pk_bf16_f32 v51, v70, v71
  v_pk_fma_f32 v[0:1], v[168:169], v[188:189], v[0:1] op_sel:[0,1,0] op_sel_hi:[1,1,1]
  v_pk_fma_f32 v[2:3], v[170:171], v[188:189], v[2:3] op_sel:[0,1,0] op_sel_hi:[1,1,1]
  v_pk_mul_f32 v[0:1], v[0:1], v[194:195] op_sel:[0,1] op_sel_hi:[1,1]
  v_pk_mul_f32 v[2:3], v[2:3], v[194:195] op_sel:[0,1] op_sel_hi:[1,1]
  v_pk_fma_f32 v[16:17], v[172:173], v[188:189], v[16:17] op_sel:[0,1,0] op_sel_hi:[1,1,1]
  v_pk_fma_f32 v[18:19], v[174:175], v[188:189], v[18:19] op_sel:[0,1,0] op_sel_hi:[1,1,1]
  v_pk_mul_f32 v[16:17], v[16:17], v[194:195] op_sel:[0,1] op_sel_hi:[1,1]
  v_pk_mul_f32 v[18:19], v[18:19], v[194:195] op_sel:[0,1] op_sel_hi:[1,1]
  v_cvt_pk_bf16_f32 v0, v0, v1
  v_cvt_pk_bf16_f32 v1, v2, v3
  v_cvt_pk_bf16_f32 v2, v16, v17
  v_cvt_pk_bf16_f32 v3, v18, v19
  v_pk_fma_f32 v[4:5], v[168:169], v[190:191], v[4:5] op_sel:[0,0,0] op_sel_hi:[1,0,1]
  v_pk_fma_f32 v[6:7], v[170:171], v[190:191], v[6:7] op_sel:[0,0,0] op_sel_hi:[1,0,1]
  v_pk_mul_f32 v[4:5], v[4:5], v[196:197] op_sel:[0,0] op_sel_hi:[1,0]
  v_pk_mul_f32 v[6:7], v[6:7], v[196:197] op_sel:[0,0] op_sel_hi:[1,0]
  v_pk_fma_f32 v[20:21], v[172:173], v[190:191], v[20:21] op_sel:[0,0,0] op_sel_hi:[1,0,1]
  v_pk_fma_f32 v[22:23], v[174:175], v[190:191], v[22:23] op_sel:[0,0,0] op_sel_hi:[1,0,1]
  v_pk_mul_f32 v[20:21], v[20:21], v[196:197] op_sel:[0,0] op_sel_hi:[1,0]
  v_pk_mul_f32 v[22:23], v[22:23], v[196:197] op_sel:[0,0] op_sel_hi:[1,0]
  v_cvt_pk_bf16_f32 v4, v4, v5
  v_cvt_pk_bf16_f32 v5, v6, v7
  v_cvt_pk_bf16_f32 v6, v20, v21
  v_cvt_pk_bf16_f32 v7, v22, v23
  v_pk_fma_f32 v[8:9], v[168:169], v[190:191], v[8:9] op_sel:[0,1,0] op_sel_hi:[1,1,1]
  v_pk_fma_f32 v[10:11], v[170:171], v[190:191], v[10:11] op_sel:[0,1,0] op_sel_hi:[1,1,1]
  v_pk_mul_f32 v[8:9], v[8:9], v[196:197] op_sel:[0,1] op_sel_hi:[1,1]
  v_pk_mul_f32 v[10:11], v[10:11], v[196:197] op_sel:[0,1] op_sel_hi:[1,1]
  v_pk_fma_f32 v[24:25], v[172:173], v[190:191], v[24:25] op_sel:[0,1,0] op_sel_hi:[1,1,1]
  v_pk_fma_f32 v[26:27], v[174:175], v[190:191], v[26:27] op_sel:[0,1,0] op_sel_hi:[1,1,1]
  v_pk_mul_f32 v[24:25], v[24:25], v[196:197] op_sel:[0,1] op_sel_hi:[1,1]
  v_pk_mul_f32 v[26:27], v[26:27], v[196:197] op_sel:[0,1] op_sel_hi:[1,1]
  v_cvt_pk_bf16_f32 v8, v8, v9
  v_cvt_pk_bf16_f32 v9, v10, v11
  v_cvt_pk_bf16_f32 v10, v24, v25
  v_cvt_pk_bf16_f32 v11, v26, v27
  v_pk_fma_f32 v[12:13], v[168:169], v[192:193], v[12:13] op_sel:[0,0,0] op_sel_hi:[1,0,1]
  v_pk_fma_f32 v[14:15], v[170:171], v[192:193], v[14:15] op_sel:[0,0,0] op_sel_hi:[1,0,1]
  v_pk_mul_f32 v[12:13], v[12:13], v[198:199] op_sel:[0,0] op_sel_hi:[1,0]
  v_pk_mul_f32 v[14:15], v[14:15], v[198:199] op_sel:[0,0] op_sel_hi:[1,0]
  v_pk_fma_f32 v[28:29], v[172:173], v[192:193], v[28:29] op_sel:[0,0,0] op_sel_hi:[1,0,1]
  v_pk_fma_f32 v[30:31], v[174:175], v[192:193], v[30:31] op_sel:[0,0,0] op_sel_hi:[1,0,1]
  v_pk_mul_f32 v[28:29], v[28:29], v[198:199] op_sel:[0,0] op_sel_hi:[1,0]
  v_pk_mul_f32 v[30:31], v[30:31], v[198:199] op_sel:[0,0] op_sel_hi:[1,0]
  v_cvt_pk_bf16_f32 v12, v12, v13
  v_cvt_pk_bf16_f32 v13, v14, v15
  v_cvt_pk_bf16_f32 v14, v28, v29
  v_cvt_pk_bf16_f32 v15, v30, v31
  s_nop 1
  v_mfma_f32_16x16x32_bf16 v[16:19], v[32:35], v[0:3], v[136:139]
  v_mfma_f32_16x16x32_bf16 v[56:59], v[36:39], v[0:3], v[128:131]
  v_mfma_f32_16x16x32_bf16 v[20:23], v[36:39], v[4:7], v[132:135]
  v_mfma_f32_16x16x32_bf16 v[60:63], v[40:43], v[4:7], v[128:131]
  v_mfma_f32_16x16x32_bf16 v[24:27], v[40:43], v[8:11], v[132:135]
  v_mfma_f32_16x16x32_bf16 v[64:67], v[44:47], v[8:11], v[128:131]
  v_mfma_f32_16x16x32_bf16 v[28:31], v[44:47], v[12:15], v[132:135]
  v_mfma_f32_16x16x32_bf16 v[68:71], v[48:51], v[12:15], v[128:131]
  s_waitcnt lgkmcnt(0)
  v_pk_fma_f32 v[72:73], v[200:201], v[184:185], v[72:73] op_sel:[0,0,0] op_sel_hi:[1,0,1]
  v_pk_fma_f32 v[74:75], v[202:203], v[184:185], v[74:75] op_sel:[0,0,0] op_sel_hi:[1,0,1]
  v_pk_mul_f32 v[72:73], v[72:73], v[220:221]
  v_pk_mul_f32 v[74:75], v[74:75], v[222:223]
  v_cvt_pk_bf16_f32 v140, v72, v73
  v_cvt_pk_bf16_f32 v141, v74, v75
  v_pk_fma_f32 v[92:93], v[200:201], v[184:185], v[92:93] op_sel:[0,1,0] op_sel_hi:[1,1,1]
  v_pk_fma_f32 v[94:95], v[202:203], v[184:185], v[94:95] op_sel:[0,1,0] op_sel_hi:[1,1,1]
  v_pk_mul_f32 v[92:93], v[92:93], v[220:221]
  v_pk_mul_f32 v[94:95], v[94:95], v[222:223]
  v_cvt_pk_bf16_f32 v150, v92, v93
  v_cvt_pk_bf16_f32 v151, v94, v95
  v_pk_fma_f32 v[76:77], v[204:205], v[184:185], v[76:77] op_sel:[0,0,0] op_sel_hi:[1,0,1]
  v_pk_fma_f32 v[78:79], v[206:207], v[184:185], v[78:79] op_sel:[0,0,0] op_sel_hi:[1,0,1]
  v_pk_mul_f32 v[76:77], v[76:77], v[224:225]
  v_pk_mul_f32 v[78:79], v[78:79], v[226:227]
  v_cvt_pk_bf16_f32 v142, v76, v77
  v_cvt_pk_bf16_f32 v143, v78, v79
  v_pk_fma_f32 v[96:97], v[204:205], v[184:185], v[96:97] op_sel:[0,1,0] op_sel_hi:[1,1,1]
  v_pk_fma_f32 v[98:99], v[206:207], v[184:185], v[98:99] op_sel:[0,1,0] op_sel_hi:[1,1,1]
  v_pk_mul_f32 v[96:97], v[96:97], v[224:225]
  v_pk_mul_f32 v[98:99], v[98:99], v[226:227]
  v_cvt_pk_bf16_f32 v152, v96, v97
  v_cvt_pk_bf16_f32 v153, v98, v99
  v_pk_fma_f32 v[80:81], v[208:209], v[184:185], v[80:81] op_sel:[0,0,0] op_sel_hi:[1,0,1]
  v_pk_fma_f32 v[82:83], v[210:211], v[184:185], v[82:83] op_sel:[0,0,0] op_sel_hi:[1,0,1]
  v_pk_mul_f32 v[80:81], v[80:81], v[228:229]
  v_pk_mul_f32 v[82:83], v[82:83], v[230:231]
  v_cvt_pk_bf16_f32 v144, v80, v81
  v_cvt_pk_bf16_f32 v145, v82, v83
  v_pk_fma_f32 v[100:101], v[208:209], v[184:185], v[100:101] op_sel:[0,1,0] op_sel_hi:[1,1,1]
  v_pk_fma_f32 v[102:103], v[210:211], v[184:185], v[102:103] op_sel:[0,1,0] op_sel_hi:[1,1,1]
  v_pk_mul_f32 v[100:101], v[100:101], v[228:229]
  v_pk_mul_f32 v[102:103], v[102:103], v[230:231]
  v_cvt_pk_bf16_f32 v154, v100, v101
  v_cvt_pk_bf16_f32 v155, v102, v103
  v_pk_fma_f32 v[84:85], v[212:213], v[184:185], v[84:85] op_sel:[0,0,0] op_sel_hi:[1,0,1]
  v_pk_fma_f32 v[86:87], v[214:215], v[184:185], v[86:87] op_sel:[0,0,0] op_sel_hi:[1,0,1]
  v_pk_mul_f32 v[84:85], v[84:85], v[232:233]
  v_pk_mul_f32 v[86:87], v[86:87], v[234:235]
  v_cvt_pk_bf16_f32 v146, v84, v85
  v_cvt_pk_bf16_f32 v147, v86, v87
  v_pk_fma_f32 v[104:105], v[212:213], v[184:185], v[104:105] op_sel:[0,1,0] op_sel_hi:[1,1,1]
  v_pk_fma_f32 v[106:107], v[214:215], v[184:185], v[106:107] op_sel:[0,1,0] op_sel_hi:[1,1,1]
  v_pk_mul_f32 v[104:105], v[104:105], v[232:233]
  v_pk_mul_f32 v[106:107], v[106:107], v[234:235]
  v_cvt_pk_bf16_f32 v156, v104, v105
  v_cvt_pk_bf16_f32 v157, v106, v107
  v_pk_fma_f32 v[88:89], v[216:217], v[184:185], v[88:89] op_sel:[0,0,0] op_sel_hi:[1,0,1]
  v_pk_fma_f32 v[90:91], v[218:219], v[184:185], v[90:91] op_sel:[0,0,0] op_sel_hi:[1,0,1]
  v_pk_mul_f32 v[88:89], v[88:89], v[236:237]
  v_pk_mul_f32 v[90:91], v[90:91], v[238:239]
  v_cvt_pk_bf16_f32 v148, v88, v89
  v_cvt_pk_bf16_f32 v149, v90, v91
  v_pk_fma_f32 v[108:109], v[216:217], v[184:185], v[108:109] op_sel:[0,1,0] op_sel_hi:[1,1,1]
  v_pk_fma_f32 v[110:111], v[218:219], v[184:185], v[110:111] op_sel:[0,1,0] op_sel_hi:[1,1,1]
  v_pk_mul_f32 v[108:109], v[108:109], v[236:237]
  v_pk_mul_f32 v[110:111], v[110:111], v[238:239]
  v_cvt_pk_bf16_f32 v158, v108, v109
  v_cvt_pk_bf16_f32 v159, v110, v111
  v_max3_f32 v240, v16, v17, v18
  v_max3_f32 v240, v240, v19, v56
  v_max3_f32 v240, v240, v57, v58
  v_max_f32 v240, v240, v59
  v_max3_f32 v241, v20, v21, v22
  v_max3_f32 v241, v241, v23, v60
  v_max3_f32 v241, v241, v61, v62
  v_max_f32 v241, v241, v63
  v_max3_f32 v242, v24, v25, v26
  v_max3_f32 v242, v242, v27, v64
  v_max3_f32 v242, v242, v65, v66
  v_max_f32 v242, v242, v67
  v_max3_f32 v243, v28, v29, v30
  v_max3_f32 v243, v243, v31, v68
  v_max3_f32 v243, v243, v69, v70
  v_max_f32 v243, v243, v71
  v_mov_b32 v244, v240
  v_mov_b32 v245, v241
  v_mov_b32 v246, v242
  v_mov_b32 v247, v243
  v_permlane32_swap_b32 v240, v244
  v_permlane32_swap_b32 v241, v245
  v_permlane32_swap_b32 v242, v246
  v_permlane32_swap_b32 v243, v247
  v_max_f32 v240, v240, v244
  v_max_f32 v241, v241, v245
  v_max_f32 v242, v242, v246
  v_max_f32 v243, v243, v247
  v_mov_b32 v244, v240
  v_mov_b32 v245, v241
  v_mov_b32 v246, v242
  v_mov_b32 v247, v243
  v_permlane16_swap_b32 v240, v244
  v_permlane16_swap_b32 v241, v245
  v_permlane16_swap_b32 v242, v246
  v_permlane16_swap_b32 v243, v247
  v_max_f32 v240, v240, v244
  v_max_f32 v241, v241, v245
  v_max_f32 v242, v242, v246
  v_max_f32 v243, v243, v247
  s_mov_b32 s43, 0x3e8293ee
  v_mul_f32 v240, 0xbe8293ee, v240
  v_mul_f32 v241, 0xbe8293ee, v241
  v_mul_f32 v242, 0xbe8293ee, v242
  v_mul_f32 v243, 0xbe8293ee, v243
  v_mov_b32 v160, 0x3f803f80
  v_mov_b32 v161, 0x3f803f80
  v_mov_b32 v162, 0x3f803f80
  v_mov_b32 v163, 0x3f803f80
  v_fma_f32 v16, v16, s43, v240
  v_fma_f32 v17, v17, s43, v240
  v_fma_f32 v18, v18, s43, v240
  v_fma_f32 v19, v19, s43, v240
  v_fma_f32 v56, v56, s43, v240
  v_fma_f32 v57, v57, s43, v240
  v_fma_f32 v58, v58, s43, v240
  v_fma_f32 v59, v59, s43, v240
  v_exp_f32 v16, v16
  v_exp_f32 v17, v17
  v_exp_f32 v18, v18
  v_exp_f32 v19, v19
  v_exp_f32 v56, v56
  v_exp_f32 v57, v57
  v_exp_f32 v58, v58
  v_exp_f32 v59, v59
  v_cvt_pk_bf16_f32 v0, v16, v17
  v_cvt_pk_bf16_f32 v1, v18, v19
  v_cvt_pk_bf16_f32 v2, v56, v57
  v_cvt_pk_bf16_f32 v3, v58, v59
  v_fma_f32 v20, v20, s43, v241
  v_fma_f32 v21, v21, s43, v241
  v_fma_f32 v22, v22, s43, v241
  v_fma_f32 v23, v23, s43, v241
  v_fma_f32 v60, v60, s43, v241
  v_fma_f32 v61, v61, s43, v241
  v_fma_f32 v62, v62, s43, v241
  v_fma_f32 v63, v63, s43, v241
  v_exp_f32 v20, v20
  v_exp_f32 v21, v21
  v_exp_f32 v22, v22
  v_exp_f32 v23, v23
  v_exp_f32 v60, v60
  v_exp_f32 v61, v61
  v_exp_f32 v62, v62
  v_exp_f32 v63, v63
  v_cvt_pk_bf16_f32 v4, v20, v21
  v_cvt_pk_bf16_f32 v5, v22, v23
  v_cvt_pk_bf16_f32 v6, v60, v61
  v_cvt_pk_bf16_f32 v7, v62, v63
  v_fma_f32 v24, v24, s43, v242
  v_fma_f32 v25, v25, s43, v242
  v_fma_f32 v26, v26, s43, v242
  v_fma_f32 v27, v27, s43, v242
  v_fma_f32 v64, v64, s43, v242
  v_fma_f32 v65, v65, s43, v242
  v_fma_f32 v66, v66, s43, v242
  v_fma_f32 v67, v67, s43, v242
  v_exp_f32 v24, v24
  v_exp_f32 v25, v25
  v_exp_f32 v26, v26
  v_exp_f32 v27, v27
  v_exp_f32 v64, v64
  v_exp_f32 v65, v65
  v_exp_f32 v66, v66
  v_exp_f32 v67, v67
  v_cvt_pk_bf16_f32 v8, v24, v25
  v_cvt_pk_bf16_f32 v9, v26, v27
  v_cvt_pk_bf16_f32 v10, v64, v65
  v_cvt_pk_bf16_f32 v11, v66, v67
  v_fma_f32 v28, v28, s43, v243
  v_fma_f32 v29, v29, s43, v243
  v_fma_f32 v30, v30, s43, v243
  v_fma_f32 v31, v31, s43, v243
  v_fma_f32 v68, v68, s43, v243
  v_fma_f32 v69, v69, s43, v243
  v_fma_f32 v70, v70, s43, v243
  v_fma_f32 v71, v71, s43, v243
  v_exp_f32 v28, v28
  v_exp_f32 v29, v29
  v_exp_f32 v30, v30
  v_exp_f32 v31, v31
  v_exp_f32 v68, v68
  v_exp_f32 v69, v69
  v_exp_f32 v70, v70
  v_exp_f32 v71, v71
  v_cvt_pk_bf16_f32 v12, v28, v29
  v_cvt_pk_bf16_f32 v13, v30, v31
  v_cvt_pk_bf16_f32 v14, v68, v69
  v_cvt_pk_bf16_f32 v15, v70, v71
  s_nop 1
  v_mfma_f32_16x16x32_bf16 v[36:39], v[160:163], v[0:3], 0
  v_mfma_f32_16x16x32_bf16 v[76:79], v[140:143], v[0:3], 0
  v_mfma_f32_16x16x32_bf16 v[96:99], v[150:153], v[0:3], 0
  v_mfma_f32_16x16x32_bf16 v[40:43], v[160:163], v[4:7], 0
  v_mfma_f32_16x16x32_bf16 v[80:83], v[142:145], v[4:7], 0
  v_mfma_f32_16x16x32_bf16 v[100:103], v[152:155], v[4:7], 0
  v_mfma_f32_16x16x32_bf16 v[44:47], v[160:163], v[8:11], 0
  v_mfma_f32_16x16x32_bf16 v[84:87], v[144:147], v[8:11], 0
  v_mfma_f32_16x16x32_bf16 v[104:107], v[154:157], v[8:11], 0
  v_mfma_f32_16x16x32_bf16 v[48:51], v[160:163], v[12:15], 0
  v_mfma_f32_16x16x32_bf16 v[88:91], v[146:149], v[12:15], 0
  v_mfma_f32_16x16x32_bf16 v[108:111], v[156:159], v[12:15], 0
  s_lshl_b32 s43, s48, 15
  s_lshl_b32 s57, s57, 10
  s_add_u32 s43, s43, s57
  s_add_u32 s64, s43, 16777216
  s_add_u32 s65, s64, 32768
  s_add_u32 s66, s65, 32768
  s_add_u32 s67, s66, 32768
  s_nop 0
  v_rcp_f32 v36, v36
  v_rcp_f32 v40, v40
  v_rcp_f32 v44, v44
  v_rcp_f32 v48, v48
  v_pk_mul_f32 v[76:77], v[76:77], v[36:37] op_sel:[0,0] op_sel_hi:[1,0]
  v_pk_mul_f32 v[78:79], v[78:79], v[36:37] op_sel:[0,0] op_sel_hi:[1,0]
  v_pk_mul_f32 v[96:97], v[96:97], v[36:37] op_sel:[0,0] op_sel_hi:[1,0]
  v_pk_mul_f32 v[98:99], v[98:99], v[36:37] op_sel:[0,0] op_sel_hi:[1,0]
  v_cvt_pk_bf16_f32 v16, v76, v77
  v_cvt_pk_bf16_f32 v17, v78, v79
  v_cvt_pk_bf16_f32 v18, v96, v97
  v_cvt_pk_bf16_f32 v19, v98, v99
  buffer_store_dwordx4 v[16:19], v119, s[4:7], s64 offen
  v_pk_mul_f32 v[80:81], v[80:81], v[40:41] op_sel:[0,0] op_sel_hi:[1,0]
  v_pk_mul_f32 v[82:83], v[82:83], v[40:41] op_sel:[0,0] op_sel_hi:[1,0]
  v_pk_mul_f32 v[100:101], v[100:101], v[40:41] op_sel:[0,0] op_sel_hi:[1,0]
  v_pk_mul_f32 v[102:103], v[102:103], v[40:41] op_sel:[0,0] op_sel_hi:[1,0]
  v_cvt_pk_bf16_f32 v20, v80, v81
  v_cvt_pk_bf16_f32 v21, v82, v83
  v_cvt_pk_bf16_f32 v22, v100, v101
  v_cvt_pk_bf16_f32 v23, v102, v103
  buffer_store_dwordx4 v[20:23], v119, s[4:7], s65 offen
  v_pk_mul_f32 v[84:85], v[84:85], v[44:45] op_sel:[0,0] op_sel_hi:[1,0]
  v_pk_mul_f32 v[86:87], v[86:87], v[44:45] op_sel:[0,0] op_sel_hi:[1,0]
  v_pk_mul_f32 v[104:105], v[104:105], v[44:45] op_sel:[0,0] op_sel_hi:[1,0]
  v_pk_mul_f32 v[106:107], v[106:107], v[44:45] op_sel:[0,0] op_sel_hi:[1,0]
  v_cvt_pk_bf16_f32 v24, v84, v85
  v_cvt_pk_bf16_f32 v25, v86, v87
  v_cvt_pk_bf16_f32 v26, v104, v105
  v_cvt_pk_bf16_f32 v27, v106, v107
  buffer_store_dwordx4 v[24:27], v119, s[4:7], s66 offen
  v_pk_mul_f32 v[88:89], v[88:89], v[48:49] op_sel:[0,0] op_sel_hi:[1,0]
  v_pk_mul_f32 v[90:91], v[90:91], v[48:49] op_sel:[0,0] op_sel_hi:[1,0]
  v_pk_mul_f32 v[108:109], v[108:109], v[48:49] op_sel:[0,0] op_sel_hi:[1,0]
  v_pk_mul_f32 v[110:111], v[110:111], v[48:49] op_sel:[0,0] op_sel_hi:[1,0]
  v_cvt_pk_bf16_f32 v28, v88, v89
  v_cvt_pk_bf16_f32 v29, v90, v91
  v_cvt_pk_bf16_f32 v30, v108, v109
  v_cvt_pk_bf16_f32 v31, v110, v111
  buffer_store_dwordx4 v[28:31], v119, s[4:7], s67 offen
  s_endpgm
.globl o1_kernel
.p2align 8
.type o1_kernel,@function
o1_kernel:
  s_mov_b32 s40, 0x0
  s_mov_b32 s41, 0x400000
  s_mov_b32 s47, 0x2240000
  s_cmp_lt_u32 s2, 256
  s_cbranch_scc1 o_body
  s_endpgm
.globl o2_kernel
.p2align 8
.type o2_kernel,@function
o2_kernel:
  s_mov_b32 s40, 0x800000
  s_mov_b32 s41, 0xc00000
  s_mov_b32 s47, 0x22c0000
  s_cmp_lt_u32 s2, 256
  s_cbranch_scc1 o_body
  s_endpgm
.p2align 6
o_body:
  s_load_dwordx2 s[32:33], s[0:1], 72
  s_load_dwordx2 s[36:37], s[0:1], 16
  s_load_dwordx2 s[38:39], s[0:1], 56
  v_lshrrev_b32 v1, 6, v0
  v_and_b32 v47, 63, v0
  v_readfirstlane_b32 s24, v1
  s_and_b32 s34, s2, 7
  s_lshr_b32 s35, s2, 3
  s_and_b32 s25, s34, 3
  s_lshl_b32 s25, s25, 2
  s_and_b32 s43, s35, 3
  s_add_u32 s25, s25, s43
  s_lshr_b32 s26, s34, 2
  s_lshl_b32 s26, s26, 3
  s_lshr_b32 s43, s35, 2
  s_add_u32 s26, s26, s43
  v_lshrrev_b32 v2, 3, v47
  v_bfe_u32 v3, v47, 1, 2
  v_lshrrev_b32 v4, 4, v47
  v_xor_b32 v3, v3, v4
  v_and_b32 v4, 1, v47
  v_lshlrev_b32 v2, 11, v2
  v_lshl_add_u32 v2, v3, 5, v2
  v_lshl_add_u32 v44, v4, 4, v2
  v_lshlrev_b32 v45, 4, v47
  v_add_u32 v46, 32768, v45
  s_lshl_b32 s44, s25, 3
  s_lshl_b32 s43, s24, 1
  s_add_u32 s44, s44, s43
  s_mul_i32 s28, s44, 32768
  s_add_u32 s28, s28, 16777216
  s_lshl_b32 s29, s26, 7
  s_lshl_b32 s43, s24, 14
  s_add_u32 s29, s29, s43
  s_lshl_b32 s30, s24, 10
  s_lshl_b32 s45, s44, 15
  s_lshl_b32 s43, s26, 11
  s_add_u32 s45, s45, s43
  s_add_u32 s46, s45, s40
  s_add_u32 s49, s46, 32768
  s_waitcnt lgkmcnt(0)
  s_mov_b32 s4, s32
  s_mov_b32 s5, s33
  s_mov_b32 s6, 0x10000000
  s_mov_b32 s7, 0x20000
  s_mov_b32 s8, s36
  s_mov_b32 s9, s37
  s_mov_b32 s10, 0x200000
  s_mov_b32 s11, 0x20000
  s_mov_b32 s12, s38
  s_mov_b32 s13, s39
  s_mov_b32 s14, 0x400000
  s_mov_b32 s15, 0x20000
  s_add_u32 m0, s30, 0
  s_nop 0
  buffer_load_dwordx4 v44, s[8:11], s29 offen lds
  s_add_u32 s29, s29, 65536
  buffer_load_dwordx4 v[48:51], v45, s[4:7], s46 offen offset:0
  buffer_load_dwordx4 v[52:55], v45, s[4:7], s46 offen offset:1024
  buffer_load_dwordx4 v[56:59], v45, s[4:7], s49 offen offset:0
  buffer_load_dwordx4 v[60:63], v45, s[4:7], s49 offen offset:1024
  s_add_u32 m0, s30, 4096
  s_nop 0
  buffer_load_dwordx4 v44, s[8:11], s29 offen lds
  s_add_u32 s29, s29, 65536
  buffer_load_dwordx4 a[0:3], v45, s[4:7], s28 offen
  buffer_load_dwordx4 a[4:7], v46, s[4:7], s28 offen
  s_add_u32 s28, s28, 1024
  s_add_u32 m0, s30, 8192
  s_nop 0
  buffer_load_dwordx4 v44, s[8:11], s29 offen lds
  s_add_u32 s29, s29, 65536
  buffer_load_dwordx4 a[8:11], v45, s[4:7], s28 offen
  buffer_load_dwordx4 a[12:15], v46, s[4:7], s28 offen
  s_add_u32 s28, s28, 1024
  s_add_u32 m0, s30, 12288
  s_nop 0
  buffer_load_dwordx4 v44, s[8:11], s29 offen lds
  s_add_u32 s29, s29, 65536
  buffer_load_dwordx4 a[16:19], v45, s[4:7], s28 offen
  buffer_load_dwordx4 a[20:23], v46, s[4:7], s28 offen
  s_add_u32 s28, s28, 1024
  s_add_u32 m0, s30, 16384
  s_nop 0
  buffer_load_dwordx4 v44, s[8:11], s29 offen lds
  s_add_u32 s29, s29, 65536
  buffer_load_dwordx4 a[24:27], v45, s[4:7], s28 offen
  buffer_load_dwordx4 a[28:31], v46, s[4:7], s28 offen
  s_add_u32 s28, s28, 1024
  s_add_u32 m0, s30, 20480
  s_nop 0
  buffer_load_dwordx4 v44, s[8:11], s29 offen lds
  s_add_u32 s29, s29, 65536
  buffer_load_dwordx4 a[32:35], v45, s[4:7], s28 offen
  buffer_load_dwordx4 a[36:39], v46, s[4:7], s28 offen
  s_add_u32 s28, s28, 1024
  v_lshrrev_b32 v2, 2, v47
  v_bfe_u32 v3, v47, 3, 2
  v_and_b32 v4, 3, v47
  v_lshlrev_b32 v4, 3, v4
  v_lshl_add_u32 v4, v2, 7, v4
  v_xor_b32 v5, 0, v3
  v_lshl_add_u32 v40, v5, 5, v4
  v_xor_b32 v5, 1, v3
  v_lshl_add_u32 v41, v5, 5, v4
  v_xor_b32 v5, 2, v3
  v_lshl_add_u32 v42, v5, 5, v4
  v_xor_b32 v5, 3, v3
  v_lshl_add_u32 v43, v5, 5, v4
  s_waitcnt vmcnt(15)
  v_lshlrev_b32 v0, 16, v48
  v_and_b32 v1, 0xffff0000, v48
  v_lshlrev_b32 v2, 16, v49
  v_and_b32 v3, 0xffff0000, v49
  v_lshlrev_b32 v8, 16, v50
  v_and_b32 v9, 0xffff0000, v50
  v_lshlrev_b32 v10, 16, v51
  v_and_b32 v11, 0xffff0000, v51
  v_lshlrev_b32 v16, 16, v52
  v_and_b32 v17, 0xffff0000, v52
  v_lshlrev_b32 v18, 16, v53
  v_and_b32 v19, 0xffff0000, v53
  v_lshlrev_b32 v24, 16, v54
  v_and_b32 v25, 0xffff0000, v54
  v_lshlrev_b32 v26, 16, v55
  v_and_b32 v27, 0xffff0000, v55
  v_lshlrev_b32 v4, 16, v56
  v_and_b32 v5, 0xffff0000, v56
  v_lshlrev_b32 v6, 16, v57
  v_and_b32 v7, 0xffff0000, v57
  v_lshlrev_b32 v12, 16, v58
  v_and_b32 v13, 0xffff0000, v58
  v_lshlrev_b32 v14, 16, v59
  v_and_b32 v15, 0xffff0000, v59
  v_lshlrev_b32 v20, 16, v60
  v_and_b32 v21, 0xffff0000, v60
  v_lshlrev_b32 v22, 16, v61
  v_and_b32 v23, 0xffff0000, v61
  v_lshlrev_b32 v28, 16, v62
  v_and_b32 v29, 0xffff0000, v62
  v_lshlrev_b32 v30, 16, v63
  v_and_b32 v31, 0xffff0000, v63
  s_waitcnt vmcnt(14)
  s_barrier
  ds_read_b64_tr_b16 a[64:65], v40 offset:0
  ds_read_b64_tr_b16 a[66:67], v40 offset:2048
  ds_read_b64_tr_b16 a[68:69], v41 offset:0
  ds_read_b64_tr_b16 a[70:71], v41 offset:2048
  ds_read_b64_tr_b16 a[72:73], v42 offset:0
  ds_read_b64_tr_b16 a[74:75], v42 offset:2048
  ds_read_b64_tr_b16 a[76:77], v43 offset:0
  ds_read_b64_tr_b16 a[78:79], v43 offset:2048
  s_waitcnt vmcnt(12) lgkmcnt(6)
  v_mfma_f32_16x16x32_bf16 v[0:3], a[64:67], a[0:3], v[0:3]
  ds_read_b64_tr_b16 a[80:81], v40 offset:4096
  v_mfma_f32_16x16x32_bf16 v[4:7], a[64:67], a[4:7], v[4:7]
  ds_read_b64_tr_b16 a[82:83], v40 offset:6144
  s_add_u32 m0, s30, 24576
  s_nop 0
  buffer_load_dwordx4 v44, s[8:11], s29 offen lds
  s_add_u32 s29, s29, 65536
  s_waitcnt lgkmcnt(6)
  v_mfma_f32_16x16x32_bf16 v[12:15], a[68:71], a[4:7], v[12:15]
  ds_read_b64_tr_b16 a[84:85], v41 offset:4096
  v_mfma_f32_16x16x32_bf16 v[8:11], a[68:71], a[0:3], v[8:11]
  ds_read_b64_tr_b16 a[86:87], v41 offset:6144
  buffer_load_dwordx4 a[40:43], v45, s[4:7], s28 offen
  s_waitcnt lgkmcnt(6)
  v_mfma_f32_16x16x32_bf16 v[16:19], a[72:75], a[0:3], v[16:19]
  ds_read_b64_tr_b16 a[88:89], v42 offset:4096
  v_mfma_f32_16x16x32_bf16 v[20:23], a[72:75], a[4:7], v[20:23]
  ds_read_b64_tr_b16 a[90:91], v42 offset:6144
  buffer_load_dwordx4 a[44:47], v46, s[4:7], s28 offen
  s_add_u32 s28, s28, 1024
  s_waitcnt lgkmcnt(6)
  v_mfma_f32_16x16x32_bf16 v[28:31], a[76:79], a[4:7], v[28:31]
  ds_read_b64_tr_b16 a[92:93], v43 offset:4096
  v_mfma_f32_16x16x32_bf16 v[24:27], a[76:79], a[0:3], v[24:27]
  ds_read_b64_tr_b16 a[94:95], v43 offset:6144
  s_waitcnt vmcnt(12) lgkmcnt(6)
  v_mfma_f32_16x16x32_bf16 v[0:3], a[80:83], a[8:11], v[0:3]
  s_waitcnt vmcnt(11)
  s_barrier
  ds_read_b64_tr_b16 a[64:65], v40 offset:8192
  v_mfma_f32_16x16x32_bf16 v[4:7], a[80:83], a[12:15], v[4:7]
  ds_read_b64_tr_b16 a[66:67], v40 offset:10240
  s_add_u32 m0, s30, 28672
  s_nop 0
  buffer_load_dwordx4 v44, s[8:11], s29 offen lds
  s_add_u32 s29, s29, 65536
  s_waitcnt lgkmcnt(6)
  v_mfma_f32_16x16x32_bf16 v[12:15], a[84:87], a[12:15], v[12:15]
  ds_read_b64_tr_b16 a[68:69], v41 offset:8192
  v_mfma_f32_16x16x32_bf16 v[8:11], a[84:87], a[8:11], v[8:11]
  ds_read_b64_tr_b16 a[70:71], v41 offset:10240
  buffer_load_dwordx4 a[48:51], v45, s[4:7], s28 offen
  s_waitcnt lgkmcnt(6)
  v_mfma_f32_16x16x32_bf16 v[16:19], a[88:91], a[8:11], v[16:19]
  ds_read_b64_tr_b16 a[72:73], v42 offset:8192
  v_mfma_f32_16x16x32_bf16 v[20:23], a[88:91], a[12:15], v[20:23]
  ds_read_b64_tr_b16 a[74:75], v42 offset:10240
  buffer_load_dwordx4 a[52:55], v46, s[4:7], s28 offen
  s_add_u32 s28, s28, 1024
  s_waitcnt lgkmcnt(6)
  v_mfma_f32_16x16x32_bf16 v[28:31], a[92:95], a[12:15], v[28:31]
  ds_read_b64_tr_b16 a[76:77], v43 offset:8192
  v_mfma_f32_16x16x32_bf16 v[24:27], a[92:95], a[8:11], v[24:27]
  ds_read_b64_tr_b16 a[78:79], v43 offset:10240
  s_waitcnt vmcnt(12) lgkmcnt(6)
  v_mfma_f32_16x16x32_bf16 v[0:3], a[64:67], a[16:19], v[0:3]
  ds_read_b64_tr_b16 a[80:81], v40 offset:12288
  v_mfma_f32_16x16x32_bf16 v[4:7], a[64:67], a[20:23], v[4:7]
  ds_read_b64_tr_b16 a[82:83], v40 offset:14336
  s_add_u32 m0, s30, 32768
  s_nop 0
  buffer_load_dwordx4 v44, s[8:11], s29 offen lds
  s_add_u32 s29, s29, 65536
  s_waitcnt lgkmcnt(6)
  v_mfma_f32_16x16x32_bf16 v[12:15], a[68:71], a[20:23], v[12:15]
  ds_read_b64_tr_b16 a[84:85], v41 offset:12288
  v_mfma_f32_16x16x32_bf16 v[8:11], a[68:71], a[16:19], v[8:11]
  ds_read_b64_tr_b16 a[86:87], v41 offset:14336
  buffer_load_dwordx4 a[56:59], v45, s[4:7], s28 offen
  s_waitcnt lgkmcnt(6)
  v_mfma_f32_16x16x32_bf16 v[16:19], a[72:75], a[16:19], v[16:19]
  ds_read_b64_tr_b16 a[88:89], v42 offset:12288
  v_mfma_f32_16x16x32_bf16 v[20:23], a[72:75], a[20:23], v[20:23]
  ds_read_b64_tr_b16 a[90:91], v42 offset:14336
  buffer_load_dwordx4 a[60:63], v46, s[4:7], s28 offen
  s_add_u32 s28, s28, 1024
  s_waitcnt lgkmcnt(6)
  v_mfma_f32_16x16x32_bf16 v[28:31], a[76:79], a[20:23], v[28:31]
  ds_read_b64_tr_b16 a[92:93], v43 offset:12288
  v_mfma_f32_16x16x32_bf16 v[24:27], a[76:79], a[16:19], v[24:27]
  ds_read_b64_tr_b16 a[94:95], v43 offset:14336
  s_waitcnt vmcnt(12) lgkmcnt(6)
  v_mfma_f32_16x16x32_bf16 v[0:3], a[80:83], a[24:27], v[0:3]
  s_waitcnt vmcnt(11)
  s_barrier
  ds_read_b64_tr_b16 a[64:65], v40 offset:16384
  v_mfma_f32_16x16x32_bf16 v[4:7], a[80:83], a[28:31], v[4:7]
  ds_read_b64_tr_b16 a[66:67], v40 offset:18432
  s_add_u32 m0, s30, 36864
  s_nop 0
  buffer_load_dwordx4 v44, s[8:11], s29 offen lds
  s_add_u32 s29, s29, 65536
  s_waitcnt lgkmcnt(6)
  v_mfma_f32_16x16x32_bf16 v[12:15], a[84:87], a[28:31], v[12:15]
  ds_read_b64_tr_b16 a[68:69], v41 offset:16384
  v_mfma_f32_16x16x32_bf16 v[8:11], a[84:87], a[24:27], v[8:11]
  ds_read_b64_tr_b16 a[70:71], v41 offset:18432
  buffer_load_dwordx4 a[0:3], v45, s[4:7], s28 offen
  s_waitcnt lgkmcnt(6)
  v_mfma_f32_16x16x32_bf16 v[16:19], a[88:91], a[24:27], v[16:19]
  ds_read_b64_tr_b16 a[72:73], v42 offset:16384
  v_mfma_f32_16x16x32_bf16 v[20:23], a[88:91], a[28:31], v[20:23]
  ds_read_b64_tr_b16 a[74:75], v42 offset:18432
  buffer_load_dwordx4 a[4:7], v46, s[4:7], s28 offen
  s_add_u32 s28, s28, 1024
  s_waitcnt lgkmcnt(6)
  v_mfma_f32_16x16x32_bf16 v[28:31], a[92:95], a[28:31], v[28:31]
  ds_read_b64_tr_b16 a[76:77], v43 offset:16384
  v_mfma_f32_16x16x32_bf16 v[24:27], a[92:95], a[24:27], v[24:27]
  ds_read_b64_tr_b16 a[78:79], v43 offset:18432
  s_waitcnt vmcnt(12) lgkmcnt(6)
  v_mfma_f32_16x16x32_bf16 v[0:3], a[64:67], a[32:35], v[0:3]
  ds_read_b64_tr_b16 a[80:81], v40 offset:20480
  v_mfma_f32_16x16x32_bf16 v[4:7], a[64:67], a[36:39], v[4:7]
  ds_read_b64_tr_b16 a[82:83], v40 offset:22528
  s_add_u32 m0, s30, 40960
  s_nop 0
  buffer_load_dwordx4 v44, s[8:11], s29 offen lds
  s_add_u32 s29, s29, 65536
  s_waitcnt lgkmcnt(6)
  v_mfma_f32_16x16x32_bf16 v[12:15], a[68:71], a[36:39], v[12:15]
  ds_read_b64_tr_b16 a[84:85], v41 offset:20480
  v_mfma_f32_16x16x32_bf16 v[8:11], a[68:71], a[32:35], v[8:11]
  ds_read_b64_tr_b16 a[86:87], v41 offset:22528
  buffer_load_dwordx4 a[8:11], v45, s[4:7], s28 offen
  s_waitcnt lgkmcnt(6)
  v_mfma_f32_16x16x32_bf16 v[16:19], a[72:75], a[32:35], v[16:19]
  ds_read_b64_tr_b16 a[88:89], v42 offset:20480
  v_mfma_f32_16x16x32_bf16 v[20:23], a[72:75], a[36:39], v[20:23]
  ds_read_b64_tr_b16 a[90:91], v42 offset:22528
  buffer_load_dwordx4 a[12:15], v46, s[4:7], s28 offen
  s_add_u32 s28, s28, 1024
  s_waitcnt lgkmcnt(6)
  v_mfma_f32_16x16x32_bf16 v[28:31], a[76:79], a[36:39], v[28:31]
  ds_read_b64_tr_b16 a[92:93], v43 offset:20480
  v_mfma_f32_16x16x32_bf16 v[24:27], a[76:79], a[32:35], v[24:27]
  ds_read_b64_tr_b16 a[94:95], v43 offset:22528
  s_waitcnt vmcnt(12) lgkmcnt(6)
  v_mfma_f32_16x16x32_bf16 v[0:3], a[80:83], a[40:43], v[0:3]
  s_waitcnt vmcnt(11)
  s_barrier
  ds_read_b64_tr_b16 a[64:65], v40 offset:24576
  v_mfma_f32_16x16x32_bf16 v[4:7], a[80:83], a[44:47], v[4:7]
  ds_read_b64_tr_b16 a[66:67], v40 offset:26624
  s_add_u32 m0, s30, 45056
  s_nop 0
  buffer_load_dwordx4 v44, s[8:11], s29 offen lds
  s_add_u32 s29, s29, 65536
  s_waitcnt lgkmcnt(6)
  v_mfma_f32_16x16x32_bf16 v[12:15], a[84:87], a[44:47], v[12:15]
  ds_read_b64_tr_b16 a[68:69], v41 offset:24576
  v_mfma_f32_16x16x32_bf16 v[8:11], a[84:87], a[40:43], v[8:11]
  ds_read_b64_tr_b16 a[70:71], v41 offset:26624
  buffer_load_dwordx4 a[16:19], v45, s[4:7], s28 offen
  s_waitcnt lgkmcnt(6)
  v_mfma_f32_16x16x32_bf16 v[16:19], a[88:91], a[40:43], v[16:19]
  ds_read_b64_tr_b16 a[72:73], v42 offset:24576
  v_mfma_f32_16x16x32_bf16 v[20:23], a[88:91], a[44:47], v[20:23]
  ds_read_b64_tr_b16 a[74:75], v42 offset:26624
  buffer_load_dwordx4 a[20:23], v46, s[4:7], s28 offen
  s_add_u32 s28, s28, 1024
  s_waitcnt lgkmcnt(6)
  v_mfma_f32_16x16x32_bf16 v[28:31], a[92:95], a[44:47], v[28:31]
  ds_read_b64_tr_b16 a[76:77], v43 offset:24576
  v_mfma_f32_16x16x32_bf16 v[24:27], a[92:95], a[40:43], v[24:27]
  ds_read_b64_tr_b16 a[78:79], v43 offset:26624
  s_waitcnt vmcnt(12) lgkmcnt(6)
  v_mfma_f32_16x16x32_bf16 v[0:3], a[64:67], a[48:51], v[0:3]
  ds_read_b64_tr_b16 a[80:81], v40 offset:28672
  v_mfma_f32_16x16x32_bf16 v[4:7], a[64:67], a[52:55], v[4:7]
  ds_read_b64_tr_b16 a[82:83], v40 offset:30720
  s_add_u32 m0, s30, 49152
  s_nop 0
  buffer_load_dwordx4 v44, s[8:11], s29 offen lds
  s_add_u32 s29, s29, 65536
  s_waitcnt lgkmcnt(6)
  v_mfma_f32_16x16x32_bf16 v[12:15], a[68:71], a[52:55], v[12:15]
  ds_read_b64_tr_b16 a[84:85], v41 offset:28672
  v_mfma_f32_16x16x32_bf16 v[8:11], a[68:71], a[48:51], v[8:11]
  ds_read_b64_tr_b16 a[86:87], v41 offset:30720
  buffer_load_dwordx4 a[24:27], v45, s[4:7], s28 offen
  s_waitcnt lgkmcnt(6)
  v_mfma_f32_16x16x32_bf16 v[16:19], a[72:75], a[48:51], v[16:19]
  ds_read_b64_tr_b16 a[88:89], v42 offset:28672
  v_mfma_f32_16x16x32_bf16 v[20:23], a[72:75], a[52:55], v[20:23]
  ds_read_b64_tr_b16 a[90:91], v42 offset:30720
  buffer_load_dwordx4 a[28:31], v46, s[4:7], s28 offen
  s_add_u32 s28, s28, 1024
  s_waitcnt lgkmcnt(6)
  v_mfma_f32_16x16x32_bf16 v[28:31], a[76:79], a[52:55], v[28:31]
  ds_read_b64_tr_b16 a[92:93], v43 offset:28672
  v_mfma_f32_16x16x32_bf16 v[24:27], a[76:79], a[48:51], v[24:27]
  ds_read_b64_tr_b16 a[94:95], v43 offset:30720
  s_waitcnt vmcnt(12) lgkmcnt(6)
  v_mfma_f32_16x16x32_bf16 v[0:3], a[80:83], a[56:59], v[0:3]
  s_waitcnt vmcnt(11)
  s_barrier
  ds_read_b64_tr_b16 a[64:65], v40 offset:32768
  v_mfma_f32_16x16x32_bf16 v[4:7], a[80:83], a[60:63], v[4:7]
  ds_read_b64_tr_b16 a[66:67], v40 offset:34816
  s_add_u32 m0, s30, 53248
  s_nop 0
  buffer_load_dwordx4 v44, s[8:11], s29 offen lds
  s_add_u32 s29, s29, 65536
  s_waitcnt lgkmcnt(6)
  v_mfma_f32_16x16x32_bf16 v[12:15], a[84:87], a[60:63], v[12:15]
  ds_read_b64_tr_b16 a[68:69], v41 offset:32768
  v_mfma_f32_16x16x32_bf16 v[8:11], a[84:87], a[56:59], v[8:11]
  ds_read_b64_tr_b16 a[70:71], v41 offset:34816
  buffer_load_dwordx4 a[32:35], v45, s[4:7], s28 offen
  s_waitcnt lgkmcnt(6)
  v_mfma_f32_16x16x32_bf16 v[16:19], a[88:91], a[56:59], v[16:19]
  ds_read_b64_tr_b16 a[72:73], v42 offset:32768
  v_mfma_f32_16x16x32_bf16 v[20:23], a[88:91], a[60:63], v[20:23]
  ds_read_b64_tr_b16 a[74:75], v42 offset:34816
  buffer_load_dwordx4 a[36:39], v46, s[4:7], s28 offen
  s_add_u32 s28, s28, 1024
  s_waitcnt lgkmcnt(6)
  v_mfma_f32_16x16x32_bf16 v[28:31], a[92:95], a[60:63], v[28:31]
  ds_read_b64_tr_b16 a[76:77], v43 offset:32768
  v_mfma_f32_16x16x32_bf16 v[24:27], a[92:95], a[56:59], v[24:27]
  ds_read_b64_tr_b16 a[78:79], v43 offset:34816
  s_waitcnt vmcnt(12) lgkmcnt(6)
  v_mfma_f32_16x16x32_bf16 v[0:3], a[64:67], a[0:3], v[0:3]
  ds_read_b64_tr_b16 a[80:81], v40 offset:36864
  v_mfma_f32_16x16x32_bf16 v[4:7], a[64:67], a[4:7], v[4:7]
  ds_read_b64_tr_b16 a[82:83], v40 offset:38912
  s_add_u32 m0, s30, 57344
  s_nop 0
  buffer_load_dwordx4 v44, s[8:11], s29 offen lds
  s_add_u32 s29, s29, 65536
  s_waitcnt lgkmcnt(6)
  v_mfma_f32_16x16x32_bf16 v[12:15], a[68:71], a[4:7], v[12:15]
  ds_read_b64_tr_b16 a[84:85], v41 offset:36864
  v_mfma_f32_16x16x32_bf16 v[8:11], a[68:71], a[0:3], v[8:11]
  ds_read_b64_tr_b16 a[86:87], v41 offset:38912
  buffer_load_dwordx4 a[40:43], v45, s[4:7], s28 offen
  s_waitcnt lgkmcnt(6)
  v_mfma_f32_16x16x32_bf16 v[16:19], a[72:75], a[0:3], v[16:19]
  ds_read_b64_tr_b16 a[88:89], v42 offset:36864
  v_mfma_f32_16x16x32_bf16 v[20:23], a[72:75], a[4:7], v[20:23]
  ds_read_b64_tr_b16 a[90:91], v42 offset:38912
  buffer_load_dwordx4 a[44:47], v46, s[4:7], s28 offen
  s_add_u32 s28, s28, 1024
  s_waitcnt lgkmcnt(6)
  v_mfma_f32_16x16x32_bf16 v[28:31], a[76:79], a[4:7], v[28:31]
  ds_read_b64_tr_b16 a[92:93], v43 offset:36864
  v_mfma_f32_16x16x32_bf16 v[24:27], a[76:79], a[0:3], v[24:27]
  ds_read_b64_tr_b16 a[94:95], v43 offset:38912
  s_waitcnt vmcnt(12) lgkmcnt(6)
  v_mfma_f32_16x16x32_bf16 v[0:3], a[80:83], a[8:11], v[0:3]
  s_waitcnt vmcnt(11)
  s_barrier
  ds_read_b64_tr_b16 a[64:65], v40 offset:40960
  v_mfma_f32_16x16x32_bf16 v[4:7], a[80:83], a[12:15], v[4:7]
  ds_read_b64_tr_b16 a[66:67], v40 offset:43008
  s_add_u32 m0, s30, 61440
  s_nop 0
  buffer_load_dwordx4 v44, s[8:11], s29 offen lds
  s_add_u32 s29, s29, 65536
  s_waitcnt lgkmcnt(6)
  v_mfma_f32_16x16x32_bf16 v[12:15], a[84:87], a[12:15], v[12:15]
  ds_read_b64_tr_b16 a[68:69], v41 offset:40960
  v_mfma_f32_16x16x32_bf16 v[8:11], a[84:87], a[8:11], v[8:11]
  ds_read_b64_tr_b16 a[70:71], v41 offset:43008
  buffer_load_dwordx4 a[48:51], v45, s[4:7], s28 offen
  s_waitcnt lgkmcnt(6)
  v_mfma_f32_16x16x32_bf16 v[16:19], a[88:91], a[8:11], v[16:19]
  ds_read_b64_tr_b16 a[72:73], v42 offset:40960
  v_mfma_f32_16x16x32_bf16 v[20:23], a[88:91], a[12:15], v[20:23]
  ds_read_b64_tr_b16 a[74:75], v42 offset:43008
  buffer_load_dwordx4 a[52:55], v46, s[4:7], s28 offen
  s_add_u32 s28, s28, 1024
  s_waitcnt lgkmcnt(6)
  v_mfma_f32_16x16x32_bf16 v[28:31], a[92:95], a[12:15], v[28:31]
  ds_read_b64_tr_b16 a[76:77], v43 offset:40960
  v_mfma_f32_16x16x32_bf16 v[24:27], a[92:95], a[8:11], v[24:27]
  ds_read_b64_tr_b16 a[78:79], v43 offset:43008
  s_waitcnt vmcnt(12) lgkmcnt(6)
  v_mfma_f32_16x16x32_bf16 v[0:3], a[64:67], a[16:19], v[0:3]
  ds_read_b64_tr_b16 a[80:81], v40 offset:45056
  v_mfma_f32_16x16x32_bf16 v[4:7], a[64:67], a[20:23], v[4:7]
  ds_read_b64_tr_b16 a[82:83], v40 offset:47104
  s_add_u32 m0, s30, 0
  s_nop 0
  buffer_load_dwordx4 v44, s[8:11], s29 offen lds
  s_add_u32 s29, s29, 65536
  s_waitcnt lgkmcnt(6)
  v_mfma_f32_16x16x32_bf16 v[12:15], a[68:71], a[20:23], v[12:15]
  ds_read_b64_tr_b16 a[84:85], v41 offset:45056
  v_mfma_f32_16x16x32_bf16 v[8:11], a[68:71], a[16:19], v[8:11]
  ds_read_b64_tr_b16 a[86:87], v41 offset:47104
  buffer_load_dwordx4 a[56:59], v45, s[4:7], s28 offen
  s_waitcnt lgkmcnt(6)
  v_mfma_f32_16x16x32_bf16 v[16:19], a[72:75], a[16:19], v[16:19]
  ds_read_b64_tr_b16 a[88:89], v42 offset:45056
  v_mfma_f32_16x16x32_bf16 v[20:23], a[72:75], a[20:23], v[20:23]
  ds_read_b64_tr_b16 a[90:91], v42 offset:47104
  buffer_load_dwordx4 a[60:63], v46, s[4:7], s28 offen
  s_add_u32 s28, s28, 1024
  s_waitcnt lgkmcnt(6)
  v_mfma_f32_16x16x32_bf16 v[28:31], a[76:79], a[20:23], v[28:31]
  ds_read_b64_tr_b16 a[92:93], v43 offset:45056
  v_mfma_f32_16x16x32_bf16 v[24:27], a[76:79], a[16:19], v[24:27]
  ds_read_b64_tr_b16 a[94:95], v43 offset:47104
  s_waitcnt vmcnt(12) lgkmcnt(6)
  v_mfma_f32_16x16x32_bf16 v[0:3], a[80:83], a[24:27], v[0:3]
  s_waitcnt vmcnt(11)
  s_barrier
  ds_read_b64_tr_b16 a[64:65], v40 offset:49152
  v_mfma_f32_16x16x32_bf16 v[4:7], a[80:83], a[28:31], v[4:7]
  ds_read_b64_tr_b16 a[66:67], v40 offset:51200
  s_add_u32 m0, s30, 4096
  s_nop 0
  buffer_load_dwordx4 v44, s[8:11], s29 offen lds
  s_add_u32 s29, s29, 65536
  s_waitcnt lgkmcnt(6)
  v_mfma_f32_16x16x32_bf16 v[12:15], a[84:87], a[28:31], v[12:15]
  ds_read_b64_tr_b16 a[68:69], v41 offset:49152
  v_mfma_f32_16x16x32_bf16 v[8:11], a[84:87], a[24:27], v[8:11]
  ds_read_b64_tr_b16 a[70:71], v41 offset:51200
  buffer_load_dwordx4 a[0:3], v45, s[4:7], s28 offen
  s_waitcnt lgkmcnt(6)
  v_mfma_f32_16x16x32_bf16 v[16:19], a[88:91], a[24:27], v[16:19]
  ds_read_b64_tr_b16 a[72:73], v42 offset:49152
  v_mfma_f32_16x16x32_bf16 v[20:23], a[88:91], a[28:31], v[20:23]
  ds_read_b64_tr_b16 a[74:75], v42 offset:51200
  buffer_load_dwordx4 a[4:7], v46, s[4:7], s28 offen
  s_add_u32 s28, s28, 1024
  s_waitcnt lgkmcnt(6)
  v_mfma_f32_16x16x32_bf16 v[28:31], a[92:95], a[28:31], v[28:31]
  ds_read_b64_tr_b16 a[76:77], v43 offset:49152
  v_mfma_f32_16x16x32_bf16 v[24:27], a[92:95], a[24:27], v[24:27]
  ds_read_b64_tr_b16 a[78:79], v43 offset:51200
  s_waitcnt vmcnt(12) lgkmcnt(6)
  v_mfma_f32_16x16x32_bf16 v[0:3], a[64:67], a[32:35], v[0:3]
  ds_read_b64_tr_b16 a[80:81], v40 offset:53248
  v_mfma_f32_16x16x32_bf16 v[4:7], a[64:67], a[36:39], v[4:7]
  ds_read_b64_tr_b16 a[82:83], v40 offset:55296
  s_add_u32 m0, s30, 8192
  s_nop 0
  buffer_load_dwordx4 v44, s[8:11], s29 offen lds
  s_add_u32 s29, s29, 65536
  s_waitcnt lgkmcnt(6)
  v_mfma_f32_16x16x32_bf16 v[12:15], a[68:71], a[36:39], v[12:15]
  ds_read_b64_tr_b16 a[84:85], v41 offset:53248
  v_mfma_f32_16x16x32_bf16 v[8:11], a[68:71], a[32:35], v[8:11]
  ds_read_b64_tr_b16 a[86:87], v41 offset:55296
  buffer_load_dwordx4 a[8:11], v45, s[4:7], s28 offen
  s_waitcnt lgkmcnt(6)
  v_mfma_f32_16x16x32_bf16 v[16:19], a[72:75], a[32:35], v[16:19]
  ds_read_b64_tr_b16 a[88:89], v42 offset:53248
  v_mfma_f32_16x16x32_bf16 v[20:23], a[72:75], a[36:39], v[20:23]
  ds_read_b64_tr_b16 a[90:91], v42 offset:55296
  buffer_load_dwordx4 a[12:15], v46, s[4:7], s28 offen
  s_add_u32 s28, s28, 1024
  s_waitcnt lgkmcnt(6)
  v_mfma_f32_16x16x32_bf16 v[28:31], a[76:79], a[36:39], v[28:31]
  ds_read_b64_tr_b16 a[92:93], v43 offset:53248
  v_mfma_f32_16x16x32_bf16 v[24:27], a[76:79], a[32:35], v[24:27]
  ds_read_b64_tr_b16 a[94:95], v43 offset:55296
  s_waitcnt vmcnt(12) lgkmcnt(6)
  v_mfma_f32_16x16x32_bf16 v[0:3], a[80:83], a[40:43], v[0:3]
  s_waitcnt vmcnt(11)
  s_barrier
  ds_read_b64_tr_b16 a[64:65], v40 offset:57344
  v_mfma_f32_16x16x32_bf16 v[4:7], a[80:83], a[44:47], v[4:7]
  ds_read_b64_tr_b16 a[66:67], v40 offset:59392
  s_add_u32 m0, s30, 12288
  s_nop 0
  buffer_load_dwordx4 v44, s[8:11], s29 offen lds
  s_add_u32 s29, s29, 65536
  s_waitcnt lgkmcnt(6)
  v_mfma_f32_16x16x32_bf16 v[12:15], a[84:87], a[44:47], v[12:15]
  ds_read_b64_tr_b16 a[68:69], v41 offset:57344
  v_mfma_f32_16x16x32_bf16 v[8:11], a[84:87], a[40:43], v[8:11]
  ds_read_b64_tr_b16 a[70:71], v41 offset:59392
  buffer_load_dwordx4 a[16:19], v45, s[4:7], s28 offen
  s_waitcnt lgkmcnt(6)
  v_mfma_f32_16x16x32_bf16 v[16:19], a[88:91], a[40:43], v[16:19]
  ds_read_b64_tr_b16 a[72:73], v42 offset:57344
  v_mfma_f32_16x16x32_bf16 v[20:23], a[88:91], a[44:47], v[20:23]
  ds_read_b64_tr_b16 a[74:75], v42 offset:59392
  buffer_load_dwordx4 a[20:23], v46, s[4:7], s28 offen
  s_add_u32 s28, s28, 1024
  s_waitcnt lgkmcnt(6)
  v_mfma_f32_16x16x32_bf16 v[28:31], a[92:95], a[44:47], v[28:31]
  ds_read_b64_tr_b16 a[76:77], v43 offset:57344
  v_mfma_f32_16x16x32_bf16 v[24:27], a[92:95], a[40:43], v[24:27]
  ds_read_b64_tr_b16 a[78:79], v43 offset:59392
  s_waitcnt vmcnt(12) lgkmcnt(6)
  v_mfma_f32_16x16x32_bf16 v[0:3], a[64:67], a[48:51], v[0:3]
  ds_read_b64_tr_b16 a[80:81], v40 offset:61440
  v_mfma_f32_16x16x32_bf16 v[4:7], a[64:67], a[52:55], v[4:7]
  ds_read_b64_tr_b16 a[82:83], v40 offset:63488
  s_add_u32 m0, s30, 16384
  s_nop 0
  buffer_load_dwordx4 v44, s[8:11], s29 offen lds
  s_add_u32 s29, s29, 65536
  s_waitcnt lgkmcnt(6)
  v_mfma_f32_16x16x32_bf16 v[12:15], a[68:71], a[52:55], v[12:15]
  ds_read_b64_tr_b16 a[84:85], v41 offset:61440
  v_mfma_f32_16x16x32_bf16 v[8:11], a[68:71], a[48:51], v[8:11]
  ds_read_b64_tr_b16 a[86:87], v41 offset:63488
  buffer_load_dwordx4 a[24:27], v45, s[4:7], s28 offen
  s_waitcnt lgkmcnt(6)
  v_mfma_f32_16x16x32_bf16 v[16:19], a[72:75], a[48:51], v[16:19]
  ds_read_b64_tr_b16 a[88:89], v42 offset:61440
  v_mfma_f32_16x16x32_bf16 v[20:23], a[72:75], a[52:55], v[20:23]
  ds_read_b64_tr_b16 a[90:91], v42 offset:63488
  buffer_load_dwordx4 a[28:31], v46, s[4:7], s28 offen
  s_add_u32 s28, s28, 1024
  s_waitcnt lgkmcnt(6)
  v_mfma_f32_16x16x32_bf16 v[28:31], a[76:79], a[52:55], v[28:31]
  ds_read_b64_tr_b16 a[92:93], v43 offset:61440
  v_mfma_f32_16x16x32_bf16 v[24:27], a[76:79], a[48:51], v[24:27]
  ds_read_b64_tr_b16 a[94:95], v43 offset:63488
  s_waitcnt vmcnt(12) lgkmcnt(6)
  v_mfma_f32_16x16x32_bf16 v[0:3], a[80:83], a[56:59], v[0:3]
  s_waitcnt vmcnt(11)
  s_barrier
  ds_read_b64_tr_b16 a[64:65], v40 offset:0
  v_mfma_f32_16x16x32_bf16 v[4:7], a[80:83], a[60:63], v[4:7]
  ds_read_b64_tr_b16 a[66:67], v40 offset:2048
  s_add_u32 m0, s30, 20480
  s_nop 0
  buffer_load_dwordx4 v44, s[8:11], s29 offen lds
  s_add_u32 s29, s29, 65536
  s_waitcnt lgkmcnt(6)
  v_mfma_f32_16x16x32_bf16 v[12:15], a[84:87], a[60:63], v[12:15]
  ds_read_b64_tr_b16 a[68:69], v41 offset:0
  v_mfma_f32_16x16x32_bf16 v[8:11], a[84:87], a[56:59], v[8:11]
  ds_read_b64_tr_b16 a[70:71], v41 offset:2048
  buffer_load_dwordx4 a[32:35], v45, s[4:7], s28 offen
  s_waitcnt lgkmcnt(6)
  v_mfma_f32_16x16x32_bf16 v[16:19], a[88:91], a[56:59], v[16:19]
  ds_read_b64_tr_b16 a[72:73], v42 offset:0
  v_mfma_f32_16x16x32_bf16 v[20:23], a[88:91], a[60:63], v[20:23]
  ds_read_b64_tr_b16 a[74:75], v42 offset:2048
  buffer_load_dwordx4 a[36:39], v46, s[4:7], s28 offen
  s_add_u32 s28, s28, 1024
  s_waitcnt lgkmcnt(6)
  v_mfma_f32_16x16x32_bf16 v[28:31], a[92:95], a[60:63], v[28:31]
  ds_read_b64_tr_b16 a[76:77], v43 offset:0
  v_mfma_f32_16x16x32_bf16 v[24:27], a[92:95], a[56:59], v[24:27]
  ds_read_b64_tr_b16 a[78:79], v43 offset:2048
  s_waitcnt vmcnt(12) lgkmcnt(6)
  v_mfma_f32_16x16x32_bf16 v[0:3], a[64:67], a[0:3], v[0:3]
  ds_read_b64_tr_b16 a[80:81], v40 offset:4096
  v_mfma_f32_16x16x32_bf16 v[4:7], a[64:67], a[4:7], v[4:7]
  ds_read_b64_tr_b16 a[82:83], v40 offset:6144
  s_add_u32 m0, s30, 24576
  s_nop 0
  buffer_load_dwordx4 v44, s[8:11], s29 offen lds
  s_add_u32 s29, s29, 65536
  s_waitcnt lgkmcnt(6)
  v_mfma_f32_16x16x32_bf16 v[12:15], a[68:71], a[4:7], v[12:15]
  ds_read_b64_tr_b16 a[84:85], v41 offset:4096
  v_mfma_f32_16x16x32_bf16 v[8:11], a[68:71], a[0:3], v[8:11]
  ds_read_b64_tr_b16 a[86:87], v41 offset:6144
  buffer_load_dwordx4 a[40:43], v45, s[4:7], s28 offen
  s_waitcnt lgkmcnt(6)
  v_mfma_f32_16x16x32_bf16 v[16:19], a[72:75], a[0:3], v[16:19]
  ds_read_b64_tr_b16 a[88:89], v42 offset:4096
  v_mfma_f32_16x16x32_bf16 v[20:23], a[72:75], a[4:7], v[20:23]
  ds_read_b64_tr_b16 a[90:91], v42 offset:6144
  buffer_load_dwordx4 a[44:47], v46, s[4:7], s28 offen
  s_add_u32 s28, s28, 1024
  s_waitcnt lgkmcnt(6)
  v_mfma_f32_16x16x32_bf16 v[28:31], a[76:79], a[4:7], v[28:31]
  ds_read_b64_tr_b16 a[92:93], v43 offset:4096
  v_mfma_f32_16x16x32_bf16 v[24:27], a[76:79], a[0:3], v[24:27]
  ds_read_b64_tr_b16 a[94:95], v43 offset:6144
  s_waitcnt vmcnt(12) lgkmcnt(6)
  v_mfma_f32_16x16x32_bf16 v[0:3], a[80:83], a[8:11], v[0:3]
  s_waitcnt vmcnt(11)
  s_barrier
  ds_read_b64_tr_b16 a[64:65], v40 offset:8192
  v_mfma_f32_16x16x32_bf16 v[4:7], a[80:83], a[12:15], v[4:7]
  ds_read_b64_tr_b16 a[66:67], v40 offset:10240
  s_add_u32 m0, s30, 28672
  s_nop 0
  buffer_load_dwordx4 v44, s[8:11], s29 offen lds
  s_add_u32 s29, s29, 65536
  s_waitcnt lgkmcnt(6)
  v_mfma_f32_16x16x32_bf16 v[12:15], a[84:87], a[12:15], v[12:15]
  ds_read_b64_tr_b16 a[68:69], v41 offset:8192
  v_mfma_f32_16x16x32_bf16 v[8:11], a[84:87], a[8:11], v[8:11]
  ds_read_b64_tr_b16 a[70:71], v41 offset:10240
  buffer_load_dwordx4 a[48:51], v45, s[4:7], s28 offen
  s_waitcnt lgkmcnt(6)
  v_mfma_f32_16x16x32_bf16 v[16:19], a[88:91], a[8:11], v[16:19]
  ds_read_b64_tr_b16 a[72:73], v42 offset:8192
  v_mfma_f32_16x16x32_bf16 v[20:23], a[88:91], a[12:15], v[20:23]
  ds_read_b64_tr_b16 a[74:75], v42 offset:10240
  buffer_load_dwordx4 a[52:55], v46, s[4:7], s28 offen
  s_add_u32 s28, s28, 1024
  s_waitcnt lgkmcnt(6)
  v_mfma_f32_16x16x32_bf16 v[28:31], a[92:95], a[12:15], v[28:31]
  ds_read_b64_tr_b16 a[76:77], v43 offset:8192
  v_mfma_f32_16x16x32_bf16 v[24:27], a[92:95], a[8:11], v[24:27]
  ds_read_b64_tr_b16 a[78:79], v43 offset:10240
  s_waitcnt vmcnt(12) lgkmcnt(6)
  v_mfma_f32_16x16x32_bf16 v[0:3], a[64:67], a[16:19], v[0:3]
  ds_read_b64_tr_b16 a[80:81], v40 offset:12288
  v_mfma_f32_16x16x32_bf16 v[4:7], a[64:67], a[20:23], v[4:7]
  ds_read_b64_tr_b16 a[82:83], v40 offset:14336
  s_add_u32 m0, s30, 32768
  s_nop 0
  buffer_load_dwordx4 v44, s[8:11], s29 offen lds
  s_add_u32 s29, s29, 65536
  s_waitcnt lgkmcnt(6)
  v_mfma_f32_16x16x32_bf16 v[12:15], a[68:71], a[20:23], v[12:15]
  ds_read_b64_tr_b16 a[84:85], v41 offset:12288
  v_mfma_f32_16x16x32_bf16 v[8:11], a[68:71], a[16:19], v[8:11]
  ds_read_b64_tr_b16 a[86:87], v41 offset:14336
  buffer_load_dwordx4 a[56:59], v45, s[4:7], s28 offen
  s_waitcnt lgkmcnt(6)
  v_mfma_f32_16x16x32_bf16 v[16:19], a[72:75], a[16:19], v[16:19]
  ds_read_b64_tr_b16 a[88:89], v42 offset:12288
  v_mfma_f32_16x16x32_bf16 v[20:23], a[72:75], a[20:23], v[20:23]
  ds_read_b64_tr_b16 a[90:91], v42 offset:14336
  buffer_load_dwordx4 a[60:63], v46, s[4:7], s28 offen
  s_add_u32 s28, s28, 1024
  s_waitcnt lgkmcnt(6)
  v_mfma_f32_16x16x32_bf16 v[28:31], a[76:79], a[20:23], v[28:31]
  ds_read_b64_tr_b16 a[92:93], v43 offset:12288
  v_mfma_f32_16x16x32_bf16 v[24:27], a[76:79], a[16:19], v[24:27]
  ds_read_b64_tr_b16 a[94:95], v43 offset:14336
  s_waitcnt vmcnt(12) lgkmcnt(6)
  v_mfma_f32_16x16x32_bf16 v[0:3], a[80:83], a[24:27], v[0:3]
  s_waitcnt vmcnt(11)
  s_barrier
  ds_read_b64_tr_b16 a[64:65], v40 offset:16384
  v_mfma_f32_16x16x32_bf16 v[4:7], a[80:83], a[28:31], v[4:7]
  ds_read_b64_tr_b16 a[66:67], v40 offset:18432
  s_add_u32 m0, s30, 36864
  s_nop 0
  buffer_load_dwordx4 v44, s[8:11], s29 offen lds
  s_add_u32 s29, s29, 65536
  s_waitcnt lgkmcnt(6)
  v_mfma_f32_16x16x32_bf16 v[12:15], a[84:87], a[28:31], v[12:15]
  ds_read_b64_tr_b16 a[68:69], v41 offset:16384
  v_mfma_f32_16x16x32_bf16 v[8:11], a[84:87], a[24:27], v[8:11]
  ds_read_b64_tr_b16 a[70:71], v41 offset:18432
  buffer_load_dwordx4 a[0:3], v45, s[4:7], s28 offen
  s_waitcnt lgkmcnt(6)
  v_mfma_f32_16x16x32_bf16 v[16:19], a[88:91], a[24:27], v[16:19]
  ds_read_b64_tr_b16 a[72:73], v42 offset:16384
  v_mfma_f32_16x16x32_bf16 v[20:23], a[88:91], a[28:31], v[20:23]
  ds_read_b64_tr_b16 a[74:75], v42 offset:18432
  buffer_load_dwordx4 a[4:7], v46, s[4:7], s28 offen
  s_add_u32 s28, s28, 1024
  s_waitcnt lgkmcnt(6)
  v_mfma_f32_16x16x32_bf16 v[28:31], a[92:95], a[28:31], v[28:31]
  ds_read_b64_tr_b16 a[76:77], v43 offset:16384
  v_mfma_f32_16x16x32_bf16 v[24:27], a[92:95], a[24:27], v[24:27]
  ds_read_b64_tr_b16 a[78:79], v43 offset:18432
  s_waitcnt vmcnt(12) lgkmcnt(6)
  v_mfma_f32_16x16x32_bf16 v[0:3], a[64:67], a[32:35], v[0:3]
  ds_read_b64_tr_b16 a[80:81], v40 offset:20480
  v_mfma_f32_16x16x32_bf16 v[4:7], a[64:67], a[36:39], v[4:7]
  ds_read_b64_tr_b16 a[82:83], v40 offset:22528
  s_add_u32 m0, s30, 40960
  s_nop 0
  buffer_load_dwordx4 v44, s[8:11], s29 offen lds
  s_add_u32 s29, s29, 65536
  s_waitcnt lgkmcnt(6)
  v_mfma_f32_16x16x32_bf16 v[12:15], a[68:71], a[36:39], v[12:15]
  ds_read_b64_tr_b16 a[84:85], v41 offset:20480
  v_mfma_f32_16x16x32_bf16 v[8:11], a[68:71], a[32:35], v[8:11]
  ds_read_b64_tr_b16 a[86:87], v41 offset:22528
  buffer_load_dwordx4 a[8:11], v45, s[4:7], s28 offen
  s_waitcnt lgkmcnt(6)
  v_mfma_f32_16x16x32_bf16 v[16:19], a[72:75], a[32:35], v[16:19]
  ds_read_b64_tr_b16 a[88:89], v42 offset:20480
  v_mfma_f32_16x16x32_bf16 v[20:23], a[72:75], a[36:39], v[20:23]
  ds_read_b64_tr_b16 a[90:91], v42 offset:22528
  buffer_load_dwordx4 a[12:15], v46, s[4:7], s28 offen
  s_add_u32 s28, s28, 1024
  s_waitcnt lgkmcnt(6)
  v_mfma_f32_16x16x32_bf16 v[28:31], a[76:79], a[36:39], v[28:31]
  ds_read_b64_tr_b16 a[92:93], v43 offset:20480
  v_mfma_f32_16x16x32_bf16 v[24:27], a[76:79], a[32:35], v[24:27]
  ds_read_b64_tr_b16 a[94:95], v43 offset:22528
  s_waitcnt vmcnt(12) lgkmcnt(6)
  v_mfma_f32_16x16x32_bf16 v[0:3], a[80:83], a[40:43], v[0:3]
  s_waitcnt vmcnt(11)
  s_barrier
  ds_read_b64_tr_b16 a[64:65], v40 offset:24576
  v_mfma_f32_16x16x32_bf16 v[4:7], a[80:83], a[44:47], v[4:7]
  ds_read_b64_tr_b16 a[66:67], v40 offset:26624
  s_add_u32 m0, s30, 45056
  s_nop 0
  buffer_load_dwordx4 v44, s[8:11], s29 offen lds
  s_add_u32 s29, s29, 65536
  s_waitcnt lgkmcnt(6)
  v_mfma_f32_16x16x32_bf16 v[12:15], a[84:87], a[44:47], v[12:15]
  ds_read_b64_tr_b16 a[68:69], v41 offset:24576
  v_mfma_f32_16x16x32_bf16 v[8:11], a[84:87], a[40:43], v[8:11]
  ds_read_b64_tr_b16 a[70:71], v41 offset:26624
  buffer_load_dwordx4 a[16:19], v45, s[4:7], s28 offen
  s_waitcnt lgkmcnt(6)
  v_mfma_f32_16x16x32_bf16 v[16:19], a[88:91], a[40:43], v[16:19]
  ds_read_b64_tr_b16 a[72:73], v42 offset:24576
  v_mfma_f32_16x16x32_bf16 v[20:23], a[88:91], a[44:47], v[20:23]
  ds_read_b64_tr_b16 a[74:75], v42 offset:26624
  buffer_load_dwordx4 a[20:23], v46, s[4:7], s28 offen
  s_add_u32 s28, s28, 1024
  s_waitcnt lgkmcnt(6)
  v_mfma_f32_16x16x32_bf16 v[28:31], a[92:95], a[44:47], v[28:31]
  ds_read_b64_tr_b16 a[76:77], v43 offset:24576
  v_mfma_f32_16x16x32_bf16 v[24:27], a[92:95], a[40:43], v[24:27]
  ds_read_b64_tr_b16 a[78:79], v43 offset:26624
  s_waitcnt vmcnt(12) lgkmcnt(6)
  v_mfma_f32_16x16x32_bf16 v[0:3], a[64:67], a[48:51], v[0:3]
  ds_read_b64_tr_b16 a[80:81], v40 offset:28672
  v_mfma_f32_16x16x32_bf16 v[4:7], a[64:67], a[52:55], v[4:7]
  ds_read_b64_tr_b16 a[82:83], v40 offset:30720
  s_add_u32 m0, s30, 49152
  s_nop 0
  buffer_load_dwordx4 v44, s[8:11], s29 offen lds
  s_add_u32 s29, s29, 65536
  s_waitcnt lgkmcnt(6)
  v_mfma_f32_16x16x32_bf16 v[12:15], a[68:71], a[52:55], v[12:15]
  ds_read_b64_tr_b16 a[84:85], v41 offset:28672
  v_mfma_f32_16x16x32_bf16 v[8:11], a[68:71], a[48:51], v[8:11]
  ds_read_b64_tr_b16 a[86:87], v41 offset:30720
  buffer_load_dwordx4 a[24:27], v45, s[4:7], s28 offen
  s_waitcnt lgkmcnt(6)
  v_mfma_f32_16x16x32_bf16 v[16:19], a[72:75], a[48:51], v[16:19]
  ds_read_b64_tr_b16 a[88:89], v42 offset:28672
  v_mfma_f32_16x16x32_bf16 v[20:23], a[72:75], a[52:55], v[20:23]
  ds_read_b64_tr_b16 a[90:91], v42 offset:30720
  buffer_load_dwordx4 a[28:31], v46, s[4:7], s28 offen
  s_add_u32 s28, s28, 1024
  s_waitcnt lgkmcnt(6)
  v_mfma_f32_16x16x32_bf16 v[28:31], a[76:79], a[52:55], v[28:31]
  ds_read_b64_tr_b16 a[92:93], v43 offset:28672
  v_mfma_f32_16x16x32_bf16 v[24:27], a[76:79], a[48:51], v[24:27]
  ds_read_b64_tr_b16 a[94:95], v43 offset:30720
  s_waitcnt vmcnt(12) lgkmcnt(6)
  v_mfma_f32_16x16x32_bf16 v[0:3], a[80:83], a[56:59], v[0:3]
  s_waitcnt vmcnt(11)
  s_barrier
  ds_read_b64_tr_b16 a[64:65], v40 offset:32768
  v_mfma_f32_16x16x32_bf16 v[4:7], a[80:83], a[60:63], v[4:7]
  ds_read_b64_tr_b16 a[66:67], v40 offset:34816
  s_add_u32 m0, s30, 53248
  s_nop 0
  buffer_load_dwordx4 v44, s[8:11], s29 offen lds
  s_add_u32 s29, s29, 65536
  s_waitcnt lgkmcnt(6)
  v_mfma_f32_16x16x32_bf16 v[12:15], a[84:87], a[60:63], v[12:15]
  ds_read_b64_tr_b16 a[68:69], v41 offset:32768
  v_mfma_f32_16x16x32_bf16 v[8:11], a[84:87], a[56:59], v[8:11]
  ds_read_b64_tr_b16 a[70:71], v41 offset:34816
  buffer_load_dwordx4 a[32:35], v45, s[4:7], s28 offen
  s_waitcnt lgkmcnt(6)
  v_mfma_f32_16x16x32_bf16 v[16:19], a[88:91], a[56:59], v[16:19]
  ds_read_b64_tr_b16 a[72:73], v42 offset:32768
  v_mfma_f32_16x16x32_bf16 v[20:23], a[88:91], a[60:63], v[20:23]
  ds_read_b64_tr_b16 a[74:75], v42 offset:34816
  buffer_load_dwordx4 a[36:39], v46, s[4:7], s28 offen
  s_add_u32 s28, s28, 1024
  s_waitcnt lgkmcnt(6)
  v_mfma_f32_16x16x32_bf16 v[28:31], a[92:95], a[60:63], v[28:31]
  ds_read_b64_tr_b16 a[76:77], v43 offset:32768
  v_mfma_f32_16x16x32_bf16 v[24:27], a[92:95], a[56:59], v[24:27]
  ds_read_b64_tr_b16 a[78:79], v43 offset:34816
  s_waitcnt vmcnt(12) lgkmcnt(6)
  v_mfma_f32_16x16x32_bf16 v[0:3], a[64:67], a[0:3], v[0:3]
  ds_read_b64_tr_b16 a[80:81], v40 offset:36864
  v_mfma_f32_16x16x32_bf16 v[4:7], a[64:67], a[4:7], v[4:7]
  ds_read_b64_tr_b16 a[82:83], v40 offset:38912
  s_add_u32 m0, s30, 57344
  s_nop 0
  buffer_load_dwordx4 v44, s[8:11], s29 offen lds
  s_add_u32 s29, s29, 65536
  s_waitcnt lgkmcnt(6)
  v_mfma_f32_16x16x32_bf16 v[12:15], a[68:71], a[4:7], v[12:15]
  ds_read_b64_tr_b16 a[84:85], v41 offset:36864
  v_mfma_f32_16x16x32_bf16 v[8:11], a[68:71], a[0:3], v[8:11]
  ds_read_b64_tr_b16 a[86:87], v41 offset:38912
  buffer_load_dwordx4 a[40:43], v45, s[4:7], s28 offen
  s_waitcnt lgkmcnt(6)
  v_mfma_f32_16x16x32_bf16 v[16:19], a[72:75], a[0:3], v[16:19]
  ds_read_b64_tr_b16 a[88:89], v42 offset:36864
  v_mfma_f32_16x16x32_bf16 v[20:23], a[72:75], a[4:7], v[20:23]
  ds_read_b64_tr_b16 a[90:91], v42 offset:38912
  buffer_load_dwordx4 a[44:47], v46, s[4:7], s28 offen
  s_add_u32 s28, s28, 1024
  s_waitcnt lgkmcnt(6)
  v_mfma_f32_16x16x32_bf16 v[28:31], a[76:79], a[4:7], v[28:31]
  ds_read_b64_tr_b16 a[92:93], v43 offset:36864
  v_mfma_f32_16x16x32_bf16 v[24:27], a[76:79], a[0:3], v[24:27]
  ds_read_b64_tr_b16 a[94:95], v43 offset:38912
  s_waitcnt vmcnt(12) lgkmcnt(6)
  v_mfma_f32_16x16x32_bf16 v[0:3], a[80:83], a[8:11], v[0:3]
  s_waitcnt vmcnt(11)
  s_barrier
  ds_read_b64_tr_b16 a[64:65], v40 offset:40960
  v_mfma_f32_16x16x32_bf16 v[4:7], a[80:83], a[12:15], v[4:7]
  ds_read_b64_tr_b16 a[66:67], v40 offset:43008
  s_add_u32 m0, s30, 61440
  s_nop 0
  buffer_load_dwordx4 v44, s[8:11], s29 offen lds
  s_add_u32 s29, s29, 65536
  s_waitcnt lgkmcnt(6)
  v_mfma_f32_16x16x32_bf16 v[12:15], a[84:87], a[12:15], v[12:15]
  ds_read_b64_tr_b16 a[68:69], v41 offset:40960
  v_mfma_f32_16x16x32_bf16 v[8:11], a[84:87], a[8:11], v[8:11]
  ds_read_b64_tr_b16 a[70:71], v41 offset:43008
  buffer_load_dwordx4 a[48:51], v45, s[4:7], s28 offen
  s_waitcnt lgkmcnt(6)
  v_mfma_f32_16x16x32_bf16 v[16:19], a[88:91], a[8:11], v[16:19]
  ds_read_b64_tr_b16 a[72:73], v42 offset:40960
  v_mfma_f32_16x16x32_bf16 v[20:23], a[88:91], a[12:15], v[20:23]
  ds_read_b64_tr_b16 a[74:75], v42 offset:43008
  buffer_load_dwordx4 a[52:55], v46, s[4:7], s28 offen
  s_add_u32 s28, s28, 1024
  s_waitcnt lgkmcnt(6)
  v_mfma_f32_16x16x32_bf16 v[28:31], a[92:95], a[12:15], v[28:31]
  ds_read_b64_tr_b16 a[76:77], v43 offset:40960
  v_mfma_f32_16x16x32_bf16 v[24:27], a[92:95], a[8:11], v[24:27]
  ds_read_b64_tr_b16 a[78:79], v43 offset:43008
  s_waitcnt vmcnt(12) lgkmcnt(6)
  v_mfma_f32_16x16x32_bf16 v[0:3], a[64:67], a[16:19], v[0:3]
  ds_read_b64_tr_b16 a[80:81], v40 offset:45056
  v_mfma_f32_16x16x32_bf16 v[4:7], a[64:67], a[20:23], v[4:7]
  ds_read_b64_tr_b16 a[82:83], v40 offset:47104
  s_waitcnt lgkmcnt(6)
  v_mfma_f32_16x16x32_bf16 v[12:15], a[68:71], a[20:23], v[12:15]
  ds_read_b64_tr_b16 a[84:85], v41 offset:45056
  v_mfma_f32_16x16x32_bf16 v[8:11], a[68:71], a[16:19], v[8:11]
  ds_read_b64_tr_b16 a[86:87], v41 offset:47104
  buffer_load_dwordx4 a[56:59], v45, s[4:7], s28 offen
  s_waitcnt lgkmcnt(6)
  v_mfma_f32_16x16x32_bf16 v[16:19], a[72:75], a[16:19], v[16:19]
  ds_read_b64_tr_b16 a[88:89], v42 offset:45056
  v_mfma_f32_16x16x32_bf16 v[20:23], a[72:75], a[20:23], v[20:23]
  ds_read_b64_tr_b16 a[90:91], v42 offset:47104
  buffer_load_dwordx4 a[60:63], v46, s[4:7], s28 offen
  s_add_u32 s28, s28, 1024
  s_waitcnt lgkmcnt(6)
  v_mfma_f32_16x16x32_bf16 v[28:31], a[76:79], a[20:23], v[28:31]
  ds_read_b64_tr_b16 a[92:93], v43 offset:45056
  v_mfma_f32_16x16x32_bf16 v[24:27], a[76:79], a[16:19], v[24:27]
  ds_read_b64_tr_b16 a[94:95], v43 offset:47104
  s_waitcnt vmcnt(11) lgkmcnt(6)
  v_mfma_f32_16x16x32_bf16 v[0:3], a[80:83], a[24:27], v[0:3]
  s_waitcnt vmcnt(10)
  s_barrier
  ds_read_b64_tr_b16 a[64:65], v40 offset:49152
  v_mfma_f32_16x16x32_bf16 v[4:7], a[80:83], a[28:31], v[4:7]
  ds_read_b64_tr_b16 a[66:67], v40 offset:51200
  s_waitcnt lgkmcnt(6)
  v_mfma_f32_16x16x32_bf16 v[12:15], a[84:87], a[28:31], v[12:15]
  ds_read_b64_tr_b16 a[68:69], v41 offset:49152
  v_mfma_f32_16x16x32_bf16 v[8:11], a[84:87], a[24:27], v[8:11]
  ds_read_b64_tr_b16 a[70:71], v41 offset:51200
  s_waitcnt lgkmcnt(6)
  v_mfma_f32_16x16x32_bf16 v[16:19], a[88:91], a[24:27], v[16:19]
  ds_read_b64_tr_b16 a[72:73], v42 offset:49152
  v_mfma_f32_16x16x32_bf16 v[20:23], a[88:91], a[28:31], v[20:23]
  ds_read_b64_tr_b16 a[74:75], v42 offset:51200
  s_waitcnt lgkmcnt(6)
  v_mfma_f32_16x16x32_bf16 v[28:31], a[92:95], a[28:31], v[28:31]
  ds_read_b64_tr_b16 a[76:77], v43 offset:49152
  v_mfma_f32_16x16x32_bf16 v[24:27], a[92:95], a[24:27], v[24:27]
  ds_read_b64_tr_b16 a[78:79], v43 offset:51200
  s_waitcnt vmcnt(8) lgkmcnt(6)
  v_mfma_f32_16x16x32_bf16 v[0:3], a[64:67], a[32:35], v[0:3]
  ds_read_b64_tr_b16 a[80:81], v40 offset:53248
  v_mfma_f32_16x16x32_bf16 v[4:7], a[64:67], a[36:39], v[4:7]
  ds_read_b64_tr_b16 a[82:83], v40 offset:55296
  s_waitcnt lgkmcnt(6)
  v_mfma_f32_16x16x32_bf16 v[12:15], a[68:71], a[36:39], v[12:15]
  ds_read_b64_tr_b16 a[84:85], v41 offset:53248
  v_mfma_f32_16x16x32_bf16 v[8:11], a[68:71], a[32:35], v[8:11]
  ds_read_b64_tr_b16 a[86:87], v41 offset:55296
  s_waitcnt lgkmcnt(6)
  v_mfma_f32_16x16x32_bf16 v[16:19], a[72:75], a[32:35], v[16:19]
  ds_read_b64_tr_b16 a[88:89], v42 offset:53248
  v_mfma_f32_16x16x32_bf16 v[20:23], a[72:75], a[36:39], v[20:23]
  ds_read_b64_tr_b16 a[90:91], v42 offset:55296
  s_waitcnt lgkmcnt(6)
  v_mfma_f32_16x16x32_bf16 v[28:31], a[76:79], a[36:39], v[28:31]
  ds_read_b64_tr_b16 a[92:93], v43 offset:53248
  v_mfma_f32_16x16x32_bf16 v[24:27], a[76:79], a[32:35], v[24:27]
  ds_read_b64_tr_b16 a[94:95], v43 offset:55296
  s_waitcnt vmcnt(5) lgkmcnt(6)
  v_mfma_f32_16x16x32_bf16 v[0:3], a[80:83], a[40:43], v[0:3]
  s_waitcnt vmcnt(4)
  s_barrier
  ds_read_b64_tr_b16 a[64:65], v40 offset:57344
  v_mfma_f32_16x16x32_bf16 v[4:7], a[80:83], a[44:47], v[4:7]
  ds_read_b64_tr_b16 a[66:67], v40 offset:59392
  s_waitcnt lgkmcnt(6)
  v_mfma_f32_16x16x32_bf16 v[12:15], a[84:87], a[44:47], v[12:15]
  ds_read_b64_tr_b16 a[68:69], v41 offset:57344
  v_mfma_f32_16x16x32_bf16 v[8:11], a[84:87], a[40:43], v[8:11]
  ds_read_b64_tr_b16 a[70:71], v41 offset:59392
  s_waitcnt lgkmcnt(6)
  v_mfma_f32_16x16x32_bf16 v[16:19], a[88:91], a[40:43], v[16:19]
  ds_read_b64_tr_b16 a[72:73], v42 offset:57344
  v_mfma_f32_16x16x32_bf16 v[20:23], a[88:91], a[44:47], v[20:23]
  ds_read_b64_tr_b16 a[74:75], v42 offset:59392
  s_waitcnt lgkmcnt(6)
  v_mfma_f32_16x16x32_bf16 v[28:31], a[92:95], a[44:47], v[28:31]
  ds_read_b64_tr_b16 a[76:77], v43 offset:57344
  v_mfma_f32_16x16x32_bf16 v[24:27], a[92:95], a[40:43], v[24:27]
  ds_read_b64_tr_b16 a[78:79], v43 offset:59392
  s_waitcnt vmcnt(2) lgkmcnt(6)
  v_mfma_f32_16x16x32_bf16 v[0:3], a[64:67], a[48:51], v[0:3]
  ds_read_b64_tr_b16 a[80:81], v40 offset:61440
  v_mfma_f32_16x16x32_bf16 v[4:7], a[64:67], a[52:55], v[4:7]
  ds_read_b64_tr_b16 a[82:83], v40 offset:63488
  s_waitcnt lgkmcnt(6)
  v_mfma_f32_16x16x32_bf16 v[12:15], a[68:71], a[52:55], v[12:15]
  ds_read_b64_tr_b16 a[84:85], v41 offset:61440
  v_mfma_f32_16x16x32_bf16 v[8:11], a[68:71], a[48:51], v[8:11]
  ds_read_b64_tr_b16 a[86:87], v41 offset:63488
  s_waitcnt lgkmcnt(6)
  v_mfma_f32_16x16x32_bf16 v[16:19], a[72:75], a[48:51], v[16:19]
  ds_read_b64_tr_b16 a[88:89], v42 offset:61440
  v_mfma_f32_16x16x32_bf16 v[20:23], a[72:75], a[52:55], v[20:23]
  ds_read_b64_tr_b16 a[90:91], v42 offset:63488
  s_waitcnt lgkmcnt(6)
  v_mfma_f32_16x16x32_bf16 v[28:31], a[76:79], a[52:55], v[28:31]
  ds_read_b64_tr_b16 a[92:93], v43 offset:61440
  v_mfma_f32_16x16x32_bf16 v[24:27], a[76:79], a[48:51], v[24:27]
  ds_read_b64_tr_b16 a[94:95], v43 offset:63488
  s_waitcnt vmcnt(0) lgkmcnt(6)
  v_mfma_f32_16x16x32_bf16 v[0:3], a[80:83], a[56:59], v[0:3]
  v_mfma_f32_16x16x32_bf16 v[4:7], a[80:83], a[60:63], v[4:7]
  s_waitcnt lgkmcnt(4)
  v_mfma_f32_16x16x32_bf16 v[12:15], a[84:87], a[60:63], v[12:15]
  v_mfma_f32_16x16x32_bf16 v[8:11], a[84:87], a[56:59], v[8:11]
  s_waitcnt lgkmcnt(2)
  v_mfma_f32_16x16x32_bf16 v[16:19], a[88:91], a[56:59], v[16:19]
  v_mfma_f32_16x16x32_bf16 v[20:23], a[88:91], a[60:63], v[20:23]
  s_waitcnt lgkmcnt(0)
  v_mfma_f32_16x16x32_bf16 v[28:31], a[92:95], a[60:63], v[28:31]
  v_mfma_f32_16x16x32_bf16 v[24:27], a[92:95], a[56:59], v[24:27]
  s_add_u32 s46, s45, s41
  s_add_u32 s49, s46, 32768
  s_lshl_b32 s50, s44, 11
  s_lshl_b32 s43, s26, 7
  s_add_u32 s50, s50, s43
  s_add_u32 s50, s50, s47
  s_nop 1
  v_cvt_pk_bf16_f32 v48, v0, v1
  v_cvt_pk_bf16_f32 v49, v2, v3
  v_cvt_pk_bf16_f32 v50, v8, v9
  v_cvt_pk_bf16_f32 v51, v10, v11
  buffer_store_dwordx4 v[48:51], v45, s[4:7], s46 offen offset:0
  v_cvt_pk_bf16_f32 v56, v4, v5
  v_cvt_pk_bf16_f32 v57, v6, v7
  v_cvt_pk_bf16_f32 v58, v12, v13
  v_cvt_pk_bf16_f32 v59, v14, v15
  buffer_store_dwordx4 v[56:59], v45, s[4:7], s49 offen offset:0
  v_cvt_pk_bf16_f32 v52, v16, v17
  v_cvt_pk_bf16_f32 v53, v18, v19
  v_cvt_pk_bf16_f32 v54, v24, v25
  v_cvt_pk_bf16_f32 v55, v26, v27
  buffer_store_dwordx4 v[52:55], v45, s[4:7], s46 offen offset:1024
  v_cvt_pk_bf16_f32 v60, v20, v21
  v_cvt_pk_bf16_f32 v61, v22, v23
  v_cvt_pk_bf16_f32 v62, v28, v29
  v_cvt_pk_bf16_f32 v63, v30, v31
  buffer_store_dwordx4 v[60:63], v45, s[4:7], s49 offen offset:1024
  v_mov_b32 v64, 0x3f803f80
  v_mov_b32 v65, 0x3f803f80
  v_mov_b32 v66, 0x3f803f80
  v_mov_b32 v67, 0x3f803f80
  v_and_b32 v84, 15, v47
  v_lshrrev_b32 v85, 4, v47
  v_mfma_f32_16x16x32_bf16 v[68:71], v[64:67], v[48:51], 0
  v_mfma_f32_16x16x32_bf16 v[72:75], v[48:51], v[48:51], 0
  v_mfma_f32_16x16x32_bf16 v[76:79], v[64:67], v[56:59], 0
  v_mfma_f32_16x16x32_bf16 v[80:83], v[56:59], v[56:59], 0
  v_mfma_f32_16x16x32_bf16 v[68:71], v[64:67], v[52:55], v[68:71]
  v_mfma_f32_16x16x32_bf16 v[72:75], v[52:55], v[52:55], v[72:75]
  v_mfma_f32_16x16x32_bf16 v[76:79], v[64:67], v[60:63], v[76:79]
  v_mfma_f32_16x16x32_bf16 v[80:83], v[60:63], v[60:63], v[80:83]
  v_lshrrev_b32 v64, 2, v84
  v_cmp_eq_u32 s[60:61], v64, v85
  v_and_b32 v64, 3, v84
  v_cmp_eq_u32 s[62:63], 1, v64
  v_cmp_eq_u32 s[64:65], 2, v64
  v_cmp_eq_u32 s[66:67], 3, v64
  v_lshlrev_b32 v84, 3, v84
  v_mov_b32 v85, 0x7ffffff0
  s_nop 0
  v_cndmask_b32 v84, v85, v84, s[60:61]
  v_cndmask_b32 v69, v72, v73, s[62:63]
  v_cndmask_b32 v69, v69, v74, s[64:65]
  v_cndmask_b32 v69, v69, v75, s[66:67]
  buffer_store_dwordx2 v[68:69], v84, s[4:7], s50 offen offset:0
  v_cndmask_b32 v77, v80, v81, s[62:63]
  v_cndmask_b32 v77, v77, v82, s[64:65]
  v_cndmask_b32 v77, v77, v83, s[66:67]
  buffer_store_dwordx2 v[76:77], v84, s[4:7], s50 offen offset:2048
  s_endpgm
.globl gu1_kernel
.p2align 8
.type gu1_kernel,@function
gu1_kernel:
  s_mov_b32 s40, 0x400000
  s_mov_b32 s41, 0x2240000
  s_cmp_lt_u32 s2, 256
  s_cbranch_scc1 gu_body
  s_endpgm
.globl gu2_kernel
.p2align 8
.type gu2_kernel,@function
gu2_kernel:
  s_mov_b32 s40, 0xc00000
  s_mov_b32 s41, 0x22c0000
  s_cmp_lt_u32 s2, 256
  s_cbranch_scc1 gu_body
  s_endpgm
.p2align 6
gu_body:
  s_load_dwordx2 s[32:33], s[0:1], 72
  s_load_dwordx4 s[36:39], s[0:1], 32
  v_lshrrev_b32 v1, 6, v0
  v_and_b32 v239, 63, v0
  v_readfirstlane_b32 s24, v1
  s_and_b32 s34, s2, 7
  s_lshr_b32 s35, s2, 3
  s_and_b32 s25, s34, 1
  s_lshl_b32 s25, s25, 2
  s_and_b32 s43, s35, 3
  s_add_u32 s25, s25, s43
  s_lshr_b32 s26, s34, 1
  s_lshl_b32 s26, s26, 3
  s_lshr_b32 s43, s35, 2
  s_add_u32 s26, s26, s43
  s_and_b32 s27, s26, 1
  v_lshrrev_b32 v2, 4, v239
  v_bfe_u32 v3, v239, 1, 3
  v_and_b32 v4, 1, v239
  v_lshlrev_b32 v4, 4, v4
  s_mov_b32 s43, 7168
  v_mul_u32_u24 v5, s43, v2
  v_add_u32 v5, v5, v4
  v_add_u32 v6, 0, v2
  v_xor_b32 v6, v6, v3
  v_lshl_add_u32 v6, v6, 5, v5
  v_add_u32 v231, 0, v6
  v_add_u32 v6, 4, v2
  v_xor_b32 v6, v6, v3
  v_lshl_add_u32 v6, v6, 5, v5
  v_add_u32 v232, 27648, v6
  v_add_u32 v6, 0, v2
  v_xor_b32 v6, v6, v3
  v_lshl_add_u32 v6, v6, 5, v5
  v_add_u32 v233, 55296, v6
  v_add_u32 v6, 4, v2
  v_xor_b32 v6, v6, v3
  v_lshl_add_u32 v6, v6, 5, v5
  v_add_u32 v234, 82944, v6
  v_lshlrev_b32 v6, 4, v239
  v_add_u32 v235, 0, v6
  v_lshlrev_b32 v6, 4, v239
  v_add_u32 v236, 32768, v6
  v_lshlrev_b32 v6, 4, v239
  v_add_u32 v237, 65536, v6
  v_lshlrev_b32 v6, 4, v239
  v_add_u32 v238, 98304, v6
  s_lshl_b32 s28, s25, 2
  s_add_u32 s28, s28, s24
  s_mov_b32 s44, s28
  s_lshl_b32 s28, s28, 17
  s_add_u32 s28, s28, s40
  s_mul_i32 s29, s26, 224
  s_and_b32 s29, s29, 0xffffffc0
  s_mul_i32 s43, s24, 114688
  s_add_u32 s29, s29, s43
  s_lshl_b32 s30, s24, 12
  s_waitcnt lgkmcnt(0)
  s_mov_b32 s4, s32
  s_mov_b32 s5, s33
  s_mov_b32 s6, 0x10000000
  s_mov_b32 s7, 0x20000
  s_mov_b32 s8, s36
  s_mov_b32 s9, s37
  s_mov_b32 s10, 0x700000
  s_mov_b32 s11, 0x20000
  s_mov_b32 s12, s38
  s_mov_b32 s13, s39
  s_mov_b32 s14, 0x700000
  s_mov_b32 s15, 0x20000
  s_add_u32 m0, s30, 0
  s_nop 0
  buffer_load_dwordx4 v231, s[8:11], s29 offen offset:0 lds
  buffer_load_dwordx4 v232, s[8:11], s29 offen offset:1024 lds
  buffer_load_dwordx4 v233, s[8:11], s29 offen offset:2048 lds
  buffer_load_dwordx4 v234, s[8:11], s29 offen offset:3072 lds
  s_add_u32 m0, s30, 16384
  s_nop 0
  buffer_load_dwordx4 v231, s[12:15], s29 offen offset:0 lds
  buffer_load_dwordx4 a[0:3], v235, s[4:7], s28 offen offset:0
  buffer_load_dwordx4 v232, s[12:15], s29 offen offset:1024 lds
  buffer_load_dwordx4 a[4:7], v236, s[4:7], s28 offen offset:0
  buffer_load_dwordx4 v233, s[12:15], s29 offen offset:2048 lds
  buffer_load_dwordx4 a[8:11], v237, s[4:7], s28 offen offset:0
  buffer_load_dwordx4 v234, s[12:15], s29 offen offset:3072 lds
  s_add_u32 s29, s29, 458752
  buffer_load_dwordx4 a[12:15], v238, s[4:7], s28 offen offset:0
  s_add_u32 m0, s30, 32768
  s_nop 0
  buffer_load_dwordx4 v231, s[8:11], s29 offen offset:0 lds
  buffer_load_dwordx4 a[16:19], v235, s[4:7], s28 offen offset:1024
  buffer_load_dwordx4 v232, s[8:11], s29 offen offset:1024 lds
  buffer_load_dwordx4 a[20:23], v236, s[4:7], s28 offen offset:1024
  buffer_load_dwordx4 v233, s[8:11], s29 offen offset:2048 lds
  buffer_load_dwordx4 a[24:27], v237, s[4:7], s28 offen offset:1024
  buffer_load_dwordx4 v234, s[8:11], s29 offen offset:3072 lds
  buffer_load_dwordx4 a[28:31], v238, s[4:7], s28 offen offset:1024
  s_add_u32 m0, s30, 49152
  s_nop 0
  buffer_load_dwordx4 v231, s[12:15], s29 offen offset:0 lds
  buffer_load_dwordx4 a[32:35], v235, s[4:7], s28 offen offset:2048
  buffer_load_dwordx4 v232, s[12:15], s29 offen offset:1024 lds
  buffer_load_dwordx4 a[36:39], v236, s[4:7], s28 offen offset:2048
  buffer_load_dwordx4 v233, s[12:15], s29 offen offset:2048 lds
  buffer_load_dwordx4 a[40:43], v237, s[4:7], s28 offen offset:2048
  buffer_load_dwordx4 v234, s[12:15], s29 offen offset:3072 lds
  s_add_u32 s29, s29, 458752
  s_xor_b32 s30, s30, 0x10000
  buffer_load_dwordx4 a[44:47], v238, s[4:7], s28 offen offset:2048
  v_lshrrev_b32 v2, 2, v239
  v_and_b32 v3, 7, v2
  v_and_b32 v4, 3, v239
  v_lshlrev_b32 v4, 3, v4
  v_lshl_add_u32 v4, v2, 8, v4
  s_lshl_b32 s43, s27, 1
  s_cmp_eq_u32 s27, 0
  s_cselect_b32 s45, 6, 1
  s_add_u32 s46, s43, 0
  v_xor_b32 v5, s46, v3
  v_lshl_add_u32 v224, v5, 5, v4
  s_add_u32 s46, s43, 1
  v_xor_b32 v5, s46, v3
  v_lshl_add_u32 v225, v5, 5, v4
  s_add_u32 s46, s43, 2
  v_xor_b32 v5, s46, v3
  v_lshl_add_u32 v226, v5, 5, v4
  s_add_u32 s46, s43, 3
  v_xor_b32 v5, s46, v3
  v_lshl_add_u32 v227, v5, 5, v4
  s_add_u32 s46, s43, 4
  v_xor_b32 v5, s46, v3
  v_lshl_add_u32 v228, v5, 5, v4
  s_add_u32 s46, s43, 5
  v_xor_b32 v5, s46, v3
  v_lshl_add_u32 v229, v5, 5, v4
  v_xor_b32 v5, s45, v3
  v_lshl_add_u32 v230, v5, 5, v4
  v_mov_b32 v0, 0
  v_mov_b32 v1, 0
  v_mov_b32 v2, 0
  v_mov_b32 v3, 0
  v_mov_b32 v4, 0
  v_mov_b32 v5, 0
  v_mov_b32 v6, 0
  v_mov_b32 v7, 0
  v_mov_b32 v8, 0
  v_mov_b32 v9, 0
  v_mov_b32 v10, 0
  v_mov_b32 v11, 0
  v_mov_b32 v12, 0
  v_mov_b32 v13, 0
  v_mov_b32 v14, 0
  v_mov_b32 v15, 0
  v_mov_b32 v16, 0
  v_mov_b32 v17, 0
  v_mov_b32 v18, 0
  v_mov_b32 v19, 0
  v_mov_b32 v20, 0
  v_mov_b32 v21, 0
  v_mov_b32 v22, 0
  v_mov_b32 v23, 0
  v_mov_b32 v24, 0
  v_mov_b32 v25, 0
  v_mov_b32 v26, 0
  v_mov_b32 v27, 0
  v_mov_b32 v28, 0
  v_mov_b32 v29, 0
  v_mov_b32 v30, 0
  v_mov_b32 v31, 0
  v_mov_b32 v32, 0
  v_mov_b32 v33, 0
  v_mov_b32 v34, 0
  v_mov_b32 v35, 0
  v_mov_b32 v36, 0
  v_mov_b32 v37, 0
  v_mov_b32 v38, 0
  v_mov_b32 v39, 0
  v_mov_b32 v40, 0
  v_mov_b32 v41, 0
  v_mov_b32 v42, 0
  v_mov_b32 v43, 0
  v_mov_b32 v44, 0
  v_mov_b32 v45, 0
  v_mov_b32 v46, 0
  v_mov_b32 v47, 0
  v_mov_b32 v48, 0
  v_mov_b32 v49, 0
  v_mov_b32 v50, 0
  v_mov_b32 v51, 0
  v_mov_b32 v52, 0
  v_mov_b32 v53, 0
  v_mov_b32 v54, 0
  v_mov_b32 v55, 0
  v_mov_b32 v56, 0
  v_mov_b32 v57, 0
  v_mov_b32 v58, 0
  v_mov_b32 v59, 0
  v_mov_b32 v60, 0
  v_mov_b32 v61, 0
  v_mov_b32 v62, 0
  v_mov_b32 v63, 0
  v_mov_b32 v64, 0
  v_mov_b32 v65, 0
  v_mov_b32 v66, 0
  v_mov_b32 v67, 0
  v_mov_b32 v68, 0
  v_mov_b32 v69, 0
  v_mov_b32 v70, 0
  v_mov_b32 v71, 0
  v_mov_b32 v72, 0
  v_mov_b32 v73, 0
  v_mov_b32 v74, 0
  v_mov_b32 v75, 0
  v_mov_b32 v76, 0
  v_mov_b32 v77, 0
  v_mov_b32 v78, 0
  v_mov_b32 v79, 0
  v_mov_b32 v80, 0
  v_mov_b32 v81, 0
  v_mov_b32 v82, 0
  v_mov_b32 v83, 0
  v_mov_b32 v84, 0
  v_mov_b32 v85, 0
  v_mov_b32 v86, 0
  v_mov_b32 v87, 0
  v_mov_b32 v88, 0
  v_mov_b32 v89, 0
  v_mov_b32 v90, 0
  v_mov_b32 v91, 0
  v_mov_b32 v92, 0
  v_mov_b32 v93, 0
  v_mov_b32 v94, 0
  v_mov_b32 v95, 0
  v_mov_b32 v96, 0
  v_mov_b32 v97, 0
  v_mov_b32 v98, 0
  v_mov_b32 v99, 0
  v_mov_b32 v100, 0
  v_mov_b32 v101, 0
  v_mov_b32 v102, 0
  v_mov_b32 v103, 0
  v_mov_b32 v104, 0
  v_mov_b32 v105, 0
  v_mov_b32 v106, 0
  v_mov_b32 v107, 0
  v_mov_b32 v108, 0
  v_mov_b32 v109, 0
  v_mov_b32 v110, 0
  v_mov_b32 v111, 0
  v_mov_b32 v112, 0
  v_mov_b32 v113, 0
  v_mov_b32 v114, 0
  v_mov_b32 v115, 0
  v_mov_b32 v116, 0
  v_mov_b32 v117, 0
  v_mov_b32 v118, 0
  v_mov_b32 v119, 0
  v_mov_b32 v120, 0
  v_mov_b32 v121, 0
  v_mov_b32 v122, 0
  v_mov_b32 v123, 0
  v_mov_b32 v124, 0
  v_mov_b32 v125, 0
  v_mov_b32 v126, 0
  v_mov_b32 v127, 0
  v_mov_b32 v128, 0
  v_mov_b32 v129, 0
  v_mov_b32 v130, 0
  v_mov_b32 v131, 0
  v_mov_b32 v132, 0
  v_mov_b32 v133, 0
  v_mov_b32 v134, 0
  v_mov_b32 v135, 0
  v_mov_b32 v136, 0
  v_mov_b32 v137, 0
  v_mov_b32 v138, 0
  v_mov_b32 v139, 0
  v_mov_b32 v140, 0
  v_mov_b32 v141, 0
  v_mov_b32 v142, 0
  v_mov_b32 v143, 0
  v_mov_b32 v144, 0
  v_mov_b32 v145, 0
  v_mov_b32 v146, 0
  v_mov_b32 v147, 0
  v_mov_b32 v148, 0
  v_mov_b32 v149, 0
  v_mov_b32 v150, 0
  v_mov_b32 v151, 0
  v_mov_b32 v152, 0
  v_mov_b32 v153, 0
  v_mov_b32 v154, 0
  v_mov_b32 v155, 0
  v_mov_b32 v156, 0
  v_mov_b32 v157, 0
  v_mov_b32 v158, 0
  v_mov_b32 v159, 0
  v_mov_b32 v160, 0
  v_mov_b32 v161, 0
  v_mov_b32 v162, 0
  v_mov_b32 v163, 0
  v_mov_b32 v164, 0
  v_mov_b32 v165, 0
  v_mov_b32 v166, 0
  v_mov_b32 v167, 0
  v_mov_b32 v168, 0
  v_mov_b32 v169, 0
  v_mov_b32 v170, 0
  v_mov_b32 v171, 0
  v_mov_b32 v172, 0
  v_mov_b32 v173, 0
  v_mov_b32 v174, 0
  v_mov_b32 v175, 0
  v_mov_b32 v176, 0
  v_mov_b32 v177, 0
  v_mov_b32 v178, 0
  v_mov_b32 v179, 0
  v_mov_b32 v180, 0
  v_mov_b32 v181, 0
  v_mov_b32 v182, 0
  v_mov_b32 v183, 0
  v_mov_b32 v184, 0
  v_mov_b32 v185, 0
  v_mov_b32 v186, 0
  v_mov_b32 v187, 0
  v_mov_b32 v188, 0
  v_mov_b32 v189, 0
  v_mov_b32 v190, 0
  v_mov_b32 v191, 0
  v_mov_b32 v192, 0
  v_mov_b32 v193, 0
  v_mov_b32 v194, 0
  v_mov_b32 v195, 0
  v_mov_b32 v196, 0
  v_mov_b32 v197, 0
  v_mov_b32 v198, 0
  v_mov_b32 v199, 0
  v_mov_b32 v200, 0
  v_mov_b32 v201, 0
  v_mov_b32 v202, 0
  v_mov_b32 v203, 0
  v_mov_b32 v204, 0
  v_mov_b32 v205, 0
  v_mov_b32 v206, 0
  v_mov_b32 v207, 0
  v_mov_b32 v208, 0
  v_mov_b32 v209, 0
  v_mov_b32 v210, 0
  v_mov_b32 v211, 0
  v_mov_b32 v212, 0
  v_mov_b32 v213, 0
  v_mov_b32 v214, 0
  v_mov_b32 v215, 0
  v_mov_b32 v216, 0
  v_mov_b32 v217, 0
  v_mov_b32 v218, 0
  v_mov_b32 v219, 0
  v_mov_b32 v220, 0
  v_mov_b32 v221, 0
  v_mov_b32 v222, 0
  v_mov_b32 v223, 0
  s_waitcnt vmcnt(17)
  s_barrier
  ds_read_b64_tr_b16 a[64:65], v224 offset:0
  ds_read_b64_tr_b16 a[66:67], v224 offset:4096
  ds_read_b64_tr_b16 a[68:69], v224 offset:16384
  ds_read_b64_tr_b16 a[70:71], v224 offset:20480
  ds_read_b64_tr_b16 a[72:73], v225 offset:0
  ds_read_b64_tr_b16 a[74:75], v225 offset:4096
  s_mov_b32 s31, 7
.p2align 3
Lgu_body_loop:
  s_waitcnt vmcnt(16) lgkmcnt(4)
  v_mfma_f32_16x16x32_bf16 v[0:3], a[64:67], a[0:3], v[0:3]
  ds_read_b64_tr_b16 a[76:77], v225 offset:16384
  v_mfma_f32_16x16x32_bf16 v[4:7], a[64:67], a[4:7], v[4:7]
  ds_read_b64_tr_b16 a[78:79], v225 offset:20480
  v_mfma_f32_16x16x32_bf16 v[8:11], a[64:67], a[8:11], v[8:11]
  v_mfma_f32_16x16x32_bf16 v[12:15], a[64:67], a[12:15], v[12:15]
  s_waitcnt lgkmcnt(4)
  v_mfma_f32_16x16x32_bf16 v[16:19], a[68:71], a[0:3], v[16:19]
  ds_read_b64_tr_b16 a[64:65], v226 offset:0
  v_mfma_f32_16x16x32_bf16 v[20:23], a[68:71], a[4:7], v[20:23]
  ds_read_b64_tr_b16 a[66:67], v226 offset:4096
  v_mfma_f32_16x16x32_bf16 v[24:27], a[68:71], a[8:11], v[24:27]
  s_add_u32 m0, s30, 0
  s_nop 0
  buffer_load_dwordx4 v231, s[8:11], s29 offen offset:0 lds
  v_mfma_f32_16x16x32_bf16 v[28:31], a[68:71], a[12:15], v[28:31]
  s_waitcnt lgkmcnt(4)
  v_mfma_f32_16x16x32_bf16 v[32:35], a[72:75], a[0:3], v[32:35]
  ds_read_b64_tr_b16 a[68:69], v226 offset:16384
  v_mfma_f32_16x16x32_bf16 v[36:39], a[72:75], a[4:7], v[36:39]
  ds_read_b64_tr_b16 a[70:71], v226 offset:20480
  v_mfma_f32_16x16x32_bf16 v[40:43], a[72:75], a[8:11], v[40:43]
  buffer_load_dwordx4 a[48:51], v235, s[4:7], s28 offen offset:3072
  v_mfma_f32_16x16x32_bf16 v[44:47], a[72:75], a[12:15], v[44:47]
  s_waitcnt lgkmcnt(4)
  v_mfma_f32_16x16x32_bf16 v[48:51], a[76:79], a[0:3], v[48:51]
  ds_read_b64_tr_b16 a[72:73], v227 offset:0
  v_mfma_f32_16x16x32_bf16 v[52:55], a[76:79], a[4:7], v[52:55]
  ds_read_b64_tr_b16 a[74:75], v227 offset:4096
  v_mfma_f32_16x16x32_bf16 v[56:59], a[76:79], a[8:11], v[56:59]
  v_mfma_f32_16x16x32_bf16 v[60:63], a[76:79], a[12:15], v[60:63]
  s_waitcnt lgkmcnt(4)
  v_mfma_f32_16x16x32_bf16 v[64:67], a[64:67], a[0:3], v[64:67]
  ds_read_b64_tr_b16 a[76:77], v227 offset:16384
  v_mfma_f32_16x16x32_bf16 v[68:71], a[64:67], a[4:7], v[68:71]
  ds_read_b64_tr_b16 a[78:79], v227 offset:20480
  v_mfma_f32_16x16x32_bf16 v[72:75], a[64:67], a[8:11], v[72:75]
  buffer_load_dwordx4 v232, s[8:11], s29 offen offset:1024 lds
  v_mfma_f32_16x16x32_bf16 v[76:79], a[64:67], a[12:15], v[76:79]
  s_waitcnt lgkmcnt(4)
  v_mfma_f32_16x16x32_bf16 v[80:83], a[68:71], a[0:3], v[80:83]
  ds_read_b64_tr_b16 a[64:65], v228 offset:0
  v_mfma_f32_16x16x32_bf16 v[84:87], a[68:71], a[4:7], v[84:87]
  ds_read_b64_tr_b16 a[66:67], v228 offset:4096
  v_mfma_f32_16x16x32_bf16 v[88:91], a[68:71], a[8:11], v[88:91]
  buffer_load_dwordx4 a[52:55], v236, s[4:7], s28 offen offset:3072
  v_mfma_f32_16x16x32_bf16 v[92:95], a[68:71], a[12:15], v[92:95]
  s_waitcnt lgkmcnt(4)
  v_mfma_f32_16x16x32_bf16 v[96:99], a[72:75], a[0:3], v[96:99]
  ds_read_b64_tr_b16 a[68:69], v228 offset:16384
  v_mfma_f32_16x16x32_bf16 v[100:103], a[72:75], a[4:7], v[100:103]
  ds_read_b64_tr_b16 a[70:71], v228 offset:20480
  v_mfma_f32_16x16x32_bf16 v[104:107], a[72:75], a[8:11], v[104:107]
  v_mfma_f32_16x16x32_bf16 v[108:111], a[72:75], a[12:15], v[108:111]
  s_waitcnt lgkmcnt(4)
  v_mfma_f32_16x16x32_bf16 v[112:115], a[76:79], a[0:3], v[112:115]
  ds_read_b64_tr_b16 a[72:73], v229 offset:0
  v_mfma_f32_16x16x32_bf16 v[116:119], a[76:79], a[4:7], v[116:119]
  ds_read_b64_tr_b16 a[74:75], v229 offset:4096
  v_mfma_f32_16x16x32_bf16 v[120:123], a[76:79], a[8:11], v[120:123]
  buffer_load_dwordx4 v233, s[8:11], s29 offen offset:2048 lds
  v_mfma_f32_16x16x32_bf16 v[124:127], a[76:79], a[12:15], v[124:127]
  s_waitcnt lgkmcnt(4)
  v_mfma_f32_16x16x32_bf16 v[128:131], a[64:67], a[0:3], v[128:131]
  ds_read_b64_tr_b16 a[76:77], v229 offset:16384
  v_mfma_f32_16x16x32_bf16 v[132:135], a[64:67], a[4:7], v[132:135]
  ds_read_b64_tr_b16 a[78:79], v229 offset:20480
  v_mfma_f32_16x16x32_bf16 v[136:139], a[64:67], a[8:11], v[136:139]
  buffer_load_dwordx4 a[56:59], v237, s[4:7], s28 offen offset:3072
  v_mfma_f32_16x16x32_bf16 v[140:143], a[64:67], a[12:15], v[140:143]
  s_waitcnt lgkmcnt(4)
  v_mfma_f32_16x16x32_bf16 v[144:147], a[68:71], a[0:3], v[144:147]
  ds_read_b64_tr_b16 a[64:65], v230 offset:0
  v_mfma_f32_16x16x32_bf16 v[148:151], a[68:71], a[4:7], v[148:151]
  ds_read_b64_tr_b16 a[66:67], v230 offset:4096
  v_mfma_f32_16x16x32_bf16 v[152:155], a[68:71], a[8:11], v[152:155]
  v_mfma_f32_16x16x32_bf16 v[156:159], a[68:71], a[12:15], v[156:159]
  s_waitcnt lgkmcnt(4)
  v_mfma_f32_16x16x32_bf16 v[160:163], a[72:75], a[0:3], v[160:163]
  ds_read_b64_tr_b16 a[68:69], v230 offset:16384
  v_mfma_f32_16x16x32_bf16 v[164:167], a[72:75], a[4:7], v[164:167]
  ds_read_b64_tr_b16 a[70:71], v230 offset:20480
  v_mfma_f32_16x16x32_bf16 v[168:171], a[72:75], a[8:11], v[168:171]
  buffer_load_dwordx4 v234, s[8:11], s29 offen offset:3072 lds
  v_mfma_f32_16x16x32_bf16 v[172:175], a[72:75], a[12:15], v[172:175]
  s_waitcnt lgkmcnt(4)
  v_mfma_f32_16x16x32_bf16 v[176:179], a[76:79], a[0:3], v[176:179]
  ds_read_b64_tr_b16 a[72:73], v224 offset:8192
  v_mfma_f32_16x16x32_bf16 v[180:183], a[76:79], a[4:7], v[180:183]
  ds_read_b64_tr_b16 a[74:75], v224 offset:12288
  v_mfma_f32_16x16x32_bf16 v[184:187], a[76:79], a[8:11], v[184:187]
  buffer_load_dwordx4 a[60:63], v238, s[4:7], s28 offen offset:3072
  s_add_u32 s28, s28, 4096
  v_mfma_f32_16x16x32_bf16 v[188:191], a[76:79], a[12:15], v[188:191]
  s_waitcnt lgkmcnt(4)
  v_mfma_f32_16x16x32_bf16 v[192:195], a[64:67], a[0:3], v[192:195]
  ds_read_b64_tr_b16 a[76:77], v224 offset:24576
  v_mfma_f32_16x16x32_bf16 v[196:199], a[64:67], a[4:7], v[196:199]
  ds_read_b64_tr_b16 a[78:79], v224 offset:28672
  v_mfma_f32_16x16x32_bf16 v[200:203], a[64:67], a[8:11], v[200:203]
  v_mfma_f32_16x16x32_bf16 v[204:207], a[64:67], a[12:15], v[204:207]
  s_waitcnt lgkmcnt(4)
  v_mfma_f32_16x16x32_bf16 v[208:211], a[68:71], a[0:3], v[208:211]
  ds_read_b64_tr_b16 a[64:65], v225 offset:8192
  v_mfma_f32_16x16x32_bf16 v[212:215], a[68:71], a[4:7], v[212:215]
  ds_read_b64_tr_b16 a[66:67], v225 offset:12288
  v_mfma_f32_16x16x32_bf16 v[216:219], a[68:71], a[8:11], v[216:219]
  v_mfma_f32_16x16x32_bf16 v[220:223], a[68:71], a[12:15], v[220:223]
  s_waitcnt vmcnt(16) lgkmcnt(4)
  v_mfma_f32_16x16x32_bf16 v[0:3], a[72:75], a[16:19], v[0:3]
  ds_read_b64_tr_b16 a[68:69], v225 offset:24576
  v_mfma_f32_16x16x32_bf16 v[4:7], a[72:75], a[20:23], v[4:7]
  ds_read_b64_tr_b16 a[70:71], v225 offset:28672
  v_mfma_f32_16x16x32_bf16 v[8:11], a[72:75], a[24:27], v[8:11]
  v_mfma_f32_16x16x32_bf16 v[12:15], a[72:75], a[28:31], v[12:15]
  s_waitcnt lgkmcnt(4)
  v_mfma_f32_16x16x32_bf16 v[16:19], a[76:79], a[16:19], v[16:19]
  ds_read_b64_tr_b16 a[72:73], v226 offset:8192
  v_mfma_f32_16x16x32_bf16 v[20:23], a[76:79], a[20:23], v[20:23]
  ds_read_b64_tr_b16 a[74:75], v226 offset:12288
  v_mfma_f32_16x16x32_bf16 v[24:27], a[76:79], a[24:27], v[24:27]
  s_add_u32 m0, s30, 16384
  s_nop 0
  buffer_load_dwordx4 v231, s[12:15], s29 offen offset:0 lds
  v_mfma_f32_16x16x32_bf16 v[28:31], a[76:79], a[28:31], v[28:31]
  s_waitcnt lgkmcnt(4)
  v_mfma_f32_16x16x32_bf16 v[32:35], a[64:67], a[16:19], v[32:35]
  ds_read_b64_tr_b16 a[76:77], v226 offset:24576
  v_mfma_f32_16x16x32_bf16 v[36:39], a[64:67], a[20:23], v[36:39]
  ds_read_b64_tr_b16 a[78:79], v226 offset:28672
  v_mfma_f32_16x16x32_bf16 v[40:43], a[64:67], a[24:27], v[40:43]
  buffer_load_dwordx4 a[0:3], v235, s[4:7], s28 offen offset:0
  v_mfma_f32_16x16x32_bf16 v[44:47], a[64:67], a[28:31], v[44:47]
  s_waitcnt lgkmcnt(4)
  v_mfma_f32_16x16x32_bf16 v[48:51], a[68:71], a[16:19], v[48:51]
  ds_read_b64_tr_b16 a[64:65], v227 offset:8192
  v_mfma_f32_16x16x32_bf16 v[52:55], a[68:71], a[20:23], v[52:55]
  ds_read_b64_tr_b16 a[66:67], v227 offset:12288
  v_mfma_f32_16x16x32_bf16 v[56:59], a[68:71], a[24:27], v[56:59]
  v_mfma_f32_16x16x32_bf16 v[60:63], a[68:71], a[28:31], v[60:63]
  s_waitcnt lgkmcnt(4)
  v_mfma_f32_16x16x32_bf16 v[64:67], a[72:75], a[16:19], v[64:67]
  ds_read_b64_tr_b16 a[68:69], v227 offset:24576
  v_mfma_f32_16x16x32_bf16 v[68:71], a[72:75], a[20:23], v[68:71]
  ds_read_b64_tr_b16 a[70:71], v227 offset:28672
  v_mfma_f32_16x16x32_bf16 v[72:75], a[72:75], a[24:27], v[72:75]
  buffer_load_dwordx4 v232, s[12:15], s29 offen offset:1024 lds
  v_mfma_f32_16x16x32_bf16 v[76:79], a[72:75], a[28:31], v[76:79]
  s_waitcnt lgkmcnt(4)
  v_mfma_f32_16x16x32_bf16 v[80:83], a[76:79], a[16:19], v[80:83]
  ds_read_b64_tr_b16 a[72:73], v228 offset:8192
  v_mfma_f32_16x16x32_bf16 v[84:87], a[76:79], a[20:23], v[84:87]
  ds_read_b64_tr_b16 a[74:75], v228 offset:12288
  v_mfma_f32_16x16x32_bf16 v[88:91], a[76:79], a[24:27], v[88:91]
  buffer_load_dwordx4 a[4:7], v236, s[4:7], s28 offen offset:0
  v_mfma_f32_16x16x32_bf16 v[92:95], a[76:79], a[28:31], v[92:95]
  s_waitcnt lgkmcnt(4)
  v_mfma_f32_16x16x32_bf16 v[96:99], a[64:67], a[16:19], v[96:99]
  ds_read_b64_tr_b16 a[76:77], v228 offset:24576
  v_mfma_f32_16x16x32_bf16 v[100:103], a[64:67], a[20:23], v[100:103]
  ds_read_b64_tr_b16 a[78:79], v228 offset:28672
  v_mfma_f32_16x16x32_bf16 v[104:107], a[64:67], a[24:27], v[104:107]
  v_mfma_f32_16x16x32_bf16 v[108:111], a[64:67], a[28:31], v[108:111]
  s_waitcnt lgkmcnt(4)
  v_mfma_f32_16x16x32_bf16 v[112:115], a[68:71], a[16:19], v[112:115]
  ds_read_b64_tr_b16 a[64:65], v229 offset:8192
  v_mfma_f32_16x16x32_bf16 v[116:119], a[68:71], a[20:23], v[116:119]
  ds_read_b64_tr_b16 a[66:67], v229 offset:12288
  v_mfma_f32_16x16x32_bf16 v[120:123], a[68:71], a[24:27], v[120:123]
  buffer_load_dwordx4 v233, s[12:15], s29 offen offset:2048 lds
  v_mfma_f32_16x16x32_bf16 v[124:127], a[68:71], a[28:31], v[124:127]
  s_waitcnt lgkmcnt(4)
  v_mfma_f32_16x16x32_bf16 v[128:131], a[72:75], a[16:19], v[128:131]
  ds_read_b64_tr_b16 a[68:69], v229 offset:24576
  v_mfma_f32_16x16x32_bf16 v[132:135], a[72:75], a[20:23], v[132:135]
  ds_read_b64_tr_b16 a[70:71], v229 offset:28672
  v_mfma_f32_16x16x32_bf16 v[136:139], a[72:75], a[24:27], v[136:139]
  buffer_load_dwordx4 a[8:11], v237, s[4:7], s28 offen offset:0
  v_mfma_f32_16x16x32_bf16 v[140:143], a[72:75], a[28:31], v[140:143]
  s_waitcnt lgkmcnt(4)
  v_mfma_f32_16x16x32_bf16 v[144:147], a[76:79], a[16:19], v[144:147]
  ds_read_b64_tr_b16 a[72:73], v230 offset:8192
  v_mfma_f32_16x16x32_bf16 v[148:151], a[76:79], a[20:23], v[148:151]
  ds_read_b64_tr_b16 a[74:75], v230 offset:12288
  v_mfma_f32_16x16x32_bf16 v[152:155], a[76:79], a[24:27], v[152:155]
  v_mfma_f32_16x16x32_bf16 v[156:159], a[76:79], a[28:31], v[156:159]
  s_waitcnt lgkmcnt(4)
  v_mfma_f32_16x16x32_bf16 v[160:163], a[64:67], a[16:19], v[160:163]
  ds_read_b64_tr_b16 a[76:77], v230 offset:24576
  v_mfma_f32_16x16x32_bf16 v[164:167], a[64:67], a[20:23], v[164:167]
  ds_read_b64_tr_b16 a[78:79], v230 offset:28672
  v_mfma_f32_16x16x32_bf16 v[168:171], a[64:67], a[24:27], v[168:171]
  buffer_load_dwordx4 v234, s[12:15], s29 offen offset:3072 lds
  s_add_u32 s29, s29, 458752
  v_mfma_f32_16x16x32_bf16 v[172:175], a[64:67], a[28:31], v[172:175]
  s_waitcnt lgkmcnt(4)
  v_mfma_f32_16x16x32_bf16 v[176:179], a[68:71], a[16:19], v[176:179]
  s_waitcnt vmcnt(16)
  s_barrier
  ds_read_b64_tr_b16 a[64:65], v224 offset:32768
  v_mfma_f32_16x16x32_bf16 v[180:183], a[68:71], a[20:23], v[180:183]
  ds_read_b64_tr_b16 a[66:67], v224 offset:36864
  v_mfma_f32_16x16x32_bf16 v[184:187], a[68:71], a[24:27], v[184:187]
  buffer_load_dwordx4 a[12:15], v238, s[4:7], s28 offen offset:0
  v_mfma_f32_16x16x32_bf16 v[188:191], a[68:71], a[28:31], v[188:191]
  s_waitcnt lgkmcnt(4)
  v_mfma_f32_16x16x32_bf16 v[192:195], a[72:75], a[16:19], v[192:195]
  ds_read_b64_tr_b16 a[68:69], v224 offset:49152
  v_mfma_f32_16x16x32_bf16 v[196:199], a[72:75], a[20:23], v[196:199]
  ds_read_b64_tr_b16 a[70:71], v224 offset:53248
  v_mfma_f32_16x16x32_bf16 v[200:203], a[72:75], a[24:27], v[200:203]
  v_mfma_f32_16x16x32_bf16 v[204:207], a[72:75], a[28:31], v[204:207]
  s_waitcnt lgkmcnt(4)
  v_mfma_f32_16x16x32_bf16 v[208:211], a[76:79], a[16:19], v[208:211]
  ds_read_b64_tr_b16 a[72:73], v225 offset:32768
  v_mfma_f32_16x16x32_bf16 v[212:215], a[76:79], a[20:23], v[212:215]
  ds_read_b64_tr_b16 a[74:75], v225 offset:36864
  v_mfma_f32_16x16x32_bf16 v[216:219], a[76:79], a[24:27], v[216:219]
  v_mfma_f32_16x16x32_bf16 v[220:223], a[76:79], a[28:31], v[220:223]
  s_waitcnt vmcnt(16) lgkmcnt(4)
  v_mfma_f32_16x16x32_bf16 v[0:3], a[64:67], a[32:35], v[0:3]
  ds_read_b64_tr_b16 a[76:77], v225 offset:49152
  v_mfma_f32_16x16x32_bf16 v[4:7], a[64:67], a[36:39], v[4:7]
  ds_read_b64_tr_b16 a[78:79], v225 offset:53248
  v_mfma_f32_16x16x32_bf16 v[8:11], a[64:67], a[40:43], v[8:11]
  v_mfma_f32_16x16x32_bf16 v[12:15], a[64:67], a[44:47], v[12:15]
  s_waitcnt lgkmcnt(4)
  v_mfma_f32_16x16x32_bf16 v[16:19], a[68:71], a[32:35], v[16:19]
  ds_read_b64_tr_b16 a[64:65], v226 offset:32768
  v_mfma_f32_16x16x32_bf16 v[20:23], a[68:71], a[36:39], v[20:23]
  ds_read_b64_tr_b16 a[66:67], v226 offset:36864
  v_mfma_f32_16x16x32_bf16 v[24:27], a[68:71], a[40:43], v[24:27]
  s_add_u32 m0, s30, 32768
  s_nop 0
  buffer_load_dwordx4 v231, s[8:11], s29 offen offset:0 lds
  v_mfma_f32_16x16x32_bf16 v[28:31], a[68:71], a[44:47], v[28:31]
  s_waitcnt lgkmcnt(4)
  v_mfma_f32_16x16x32_bf16 v[32:35], a[72:75], a[32:35], v[32:35]
  ds_read_b64_tr_b16 a[68:69], v226 offset:49152
  v_mfma_f32_16x16x32_bf16 v[36:39], a[72:75], a[36:39], v[36:39]
  ds_read_b64_tr_b16 a[70:71], v226 offset:53248
  v_mfma_f32_16x16x32_bf16 v[40:43], a[72:75], a[40:43], v[40:43]
  buffer_load_dwordx4 a[16:19], v235, s[4:7], s28 offen offset:1024
  v_mfma_f32_16x16x32_bf16 v[44:47], a[72:75], a[44:47], v[44:47]
  s_waitcnt lgkmcnt(4)
  v_mfma_f32_16x16x32_bf16 v[48:51], a[76:79], a[32:35], v[48:51]
  ds_read_b64_tr_b16 a[72:73], v227 offset:32768
  v_mfma_f32_16x16x32_bf16 v[52:55], a[76:79], a[36:39], v[52:55]
  ds_read_b64_tr_b16 a[74:75], v227 offset:36864
  v_mfma_f32_16x16x32_bf16 v[56:59], a[76:79], a[40:43], v[56:59]
  v_mfma_f32_16x16x32_bf16 v[60:63], a[76:79], a[44:47], v[60:63]
  s_waitcnt lgkmcnt(4)
  v_mfma_f32_16x16x32_bf16 v[64:67], a[64:67], a[32:35], v[64:67]
  ds_read_b64_tr_b16 a[76:77], v227 offset:49152
  v_mfma_f32_16x16x32_bf16 v[68:71], a[64:67], a[36:39], v[68:71]
  ds_read_b64_tr_b16 a[78:79], v227 offset:53248
  v_mfma_f32_16x16x32_bf16 v[72:75], a[64:67], a[40:43], v[72:75]
  buffer_load_dwordx4 v232, s[8:11], s29 offen offset:1024 lds
  v_mfma_f32_16x16x32_bf16 v[76:79], a[64:67], a[44:47], v[76:79]
  s_waitcnt lgkmcnt(4)
  v_mfma_f32_16x16x32_bf16 v[80:83], a[68:71], a[32:35], v[80:83]
  ds_read_b64_tr_b16 a[64:65], v228 offset:32768
  v_mfma_f32_16x16x32_bf16 v[84:87], a[68:71], a[36:39], v[84:87]
  ds_read_b64_tr_b16 a[66:67], v228 offset:36864
  v_mfma_f32_16x16x32_bf16 v[88:91], a[68:71], a[40:43], v[88:91]
  buffer_load_dwordx4 a[20:23], v236, s[4:7], s28 offen offset:1024
  v_mfma_f32_16x16x32_bf16 v[92:95], a[68:71], a[44:47], v[92:95]
  s_waitcnt lgkmcnt(4)
  v_mfma_f32_16x16x32_bf16 v[96:99], a[72:75], a[32:35], v[96:99]
  ds_read_b64_tr_b16 a[68:69], v228 offset:49152
  v_mfma_f32_16x16x32_bf16 v[100:103], a[72:75], a[36:39], v[100:103]
  ds_read_b64_tr_b16 a[70:71], v228 offset:53248
  v_mfma_f32_16x16x32_bf16 v[104:107], a[72:75], a[40:43], v[104:107]
  v_mfma_f32_16x16x32_bf16 v[108:111], a[72:75], a[44:47], v[108:111]
  s_waitcnt lgkmcnt(4)
  v_mfma_f32_16x16x32_bf16 v[112:115], a[76:79], a[32:35], v[112:115]
  ds_read_b64_tr_b16 a[72:73], v229 offset:32768
  v_mfma_f32_16x16x32_bf16 v[116:119], a[76:79], a[36:39], v[116:119]
  ds_read_b64_tr_b16 a[74:75], v229 offset:36864
  v_mfma_f32_16x16x32_bf16 v[120:123], a[76:79], a[40:43], v[120:123]
  buffer_load_dwordx4 v233, s[8:11], s29 offen offset:2048 lds
  v_mfma_f32_16x16x32_bf16 v[124:127], a[76:79], a[44:47], v[124:127]
  s_waitcnt lgkmcnt(4)
  v_mfma_f32_16x16x32_bf16 v[128:131], a[64:67], a[32:35], v[128:131]
  ds_read_b64_tr_b16 a[76:77], v229 offset:49152
  v_mfma_f32_16x16x32_bf16 v[132:135], a[64:67], a[36:39], v[132:135]
  ds_read_b64_tr_b16 a[78:79], v229 offset:53248
  v_mfma_f32_16x16x32_bf16 v[136:139], a[64:67], a[40:43], v[136:139]
  buffer_load_dwordx4 a[24:27], v237, s[4:7], s28 offen offset:1024
  v_mfma_f32_16x16x32_bf16 v[140:143], a[64:67], a[44:47], v[140:143]
  s_waitcnt lgkmcnt(4)
  v_mfma_f32_16x16x32_bf16 v[144:147], a[68:71], a[32:35], v[144:147]
  ds_read_b64_tr_b16 a[64:65], v230 offset:32768
  v_mfma_f32_16x16x32_bf16 v[148:151], a[68:71], a[36:39], v[148:151]
  ds_read_b64_tr_b16 a[66:67], v230 offset:36864
  v_mfma_f32_16x16x32_bf16 v[152:155], a[68:71], a[40:43], v[152:155]
  v_mfma_f32_16x16x32_bf16 v[156:159], a[68:71], a[44:47], v[156:159]
  s_waitcnt lgkmcnt(4)
  v_mfma_f32_16x16x32_bf16 v[160:163], a[72:75], a[32:35], v[160:163]
  ds_read_b64_tr_b16 a[68:69], v230 offset:49152
  v_mfma_f32_16x16x32_bf16 v[164:167], a[72:75], a[36:39], v[164:167]
  ds_read_b64_tr_b16 a[70:71], v230 offset:53248
  v_mfma_f32_16x16x32_bf16 v[168:171], a[72:75], a[40:43], v[168:171]
  buffer_load_dwordx4 v234, s[8:11], s29 offen offset:3072 lds
  v_mfma_f32_16x16x32_bf16 v[172:175], a[72:75], a[44:47], v[172:175]
  s_waitcnt lgkmcnt(4)
  v_mfma_f32_16x16x32_bf16 v[176:179], a[76:79], a[32:35], v[176:179]
  ds_read_b64_tr_b16 a[72:73], v224 offset:40960
  v_mfma_f32_16x16x32_bf16 v[180:183], a[76:79], a[36:39], v[180:183]
  ds_read_b64_tr_b16 a[74:75], v224 offset:45056
  v_mfma_f32_16x16x32_bf16 v[184:187], a[76:79], a[40:43], v[184:187]
  buffer_load_dwordx4 a[28:31], v238, s[4:7], s28 offen offset:1024
  v_mfma_f32_16x16x32_bf16 v[188:191], a[76:79], a[44:47], v[188:191]
  s_waitcnt lgkmcnt(4)
  v_mfma_f32_16x16x32_bf16 v[192:195], a[64:67], a[32:35], v[192:195]
  ds_read_b64_tr_b16 a[76:77], v224 offset:57344
  v_mfma_f32_16x16x32_bf16 v[196:199], a[64:67], a[36:39], v[196:199]
  ds_read_b64_tr_b16 a[78:79], v224 offset:61440
  v_xor_b32 v224, 0x10000, v224
  v_mfma_f32_16x16x32_bf16 v[200:203], a[64:67], a[40:43], v[200:203]
  v_mfma_f32_16x16x32_bf16 v[204:207], a[64:67], a[44:47], v[204:207]
  s_waitcnt lgkmcnt(4)
  v_mfma_f32_16x16x32_bf16 v[208:211], a[68:71], a[32:35], v[208:211]
  ds_read_b64_tr_b16 a[64:65], v225 offset:40960
  v_mfma_f32_16x16x32_bf16 v[212:215], a[68:71], a[36:39], v[212:215]
  ds_read_b64_tr_b16 a[66:67], v225 offset:45056
  v_mfma_f32_16x16x32_bf16 v[216:219], a[68:71], a[40:43], v[216:219]
  v_mfma_f32_16x16x32_bf16 v[220:223], a[68:71], a[44:47], v[220:223]
  s_waitcnt vmcnt(16) lgkmcnt(4)
  v_mfma_f32_16x16x32_bf16 v[0:3], a[72:75], a[48:51], v[0:3]
  ds_read_b64_tr_b16 a[68:69], v225 offset:57344
  v_mfma_f32_16x16x32_bf16 v[4:7], a[72:75], a[52:55], v[4:7]
  ds_read_b64_tr_b16 a[70:71], v225 offset:61440
  v_xor_b32 v225, 0x10000, v225
  v_mfma_f32_16x16x32_bf16 v[8:11], a[72:75], a[56:59], v[8:11]
  v_mfma_f32_16x16x32_bf16 v[12:15], a[72:75], a[60:63], v[12:15]
  s_waitcnt lgkmcnt(4)
  v_mfma_f32_16x16x32_bf16 v[16:19], a[76:79], a[48:51], v[16:19]
  ds_read_b64_tr_b16 a[72:73], v226 offset:40960
  v_mfma_f32_16x16x32_bf16 v[20:23], a[76:79], a[52:55], v[20:23]
  ds_read_b64_tr_b16 a[74:75], v226 offset:45056
  v_mfma_f32_16x16x32_bf16 v[24:27], a[76:79], a[56:59], v[24:27]
  s_add_u32 m0, s30, 49152
  s_nop 0
  buffer_load_dwordx4 v231, s[12:15], s29 offen offset:0 lds
  v_mfma_f32_16x16x32_bf16 v[28:31], a[76:79], a[60:63], v[28:31]
  s_waitcnt lgkmcnt(4)
  v_mfma_f32_16x16x32_bf16 v[32:35], a[64:67], a[48:51], v[32:35]
  ds_read_b64_tr_b16 a[76:77], v226 offset:57344
  v_mfma_f32_16x16x32_bf16 v[36:39], a[64:67], a[52:55], v[36:39]
  ds_read_b64_tr_b16 a[78:79], v226 offset:61440
  v_xor_b32 v226, 0x10000, v226
  v_mfma_f32_16x16x32_bf16 v[40:43], a[64:67], a[56:59], v[40:43]
  buffer_load_dwordx4 a[32:35], v235, s[4:7], s28 offen offset:2048
  v_mfma_f32_16x16x32_bf16 v[44:47], a[64:67], a[60:63], v[44:47]
  s_waitcnt lgkmcnt(4)
  v_mfma_f32_16x16x32_bf16 v[48:51], a[68:71], a[48:51], v[48:51]
  ds_read_b64_tr_b16 a[64:65], v227 offset:40960
  v_mfma_f32_16x16x32_bf16 v[52:55], a[68:71], a[52:55], v[52:55]
  ds_read_b64_tr_b16 a[66:67], v227 offset:45056
  v_mfma_f32_16x16x32_bf16 v[56:59], a[68:71], a[56:59], v[56:59]
  v_mfma_f32_16x16x32_bf16 v[60:63], a[68:71], a[60:63], v[60:63]
  s_waitcnt lgkmcnt(4)
  v_mfma_f32_16x16x32_bf16 v[64:67], a[72:75], a[48:51], v[64:67]
  ds_read_b64_tr_b16 a[68:69], v227 offset:57344
  v_mfma_f32_16x16x32_bf16 v[68:71], a[72:75], a[52:55], v[68:71]
  ds_read_b64_tr_b16 a[70:71], v227 offset:61440
  v_xor_b32 v227, 0x10000, v227
  v_mfma_f32_16x16x32_bf16 v[72:75], a[72:75], a[56:59], v[72:75]
  buffer_load_dwordx4 v232, s[12:15], s29 offen offset:1024 lds
  v_mfma_f32_16x16x32_bf16 v[76:79], a[72:75], a[60:63], v[76:79]
  s_waitcnt lgkmcnt(4)
  v_mfma_f32_16x16x32_bf16 v[80:83], a[76:79], a[48:51], v[80:83]
  ds_read_b64_tr_b16 a[72:73], v228 offset:40960
  v_mfma_f32_16x16x32_bf16 v[84:87], a[76:79], a[52:55], v[84:87]
  ds_read_b64_tr_b16 a[74:75], v228 offset:45056
  v_mfma_f32_16x16x32_bf16 v[88:91], a[76:79], a[56:59], v[88:91]
  buffer_load_dwordx4 a[36:39], v236, s[4:7], s28 offen offset:2048
  v_mfma_f32_16x16x32_bf16 v[92:95], a[76:79], a[60:63], v[92:95]
  s_waitcnt lgkmcnt(4)
  v_mfma_f32_16x16x32_bf16 v[96:99], a[64:67], a[48:51], v[96:99]
  ds_read_b64_tr_b16 a[76:77], v228 offset:57344
  v_mfma_f32_16x16x32_bf16 v[100:103], a[64:67], a[52:55], v[100:103]
  ds_read_b64_tr_b16 a[78:79], v228 offset:61440
  v_xor_b32 v228, 0x10000, v228
  v_mfma_f32_16x16x32_bf16 v[104:107], a[64:67], a[56:59], v[104:107]
  v_mfma_f32_16x16x32_bf16 v[108:111], a[64:67], a[60:63], v[108:111]
  s_waitcnt lgkmcnt(4)
  v_mfma_f32_16x16x32_bf16 v[112:115], a[68:71], a[48:51], v[112:115]
  ds_read_b64_tr_b16 a[64:65], v229 offset:40960
  v_mfma_f32_16x16x32_bf16 v[116:119], a[68:71], a[52:55], v[116:119]
  ds_read_b64_tr_b16 a[66:67], v229 offset:45056
  v_mfma_f32_16x16x32_bf16 v[120:123], a[68:71], a[56:59], v[120:123]
  buffer_load_dwordx4 v233, s[12:15], s29 offen offset:2048 lds
  v_mfma_f32_16x16x32_bf16 v[124:127], a[68:71], a[60:63], v[124:127]
  s_waitcnt lgkmcnt(4)
  v_mfma_f32_16x16x32_bf16 v[128:131], a[72:75], a[48:51], v[128:131]
  ds_read_b64_tr_b16 a[68:69], v229 offset:57344
  v_mfma_f32_16x16x32_bf16 v[132:135], a[72:75], a[52:55], v[132:135]
  ds_read_b64_tr_b16 a[70:71], v229 offset:61440
  v_xor_b32 v229, 0x10000, v229
  v_mfma_f32_16x16x32_bf16 v[136:139], a[72:75], a[56:59], v[136:139]
  buffer_load_dwordx4 a[40:43], v237, s[4:7], s28 offen offset:2048
  v_mfma_f32_16x16x32_bf16 v[140:143], a[72:75], a[60:63], v[140:143]
  s_waitcnt lgkmcnt(4)
  v_mfma_f32_16x16x32_bf16 v[144:147], a[76:79], a[48:51], v[144:147]
  ds_read_b64_tr_b16 a[72:73], v230 offset:40960
  v_mfma_f32_16x16x32_bf16 v[148:151], a[76:79], a[52:55], v[148:151]
  ds_read_b64_tr_b16 a[74:75], v230 offset:45056
  v_mfma_f32_16x16x32_bf16 v[152:155], a[76:79], a[56:59], v[152:155]
  v_mfma_f32_16x16x32_bf16 v[156:159], a[76:79], a[60:63], v[156:159]
  s_waitcnt lgkmcnt(4)
  v_mfma_f32_16x16x32_bf16 v[160:163], a[64:67], a[48:51], v[160:163]
  ds_read_b64_tr_b16 a[76:77], v230 offset:57344
  v_mfma_f32_16x16x32_bf16 v[164:167], a[64:67], a[52:55], v[164:167]
  ds_read_b64_tr_b16 a[78:79], v230 offset:61440
  v_xor_b32 v230, 0x10000, v230
  v_mfma_f32_16x16x32_bf16 v[168:171], a[64:67], a[56:59], v[168:171]
  buffer_load_dwordx4 v234, s[12:15], s29 offen offset:3072 lds
  s_add_u32 s29, s29, 458752
  s_xor_b32 s30, s30, 0x10000
  v_mfma_f32_16x16x32_bf16 v[172:175], a[64:67], a[60:63], v[172:175]
  s_waitcnt lgkmcnt(4)
  v_mfma_f32_16x16x32_bf16 v[176:179], a[68:71], a[48:51], v[176:179]
  s_waitcnt vmcnt(16)
  s_barrier
  ds_read_b64_tr_b16 a[64:65], v224 offset:0
  v_mfma_f32_16x16x32_bf16 v[180:183], a[68:71], a[52:55], v[180:183]
  ds_read_b64_tr_b16 a[66:67], v224 offset:4096
  v_mfma_f32_16x16x32_bf16 v[184:187], a[68:71], a[56:59], v[184:187]
  buffer_load_dwordx4 a[44:47], v238, s[4:7], s28 offen offset:2048
  v_mfma_f32_16x16x32_bf16 v[188:191], a[68:71], a[60:63], v[188:191]
  s_waitcnt lgkmcnt(4)
  v_mfma_f32_16x16x32_bf16 v[192:195], a[72:75], a[48:51], v[192:195]
  ds_read_b64_tr_b16 a[68:69], v224 offset:16384
  v_mfma_f32_16x16x32_bf16 v[196:199], a[72:75], a[52:55], v[196:199]
  ds_read_b64_tr_b16 a[70:71], v224 offset:20480
  v_mfma_f32_16x16x32_bf16 v[200:203], a[72:75], a[56:59], v[200:203]
  v_mfma_f32_16x16x32_bf16 v[204:207], a[72:75], a[60:63], v[204:207]
  s_waitcnt lgkmcnt(4)
  v_mfma_f32_16x16x32_bf16 v[208:211], a[76:79], a[48:51], v[208:211]
  ds_read_b64_tr_b16 a[72:73], v225 offset:0
  v_mfma_f32_16x16x32_bf16 v[212:215], a[76:79], a[52:55], v[212:215]
  ds_read_b64_tr_b16 a[74:75], v225 offset:4096
  v_mfma_f32_16x16x32_bf16 v[216:219], a[76:79], a[56:59], v[216:219]
  v_mfma_f32_16x16x32_bf16 v[220:223], a[76:79], a[60:63], v[220:223]
  s_sub_u32 s31, s31, 1
  s_cmp_lg_u32 s31, 0
  s_cbranch_scc1 Lgu_body_loop
  s_waitcnt vmcnt(16) lgkmcnt(4)
  v_mfma_f32_16x16x32_bf16 v[0:3], a[64:67], a[0:3], v[0:3]
  ds_read_b64_tr_b16 a[76:77], v225 offset:16384
  v_mfma_f32_16x16x32_bf16 v[4:7], a[64:67], a[4:7], v[4:7]
  ds_read_b64_tr_b16 a[78:79], v225 offset:20480
  v_mfma_f32_16x16x32_bf16 v[8:11], a[64:67], a[8:11], v[8:11]
  v_mfma_f32_16x16x32_bf16 v[12:15], a[64:67], a[12:15], v[12:15]
  s_waitcnt lgkmcnt(4)
  v_mfma_f32_16x16x32_bf16 v[16:19], a[68:71], a[0:3], v[16:19]
  ds_read_b64_tr_b16 a[64:65], v226 offset:0
  v_mfma_f32_16x16x32_bf16 v[20:23], a[68:71], a[4:7], v[20:23]
  ds_read_b64_tr_b16 a[66:67], v226 offset:4096
  v_mfma_f32_16x16x32_bf16 v[24:27], a[68:71], a[8:11], v[24:27]
  v_mfma_f32_16x16x32_bf16 v[28:31], a[68:71], a[12:15], v[28:31]
  s_waitcnt lgkmcnt(4)
  v_mfma_f32_16x16x32_bf16 v[32:35], a[72:75], a[0:3], v[32:35]
  ds_read_b64_tr_b16 a[68:69], v226 offset:16384
  v_mfma_f32_16x16x32_bf16 v[36:39], a[72:75], a[4:7], v[36:39]
  ds_read_b64_tr_b16 a[70:71], v226 offset:20480
  v_mfma_f32_16x16x32_bf16 v[40:43], a[72:75], a[8:11], v[40:43]
  buffer_load_dwordx4 a[48:51], v235, s[4:7], s28 offen offset:3072
  v_mfma_f32_16x16x32_bf16 v[44:47], a[72:75], a[12:15], v[44:47]
  s_waitcnt lgkmcnt(4)
  v_mfma_f32_16x16x32_bf16 v[48:51], a[76:79], a[0:3], v[48:51]
  ds_read_b64_tr_b16 a[72:73], v227 offset:0
  v_mfma_f32_16x16x32_bf16 v[52:55], a[76:79], a[4:7], v[52:55]
  ds_read_b64_tr_b16 a[74:75], v227 offset:4096
  v_mfma_f32_16x16x32_bf16 v[56:59], a[76:79], a[8:11], v[56:59]
  v_mfma_f32_16x16x32_bf16 v[60:63], a[76:79], a[12:15], v[60:63]
  s_waitcnt lgkmcnt(4)
  v_mfma_f32_16x16x32_bf16 v[64:67], a[64:67], a[0:3], v[64:67]
  ds_read_b64_tr_b16 a[76:77], v227 offset:16384
  v_mfma_f32_16x16x32_bf16 v[68:71], a[64:67], a[4:7], v[68:71]
  ds_read_b64_tr_b16 a[78:79], v227 offset:20480
  v_mfma_f32_16x16x32_bf16 v[72:75], a[64:67], a[8:11], v[72:75]
  v_mfma_f32_16x16x32_bf16 v[76:79], a[64:67], a[12:15], v[76:79]
  s_waitcnt lgkmcnt(4)
  v_mfma_f32_16x16x32_bf16 v[80:83], a[68:71], a[0:3], v[80:83]
  ds_read_b64_tr_b16 a[64:65], v228 offset:0
  v_mfma_f32_16x16x32_bf16 v[84:87], a[68:71], a[4:7], v[84:87]
  ds_read_b64_tr_b16 a[66:67], v228 offset:4096
  v_mfma_f32_16x16x32_bf16 v[88:91], a[68:71], a[8:11], v[88:91]
  buffer_load_dwordx4 a[52:55], v236, s[4:7], s28 offen offset:3072
  v_mfma_f32_16x16x32_bf16 v[92:95], a[68:71], a[12:15], v[92:95]
  s_waitcnt lgkmcnt(4)
  v_mfma_f32_16x16x32_bf16 v[96:99], a[72:75], a[0:3], v[96:99]
  ds_read_b64_tr_b16 a[68:69], v228 offset:16384
  v_mfma_f32_16x16x32_bf16 v[100:103], a[72:75], a[4:7], v[100:103]
  ds_read_b64_tr_b16 a[70:71], v228 offset:20480
  v_mfma_f32_16x16x32_bf16 v[104:107], a[72:75], a[8:11], v[104:107]
  v_mfma_f32_16x16x32_bf16 v[108:111], a[72:75], a[12:15], v[108:111]
  s_waitcnt lgkmcnt(4)
  v_mfma_f32_16x16x32_bf16 v[112:115], a[76:79], a[0:3], v[112:115]
  ds_read_b64_tr_b16 a[72:73], v229 offset:0
  v_mfma_f32_16x16x32_bf16 v[116:119], a[76:79], a[4:7], v[116:119]
  ds_read_b64_tr_b16 a[74:75], v229 offset:4096
  v_mfma_f32_16x16x32_bf16 v[120:123], a[76:79], a[8:11], v[120:123]
  v_mfma_f32_16x16x32_bf16 v[124:127], a[76:79], a[12:15], v[124:127]
  s_waitcnt lgkmcnt(4)
  v_mfma_f32_16x16x32_bf16 v[128:131], a[64:67], a[0:3], v[128:131]
  ds_read_b64_tr_b16 a[76:77], v229 offset:16384
  v_mfma_f32_16x16x32_bf16 v[132:135], a[64:67], a[4:7], v[132:135]
  ds_read_b64_tr_b16 a[78:79], v229 offset:20480
  v_mfma_f32_16x16x32_bf16 v[136:139], a[64:67], a[8:11], v[136:139]
  buffer_load_dwordx4 a[56:59], v237, s[4:7], s28 offen offset:3072
  v_mfma_f32_16x16x32_bf16 v[140:143], a[64:67], a[12:15], v[140:143]
  s_waitcnt lgkmcnt(4)
  v_mfma_f32_16x16x32_bf16 v[144:147], a[68:71], a[0:3], v[144:147]
  ds_read_b64_tr_b16 a[64:65], v230 offset:0
  v_mfma_f32_16x16x32_bf16 v[148:151], a[68:71], a[4:7], v[148:151]
  ds_read_b64_tr_b16 a[66:67], v230 offset:4096
  v_mfma_f32_16x16x32_bf16 v[152:155], a[68:71], a[8:11], v[152:155]
  v_mfma_f32_16x16x32_bf16 v[156:159], a[68:71], a[12:15], v[156:159]
  s_waitcnt lgkmcnt(4)
  v_mfma_f32_16x16x32_bf16 v[160:163], a[72:75], a[0:3], v[160:163]
  ds_read_b64_tr_b16 a[68:69], v230 offset:16384
  v_mfma_f32_16x16x32_bf16 v[164:167], a[72:75], a[4:7], v[164:167]
  ds_read_b64_tr_b16 a[70:71], v230 offset:20480
  v_mfma_f32_16x16x32_bf16 v[168:171], a[72:75], a[8:11], v[168:171]
  v_mfma_f32_16x16x32_bf16 v[172:175], a[72:75], a[12:15], v[172:175]
  s_waitcnt lgkmcnt(4)
  v_mfma_f32_16x16x32_bf16 v[176:179], a[76:79], a[0:3], v[176:179]
  ds_read_b64_tr_b16 a[72:73], v224 offset:8192
  v_mfma_f32_16x16x32_bf16 v[180:183], a[76:79], a[4:7], v[180:183]
  ds_read_b64_tr_b16 a[74:75], v224 offset:12288
  v_mfma_f32_16x16x32_bf16 v[184:187], a[76:79], a[8:11], v[184:187]
  buffer_load_dwordx4 a[60:63], v238, s[4:7], s28 offen offset:3072
  s_add_u32 s28, s28, 4096
  v_mfma_f32_16x16x32_bf16 v[188:191], a[76:79], a[12:15], v[188:191]
  s_waitcnt lgkmcnt(4)
  v_mfma_f32_16x16x32_bf16 v[192:195], a[64:67], a[0:3], v[192:195]
  ds_read_b64_tr_b16 a[76:77], v224 offset:24576
  v_mfma_f32_16x16x32_bf16 v[196:199], a[64:67], a[4:7], v[196:199]
  ds_read_b64_tr_b16 a[78:79], v224 offset:28672
  v_mfma_f32_16x16x32_bf16 v[200:203], a[64:67], a[8:11], v[200:203]
  v_mfma_f32_16x16x32_bf16 v[204:207], a[64:67], a[12:15], v[204:207]
  s_waitcnt lgkmcnt(4)
  v_mfma_f32_16x16x32_bf16 v[208:211], a[68:71], a[0:3], v[208:211]
  ds_read_b64_tr_b16 a[64:65], v225 offset:8192
  v_mfma_f32_16x16x32_bf16 v[212:215], a[68:71], a[4:7], v[212:215]
  ds_read_b64_tr_b16 a[66:67], v225 offset:12288
  v_mfma_f32_16x16x32_bf16 v[216:219], a[68:71], a[8:11], v[216:219]
  v_mfma_f32_16x16x32_bf16 v[220:223], a[68:71], a[12:15], v[220:223]
  s_waitcnt vmcnt(12) lgkmcnt(4)
  v_mfma_f32_16x16x32_bf16 v[0:3], a[72:75], a[16:19], v[0:3]
  ds_read_b64_tr_b16 a[68:69], v225 offset:24576
  v_mfma_f32_16x16x32_bf16 v[4:7], a[72:75], a[20:23], v[4:7]
  ds_read_b64_tr_b16 a[70:71], v225 offset:28672
  v_mfma_f32_16x16x32_bf16 v[8:11], a[72:75], a[24:27], v[8:11]
  v_mfma_f32_16x16x32_bf16 v[12:15], a[72:75], a[28:31], v[12:15]
  s_waitcnt lgkmcnt(4)
  v_mfma_f32_16x16x32_bf16 v[16:19], a[76:79], a[16:19], v[16:19]
  ds_read_b64_tr_b16 a[72:73], v226 offset:8192
  v_mfma_f32_16x16x32_bf16 v[20:23], a[76:79], a[20:23], v[20:23]
  ds_read_b64_tr_b16 a[74:75], v226 offset:12288
  v_mfma_f32_16x16x32_bf16 v[24:27], a[76:79], a[24:27], v[24:27]
  s_lshl_b32 s43, s44, 13
  s_add_u32 s43, s43, s41
  v_lshlrev_b32 v231, 3, v239
  s_add_u32 s45, s43, 4096
  buffer_load_dwordx2 a[128:129], v231, s[4:7], s43 offen offset:0
  buffer_load_dwordx2 a[130:131], v231, s[4:7], s43 offen offset:512
  v_mfma_f32_16x16x32_bf16 v[28:31], a[76:79], a[28:31], v[28:31]
  s_waitcnt lgkmcnt(4)
  v_mfma_f32_16x16x32_bf16 v[32:35], a[64:67], a[16:19], v[32:35]
  ds_read_b64_tr_b16 a[76:77], v226 offset:24576
  v_mfma_f32_16x16x32_bf16 v[36:39], a[64:67], a[20:23], v[36:39]
  ds_read_b64_tr_b16 a[78:79], v226 offset:28672
  v_mfma_f32_16x16x32_bf16 v[40:43], a[64:67], a[24:27], v[40:43]
  buffer_load_dwordx2 a[132:133], v231, s[4:7], s43 offen offset:1024
  buffer_load_dwordx2 a[134:135], v231, s[4:7], s43 offen offset:1536
  v_mfma_f32_16x16x32_bf16 v[44:47], a[64:67], a[28:31], v[44:47]
  s_waitcnt lgkmcnt(4)
  v_mfma_f32_16x16x32_bf16 v[48:51], a[68:71], a[16:19], v[48:51]
  ds_read_b64_tr_b16 a[64:65], v227 offset:8192
  v_mfma_f32_16x16x32_bf16 v[52:55], a[68:71], a[20:23], v[52:55]
  ds_read_b64_tr_b16 a[66:67], v227 offset:12288
  v_mfma_f32_16x16x32_bf16 v[56:59], a[68:71], a[24:27], v[56:59]
  v_mfma_f32_16x16x32_bf16 v[60:63], a[68:71], a[28:31], v[60:63]
  s_waitcnt lgkmcnt(4)
  v_mfma_f32_16x16x32_bf16 v[64:67], a[72:75], a[16:19], v[64:67]
  ds_read_b64_tr_b16 a[68:69], v227 offset:24576
  v_mfma_f32_16x16x32_bf16 v[68:71], a[72:75], a[20:23], v[68:71]
  ds_read_b64_tr_b16 a[70:71], v227 offset:28672
  v_mfma_f32_16x16x32_bf16 v[72:75], a[72:75], a[24:27], v[72:75]
  buffer_load_dwordx2 a[136:137], v231, s[4:7], s43 offen offset:2048
  buffer_load_dwordx2 a[138:139], v231, s[4:7], s43 offen offset:2560
  v_mfma_f32_16x16x32_bf16 v[76:79], a[72:75], a[28:31], v[76:79]
  s_waitcnt lgkmcnt(4)
  v_mfma_f32_16x16x32_bf16 v[80:83], a[76:79], a[16:19], v[80:83]
  ds_read_b64_tr_b16 a[72:73], v228 offset:8192
  v_mfma_f32_16x16x32_bf16 v[84:87], a[76:79], a[20:23], v[84:87]
  ds_read_b64_tr_b16 a[74:75], v228 offset:12288
  v_mfma_f32_16x16x32_bf16 v[88:91], a[76:79], a[24:27], v[88:91]
  buffer_load_dwordx2 a[140:141], v231, s[4:7], s43 offen offset:3072
  buffer_load_dwordx2 a[142:143], v231, s[4:7], s43 offen offset:3584
  v_mfma_f32_16x16x32_bf16 v[92:95], a[76:79], a[28:31], v[92:95]
  s_waitcnt lgkmcnt(4)
  v_mfma_f32_16x16x32_bf16 v[96:99], a[64:67], a[16:19], v[96:99]
  ds_read_b64_tr_b16 a[76:77], v228 offset:24576
  v_mfma_f32_16x16x32_bf16 v[100:103], a[64:67], a[20:23], v[100:103]
  ds_read_b64_tr_b16 a[78:79], v228 offset:28672
  v_mfma_f32_16x16x32_bf16 v[104:107], a[64:67], a[24:27], v[104:107]
  v_mfma_f32_16x16x32_bf16 v[108:111], a[64:67], a[28:31], v[108:111]
  s_waitcnt lgkmcnt(4)
  v_mfma_f32_16x16x32_bf16 v[112:115], a[68:71], a[16:19], v[112:115]
  ds_read_b64_tr_b16 a[64:65], v229 offset:8192
  v_mfma_f32_16x16x32_bf16 v[116:119], a[68:71], a[20:23], v[116:119]
  ds_read_b64_tr_b16 a[66:67], v229 offset:12288
  v_mfma_f32_16x16x32_bf16 v[120:123], a[68:71], a[24:27], v[120:123]
  buffer_load_dwordx2 a[144:145], v231, s[4:7], s45 offen offset:0
  buffer_load_dwordx2 a[146:147], v231, s[4:7], s45 offen offset:512
  v_mfma_f32_16x16x32_bf16 v[124:127], a[68:71], a[28:31], v[124:127]
  s_waitcnt lgkmcnt(4)
  v_mfma_f32_16x16x32_bf16 v[128:131], a[72:75], a[16:19], v[128:131]
  ds_read_b64_tr_b16 a[68:69], v229 offset:24576
  v_mfma_f32_16x16x32_bf16 v[132:135], a[72:75], a[20:23], v[132:135]
  ds_read_b64_tr_b16 a[70:71], v229 offset:28672
  v_mfma_f32_16x16x32_bf16 v[136:139], a[72:75], a[24:27], v[136:139]
  buffer_load_dwordx2 a[148:149], v231, s[4:7], s45 offen offset:1024
  buffer_load_dwordx2 a[150:151], v231, s[4:7], s45 offen offset:1536
  v_mfma_f32_16x16x32_bf16 v[140:143], a[72:75], a[28:31], v[140:143]
  s_waitcnt lgkmcnt(4)
  v_mfma_f32_16x16x32_bf16 v[144:147], a[76:79], a[16:19], v[144:147]
  ds_read_b64_tr_b16 a[72:73], v230 offset:8192
  v_mfma_f32_16x16x32_bf16 v[148:151], a[76:79], a[20:23], v[148:151]
  ds_read_b64_tr_b16 a[74:75], v230 offset:12288
  v_mfma_f32_16x16x32_bf16 v[152:155], a[76:79], a[24:27], v[152:155]
  v_mfma_f32_16x16x32_bf16 v[156:159], a[76:79], a[28:31], v[156:159]
  s_waitcnt lgkmcnt(4)
  v_mfma_f32_16x16x32_bf16 v[160:163], a[64:67], a[16:19], v[160:163]
  ds_read_b64_tr_b16 a[76:77], v230 offset:24576
  v_mfma_f32_16x16x32_bf16 v[164:167], a[64:67], a[20:23], v[164:167]
  ds_read_b64_tr_b16 a[78:79], v230 offset:28672
  v_mfma_f32_16x16x32_bf16 v[168:171], a[64:67], a[24:27], v[168:171]
  buffer_load_dwordx2 a[152:153], v231, s[4:7], s45 offen offset:2048
  buffer_load_dwordx2 a[154:155], v231, s[4:7], s45 offen offset:2560
  v_mfma_f32_16x16x32_bf16 v[172:175], a[64:67], a[28:31], v[172:175]
  s_waitcnt lgkmcnt(4)
  v_mfma_f32_16x16x32_bf16 v[176:179], a[68:71], a[16:19], v[176:179]
  s_waitcnt vmcnt(19)
  s_barrier
  ds_read_b64_tr_b16 a[64:65], v224 offset:32768
  v_mfma_f32_16x16x32_bf16 v[180:183], a[68:71], a[20:23], v[180:183]
  ds_read_b64_tr_b16 a[66:67], v224 offset:36864
  v_mfma_f32_16x16x32_bf16 v[184:187], a[68:71], a[24:27], v[184:187]
  buffer_load_dwordx2 a[156:157], v231, s[4:7], s45 offen offset:3072
  buffer_load_dwordx2 a[158:159], v231, s[4:7], s45 offen offset:3584
  v_mfma_f32_16x16x32_bf16 v[188:191], a[68:71], a[28:31], v[188:191]
  s_waitcnt lgkmcnt(4)
  v_mfma_f32_16x16x32_bf16 v[192:195], a[72:75], a[16:19], v[192:195]
  ds_read_b64_tr_b16 a[68:69], v224 offset:49152
  v_mfma_f32_16x16x32_bf16 v[196:199], a[72:75], a[20:23], v[196:199]
  ds_read_b64_tr_b16 a[70:71], v224 offset:53248
  v_mfma_f32_16x16x32_bf16 v[200:203], a[72:75], a[24:27], v[200:203]
  v_mfma_f32_16x16x32_bf16 v[204:207], a[72:75], a[28:31], v[204:207]
  s_waitcnt lgkmcnt(4)
  v_mfma_f32_16x16x32_bf16 v[208:211], a[76:79], a[16:19], v[208:211]
  ds_read_b64_tr_b16 a[72:73], v225 offset:32768
  v_mfma_f32_16x16x32_bf16 v[212:215], a[76:79], a[20:23], v[212:215]
  ds_read_b64_tr_b16 a[74:75], v225 offset:36864
  v_mfma_f32_16x16x32_bf16 v[216:219], a[76:79], a[24:27], v[216:219]
  v_mfma_f32_16x16x32_bf16 v[220:223], a[76:79], a[28:31], v[220:223]
  s_waitcnt vmcnt(20) lgkmcnt(4)
  v_mfma_f32_16x16x32_bf16 v[0:3], a[64:67], a[32:35], v[0:3]
  ds_read_b64_tr_b16 a[76:77], v225 offset:49152
  v_mfma_f32_16x16x32_bf16 v[4:7], a[64:67], a[36:39], v[4:7]
  ds_read_b64_tr_b16 a[78:79], v225 offset:53248
  v_mfma_f32_16x16x32_bf16 v[8:11], a[64:67], a[40:43], v[8:11]
  v_mfma_f32_16x16x32_bf16 v[12:15], a[64:67], a[44:47], v[12:15]
  s_waitcnt lgkmcnt(4)
  v_mfma_f32_16x16x32_bf16 v[16:19], a[68:71], a[32:35], v[16:19]
  ds_read_b64_tr_b16 a[64:65], v226 offset:32768
  v_mfma_f32_16x16x32_bf16 v[20:23], a[68:71], a[36:39], v[20:23]
  ds_read_b64_tr_b16 a[66:67], v226 offset:36864
  v_mfma_f32_16x16x32_bf16 v[24:27], a[68:71], a[40:43], v[24:27]
  s_mul_i32 s43, s26, 448
  s_add_u32 s43, s43, 36716544
  s_lshl_b32 s45, s27, 6
  s_add_u32 s45, s43, s45
  s_add_u32 s46, s45, 14336
  s_cmp_eq_u32 s27, 0
  s_cselect_b32 s47, 384, 0
  s_add_u32 s47, s47, s43
  s_add_u32 s48, s47, 14336
  v_lshrrev_b32 v232, 4, v239
  v_lshlrev_b32 v232, 4, v232
  buffer_load_dwordx4 a[160:163], v232, s[4:7], s45 offen offset:0
  buffer_load_dwordx4 a[164:167], v232, s[4:7], s46 offen offset:0
  v_mfma_f32_16x16x32_bf16 v[28:31], a[68:71], a[44:47], v[28:31]
  s_waitcnt lgkmcnt(4)
  v_mfma_f32_16x16x32_bf16 v[32:35], a[72:75], a[32:35], v[32:35]
  ds_read_b64_tr_b16 a[68:69], v226 offset:49152
  v_mfma_f32_16x16x32_bf16 v[36:39], a[72:75], a[36:39], v[36:39]
  ds_read_b64_tr_b16 a[70:71], v226 offset:53248
  v_mfma_f32_16x16x32_bf16 v[40:43], a[72:75], a[40:43], v[40:43]
  buffer_load_dwordx4 a[168:171], v232, s[4:7], s45 offen offset:64
  buffer_load_dwordx4 a[172:175], v232, s[4:7], s46 offen offset:64
  v_mfma_f32_16x16x32_bf16 v[44:47], a[72:75], a[44:47], v[44:47]
  s_waitcnt lgkmcnt(4)
  v_mfma_f32_16x16x32_bf16 v[48:51], a[76:79], a[32:35], v[48:51]
  ds_read_b64_tr_b16 a[72:73], v227 offset:32768
  v_mfma_f32_16x16x32_bf16 v[52:55], a[76:79], a[36:39], v[52:55]
  ds_read_b64_tr_b16 a[74:75], v227 offset:36864
  v_mfma_f32_16x16x32_bf16 v[56:59], a[76:79], a[40:43], v[56:59]
  v_mfma_f32_16x16x32_bf16 v[60:63], a[76:79], a[44:47], v[60:63]
  s_waitcnt lgkmcnt(4)
  v_mfma_f32_16x16x32_bf16 v[64:67], a[64:67], a[32:35], v[64:67]
  ds_read_b64_tr_b16 a[76:77], v227 offset:49152
  v_mfma_f32_16x16x32_bf16 v[68:71], a[64:67], a[36:39], v[68:71]
  ds_read_b64_tr_b16 a[78:79], v227 offset:53248
  v_mfma_f32_16x16x32_bf16 v[72:75], a[64:67], a[40:43], v[72:75]
  buffer_load_dwordx4 a[176:179], v232, s[4:7], s45 offen offset:128
  buffer_load_dwordx4 a[180:183], v232, s[4:7], s46 offen offset:128
  v_mfma_f32_16x16x32_bf16 v[76:79], a[64:67], a[44:47], v[76:79]
  s_waitcnt lgkmcnt(4)
  v_mfma_f32_16x16x32_bf16 v[80:83], a[68:71], a[32:35], v[80:83]
  ds_read_b64_tr_b16 a[64:65], v228 offset:32768
  v_mfma_f32_16x16x32_bf16 v[84:87], a[68:71], a[36:39], v[84:87]
  ds_read_b64_tr_b16 a[66:67], v228 offset:36864
  v_mfma_f32_16x16x32_bf16 v[88:91], a[68:71], a[40:43], v[88:91]
  buffer_load_dwordx4 a[184:187], v232, s[4:7], s45 offen offset:192
  buffer_load_dwordx4 a[188:191], v232, s[4:7], s46 offen offset:192
  v_mfma_f32_16x16x32_bf16 v[92:95], a[68:71], a[44:47], v[92:95]
  s_waitcnt lgkmcnt(4)
  v_mfma_f32_16x16x32_bf16 v[96:99], a[72:75], a[32:35], v[96:99]
  ds_read_b64_tr_b16 a[68:69], v228 offset:49152
  v_mfma_f32_16x16x32_bf16 v[100:103], a[72:75], a[36:39], v[100:103]
  ds_read_b64_tr_b16 a[70:71], v228 offset:53248
  v_mfma_f32_16x16x32_bf16 v[104:107], a[72:75], a[40:43], v[104:107]
  v_mfma_f32_16x16x32_bf16 v[108:111], a[72:75], a[44:47], v[108:111]
  s_waitcnt lgkmcnt(4)
  v_mfma_f32_16x16x32_bf16 v[112:115], a[76:79], a[32:35], v[112:115]
  ds_read_b64_tr_b16 a[72:73], v229 offset:32768
  v_mfma_f32_16x16x32_bf16 v[116:119], a[76:79], a[36:39], v[116:119]
  ds_read_b64_tr_b16 a[74:75], v229 offset:36864
  v_mfma_f32_16x16x32_bf16 v[120:123], a[76:79], a[40:43], v[120:123]
  buffer_load_dwordx4 a[192:195], v232, s[4:7], s45 offen offset:256
  buffer_load_dwordx4 a[196:199], v232, s[4:7], s46 offen offset:256
  v_mfma_f32_16x16x32_bf16 v[124:127], a[76:79], a[44:47], v[124:127]
  s_waitcnt lgkmcnt(4)
  v_mfma_f32_16x16x32_bf16 v[128:131], a[64:67], a[32:35], v[128:131]
  ds_read_b64_tr_b16 a[76:77], v229 offset:49152
  v_mfma_f32_16x16x32_bf16 v[132:135], a[64:67], a[36:39], v[132:135]
  ds_read_b64_tr_b16 a[78:79], v229 offset:53248
  v_mfma_f32_16x16x32_bf16 v[136:139], a[64:67], a[40:43], v[136:139]
  buffer_load_dwordx4 a[200:203], v232, s[4:7], s45 offen offset:320
  buffer_load_dwordx4 a[204:207], v232, s[4:7], s46 offen offset:320
  v_mfma_f32_16x16x32_bf16 v[140:143], a[64:67], a[44:47], v[140:143]
  s_waitcnt lgkmcnt(4)
  v_mfma_f32_16x16x32_bf16 v[144:147], a[68:71], a[32:35], v[144:147]
  ds_read_b64_tr_b16 a[64:65], v230 offset:32768
  v_mfma_f32_16x16x32_bf16 v[148:151], a[68:71], a[36:39], v[148:151]
  ds_read_b64_tr_b16 a[66:67], v230 offset:36864
  v_mfma_f32_16x16x32_bf16 v[152:155], a[68:71], a[40:43], v[152:155]
  v_mfma_f32_16x16x32_bf16 v[156:159], a[68:71], a[44:47], v[156:159]
  s_waitcnt lgkmcnt(4)
  v_mfma_f32_16x16x32_bf16 v[160:163], a[72:75], a[32:35], v[160:163]
  ds_read_b64_tr_b16 a[68:69], v230 offset:49152
  v_mfma_f32_16x16x32_bf16 v[164:167], a[72:75], a[36:39], v[164:167]
  ds_read_b64_tr_b16 a[70:71], v230 offset:53248
  v_mfma_f32_16x16x32_bf16 v[168:171], a[72:75], a[40:43], v[168:171]
  buffer_load_dwordx4 a[208:211], v232, s[4:7], s47 offen offset:0
  buffer_load_dwordx4 a[212:215], v232, s[4:7], s48 offen offset:0
  v_mfma_f32_16x16x32_bf16 v[172:175], a[72:75], a[44:47], v[172:175]
  s_waitcnt lgkmcnt(4)
  v_mfma_f32_16x16x32_bf16 v[176:179], a[76:79], a[32:35], v[176:179]
  ds_read_b64_tr_b16 a[72:73], v224 offset:40960
  v_mfma_f32_16x16x32_bf16 v[180:183], a[76:79], a[36:39], v[180:183]
  ds_read_b64_tr_b16 a[74:75], v224 offset:45056
  v_mfma_f32_16x16x32_bf16 v[184:187], a[76:79], a[40:43], v[184:187]
  v_mfma_f32_16x16x32_bf16 v[188:191], a[76:79], a[44:47], v[188:191]
  s_waitcnt lgkmcnt(4)
  v_mfma_f32_16x16x32_bf16 v[192:195], a[64:67], a[32:35], v[192:195]
  ds_read_b64_tr_b16 a[76:77], v224 offset:57344
  v_mfma_f32_16x16x32_bf16 v[196:199], a[64:67], a[36:39], v[196:199]
  ds_read_b64_tr_b16 a[78:79], v224 offset:61440
  v_xor_b32 v224, 0x10000, v224
  v_mfma_f32_16x16x32_bf16 v[200:203], a[64:67], a[40:43], v[200:203]
  v_mfma_f32_16x16x32_bf16 v[204:207], a[64:67], a[44:47], v[204:207]
  s_waitcnt lgkmcnt(4)
  v_mfma_f32_16x16x32_bf16 v[208:211], a[68:71], a[32:35], v[208:211]
  ds_read_b64_tr_b16 a[64:65], v225 offset:40960
  v_mfma_f32_16x16x32_bf16 v[212:215], a[68:71], a[36:39], v[212:215]
  ds_read_b64_tr_b16 a[66:67], v225 offset:45056
  v_mfma_f32_16x16x32_bf16 v[216:219], a[68:71], a[40:43], v[216:219]
  v_mfma_f32_16x16x32_bf16 v[220:223], a[68:71], a[44:47], v[220:223]
  s_waitcnt vmcnt(30) lgkmcnt(4)
  v_mfma_f32_16x16x32_bf16 v[0:3], a[72:75], a[48:51], v[0:3]
  ds_read_b64_tr_b16 a[68:69], v225 offset:57344
  v_mfma_f32_16x16x32_bf16 v[4:7], a[72:75], a[52:55], v[4:7]
  ds_read_b64_tr_b16 a[70:71], v225 offset:61440
  v_xor_b32 v225, 0x10000, v225
  v_mfma_f32_16x16x32_bf16 v[8:11], a[72:75], a[56:59], v[8:11]
  v_mfma_f32_16x16x32_bf16 v[12:15], a[72:75], a[60:63], v[12:15]
  s_waitcnt lgkmcnt(4)
  v_mfma_f32_16x16x32_bf16 v[16:19], a[76:79], a[48:51], v[16:19]
  ds_read_b64_tr_b16 a[72:73], v226 offset:40960
  v_mfma_f32_16x16x32_bf16 v[20:23], a[76:79], a[52:55], v[20:23]
  ds_read_b64_tr_b16 a[74:75], v226 offset:45056
  v_mfma_f32_16x16x32_bf16 v[24:27], a[76:79], a[56:59], v[24:27]
  v_mfma_f32_16x16x32_bf16 v[28:31], a[76:79], a[60:63], v[28:31]
  s_waitcnt lgkmcnt(4)
  v_mfma_f32_16x16x32_bf16 v[32:35], a[64:67], a[48:51], v[32:35]
  ds_read_b64_tr_b16 a[76:77], v226 offset:57344
  v_mfma_f32_16x16x32_bf16 v[36:39], a[64:67], a[52:55], v[36:39]
  ds_read_b64_tr_b16 a[78:79], v226 offset:61440
  v_xor_b32 v226, 0x10000, v226
  v_mfma_f32_16x16x32_bf16 v[40:43], a[64:67], a[56:59], v[40:43]
  v_mfma_f32_16x16x32_bf16 v[44:47], a[64:67], a[60:63], v[44:47]
  s_waitcnt lgkmcnt(4)
  v_mfma_f32_16x16x32_bf16 v[48:51], a[68:71], a[48:51], v[48:51]
  ds_read_b64_tr_b16 a[64:65], v227 offset:40960
  v_mfma_f32_16x16x32_bf16 v[52:55], a[68:71], a[52:55], v[52:55]
  ds_read_b64_tr_b16 a[66:67], v227 offset:45056
  v_mfma_f32_16x16x32_bf16 v[56:59], a[68:71], a[56:59], v[56:59]
  v_mfma_f32_16x16x32_bf16 v[60:63], a[68:71], a[60:63], v[60:63]
  s_waitcnt lgkmcnt(4)
  v_mfma_f32_16x16x32_bf16 v[64:67], a[72:75], a[48:51], v[64:67]
  ds_read_b64_tr_b16 a[68:69], v227 offset:57344
  v_mfma_f32_16x16x32_bf16 v[68:71], a[72:75], a[52:55], v[68:71]
  ds_read_b64_tr_b16 a[70:71], v227 offset:61440
  v_xor_b32 v227, 0x10000, v227
  v_mfma_f32_16x16x32_bf16 v[72:75], a[72:75], a[56:59], v[72:75]
  v_mfma_f32_16x16x32_bf16 v[76:79], a[72:75], a[60:63], v[76:79]
  s_waitcnt lgkmcnt(4)
  v_mfma_f32_16x16x32_bf16 v[80:83], a[76:79], a[48:51], v[80:83]
  ds_read_b64_tr_b16 a[72:73], v228 offset:40960
  v_mfma_f32_16x16x32_bf16 v[84:87], a[76:79], a[52:55], v[84:87]
  ds_read_b64_tr_b16 a[74:75], v228 offset:45056
  v_mfma_f32_16x16x32_bf16 v[88:91], a[76:79], a[56:59], v[88:91]
  v_mfma_f32_16x16x32_bf16 v[92:95], a[76:79], a[60:63], v[92:95]
  s_waitcnt lgkmcnt(4)
  v_mfma_f32_16x16x32_bf16 v[96:99], a[64:67], a[48:51], v[96:99]
  ds_read_b64_tr_b16 a[76:77], v228 offset:57344
  v_mfma_f32_16x16x32_bf16 v[100:103], a[64:67], a[52:55], v[100:103]
  ds_read_b64_tr_b16 a[78:79], v228 offset:61440
  v_xor_b32 v228, 0x10000, v228
  v_mfma_f32_16x16x32_bf16 v[104:107], a[64:67], a[56:59], v[104:107]
  v_mfma_f32_16x16x32_bf16 v[108:111], a[64:67], a[60:63], v[108:111]
  s_waitcnt lgkmcnt(4)
  v_mfma_f32_16x16x32_bf16 v[112:115], a[68:71], a[48:51], v[112:115]
  ds_read_b64_tr_b16 a[64:65], v229 offset:40960
  v_mfma_f32_16x16x32_bf16 v[116:119], a[68:71], a[52:55], v[116:119]
  ds_read_b64_tr_b16 a[66:67], v229 offset:45056
  v_mfma_f32_16x16x32_bf16 v[120:123], a[68:71], a[56:59], v[120:123]
  v_mfma_f32_16x16x32_bf16 v[124:127], a[68:71], a[60:63], v[124:127]
  s_waitcnt lgkmcnt(4)
  v_mfma_f32_16x16x32_bf16 v[128:131], a[72:75], a[48:51], v[128:131]
  ds_read_b64_tr_b16 a[68:69], v229 offset:57344
  v_mfma_f32_16x16x32_bf16 v[132:135], a[72:75], a[52:55], v[132:135]
  ds_read_b64_tr_b16 a[70:71], v229 offset:61440
  v_xor_b32 v229, 0x10000, v229
  v_mfma_f32_16x16x32_bf16 v[136:139], a[72:75], a[56:59], v[136:139]
  v_mfma_f32_16x16x32_bf16 v[140:143], a[72:75], a[60:63], v[140:143]
  s_waitcnt lgkmcnt(4)
  v_mfma_f32_16x16x32_bf16 v[144:147], a[76:79], a[48:51], v[144:147]
  ds_read_b64_tr_b16 a[72:73], v230 offset:40960
  v_mfma_f32_16x16x32_bf16 v[148:151], a[76:79], a[52:55], v[148:151]
  ds_read_b64_tr_b16 a[74:75], v230 offset:45056
  v_mfma_f32_16x16x32_bf16 v[152:155], a[76:79], a[56:59], v[152:155]
  v_mfma_f32_16x16x32_bf16 v[156:159], a[76:79], a[60:63], v[156:159]
  s_waitcnt lgkmcnt(4)
  v_mfma_f32_16x16x32_bf16 v[160:163], a[64:67], a[48:51], v[160:163]
  ds_read_b64_tr_b16 a[76:77], v230 offset:57344
  v_mfma_f32_16x16x32_bf16 v[164:167], a[64:67], a[52:55], v[164:167]
  ds_read_b64_tr_b16 a[78:79], v230 offset:61440
  v_xor_b32 v230, 0x10000, v230
  v_mfma_f32_16x16x32_bf16 v[168:171], a[64:67], a[56:59], v[168:171]
  v_mfma_f32_16x16x32_bf16 v[172:175], a[64:67], a[60:63], v[172:175]
  s_waitcnt lgkmcnt(4)
  v_mfma_f32_16x16x32_bf16 v[176:179], a[68:71], a[48:51], v[176:179]
  v_mfma_f32_16x16x32_bf16 v[180:183], a[68:71], a[52:55], v[180:183]
  v_mfma_f32_16x16x32_bf16 v[184:187], a[68:71], a[56:59], v[184:187]
  v_mfma_f32_16x16x32_bf16 v[188:191], a[68:71], a[60:63], v[188:191]
  s_waitcnt lgkmcnt(2)
  v_mfma_f32_16x16x32_bf16 v[192:195], a[72:75], a[48:51], v[192:195]
  v_mfma_f32_16x16x32_bf16 v[196:199], a[72:75], a[52:55], v[196:199]
  v_mfma_f32_16x16x32_bf16 v[200:203], a[72:75], a[56:59], v[200:203]
  v_mfma_f32_16x16x32_bf16 v[204:207], a[72:75], a[60:63], v[204:207]
  s_waitcnt lgkmcnt(0)
  v_mfma_f32_16x16x32_bf16 v[208:211], a[76:79], a[48:51], v[208:211]
  v_mfma_f32_16x16x32_bf16 v[212:215], a[76:79], a[52:55], v[212:215]
  v_mfma_f32_16x16x32_bf16 v[216:219], a[76:79], a[56:59], v[216:219]
  v_mfma_f32_16x16x32_bf16 v[220:223], a[76:79], a[60:63], v[220:223]
  s_waitcnt vmcnt(0)
  v_accvgpr_read_b32 v224, a128
  v_accvgpr_read_b32 v225, a129
  v_accvgpr_read_b32 v226, a130
  v_accvgpr_read_b32 v227, a131
  v_accvgpr_read_b32 v228, a132
  v_accvgpr_read_b32 v229, a133
  v_accvgpr_read_b32 v230, a134
  v_accvgpr_read_b32 v231, a135
  v_add_f32 v224, v224, v226
  v_add_f32 v225, v225, v227
  v_add_f32 v228, v228, v230
  v_add_f32 v229, v229, v231
  v_add_f32 v240, v224, v228
  v_add_f32 v248, v225, v229
  v_accvgpr_read_b32 v224, a136
  v_accvgpr_read_b32 v225, a137
  v_accvgpr_read_b32 v226, a138
  v_accvgpr_read_b32 v227, a139
  v_accvgpr_read_b32 v228, a140
  v_accvgpr_read_b32 v229, a141
  v_accvgpr_read_b32 v230, a142
  v_accvgpr_read_b32 v231, a143
  v_add_f32 v224, v224, v226
  v_add_f32 v225, v225, v227
  v_add_f32 v228, v228, v230
  v_add_f32 v229, v229, v231
  v_add_f32 v241, v224, v228
  v_add_f32 v249, v225, v229
  v_accvgpr_read_b32 v224, a144
  v_accvgpr_read_b32 v225, a145
  v_accvgpr_read_b32 v226, a146
  v_accvgpr_read_b32 v227, a147
  v_accvgpr_read_b32 v228, a148
  v_accvgpr_read_b32 v229, a149
  v_accvgpr_read_b32 v230, a150
  v_accvgpr_read_b32 v231, a151
  v_add_f32 v224, v224, v226
  v_add_f32 v225, v225, v227
  v_add_f32 v228, v228, v230
  v_add_f32 v229, v229, v231
  v_add_f32 v242, v224, v228
  v_add_f32 v250, v225, v229
  v_accvgpr_read_b32 v224, a152
  v_accvgpr_read_b32 v225, a153
  v_accvgpr_read_b32 v226, a154
  v_accvgpr_read_b32 v227, a155
  v_accvgpr_read_b32 v228, a156
  v_accvgpr_read_b32 v229, a157
  v_accvgpr_read_b32 v230, a158
  v_accvgpr_read_b32 v231, a159
  v_add_f32 v224, v224, v226
  v_add_f32 v225, v225, v227
  v_add_f32 v228, v228, v230
  v_add_f32 v229, v229, v231
  v_add_f32 v243, v224, v228
  v_add_f32 v251, v225, v229
  v_mov_b32 v224, v240
  v_mov_b32 v225, v241
  v_mov_b32 v226, v242
  v_mov_b32 v227, v243
  v_mov_b32 v228, v248
  v_mov_b32 v229, v249
  v_mov_b32 v230, v250
  v_mov_b32 v231, v251
  v_permlane32_swap_b32 v240, v224
  v_permlane32_swap_b32 v241, v225
  v_permlane32_swap_b32 v242, v226
  v_permlane32_swap_b32 v243, v227
  v_permlane32_swap_b32 v248, v228
  v_permlane32_swap_b32 v249, v229
  v_permlane32_swap_b32 v250, v230
  v_permlane32_swap_b32 v251, v231
  v_add_f32 v240, v240, v224
  v_add_f32 v241, v241, v225
  v_add_f32 v242, v242, v226
  v_add_f32 v243, v243, v227
  v_add_f32 v248, v248, v228
  v_add_f32 v249, v249, v229
  v_add_f32 v250, v250, v230
  v_add_f32 v251, v251, v231
  v_mov_b32 v224, v240
  v_mov_b32 v225, v241
  v_mov_b32 v226, v242
  v_mov_b32 v227, v243
  v_mov_b32 v228, v248
  v_mov_b32 v229, v249
  v_mov_b32 v230, v250
  v_mov_b32 v231, v251
  v_permlane16_swap_b32 v240, v224
  v_permlane16_swap_b32 v241, v225
  v_permlane16_swap_b32 v242, v226
  v_permlane16_swap_b32 v243, v227
  v_permlane16_swap_b32 v248, v228
  v_permlane16_swap_b32 v249, v229
  v_permlane16_swap_b32 v250, v230
  v_permlane16_swap_b32 v251, v231
  v_add_f32 v240, v240, v224
  v_add_f32 v241, v241, v225
  v_add_f32 v242, v242, v226
  v_add_f32 v243, v243, v227
  v_add_f32 v248, v248, v228
  v_add_f32 v249, v249, v229
  v_add_f32 v250, v250, v230
  v_add_f32 v251, v251, v231
  s_mov_b32 s43, 0x3a800000
  v_mov_b32 v224, 0x3727c5ac
  v_mul_f32 v240, 0xba800000, v240
  v_fma_f32 v248, v248, s43, v224
  v_fma_f32 v248, -v240, v240, v248
  v_max_f32 v248, v248, v224
  v_rsq_f32 v244, v248
  v_mul_f32 v241, 0xba800000, v241
  v_fma_f32 v249, v249, s43, v224
  v_fma_f32 v249, -v241, v241, v249
  v_max_f32 v249, v249, v224
  v_rsq_f32 v245, v249
  v_mul_f32 v242, 0xba800000, v242
  v_fma_f32 v250, v250, s43, v224
  v_fma_f32 v250, -v242, v242, v250
  v_max_f32 v250, v250, v224
  v_rsq_f32 v246, v250
  v_mul_f32 v243, 0xba800000, v243
  v_fma_f32 v251, v251, s43, v224
  v_fma_f32 v251, -v243, v243, v251
  v_max_f32 v251, v251, v224
  v_rsq_f32 v247, v251
  s_nop 0
  v_mul_f32 v244, 0xbfb8aa3b, v244
  v_mul_f32 v245, 0xbfb8aa3b, v245
  v_mul_f32 v246, 0xbfb8aa3b, v246
  v_mul_f32 v247, 0xbfb8aa3b, v247
  v_lshlrev_b32 v252, 4, v239
  v_and_b32 v253, 31, v239
  v_lshlrev_b32 v253, 4, v253
  v_lshrrev_b32 v224, 5, v239
  s_mov_b32 s43, 114688
  v_mad_u32_u24 v253, v224, s43, v253
  s_mul_i32 s43, s44, 458752
  s_lshr_b32 s45, s26, 1
  s_mul_i32 s45, s45, 7168
  s_add_u32 s43, s43, s45
  s_add_u32 s43, s43, 20971520
  s_lshl_b32 s45, s27, 12
  s_add_u32 s50, s43, s45
  s_lshl_b32 s45, s27, 9
  s_add_u32 s54, s43, s45
  s_add_u32 s54, s54, 3072
  s_add_u32 s55, s54, 229376
  s_add_u32 s51, s50, 114688
  s_add_u32 s52, s51, 114688
  s_add_u32 s53, s52, 114688
  v_accvgpr_read_b32 v224, a160
  v_accvgpr_read_b32 v225, a161
  v_accvgpr_read_b32 v226, a162
  v_accvgpr_read_b32 v227, a163
  v_accvgpr_read_b32 v228, a164
  v_accvgpr_read_b32 v229, a165
  v_accvgpr_read_b32 v230, a166
  v_accvgpr_read_b32 v231, a167
  v_pk_fma_f32 v[0:1], v[224:225], v[240:241], v[0:1] op_sel:[0,0,0] op_sel_hi:[1,0,1]
  v_pk_fma_f32 v[16:17], v[228:229], v[240:241], v[16:17] op_sel:[0,0,0] op_sel_hi:[1,0,1]
  v_pk_fma_f32 v[2:3], v[226:227], v[240:241], v[2:3] op_sel:[0,0,0] op_sel_hi:[1,0,1]
  v_pk_fma_f32 v[18:19], v[230:231], v[240:241], v[18:19] op_sel:[0,0,0] op_sel_hi:[1,0,1]
  v_pk_mul_f32 v[232:233], v[0:1], v[244:245] op_sel:[0,0] op_sel_hi:[1,0]
  v_pk_mul_f32 v[234:235], v[2:3], v[244:245] op_sel:[0,0] op_sel_hi:[1,0]
  v_exp_f32 v232, v232
  v_exp_f32 v233, v233
  v_exp_f32 v234, v234
  v_exp_f32 v235, v235
  v_pk_mul_f32 v[0:1], v[0:1], v[16:17]
  v_pk_mul_f32 v[2:3], v[2:3], v[18:19]
  v_pk_fma_f32 v[232:233], v[232:233], v[248:249], v[248:249] op_sel:[0,0,0] op_sel_hi:[1,0,0]
  v_pk_fma_f32 v[234:235], v[234:235], v[248:249], v[248:249] op_sel:[0,0,0] op_sel_hi:[1,0,0]
  v_rcp_f32 v232, v232
  v_rcp_f32 v233, v233
  v_rcp_f32 v234, v234
  v_rcp_f32 v235, v235
  s_nop 0
  v_pk_mul_f32 v[0:1], v[0:1], v[232:233]
  v_pk_mul_f32 v[2:3], v[2:3], v[234:235]
  v_cvt_pk_bf16_f32 v16, v0, v1
  v_cvt_pk_bf16_f32 v17, v2, v3
  v_pk_fma_f32 v[4:5], v[224:225], v[240:241], v[4:5] op_sel:[0,1,0] op_sel_hi:[1,1,1]
  v_pk_fma_f32 v[20:21], v[228:229], v[240:241], v[20:21] op_sel:[0,1,0] op_sel_hi:[1,1,1]
  v_pk_fma_f32 v[6:7], v[226:227], v[240:241], v[6:7] op_sel:[0,1,0] op_sel_hi:[1,1,1]
  v_pk_fma_f32 v[22:23], v[230:231], v[240:241], v[22:23] op_sel:[0,1,0] op_sel_hi:[1,1,1]
  v_pk_mul_f32 v[232:233], v[4:5], v[244:245] op_sel:[0,1] op_sel_hi:[1,1]
  v_pk_mul_f32 v[234:235], v[6:7], v[244:245] op_sel:[0,1] op_sel_hi:[1,1]
  v_exp_f32 v232, v232
  v_exp_f32 v233, v233
  v_exp_f32 v234, v234
  v_exp_f32 v235, v235
  v_pk_mul_f32 v[4:5], v[4:5], v[20:21]
  v_pk_mul_f32 v[6:7], v[6:7], v[22:23]
  v_pk_fma_f32 v[232:233], v[232:233], v[248:249], v[248:249] op_sel:[0,1,1] op_sel_hi:[1,1,1]
  v_pk_fma_f32 v[234:235], v[234:235], v[248:249], v[248:249] op_sel:[0,1,1] op_sel_hi:[1,1,1]
  v_rcp_f32 v232, v232
  v_rcp_f32 v233, v233
  v_rcp_f32 v234, v234
  v_rcp_f32 v235, v235
  s_nop 0
  v_pk_mul_f32 v[4:5], v[4:5], v[232:233]
  v_pk_mul_f32 v[6:7], v[6:7], v[234:235]
  v_cvt_pk_bf16_f32 v20, v4, v5
  v_cvt_pk_bf16_f32 v21, v6, v7
  v_pk_fma_f32 v[8:9], v[224:225], v[242:243], v[8:9] op_sel:[0,0,0] op_sel_hi:[1,0,1]
  v_pk_fma_f32 v[24:25], v[228:229], v[242:243], v[24:25] op_sel:[0,0,0] op_sel_hi:[1,0,1]
  v_pk_fma_f32 v[10:11], v[226:227], v[242:243], v[10:11] op_sel:[0,0,0] op_sel_hi:[1,0,1]
  v_pk_fma_f32 v[26:27], v[230:231], v[242:243], v[26:27] op_sel:[0,0,0] op_sel_hi:[1,0,1]
  v_pk_mul_f32 v[232:233], v[8:9], v[246:247] op_sel:[0,0] op_sel_hi:[1,0]
  v_pk_mul_f32 v[234:235], v[10:11], v[246:247] op_sel:[0,0] op_sel_hi:[1,0]
  v_exp_f32 v232, v232
  v_exp_f32 v233, v233
  v_exp_f32 v234, v234
  v_exp_f32 v235, v235
  v_pk_mul_f32 v[8:9], v[8:9], v[24:25]
  v_pk_mul_f32 v[10:11], v[10:11], v[26:27]
  v_pk_fma_f32 v[232:233], v[232:233], v[250:251], v[250:251] op_sel:[0,0,0] op_sel_hi:[1,0,0]
  v_pk_fma_f32 v[234:235], v[234:235], v[250:251], v[250:251] op_sel:[0,0,0] op_sel_hi:[1,0,0]
  v_rcp_f32 v232, v232
  v_rcp_f32 v233, v233
  v_rcp_f32 v234, v234
  v_rcp_f32 v235, v235
  s_nop 0
  v_pk_mul_f32 v[8:9], v[8:9], v[232:233]
  v_pk_mul_f32 v[10:11], v[10:11], v[234:235]
  v_cvt_pk_bf16_f32 v24, v8, v9
  v_cvt_pk_bf16_f32 v25, v10, v11
  v_pk_fma_f32 v[12:13], v[224:225], v[242:243], v[12:13] op_sel:[0,1,0] op_sel_hi:[1,1,1]
  v_pk_fma_f32 v[28:29], v[228:229], v[242:243], v[28:29] op_sel:[0,1,0] op_sel_hi:[1,1,1]
  v_pk_fma_f32 v[14:15], v[226:227], v[242:243], v[14:15] op_sel:[0,1,0] op_sel_hi:[1,1,1]
  v_pk_fma_f32 v[30:31], v[230:231], v[242:243], v[30:31] op_sel:[0,1,0] op_sel_hi:[1,1,1]
  v_pk_mul_f32 v[232:233], v[12:13], v[246:247] op_sel:[0,1] op_sel_hi:[1,1]
  v_pk_mul_f32 v[234:235], v[14:15], v[246:247] op_sel:[0,1] op_sel_hi:[1,1]
  v_exp_f32 v232, v232
  v_exp_f32 v233, v233
  v_exp_f32 v234, v234
  v_exp_f32 v235, v235
  v_pk_mul_f32 v[12:13], v[12:13], v[28:29]
  v_pk_mul_f32 v[14:15], v[14:15], v[30:31]
  v_pk_fma_f32 v[232:233], v[232:233], v[250:251], v[250:251] op_sel:[0,1,1] op_sel_hi:[1,1,1]
  v_pk_fma_f32 v[234:235], v[234:235], v[250:251], v[250:251] op_sel:[0,1,1] op_sel_hi:[1,1,1]
  v_rcp_f32 v232, v232
  v_rcp_f32 v233, v233
  v_rcp_f32 v234, v234
  v_rcp_f32 v235, v235
  s_nop 0
  v_pk_mul_f32 v[12:13], v[12:13], v[232:233]
  v_pk_mul_f32 v[14:15], v[14:15], v[234:235]
  v_cvt_pk_bf16_f32 v28, v12, v13
  v_cvt_pk_bf16_f32 v29, v14, v15
  v_accvgpr_read_b32 v224, a168
  v_accvgpr_read_b32 v225, a169
  v_accvgpr_read_b32 v226, a170
  v_accvgpr_read_b32 v227, a171
  v_accvgpr_read_b32 v228, a172
  v_accvgpr_read_b32 v229, a173
  v_accvgpr_read_b32 v230, a174
  v_accvgpr_read_b32 v231, a175
  v_pk_fma_f32 v[32:33], v[224:225], v[240:241], v[32:33] op_sel:[0,0,0] op_sel_hi:[1,0,1]
  v_pk_fma_f32 v[48:49], v[228:229], v[240:241], v[48:49] op_sel:[0,0,0] op_sel_hi:[1,0,1]
  v_pk_fma_f32 v[34:35], v[226:227], v[240:241], v[34:35] op_sel:[0,0,0] op_sel_hi:[1,0,1]
  v_pk_fma_f32 v[50:51], v[230:231], v[240:241], v[50:51] op_sel:[0,0,0] op_sel_hi:[1,0,1]
  v_pk_mul_f32 v[232:233], v[32:33], v[244:245] op_sel:[0,0] op_sel_hi:[1,0]
  v_pk_mul_f32 v[234:235], v[34:35], v[244:245] op_sel:[0,0] op_sel_hi:[1,0]
  v_exp_f32 v232, v232
  v_exp_f32 v233, v233
  v_exp_f32 v234, v234
  v_exp_f32 v235, v235
  v_pk_mul_f32 v[32:33], v[32:33], v[48:49]
  v_pk_mul_f32 v[34:35], v[34:35], v[50:51]
  v_pk_fma_f32 v[232:233], v[232:233], v[248:249], v[248:249] op_sel:[0,0,0] op_sel_hi:[1,0,0]
  v_pk_fma_f32 v[234:235], v[234:235], v[248:249], v[248:249] op_sel:[0,0,0] op_sel_hi:[1,0,0]
  v_rcp_f32 v232, v232
  v_rcp_f32 v233, v233
  v_rcp_f32 v234, v234
  v_rcp_f32 v235, v235
  s_nop 0
  v_pk_mul_f32 v[32:33], v[32:33], v[232:233]
  v_pk_mul_f32 v[34:35], v[34:35], v[234:235]
  v_cvt_pk_bf16_f32 v18, v32, v33
  v_cvt_pk_bf16_f32 v19, v34, v35
  buffer_store_dwordx4 v[16:19], v252, s[4:7], s50 offen offset:0
  v_pk_fma_f32 v[36:37], v[224:225], v[240:241], v[36:37] op_sel:[0,1,0] op_sel_hi:[1,1,1]
  v_pk_fma_f32 v[52:53], v[228:229], v[240:241], v[52:53] op_sel:[0,1,0] op_sel_hi:[1,1,1]
  v_pk_fma_f32 v[38:39], v[226:227], v[240:241], v[38:39] op_sel:[0,1,0] op_sel_hi:[1,1,1]
  v_pk_fma_f32 v[54:55], v[230:231], v[240:241], v[54:55] op_sel:[0,1,0] op_sel_hi:[1,1,1]
  v_pk_mul_f32 v[232:233], v[36:37], v[244:245] op_sel:[0,1] op_sel_hi:[1,1]
  v_pk_mul_f32 v[234:235], v[38:39], v[244:245] op_sel:[0,1] op_sel_hi:[1,1]
  v_exp_f32 v232, v232
  v_exp_f32 v233, v233
  v_exp_f32 v234, v234
  v_exp_f32 v235, v235
  v_pk_mul_f32 v[36:37], v[36:37], v[52:53]
  v_pk_mul_f32 v[38:39], v[38:39], v[54:55]
  v_pk_fma_f32 v[232:233], v[232:233], v[248:249], v[248:249] op_sel:[0,1,1] op_sel_hi:[1,1,1]
  v_pk_fma_f32 v[234:235], v[234:235], v[248:249], v[248:249] op_sel:[0,1,1] op_sel_hi:[1,1,1]
  v_rcp_f32 v232, v232
  v_rcp_f32 v233, v233
  v_rcp_f32 v234, v234
  v_rcp_f32 v235, v235
  s_nop 0
  v_pk_mul_f32 v[36:37], v[36:37], v[232:233]
  v_pk_mul_f32 v[38:39], v[38:39], v[234:235]
  v_cvt_pk_bf16_f32 v22, v36, v37
  v_cvt_pk_bf16_f32 v23, v38, v39
  buffer_store_dwordx4 v[20:23], v252, s[4:7], s51 offen offset:0
  v_pk_fma_f32 v[40:41], v[224:225], v[242:243], v[40:41] op_sel:[0,0,0] op_sel_hi:[1,0,1]
  v_pk_fma_f32 v[56:57], v[228:229], v[242:243], v[56:57] op_sel:[0,0,0] op_sel_hi:[1,0,1]
  v_pk_fma_f32 v[42:43], v[226:227], v[242:243], v[42:43] op_sel:[0,0,0] op_sel_hi:[1,0,1]
  v_pk_fma_f32 v[58:59], v[230:231], v[242:243], v[58:59] op_sel:[0,0,0] op_sel_hi:[1,0,1]
  v_pk_mul_f32 v[232:233], v[40:41], v[246:247] op_sel:[0,0] op_sel_hi:[1,0]
  v_pk_mul_f32 v[234:235], v[42:43], v[246:247] op_sel:[0,0] op_sel_hi:[1,0]
  v_exp_f32 v232, v232
  v_exp_f32 v233, v233
  v_exp_f32 v234, v234
  v_exp_f32 v235, v235
  v_pk_mul_f32 v[40:41], v[40:41], v[56:57]
  v_pk_mul_f32 v[42:43], v[42:43], v[58:59]
  v_pk_fma_f32 v[232:233], v[232:233], v[250:251], v[250:251] op_sel:[0,0,0] op_sel_hi:[1,0,0]
  v_pk_fma_f32 v[234:235], v[234:235], v[250:251], v[250:251] op_sel:[0,0,0] op_sel_hi:[1,0,0]
  v_rcp_f32 v232, v232
  v_rcp_f32 v233, v233
  v_rcp_f32 v234, v234
  v_rcp_f32 v235, v235
  s_nop 0
  v_pk_mul_f32 v[40:41], v[40:41], v[232:233]
  v_pk_mul_f32 v[42:43], v[42:43], v[234:235]
  v_cvt_pk_bf16_f32 v26, v40, v41
  v_cvt_pk_bf16_f32 v27, v42, v43
  buffer_store_dwordx4 v[24:27], v252, s[4:7], s52 offen offset:0
  v_pk_fma_f32 v[44:45], v[224:225], v[242:243], v[44:45] op_sel:[0,1,0] op_sel_hi:[1,1,1]
  v_pk_fma_f32 v[60:61], v[228:229], v[242:243], v[60:61] op_sel:[0,1,0] op_sel_hi:[1,1,1]
  v_pk_fma_f32 v[46:47], v[226:227], v[242:243], v[46:47] op_sel:[0,1,0] op_sel_hi:[1,1,1]
  v_pk_fma_f32 v[62:63], v[230:231], v[242:243], v[62:63] op_sel:[0,1,0] op_sel_hi:[1,1,1]
  v_pk_mul_f32 v[232:233], v[44:45], v[246:247] op_sel:[0,1] op_sel_hi:[1,1]
  v_pk_mul_f32 v[234:235], v[46:47], v[246:247] op_sel:[0,1] op_sel_hi:[1,1]
  v_exp_f32 v232, v232
  v_exp_f32 v233, v233
  v_exp_f32 v234, v234
  v_exp_f32 v235, v235
  v_pk_mul_f32 v[44:45], v[44:45], v[60:61]
  v_pk_mul_f32 v[46:47], v[46:47], v[62:63]
  v_pk_fma_f32 v[232:233], v[232:233], v[250:251], v[250:251] op_sel:[0,1,1] op_sel_hi:[1,1,1]
  v_pk_fma_f32 v[234:235], v[234:235], v[250:251], v[250:251] op_sel:[0,1,1] op_sel_hi:[1,1,1]
  v_rcp_f32 v232, v232
  v_rcp_f32 v233, v233
  v_rcp_f32 v234, v234
  v_rcp_f32 v235, v235
  s_nop 0
  v_pk_mul_f32 v[44:45], v[44:45], v[232:233]
  v_pk_mul_f32 v[46:47], v[46:47], v[234:235]
  v_cvt_pk_bf16_f32 v30, v44, v45
  v_cvt_pk_bf16_f32 v31, v46, v47
  buffer_store_dwordx4 v[28:31], v252, s[4:7], s53 offen offset:0
  v_accvgpr_read_b32 v224, a176
  v_accvgpr_read_b32 v225, a177
  v_accvgpr_read_b32 v226, a178
  v_accvgpr_read_b32 v227, a179
  v_accvgpr_read_b32 v228, a180
  v_accvgpr_read_b32 v229, a181
  v_accvgpr_read_b32 v230, a182
  v_accvgpr_read_b32 v231, a183
  v_pk_fma_f32 v[64:65], v[224:225], v[240:241], v[64:65] op_sel:[0,0,0] op_sel_hi:[1,0,1]
  v_pk_fma_f32 v[80:81], v[228:229], v[240:241], v[80:81] op_sel:[0,0,0] op_sel_hi:[1,0,1]
  v_pk_fma_f32 v[66:67], v[226:227], v[240:241], v[66:67] op_sel:[0,0,0] op_sel_hi:[1,0,1]
  v_pk_fma_f32 v[82:83], v[230:231], v[240:241], v[82:83] op_sel:[0,0,0] op_sel_hi:[1,0,1]
  v_pk_mul_f32 v[232:233], v[64:65], v[244:245] op_sel:[0,0] op_sel_hi:[1,0]
  v_pk_mul_f32 v[234:235], v[66:67], v[244:245] op_sel:[0,0] op_sel_hi:[1,0]
  v_exp_f32 v232, v232
  v_exp_f32 v233, v233
  v_exp_f32 v234, v234
  v_exp_f32 v235, v235
  v_pk_mul_f32 v[64:65], v[64:65], v[80:81]
  v_pk_mul_f32 v[66:67], v[66:67], v[82:83]
  v_pk_fma_f32 v[232:233], v[232:233], v[248:249], v[248:249] op_sel:[0,0,0] op_sel_hi:[1,0,0]
  v_pk_fma_f32 v[234:235], v[234:235], v[248:249], v[248:249] op_sel:[0,0,0] op_sel_hi:[1,0,0]
  v_rcp_f32 v232, v232
  v_rcp_f32 v233, v233
  v_rcp_f32 v234, v234
  v_rcp_f32 v235, v235
  s_nop 0
  v_pk_mul_f32 v[64:65], v[64:65], v[232:233]
  v_pk_mul_f32 v[66:67], v[66:67], v[234:235]
  v_cvt_pk_bf16_f32 v80, v64, v65
  v_cvt_pk_bf16_f32 v81, v66, v67
  v_pk_fma_f32 v[68:69], v[224:225], v[240:241], v[68:69] op_sel:[0,1,0] op_sel_hi:[1,1,1]
  v_pk_fma_f32 v[84:85], v[228:229], v[240:241], v[84:85] op_sel:[0,1,0] op_sel_hi:[1,1,1]
  v_pk_fma_f32 v[70:71], v[226:227], v[240:241], v[70:71] op_sel:[0,1,0] op_sel_hi:[1,1,1]
  v_pk_fma_f32 v[86:87], v[230:231], v[240:241], v[86:87] op_sel:[0,1,0] op_sel_hi:[1,1,1]
  v_pk_mul_f32 v[232:233], v[68:69], v[244:245] op_sel:[0,1] op_sel_hi:[1,1]
  v_pk_mul_f32 v[234:235], v[70:71], v[244:245] op_sel:[0,1] op_sel_hi:[1,1]
  v_exp_f32 v232, v232
  v_exp_f32 v233, v233
  v_exp_f32 v234, v234
  v_exp_f32 v235, v235
  v_pk_mul_f32 v[68:69], v[68:69], v[84:85]
  v_pk_mul_f32 v[70:71], v[70:71], v[86:87]
  v_pk_fma_f32 v[232:233], v[232:233], v[248:249], v[248:249] op_sel:[0,1,1] op_sel_hi:[1,1,1]
  v_pk_fma_f32 v[234:235], v[234:235], v[248:249], v[248:249] op_sel:[0,1,1] op_sel_hi:[1,1,1]
  v_rcp_f32 v232, v232
  v_rcp_f32 v233, v233
  v_rcp_f32 v234, v234
  v_rcp_f32 v235, v235
  s_nop 0
  v_pk_mul_f32 v[68:69], v[68:69], v[232:233]
  v_pk_mul_f32 v[70:71], v[70:71], v[234:235]
  v_cvt_pk_bf16_f32 v84, v68, v69
  v_cvt_pk_bf16_f32 v85, v70, v71
  v_pk_fma_f32 v[72:73], v[224:225], v[242:243], v[72:73] op_sel:[0,0,0] op_sel_hi:[1,0,1]
  v_pk_fma_f32 v[88:89], v[228:229], v[242:243], v[88:89] op_sel:[0,0,0] op_sel_hi:[1,0,1]
  v_pk_fma_f32 v[74:75], v[226:227], v[242:243], v[74:75] op_sel:[0,0,0] op_sel_hi:[1,0,1]
  v_pk_fma_f32 v[90:91], v[230:231], v[242:243], v[90:91] op_sel:[0,0,0] op_sel_hi:[1,0,1]
  v_pk_mul_f32 v[232:233], v[72:73], v[246:247] op_sel:[0,0] op_sel_hi:[1,0]
  v_pk_mul_f32 v[234:235], v[74:75], v[246:247] op_sel:[0,0] op_sel_hi:[1,0]
  v_exp_f32 v232, v232
  v_exp_f32 v233, v233
  v_exp_f32 v234, v234
  v_exp_f32 v235, v235
  v_pk_mul_f32 v[72:73], v[72:73], v[88:89]
  v_pk_mul_f32 v[74:75], v[74:75], v[90:91]
  v_pk_fma_f32 v[232:233], v[232:233], v[250:251], v[250:251] op_sel:[0,0,0] op_sel_hi:[1,0,0]
  v_pk_fma_f32 v[234:235], v[234:235], v[250:251], v[250:251] op_sel:[0,0,0] op_sel_hi:[1,0,0]
  v_rcp_f32 v232, v232
  v_rcp_f32 v233, v233
  v_rcp_f32 v234, v234
  v_rcp_f32 v235, v235
  s_nop 0
  v_pk_mul_f32 v[72:73], v[72:73], v[232:233]
  v_pk_mul_f32 v[74:75], v[74:75], v[234:235]
  v_cvt_pk_bf16_f32 v88, v72, v73
  v_cvt_pk_bf16_f32 v89, v74, v75
  v_pk_fma_f32 v[76:77], v[224:225], v[242:243], v[76:77] op_sel:[0,1,0] op_sel_hi:[1,1,1]
  v_pk_fma_f32 v[92:93], v[228:229], v[242:243], v[92:93] op_sel:[0,1,0] op_sel_hi:[1,1,1]
  v_pk_fma_f32 v[78:79], v[226:227], v[242:243], v[78:79] op_sel:[0,1,0] op_sel_hi:[1,1,1]
  v_pk_fma_f32 v[94:95], v[230:231], v[242:243], v[94:95] op_sel:[0,1,0] op_sel_hi:[1,1,1]
  v_pk_mul_f32 v[232:233], v[76:77], v[246:247] op_sel:[0,1] op_sel_hi:[1,1]
  v_pk_mul_f32 v[234:235], v[78:79], v[246:247] op_sel:[0,1] op_sel_hi:[1,1]
  v_exp_f32 v232, v232
  v_exp_f32 v233, v233
  v_exp_f32 v234, v234
  v_exp_f32 v235, v235
  v_pk_mul_f32 v[76:77], v[76:77], v[92:93]
  v_pk_mul_f32 v[78:79], v[78:79], v[94:95]
  v_pk_fma_f32 v[232:233], v[232:233], v[250:251], v[250:251] op_sel:[0,1,1] op_sel_hi:[1,1,1]
  v_pk_fma_f32 v[234:235], v[234:235], v[250:251], v[250:251] op_sel:[0,1,1] op_sel_hi:[1,1,1]
  v_rcp_f32 v232, v232
  v_rcp_f32 v233, v233
  v_rcp_f32 v234, v234
  v_rcp_f32 v235, v235
  s_nop 0
  v_pk_mul_f32 v[76:77], v[76:77], v[232:233]
  v_pk_mul_f32 v[78:79], v[78:79], v[234:235]
  v_cvt_pk_bf16_f32 v92, v76, v77
  v_cvt_pk_bf16_f32 v93, v78, v79
  v_accvgpr_read_b32 v224, a184
  v_accvgpr_read_b32 v225, a185
  v_accvgpr_read_b32 v226, a186
  v_accvgpr_read_b32 v227, a187
  v_accvgpr_read_b32 v228, a188
  v_accvgpr_read_b32 v229, a189
  v_accvgpr_read_b32 v230, a190
  v_accvgpr_read_b32 v231, a191
  v_pk_fma_f32 v[96:97], v[224:225], v[240:241], v[96:97] op_sel:[0,0,0] op_sel_hi:[1,0,1]
  v_pk_fma_f32 v[112:113], v[228:229], v[240:241], v[112:113] op_sel:[0,0,0] op_sel_hi:[1,0,1]
  v_pk_fma_f32 v[98:99], v[226:227], v[240:241], v[98:99] op_sel:[0,0,0] op_sel_hi:[1,0,1]
  v_pk_fma_f32 v[114:115], v[230:231], v[240:241], v[114:115] op_sel:[0,0,0] op_sel_hi:[1,0,1]
  v_pk_mul_f32 v[232:233], v[96:97], v[244:245] op_sel:[0,0] op_sel_hi:[1,0]
  v_pk_mul_f32 v[234:235], v[98:99], v[244:245] op_sel:[0,0] op_sel_hi:[1,0]
  v_exp_f32 v232, v232
  v_exp_f32 v233, v233
  v_exp_f32 v234, v234
  v_exp_f32 v235, v235
  v_pk_mul_f32 v[96:97], v[96:97], v[112:113]
  v_pk_mul_f32 v[98:99], v[98:99], v[114:115]
  v_pk_fma_f32 v[232:233], v[232:233], v[248:249], v[248:249] op_sel:[0,0,0] op_sel_hi:[1,0,0]
  v_pk_fma_f32 v[234:235], v[234:235], v[248:249], v[248:249] op_sel:[0,0,0] op_sel_hi:[1,0,0]
  v_rcp_f32 v232, v232
  v_rcp_f32 v233, v233
  v_rcp_f32 v234, v234
  v_rcp_f32 v235, v235
  s_nop 0
  v_pk_mul_f32 v[96:97], v[96:97], v[232:233]
  v_pk_mul_f32 v[98:99], v[98:99], v[234:235]
  v_cvt_pk_bf16_f32 v82, v96, v97
  v_cvt_pk_bf16_f32 v83, v98, v99
  buffer_store_dwordx4 v[80:83], v252, s[4:7], s50 offen offset:1024
  v_pk_fma_f32 v[100:101], v[224:225], v[240:241], v[100:101] op_sel:[0,1,0] op_sel_hi:[1,1,1]
  v_pk_fma_f32 v[116:117], v[228:229], v[240:241], v[116:117] op_sel:[0,1,0] op_sel_hi:[1,1,1]
  v_pk_fma_f32 v[102:103], v[226:227], v[240:241], v[102:103] op_sel:[0,1,0] op_sel_hi:[1,1,1]
  v_pk_fma_f32 v[118:119], v[230:231], v[240:241], v[118:119] op_sel:[0,1,0] op_sel_hi:[1,1,1]
  v_pk_mul_f32 v[232:233], v[100:101], v[244:245] op_sel:[0,1] op_sel_hi:[1,1]
  v_pk_mul_f32 v[234:235], v[102:103], v[244:245] op_sel:[0,1] op_sel_hi:[1,1]
  v_exp_f32 v232, v232
  v_exp_f32 v233, v233
  v_exp_f32 v234, v234
  v_exp_f32 v235, v235
  v_pk_mul_f32 v[100:101], v[100:101], v[116:117]
  v_pk_mul_f32 v[102:103], v[102:103], v[118:119]
  v_pk_fma_f32 v[232:233], v[232:233], v[248:249], v[248:249] op_sel:[0,1,1] op_sel_hi:[1,1,1]
  v_pk_fma_f32 v[234:235], v[234:235], v[248:249], v[248:249] op_sel:[0,1,1] op_sel_hi:[1,1,1]
  v_rcp_f32 v232, v232
  v_rcp_f32 v233, v233
  v_rcp_f32 v234, v234
  v_rcp_f32 v235, v235
  s_nop 0
  v_pk_mul_f32 v[100:101], v[100:101], v[232:233]
  v_pk_mul_f32 v[102:103], v[102:103], v[234:235]
  v_cvt_pk_bf16_f32 v86, v100, v101
  v_cvt_pk_bf16_f32 v87, v102, v103
  buffer_store_dwordx4 v[84:87], v252, s[4:7], s51 offen offset:1024
  v_pk_fma_f32 v[104:105], v[224:225], v[242:243], v[104:105] op_sel:[0,0,0] op_sel_hi:[1,0,1]
  v_pk_fma_f32 v[120:121], v[228:229], v[242:243], v[120:121] op_sel:[0,0,0] op_sel_hi:[1,0,1]
  v_pk_fma_f32 v[106:107], v[226:227], v[242:243], v[106:107] op_sel:[0,0,0] op_sel_hi:[1,0,1]
  v_pk_fma_f32 v[122:123], v[230:231], v[242:243], v[122:123] op_sel:[0,0,0] op_sel_hi:[1,0,1]
  v_pk_mul_f32 v[232:233], v[104:105], v[246:247] op_sel:[0,0] op_sel_hi:[1,0]
  v_pk_mul_f32 v[234:235], v[106:107], v[246:247] op_sel:[0,0] op_sel_hi:[1,0]
  v_exp_f32 v232, v232
  v_exp_f32 v233, v233
  v_exp_f32 v234, v234
  v_exp_f32 v235, v235
  v_pk_mul_f32 v[104:105], v[104:105], v[120:121]
  v_pk_mul_f32 v[106:107], v[106:107], v[122:123]
  v_pk_fma_f32 v[232:233], v[232:233], v[250:251], v[250:251] op_sel:[0,0,0] op_sel_hi:[1,0,0]
  v_pk_fma_f32 v[234:235], v[234:235], v[250:251], v[250:251] op_sel:[0,0,0] op_sel_hi:[1,0,0]
  v_rcp_f32 v232, v232
  v_rcp_f32 v233, v233
  v_rcp_f32 v234, v234
  v_rcp_f32 v235, v235
  s_nop 0
  v_pk_mul_f32 v[104:105], v[104:105], v[232:233]
  v_pk_mul_f32 v[106:107], v[106:107], v[234:235]
  v_cvt_pk_bf16_f32 v90, v104, v105
  v_cvt_pk_bf16_f32 v91, v106, v107
  buffer_store_dwordx4 v[88:91], v252, s[4:7], s52 offen offset:1024
  v_pk_fma_f32 v[108:109], v[224:225], v[242:243], v[108:109] op_sel:[0,1,0] op_sel_hi:[1,1,1]
  v_pk_fma_f32 v[124:125], v[228:229], v[242:243], v[124:125] op_sel:[0,1,0] op_sel_hi:[1,1,1]
  v_pk_fma_f32 v[110:111], v[226:227], v[242:243], v[110:111] op_sel:[0,1,0] op_sel_hi:[1,1,1]
  v_pk_fma_f32 v[126:127], v[230:231], v[242:243], v[126:127] op_sel:[0,1,0] op_sel_hi:[1,1,1]
  v_pk_mul_f32 v[232:233], v[108:109], v[246:247] op_sel:[0,1] op_sel_hi:[1,1]
  v_pk_mul_f32 v[234:235], v[110:111], v[246:247] op_sel:[0,1] op_sel_hi:[1,1]
  v_exp_f32 v232, v232
  v_exp_f32 v233, v233
  v_exp_f32 v234, v234
  v_exp_f32 v235, v235
  v_pk_mul_f32 v[108:109], v[108:109], v[124:125]
  v_pk_mul_f32 v[110:111], v[110:111], v[126:127]
  v_pk_fma_f32 v[232:233], v[232:233], v[250:251], v[250:251] op_sel:[0,1,1] op_sel_hi:[1,1,1]
  v_pk_fma_f32 v[234:235], v[234:235], v[250:251], v[250:251] op_sel:[0,1,1] op_sel_hi:[1,1,1]
  v_rcp_f32 v232, v232
  v_rcp_f32 v233, v233
  v_rcp_f32 v234, v234
  v_rcp_f32 v235, v235
  s_nop 0
  v_pk_mul_f32 v[108:109], v[108:109], v[232:233]
  v_pk_mul_f32 v[110:111], v[110:111], v[234:235]
  v_cvt_pk_bf16_f32 v94, v108, v109
  v_cvt_pk_bf16_f32 v95, v110, v111
  buffer_store_dwordx4 v[92:95], v252, s[4:7], s53 offen offset:1024
  v_accvgpr_read_b32 v224, a192
  v_accvgpr_read_b32 v225, a193
  v_accvgpr_read_b32 v226, a194
  v_accvgpr_read_b32 v227, a195
  v_accvgpr_read_b32 v228, a196
  v_accvgpr_read_b32 v229, a197
  v_accvgpr_read_b32 v230, a198
  v_accvgpr_read_b32 v231, a199
  v_pk_fma_f32 v[128:129], v[224:225], v[240:241], v[128:129] op_sel:[0,0,0] op_sel_hi:[1,0,1]
  v_pk_fma_f32 v[144:145], v[228:229], v[240:241], v[144:145] op_sel:[0,0,0] op_sel_hi:[1,0,1]
  v_pk_fma_f32 v[130:131], v[226:227], v[240:241], v[130:131] op_sel:[0,0,0] op_sel_hi:[1,0,1]
  v_pk_fma_f32 v[146:147], v[230:231], v[240:241], v[146:147] op_sel:[0,0,0] op_sel_hi:[1,0,1]
  v_pk_mul_f32 v[232:233], v[128:129], v[244:245] op_sel:[0,0] op_sel_hi:[1,0]
  v_pk_mul_f32 v[234:235], v[130:131], v[244:245] op_sel:[0,0] op_sel_hi:[1,0]
  v_exp_f32 v232, v232
  v_exp_f32 v233, v233
  v_exp_f32 v234, v234
  v_exp_f32 v235, v235
  v_pk_mul_f32 v[128:129], v[128:129], v[144:145]
  v_pk_mul_f32 v[130:131], v[130:131], v[146:147]
  v_pk_fma_f32 v[232:233], v[232:233], v[248:249], v[248:249] op_sel:[0,0,0] op_sel_hi:[1,0,0]
  v_pk_fma_f32 v[234:235], v[234:235], v[248:249], v[248:249] op_sel:[0,0,0] op_sel_hi:[1,0,0]
  v_rcp_f32 v232, v232
  v_rcp_f32 v233, v233
  v_rcp_f32 v234, v234
  v_rcp_f32 v235, v235
  s_nop 0
  v_pk_mul_f32 v[128:129], v[128:129], v[232:233]
  v_pk_mul_f32 v[130:131], v[130:131], v[234:235]
  v_cvt_pk_bf16_f32 v144, v128, v129
  v_cvt_pk_bf16_f32 v145, v130, v131
  v_pk_fma_f32 v[132:133], v[224:225], v[240:241], v[132:133] op_sel:[0,1,0] op_sel_hi:[1,1,1]
  v_pk_fma_f32 v[148:149], v[228:229], v[240:241], v[148:149] op_sel:[0,1,0] op_sel_hi:[1,1,1]
  v_pk_fma_f32 v[134:135], v[226:227], v[240:241], v[134:135] op_sel:[0,1,0] op_sel_hi:[1,1,1]
  v_pk_fma_f32 v[150:151], v[230:231], v[240:241], v[150:151] op_sel:[0,1,0] op_sel_hi:[1,1,1]
  v_pk_mul_f32 v[232:233], v[132:133], v[244:245] op_sel:[0,1] op_sel_hi:[1,1]
  v_pk_mul_f32 v[234:235], v[134:135], v[244:245] op_sel:[0,1] op_sel_hi:[1,1]
  v_exp_f32 v232, v232
  v_exp_f32 v233, v233
  v_exp_f32 v234, v234
  v_exp_f32 v235, v235
  v_pk_mul_f32 v[132:133], v[132:133], v[148:149]
  v_pk_mul_f32 v[134:135], v[134:135], v[150:151]
  v_pk_fma_f32 v[232:233], v[232:233], v[248:249], v[248:249] op_sel:[0,1,1] op_sel_hi:[1,1,1]
  v_pk_fma_f32 v[234:235], v[234:235], v[248:249], v[248:249] op_sel:[0,1,1] op_sel_hi:[1,1,1]
  v_rcp_f32 v232, v232
  v_rcp_f32 v233, v233
  v_rcp_f32 v234, v234
  v_rcp_f32 v235, v235
  s_nop 0
  v_pk_mul_f32 v[132:133], v[132:133], v[232:233]
  v_pk_mul_f32 v[134:135], v[134:135], v[234:235]
  v_cvt_pk_bf16_f32 v148, v132, v133
  v_cvt_pk_bf16_f32 v149, v134, v135
  v_pk_fma_f32 v[136:137], v[224:225], v[242:243], v[136:137] op_sel:[0,0,0] op_sel_hi:[1,0,1]
  v_pk_fma_f32 v[152:153], v[228:229], v[242:243], v[152:153] op_sel:[0,0,0] op_sel_hi:[1,0,1]
  v_pk_fma_f32 v[138:139], v[226:227], v[242:243], v[138:139] op_sel:[0,0,0] op_sel_hi:[1,0,1]
  v_pk_fma_f32 v[154:155], v[230:231], v[242:243], v[154:155] op_sel:[0,0,0] op_sel_hi:[1,0,1]
  v_pk_mul_f32 v[232:233], v[136:137], v[246:247] op_sel:[0,0] op_sel_hi:[1,0]
  v_pk_mul_f32 v[234:235], v[138:139], v[246:247] op_sel:[0,0] op_sel_hi:[1,0]
  v_exp_f32 v232, v232
  v_exp_f32 v233, v233
  v_exp_f32 v234, v234
  v_exp_f32 v235, v235
  v_pk_mul_f32 v[136:137], v[136:137], v[152:153]
  v_pk_mul_f32 v[138:139], v[138:139], v[154:155]
  v_pk_fma_f32 v[232:233], v[232:233], v[250:251], v[250:251] op_sel:[0,0,0] op_sel_hi:[1,0,0]
  v_pk_fma_f32 v[234:235], v[234:235], v[250:251], v[250:251] op_sel:[0,0,0] op_sel_hi:[1,0,0]
  v_rcp_f32 v232, v232
  v_rcp_f32 v233, v233
  v_rcp_f32 v234, v234
  v_rcp_f32 v235, v235
  s_nop 0
  v_pk_mul_f32 v[136:137], v[136:137], v[232:233]
  v_pk_mul_f32 v[138:139], v[138:139], v[234:235]
  v_cvt_pk_bf16_f32 v152, v136, v137
  v_cvt_pk_bf16_f32 v153, v138, v139
  v_pk_fma_f32 v[140:141], v[224:225], v[242:243], v[140:141] op_sel:[0,1,0] op_sel_hi:[1,1,1]
  v_pk_fma_f32 v[156:157], v[228:229], v[242:243], v[156:157] op_sel:[0,1,0] op_sel_hi:[1,1,1]
  v_pk_fma_f32 v[142:143], v[226:227], v[242:243], v[142:143] op_sel:[0,1,0] op_sel_hi:[1,1,1]
  v_pk_fma_f32 v[158:159], v[230:231], v[242:243], v[158:159] op_sel:[0,1,0] op_sel_hi:[1,1,1]
  v_pk_mul_f32 v[232:233], v[140:141], v[246:247] op_sel:[0,1] op_sel_hi:[1,1]
  v_pk_mul_f32 v[234:235], v[142:143], v[246:247] op_sel:[0,1] op_sel_hi:[1,1]
  v_exp_f32 v232, v232
  v_exp_f32 v233, v233
  v_exp_f32 v234, v234
  v_exp_f32 v235, v235
  v_pk_mul_f32 v[140:141], v[140:141], v[156:157]
  v_pk_mul_f32 v[142:143], v[142:143], v[158:159]
  v_pk_fma_f32 v[232:233], v[232:233], v[250:251], v[250:251] op_sel:[0,1,1] op_sel_hi:[1,1,1]
  v_pk_fma_f32 v[234:235], v[234:235], v[250:251], v[250:251] op_sel:[0,1,1] op_sel_hi:[1,1,1]
  v_rcp_f32 v232, v232
  v_rcp_f32 v233, v233
  v_rcp_f32 v234, v234
  v_rcp_f32 v235, v235
  s_nop 0
  v_pk_mul_f32 v[140:141], v[140:141], v[232:233]
  v_pk_mul_f32 v[142:143], v[142:143], v[234:235]
  v_cvt_pk_bf16_f32 v156, v140, v141
  v_cvt_pk_bf16_f32 v157, v142, v143
  v_accvgpr_read_b32 v224, a200
  v_accvgpr_read_b32 v225, a201
  v_accvgpr_read_b32 v226, a202
  v_accvgpr_read_b32 v227, a203
  v_accvgpr_read_b32 v228, a204
  v_accvgpr_read_b32 v229, a205
  v_accvgpr_read_b32 v230, a206
  v_accvgpr_read_b32 v231, a207
  v_pk_fma_f32 v[160:161], v[224:225], v[240:241], v[160:161] op_sel:[0,0,0] op_sel_hi:[1,0,1]
  v_pk_fma_f32 v[176:177], v[228:229], v[240:241], v[176:177] op_sel:[0,0,0] op_sel_hi:[1,0,1]
  v_pk_fma_f32 v[162:163], v[226:227], v[240:241], v[162:163] op_sel:[0,0,0] op_sel_hi:[1,0,1]
  v_pk_fma_f32 v[178:179], v[230:231], v[240:241], v[178:179] op_sel:[0,0,0] op_sel_hi:[1,0,1]
  v_pk_mul_f32 v[232:233], v[160:161], v[244:245] op_sel:[0,0] op_sel_hi:[1,0]
  v_pk_mul_f32 v[234:235], v[162:163], v[244:245] op_sel:[0,0] op_sel_hi:[1,0]
  v_exp_f32 v232, v232
  v_exp_f32 v233, v233
  v_exp_f32 v234, v234
  v_exp_f32 v235, v235
  v_pk_mul_f32 v[160:161], v[160:161], v[176:177]
  v_pk_mul_f32 v[162:163], v[162:163], v[178:179]
  v_pk_fma_f32 v[232:233], v[232:233], v[248:249], v[248:249] op_sel:[0,0,0] op_sel_hi:[1,0,0]
  v_pk_fma_f32 v[234:235], v[234:235], v[248:249], v[248:249] op_sel:[0,0,0] op_sel_hi:[1,0,0]
  v_rcp_f32 v232, v232
  v_rcp_f32 v233, v233
  v_rcp_f32 v234, v234
  v_rcp_f32 v235, v235
  s_nop 0
  v_pk_mul_f32 v[160:161], v[160:161], v[232:233]
  v_pk_mul_f32 v[162:163], v[162:163], v[234:235]
  v_cvt_pk_bf16_f32 v146, v160, v161
  v_cvt_pk_bf16_f32 v147, v162, v163
  buffer_store_dwordx4 v[144:147], v252, s[4:7], s50 offen offset:2048
  v_pk_fma_f32 v[164:165], v[224:225], v[240:241], v[164:165] op_sel:[0,1,0] op_sel_hi:[1,1,1]
  v_pk_fma_f32 v[180:181], v[228:229], v[240:241], v[180:181] op_sel:[0,1,0] op_sel_hi:[1,1,1]
  v_pk_fma_f32 v[166:167], v[226:227], v[240:241], v[166:167] op_sel:[0,1,0] op_sel_hi:[1,1,1]
  v_pk_fma_f32 v[182:183], v[230:231], v[240:241], v[182:183] op_sel:[0,1,0] op_sel_hi:[1,1,1]
  v_pk_mul_f32 v[232:233], v[164:165], v[244:245] op_sel:[0,1] op_sel_hi:[1,1]
  v_pk_mul_f32 v[234:235], v[166:167], v[244:245] op_sel:[0,1] op_sel_hi:[1,1]
  v_exp_f32 v232, v232
  v_exp_f32 v233, v233
  v_exp_f32 v234, v234
  v_exp_f32 v235, v235
  v_pk_mul_f32 v[164:165], v[164:165], v[180:181]
  v_pk_mul_f32 v[166:167], v[166:167], v[182:183]
  v_pk_fma_f32 v[232:233], v[232:233], v[248:249], v[248:249] op_sel:[0,1,1] op_sel_hi:[1,1,1]
  v_pk_fma_f32 v[234:235], v[234:235], v[248:249], v[248:249] op_sel:[0,1,1] op_sel_hi:[1,1,1]
  v_rcp_f32 v232, v232
  v_rcp_f32 v233, v233
  v_rcp_f32 v234, v234
  v_rcp_f32 v235, v235
  s_nop 0
  v_pk_mul_f32 v[164:165], v[164:165], v[232:233]
  v_pk_mul_f32 v[166:167], v[166:167], v[234:235]
  v_cvt_pk_bf16_f32 v150, v164, v165
  v_cvt_pk_bf16_f32 v151, v166, v167
  buffer_store_dwordx4 v[148:151], v252, s[4:7], s51 offen offset:2048
  v_pk_fma_f32 v[168:169], v[224:225], v[242:243], v[168:169] op_sel:[0,0,0] op_sel_hi:[1,0,1]
  v_pk_fma_f32 v[184:185], v[228:229], v[242:243], v[184:185] op_sel:[0,0,0] op_sel_hi:[1,0,1]
  v_pk_fma_f32 v[170:171], v[226:227], v[242:243], v[170:171] op_sel:[0,0,0] op_sel_hi:[1,0,1]
  v_pk_fma_f32 v[186:187], v[230:231], v[242:243], v[186:187] op_sel:[0,0,0] op_sel_hi:[1,0,1]
  v_pk_mul_f32 v[232:233], v[168:169], v[246:247] op_sel:[0,0] op_sel_hi:[1,0]
  v_pk_mul_f32 v[234:235], v[170:171], v[246:247] op_sel:[0,0] op_sel_hi:[1,0]
  v_exp_f32 v232, v232
  v_exp_f32 v233, v233
  v_exp_f32 v234, v234
  v_exp_f32 v235, v235
  v_pk_mul_f32 v[168:169], v[168:169], v[184:185]
  v_pk_mul_f32 v[170:171], v[170:171], v[186:187]
  v_pk_fma_f32 v[232:233], v[232:233], v[250:251], v[250:251] op_sel:[0,0,0] op_sel_hi:[1,0,0]
  v_pk_fma_f32 v[234:235], v[234:235], v[250:251], v[250:251] op_sel:[0,0,0] op_sel_hi:[1,0,0]
  v_rcp_f32 v232, v232
  v_rcp_f32 v233, v233
  v_rcp_f32 v234, v234
  v_rcp_f32 v235, v235
  s_nop 0
  v_pk_mul_f32 v[168:169], v[168:169], v[232:233]
  v_pk_mul_f32 v[170:171], v[170:171], v[234:235]
  v_cvt_pk_bf16_f32 v154, v168, v169
  v_cvt_pk_bf16_f32 v155, v170, v171
  buffer_store_dwordx4 v[152:155], v252, s[4:7], s52 offen offset:2048
  v_pk_fma_f32 v[172:173], v[224:225], v[242:243], v[172:173] op_sel:[0,1,0] op_sel_hi:[1,1,1]
  v_pk_fma_f32 v[188:189], v[228:229], v[242:243], v[188:189] op_sel:[0,1,0] op_sel_hi:[1,1,1]
  v_pk_fma_f32 v[174:175], v[226:227], v[242:243], v[174:175] op_sel:[0,1,0] op_sel_hi:[1,1,1]
  v_pk_fma_f32 v[190:191], v[230:231], v[242:243], v[190:191] op_sel:[0,1,0] op_sel_hi:[1,1,1]
  v_pk_mul_f32 v[232:233], v[172:173], v[246:247] op_sel:[0,1] op_sel_hi:[1,1]
  v_pk_mul_f32 v[234:235], v[174:175], v[246:247] op_sel:[0,1] op_sel_hi:[1,1]
  v_exp_f32 v232, v232
  v_exp_f32 v233, v233
  v_exp_f32 v234, v234
  v_exp_f32 v235, v235
  v_pk_mul_f32 v[172:173], v[172:173], v[188:189]
  v_pk_mul_f32 v[174:175], v[174:175], v[190:191]
  v_pk_fma_f32 v[232:233], v[232:233], v[250:251], v[250:251] op_sel:[0,1,1] op_sel_hi:[1,1,1]
  v_pk_fma_f32 v[234:235], v[234:235], v[250:251], v[250:251] op_sel:[0,1,1] op_sel_hi:[1,1,1]
  v_rcp_f32 v232, v232
  v_rcp_f32 v233, v233
  v_rcp_f32 v234, v234
  v_rcp_f32 v235, v235
  s_nop 0
  v_pk_mul_f32 v[172:173], v[172:173], v[232:233]
  v_pk_mul_f32 v[174:175], v[174:175], v[234:235]
  v_cvt_pk_bf16_f32 v158, v172, v173
  v_cvt_pk_bf16_f32 v159, v174, v175
  buffer_store_dwordx4 v[156:159], v252, s[4:7], s53 offen offset:2048
  v_accvgpr_read_b32 v224, a208
  v_accvgpr_read_b32 v225, a209
  v_accvgpr_read_b32 v226, a210
  v_accvgpr_read_b32 v227, a211
  v_accvgpr_read_b32 v228, a212
  v_accvgpr_read_b32 v229, a213
  v_accvgpr_read_b32 v230, a214
  v_accvgpr_read_b32 v231, a215
  v_pk_fma_f32 v[192:193], v[224:225], v[240:241], v[192:193] op_sel:[0,0,0] op_sel_hi:[1,0,1]
  v_pk_fma_f32 v[208:209], v[228:229], v[240:241], v[208:209] op_sel:[0,0,0] op_sel_hi:[1,0,1]
  v_pk_fma_f32 v[194:195], v[226:227], v[240:241], v[194:195] op_sel:[0,0,0] op_sel_hi:[1,0,1]
  v_pk_fma_f32 v[210:211], v[230:231], v[240:241], v[210:211] op_sel:[0,0,0] op_sel_hi:[1,0,1]
  v_pk_mul_f32 v[232:233], v[192:193], v[244:245] op_sel:[0,0] op_sel_hi:[1,0]
  v_pk_mul_f32 v[234:235], v[194:195], v[244:245] op_sel:[0,0] op_sel_hi:[1,0]
  v_exp_f32 v232, v232
  v_exp_f32 v233, v233
  v_exp_f32 v234, v234
  v_exp_f32 v235, v235
  v_pk_mul_f32 v[192:193], v[192:193], v[208:209]
  v_pk_mul_f32 v[194:195], v[194:195], v[210:211]
  v_pk_fma_f32 v[232:233], v[232:233], v[248:249], v[248:249] op_sel:[0,0,0] op_sel_hi:[1,0,0]
  v_pk_fma_f32 v[234:235], v[234:235], v[248:249], v[248:249] op_sel:[0,0,0] op_sel_hi:[1,0,0]
  v_rcp_f32 v232, v232
  v_rcp_f32 v233, v233
  v_rcp_f32 v234, v234
  v_rcp_f32 v235, v235
  s_nop 0
  v_pk_mul_f32 v[192:193], v[192:193], v[232:233]
  v_pk_mul_f32 v[194:195], v[194:195], v[234:235]
  v_cvt_pk_bf16_f32 v208, v192, v193
  v_cvt_pk_bf16_f32 v209, v194, v195
  v_pk_fma_f32 v[196:197], v[224:225], v[240:241], v[196:197] op_sel:[0,1,0] op_sel_hi:[1,1,1]
  v_pk_fma_f32 v[212:213], v[228:229], v[240:241], v[212:213] op_sel:[0,1,0] op_sel_hi:[1,1,1]
  v_pk_fma_f32 v[198:199], v[226:227], v[240:241], v[198:199] op_sel:[0,1,0] op_sel_hi:[1,1,1]
  v_pk_fma_f32 v[214:215], v[230:231], v[240:241], v[214:215] op_sel:[0,1,0] op_sel_hi:[1,1,1]
  v_pk_mul_f32 v[232:233], v[196:197], v[244:245] op_sel:[0,1] op_sel_hi:[1,1]
  v_pk_mul_f32 v[234:235], v[198:199], v[244:245] op_sel:[0,1] op_sel_hi:[1,1]
  v_exp_f32 v232, v232
  v_exp_f32 v233, v233
  v_exp_f32 v234, v234
  v_exp_f32 v235, v235
  v_pk_mul_f32 v[196:197], v[196:197], v[212:213]
  v_pk_mul_f32 v[198:199], v[198:199], v[214:215]
  v_pk_fma_f32 v[232:233], v[232:233], v[248:249], v[248:249] op_sel:[0,1,1] op_sel_hi:[1,1,1]
  v_pk_fma_f32 v[234:235], v[234:235], v[248:249], v[248:249] op_sel:[0,1,1] op_sel_hi:[1,1,1]
  v_rcp_f32 v232, v232
  v_rcp_f32 v233, v233
  v_rcp_f32 v234, v234
  v_rcp_f32 v235, v235
  s_nop 0
  v_pk_mul_f32 v[196:197], v[196:197], v[232:233]
  v_pk_mul_f32 v[198:199], v[198:199], v[234:235]
  v_cvt_pk_bf16_f32 v210, v196, v197
  v_cvt_pk_bf16_f32 v211, v198, v199
  s_nop 1
  v_permlane32_swap_b32 v208, v210
  v_permlane32_swap_b32 v209, v211
  buffer_store_dwordx4 v[208:211], v253, s[4:7], s54 offen
  v_pk_fma_f32 v[200:201], v[224:225], v[242:243], v[200:201] op_sel:[0,0,0] op_sel_hi:[1,0,1]
  v_pk_fma_f32 v[216:217], v[228:229], v[242:243], v[216:217] op_sel:[0,0,0] op_sel_hi:[1,0,1]
  v_pk_fma_f32 v[202:203], v[226:227], v[242:243], v[202:203] op_sel:[0,0,0] op_sel_hi:[1,0,1]
  v_pk_fma_f32 v[218:219], v[230:231], v[242:243], v[218:219] op_sel:[0,0,0] op_sel_hi:[1,0,1]
  v_pk_mul_f32 v[232:233], v[200:201], v[246:247] op_sel:[0,0] op_sel_hi:[1,0]
  v_pk_mul_f32 v[234:235], v[202:203], v[246:247] op_sel:[0,0] op_sel_hi:[1,0]
  v_exp_f32 v232, v232
  v_exp_f32 v233, v233
  v_exp_f32 v234, v234
  v_exp_f32 v235, v235
  v_pk_mul_f32 v[200:201], v[200:201], v[216:217]
  v_pk_mul_f32 v[202:203], v[202:203], v[218:219]
  v_pk_fma_f32 v[232:233], v[232:233], v[250:251], v[250:251] op_sel:[0,0,0] op_sel_hi:[1,0,0]
  v_pk_fma_f32 v[234:235], v[234:235], v[250:251], v[250:251] op_sel:[0,0,0] op_sel_hi:[1,0,0]
  v_rcp_f32 v232, v232
  v_rcp_f32 v233, v233
  v_rcp_f32 v234, v234
  v_rcp_f32 v235, v235
  s_nop 0
  v_pk_mul_f32 v[200:201], v[200:201], v[232:233]
  v_pk_mul_f32 v[202:203], v[202:203], v[234:235]
  v_cvt_pk_bf16_f32 v216, v200, v201
  v_cvt_pk_bf16_f32 v217, v202, v203
  v_pk_fma_f32 v[204:205], v[224:225], v[242:243], v[204:205] op_sel:[0,1,0] op_sel_hi:[1,1,1]
  v_pk_fma_f32 v[220:221], v[228:229], v[242:243], v[220:221] op_sel:[0,1,0] op_sel_hi:[1,1,1]
  v_pk_fma_f32 v[206:207], v[226:227], v[242:243], v[206:207] op_sel:[0,1,0] op_sel_hi:[1,1,1]
  v_pk_fma_f32 v[222:223], v[230:231], v[242:243], v[222:223] op_sel:[0,1,0] op_sel_hi:[1,1,1]
  v_pk_mul_f32 v[232:233], v[204:205], v[246:247] op_sel:[0,1] op_sel_hi:[1,1]
  v_pk_mul_f32 v[234:235], v[206:207], v[246:247] op_sel:[0,1] op_sel_hi:[1,1]
  v_exp_f32 v232, v232
  v_exp_f32 v233, v233
  v_exp_f32 v234, v234
  v_exp_f32 v235, v235
  v_pk_mul_f32 v[204:205], v[204:205], v[220:221]
  v_pk_mul_f32 v[206:207], v[206:207], v[222:223]
  v_pk_fma_f32 v[232:233], v[232:233], v[250:251], v[250:251] op_sel:[0,1,1] op_sel_hi:[1,1,1]
  v_pk_fma_f32 v[234:235], v[234:235], v[250:251], v[250:251] op_sel:[0,1,1] op_sel_hi:[1,1,1]
  v_rcp_f32 v232, v232
  v_rcp_f32 v233, v233
  v_rcp_f32 v234, v234
  v_rcp_f32 v235, v235
  s_nop 0
  v_pk_mul_f32 v[204:205], v[204:205], v[232:233]
  v_pk_mul_f32 v[206:207], v[206:207], v[234:235]
  v_cvt_pk_bf16_f32 v218, v204, v205
  v_cvt_pk_bf16_f32 v219, v206, v207
  s_nop 1
  v_permlane32_swap_b32 v216, v218
  v_permlane32_swap_b32 v217, v219
  buffer_store_dwordx4 v[216:219], v253, s[4:7], s55 offen
  s_endpgm
.globl down1_kernel
.p2align 8
.type down1_kernel,@function
down1_kernel:
  s_mov_b32 s40, 0x400000
  s_mov_b32 s41, 0x800000
  s_mov_b32 s47, 0x2280000
  s_mov_b32 s48, 0x0
  s_cmp_lt_u32 s2, 256
  s_cbranch_scc1 down_body
  s_endpgm
.globl down2_kernel
.p2align 8
.type down2_kernel,@function
down2_kernel:
  s_mov_b32 s40, 0xc00000
  s_mov_b32 s41, 0x0
  s_mov_b32 s47, 0x2200000
  s_mov_b32 s48, 0x1
  s_cmp_lt_u32 s2, 256
  s_cbranch_scc1 down_body
  s_endpgm
.p2align 6
down_body:
  s_load_dwordx2 s[32:33], s[0:1], 72
  s_load_dwordx2 s[36:37], s[0:1], 48
  s_load_dwordx2 s[38:39], s[0:1], 56
  v_lshrrev_b32 v1, 6, v0
  v_and_b32 v47, 63, v0
  v_readfirstlane_b32 s24, v1
  s_and_b32 s34, s2, 7
  s_lshr_b32 s35, s2, 3
  s_and_b32 s25, s34, 3
  s_lshl_b32 s25, s25, 2
  s_and_b32 s43, s35, 3
  s_add_u32 s25, s25, s43
  s_lshr_b32 s26, s34, 2
  s_lshl_b32 s26, s26, 3
  s_lshr_b32 s43, s35, 2
  s_add_u32 s26, s26, s43
  v_lshrrev_b32 v2, 3, v47
  v_bfe_u32 v3, v47, 1, 2
  v_lshrrev_b32 v4, 4, v47
  v_xor_b32 v3, v3, v4
  v_and_b32 v4, 1, v47
  v_lshlrev_b32 v2, 11, v2
  v_lshl_add_u32 v2, v3, 5, v2
  v_lshl_add_u32 v44, v4, 4, v2
  v_lshlrev_b32 v45, 4, v47
  v_add_u32 v46, 114688, v45
  s_lshl_b32 s44, s25, 3
  s_lshl_b32 s43, s24, 1
  s_add_u32 s44, s44, s43
  s_mul_i32 s28, s44, 114688
  s_add_u32 s28, s28, 20971520
  s_lshl_b32 s29, s26, 7
  s_lshl_b32 s43, s24, 14
  s_add_u32 s29, s29, s43
  s_lshl_b32 s30, s24, 10
  s_cmp_eq_u32 s24, 1
  s_cselect_b32 s27, 16384, 0
  s_cmp_eq_u32 s24, 2
  s_cselect_b32 s27, -16384, s27
  s_lshl_b32 s45, s44, 15
  s_lshl_b32 s43, s26, 11
  s_add_u32 s45, s45, s43
  s_add_u32 s46, s45, s40
  s_add_u32 s49, s46, 32768
  s_waitcnt lgkmcnt(0)
  s_mov_b32 s4, s32
  s_mov_b32 s5, s33
  s_mov_b32 s6, 0x10000000
  s_mov_b32 s7, 0x20000
  s_mov_b32 s8, s36
  s_mov_b32 s9, s37
  s_mov_b32 s10, 0x700000
  s_mov_b32 s11, 0x20000
  s_mov_b32 s12, s38
  s_mov_b32 s13, s39
  s_mov_b32 s14, 0x400000
  s_mov_b32 s15, 0x20000
  s_add_u32 m0, s30, 0
  s_nop 0
  buffer_load_dwordx4 v44, s[8:11], s29 offen lds
  s_add_u32 s29, s29, 65536
  buffer_load_dwordx4 v[48:51], v45, s[4:7], s46 offen offset:0
  buffer_load_dwordx4 v[52:55], v45, s[4:7], s46 offen offset:1024
  buffer_load_dwordx4 v[56:59], v45, s[4:7], s49 offen offset:0
  buffer_load_dwordx4 v[60:63], v45, s[4:7], s49 offen offset:1024
  s_add_u32 m0, s30, 4096
  s_nop 0
  buffer_load_dwordx4 v44, s[8:11], s29 offen lds
  s_add_u32 s29, s29, 65536
  buffer_load_dwordx4 a[0:3], v45, s[4:7], s28 offen
  buffer_load_dwordx4 a[4:7], v46, s[4:7], s28 offen
  s_add_u32 s28, s28, 1024
  s_add_u32 m0, s30, 8192
  s_nop 0
  buffer_load_dwordx4 v44, s[8:11], s29 offen lds
  s_add_u32 s29, s29, 65536
  buffer_load_dwordx4 a[8:11], v45, s[4:7], s28 offen
  buffer_load_dwordx4 a[12:15], v46, s[4:7], s28 offen
  s_add_u32 s28, s28, 1024
  s_add_u32 m0, s30, 12288
  s_add_u32 s43, s29, s27
  buffer_load_dwordx4 v44, s[8:11], s43 offen lds
  s_add_u32 s29, s29, 65536
  buffer_load_dwordx4 a[16:19], v45, s[4:7], s28 offen
  buffer_load_dwordx4 a[20:23], v46, s[4:7], s28 offen
  s_add_u32 s28, s28, 1024
  s_add_u32 m0, s30, 16384
  s_nop 0
  buffer_load_dwordx4 v44, s[8:11], s29 offen lds
  s_add_u32 s29, s29, 65536
  buffer_load_dwordx4 a[24:27], v45, s[4:7], s28 offen
  buffer_load_dwordx4 a[28:31], v46, s[4:7], s28 offen
  s_add_u32 s28, s28, 1024
  s_add_u32 m0, s30, 20480
  s_nop 0
  buffer_load_dwordx4 v44, s[8:11], s29 offen lds
  s_add_u32 s29, s29, 65536
  buffer_load_dwordx4 a[32:35], v45, s[4:7], s28 offen
  buffer_load_dwordx4 a[36:39], v46, s[4:7], s28 offen
  s_add_u32 s28, s28, 1024
  v_lshrrev_b32 v2, 2, v47
  v_bfe_u32 v3, v47, 3, 2
  v_and_b32 v4, 3, v47
  v_lshlrev_b32 v4, 3, v4
  v_lshl_add_u32 v4, v2, 7, v4
  v_xor_b32 v5, 0, v3
  v_lshl_add_u32 v40, v5, 5, v4
  v_xor_b32 v5, 1, v3
  v_lshl_add_u32 v41, v5, 5, v4
  v_xor_b32 v5, 2, v3
  v_lshl_add_u32 v42, v5, 5, v4
  v_xor_b32 v5, 3, v3
  v_lshl_add_u32 v43, v5, 5, v4
  s_waitcnt vmcnt(15)
  v_lshlrev_b32 v0, 16, v48
  v_and_b32 v1, 0xffff0000, v48
  v_lshlrev_b32 v2, 16, v49
  v_and_b32 v3, 0xffff0000, v49
  v_lshlrev_b32 v8, 16, v50
  v_and_b32 v9, 0xffff0000, v50
  v_lshlrev_b32 v10, 16, v51
  v_and_b32 v11, 0xffff0000, v51
  v_lshlrev_b32 v16, 16, v52
  v_and_b32 v17, 0xffff0000, v52
  v_lshlrev_b32 v18, 16, v53
  v_and_b32 v19, 0xffff0000, v53
  v_lshlrev_b32 v24, 16, v54
  v_and_b32 v25, 0xffff0000, v54
  v_lshlrev_b32 v26, 16, v55
  v_and_b32 v27, 0xffff0000, v55
  v_lshlrev_b32 v4, 16, v56
  v_and_b32 v5, 0xffff0000, v56
  v_lshlrev_b32 v6, 16, v57
  v_and_b32 v7, 0xffff0000, v57
  v_lshlrev_b32 v12, 16, v58
  v_and_b32 v13, 0xffff0000, v58
  v_lshlrev_b32 v14, 16, v59
  v_and_b32 v15, 0xffff0000, v59
  v_lshlrev_b32 v20, 16, v60
  v_and_b32 v21, 0xffff0000, v60
  v_lshlrev_b32 v22, 16, v61
  v_and_b32 v23, 0xffff0000, v61
  v_lshlrev_b32 v28, 16, v62
  v_and_b32 v29, 0xffff0000, v62
  v_lshlrev_b32 v30, 16, v63
  v_and_b32 v31, 0xffff0000, v63
  s_waitcnt vmcnt(14)
  s_barrier
  ds_read_b64_tr_b16 a[64:65], v40 offset:0
  ds_read_b64_tr_b16 a[66:67], v40 offset:2048
  ds_read_b64_tr_b16 a[68:69], v41 offset:0
  ds_read_b64_tr_b16 a[70:71], v41 offset:2048
  ds_read_b64_tr_b16 a[72:73], v42 offset:0
  ds_read_b64_tr_b16 a[74:75], v42 offset:2048
  ds_read_b64_tr_b16 a[76:77], v43 offset:0
  ds_read_b64_tr_b16 a[78:79], v43 offset:2048
  s_mov_b32 s31, 7
.p2align 3
Ldown_body_loop:
  s_waitcnt vmcnt(12) lgkmcnt(6)
  v_mfma_f32_16x16x32_bf16 v[0:3], a[64:67], a[0:3], v[0:3]
  ds_read_b64_tr_b16 a[80:81], v40 offset:4096
  v_mfma_f32_16x16x32_bf16 v[4:7], a[64:67], a[4:7], v[4:7]
  ds_read_b64_tr_b16 a[82:83], v40 offset:6144
  s_add_u32 m0, s30, 24576
  s_nop 0
  buffer_load_dwordx4 v44, s[8:11], s29 offen lds
  s_add_u32 s29, s29, 65536
  s_waitcnt lgkmcnt(6)
  v_mfma_f32_16x16x32_bf16 v[12:15], a[68:71], a[4:7], v[12:15]
  ds_read_b64_tr_b16 a[84:85], v41 offset:4096
  v_mfma_f32_16x16x32_bf16 v[8:11], a[68:71], a[0:3], v[8:11]
  ds_read_b64_tr_b16 a[86:87], v41 offset:6144
  buffer_load_dwordx4 a[40:43], v45, s[4:7], s28 offen
  s_waitcnt lgkmcnt(6)
  v_mfma_f32_16x16x32_bf16 v[16:19], a[72:75], a[0:3], v[16:19]
  ds_read_b64_tr_b16 a[88:89], v42 offset:4096
  v_mfma_f32_16x16x32_bf16 v[20:23], a[72:75], a[4:7], v[20:23]
  ds_read_b64_tr_b16 a[90:91], v42 offset:6144
  buffer_load_dwordx4 a[44:47], v46, s[4:7], s28 offen
  s_add_u32 s28, s28, 1024
  s_waitcnt lgkmcnt(6)
  v_mfma_f32_16x16x32_bf16 v[28:31], a[76:79], a[4:7], v[28:31]
  ds_read_b64_tr_b16 a[92:93], v43 offset:4096
  v_mfma_f32_16x16x32_bf16 v[24:27], a[76:79], a[0:3], v[24:27]
  ds_read_b64_tr_b16 a[94:95], v43 offset:6144
  s_waitcnt vmcnt(12) lgkmcnt(6)
  v_mfma_f32_16x16x32_bf16 v[0:3], a[80:83], a[8:11], v[0:3]
  s_waitcnt vmcnt(11)
  s_barrier
  ds_read_b64_tr_b16 a[64:65], v40 offset:8192
  v_mfma_f32_16x16x32_bf16 v[4:7], a[80:83], a[12:15], v[4:7]
  ds_read_b64_tr_b16 a[66:67], v40 offset:10240
  s_add_u32 m0, s30, 28672
  s_nop 0
  buffer_load_dwordx4 v44, s[8:11], s29 offen lds
  s_add_u32 s29, s29, 65536
  s_waitcnt lgkmcnt(6)
  v_mfma_f32_16x16x32_bf16 v[12:15], a[84:87], a[12:15], v[12:15]
  ds_read_b64_tr_b16 a[68:69], v41 offset:8192
  v_mfma_f32_16x16x32_bf16 v[8:11], a[84:87], a[8:11], v[8:11]
  ds_read_b64_tr_b16 a[70:71], v41 offset:10240
  buffer_load_dwordx4 a[48:51], v45, s[4:7], s28 offen
  s_waitcnt lgkmcnt(6)
  v_mfma_f32_16x16x32_bf16 v[16:19], a[88:91], a[8:11], v[16:19]
  ds_read_b64_tr_b16 a[72:73], v42 offset:8192
  v_mfma_f32_16x16x32_bf16 v[20:23], a[88:91], a[12:15], v[20:23]
  ds_read_b64_tr_b16 a[74:75], v42 offset:10240
  buffer_load_dwordx4 a[52:55], v46, s[4:7], s28 offen
  s_add_u32 s28, s28, 1024
  s_waitcnt lgkmcnt(6)
  v_mfma_f32_16x16x32_bf16 v[28:31], a[92:95], a[12:15], v[28:31]
  ds_read_b64_tr_b16 a[76:77], v43 offset:8192
  v_mfma_f32_16x16x32_bf16 v[24:27], a[92:95], a[8:11], v[24:27]
  ds_read_b64_tr_b16 a[78:79], v43 offset:10240
  s_waitcnt vmcnt(12) lgkmcnt(6)
  v_mfma_f32_16x16x32_bf16 v[0:3], a[64:67], a[16:19], v[0:3]
  ds_read_b64_tr_b16 a[80:81], v40 offset:12288
  v_mfma_f32_16x16x32_bf16 v[4:7], a[64:67], a[20:23], v[4:7]
  ds_read_b64_tr_b16 a[82:83], v40 offset:14336
  s_add_u32 m0, s30, 32768
  s_nop 0
  buffer_load_dwordx4 v44, s[8:11], s29 offen lds
  s_add_u32 s29, s29, 65536
  s_waitcnt lgkmcnt(6)
  v_mfma_f32_16x16x32_bf16 v[12:15], a[68:71], a[20:23], v[12:15]
  ds_read_b64_tr_b16 a[84:85], v41 offset:12288
  v_mfma_f32_16x16x32_bf16 v[8:11], a[68:71], a[16:19], v[8:11]
  ds_read_b64_tr_b16 a[86:87], v41 offset:14336
  buffer_load_dwordx4 a[0:3], v45, s[4:7], s28 offen
  s_waitcnt lgkmcnt(6)
  v_mfma_f32_16x16x32_bf16 v[16:19], a[72:75], a[16:19], v[16:19]
  ds_read_b64_tr_b16 a[88:89], v42 offset:12288
  v_mfma_f32_16x16x32_bf16 v[20:23], a[72:75], a[20:23], v[20:23]
  ds_read_b64_tr_b16 a[90:91], v42 offset:14336
  buffer_load_dwordx4 a[4:7], v46, s[4:7], s28 offen
  s_add_u32 s28, s28, 1024
  s_waitcnt lgkmcnt(6)
  v_mfma_f32_16x16x32_bf16 v[28:31], a[76:79], a[20:23], v[28:31]
  ds_read_b64_tr_b16 a[92:93], v43 offset:12288
  v_mfma_f32_16x16x32_bf16 v[24:27], a[76:79], a[16:19], v[24:27]
  ds_read_b64_tr_b16 a[94:95], v43 offset:14336
  s_waitcnt vmcnt(12) lgkmcnt(6)
  v_mfma_f32_16x16x32_bf16 v[0:3], a[80:83], a[24:27], v[0:3]
  s_waitcnt vmcnt(11)
  s_barrier
  ds_read_b64_tr_b16 a[64:65], v40 offset:16384
  v_mfma_f32_16x16x32_bf16 v[4:7], a[80:83], a[28:31], v[4:7]
  ds_read_b64_tr_b16 a[66:67], v40 offset:18432
  s_add_u32 m0, s30, 36864
  s_nop 0
  buffer_load_dwordx4 v44, s[8:11], s29 offen lds
  s_add_u32 s29, s29, 65536
  s_waitcnt lgkmcnt(6)
  v_mfma_f32_16x16x32_bf16 v[12:15], a[84:87], a[28:31], v[12:15]
  ds_read_b64_tr_b16 a[68:69], v41 offset:16384
  v_mfma_f32_16x16x32_bf16 v[8:11], a[84:87], a[24:27], v[8:11]
  ds_read_b64_tr_b16 a[70:71], v41 offset:18432
  buffer_load_dwordx4 a[8:11], v45, s[4:7], s28 offen
  s_waitcnt lgkmcnt(6)
  v_mfma_f32_16x16x32_bf16 v[16:19], a[88:91], a[24:27], v[16:19]
  ds_read_b64_tr_b16 a[72:73], v42 offset:16384
  v_mfma_f32_16x16x32_bf16 v[20:23], a[88:91], a[28:31], v[20:23]
  ds_read_b64_tr_b16 a[74:75], v42 offset:18432
  buffer_load_dwordx4 a[12:15], v46, s[4:7], s28 offen
  s_add_u32 s28, s28, 1024
  s_waitcnt lgkmcnt(6)
  v_mfma_f32_16x16x32_bf16 v[28:31], a[92:95], a[28:31], v[28:31]
  ds_read_b64_tr_b16 a[76:77], v43 offset:16384
  v_mfma_f32_16x16x32_bf16 v[24:27], a[92:95], a[24:27], v[24:27]
  ds_read_b64_tr_b16 a[78:79], v43 offset:18432
  s_waitcnt vmcnt(12) lgkmcnt(6)
  v_mfma_f32_16x16x32_bf16 v[0:3], a[64:67], a[32:35], v[0:3]
  ds_read_b64_tr_b16 a[80:81], v40 offset:20480
  v_mfma_f32_16x16x32_bf16 v[4:7], a[64:67], a[36:39], v[4:7]
  ds_read_b64_tr_b16 a[82:83], v40 offset:22528
  s_add_u32 m0, s30, 40960
  s_add_u32 s43, s29, s27
  buffer_load_dwordx4 v44, s[8:11], s43 offen lds
  s_add_u32 s29, s29, 65536
  s_waitcnt lgkmcnt(6)
  v_mfma_f32_16x16x32_bf16 v[12:15], a[68:71], a[36:39], v[12:15]
  ds_read_b64_tr_b16 a[84:85], v41 offset:20480
  v_mfma_f32_16x16x32_bf16 v[8:11], a[68:71], a[32:35], v[8:11]
  ds_read_b64_tr_b16 a[86:87], v41 offset:22528
  buffer_load_dwordx4 a[16:19], v45, s[4:7], s28 offen
  s_waitcnt lgkmcnt(6)
  v_mfma_f32_16x16x32_bf16 v[16:19], a[72:75], a[32:35], v[16:19]
  ds_read_b64_tr_b16 a[88:89], v42 offset:20480
  v_mfma_f32_16x16x32_bf16 v[20:23], a[72:75], a[36:39], v[20:23]
  ds_read_b64_tr_b16 a[90:91], v42 offset:22528
  buffer_load_dwordx4 a[20:23], v46, s[4:7], s28 offen
  s_add_u32 s28, s28, 1024
  s_waitcnt lgkmcnt(6)
  v_mfma_f32_16x16x32_bf16 v[28:31], a[76:79], a[36:39], v[28:31]
  ds_read_b64_tr_b16 a[92:93], v43 offset:20480
  v_mfma_f32_16x16x32_bf16 v[24:27], a[76:79], a[32:35], v[24:27]
  ds_read_b64_tr_b16 a[94:95], v43 offset:22528
  s_waitcnt vmcnt(12) lgkmcnt(6)
  v_mfma_f32_16x16x32_bf16 v[0:3], a[80:83], a[40:43], v[0:3]
  s_waitcnt vmcnt(11)
  s_barrier
  ds_read_b64_tr_b16 a[64:65], v40 offset:24576
  v_mfma_f32_16x16x32_bf16 v[4:7], a[80:83], a[44:47], v[4:7]
  ds_read_b64_tr_b16 a[66:67], v40 offset:26624
  s_add_u32 m0, s30, 45056
  s_nop 0
  buffer_load_dwordx4 v44, s[8:11], s29 offen lds
  s_add_u32 s29, s29, 65536
  s_waitcnt lgkmcnt(6)
  v_mfma_f32_16x16x32_bf16 v[12:15], a[84:87], a[44:47], v[12:15]
  ds_read_b64_tr_b16 a[68:69], v41 offset:24576
  v_mfma_f32_16x16x32_bf16 v[8:11], a[84:87], a[40:43], v[8:11]
  ds_read_b64_tr_b16 a[70:71], v41 offset:26624
  buffer_load_dwordx4 a[24:27], v45, s[4:7], s28 offen
  s_waitcnt lgkmcnt(6)
  v_mfma_f32_16x16x32_bf16 v[16:19], a[88:91], a[40:43], v[16:19]
  ds_read_b64_tr_b16 a[72:73], v42 offset:24576
  v_mfma_f32_16x16x32_bf16 v[20:23], a[88:91], a[44:47], v[20:23]
  ds_read_b64_tr_b16 a[74:75], v42 offset:26624
  buffer_load_dwordx4 a[28:31], v46, s[4:7], s28 offen
  s_add_u32 s28, s28, 1024
  s_waitcnt lgkmcnt(6)
  v_mfma_f32_16x16x32_bf16 v[28:31], a[92:95], a[44:47], v[28:31]
  ds_read_b64_tr_b16 a[76:77], v43 offset:24576
  v_mfma_f32_16x16x32_bf16 v[24:27], a[92:95], a[40:43], v[24:27]
  ds_read_b64_tr_b16 a[78:79], v43 offset:26624
  s_waitcnt vmcnt(12) lgkmcnt(6)
  v_mfma_f32_16x16x32_bf16 v[0:3], a[64:67], a[48:51], v[0:3]
  ds_read_b64_tr_b16 a[80:81], v40 offset:28672
  v_mfma_f32_16x16x32_bf16 v[4:7], a[64:67], a[52:55], v[4:7]
  ds_read_b64_tr_b16 a[82:83], v40 offset:30720
  s_add_u32 m0, s30, 49152
  s_nop 0
  buffer_load_dwordx4 v44, s[8:11], s29 offen lds
  s_add_u32 s29, s29, 65536
  s_waitcnt lgkmcnt(6)
  v_mfma_f32_16x16x32_bf16 v[12:15], a[68:71], a[52:55], v[12:15]
  ds_read_b64_tr_b16 a[84:85], v41 offset:28672
  v_mfma_f32_16x16x32_bf16 v[8:11], a[68:71], a[48:51], v[8:11]
  ds_read_b64_tr_b16 a[86:87], v41 offset:30720
  buffer_load_dwordx4 a[32:35], v45, s[4:7], s28 offen
  s_waitcnt lgkmcnt(6)
  v_mfma_f32_16x16x32_bf16 v[16:19], a[72:75], a[48:51], v[16:19]
  ds_read_b64_tr_b16 a[88:89], v42 offset:28672
  v_mfma_f32_16x16x32_bf16 v[20:23], a[72:75], a[52:55], v[20:23]
  ds_read_b64_tr_b16 a[90:91], v42 offset:30720
  buffer_load_dwordx4 a[36:39], v46, s[4:7], s28 offen
  s_add_u32 s28, s28, 1024
  s_waitcnt lgkmcnt(6)
  v_mfma_f32_16x16x32_bf16 v[28:31], a[76:79], a[52:55], v[28:31]
  ds_read_b64_tr_b16 a[92:93], v43 offset:28672
  v_mfma_f32_16x16x32_bf16 v[24:27], a[76:79], a[48:51], v[24:27]
  ds_read_b64_tr_b16 a[94:95], v43 offset:30720
  s_waitcnt vmcnt(12) lgkmcnt(6)
  v_mfma_f32_16x16x32_bf16 v[0:3], a[80:83], a[0:3], v[0:3]
  s_waitcnt vmcnt(11)
  s_barrier
  ds_read_b64_tr_b16 a[64:65], v40 offset:32768
  v_mfma_f32_16x16x32_bf16 v[4:7], a[80:83], a[4:7], v[4:7]
  ds_read_b64_tr_b16 a[66:67], v40 offset:34816
  s_add_u32 m0, s30, 53248
  s_nop 0
  buffer_load_dwordx4 v44, s[8:11], s29 offen lds
  s_add_u32 s29, s29, 65536
  s_waitcnt lgkmcnt(6)
  v_mfma_f32_16x16x32_bf16 v[12:15], a[84:87], a[4:7], v[12:15]
  ds_read_b64_tr_b16 a[68:69], v41 offset:32768
  v_mfma_f32_16x16x32_bf16 v[8:11], a[84:87], a[0:3], v[8:11]
  ds_read_b64_tr_b16 a[70:71], v41 offset:34816
  buffer_load_dwordx4 a[40:43], v45, s[4:7], s28 offen
  s_waitcnt lgkmcnt(6)
  v_mfma_f32_16x16x32_bf16 v[16:19], a[88:91], a[0:3], v[16:19]
  ds_read_b64_tr_b16 a[72:73], v42 offset:32768
  v_mfma_f32_16x16x32_bf16 v[20:23], a[88:91], a[4:7], v[20:23]
  ds_read_b64_tr_b16 a[74:75], v42 offset:34816
  buffer_load_dwordx4 a[44:47], v46, s[4:7], s28 offen
  s_add_u32 s28, s28, 1024
  s_waitcnt lgkmcnt(6)
  v_mfma_f32_16x16x32_bf16 v[28:31], a[92:95], a[4:7], v[28:31]
  ds_read_b64_tr_b16 a[76:77], v43 offset:32768
  v_mfma_f32_16x16x32_bf16 v[24:27], a[92:95], a[0:3], v[24:27]
  ds_read_b64_tr_b16 a[78:79], v43 offset:34816
  s_waitcnt vmcnt(12) lgkmcnt(6)
  v_mfma_f32_16x16x32_bf16 v[0:3], a[64:67], a[8:11], v[0:3]
  ds_read_b64_tr_b16 a[80:81], v40 offset:36864
  v_mfma_f32_16x16x32_bf16 v[4:7], a[64:67], a[12:15], v[4:7]
  ds_read_b64_tr_b16 a[82:83], v40 offset:38912
  s_add_u32 m0, s30, 0
  s_nop 0
  buffer_load_dwordx4 v44, s[8:11], s29 offen lds
  s_add_u32 s29, s29, 65536
  s_waitcnt lgkmcnt(6)
  v_mfma_f32_16x16x32_bf16 v[12:15], a[68:71], a[12:15], v[12:15]
  ds_read_b64_tr_b16 a[84:85], v41 offset:36864
  v_mfma_f32_16x16x32_bf16 v[8:11], a[68:71], a[8:11], v[8:11]
  ds_read_b64_tr_b16 a[86:87], v41 offset:38912
  buffer_load_dwordx4 a[48:51], v45, s[4:7], s28 offen
  s_waitcnt lgkmcnt(6)
  v_mfma_f32_16x16x32_bf16 v[16:19], a[72:75], a[8:11], v[16:19]
  ds_read_b64_tr_b16 a[88:89], v42 offset:36864
  v_mfma_f32_16x16x32_bf16 v[20:23], a[72:75], a[12:15], v[20:23]
  ds_read_b64_tr_b16 a[90:91], v42 offset:38912
  buffer_load_dwordx4 a[52:55], v46, s[4:7], s28 offen
  s_add_u32 s28, s28, 1024
  s_waitcnt lgkmcnt(6)
  v_mfma_f32_16x16x32_bf16 v[28:31], a[76:79], a[12:15], v[28:31]
  ds_read_b64_tr_b16 a[92:93], v43 offset:36864
  v_mfma_f32_16x16x32_bf16 v[24:27], a[76:79], a[8:11], v[24:27]
  ds_read_b64_tr_b16 a[94:95], v43 offset:38912
  s_waitcnt vmcnt(12) lgkmcnt(6)
  v_mfma_f32_16x16x32_bf16 v[0:3], a[80:83], a[16:19], v[0:3]
  s_waitcnt vmcnt(11)
  s_barrier
  ds_read_b64_tr_b16 a[64:65], v40 offset:40960
  v_mfma_f32_16x16x32_bf16 v[4:7], a[80:83], a[20:23], v[4:7]
  ds_read_b64_tr_b16 a[66:67], v40 offset:43008
  s_add_u32 m0, s30, 4096
  s_nop 0
  buffer_load_dwordx4 v44, s[8:11], s29 offen lds
  s_add_u32 s29, s29, 65536
  s_waitcnt lgkmcnt(6)
  v_mfma_f32_16x16x32_bf16 v[12:15], a[84:87], a[20:23], v[12:15]
  ds_read_b64_tr_b16 a[68:69], v41 offset:40960
  v_mfma_f32_16x16x32_bf16 v[8:11], a[84:87], a[16:19], v[8:11]
  ds_read_b64_tr_b16 a[70:71], v41 offset:43008
  buffer_load_dwordx4 a[0:3], v45, s[4:7], s28 offen
  s_waitcnt lgkmcnt(6)
  v_mfma_f32_16x16x32_bf16 v[16:19], a[88:91], a[16:19], v[16:19]
  ds_read_b64_tr_b16 a[72:73], v42 offset:40960
  v_mfma_f32_16x16x32_bf16 v[20:23], a[88:91], a[20:23], v[20:23]
  ds_read_b64_tr_b16 a[74:75], v42 offset:43008
  buffer_load_dwordx4 a[4:7], v46, s[4:7], s28 offen
  s_add_u32 s28, s28, 1024
  s_waitcnt lgkmcnt(6)
  v_mfma_f32_16x16x32_bf16 v[28:31], a[92:95], a[20:23], v[28:31]
  ds_read_b64_tr_b16 a[76:77], v43 offset:40960
  v_mfma_f32_16x16x32_bf16 v[24:27], a[92:95], a[16:19], v[24:27]
  ds_read_b64_tr_b16 a[78:79], v43 offset:43008
  s_waitcnt vmcnt(12) lgkmcnt(6)
  v_mfma_f32_16x16x32_bf16 v[0:3], a[64:67], a[24:27], v[0:3]
  ds_read_b64_tr_b16 a[80:81], v40 offset:45056
  v_mfma_f32_16x16x32_bf16 v[4:7], a[64:67], a[28:31], v[4:7]
  ds_read_b64_tr_b16 a[82:83], v40 offset:47104
  s_add_u32 m0, s30, 8192
  s_nop 0
  buffer_load_dwordx4 v44, s[8:11], s29 offen lds
  s_add_u32 s29, s29, 65536
  s_waitcnt lgkmcnt(6)
  v_mfma_f32_16x16x32_bf16 v[12:15], a[68:71], a[28:31], v[12:15]
  ds_read_b64_tr_b16 a[84:85], v41 offset:45056
  v_mfma_f32_16x16x32_bf16 v[8:11], a[68:71], a[24:27], v[8:11]
  ds_read_b64_tr_b16 a[86:87], v41 offset:47104
  buffer_load_dwordx4 a[8:11], v45, s[4:7], s28 offen
  s_waitcnt lgkmcnt(6)
  v_mfma_f32_16x16x32_bf16 v[16:19], a[72:75], a[24:27], v[16:19]
  ds_read_b64_tr_b16 a[88:89], v42 offset:45056
  v_mfma_f32_16x16x32_bf16 v[20:23], a[72:75], a[28:31], v[20:23]
  ds_read_b64_tr_b16 a[90:91], v42 offset:47104
  buffer_load_dwordx4 a[12:15], v46, s[4:7], s28 offen
  s_add_u32 s28, s28, 1024
  s_waitcnt lgkmcnt(6)
  v_mfma_f32_16x16x32_bf16 v[28:31], a[76:79], a[28:31], v[28:31]
  ds_read_b64_tr_b16 a[92:93], v43 offset:45056
  v_mfma_f32_16x16x32_bf16 v[24:27], a[76:79], a[24:27], v[24:27]
  ds_read_b64_tr_b16 a[94:95], v43 offset:47104
  s_waitcnt vmcnt(12) lgkmcnt(6)
  v_mfma_f32_16x16x32_bf16 v[0:3], a[80:83], a[32:35], v[0:3]
  s_waitcnt vmcnt(11)
  s_barrier
  ds_read_b64_tr_b16 a[64:65], v40 offset:49152
  v_mfma_f32_16x16x32_bf16 v[4:7], a[80:83], a[36:39], v[4:7]
  ds_read_b64_tr_b16 a[66:67], v40 offset:51200
  s_add_u32 m0, s30, 12288
  s_add_u32 s43, s29, s27
  buffer_load_dwordx4 v44, s[8:11], s43 offen lds
  s_add_u32 s29, s29, 65536
  s_waitcnt lgkmcnt(6)
  v_mfma_f32_16x16x32_bf16 v[12:15], a[84:87], a[36:39], v[12:15]
  ds_read_b64_tr_b16 a[68:69], v41 offset:49152
  v_mfma_f32_16x16x32_bf16 v[8:11], a[84:87], a[32:35], v[8:11]
  ds_read_b64_tr_b16 a[70:71], v41 offset:51200
  buffer_load_dwordx4 a[16:19], v45, s[4:7], s28 offen
  s_waitcnt lgkmcnt(6)
  v_mfma_f32_16x16x32_bf16 v[16:19], a[88:91], a[32:35], v[16:19]
  ds_read_b64_tr_b16 a[72:73], v42 offset:49152
  v_mfma_f32_16x16x32_bf16 v[20:23], a[88:91], a[36:39], v[20:23]
  ds_read_b64_tr_b16 a[74:75], v42 offset:51200
  buffer_load_dwordx4 a[20:23], v46, s[4:7], s28 offen
  s_add_u32 s28, s28, 1024
  s_waitcnt lgkmcnt(6)
  v_mfma_f32_16x16x32_bf16 v[28:31], a[92:95], a[36:39], v[28:31]
  ds_read_b64_tr_b16 a[76:77], v43 offset:49152
  v_mfma_f32_16x16x32_bf16 v[24:27], a[92:95], a[32:35], v[24:27]
  ds_read_b64_tr_b16 a[78:79], v43 offset:51200
  s_waitcnt vmcnt(12) lgkmcnt(6)
  v_mfma_f32_16x16x32_bf16 v[0:3], a[64:67], a[40:43], v[0:3]
  ds_read_b64_tr_b16 a[80:81], v40 offset:53248
  v_mfma_f32_16x16x32_bf16 v[4:7], a[64:67], a[44:47], v[4:7]
  ds_read_b64_tr_b16 a[82:83], v40 offset:55296
  s_add_u32 m0, s30, 16384
  s_nop 0
  buffer_load_dwordx4 v44, s[8:11], s29 offen lds
  s_add_u32 s29, s29, 65536
  s_waitcnt lgkmcnt(6)
  v_mfma_f32_16x16x32_bf16 v[12:15], a[68:71], a[44:47], v[12:15]
  ds_read_b64_tr_b16 a[84:85], v41 offset:53248
  v_mfma_f32_16x16x32_bf16 v[8:11], a[68:71], a[40:43], v[8:11]
  ds_read_b64_tr_b16 a[86:87], v41 offset:55296
  buffer_load_dwordx4 a[24:27], v45, s[4:7], s28 offen
  s_waitcnt lgkmcnt(6)
  v_mfma_f32_16x16x32_bf16 v[16:19], a[72:75], a[40:43], v[16:19]
  ds_read_b64_tr_b16 a[88:89], v42 offset:53248
  v_mfma_f32_16x16x32_bf16 v[20:23], a[72:75], a[44:47], v[20:23]
  ds_read_b64_tr_b16 a[90:91], v42 offset:55296
  buffer_load_dwordx4 a[28:31], v46, s[4:7], s28 offen
  s_add_u32 s28, s28, 1024
  s_waitcnt lgkmcnt(6)
  v_mfma_f32_16x16x32_bf16 v[28:31], a[76:79], a[44:47], v[28:31]
  ds_read_b64_tr_b16 a[92:93], v43 offset:53248
  v_mfma_f32_16x16x32_bf16 v[24:27], a[76:79], a[40:43], v[24:27]
  ds_read_b64_tr_b16 a[94:95], v43 offset:55296
  s_waitcnt vmcnt(12) lgkmcnt(6)
  v_mfma_f32_16x16x32_bf16 v[0:3], a[80:83], a[48:51], v[0:3]
  s_waitcnt vmcnt(11)
  s_barrier
  ds_read_b64_tr_b16 a[64:65], v40 offset:0
  v_mfma_f32_16x16x32_bf16 v[4:7], a[80:83], a[52:55], v[4:7]
  ds_read_b64_tr_b16 a[66:67], v40 offset:2048
  s_add_u32 m0, s30, 20480
  s_nop 0
  buffer_load_dwordx4 v44, s[8:11], s29 offen lds
  s_add_u32 s29, s29, 65536
  s_waitcnt lgkmcnt(6)
  v_mfma_f32_16x16x32_bf16 v[12:15], a[84:87], a[52:55], v[12:15]
  ds_read_b64_tr_b16 a[68:69], v41 offset:0
  v_mfma_f32_16x16x32_bf16 v[8:11], a[84:87], a[48:51], v[8:11]
  ds_read_b64_tr_b16 a[70:71], v41 offset:2048
  buffer_load_dwordx4 a[32:35], v45, s[4:7], s28 offen
  s_waitcnt lgkmcnt(6)
  v_mfma_f32_16x16x32_bf16 v[16:19], a[88:91], a[48:51], v[16:19]
  ds_read_b64_tr_b16 a[72:73], v42 offset:0
  v_mfma_f32_16x16x32_bf16 v[20:23], a[88:91], a[52:55], v[20:23]
  ds_read_b64_tr_b16 a[74:75], v42 offset:2048
  buffer_load_dwordx4 a[36:39], v46, s[4:7], s28 offen
  s_add_u32 s28, s28, 1024
  s_waitcnt lgkmcnt(6)
  v_mfma_f32_16x16x32_bf16 v[28:31], a[92:95], a[52:55], v[28:31]
  ds_read_b64_tr_b16 a[76:77], v43 offset:0
  v_mfma_f32_16x16x32_bf16 v[24:27], a[92:95], a[48:51], v[24:27]
  ds_read_b64_tr_b16 a[78:79], v43 offset:2048
  s_sub_u32 s31, s31, 1
  s_cmp_lg_u32 s31, 0
  s_cbranch_scc1 Ldown_body_loop
  s_waitcnt vmcnt(12) lgkmcnt(6)
  v_mfma_f32_16x16x32_bf16 v[0:3], a[64:67], a[0:3], v[0:3]
  ds_read_b64_tr_b16 a[80:81], v40 offset:4096
  v_mfma_f32_16x16x32_bf16 v[4:7], a[64:67], a[4:7], v[4:7]
  ds_read_b64_tr_b16 a[82:83], v40 offset:6144
  s_add_u32 m0, s30, 24576
  s_nop 0
  buffer_load_dwordx4 v44, s[8:11], s29 offen lds
  s_add_u32 s29, s29, 65536
  s_waitcnt lgkmcnt(6)
  v_mfma_f32_16x16x32_bf16 v[12:15], a[68:71], a[4:7], v[12:15]
  ds_read_b64_tr_b16 a[84:85], v41 offset:4096
  v_mfma_f32_16x16x32_bf16 v[8:11], a[68:71], a[0:3], v[8:11]
  ds_read_b64_tr_b16 a[86:87], v41 offset:6144
  buffer_load_dwordx4 a[40:43], v45, s[4:7], s28 offen
  s_waitcnt lgkmcnt(6)
  v_mfma_f32_16x16x32_bf16 v[16:19], a[72:75], a[0:3], v[16:19]
  ds_read_b64_tr_b16 a[88:89], v42 offset:4096
  v_mfma_f32_16x16x32_bf16 v[20:23], a[72:75], a[4:7], v[20:23]
  ds_read_b64_tr_b16 a[90:91], v42 offset:6144
  buffer_load_dwordx4 a[44:47], v46, s[4:7], s28 offen
  s_add_u32 s28, s28, 1024
  s_waitcnt lgkmcnt(6)
  v_mfma_f32_16x16x32_bf16 v[28:31], a[76:79], a[4:7], v[28:31]
  ds_read_b64_tr_b16 a[92:93], v43 offset:4096
  v_mfma_f32_16x16x32_bf16 v[24:27], a[76:79], a[0:3], v[24:27]
  ds_read_b64_tr_b16 a[94:95], v43 offset:6144
  s_waitcnt vmcnt(12) lgkmcnt(6)
  v_mfma_f32_16x16x32_bf16 v[0:3], a[80:83], a[8:11], v[0:3]
  s_waitcnt vmcnt(11)
  s_barrier
  ds_read_b64_tr_b16 a[64:65], v40 offset:8192
  v_mfma_f32_16x16x32_bf16 v[4:7], a[80:83], a[12:15], v[4:7]
  ds_read_b64_tr_b16 a[66:67], v40 offset:10240
  s_add_u32 m0, s30, 28672
  s_nop 0
  buffer_load_dwordx4 v44, s[8:11], s29 offen lds
  s_add_u32 s29, s29, 65536
  s_waitcnt lgkmcnt(6)
  v_mfma_f32_16x16x32_bf16 v[12:15], a[84:87], a[12:15], v[12:15]
  ds_read_b64_tr_b16 a[68:69], v41 offset:8192
  v_mfma_f32_16x16x32_bf16 v[8:11], a[84:87], a[8:11], v[8:11]
  ds_read_b64_tr_b16 a[70:71], v41 offset:10240
  buffer_load_dwordx4 a[48:51], v45, s[4:7], s28 offen
  s_waitcnt lgkmcnt(6)
  v_mfma_f32_16x16x32_bf16 v[16:19], a[88:91], a[8:11], v[16:19]
  ds_read_b64_tr_b16 a[72:73], v42 offset:8192
  v_mfma_f32_16x16x32_bf16 v[20:23], a[88:91], a[12:15], v[20:23]
  ds_read_b64_tr_b16 a[74:75], v42 offset:10240
  buffer_load_dwordx4 a[52:55], v46, s[4:7], s28 offen
  s_add_u32 s28, s28, 1024
  s_waitcnt lgkmcnt(6)
  v_mfma_f32_16x16x32_bf16 v[28:31], a[92:95], a[12:15], v[28:31]
  ds_read_b64_tr_b16 a[76:77], v43 offset:8192
  v_mfma_f32_16x16x32_bf16 v[24:27], a[92:95], a[8:11], v[24:27]
  ds_read_b64_tr_b16 a[78:79], v43 offset:10240
  s_waitcnt vmcnt(12) lgkmcnt(6)
  v_mfma_f32_16x16x32_bf16 v[0:3], a[64:67], a[16:19], v[0:3]
  ds_read_b64_tr_b16 a[80:81], v40 offset:12288
  v_mfma_f32_16x16x32_bf16 v[4:7], a[64:67], a[20:23], v[4:7]
  ds_read_b64_tr_b16 a[82:83], v40 offset:14336
  s_add_u32 m0, s30, 32768
  s_nop 0
  buffer_load_dwordx4 v44, s[8:11], s29 offen lds
  s_add_u32 s29, s29, 65536
  s_waitcnt lgkmcnt(6)
  v_mfma_f32_16x16x32_bf16 v[12:15], a[68:71], a[20:23], v[12:15]
  ds_read_b64_tr_b16 a[84:85], v41 offset:12288
  v_mfma_f32_16x16x32_bf16 v[8:11], a[68:71], a[16:19], v[8:11]
  ds_read_b64_tr_b16 a[86:87], v41 offset:14336
  buffer_load_dwordx4 a[0:3], v45, s[4:7], s28 offen
  s_waitcnt lgkmcnt(6)
  v_mfma_f32_16x16x32_bf16 v[16:19], a[72:75], a[16:19], v[16:19]
  ds_read_b64_tr_b16 a[88:89], v42 offset:12288
  v_mfma_f32_16x16x32_bf16 v[20:23], a[72:75], a[20:23], v[20:23]
  ds_read_b64_tr_b16 a[90:91], v42 offset:14336
  buffer_load_dwordx4 a[4:7], v46, s[4:7], s28 offen
  s_add_u32 s28, s28, 1024
  s_waitcnt lgkmcnt(6)
  v_mfma_f32_16x16x32_bf16 v[28:31], a[76:79], a[20:23], v[28:31]
  ds_read_b64_tr_b16 a[92:93], v43 offset:12288
  v_mfma_f32_16x16x32_bf16 v[24:27], a[76:79], a[16:19], v[24:27]
  ds_read_b64_tr_b16 a[94:95], v43 offset:14336
  s_waitcnt vmcnt(12) lgkmcnt(6)
  v_mfma_f32_16x16x32_bf16 v[0:3], a[80:83], a[24:27], v[0:3]
  s_waitcnt vmcnt(11)
  s_barrier
  ds_read_b64_tr_b16 a[64:65], v40 offset:16384
  v_mfma_f32_16x16x32_bf16 v[4:7], a[80:83], a[28:31], v[4:7]
  ds_read_b64_tr_b16 a[66:67], v40 offset:18432
  s_add_u32 m0, s30, 36864
  s_nop 0
  buffer_load_dwordx4 v44, s[8:11], s29 offen lds
  s_add_u32 s29, s29, 65536
  s_waitcnt lgkmcnt(6)
  v_mfma_f32_16x16x32_bf16 v[12:15], a[84:87], a[28:31], v[12:15]
  ds_read_b64_tr_b16 a[68:69], v41 offset:16384
  v_mfma_f32_16x16x32_bf16 v[8:11], a[84:87], a[24:27], v[8:11]
  ds_read_b64_tr_b16 a[70:71], v41 offset:18432
  buffer_load_dwordx4 a[8:11], v45, s[4:7], s28 offen
  s_waitcnt lgkmcnt(6)
  v_mfma_f32_16x16x32_bf16 v[16:19], a[88:91], a[24:27], v[16:19]
  ds_read_b64_tr_b16 a[72:73], v42 offset:16384
  v_mfma_f32_16x16x32_bf16 v[20:23], a[88:91], a[28:31], v[20:23]
  ds_read_b64_tr_b16 a[74:75], v42 offset:18432
  buffer_load_dwordx4 a[12:15], v46, s[4:7], s28 offen
  s_add_u32 s28, s28, 1024
  s_waitcnt lgkmcnt(6)
  v_mfma_f32_16x16x32_bf16 v[28:31], a[92:95], a[28:31], v[28:31]
  ds_read_b64_tr_b16 a[76:77], v43 offset:16384
  v_mfma_f32_16x16x32_bf16 v[24:27], a[92:95], a[24:27], v[24:27]
  ds_read_b64_tr_b16 a[78:79], v43 offset:18432
  s_waitcnt vmcnt(12) lgkmcnt(6)
  v_mfma_f32_16x16x32_bf16 v[0:3], a[64:67], a[32:35], v[0:3]
  ds_read_b64_tr_b16 a[80:81], v40 offset:20480
  v_mfma_f32_16x16x32_bf16 v[4:7], a[64:67], a[36:39], v[4:7]
  ds_read_b64_tr_b16 a[82:83], v40 offset:22528
  s_add_u32 m0, s30, 40960
  s_add_u32 s43, s29, s27
  buffer_load_dwordx4 v44, s[8:11], s43 offen lds
  s_add_u32 s29, s29, 65536
  s_waitcnt lgkmcnt(6)
  v_mfma_f32_16x16x32_bf16 v[12:15], a[68:71], a[36:39], v[12:15]
  ds_read_b64_tr_b16 a[84:85], v41 offset:20480
  v_mfma_f32_16x16x32_bf16 v[8:11], a[68:71], a[32:35], v[8:11]
  ds_read_b64_tr_b16 a[86:87], v41 offset:22528
  buffer_load_dwordx4 a[16:19], v45, s[4:7], s28 offen
  s_waitcnt lgkmcnt(6)
  v_mfma_f32_16x16x32_bf16 v[16:19], a[72:75], a[32:35], v[16:19]
  ds_read_b64_tr_b16 a[88:89], v42 offset:20480
  v_mfma_f32_16x16x32_bf16 v[20:23], a[72:75], a[36:39], v[20:23]
  ds_read_b64_tr_b16 a[90:91], v42 offset:22528
  buffer_load_dwordx4 a[20:23], v46, s[4:7], s28 offen
  s_add_u32 s28, s28, 1024
  s_waitcnt lgkmcnt(6)
  v_mfma_f32_16x16x32_bf16 v[28:31], a[76:79], a[36:39], v[28:31]
  ds_read_b64_tr_b16 a[92:93], v43 offset:20480
  v_mfma_f32_16x16x32_bf16 v[24:27], a[76:79], a[32:35], v[24:27]
  ds_read_b64_tr_b16 a[94:95], v43 offset:22528
  s_waitcnt vmcnt(12) lgkmcnt(6)
  v_mfma_f32_16x16x32_bf16 v[0:3], a[80:83], a[40:43], v[0:3]
  s_waitcnt vmcnt(11)
  s_barrier
  ds_read_b64_tr_b16 a[64:65], v40 offset:24576
  v_mfma_f32_16x16x32_bf16 v[4:7], a[80:83], a[44:47], v[4:7]
  ds_read_b64_tr_b16 a[66:67], v40 offset:26624
  s_add_u32 m0, s30, 45056
  s_nop 0
  buffer_load_dwordx4 v44, s[8:11], s29 offen lds
  s_add_u32 s29, s29, 65536
  s_waitcnt lgkmcnt(6)
  v_mfma_f32_16x16x32_bf16 v[12:15], a[84:87], a[44:47], v[12:15]
  ds_read_b64_tr_b16 a[68:69], v41 offset:24576
  v_mfma_f32_16x16x32_bf16 v[8:11], a[84:87], a[40:43], v[8:11]
  ds_read_b64_tr_b16 a[70:71], v41 offset:26624
  buffer_load_dwordx4 a[24:27], v45, s[4:7], s28 offen
  s_waitcnt lgkmcnt(6)
  v_mfma_f32_16x16x32_bf16 v[16:19], a[88:91], a[40:43], v[16:19]
  ds_read_b64_tr_b16 a[72:73], v42 offset:24576
  v_mfma_f32_16x16x32_bf16 v[20:23], a[88:91], a[44:47], v[20:23]
  ds_read_b64_tr_b16 a[74:75], v42 offset:26624
  buffer_load_dwordx4 a[28:31], v46, s[4:7], s28 offen
  s_add_u32 s28, s28, 1024
  s_waitcnt lgkmcnt(6)
  v_mfma_f32_16x16x32_bf16 v[28:31], a[92:95], a[44:47], v[28:31]
  ds_read_b64_tr_b16 a[76:77], v43 offset:24576
  v_mfma_f32_16x16x32_bf16 v[24:27], a[92:95], a[40:43], v[24:27]
  ds_read_b64_tr_b16 a[78:79], v43 offset:26624
  s_waitcnt vmcnt(12) lgkmcnt(6)
  v_mfma_f32_16x16x32_bf16 v[0:3], a[64:67], a[48:51], v[0:3]
  ds_read_b64_tr_b16 a[80:81], v40 offset:28672
  v_mfma_f32_16x16x32_bf16 v[4:7], a[64:67], a[52:55], v[4:7]
  ds_read_b64_tr_b16 a[82:83], v40 offset:30720
  s_add_u32 m0, s30, 49152
  s_nop 0
  buffer_load_dwordx4 v44, s[8:11], s29 offen lds
  s_add_u32 s29, s29, 65536
  s_waitcnt lgkmcnt(6)
  v_mfma_f32_16x16x32_bf16 v[12:15], a[68:71], a[52:55], v[12:15]
  ds_read_b64_tr_b16 a[84:85], v41 offset:28672
  v_mfma_f32_16x16x32_bf16 v[8:11], a[68:71], a[48:51], v[8:11]
  ds_read_b64_tr_b16 a[86:87], v41 offset:30720
  buffer_load_dwordx4 a[32:35], v45, s[4:7], s28 offen
  s_waitcnt lgkmcnt(6)
  v_mfma_f32_16x16x32_bf16 v[16:19], a[72:75], a[48:51], v[16:19]
  ds_read_b64_tr_b16 a[88:89], v42 offset:28672
  v_mfma_f32_16x16x32_bf16 v[20:23], a[72:75], a[52:55], v[20:23]
  ds_read_b64_tr_b16 a[90:91], v42 offset:30720
  buffer_load_dwordx4 a[36:39], v46, s[4:7], s28 offen
  s_add_u32 s28, s28, 1024
  s_waitcnt lgkmcnt(6)
  v_mfma_f32_16x16x32_bf16 v[28:31], a[76:79], a[52:55], v[28:31]
  ds_read_b64_tr_b16 a[92:93], v43 offset:28672
  v_mfma_f32_16x16x32_bf16 v[24:27], a[76:79], a[48:51], v[24:27]
  ds_read_b64_tr_b16 a[94:95], v43 offset:30720
  s_waitcnt vmcnt(12) lgkmcnt(6)
  v_mfma_f32_16x16x32_bf16 v[0:3], a[80:83], a[0:3], v[0:3]
  s_waitcnt vmcnt(11)
  s_barrier
  ds_read_b64_tr_b16 a[64:65], v40 offset:32768
  v_mfma_f32_16x16x32_bf16 v[4:7], a[80:83], a[4:7], v[4:7]
  ds_read_b64_tr_b16 a[66:67], v40 offset:34816
  s_add_u32 m0, s30, 53248
  s_nop 0
  buffer_load_dwordx4 v44, s[8:11], s29 offen lds
  s_add_u32 s29, s29, 65536
  s_waitcnt lgkmcnt(6)
  v_mfma_f32_16x16x32_bf16 v[12:15], a[84:87], a[4:7], v[12:15]
  ds_read_b64_tr_b16 a[68:69], v41 offset:32768
  v_mfma_f32_16x16x32_bf16 v[8:11], a[84:87], a[0:3], v[8:11]
  ds_read_b64_tr_b16 a[70:71], v41 offset:34816
  buffer_load_dwordx4 a[40:43], v45, s[4:7], s28 offen
  s_waitcnt lgkmcnt(6)
  v_mfma_f32_16x16x32_bf16 v[16:19], a[88:91], a[0:3], v[16:19]
  ds_read_b64_tr_b16 a[72:73], v42 offset:32768
  v_mfma_f32_16x16x32_bf16 v[20:23], a[88:91], a[4:7], v[20:23]
  ds_read_b64_tr_b16 a[74:75], v42 offset:34816
  buffer_load_dwordx4 a[44:47], v46, s[4:7], s28 offen
  s_add_u32 s28, s28, 1024
  s_waitcnt lgkmcnt(6)
  v_mfma_f32_16x16x32_bf16 v[28:31], a[92:95], a[4:7], v[28:31]
  ds_read_b64_tr_b16 a[76:77], v43 offset:32768
  v_mfma_f32_16x16x32_bf16 v[24:27], a[92:95], a[0:3], v[24:27]
  ds_read_b64_tr_b16 a[78:79], v43 offset:34816
  s_waitcnt vmcnt(12) lgkmcnt(6)
  v_mfma_f32_16x16x32_bf16 v[0:3], a[64:67], a[8:11], v[0:3]
  ds_read_b64_tr_b16 a[80:81], v40 offset:36864
  v_mfma_f32_16x16x32_bf16 v[4:7], a[64:67], a[12:15], v[4:7]
  ds_read_b64_tr_b16 a[82:83], v40 offset:38912
  s_waitcnt lgkmcnt(6)
  v_mfma_f32_16x16x32_bf16 v[12:15], a[68:71], a[12:15], v[12:15]
  ds_read_b64_tr_b16 a[84:85], v41 offset:36864
  v_mfma_f32_16x16x32_bf16 v[8:11], a[68:71], a[8:11], v[8:11]
  ds_read_b64_tr_b16 a[86:87], v41 offset:38912
  buffer_load_dwordx4 a[48:51], v45, s[4:7], s28 offen
  s_waitcnt lgkmcnt(6)
  v_mfma_f32_16x16x32_bf16 v[16:19], a[72:75], a[8:11], v[16:19]
  ds_read_b64_tr_b16 a[88:89], v42 offset:36864
  v_mfma_f32_16x16x32_bf16 v[20:23], a[72:75], a[12:15], v[20:23]
  ds_read_b64_tr_b16 a[90:91], v42 offset:38912
  buffer_load_dwordx4 a[52:55], v46, s[4:7], s28 offen
  s_add_u32 s28, s28, 1024
  s_waitcnt lgkmcnt(6)
  v_mfma_f32_16x16x32_bf16 v[28:31], a[76:79], a[12:15], v[28:31]
  ds_read_b64_tr_b16 a[92:93], v43 offset:36864
  v_mfma_f32_16x16x32_bf16 v[24:27], a[76:79], a[8:11], v[24:27]
  ds_read_b64_tr_b16 a[94:95], v43 offset:38912
  s_waitcnt vmcnt(11) lgkmcnt(6)
  v_mfma_f32_16x16x32_bf16 v[0:3], a[80:83], a[16:19], v[0:3]
  s_waitcnt vmcnt(10)
  s_barrier
  ds_read_b64_tr_b16 a[64:65], v40 offset:40960
  v_mfma_f32_16x16x32_bf16 v[4:7], a[80:83], a[20:23], v[4:7]
  ds_read_b64_tr_b16 a[66:67], v40 offset:43008
  s_waitcnt lgkmcnt(6)
  v_mfma_f32_16x16x32_bf16 v[12:15], a[84:87], a[20:23], v[12:15]
  ds_read_b64_tr_b16 a[68:69], v41 offset:40960
  v_mfma_f32_16x16x32_bf16 v[8:11], a[84:87], a[16:19], v[8:11]
  ds_read_b64_tr_b16 a[70:71], v41 offset:43008
  s_waitcnt lgkmcnt(6)
  v_mfma_f32_16x16x32_bf16 v[16:19], a[88:91], a[16:19], v[16:19]
  ds_read_b64_tr_b16 a[72:73], v42 offset:40960
  v_mfma_f32_16x16x32_bf16 v[20:23], a[88:91], a[20:23], v[20:23]
  ds_read_b64_tr_b16 a[74:75], v42 offset:43008
  s_waitcnt lgkmcnt(6)
  v_mfma_f32_16x16x32_bf16 v[28:31], a[92:95], a[20:23], v[28:31]
  ds_read_b64_tr_b16 a[76:77], v43 offset:40960
  v_mfma_f32_16x16x32_bf16 v[24:27], a[92:95], a[16:19], v[24:27]
  ds_read_b64_tr_b16 a[78:79], v43 offset:43008
  s_waitcnt vmcnt(8) lgkmcnt(6)
  v_mfma_f32_16x16x32_bf16 v[0:3], a[64:67], a[24:27], v[0:3]
  ds_read_b64_tr_b16 a[80:81], v40 offset:45056
  v_mfma_f32_16x16x32_bf16 v[4:7], a[64:67], a[28:31], v[4:7]
  ds_read_b64_tr_b16 a[82:83], v40 offset:47104
  s_waitcnt lgkmcnt(6)
  v_mfma_f32_16x16x32_bf16 v[12:15], a[68:71], a[28:31], v[12:15]
  ds_read_b64_tr_b16 a[84:85], v41 offset:45056
  v_mfma_f32_16x16x32_bf16 v[8:11], a[68:71], a[24:27], v[8:11]
  ds_read_b64_tr_b16 a[86:87], v41 offset:47104
  s_waitcnt lgkmcnt(6)
  v_mfma_f32_16x16x32_bf16 v[16:19], a[72:75], a[24:27], v[16:19]
  ds_read_b64_tr_b16 a[88:89], v42 offset:45056
  v_mfma_f32_16x16x32_bf16 v[20:23], a[72:75], a[28:31], v[20:23]
  ds_read_b64_tr_b16 a[90:91], v42 offset:47104
  s_waitcnt lgkmcnt(6)
  v_mfma_f32_16x16x32_bf16 v[28:31], a[76:79], a[28:31], v[28:31]
  ds_read_b64_tr_b16 a[92:93], v43 offset:45056
  v_mfma_f32_16x16x32_bf16 v[24:27], a[76:79], a[24:27], v[24:27]
  ds_read_b64_tr_b16 a[94:95], v43 offset:47104
  s_waitcnt vmcnt(5) lgkmcnt(6)
  v_mfma_f32_16x16x32_bf16 v[0:3], a[80:83], a[32:35], v[0:3]
  s_waitcnt vmcnt(4)
  s_barrier
  ds_read_b64_tr_b16 a[64:65], v40 offset:49152
  v_mfma_f32_16x16x32_bf16 v[4:7], a[80:83], a[36:39], v[4:7]
  ds_read_b64_tr_b16 a[66:67], v40 offset:51200
  s_waitcnt lgkmcnt(6)
  v_mfma_f32_16x16x32_bf16 v[12:15], a[84:87], a[36:39], v[12:15]
  ds_read_b64_tr_b16 a[68:69], v41 offset:49152
  v_mfma_f32_16x16x32_bf16 v[8:11], a[84:87], a[32:35], v[8:11]
  ds_read_b64_tr_b16 a[70:71], v41 offset:51200
  s_waitcnt lgkmcnt(6)
  v_mfma_f32_16x16x32_bf16 v[16:19], a[88:91], a[32:35], v[16:19]
  ds_read_b64_tr_b16 a[72:73], v42 offset:49152
  v_mfma_f32_16x16x32_bf16 v[20:23], a[88:91], a[36:39], v[20:23]
  ds_read_b64_tr_b16 a[74:75], v42 offset:51200
  s_waitcnt lgkmcnt(6)
  v_mfma_f32_16x16x32_bf16 v[28:31], a[92:95], a[36:39], v[28:31]
  ds_read_b64_tr_b16 a[76:77], v43 offset:49152
  v_mfma_f32_16x16x32_bf16 v[24:27], a[92:95], a[32:35], v[24:27]
  ds_read_b64_tr_b16 a[78:79], v43 offset:51200
  s_waitcnt vmcnt(2) lgkmcnt(6)
  v_mfma_f32_16x16x32_bf16 v[0:3], a[64:67], a[40:43], v[0:3]
  ds_read_b64_tr_b16 a[80:81], v40 offset:53248
  v_mfma_f32_16x16x32_bf16 v[4:7], a[64:67], a[44:47], v[4:7]
  ds_read_b64_tr_b16 a[82:83], v40 offset:55296
  s_waitcnt lgkmcnt(6)
  v_mfma_f32_16x16x32_bf16 v[12:15], a[68:71], a[44:47], v[12:15]
  ds_read_b64_tr_b16 a[84:85], v41 offset:53248
  v_mfma_f32_16x16x32_bf16 v[8:11], a[68:71], a[40:43], v[8:11]
  ds_read_b64_tr_b16 a[86:87], v41 offset:55296
  s_waitcnt lgkmcnt(6)
  v_mfma_f32_16x16x32_bf16 v[16:19], a[72:75], a[40:43], v[16:19]
  ds_read_b64_tr_b16 a[88:89], v42 offset:53248
  v_mfma_f32_16x16x32_bf16 v[20:23], a[72:75], a[44:47], v[20:23]
  ds_read_b64_tr_b16 a[90:91], v42 offset:55296
  s_waitcnt lgkmcnt(6)
  v_mfma_f32_16x16x32_bf16 v[28:31], a[76:79], a[44:47], v[28:31]
  ds_read_b64_tr_b16 a[92:93], v43 offset:53248
  v_mfma_f32_16x16x32_bf16 v[24:27], a[76:79], a[40:43], v[24:27]
  ds_read_b64_tr_b16 a[94:95], v43 offset:55296
  s_waitcnt vmcnt(0) lgkmcnt(6)
  v_mfma_f32_16x16x32_bf16 v[0:3], a[80:83], a[48:51], v[0:3]
  v_mfma_f32_16x16x32_bf16 v[4:7], a[80:83], a[52:55], v[4:7]
  s_waitcnt lgkmcnt(4)
  v_mfma_f32_16x16x32_bf16 v[12:15], a[84:87], a[52:55], v[12:15]
  v_mfma_f32_16x16x32_bf16 v[8:11], a[84:87], a[48:51], v[8:11]
  s_waitcnt lgkmcnt(2)
  v_mfma_f32_16x16x32_bf16 v[16:19], a[88:91], a[48:51], v[16:19]
  v_mfma_f32_16x16x32_bf16 v[20:23], a[88:91], a[52:55], v[20:23]
  s_waitcnt lgkmcnt(0)
  v_mfma_f32_16x16x32_bf16 v[28:31], a[92:95], a[52:55], v[28:31]
  v_mfma_f32_16x16x32_bf16 v[24:27], a[92:95], a[48:51], v[24:27]
  s_add_u32 s46, s45, s41
  s_add_u32 s49, s46, 32768
  s_lshl_b32 s50, s44, 11
  s_lshl_b32 s43, s26, 7
  s_add_u32 s50, s50, s43
  s_add_u32 s50, s50, s47
  s_nop 1
  s_cmp_lg_u32 s48, 0
  s_cbranch_scc1 Ldown_body_final
  v_cvt_pk_bf16_f32 v48, v0, v1
  v_cvt_pk_bf16_f32 v49, v2, v3
  v_cvt_pk_bf16_f32 v50, v8, v9
  v_cvt_pk_bf16_f32 v51, v10, v11
  buffer_store_dwordx4 v[48:51], v45, s[4:7], s46 offen offset:0
  v_cvt_pk_bf16_f32 v56, v4, v5
  v_cvt_pk_bf16_f32 v57, v6, v7
  v_cvt_pk_bf16_f32 v58, v12, v13
  v_cvt_pk_bf16_f32 v59, v14, v15
  buffer_store_dwordx4 v[56:59], v45, s[4:7], s49 offen offset:0
  v_cvt_pk_bf16_f32 v52, v16, v17
  v_cvt_pk_bf16_f32 v53, v18, v19
  v_cvt_pk_bf16_f32 v54, v24, v25
  v_cvt_pk_bf16_f32 v55, v26, v27
  buffer_store_dwordx4 v[52:55], v45, s[4:7], s46 offen offset:1024
  v_cvt_pk_bf16_f32 v60, v20, v21
  v_cvt_pk_bf16_f32 v61, v22, v23
  v_cvt_pk_bf16_f32 v62, v28, v29
  v_cvt_pk_bf16_f32 v63, v30, v31
  buffer_store_dwordx4 v[60:63], v45, s[4:7], s49 offen offset:1024
  v_mov_b32 v64, 0x3f803f80
  v_mov_b32 v65, 0x3f803f80
  v_mov_b32 v66, 0x3f803f80
  v_mov_b32 v67, 0x3f803f80
  v_and_b32 v84, 15, v47
  v_lshrrev_b32 v85, 4, v47
  v_mfma_f32_16x16x32_bf16 v[68:71], v[64:67], v[48:51], 0
  v_mfma_f32_16x16x32_bf16 v[72:75], v[48:51], v[48:51], 0
  v_mfma_f32_16x16x32_bf16 v[76:79], v[64:67], v[56:59], 0
  v_mfma_f32_16x16x32_bf16 v[80:83], v[56:59], v[56:59], 0
  v_mfma_f32_16x16x32_bf16 v[68:71], v[64:67], v[52:55], v[68:71]
  v_mfma_f32_16x16x32_bf16 v[72:75], v[52:55], v[52:55], v[72:75]
  v_mfma_f32_16x16x32_bf16 v[76:79], v[64:67], v[60:63], v[76:79]
  v_mfma_f32_16x16x32_bf16 v[80:83], v[60:63], v[60:63], v[80:83]
  v_lshrrev_b32 v64, 2, v84
  v_cmp_eq_u32 s[60:61], v64, v85
  v_and_b32 v64, 3, v84
  v_cmp_eq_u32 s[62:63], 1, v64
  v_cmp_eq_u32 s[64:65], 2, v64
  v_cmp_eq_u32 s[66:67], 3, v64
  v_lshlrev_b32 v84, 3, v84
  v_mov_b32 v85, 0x7ffffff0
  s_nop 0
  v_cndmask_b32 v84, v85, v84, s[60:61]
  v_cndmask_b32 v69, v72, v73, s[62:63]
  v_cndmask_b32 v69, v69, v74, s[64:65]
  v_cndmask_b32 v69, v69, v75, s[66:67]
  buffer_store_dwordx2 v[68:69], v84, s[4:7], s50 offen offset:0
  v_cndmask_b32 v77, v80, v81, s[62:63]
  v_cndmask_b32 v77, v77, v82, s[64:65]
  v_cndmask_b32 v77, v77, v83, s[66:67]
  buffer_store_dwordx2 v[76:77], v84, s[4:7], s50 offen offset:2048
  s_endpgm
Ldown_body_final:
  v_and_b32 v64, 15, v47
  v_lshlrev_b32 v64, 12, v64
  v_bfe_u32 v65, v47, 4, 1
  v_lshl_add_u32 v64, v65, 5, v64
  v_lshrrev_b32 v65, 5, v47
  v_lshl_add_u32 v64, v65, 4, v64
  s_and_b32 s43, s44, 63
  s_lshl_b32 s43, s43, 16
  s_lshr_b32 s46, s44, 6
  s_lshl_b32 s46, s46, 11
  s_add_u32 s46, s46, s43
  s_lshl_b32 s43, s26, 7
  s_add_u32 s46, s46, s43
  s_add_u32 s49, s46, 65536
  v_cvt_pk_bf16_f32 v48, v0, v1
  v_cvt_pk_bf16_f32 v49, v2, v3
  v_cvt_pk_bf16_f32 v50, v8, v9
  v_cvt_pk_bf16_f32 v51, v10, v11
  v_cvt_pk_bf16_f32 v56, v4, v5
  v_cvt_pk_bf16_f32 v57, v6, v7
  v_cvt_pk_bf16_f32 v58, v12, v13
  v_cvt_pk_bf16_f32 v59, v14, v15
  v_permlane16_swap_b32 v48, v50
  v_permlane16_swap_b32 v49, v51
  buffer_store_dwordx4 v[48:51], v64, s[12:15], s46 offen offset:0
  s_nop 0
  v_permlane16_swap_b32 v56, v58
  v_permlane16_swap_b32 v57, v59
  buffer_store_dwordx4 v[56:59], v64, s[12:15], s49 offen offset:0
  v_cvt_pk_bf16_f32 v52, v16, v17
  v_cvt_pk_bf16_f32 v53, v18, v19
  v_cvt_pk_bf16_f32 v54, v24, v25
  v_cvt_pk_bf16_f32 v55, v26, v27
  v_cvt_pk_bf16_f32 v60, v20, v21
  v_cvt_pk_bf16_f32 v61, v22, v23
  v_cvt_pk_bf16_f32 v62, v28, v29
  v_cvt_pk_bf16_f32 v63, v30, v31
  v_permlane16_swap_b32 v52, v54
  v_permlane16_swap_b32 v53, v55
  buffer_store_dwordx4 v[52:55], v64, s[12:15], s46 offen offset:64
  s_nop 0
  v_permlane16_swap_b32 v60, v62
  v_permlane16_swap_b32 v61, v63
  buffer_store_dwordx4 v[60:63], v64, s[12:15], s49 offen offset:64
  s_endpgm
.section .rodata,"a"
.p2align 6
.amdhsa_kernel prep_kernel
  .amdhsa_next_free_vgpr 256
  .amdhsa_next_free_sgpr 102
  .amdhsa_accum_offset 256
  .amdhsa_group_segment_fixed_size 0
  .amdhsa_kernarg_size 80
  .amdhsa_user_sgpr_count 2
  .amdhsa_user_sgpr_kernarg_segment_ptr 1
  .amdhsa_system_sgpr_workgroup_id_x 1
  .amdhsa_float_denorm_mode_32 3
.end_amdhsa_kernel
.p2align 6
.amdhsa_kernel qkv1_kernel
  .amdhsa_next_free_vgpr 512
  .amdhsa_next_free_sgpr 102
  .amdhsa_accum_offset 256
  .amdhsa_group_segment_fixed_size 0
  .amdhsa_kernarg_size 80
  .amdhsa_user_sgpr_count 2
  .amdhsa_user_sgpr_kernarg_segment_ptr 1
  .amdhsa_system_sgpr_workgroup_id_x 1
  .amdhsa_float_denorm_mode_32 3
.end_amdhsa_kernel
.p2align 6
.amdhsa_kernel qkv2_kernel
  .amdhsa_next_free_vgpr 512
  .amdhsa_next_free_sgpr 102
  .amdhsa_accum_offset 256
  .amdhsa_group_segment_fixed_size 0
  .amdhsa_kernarg_size 80
  .amdhsa_user_sgpr_count 2
  .amdhsa_user_sgpr_kernarg_segment_ptr 1
  .amdhsa_system_sgpr_workgroup_id_x 1
  .amdhsa_float_denorm_mode_32 3
.end_amdhsa_kernel
.p2align 6
.amdhsa_kernel o1_kernel
  .amdhsa_next_free_vgpr 512
  .amdhsa_next_free_sgpr 102
  .amdhsa_accum_offset 256
  .amdhsa_group_segment_fixed_size 0
  .amdhsa_kernarg_size 80
  .amdhsa_user_sgpr_count 2
  .amdhsa_user_sgpr_kernarg_segment_ptr 1
  .amdhsa_system_sgpr_workgroup_id_x 1
  .amdhsa_float_denorm_mode_32 3
.end_amdhsa_kernel
.p2align 6
.amdhsa_kernel o2_kernel
  .amdhsa_next_free_vgpr 512
  .amdhsa_next_free_sgpr 102
  .amdhsa_accum_offset 256
  .amdhsa_group_segment_fixed_size 0
  .amdhsa_kernarg_size 80
  .amdhsa_user_sgpr_count 2
  .amdhsa_user_sgpr_kernarg_segment_ptr 1
  .amdhsa_system_sgpr_workgroup_id_x 1
  .amdhsa_float_denorm_mode_32 3
.end_amdhsa_kernel
.p2align 6
.amdhsa_kernel gu1_kernel
  .amdhsa_next_free_vgpr 512
  .amdhsa_next_free_sgpr 102
  .amdhsa_accum_offset 256
  .amdhsa_group_segment_fixed_size 0
  .amdhsa_kernarg_size 80
  .amdhsa_user_sgpr_count 2
  .amdhsa_user_sgpr_kernarg_segment_ptr 1
  .amdhsa_system_sgpr_workgroup_id_x 1
  .amdhsa_float_denorm_mode_32 3
.end_amdhsa_kernel
.p2align 6
.amdhsa_kernel gu2_kernel
  .amdhsa_next_free_vgpr 512
  .amdhsa_next_free_sgpr 102
  .amdhsa_accum_offset 256
  .amdhsa_group_segment_fixed_size 0
  .amdhsa_kernarg_size 80
  .amdhsa_user_sgpr_count 2
  .amdhsa_user_sgpr_kernarg_segment_ptr 1
  .amdhsa_system_sgpr_workgroup_id_x 1
  .amdhsa_float_denorm_mode_32 3
.end_amdhsa_kernel
.p2align 6
.amdhsa_kernel down1_kernel
  .amdhsa_next_free_vgpr 512
  .amdhsa_next_free_sgpr 102
  .amdhsa_accum_offset 256
  .amdhsa_group_segment_fixed_size 0
  .amdhsa_kernarg_size 80
  .amdhsa_user_sgpr_count 2
  .amdhsa_user_sgpr_kernarg_segment_ptr 1
  .amdhsa_system_sgpr_workgroup_id_x 1
  .amdhsa_float_denorm_mode_32 3
.end_amdhsa_kernel
.p2align 6
.amdhsa_kernel down2_kernel
  .amdhsa_next_free_vgpr 512
  .amdhsa_next_free_sgpr 102
  .amdhsa_accum_offset 256
  .amdhsa_group_segment_fixed_size 0
  .amdhsa_kernarg_size 80
  .amdhsa_user_sgpr_count 2
  .amdhsa_user_sgpr_kernarg_segment_ptr 1
  .amdhsa_system_sgpr_workgroup_id_x 1
  .amdhsa_float_denorm_mode_32 3
.end_amdhsa_kernel
```

```asm
; @launch grid=(256,1,1) block=(256,1,1) lds=163840
.amdgcn_target "amdgcn-amd-amdhsa--gfx950"
.text
.globl interleave_layers__sliding_local_dilated__swiglu_ffn__prompt_kernel
.p2align 8
.type interleave_layers__sliding_local_dilated__swiglu_ffn__prompt_kernel,@function
interleave_layers__sliding_local_dilated__swiglu_ffn__prompt_kernel:
  s_cmp_lt_u32 s2, 256
  s_cbranch_scc1 Lgo
  s_endpgm
Lgo:
  s_load_dwordx16 s[60:75], s[0:1], 0
  s_load_dwordx4 s[76:79], s[0:1], 64
  v_lshrrev_b32 v1, 6, v0
  v_and_b32 v253, 63, v0
  v_readfirstlane_b32 s40, v1
  v_mov_b32 v251, 0
  s_mov_b32 s41, 0
  s_mov_b32 s42, 0
  s_and_b32 s44, s2, 1
  s_bfe_u32 s45, s2, 0x20001
  s_lshr_b32 s46, s2, 3
  s_lshl_b32 s47, s44, 3
  s_and_b32 s43, s46, 7
  s_add_u32 s50, s47, s43
  s_lshl_b32 s43, s45, 2
  s_lshr_b32 s51, s46, 3
  s_add_u32 s51, s51, s43
  s_and_b32 s43, s45, 1
  s_lshl_b32 s43, s43, 2
  s_add_u32 s52, s47, s43
  s_and_b32 s48, s46, 3
  s_add_u32 s52, s52, s48
  s_lshr_b32 s43, s45, 1
  s_lshl_b32 s43, s43, 3
  s_lshr_b32 s49, s46, 2
  s_add_u32 s53, s43, s49
  s_lshl_b32 s43, s44, 2
  s_add_u32 s54, s43, s48
  s_lshl_b32 s43, s45, 3
  s_add_u32 s55, s43, s49
  v_lshrrev_b32 v2, 3, v253
  v_bfe_u32 v3, v253, 1, 2
  v_lshrrev_b32 v4, 4, v253
  v_xor_b32 v3, v3, v4
  v_and_b32 v4, 1, v253
  v_lshlrev_b32 v2, 11, v2
  v_lshl_add_u32 v2, v3, 5, v2
  v_lshl_add_u32 v252, v4, 4, v2
  s_waitcnt lgkmcnt(0)
  s_mov_b32 s28, s60
  s_mov_b32 s29, s61
  s_mov_b32 s30, 0x400000
  s_mov_b32 s31, 0x20000
  s_mov_b32 s8, s62
  s_mov_b32 s9, s63
  s_mov_b32 s10, 0x600000
  s_mov_b32 s11, 0x20000
  s_mov_b32 s4, s78
  s_mov_b32 s5, s79
  s_mov_b32 s6, 0x10000000
  s_mov_b32 s7, 0x20000
  s_mov_b32 s12, s64
  s_mov_b32 s13, s65
  s_mov_b32 s14, 0x200000
  s_mov_b32 s15, 0x20000
  s_mov_b32 s16, s68
  s_mov_b32 s17, s69
  s_mov_b32 s18, 0x700000
  s_mov_b32 s19, 0x20000
  s_mov_b32 s20, s70
  s_mov_b32 s21, s71
  s_mov_b32 s22, 0x700000
  s_mov_b32 s23, 0x20000
  s_mov_b32 s24, s72
  s_mov_b32 s25, s73
  s_mov_b32 s26, 0x700000
  s_mov_b32 s27, 0x20000
  s_mov_b32 s32, s74
  s_mov_b32 s33, s75
  s_mov_b32 s34, 0x400000
  s_mov_b32 s35, 0x20000
  s_mov_b32 s36, s76
  s_mov_b32 s37, s77
  s_mov_b32 s38, 0x100
  s_mov_b32 s39, 0x20000
  s_mul_i32 s76, s40, 6144
  s_add_u32 s76, s76, 139264
  s_mov_b32 m0, s76
  s_lshr_b32 s80, s2, 2
  s_bfe_u32 s81, s2, 0x10001
  s_lshl_b32 s81, s81, 2
  s_add_u32 s81, s81, s40
  s_and_b32 s82, s2, 1
  s_lshl_b32 s43, s80, 16
  s_lshl_b32 s44, s82, 11
  s_add_u32 s43, s43, s44
  s_lshl_b32 s44, s81, 8
  s_add_u32 s43, s43, s44
  v_lshrrev_b32 v2, 4, v253
  v_and_b32 v3, 15, v253
  v_add_u32 v4, 0, v2
  v_xor_b32 v5, v4, v3
  v_lshlrev_b32 v5, 4, v5
  v_lshl_add_u32 v5, v2, 12, v5
  v_add_u32 v5, 0, v5
  buffer_load_dwordx4 v5, s[28:31], s43 offen offset:0 lds
  v_add_u32 v4, 4, v2
  v_xor_b32 v5, v4, v3
  v_lshlrev_b32 v5, 4, v5
  v_lshl_add_u32 v5, v2, 12, v5
  v_add_u32 v5, 15360, v5
  buffer_load_dwordx4 v5, s[28:31], s43 offen offset:1024 lds
  v_add_u32 v4, 8, v2
  v_xor_b32 v5, v4, v3
  v_lshlrev_b32 v5, 4, v5
  v_lshl_add_u32 v5, v2, 12, v5
  v_add_u32 v5, 30720, v5
  buffer_load_dwordx4 v5, s[28:31], s43 offen offset:2048 lds
  v_add_u32 v4, 12, v2
  v_xor_b32 v5, v4, v3
  v_lshlrev_b32 v5, 4, v5
  v_lshl_add_u32 v5, v2, 12, v5
  v_add_u32 v5, 46080, v5
  buffer_load_dwordx4 v5, s[28:31], s43 offen offset:3072 lds
  s_lshr_b32 s46, s2, 3
  s_cmp_ge_u32 s46, 12
  s_cselect_b32 s44, 12, 0
  s_cselect_b32 s45, 2, 0
  s_sub_u32 s44, s46, s44
  s_add_u32 s45, s45, s82
  s_lshr_b32 s47, s44, 2
  s_lshl_b32 s47, s47, 4
  s_and_b32 s44, s44, 3
  s_add_u32 s44, s44, s47
  s_bfe_u32 s47, s2, 0x20001
  s_lshl_b32 s47, s47, 2
  s_add_u32 s44, s44, s47
  s_mul_i32 s83, s45, 12288
  s_lshl_b32 s47, s44, 8
  s_add_u32 s83, s83, s47
  s_add_u32 s83, s83, 27852800
  s_lshl_b32 s45, s45, 2
  s_add_u32 s45, s45, s40
  s_mul_i32 s45, s45, 393216
  s_lshl_b32 s44, s44, 7
  s_add_u32 s45, s45, s44
  s_cmp_ge_u32 s46, 24
  s_cselect_b32 s92, 0x40000000, 0
  s_cselect_b32 s45, 0, s45
  v_lshrrev_b32 v4, 3, v253
  v_mul_u32_u24 v4, 6144, v4
  v_and_b32 v5, 7, v253
  v_lshl_add_u32 v4, v5, 4, v4
  v_or_b32 v4, s92, v4
  buffer_load_dwordx4 v[160:163], v4, s[8:11], s45 offen
  s_add_u32 s45, s45, 49152
  buffer_load_dwordx4 v[164:167], v4, s[8:11], s45 offen
  s_add_u32 s45, s45, 49152
  buffer_load_dwordx4 v[168:171], v4, s[8:11], s45 offen
  s_add_u32 s45, s45, 49152
  buffer_load_dwordx4 v[172:175], v4, s[8:11], s45 offen
  s_add_u32 s45, s45, 49152
  buffer_load_dwordx4 v[176:179], v4, s[8:11], s45 offen
  s_add_u32 s45, s45, 49152
  buffer_load_dwordx4 v[180:183], v4, s[8:11], s45 offen
  s_add_u32 s45, s45, 49152
  buffer_load_dwordx4 v[184:187], v4, s[8:11], s45 offen
  s_add_u32 s45, s45, 49152
  buffer_load_dwordx4 v[188:191], v4, s[8:11], s45 offen
  s_add_u32 s45, s45, 49152
  s_bfe_u32 s43, s2, 0x10006
  s_mul_i32 s43, s43, 33554432
  s_and_b32 s44, s2, 63
  s_lshl_b32 s44, s44, 7
  s_add_u32 s43, s43, s44
  s_add_u32 s43, s43, 27787264
  buffer_store_dword v251, v251, s[4:7], s43 offen sc1
  s_lshr_b32 s57, s40, 1
  s_and_b32 s58, s40, 1
  s_lshl_b32 s71, s50, 3
  s_add_u32 s67, s50, s51
  s_and_b32 s67, s67, 3
  s_lshl_b32 s62, s40, 12
  s_mul_i32 s63, s40, 6144
  s_add_u32 s76, s63, 139264
  s_and_b32 s43, s50, 7
  s_cmp_lg_u32 s43, 0
  s_cselect_b32 s43, 1, 0
  s_sub_u32 s72, s71, s43
  v_lshrrev_b32 v2, 3, v253
  v_bfe_u32 v3, v253, 1, 2
  v_lshrrev_b32 v4, 4, v253
  v_xor_b32 v3, v3, v4
  v_and_b32 v5, 1, v253
  v_lshrrev_b32 v6, 5, v253
  v_lshl_add_u32 v6, v6, 2, v2
  s_lshl_b32 s43, s57, 5
  s_lshl_b32 s44, s58, 2
  s_add_u32 s43, s43, s44
  v_mul_u32_u24 v6, 6144, v6
  v_lshl_add_u32 v6, v3, 5, v6
  v_lshl_add_u32 v124, v5, 4, v6
  v_add_u32 v125, 97280, v124
  s_mul_i32 s43, s43, 6144
  s_lshl_b32 s60, s51, 7
  s_add_u32 s60, s60, s43
  v_and_b32 v3, 7, v253
  s_lshl_b32 s43, s40, 1
  s_add_u32 s43, s43, s71
  v_add_u32 v5, 0, v4
  v_xor_b32 v5, v5, v3
  v_lshlrev_b32 v5, 4, v5
  v_lshl_add_u32 v5, v2, 12, v5
  v_add_u32 v120, 0, v5
  v_add_u32 v5, 4, v4
  v_xor_b32 v5, v5, v3
  v_lshlrev_b32 v5, 4, v5
  v_lshl_add_u32 v5, v2, 12, v5
  v_add_u32 v121, 31744, v5
  v_add_u32 v5, 0, v4
  v_xor_b32 v5, v5, v3
  v_lshlrev_b32 v5, 4, v5
  v_lshl_add_u32 v5, v2, 12, v5
  v_add_u32 v122, 63488, v5
  v_add_u32 v5, 4, v4
  v_xor_b32 v5, v5, v3
  v_lshlrev_b32 v5, 4, v5
  v_lshl_add_u32 v5, v2, 12, v5
  v_add_u32 v123, 95232, v5
  v_and_b32 v5, 6, v2
  v_xor_b32 v5, v5, v3
  v_lshlrev_b32 v5, 4, v5
  v_lshl_add_u32 v5, v2, 12, v5
  v_add_u32 v126, 32768, v5
  s_lshr_b32 s44, s50, 3
  s_lshl_b32 s44, s44, 11
  s_and_b32 s43, s43, 63
  s_lshl_b32 s43, s43, 16
  s_add_u32 s59, s43, s44
  s_and_b32 s43, s72, 63
  s_lshl_b32 s43, s43, 16
  s_add_u32 s73, s43, s44
  s_movk_i32 s61, 128
  s_cmp_eq_u32 s67, 0
  s_cselect_b32 s44, 4, 0
  s_mul_i32 s45, s44, 393216
  s_add_u32 s69, s45, s60
  s_add_u32 s70, s69, 4096
  s_add_u32 m0, s63, 0
  s_nop 0
  buffer_load_dwordx4 v124, s[8:11], s69 offen offset:0 lds
  buffer_load_dwordx4 v125, s[8:11], s69 offen offset:1024 lds
  buffer_load_dwordx4 v124, s[8:11], s69 offen offset:2048 lds
  buffer_load_dwordx4 v125, s[8:11], s69 offen offset:3072 lds
  s_add_u32 m0, s63, 4096
  s_nop 0
  buffer_load_dwordx4 v124, s[8:11], s70 offen offset:0 lds
  buffer_load_dwordx4 v125, s[8:11], s70 offen offset:1024 lds
  s_cmp_eq_u32 s67, 1
  s_cselect_b32 s44, 5, 1
  s_mul_i32 s45, s44, 393216
  s_add_u32 s69, s45, s60
  s_add_u32 s70, s69, 4096
  s_add_u32 m0, s63, 24576
  s_nop 0
  buffer_load_dwordx4 v124, s[8:11], s69 offen offset:0 lds
  buffer_load_dwordx4 v125, s[8:11], s69 offen offset:1024 lds
  buffer_load_dwordx4 v124, s[8:11], s69 offen offset:2048 lds
  buffer_load_dwordx4 v125, s[8:11], s69 offen offset:3072 lds
  s_add_u32 m0, s63, 28672
  s_nop 0
  buffer_load_dwordx4 v124, s[8:11], s70 offen offset:0 lds
  buffer_load_dwordx4 v125, s[8:11], s70 offen offset:1024 lds
  s_cmp_eq_u32 s67, s40
  s_cselect_b32 s44, 4, 0
  s_add_u32 s44, s44, s40
  s_mul_i32 s44, s44, s61
  s_lshl_b32 s45, s40, 10
  s_add_u32 m0, s45, 122880
  s_add_u32 s44, s44, s73
  buffer_load_dwordx4 v126, s[28:31], s44 offen sc1 lds
  s_cmp_eq_u32 s67, 0
  s_cselect_b32 s44, 4, 0
  s_mul_i32 s45, s44, s61
  s_add_u32 s68, s45, s59
  s_add_u32 m0, s62, 73728
  s_nop 0
  buffer_load_dwordx4 v120, s[28:31], s68 offen offset:0 sc1 lds
  buffer_load_dwordx4 v121, s[28:31], s68 offen offset:1024 sc1 lds
  buffer_load_dwordx4 v122, s[28:31], s68 offen offset:2048 sc1 lds
  buffer_load_dwordx4 v123, s[28:31], s68 offen offset:3072 sc1 lds
  v_and_b32 v2, 15, v253
  v_lshrrev_b32 v3, 4, v253
  v_and_b32 v4, 7, v253
  v_lshrrev_b32 v5, 1, v2
  v_xor_b32 v5, v5, v3
  v_lshlrev_b32 v5, 4, v5
  v_lshl_add_u32 v6, v2, 7, v5
  v_xor_b32 v7, 64, v6
  v_and_b32 v5, 6, v4
  v_xor_b32 v5, v5, v3
  v_lshlrev_b32 v5, 4, v5
  v_lshl_add_u32 v8, v4, 7, v5
  v_xor_b32 v9, 64, v8
  s_lshl_b32 s43, s57, 13
  s_add_u32 s43, s43, 73728
  v_add_u32 v112, s43, v6
  v_add_u32 v113, s43, v7
  s_cmp_eq_u32 s57, 0
  s_cselect_b64 vcc, 0, -1
  s_movk_i32 s43, 1024
  s_cselect_b32 s64, s43, 16384
  s_cselect_b32 s65, s43, -32768
  s_mov_b32 s43, 122880
  s_cselect_b32 s43, s43, 79872
  v_cndmask_b32 v8, v8, v6, vcc
  v_cndmask_b32 v9, v9, v7, vcc
  v_add_u32 v114, s43, v8
  v_add_u32 v115, s43, v9
  v_lshrrev_b32 v2, 2, v253
  v_bfe_u32 v3, v253, 3, 2
  v_and_b32 v4, 3, v253
  v_lshlrev_b32 v4, 3, v4
  v_lshl_add_u32 v4, v2, 7, v4
  s_lshl_b32 s43, s58, 1
  v_xor_b32 v5, s43, v3
  v_lshl_add_u32 v116, v5, 5, v4
  v_xor_b32 v5, 1, v5
  v_lshl_add_u32 v117, v5, 5, v4
  v_add_u32 v118, 49152, v116
  v_add_u32 v119, 49152, v117
  v_mov_b32 v0, 0
  v_mov_b32 v1, 0
  v_mov_b32 v2, 0
  v_mov_b32 v3, 0
  v_mov_b32 v4, 0
  v_mov_b32 v5, 0
  v_mov_b32 v6, 0
  v_mov_b32 v7, 0
  v_mov_b32 v8, 0
  v_mov_b32 v9, 0
  v_mov_b32 v10, 0
  v_mov_b32 v11, 0
  v_mov_b32 v12, 0
  v_mov_b32 v13, 0
  v_mov_b32 v14, 0
  v_mov_b32 v15, 0
  v_mov_b32 v16, 0
  v_mov_b32 v17, 0
  v_mov_b32 v18, 0
  v_mov_b32 v19, 0
  v_mov_b32 v20, 0
  v_mov_b32 v21, 0
  v_mov_b32 v22, 0
  v_mov_b32 v23, 0
  v_mov_b32 v24, 0
  v_mov_b32 v25, 0
  v_mov_b32 v26, 0
  v_mov_b32 v27, 0
  v_mov_b32 v28, 0
  v_mov_b32 v29, 0
  v_mov_b32 v30, 0
  v_mov_b32 v31, 0
  v_mov_b32 v32, 0
  v_mov_b32 v33, 0
  v_mov_b32 v34, 0
  v_mov_b32 v35, 0
  v_mov_b32 v36, 0
  v_mov_b32 v37, 0
  v_mov_b32 v38, 0
  v_mov_b32 v39, 0
  v_mov_b32 v40, 0
  v_mov_b32 v41, 0
  v_mov_b32 v42, 0
  v_mov_b32 v43, 0
  v_mov_b32 v44, 0
  v_mov_b32 v45, 0
  v_mov_b32 v46, 0
  v_mov_b32 v47, 0
  v_mov_b32 v48, 0
  v_mov_b32 v49, 0
  v_mov_b32 v50, 0
  v_mov_b32 v51, 0
  v_mov_b32 v52, 0
  v_mov_b32 v53, 0
  v_mov_b32 v54, 0
  v_mov_b32 v55, 0
  v_mov_b32 v56, 0
  v_mov_b32 v57, 0
  v_mov_b32 v58, 0
  v_mov_b32 v59, 0
  v_mov_b32 v60, 0
  v_mov_b32 v61, 0
  v_mov_b32 v62, 0
  v_mov_b32 v63, 0
  v_mov_b32 v64, 0
  v_mov_b32 v65, 0
  v_mov_b32 v66, 0
  v_mov_b32 v67, 0
  v_mov_b32 v68, 0
  v_mov_b32 v69, 0
  v_mov_b32 v70, 0
  v_mov_b32 v71, 0
  v_mov_b32 v72, 0
  v_mov_b32 v73, 0
  v_mov_b32 v74, 0
  v_mov_b32 v75, 0
  v_mov_b32 v76, 0
  v_mov_b32 v77, 0
  v_mov_b32 v78, 0
  v_mov_b32 v79, 0
  v_mov_b32 v80, 0
  v_mov_b32 v81, 0
  v_mov_b32 v82, 0
  v_mov_b32 v83, 0
  v_mov_b32 v84, 0
  v_mov_b32 v85, 0
  v_mov_b32 v86, 0
  v_mov_b32 v87, 0
  v_mov_b32 v88, 0
  v_mov_b32 v89, 0
  v_mov_b32 v90, 0
  v_mov_b32 v91, 0
  v_mov_b32 v92, 0
  v_mov_b32 v93, 0
  v_mov_b32 v94, 0
  v_mov_b32 v95, 0
  v_mov_b32 v96, 0
  v_mov_b32 v97, 0
  v_mov_b32 v98, 0
  v_mov_b32 v99, 0
  v_mov_b32 v100, 0
  v_mov_b32 v101, 0
  v_mov_b32 v102, 0
  v_mov_b32 v103, 0
  v_mov_b32 v104, 0
  v_mov_b32 v105, 0
  v_mov_b32 v106, 0
  v_mov_b32 v107, 0
  v_mov_b32 v108, 0
  v_mov_b32 v109, 0
  v_mov_b32 v110, 0
  v_mov_b32 v111, 0
  v_and_b32 v128, 15, v253
  v_lshrrev_b32 v129, 5, v253
  v_bfe_u32 v130, v253, 4, 1
  v_lshlrev_b32 v130, 3, v130
  v_lshl_add_u32 v130, v128, 8, v130
  v_add_u32 v130, s76, v130
  s_waitcnt vmcnt(26)
  v_add_u32 v131, 0, v129
  v_xor_b32 v131, v131, v128
  v_lshl_add_u32 v131, v131, 4, v130
  ds_read_b64 v[140:141], v131
  v_add_u32 v131, 2, v129
  v_xor_b32 v131, v131, v128
  v_lshl_add_u32 v131, v131, 4, v130
  ds_read_b64 v[142:143], v131
  v_add_u32 v131, 4, v129
  v_xor_b32 v131, v131, v128
  v_lshl_add_u32 v131, v131, 4, v130
  ds_read_b64 v[144:145], v131
  v_add_u32 v131, 6, v129
  v_xor_b32 v131, v131, v128
  v_lshl_add_u32 v131, v131, 4, v130
  ds_read_b64 v[146:147], v131
  v_add_u32 v131, 8, v129
  v_xor_b32 v131, v131, v128
  v_lshl_add_u32 v131, v131, 4, v130
  ds_read_b64 v[148:149], v131
  v_add_u32 v131, 10, v129
  v_xor_b32 v131, v131, v128
  v_lshl_add_u32 v131, v131, 4, v130
  ds_read_b64 v[150:151], v131
  v_add_u32 v131, 12, v129
  v_xor_b32 v131, v131, v128
  v_lshl_add_u32 v131, v131, 4, v130
  ds_read_b64 v[152:153], v131
  v_add_u32 v131, 14, v129
  v_xor_b32 v131, v131, v128
  v_lshl_add_u32 v131, v131, 4, v130
  ds_read_b64 v[154:155], v131
  s_lshl_b32 s43, s82, 6
  s_add_u32 s80, s80, s43
  s_lshl_b32 s43, s80, 15
  s_lshl_b32 s44, s81, 12
  s_add_u32 s43, s43, s44
  s_add_u32 s46, s43, 0
  s_lshl_b32 s43, s80, 11
  s_lshl_b32 s44, s81, 8
  s_add_u32 s43, s43, s44
  s_add_u32 s47, s43, 27262976
  v_lshlrev_b32 v128, 4, v253
  s_waitcnt lgkmcnt(0)
  buffer_store_dwordx4 v[140:143], v128, s[4:7], s46 offen offset:0 sc1
  buffer_store_dwordx4 v[144:147], v128, s[4:7], s46 offen offset:1024 sc1
  buffer_store_dwordx4 v[148:151], v128, s[4:7], s46 offen offset:2048 sc1
  buffer_store_dwordx4 v[152:155], v128, s[4:7], s46 offen offset:3072 sc1
  v_mov_b32 v192, 0x3f803f80
  v_mov_b32 v193, 0x3f803f80
  v_mov_b32 v194, 0x3f803f80
  v_mov_b32 v195, 0x3f803f80
  v_and_b32 v212, 15, v253
  v_lshrrev_b32 v213, 4, v253
  v_mfma_f32_16x16x32_bf16 v[196:199], v[192:195], v[140:143], 0
  v_mfma_f32_16x16x32_bf16 v[200:203], v[140:143], v[140:143], 0
  v_mfma_f32_16x16x32_bf16 v[204:207], v[192:195], v[148:151], 0
  v_mfma_f32_16x16x32_bf16 v[208:211], v[148:151], v[148:151], 0
  v_mfma_f32_16x16x32_bf16 v[196:199], v[192:195], v[144:147], v[196:199]
  v_mfma_f32_16x16x32_bf16 v[200:203], v[144:147], v[144:147], v[200:203]
  v_mfma_f32_16x16x32_bf16 v[204:207], v[192:195], v[152:155], v[204:207]
  v_mfma_f32_16x16x32_bf16 v[208:211], v[152:155], v[152:155], v[208:211]
  v_lshrrev_b32 v192, 2, v212
  v_cmp_eq_u32 s[84:85], v192, v213
  v_and_b32 v192, 3, v212
  v_cmp_eq_u32 s[86:87], 1, v192
  v_cmp_eq_u32 s[88:89], 2, v192
  v_cmp_eq_u32 s[90:91], 3, v192
  v_lshlrev_b32 v212, 3, v212
  v_mov_b32 v213, 0x7ffffff0
  s_nop 0
  v_cndmask_b32 v212, v213, v212, s[84:85]
  v_cndmask_b32 v197, v200, v201, s[86:87]
  v_cndmask_b32 v197, v197, v202, s[88:89]
  v_cndmask_b32 v197, v197, v203, s[90:91]
  buffer_store_dwordx2 v[196:197], v212, s[4:7], s47 offen offset:0 sc1
  v_cndmask_b32 v205, v208, v209, s[86:87]
  v_cndmask_b32 v205, v205, v210, s[88:89]
  v_cndmask_b32 v205, v205, v211, s[90:91]
  buffer_store_dwordx2 v[204:205], v212, s[4:7], s47 offen offset:128 sc1
  s_waitcnt vmcnt(24)
  v_lshlrev_b32 v216, 16, v160
  v_and_b32 v217, 0xffff0000, v160
  v_lshlrev_b32 v218, 16, v161
  v_and_b32 v219, 0xffff0000, v161
  v_lshlrev_b32 v220, 16, v162
  v_and_b32 v221, 0xffff0000, v162
  v_lshlrev_b32 v222, 16, v163
  v_and_b32 v223, 0xffff0000, v163
  v_lshlrev_b32 v224, 16, v164
  v_and_b32 v225, 0xffff0000, v164
  v_pk_add_f32 v[216:217], v[216:217], v[224:225]
  v_lshlrev_b32 v224, 16, v165
  v_and_b32 v225, 0xffff0000, v165
  v_pk_add_f32 v[218:219], v[218:219], v[224:225]
  v_lshlrev_b32 v224, 16, v166
  v_and_b32 v225, 0xffff0000, v166
  v_pk_add_f32 v[220:221], v[220:221], v[224:225]
  v_lshlrev_b32 v224, 16, v167
  v_and_b32 v225, 0xffff0000, v167
  v_pk_add_f32 v[222:223], v[222:223], v[224:225]
  v_lshlrev_b32 v224, 16, v168
  v_and_b32 v225, 0xffff0000, v168
  v_pk_add_f32 v[216:217], v[216:217], v[224:225]
  v_lshlrev_b32 v224, 16, v169
  v_and_b32 v225, 0xffff0000, v169
  v_pk_add_f32 v[218:219], v[218:219], v[224:225]
  v_lshlrev_b32 v224, 16, v170
  v_and_b32 v225, 0xffff0000, v170
  v_pk_add_f32 v[220:221], v[220:221], v[224:225]
  v_lshlrev_b32 v224, 16, v171
  v_and_b32 v225, 0xffff0000, v171
  v_pk_add_f32 v[222:223], v[222:223], v[224:225]
  v_lshlrev_b32 v224, 16, v172
  v_and_b32 v225, 0xffff0000, v172
  v_pk_add_f32 v[216:217], v[216:217], v[224:225]
  v_lshlrev_b32 v224, 16, v173
  v_and_b32 v225, 0xffff0000, v173
  v_pk_add_f32 v[218:219], v[218:219], v[224:225]
  v_lshlrev_b32 v224, 16, v174
  v_and_b32 v225, 0xffff0000, v174
  v_pk_add_f32 v[220:221], v[220:221], v[224:225]
  v_lshlrev_b32 v224, 16, v175
  v_and_b32 v225, 0xffff0000, v175
  v_pk_add_f32 v[222:223], v[222:223], v[224:225]
  v_lshlrev_b32 v224, 16, v176
  v_and_b32 v225, 0xffff0000, v176
  v_pk_add_f32 v[216:217], v[216:217], v[224:225]
  v_lshlrev_b32 v224, 16, v177
  v_and_b32 v225, 0xffff0000, v177
  v_pk_add_f32 v[218:219], v[218:219], v[224:225]
  v_lshlrev_b32 v224, 16, v178
  v_and_b32 v225, 0xffff0000, v178
  v_pk_add_f32 v[220:221], v[220:221], v[224:225]
  v_lshlrev_b32 v224, 16, v179
  v_and_b32 v225, 0xffff0000, v179
  v_pk_add_f32 v[222:223], v[222:223], v[224:225]
  v_lshlrev_b32 v224, 16, v180
  v_and_b32 v225, 0xffff0000, v180
  v_pk_add_f32 v[216:217], v[216:217], v[224:225]
  v_lshlrev_b32 v224, 16, v181
  v_and_b32 v225, 0xffff0000, v181
  v_pk_add_f32 v[218:219], v[218:219], v[224:225]
  v_lshlrev_b32 v224, 16, v182
  v_and_b32 v225, 0xffff0000, v182
  v_pk_add_f32 v[220:221], v[220:221], v[224:225]
  v_lshlrev_b32 v224, 16, v183
  v_and_b32 v225, 0xffff0000, v183
  v_pk_add_f32 v[222:223], v[222:223], v[224:225]
  v_lshlrev_b32 v224, 16, v184
  v_and_b32 v225, 0xffff0000, v184
  v_pk_add_f32 v[216:217], v[216:217], v[224:225]
  v_lshlrev_b32 v224, 16, v185
  v_and_b32 v225, 0xffff0000, v185
  v_pk_add_f32 v[218:219], v[218:219], v[224:225]
  v_lshlrev_b32 v224, 16, v186
  v_and_b32 v225, 0xffff0000, v186
  v_pk_add_f32 v[220:221], v[220:221], v[224:225]
  v_lshlrev_b32 v224, 16, v187
  v_and_b32 v225, 0xffff0000, v187
  v_pk_add_f32 v[222:223], v[222:223], v[224:225]
  v_lshlrev_b32 v224, 16, v188
  v_and_b32 v225, 0xffff0000, v188
  v_pk_add_f32 v[216:217], v[216:217], v[224:225]
  v_lshlrev_b32 v224, 16, v189
  v_and_b32 v225, 0xffff0000, v189
  v_pk_add_f32 v[218:219], v[218:219], v[224:225]
  v_lshlrev_b32 v224, 16, v190
  v_and_b32 v225, 0xffff0000, v190
  v_pk_add_f32 v[220:221], v[220:221], v[224:225]
  v_lshlrev_b32 v224, 16, v191
  v_and_b32 v225, 0xffff0000, v191
  v_pk_add_f32 v[222:223], v[222:223], v[224:225]
  v_mov_b32 v224, v216
  v_mov_b32 v225, v217
  v_mov_b32 v226, v218
  v_mov_b32 v227, v219
  v_mov_b32 v228, v220
  v_mov_b32 v229, v221
  v_mov_b32 v230, v222
  v_mov_b32 v231, v223
  v_permlane32_swap_b32 v216, v224
  v_permlane32_swap_b32 v217, v225
  v_permlane32_swap_b32 v218, v226
  v_permlane32_swap_b32 v219, v227
  v_permlane32_swap_b32 v220, v228
  v_permlane32_swap_b32 v221, v229
  v_permlane32_swap_b32 v222, v230
  v_permlane32_swap_b32 v223, v231
  v_add_f32 v216, v216, v224
  v_add_f32 v217, v217, v225
  v_add_f32 v218, v218, v226
  v_add_f32 v219, v219, v227
  v_add_f32 v220, v220, v228
  v_add_f32 v221, v221, v229
  v_add_f32 v222, v222, v230
  v_add_f32 v223, v223, v231
  v_mov_b32 v224, v216
  v_mov_b32 v225, v217
  v_mov_b32 v226, v218
  v_mov_b32 v227, v219
  v_mov_b32 v228, v220
  v_mov_b32 v229, v221
  v_mov_b32 v230, v222
  v_mov_b32 v231, v223
  v_permlane16_swap_b32 v216, v224
  v_permlane16_swap_b32 v217, v225
  v_permlane16_swap_b32 v218, v226
  v_permlane16_swap_b32 v219, v227
  v_permlane16_swap_b32 v220, v228
  v_permlane16_swap_b32 v221, v229
  v_permlane16_swap_b32 v222, v230
  v_permlane16_swap_b32 v223, v231
  v_add_f32 v216, v216, v224
  v_add_f32 v217, v217, v225
  v_add_f32 v218, v218, v226
  v_add_f32 v219, v219, v227
  v_add_f32 v220, v220, v228
  v_add_f32 v221, v221, v229
  v_add_f32 v222, v222, v230
  v_add_f32 v223, v223, v231
  v_and_b32 v224, 7, v253
  s_lshl_b32 s43, s40, 8
  s_add_u32 s43, s43, 143360
  v_add_f32_dpp v216, v216, v216 row_ror:8 row_mask:0xf bank_mask:0xf
  v_add_f32_dpp v217, v217, v217 row_ror:8 row_mask:0xf bank_mask:0xf
  v_add_f32_dpp v218, v218, v218 row_ror:8 row_mask:0xf bank_mask:0xf
  v_add_f32_dpp v219, v219, v219 row_ror:8 row_mask:0xf bank_mask:0xf
  v_add_f32_dpp v220, v220, v220 row_ror:8 row_mask:0xf bank_mask:0xf
  v_add_f32_dpp v221, v221, v221 row_ror:8 row_mask:0xf bank_mask:0xf
  v_add_f32_dpp v222, v222, v222 row_ror:8 row_mask:0xf bank_mask:0xf
  v_add_f32_dpp v223, v223, v223 row_ror:8 row_mask:0xf bank_mask:0xf
  v_lshl_add_u32 v224, v224, 5, s43
  ds_write_b128 v224, v[216:219]
  ds_write_b128 v224, v[220:223] offset:16
  s_waitcnt lgkmcnt(0)
  s_barrier
  s_or_b32 s43, s40, s92
  s_cbranch_scc1 Lpf1
  v_lshlrev_b32 v224, 2, v253
  v_add_u32 v225, 143360, v224
  ds_read_b32 v226, v225 offset:0
  ds_read_b32 v227, v225 offset:256
  ds_read_b32 v228, v225 offset:512
  ds_read_b32 v229, v225 offset:768
  s_waitcnt lgkmcnt(0)
  v_add_f32 v226, v226, v227
  v_add_f32 v228, v228, v229
  v_add_f32 v226, v226, v228
  buffer_store_dword v226, v224, s[4:7], s83 offen sc1
Lpf1:
  s_branch Lp1_common
Llayer:
  s_cmp_lg_u32 s40, 0
  s_cbranch_scc1 Lpdn3
  s_mov_b32 s43, 0x40000
  s_mov_b64 exec, 3
Lpol2:
  buffer_load_dword v250, v249, s[4:7], s77 offen sc1
  s_waitcnt vmcnt(0)
  v_cmp_gt_u32 vcc, 16, v250
  s_cbranch_vccz Lpdn3
  s_sub_u32 s43, s43, 1
  s_cmp_lg_u32 s43, 0
  s_cbranch_scc1 Lpol2
Lpdn3:
  s_mov_b64 exec, -1
  s_waitcnt vmcnt(0) lgkmcnt(0)
  s_barrier
  s_cmp_eq_u32 s67, s40
  s_cselect_b32 s44, 4, 0
  s_add_u32 s44, s44, s40
  s_mul_i32 s44, s44, s61
  s_lshl_b32 s45, s40, 10
  s_add_u32 m0, s45, 122880
  s_add_u32 s44, s44, s73
  buffer_load_dwordx4 v126, s[28:31], s44 offen sc1 lds
  s_cmp_eq_u32 s67, 0
  s_cselect_b32 s44, 4, 0
  s_mul_i32 s45, s44, s61
  s_add_u32 s68, s45, s59
  s_add_u32 m0, s62, 73728
  s_nop 0
  buffer_load_dwordx4 v120, s[28:31], s68 offen offset:0 sc1 lds
  buffer_load_dwordx4 v121, s[28:31], s68 offen offset:1024 sc1 lds
  buffer_load_dwordx4 v122, s[28:31], s68 offen offset:2048 sc1 lds
  buffer_load_dwordx4 v123, s[28:31], s68 offen offset:3072 sc1 lds
Lp1_common:
  s_cmp_eq_u32 s67, s40
  s_cselect_b32 s44, 8, 4
  s_add_u32 s44, s44, s40
  s_mul_i32 s44, s44, s61
  s_lshl_b32 s45, s40, 10
  s_add_u32 m0, s45, 126976
  s_add_u32 s44, s44, s73
  buffer_load_dwordx4 v126, s[28:31], s44 offen sc1 lds
  s_cmp_eq_u32 s67, s40
  s_cselect_b32 s44, 12, 8
  s_add_u32 s44, s44, s40
  s_mul_i32 s44, s44, s61
  s_lshl_b32 s45, s40, 10
  s_add_u32 m0, s45, 131072
  s_add_u32 s44, s44, s73
  buffer_load_dwordx4 v126, s[28:31], s44 offen sc1 lds
  s_cmp_eq_u32 s67, s40
  s_cselect_b32 s44, 0, 12
  s_add_u32 s44, s44, s40
  s_mul_i32 s44, s44, s61
  s_lshl_b32 s45, s40, 10
  s_add_u32 m0, s45, 135168
  s_add_u32 s44, s44, s73
  buffer_load_dwordx4 v126, s[28:31], s44 offen sc1 lds
  s_cmp_eq_u32 s67, 1
  s_cselect_b32 s44, 5, 1
  s_mul_i32 s45, s44, s61
  s_add_u32 s68, s45, s59
  s_add_u32 m0, s62, 90112
  s_nop 0
  buffer_load_dwordx4 v120, s[28:31], s68 offen offset:0 sc1 lds
  buffer_load_dwordx4 v121, s[28:31], s68 offen offset:1024 sc1 lds
  buffer_load_dwordx4 v122, s[28:31], s68 offen offset:2048 sc1 lds
  buffer_load_dwordx4 v123, s[28:31], s68 offen offset:3072 sc1 lds
  s_cmp_eq_u32 s67, 2
  s_cselect_b32 s44, 6, 2
  s_mul_i32 s45, s44, s61
  s_add_u32 s68, s45, s59
  s_mul_i32 s45, s44, 393216
  s_add_u32 s69, s45, s60
  s_add_u32 s70, s69, 4096
  s_add_u32 m0, s62, 106496
  s_nop 0
  buffer_load_dwordx4 v120, s[28:31], s68 offen offset:0 sc1 lds
  buffer_load_dwordx4 v121, s[28:31], s68 offen offset:1024 sc1 lds
  buffer_load_dwordx4 v122, s[28:31], s68 offen offset:2048 sc1 lds
  buffer_load_dwordx4 v123, s[28:31], s68 offen offset:3072 sc1 lds
  s_add_u32 m0, s63, 49152
  s_nop 0
  buffer_load_dwordx4 v124, s[8:11], s69 offen offset:0 lds
  buffer_load_dwordx4 v125, s[8:11], s69 offen offset:1024 lds
  buffer_load_dwordx4 v124, s[8:11], s69 offen offset:2048 lds
  buffer_load_dwordx4 v125, s[8:11], s69 offen offset:3072 lds
  s_add_u32 m0, s63, 53248
  s_nop 0
  buffer_load_dwordx4 v124, s[8:11], s70 offen offset:0 lds
  buffer_load_dwordx4 v125, s[8:11], s70 offen offset:1024 lds
  s_mov_b32 s66, 3
  s_waitcnt vmcnt(17)
  s_barrier
  ds_read_b64_tr_b16 a[40:41], v116 offset:0
  ds_read_b64_tr_b16 a[42:43], v116 offset:6144
  ds_read_b64_tr_b16 a[64:65], v116 offset:12288
  ds_read_b64_tr_b16 a[66:67], v116 offset:18432
  ds_read_b128 a[4:7], v112 offset:0
  ds_read_b128 a[24:27], v113 offset:0
  ds_read_b128 a[8:11], v112 offset:2048
  ds_read_b128 a[28:31], v113 offset:2048
  ds_read_b128 a[12:15], v112 offset:4096
  ds_read_b128 a[32:35], v113 offset:4096
  ds_read_b128 a[16:19], v112 offset:6144
  ds_read_b128 a[36:39], v113 offset:6144
  ds_read_b64_tr_b16 a[44:45], v117 offset:0
  ds_read_b64_tr_b16 a[46:47], v117 offset:6144
  ds_read_b64_tr_b16 a[68:69], v117 offset:12288
  ds_read_b64_tr_b16 a[70:71], v117 offset:18432
  ds_read_b128 a[0:3], v114
  v_add_u32 v114, s64, v114
  ds_read_b128 a[20:23], v115
  v_add_u32 v115, s64, v115
  ds_read_b64_tr_b16 a[48:49], v116 offset:2048
  ds_read_b64_tr_b16 a[50:51], v116 offset:8192
  ds_read_b64_tr_b16 a[72:73], v116 offset:14336
  ds_read_b64_tr_b16 a[74:75], v116 offset:20480
  ds_read_b64_tr_b16 a[52:53], v117 offset:2048
  ds_read_b64_tr_b16 a[54:55], v117 offset:8192
  ds_read_b64_tr_b16 a[76:77], v117 offset:14336
  ds_read_b64_tr_b16 a[78:79], v117 offset:20480
  ds_read_b64_tr_b16 a[56:57], v116 offset:4096
  ds_read_b64_tr_b16 a[58:59], v116 offset:10240
  ds_read_b64_tr_b16 a[80:81], v116 offset:16384
  ds_read_b64_tr_b16 a[82:83], v116 offset:22528
  ds_read_b64_tr_b16 a[60:61], v117 offset:4096
  ds_read_b64_tr_b16 a[62:63], v117 offset:10240
  ds_read_b64_tr_b16 a[84:85], v117 offset:16384
  ds_read_b64_tr_b16 a[86:87], v117 offset:22528
  s_or_b32 s43, s40, s41
  s_cbranch_scc1 Lar4
  v_mov_b32 v250, 1
  s_mov_b64 exec, 1
  buffer_atomic_add v250, v251, s[36:39], 0 offen offset:0 sc1
  s_mov_b64 exec, -1
Lar4:
  s_mov_b32 s56, 2
.p2align 3
Lp1_loop:
  s_waitcnt lgkmcnt(15)
  v_mfma_f32_16x16x32_bf16 v[0:3], a[40:43], a[4:7], v[0:3]
  s_and_b32 s44, s66, 3
  v_mfma_f32_16x16x32_bf16 v[0:3], a[64:67], a[24:27], v[0:3]
  s_cmp_eq_u32 s44, s67
  s_cselect_b32 s44, 4, 0
  v_mfma_f32_16x16x32_bf16 v[4:7], a[64:67], a[28:31], v[4:7]
  s_add_u32 s44, s44, s66
  v_mfma_f32_16x16x32_bf16 v[4:7], a[40:43], a[8:11], v[4:7]
  s_and_b32 s44, s44, 15
  v_mfma_f32_16x16x32_bf16 v[8:11], a[40:43], a[12:15], v[8:11]
  s_add_u32 s66, s66, 1
  v_mfma_f32_16x16x32_bf16 v[8:11], a[64:67], a[32:35], v[8:11]
  s_mul_i32 s45, s44, s61
  v_mfma_f32_16x16x32_bf16 v[12:15], a[64:67], a[36:39], v[12:15]
  s_add_u32 s68, s45, s59
  v_mfma_f32_16x16x32_bf16 v[12:15], a[40:43], a[16:19], v[12:15]
  s_mul_i32 s45, s44, 393216
  v_mfma_f32_16x16x32_bf16 v[28:31], a[44:47], a[16:19], v[28:31]
  s_add_u32 s69, s45, s60
  v_mfma_f32_16x16x32_bf16 v[28:31], a[68:71], a[36:39], v[28:31]
  s_add_u32 s70, s69, 4096
  v_mfma_f32_16x16x32_bf16 v[24:27], a[68:71], a[32:35], v[24:27]
  v_mfma_f32_16x16x32_bf16 v[24:27], a[44:47], a[12:15], v[24:27]
  v_mfma_f32_16x16x32_bf16 v[20:23], a[44:47], a[8:11], v[20:23]
  s_waitcnt vmcnt(10) lgkmcnt(0)
  s_barrier
  ds_read_b64_tr_b16 a[128:129], v116 offset:24576
  v_mfma_f32_16x16x32_bf16 v[20:23], a[68:71], a[28:31], v[20:23]
  ds_read_b64_tr_b16 a[130:131], v116 offset:30720
  s_add_u32 m0, s62, 73728
  v_mfma_f32_16x16x32_bf16 v[16:19], a[68:71], a[24:27], v[16:19]
  ds_read_b64_tr_b16 a[152:153], v116 offset:36864
  buffer_load_dwordx4 v120, s[28:31], s68 offen offset:0 sc1 lds
  v_mfma_f32_16x16x32_bf16 v[16:19], a[44:47], a[4:7], v[16:19]
  ds_read_b64_tr_b16 a[154:155], v116 offset:43008
  v_mfma_f32_16x16x32_bf16 v[32:35], a[48:51], a[0:3], v[32:35]
  ds_read_b128 a[92:95], v112 offset:16384
  v_mfma_f32_16x16x32_bf16 v[32:35], a[72:75], a[20:23], v[32:35]
  ds_read_b128 a[112:115], v113 offset:16384
  v_mfma_f32_16x16x32_bf16 v[36:39], a[72:75], a[24:27], v[36:39]
  ds_read_b128 a[96:99], v112 offset:18432
  buffer_load_dwordx4 v121, s[28:31], s68 offen offset:1024 sc1 lds
  v_mfma_f32_16x16x32_bf16 v[36:39], a[48:51], a[4:7], v[36:39]
  ds_read_b128 a[116:119], v113 offset:18432
  v_mfma_f32_16x16x32_bf16 v[40:43], a[48:51], a[8:11], v[40:43]
  ds_read_b128 a[100:103], v112 offset:20480
  v_mfma_f32_16x16x32_bf16 v[40:43], a[72:75], a[28:31], v[40:43]
  ds_read_b128 a[120:123], v113 offset:20480
  v_mfma_f32_16x16x32_bf16 v[44:47], a[72:75], a[32:35], v[44:47]
  ds_read_b128 a[104:107], v112 offset:22528
  buffer_load_dwordx4 v122, s[28:31], s68 offen offset:2048 sc1 lds
  v_mfma_f32_16x16x32_bf16 v[44:47], a[48:51], a[12:15], v[44:47]
  ds_read_b128 a[124:127], v113 offset:22528
  v_mfma_f32_16x16x32_bf16 v[48:51], a[48:51], a[16:19], v[48:51]
  ds_read_b64_tr_b16 a[132:133], v117 offset:24576
  v_mfma_f32_16x16x32_bf16 v[48:51], a[72:75], a[36:39], v[48:51]
  ds_read_b64_tr_b16 a[134:135], v117 offset:30720
  v_mfma_f32_16x16x32_bf16 v[68:71], a[76:79], a[36:39], v[68:71]
  ds_read_b64_tr_b16 a[156:157], v117 offset:36864
  buffer_load_dwordx4 v123, s[28:31], s68 offen offset:3072 sc1 lds
  v_mfma_f32_16x16x32_bf16 v[68:71], a[52:55], a[16:19], v[68:71]
  ds_read_b64_tr_b16 a[158:159], v117 offset:43008
  v_mfma_f32_16x16x32_bf16 v[64:67], a[52:55], a[12:15], v[64:67]
  ds_read_b128 a[88:91], v114
  v_add_u32 v114, s64, v114
  v_mfma_f32_16x16x32_bf16 v[64:67], a[76:79], a[32:35], v[64:67]
  ds_read_b128 a[108:111], v115
  v_add_u32 v115, s64, v115
  s_add_u32 m0, s63, 0
  v_mfma_f32_16x16x32_bf16 v[60:63], a[76:79], a[28:31], v[60:63]
  ds_read_b64_tr_b16 a[136:137], v116 offset:26624
  buffer_load_dwordx4 v124, s[8:11], s69 offen offset:0 lds
  v_mfma_f32_16x16x32_bf16 v[60:63], a[52:55], a[8:11], v[60:63]
  ds_read_b64_tr_b16 a[138:139], v116 offset:32768
  v_mfma_f32_16x16x32_bf16 v[56:59], a[52:55], a[4:7], v[56:59]
  ds_read_b64_tr_b16 a[160:161], v116 offset:38912
  v_mfma_f32_16x16x32_bf16 v[56:59], a[76:79], a[24:27], v[56:59]
  ds_read_b64_tr_b16 a[162:163], v116 offset:45056
  v_mfma_f32_16x16x32_bf16 v[52:55], a[76:79], a[20:23], v[52:55]
  ds_read_b64_tr_b16 a[140:141], v117 offset:26624
  buffer_load_dwordx4 v125, s[8:11], s69 offen offset:1024 lds
  v_mfma_f32_16x16x32_bf16 v[52:55], a[52:55], a[0:3], v[52:55]
  ds_read_b64_tr_b16 a[142:143], v117 offset:32768
  v_mfma_f32_16x16x32_bf16 v[72:75], a[0:3], a[56:59], v[72:75]
  ds_read_b64_tr_b16 a[164:165], v117 offset:38912
  v_mfma_f32_16x16x32_bf16 v[72:75], a[20:23], a[80:83], v[72:75]
  ds_read_b64_tr_b16 a[166:167], v117 offset:45056
  v_mfma_f32_16x16x32_bf16 v[76:79], a[24:27], a[80:83], v[76:79]
  ds_read_b64_tr_b16 a[144:145], v116 offset:28672
  buffer_load_dwordx4 v124, s[8:11], s69 offen offset:2048 lds
  v_mfma_f32_16x16x32_bf16 v[76:79], a[4:7], a[56:59], v[76:79]
  ds_read_b64_tr_b16 a[146:147], v116 offset:34816
  v_mfma_f32_16x16x32_bf16 v[80:83], a[8:11], a[56:59], v[80:83]
  ds_read_b64_tr_b16 a[168:169], v116 offset:40960
  v_mfma_f32_16x16x32_bf16 v[80:83], a[28:31], a[80:83], v[80:83]
  ds_read_b64_tr_b16 a[170:171], v116 offset:47104
  v_mfma_f32_16x16x32_bf16 v[84:87], a[32:35], a[80:83], v[84:87]
  ds_read_b64_tr_b16 a[148:149], v117 offset:28672
  buffer_load_dwordx4 v125, s[8:11], s69 offen offset:3072 lds
  v_mfma_f32_16x16x32_bf16 v[84:87], a[12:15], a[56:59], v[84:87]
  ds_read_b64_tr_b16 a[150:151], v117 offset:34816
  v_mfma_f32_16x16x32_bf16 v[88:91], a[16:19], a[56:59], v[88:91]
  ds_read_b64_tr_b16 a[172:173], v117 offset:40960
  v_mfma_f32_16x16x32_bf16 v[88:91], a[36:39], a[80:83], v[88:91]
  ds_read_b64_tr_b16 a[174:175], v117 offset:47104
  s_add_u32 m0, s63, 4096
  v_mfma_f32_16x16x32_bf16 v[108:111], a[36:39], a[84:87], v[108:111]
  buffer_load_dwordx4 v124, s[8:11], s70 offen offset:0 lds
  v_mfma_f32_16x16x32_bf16 v[108:111], a[16:19], a[60:63], v[108:111]
  v_mfma_f32_16x16x32_bf16 v[104:107], a[12:15], a[60:63], v[104:107]
  v_mfma_f32_16x16x32_bf16 v[104:107], a[32:35], a[84:87], v[104:107]
  v_mfma_f32_16x16x32_bf16 v[100:103], a[28:31], a[84:87], v[100:103]
  buffer_load_dwordx4 v125, s[8:11], s70 offen offset:1024 lds
  v_mfma_f32_16x16x32_bf16 v[100:103], a[8:11], a[60:63], v[100:103]
  v_mfma_f32_16x16x32_bf16 v[96:99], a[4:7], a[60:63], v[96:99]
  v_mfma_f32_16x16x32_bf16 v[96:99], a[24:27], a[84:87], v[96:99]
  v_mfma_f32_16x16x32_bf16 v[92:95], a[20:23], a[84:87], v[92:95]
  v_mfma_f32_16x16x32_bf16 v[92:95], a[0:3], a[60:63], v[92:95]
  s_waitcnt lgkmcnt(15)
  v_mfma_f32_16x16x32_bf16 v[0:3], a[128:131], a[92:95], v[0:3]
  s_and_b32 s44, s66, 3
  v_mfma_f32_16x16x32_bf16 v[0:3], a[152:155], a[112:115], v[0:3]
  s_cmp_eq_u32 s44, s67
  s_cselect_b32 s44, 4, 0
  v_mfma_f32_16x16x32_bf16 v[4:7], a[152:155], a[116:119], v[4:7]
  s_add_u32 s44, s44, s66
  v_mfma_f32_16x16x32_bf16 v[4:7], a[128:131], a[96:99], v[4:7]
  s_and_b32 s44, s44, 15
  v_mfma_f32_16x16x32_bf16 v[8:11], a[128:131], a[100:103], v[8:11]
  s_add_u32 s66, s66, 1
  v_mfma_f32_16x16x32_bf16 v[8:11], a[152:155], a[120:123], v[8:11]
  s_mul_i32 s45, s44, s61
  v_mfma_f32_16x16x32_bf16 v[12:15], a[152:155], a[124:127], v[12:15]
  s_add_u32 s68, s45, s59
  v_mfma_f32_16x16x32_bf16 v[12:15], a[128:131], a[104:107], v[12:15]
  s_mul_i32 s45, s44, 393216
  v_mfma_f32_16x16x32_bf16 v[28:31], a[132:135], a[104:107], v[28:31]
  s_add_u32 s69, s45, s60
  v_mfma_f32_16x16x32_bf16 v[28:31], a[156:159], a[124:127], v[28:31]
  s_add_u32 s70, s69, 4096
  v_mfma_f32_16x16x32_bf16 v[24:27], a[156:159], a[120:123], v[24:27]
  v_mfma_f32_16x16x32_bf16 v[24:27], a[132:135], a[100:103], v[24:27]
  v_mfma_f32_16x16x32_bf16 v[20:23], a[132:135], a[96:99], v[20:23]
  s_waitcnt vmcnt(10) lgkmcnt(0)
  s_barrier
  ds_read_b64_tr_b16 a[40:41], v118 offset:0
  v_mfma_f32_16x16x32_bf16 v[20:23], a[156:159], a[116:119], v[20:23]
  ds_read_b64_tr_b16 a[42:43], v118 offset:6144
  s_add_u32 m0, s62, 90112
  v_mfma_f32_16x16x32_bf16 v[16:19], a[156:159], a[112:115], v[16:19]
  ds_read_b64_tr_b16 a[64:65], v118 offset:12288
  buffer_load_dwordx4 v120, s[28:31], s68 offen offset:0 sc1 lds
  v_mfma_f32_16x16x32_bf16 v[16:19], a[132:135], a[92:95], v[16:19]
  ds_read_b64_tr_b16 a[66:67], v118 offset:18432
  v_mfma_f32_16x16x32_bf16 v[32:35], a[136:139], a[88:91], v[32:35]
  ds_read_b128 a[4:7], v112 offset:32768
  v_mfma_f32_16x16x32_bf16 v[32:35], a[160:163], a[108:111], v[32:35]
  ds_read_b128 a[24:27], v113 offset:32768
  v_mfma_f32_16x16x32_bf16 v[36:39], a[160:163], a[112:115], v[36:39]
  ds_read_b128 a[8:11], v112 offset:34816
  buffer_load_dwordx4 v121, s[28:31], s68 offen offset:1024 sc1 lds
  v_mfma_f32_16x16x32_bf16 v[36:39], a[136:139], a[92:95], v[36:39]
  ds_read_b128 a[28:31], v113 offset:34816
  v_mfma_f32_16x16x32_bf16 v[40:43], a[136:139], a[96:99], v[40:43]
  ds_read_b128 a[12:15], v112 offset:36864
  v_mfma_f32_16x16x32_bf16 v[40:43], a[160:163], a[116:119], v[40:43]
  ds_read_b128 a[32:35], v113 offset:36864
  v_mfma_f32_16x16x32_bf16 v[44:47], a[160:163], a[120:123], v[44:47]
  ds_read_b128 a[16:19], v112 offset:38912
  buffer_load_dwordx4 v122, s[28:31], s68 offen offset:2048 sc1 lds
  v_mfma_f32_16x16x32_bf16 v[44:47], a[136:139], a[100:103], v[44:47]
  ds_read_b128 a[36:39], v113 offset:38912
  v_mfma_f32_16x16x32_bf16 v[48:51], a[136:139], a[104:107], v[48:51]
  ds_read_b64_tr_b16 a[44:45], v119 offset:0
  v_mfma_f32_16x16x32_bf16 v[48:51], a[160:163], a[124:127], v[48:51]
  ds_read_b64_tr_b16 a[46:47], v119 offset:6144
  v_mfma_f32_16x16x32_bf16 v[68:71], a[164:167], a[124:127], v[68:71]
  ds_read_b64_tr_b16 a[68:69], v119 offset:12288
  buffer_load_dwordx4 v123, s[28:31], s68 offen offset:3072 sc1 lds
  v_mfma_f32_16x16x32_bf16 v[68:71], a[140:143], a[104:107], v[68:71]
  ds_read_b64_tr_b16 a[70:71], v119 offset:18432
  v_mfma_f32_16x16x32_bf16 v[64:67], a[140:143], a[100:103], v[64:67]
  ds_read_b128 a[0:3], v114
  v_add_u32 v114, s65, v114
  v_mfma_f32_16x16x32_bf16 v[64:67], a[164:167], a[120:123], v[64:67]
  ds_read_b128 a[20:23], v115
  v_add_u32 v115, s65, v115
  s_add_u32 m0, s63, 24576
  v_mfma_f32_16x16x32_bf16 v[60:63], a[164:167], a[116:119], v[60:63]
  ds_read_b64_tr_b16 a[48:49], v118 offset:2048
  buffer_load_dwordx4 v124, s[8:11], s69 offen offset:0 lds
  v_mfma_f32_16x16x32_bf16 v[60:63], a[140:143], a[96:99], v[60:63]
  ds_read_b64_tr_b16 a[50:51], v118 offset:8192
  v_mfma_f32_16x16x32_bf16 v[56:59], a[140:143], a[92:95], v[56:59]
  ds_read_b64_tr_b16 a[72:73], v118 offset:14336
  v_mfma_f32_16x16x32_bf16 v[56:59], a[164:167], a[112:115], v[56:59]
  ds_read_b64_tr_b16 a[74:75], v118 offset:20480
  v_mfma_f32_16x16x32_bf16 v[52:55], a[164:167], a[108:111], v[52:55]
  ds_read_b64_tr_b16 a[52:53], v119 offset:2048
  buffer_load_dwordx4 v125, s[8:11], s69 offen offset:1024 lds
  v_mfma_f32_16x16x32_bf16 v[52:55], a[140:143], a[88:91], v[52:55]
  ds_read_b64_tr_b16 a[54:55], v119 offset:8192
  v_mfma_f32_16x16x32_bf16 v[72:75], a[88:91], a[144:147], v[72:75]
  ds_read_b64_tr_b16 a[76:77], v119 offset:14336
  v_mfma_f32_16x16x32_bf16 v[72:75], a[108:111], a[168:171], v[72:75]
  ds_read_b64_tr_b16 a[78:79], v119 offset:20480
  v_mfma_f32_16x16x32_bf16 v[76:79], a[112:115], a[168:171], v[76:79]
  ds_read_b64_tr_b16 a[56:57], v118 offset:4096
  buffer_load_dwordx4 v124, s[8:11], s69 offen offset:2048 lds
  v_mfma_f32_16x16x32_bf16 v[76:79], a[92:95], a[144:147], v[76:79]
  ds_read_b64_tr_b16 a[58:59], v118 offset:10240
  v_mfma_f32_16x16x32_bf16 v[80:83], a[96:99], a[144:147], v[80:83]
  ds_read_b64_tr_b16 a[80:81], v118 offset:16384
  v_mfma_f32_16x16x32_bf16 v[80:83], a[116:119], a[168:171], v[80:83]
  ds_read_b64_tr_b16 a[82:83], v118 offset:22528
  v_mfma_f32_16x16x32_bf16 v[84:87], a[120:123], a[168:171], v[84:87]
  ds_read_b64_tr_b16 a[60:61], v119 offset:4096
  buffer_load_dwordx4 v125, s[8:11], s69 offen offset:3072 lds
  v_mfma_f32_16x16x32_bf16 v[84:87], a[100:103], a[144:147], v[84:87]
  ds_read_b64_tr_b16 a[62:63], v119 offset:10240
  v_mfma_f32_16x16x32_bf16 v[88:91], a[104:107], a[144:147], v[88:91]
  ds_read_b64_tr_b16 a[84:85], v119 offset:16384
  v_mfma_f32_16x16x32_bf16 v[88:91], a[124:127], a[168:171], v[88:91]
  ds_read_b64_tr_b16 a[86:87], v119 offset:22528
  s_add_u32 m0, s63, 28672
  v_mfma_f32_16x16x32_bf16 v[108:111], a[124:127], a[172:175], v[108:111]
  buffer_load_dwordx4 v124, s[8:11], s70 offen offset:0 lds
  v_mfma_f32_16x16x32_bf16 v[108:111], a[104:107], a[148:151], v[108:111]
  v_mfma_f32_16x16x32_bf16 v[104:107], a[100:103], a[148:151], v[104:107]
  v_mfma_f32_16x16x32_bf16 v[104:107], a[120:123], a[172:175], v[104:107]
  v_mfma_f32_16x16x32_bf16 v[100:103], a[116:119], a[172:175], v[100:103]
  buffer_load_dwordx4 v125, s[8:11], s70 offen offset:1024 lds
  v_mfma_f32_16x16x32_bf16 v[100:103], a[96:99], a[148:151], v[100:103]
  v_mfma_f32_16x16x32_bf16 v[96:99], a[92:95], a[148:151], v[96:99]
  v_mfma_f32_16x16x32_bf16 v[96:99], a[112:115], a[172:175], v[96:99]
  v_mfma_f32_16x16x32_bf16 v[92:95], a[108:111], a[172:175], v[92:95]
  v_mfma_f32_16x16x32_bf16 v[92:95], a[88:91], a[148:151], v[92:95]
  s_waitcnt lgkmcnt(15)
  v_mfma_f32_16x16x32_bf16 v[0:3], a[40:43], a[4:7], v[0:3]
  s_and_b32 s44, s66, 3
  v_mfma_f32_16x16x32_bf16 v[0:3], a[64:67], a[24:27], v[0:3]
  s_cmp_eq_u32 s44, s67
  s_cselect_b32 s44, 4, 0
  v_mfma_f32_16x16x32_bf16 v[4:7], a[64:67], a[28:31], v[4:7]
  s_add_u32 s44, s44, s66
  v_mfma_f32_16x16x32_bf16 v[4:7], a[40:43], a[8:11], v[4:7]
  s_and_b32 s44, s44, 15
  v_mfma_f32_16x16x32_bf16 v[8:11], a[40:43], a[12:15], v[8:11]
  s_add_u32 s66, s66, 1
  v_mfma_f32_16x16x32_bf16 v[8:11], a[64:67], a[32:35], v[8:11]
  s_mul_i32 s45, s44, s61
  v_mfma_f32_16x16x32_bf16 v[12:15], a[64:67], a[36:39], v[12:15]
  s_add_u32 s68, s45, s59
  v_mfma_f32_16x16x32_bf16 v[12:15], a[40:43], a[16:19], v[12:15]
  s_mul_i32 s45, s44, 393216
  v_mfma_f32_16x16x32_bf16 v[28:31], a[44:47], a[16:19], v[28:31]
  s_add_u32 s69, s45, s60
  v_mfma_f32_16x16x32_bf16 v[28:31], a[68:71], a[36:39], v[28:31]
  s_add_u32 s70, s69, 4096
  v_mfma_f32_16x16x32_bf16 v[24:27], a[68:71], a[32:35], v[24:27]
  v_mfma_f32_16x16x32_bf16 v[24:27], a[44:47], a[12:15], v[24:27]
  v_mfma_f32_16x16x32_bf16 v[20:23], a[44:47], a[8:11], v[20:23]
  s_waitcnt vmcnt(10) lgkmcnt(0)
  s_barrier
  ds_read_b64_tr_b16 a[128:129], v116 offset:0
  v_mfma_f32_16x16x32_bf16 v[20:23], a[68:71], a[28:31], v[20:23]
  ds_read_b64_tr_b16 a[130:131], v116 offset:6144
  s_add_u32 m0, s62, 106496
  v_mfma_f32_16x16x32_bf16 v[16:19], a[68:71], a[24:27], v[16:19]
  ds_read_b64_tr_b16 a[152:153], v116 offset:12288
  buffer_load_dwordx4 v120, s[28:31], s68 offen offset:0 sc1 lds
  v_mfma_f32_16x16x32_bf16 v[16:19], a[44:47], a[4:7], v[16:19]
  ds_read_b64_tr_b16 a[154:155], v116 offset:18432
  v_mfma_f32_16x16x32_bf16 v[32:35], a[48:51], a[0:3], v[32:35]
  ds_read_b128 a[92:95], v112 offset:0
  v_mfma_f32_16x16x32_bf16 v[32:35], a[72:75], a[20:23], v[32:35]
  ds_read_b128 a[112:115], v113 offset:0
  v_mfma_f32_16x16x32_bf16 v[36:39], a[72:75], a[24:27], v[36:39]
  ds_read_b128 a[96:99], v112 offset:2048
  buffer_load_dwordx4 v121, s[28:31], s68 offen offset:1024 sc1 lds
  v_mfma_f32_16x16x32_bf16 v[36:39], a[48:51], a[4:7], v[36:39]
  ds_read_b128 a[116:119], v113 offset:2048
  v_mfma_f32_16x16x32_bf16 v[40:43], a[48:51], a[8:11], v[40:43]
  ds_read_b128 a[100:103], v112 offset:4096
  v_mfma_f32_16x16x32_bf16 v[40:43], a[72:75], a[28:31], v[40:43]
  ds_read_b128 a[120:123], v113 offset:4096
  v_mfma_f32_16x16x32_bf16 v[44:47], a[72:75], a[32:35], v[44:47]
  ds_read_b128 a[104:107], v112 offset:6144
  buffer_load_dwordx4 v122, s[28:31], s68 offen offset:2048 sc1 lds
  v_mfma_f32_16x16x32_bf16 v[44:47], a[48:51], a[12:15], v[44:47]
  ds_read_b128 a[124:127], v113 offset:6144
  v_mfma_f32_16x16x32_bf16 v[48:51], a[48:51], a[16:19], v[48:51]
  ds_read_b64_tr_b16 a[132:133], v117 offset:0
  v_mfma_f32_16x16x32_bf16 v[48:51], a[72:75], a[36:39], v[48:51]
  ds_read_b64_tr_b16 a[134:135], v117 offset:6144
  v_mfma_f32_16x16x32_bf16 v[68:71], a[76:79], a[36:39], v[68:71]
  ds_read_b64_tr_b16 a[156:157], v117 offset:12288
  buffer_load_dwordx4 v123, s[28:31], s68 offen offset:3072 sc1 lds
  v_mfma_f32_16x16x32_bf16 v[68:71], a[52:55], a[16:19], v[68:71]
  ds_read_b64_tr_b16 a[158:159], v117 offset:18432
  v_mfma_f32_16x16x32_bf16 v[64:67], a[52:55], a[12:15], v[64:67]
  ds_read_b128 a[88:91], v114
  v_add_u32 v114, s64, v114
  v_mfma_f32_16x16x32_bf16 v[64:67], a[76:79], a[32:35], v[64:67]
  ds_read_b128 a[108:111], v115
  v_add_u32 v115, s64, v115
  s_add_u32 m0, s63, 49152
  v_mfma_f32_16x16x32_bf16 v[60:63], a[76:79], a[28:31], v[60:63]
  ds_read_b64_tr_b16 a[136:137], v116 offset:2048
  buffer_load_dwordx4 v124, s[8:11], s69 offen offset:0 lds
  v_mfma_f32_16x16x32_bf16 v[60:63], a[52:55], a[8:11], v[60:63]
  ds_read_b64_tr_b16 a[138:139], v116 offset:8192
  v_mfma_f32_16x16x32_bf16 v[56:59], a[52:55], a[4:7], v[56:59]
  ds_read_b64_tr_b16 a[160:161], v116 offset:14336
  v_mfma_f32_16x16x32_bf16 v[56:59], a[76:79], a[24:27], v[56:59]
  ds_read_b64_tr_b16 a[162:163], v116 offset:20480
  v_mfma_f32_16x16x32_bf16 v[52:55], a[76:79], a[20:23], v[52:55]
  ds_read_b64_tr_b16 a[140:141], v117 offset:2048
  buffer_load_dwordx4 v125, s[8:11], s69 offen offset:1024 lds
  v_mfma_f32_16x16x32_bf16 v[52:55], a[52:55], a[0:3], v[52:55]
  ds_read_b64_tr_b16 a[142:143], v117 offset:8192
  v_mfma_f32_16x16x32_bf16 v[72:75], a[0:3], a[56:59], v[72:75]
  ds_read_b64_tr_b16 a[164:165], v117 offset:14336
  v_mfma_f32_16x16x32_bf16 v[72:75], a[20:23], a[80:83], v[72:75]
  ds_read_b64_tr_b16 a[166:167], v117 offset:20480
  v_mfma_f32_16x16x32_bf16 v[76:79], a[24:27], a[80:83], v[76:79]
  ds_read_b64_tr_b16 a[144:145], v116 offset:4096
  buffer_load_dwordx4 v124, s[8:11], s69 offen offset:2048 lds
  v_mfma_f32_16x16x32_bf16 v[76:79], a[4:7], a[56:59], v[76:79]
  ds_read_b64_tr_b16 a[146:147], v116 offset:10240
  v_mfma_f32_16x16x32_bf16 v[80:83], a[8:11], a[56:59], v[80:83]
  ds_read_b64_tr_b16 a[168:169], v116 offset:16384
  v_mfma_f32_16x16x32_bf16 v[80:83], a[28:31], a[80:83], v[80:83]
  ds_read_b64_tr_b16 a[170:171], v116 offset:22528
  v_mfma_f32_16x16x32_bf16 v[84:87], a[32:35], a[80:83], v[84:87]
  ds_read_b64_tr_b16 a[148:149], v117 offset:4096
  buffer_load_dwordx4 v125, s[8:11], s69 offen offset:3072 lds
  v_mfma_f32_16x16x32_bf16 v[84:87], a[12:15], a[56:59], v[84:87]
  ds_read_b64_tr_b16 a[150:151], v117 offset:10240
  v_mfma_f32_16x16x32_bf16 v[88:91], a[16:19], a[56:59], v[88:91]
  ds_read_b64_tr_b16 a[172:173], v117 offset:16384
  v_mfma_f32_16x16x32_bf16 v[88:91], a[36:39], a[80:83], v[88:91]
  ds_read_b64_tr_b16 a[174:175], v117 offset:22528
  s_add_u32 m0, s63, 53248
  v_mfma_f32_16x16x32_bf16 v[108:111], a[36:39], a[84:87], v[108:111]
  buffer_load_dwordx4 v124, s[8:11], s70 offen offset:0 lds
  v_mfma_f32_16x16x32_bf16 v[108:111], a[16:19], a[60:63], v[108:111]
  v_mfma_f32_16x16x32_bf16 v[104:107], a[12:15], a[60:63], v[104:107]
  v_mfma_f32_16x16x32_bf16 v[104:107], a[32:35], a[84:87], v[104:107]
  v_mfma_f32_16x16x32_bf16 v[100:103], a[28:31], a[84:87], v[100:103]
  buffer_load_dwordx4 v125, s[8:11], s70 offen offset:1024 lds
  v_mfma_f32_16x16x32_bf16 v[100:103], a[8:11], a[60:63], v[100:103]
  v_mfma_f32_16x16x32_bf16 v[96:99], a[4:7], a[60:63], v[96:99]
  v_mfma_f32_16x16x32_bf16 v[96:99], a[24:27], a[84:87], v[96:99]
  v_mfma_f32_16x16x32_bf16 v[92:95], a[20:23], a[84:87], v[92:95]
  v_mfma_f32_16x16x32_bf16 v[92:95], a[0:3], a[60:63], v[92:95]
  s_waitcnt lgkmcnt(15)
  v_mfma_f32_16x16x32_bf16 v[0:3], a[128:131], a[92:95], v[0:3]
  s_and_b32 s44, s66, 3
  v_mfma_f32_16x16x32_bf16 v[0:3], a[152:155], a[112:115], v[0:3]
  s_cmp_eq_u32 s44, s67
  s_cselect_b32 s44, 4, 0
  v_mfma_f32_16x16x32_bf16 v[4:7], a[152:155], a[116:119], v[4:7]
  s_add_u32 s44, s44, s66
  v_mfma_f32_16x16x32_bf16 v[4:7], a[128:131], a[96:99], v[4:7]
  s_and_b32 s44, s44, 15
  v_mfma_f32_16x16x32_bf16 v[8:11], a[128:131], a[100:103], v[8:11]
  s_add_u32 s66, s66, 1
  v_mfma_f32_16x16x32_bf16 v[8:11], a[152:155], a[120:123], v[8:11]
  s_mul_i32 s45, s44, s61
  v_mfma_f32_16x16x32_bf16 v[12:15], a[152:155], a[124:127], v[12:15]
  s_add_u32 s68, s45, s59
  v_mfma_f32_16x16x32_bf16 v[12:15], a[128:131], a[104:107], v[12:15]
  s_mul_i32 s45, s44, 393216
  v_mfma_f32_16x16x32_bf16 v[28:31], a[132:135], a[104:107], v[28:31]
  s_add_u32 s69, s45, s60
  v_mfma_f32_16x16x32_bf16 v[28:31], a[156:159], a[124:127], v[28:31]
  s_add_u32 s70, s69, 4096
  v_mfma_f32_16x16x32_bf16 v[24:27], a[156:159], a[120:123], v[24:27]
  v_mfma_f32_16x16x32_bf16 v[24:27], a[132:135], a[100:103], v[24:27]
  v_mfma_f32_16x16x32_bf16 v[20:23], a[132:135], a[96:99], v[20:23]
  s_waitcnt vmcnt(10) lgkmcnt(0)
  s_barrier
  ds_read_b64_tr_b16 a[40:41], v116 offset:24576
  v_mfma_f32_16x16x32_bf16 v[20:23], a[156:159], a[116:119], v[20:23]
  ds_read_b64_tr_b16 a[42:43], v116 offset:30720
  s_add_u32 m0, s62, 73728
  v_mfma_f32_16x16x32_bf16 v[16:19], a[156:159], a[112:115], v[16:19]
  ds_read_b64_tr_b16 a[64:65], v116 offset:36864
  buffer_load_dwordx4 v120, s[28:31], s68 offen offset:0 sc1 lds
  v_mfma_f32_16x16x32_bf16 v[16:19], a[132:135], a[92:95], v[16:19]
  ds_read_b64_tr_b16 a[66:67], v116 offset:43008
  v_mfma_f32_16x16x32_bf16 v[32:35], a[136:139], a[88:91], v[32:35]
  ds_read_b128 a[4:7], v112 offset:16384
  v_mfma_f32_16x16x32_bf16 v[32:35], a[160:163], a[108:111], v[32:35]
  ds_read_b128 a[24:27], v113 offset:16384
  v_mfma_f32_16x16x32_bf16 v[36:39], a[160:163], a[112:115], v[36:39]
  ds_read_b128 a[8:11], v112 offset:18432
  buffer_load_dwordx4 v121, s[28:31], s68 offen offset:1024 sc1 lds
  v_mfma_f32_16x16x32_bf16 v[36:39], a[136:139], a[92:95], v[36:39]
  ds_read_b128 a[28:31], v113 offset:18432
  v_mfma_f32_16x16x32_bf16 v[40:43], a[136:139], a[96:99], v[40:43]
  ds_read_b128 a[12:15], v112 offset:20480
  v_mfma_f32_16x16x32_bf16 v[40:43], a[160:163], a[116:119], v[40:43]
  ds_read_b128 a[32:35], v113 offset:20480
  v_mfma_f32_16x16x32_bf16 v[44:47], a[160:163], a[120:123], v[44:47]
  ds_read_b128 a[16:19], v112 offset:22528
  buffer_load_dwordx4 v122, s[28:31], s68 offen offset:2048 sc1 lds
  v_mfma_f32_16x16x32_bf16 v[44:47], a[136:139], a[100:103], v[44:47]
  ds_read_b128 a[36:39], v113 offset:22528
  v_mfma_f32_16x16x32_bf16 v[48:51], a[136:139], a[104:107], v[48:51]
  ds_read_b64_tr_b16 a[44:45], v117 offset:24576
  v_mfma_f32_16x16x32_bf16 v[48:51], a[160:163], a[124:127], v[48:51]
  ds_read_b64_tr_b16 a[46:47], v117 offset:30720
  v_mfma_f32_16x16x32_bf16 v[68:71], a[164:167], a[124:127], v[68:71]
  ds_read_b64_tr_b16 a[68:69], v117 offset:36864
  buffer_load_dwordx4 v123, s[28:31], s68 offen offset:3072 sc1 lds
  v_mfma_f32_16x16x32_bf16 v[68:71], a[140:143], a[104:107], v[68:71]
  ds_read_b64_tr_b16 a[70:71], v117 offset:43008
  v_mfma_f32_16x16x32_bf16 v[64:67], a[140:143], a[100:103], v[64:67]
  ds_read_b128 a[0:3], v114
  v_add_u32 v114, s64, v114
  v_mfma_f32_16x16x32_bf16 v[64:67], a[164:167], a[120:123], v[64:67]
  ds_read_b128 a[20:23], v115
  v_add_u32 v115, s64, v115
  s_add_u32 m0, s63, 0
  v_mfma_f32_16x16x32_bf16 v[60:63], a[164:167], a[116:119], v[60:63]
  ds_read_b64_tr_b16 a[48:49], v116 offset:26624
  buffer_load_dwordx4 v124, s[8:11], s69 offen offset:0 lds
  v_mfma_f32_16x16x32_bf16 v[60:63], a[140:143], a[96:99], v[60:63]
  ds_read_b64_tr_b16 a[50:51], v116 offset:32768
  v_mfma_f32_16x16x32_bf16 v[56:59], a[140:143], a[92:95], v[56:59]
  ds_read_b64_tr_b16 a[72:73], v116 offset:38912
  v_mfma_f32_16x16x32_bf16 v[56:59], a[164:167], a[112:115], v[56:59]
  ds_read_b64_tr_b16 a[74:75], v116 offset:45056
  v_mfma_f32_16x16x32_bf16 v[52:55], a[164:167], a[108:111], v[52:55]
  ds_read_b64_tr_b16 a[52:53], v117 offset:26624
  buffer_load_dwordx4 v125, s[8:11], s69 offen offset:1024 lds
  v_mfma_f32_16x16x32_bf16 v[52:55], a[140:143], a[88:91], v[52:55]
  ds_read_b64_tr_b16 a[54:55], v117 offset:32768
  v_mfma_f32_16x16x32_bf16 v[72:75], a[88:91], a[144:147], v[72:75]
  ds_read_b64_tr_b16 a[76:77], v117 offset:38912
  v_mfma_f32_16x16x32_bf16 v[72:75], a[108:111], a[168:171], v[72:75]
  ds_read_b64_tr_b16 a[78:79], v117 offset:45056
  v_mfma_f32_16x16x32_bf16 v[76:79], a[112:115], a[168:171], v[76:79]
  ds_read_b64_tr_b16 a[56:57], v116 offset:28672
  buffer_load_dwordx4 v124, s[8:11], s69 offen offset:2048 lds
  v_mfma_f32_16x16x32_bf16 v[76:79], a[92:95], a[144:147], v[76:79]
  ds_read_b64_tr_b16 a[58:59], v116 offset:34816
  v_mfma_f32_16x16x32_bf16 v[80:83], a[96:99], a[144:147], v[80:83]
  ds_read_b64_tr_b16 a[80:81], v116 offset:40960
  v_mfma_f32_16x16x32_bf16 v[80:83], a[116:119], a[168:171], v[80:83]
  ds_read_b64_tr_b16 a[82:83], v116 offset:47104
  v_mfma_f32_16x16x32_bf16 v[84:87], a[120:123], a[168:171], v[84:87]
  ds_read_b64_tr_b16 a[60:61], v117 offset:28672
  buffer_load_dwordx4 v125, s[8:11], s69 offen offset:3072 lds
  v_mfma_f32_16x16x32_bf16 v[84:87], a[100:103], a[144:147], v[84:87]
  ds_read_b64_tr_b16 a[62:63], v117 offset:34816
  v_mfma_f32_16x16x32_bf16 v[88:91], a[104:107], a[144:147], v[88:91]
  ds_read_b64_tr_b16 a[84:85], v117 offset:40960
  v_mfma_f32_16x16x32_bf16 v[88:91], a[124:127], a[168:171], v[88:91]
  ds_read_b64_tr_b16 a[86:87], v117 offset:47104
  s_add_u32 m0, s63, 4096
  v_mfma_f32_16x16x32_bf16 v[108:111], a[124:127], a[172:175], v[108:111]
  buffer_load_dwordx4 v124, s[8:11], s70 offen offset:0 lds
  v_mfma_f32_16x16x32_bf16 v[108:111], a[104:107], a[148:151], v[108:111]
  v_mfma_f32_16x16x32_bf16 v[104:107], a[100:103], a[148:151], v[104:107]
  v_mfma_f32_16x16x32_bf16 v[104:107], a[120:123], a[172:175], v[104:107]
  v_mfma_f32_16x16x32_bf16 v[100:103], a[116:119], a[172:175], v[100:103]
  buffer_load_dwordx4 v125, s[8:11], s70 offen offset:1024 lds
  v_mfma_f32_16x16x32_bf16 v[100:103], a[96:99], a[148:151], v[100:103]
  v_mfma_f32_16x16x32_bf16 v[96:99], a[92:95], a[148:151], v[96:99]
  v_mfma_f32_16x16x32_bf16 v[96:99], a[112:115], a[172:175], v[96:99]
  v_mfma_f32_16x16x32_bf16 v[92:95], a[108:111], a[172:175], v[92:95]
  v_mfma_f32_16x16x32_bf16 v[92:95], a[88:91], a[148:151], v[92:95]
  s_waitcnt lgkmcnt(15)
  v_mfma_f32_16x16x32_bf16 v[0:3], a[40:43], a[4:7], v[0:3]
  s_and_b32 s44, s66, 3
  v_mfma_f32_16x16x32_bf16 v[0:3], a[64:67], a[24:27], v[0:3]
  s_cmp_eq_u32 s44, s67
  s_cselect_b32 s44, 4, 0
  v_mfma_f32_16x16x32_bf16 v[4:7], a[64:67], a[28:31], v[4:7]
  s_add_u32 s44, s44, s66
  v_mfma_f32_16x16x32_bf16 v[4:7], a[40:43], a[8:11], v[4:7]
  s_and_b32 s44, s44, 15
  v_mfma_f32_16x16x32_bf16 v[8:11], a[40:43], a[12:15], v[8:11]
  s_add_u32 s66, s66, 1
  v_mfma_f32_16x16x32_bf16 v[8:11], a[64:67], a[32:35], v[8:11]
  s_mul_i32 s45, s44, s61
  v_mfma_f32_16x16x32_bf16 v[12:15], a[64:67], a[36:39], v[12:15]
  s_add_u32 s68, s45, s59
  v_mfma_f32_16x16x32_bf16 v[12:15], a[40:43], a[16:19], v[12:15]
  s_mul_i32 s45, s44, 393216
  v_mfma_f32_16x16x32_bf16 v[28:31], a[44:47], a[16:19], v[28:31]
  s_add_u32 s69, s45, s60
  v_mfma_f32_16x16x32_bf16 v[28:31], a[68:71], a[36:39], v[28:31]
  s_add_u32 s70, s69, 4096
  v_mfma_f32_16x16x32_bf16 v[24:27], a[68:71], a[32:35], v[24:27]
  v_mfma_f32_16x16x32_bf16 v[24:27], a[44:47], a[12:15], v[24:27]
  v_mfma_f32_16x16x32_bf16 v[20:23], a[44:47], a[8:11], v[20:23]
  s_waitcnt vmcnt(10) lgkmcnt(0)
  s_barrier
  ds_read_b64_tr_b16 a[128:129], v118 offset:0
  v_mfma_f32_16x16x32_bf16 v[20:23], a[68:71], a[28:31], v[20:23]
  ds_read_b64_tr_b16 a[130:131], v118 offset:6144
  s_add_u32 m0, s62, 90112
  v_mfma_f32_16x16x32_bf16 v[16:19], a[68:71], a[24:27], v[16:19]
  ds_read_b64_tr_b16 a[152:153], v118 offset:12288
  buffer_load_dwordx4 v120, s[28:31], s68 offen offset:0 sc1 lds
  v_mfma_f32_16x16x32_bf16 v[16:19], a[44:47], a[4:7], v[16:19]
  ds_read_b64_tr_b16 a[154:155], v118 offset:18432
  v_mfma_f32_16x16x32_bf16 v[32:35], a[48:51], a[0:3], v[32:35]
  ds_read_b128 a[92:95], v112 offset:32768
  v_mfma_f32_16x16x32_bf16 v[32:35], a[72:75], a[20:23], v[32:35]
  ds_read_b128 a[112:115], v113 offset:32768
  v_mfma_f32_16x16x32_bf16 v[36:39], a[72:75], a[24:27], v[36:39]
  ds_read_b128 a[96:99], v112 offset:34816
  buffer_load_dwordx4 v121, s[28:31], s68 offen offset:1024 sc1 lds
  v_mfma_f32_16x16x32_bf16 v[36:39], a[48:51], a[4:7], v[36:39]
  ds_read_b128 a[116:119], v113 offset:34816
  v_mfma_f32_16x16x32_bf16 v[40:43], a[48:51], a[8:11], v[40:43]
  ds_read_b128 a[100:103], v112 offset:36864
  v_mfma_f32_16x16x32_bf16 v[40:43], a[72:75], a[28:31], v[40:43]
  ds_read_b128 a[120:123], v113 offset:36864
  v_mfma_f32_16x16x32_bf16 v[44:47], a[72:75], a[32:35], v[44:47]
  ds_read_b128 a[104:107], v112 offset:38912
  buffer_load_dwordx4 v122, s[28:31], s68 offen offset:2048 sc1 lds
  v_mfma_f32_16x16x32_bf16 v[44:47], a[48:51], a[12:15], v[44:47]
  ds_read_b128 a[124:127], v113 offset:38912
  v_mfma_f32_16x16x32_bf16 v[48:51], a[48:51], a[16:19], v[48:51]
  ds_read_b64_tr_b16 a[132:133], v119 offset:0
  v_mfma_f32_16x16x32_bf16 v[48:51], a[72:75], a[36:39], v[48:51]
  ds_read_b64_tr_b16 a[134:135], v119 offset:6144
  v_mfma_f32_16x16x32_bf16 v[68:71], a[76:79], a[36:39], v[68:71]
  ds_read_b64_tr_b16 a[156:157], v119 offset:12288
  buffer_load_dwordx4 v123, s[28:31], s68 offen offset:3072 sc1 lds
  v_mfma_f32_16x16x32_bf16 v[68:71], a[52:55], a[16:19], v[68:71]
  ds_read_b64_tr_b16 a[158:159], v119 offset:18432
  v_mfma_f32_16x16x32_bf16 v[64:67], a[52:55], a[12:15], v[64:67]
  ds_read_b128 a[88:91], v114
  v_add_u32 v114, s65, v114
  v_mfma_f32_16x16x32_bf16 v[64:67], a[76:79], a[32:35], v[64:67]
  ds_read_b128 a[108:111], v115
  v_add_u32 v115, s65, v115
  s_add_u32 m0, s63, 24576
  v_mfma_f32_16x16x32_bf16 v[60:63], a[76:79], a[28:31], v[60:63]
  ds_read_b64_tr_b16 a[136:137], v118 offset:2048
  buffer_load_dwordx4 v124, s[8:11], s69 offen offset:0 lds
  v_mfma_f32_16x16x32_bf16 v[60:63], a[52:55], a[8:11], v[60:63]
  ds_read_b64_tr_b16 a[138:139], v118 offset:8192
  v_mfma_f32_16x16x32_bf16 v[56:59], a[52:55], a[4:7], v[56:59]
  ds_read_b64_tr_b16 a[160:161], v118 offset:14336
  v_mfma_f32_16x16x32_bf16 v[56:59], a[76:79], a[24:27], v[56:59]
  ds_read_b64_tr_b16 a[162:163], v118 offset:20480
  v_mfma_f32_16x16x32_bf16 v[52:55], a[76:79], a[20:23], v[52:55]
  ds_read_b64_tr_b16 a[140:141], v119 offset:2048
  buffer_load_dwordx4 v125, s[8:11], s69 offen offset:1024 lds
  v_mfma_f32_16x16x32_bf16 v[52:55], a[52:55], a[0:3], v[52:55]
  ds_read_b64_tr_b16 a[142:143], v119 offset:8192
  v_mfma_f32_16x16x32_bf16 v[72:75], a[0:3], a[56:59], v[72:75]
  ds_read_b64_tr_b16 a[164:165], v119 offset:14336
  v_mfma_f32_16x16x32_bf16 v[72:75], a[20:23], a[80:83], v[72:75]
  ds_read_b64_tr_b16 a[166:167], v119 offset:20480
  v_mfma_f32_16x16x32_bf16 v[76:79], a[24:27], a[80:83], v[76:79]
  ds_read_b64_tr_b16 a[144:145], v118 offset:4096
  buffer_load_dwordx4 v124, s[8:11], s69 offen offset:2048 lds
  v_mfma_f32_16x16x32_bf16 v[76:79], a[4:7], a[56:59], v[76:79]
  ds_read_b64_tr_b16 a[146:147], v118 offset:10240
  v_mfma_f32_16x16x32_bf16 v[80:83], a[8:11], a[56:59], v[80:83]
  ds_read_b64_tr_b16 a[168:169], v118 offset:16384
  v_mfma_f32_16x16x32_bf16 v[80:83], a[28:31], a[80:83], v[80:83]
  ds_read_b64_tr_b16 a[170:171], v118 offset:22528
  v_mfma_f32_16x16x32_bf16 v[84:87], a[32:35], a[80:83], v[84:87]
  ds_read_b64_tr_b16 a[148:149], v119 offset:4096
  buffer_load_dwordx4 v125, s[8:11], s69 offen offset:3072 lds
  v_mfma_f32_16x16x32_bf16 v[84:87], a[12:15], a[56:59], v[84:87]
  ds_read_b64_tr_b16 a[150:151], v119 offset:10240
  v_mfma_f32_16x16x32_bf16 v[88:91], a[16:19], a[56:59], v[88:91]
  ds_read_b64_tr_b16 a[172:173], v119 offset:16384
  v_mfma_f32_16x16x32_bf16 v[88:91], a[36:39], a[80:83], v[88:91]
  ds_read_b64_tr_b16 a[174:175], v119 offset:22528
  s_add_u32 m0, s63, 28672
  v_mfma_f32_16x16x32_bf16 v[108:111], a[36:39], a[84:87], v[108:111]
  buffer_load_dwordx4 v124, s[8:11], s70 offen offset:0 lds
  v_mfma_f32_16x16x32_bf16 v[108:111], a[16:19], a[60:63], v[108:111]
  v_mfma_f32_16x16x32_bf16 v[104:107], a[12:15], a[60:63], v[104:107]
  v_mfma_f32_16x16x32_bf16 v[104:107], a[32:35], a[84:87], v[104:107]
  v_mfma_f32_16x16x32_bf16 v[100:103], a[28:31], a[84:87], v[100:103]
  buffer_load_dwordx4 v125, s[8:11], s70 offen offset:1024 lds
  v_mfma_f32_16x16x32_bf16 v[100:103], a[8:11], a[60:63], v[100:103]
  v_mfma_f32_16x16x32_bf16 v[96:99], a[4:7], a[60:63], v[96:99]
  v_mfma_f32_16x16x32_bf16 v[96:99], a[24:27], a[84:87], v[96:99]
  v_mfma_f32_16x16x32_bf16 v[92:95], a[20:23], a[84:87], v[92:95]
  v_mfma_f32_16x16x32_bf16 v[92:95], a[0:3], a[60:63], v[92:95]
  s_waitcnt lgkmcnt(15)
  v_mfma_f32_16x16x32_bf16 v[0:3], a[128:131], a[92:95], v[0:3]
  s_and_b32 s44, s66, 3
  v_mfma_f32_16x16x32_bf16 v[0:3], a[152:155], a[112:115], v[0:3]
  s_cmp_eq_u32 s44, s67
  s_cselect_b32 s44, 4, 0
  v_mfma_f32_16x16x32_bf16 v[4:7], a[152:155], a[116:119], v[4:7]
  s_add_u32 s44, s44, s66
  v_mfma_f32_16x16x32_bf16 v[4:7], a[128:131], a[96:99], v[4:7]
  s_and_b32 s44, s44, 15
  v_mfma_f32_16x16x32_bf16 v[8:11], a[128:131], a[100:103], v[8:11]
  s_add_u32 s66, s66, 1
  v_mfma_f32_16x16x32_bf16 v[8:11], a[152:155], a[120:123], v[8:11]
  s_mul_i32 s45, s44, s61
  v_mfma_f32_16x16x32_bf16 v[12:15], a[152:155], a[124:127], v[12:15]
  s_add_u32 s68, s45, s59
  v_mfma_f32_16x16x32_bf16 v[12:15], a[128:131], a[104:107], v[12:15]
  s_mul_i32 s45, s44, 393216
  v_mfma_f32_16x16x32_bf16 v[28:31], a[132:135], a[104:107], v[28:31]
  s_add_u32 s69, s45, s60
  v_mfma_f32_16x16x32_bf16 v[28:31], a[156:159], a[124:127], v[28:31]
  s_add_u32 s70, s69, 4096
  v_mfma_f32_16x16x32_bf16 v[24:27], a[156:159], a[120:123], v[24:27]
  v_mfma_f32_16x16x32_bf16 v[24:27], a[132:135], a[100:103], v[24:27]
  v_mfma_f32_16x16x32_bf16 v[20:23], a[132:135], a[96:99], v[20:23]
  s_waitcnt vmcnt(10) lgkmcnt(0)
  s_barrier
  ds_read_b64_tr_b16 a[40:41], v116 offset:0
  v_mfma_f32_16x16x32_bf16 v[20:23], a[156:159], a[116:119], v[20:23]
  ds_read_b64_tr_b16 a[42:43], v116 offset:6144
  s_add_u32 m0, s62, 106496
  v_mfma_f32_16x16x32_bf16 v[16:19], a[156:159], a[112:115], v[16:19]
  ds_read_b64_tr_b16 a[64:65], v116 offset:12288
  buffer_load_dwordx4 v120, s[28:31], s68 offen offset:0 sc1 lds
  v_mfma_f32_16x16x32_bf16 v[16:19], a[132:135], a[92:95], v[16:19]
  ds_read_b64_tr_b16 a[66:67], v116 offset:18432
  v_mfma_f32_16x16x32_bf16 v[32:35], a[136:139], a[88:91], v[32:35]
  ds_read_b128 a[4:7], v112 offset:0
  v_mfma_f32_16x16x32_bf16 v[32:35], a[160:163], a[108:111], v[32:35]
  ds_read_b128 a[24:27], v113 offset:0
  v_mfma_f32_16x16x32_bf16 v[36:39], a[160:163], a[112:115], v[36:39]
  ds_read_b128 a[8:11], v112 offset:2048
  buffer_load_dwordx4 v121, s[28:31], s68 offen offset:1024 sc1 lds
  v_mfma_f32_16x16x32_bf16 v[36:39], a[136:139], a[92:95], v[36:39]
  ds_read_b128 a[28:31], v113 offset:2048
  v_mfma_f32_16x16x32_bf16 v[40:43], a[136:139], a[96:99], v[40:43]
  ds_read_b128 a[12:15], v112 offset:4096
  v_mfma_f32_16x16x32_bf16 v[40:43], a[160:163], a[116:119], v[40:43]
  ds_read_b128 a[32:35], v113 offset:4096
  v_mfma_f32_16x16x32_bf16 v[44:47], a[160:163], a[120:123], v[44:47]
  ds_read_b128 a[16:19], v112 offset:6144
  buffer_load_dwordx4 v122, s[28:31], s68 offen offset:2048 sc1 lds
  v_mfma_f32_16x16x32_bf16 v[44:47], a[136:139], a[100:103], v[44:47]
  ds_read_b128 a[36:39], v113 offset:6144
  v_mfma_f32_16x16x32_bf16 v[48:51], a[136:139], a[104:107], v[48:51]
  ds_read_b64_tr_b16 a[44:45], v117 offset:0
  v_mfma_f32_16x16x32_bf16 v[48:51], a[160:163], a[124:127], v[48:51]
  ds_read_b64_tr_b16 a[46:47], v117 offset:6144
  v_mfma_f32_16x16x32_bf16 v[68:71], a[164:167], a[124:127], v[68:71]
  ds_read_b64_tr_b16 a[68:69], v117 offset:12288
  buffer_load_dwordx4 v123, s[28:31], s68 offen offset:3072 sc1 lds
  v_mfma_f32_16x16x32_bf16 v[68:71], a[140:143], a[104:107], v[68:71]
  ds_read_b64_tr_b16 a[70:71], v117 offset:18432
  v_mfma_f32_16x16x32_bf16 v[64:67], a[140:143], a[100:103], v[64:67]
  ds_read_b128 a[0:3], v114
  v_add_u32 v114, s64, v114
  v_mfma_f32_16x16x32_bf16 v[64:67], a[164:167], a[120:123], v[64:67]
  ds_read_b128 a[20:23], v115
  v_add_u32 v115, s64, v115
  s_add_u32 m0, s63, 49152
  v_mfma_f32_16x16x32_bf16 v[60:63], a[164:167], a[116:119], v[60:63]
  ds_read_b64_tr_b16 a[48:49], v116 offset:2048
  buffer_load_dwordx4 v124, s[8:11], s69 offen offset:0 lds
  v_mfma_f32_16x16x32_bf16 v[60:63], a[140:143], a[96:99], v[60:63]
  ds_read_b64_tr_b16 a[50:51], v116 offset:8192
  v_mfma_f32_16x16x32_bf16 v[56:59], a[140:143], a[92:95], v[56:59]
  ds_read_b64_tr_b16 a[72:73], v116 offset:14336
  v_mfma_f32_16x16x32_bf16 v[56:59], a[164:167], a[112:115], v[56:59]
  ds_read_b64_tr_b16 a[74:75], v116 offset:20480
  v_mfma_f32_16x16x32_bf16 v[52:55], a[164:167], a[108:111], v[52:55]
  ds_read_b64_tr_b16 a[52:53], v117 offset:2048
  buffer_load_dwordx4 v125, s[8:11], s69 offen offset:1024 lds
  v_mfma_f32_16x16x32_bf16 v[52:55], a[140:143], a[88:91], v[52:55]
  ds_read_b64_tr_b16 a[54:55], v117 offset:8192
  v_mfma_f32_16x16x32_bf16 v[72:75], a[88:91], a[144:147], v[72:75]
  ds_read_b64_tr_b16 a[76:77], v117 offset:14336
  v_mfma_f32_16x16x32_bf16 v[72:75], a[108:111], a[168:171], v[72:75]
  ds_read_b64_tr_b16 a[78:79], v117 offset:20480
  v_mfma_f32_16x16x32_bf16 v[76:79], a[112:115], a[168:171], v[76:79]
  ds_read_b64_tr_b16 a[56:57], v116 offset:4096
  buffer_load_dwordx4 v124, s[8:11], s69 offen offset:2048 lds
  v_mfma_f32_16x16x32_bf16 v[76:79], a[92:95], a[144:147], v[76:79]
  ds_read_b64_tr_b16 a[58:59], v116 offset:10240
  v_mfma_f32_16x16x32_bf16 v[80:83], a[96:99], a[144:147], v[80:83]
  ds_read_b64_tr_b16 a[80:81], v116 offset:16384
  v_mfma_f32_16x16x32_bf16 v[80:83], a[116:119], a[168:171], v[80:83]
  ds_read_b64_tr_b16 a[82:83], v116 offset:22528
  v_mfma_f32_16x16x32_bf16 v[84:87], a[120:123], a[168:171], v[84:87]
  ds_read_b64_tr_b16 a[60:61], v117 offset:4096
  buffer_load_dwordx4 v125, s[8:11], s69 offen offset:3072 lds
  v_mfma_f32_16x16x32_bf16 v[84:87], a[100:103], a[144:147], v[84:87]
  ds_read_b64_tr_b16 a[62:63], v117 offset:10240
  v_mfma_f32_16x16x32_bf16 v[88:91], a[104:107], a[144:147], v[88:91]
  ds_read_b64_tr_b16 a[84:85], v117 offset:16384
  v_mfma_f32_16x16x32_bf16 v[88:91], a[124:127], a[168:171], v[88:91]
  ds_read_b64_tr_b16 a[86:87], v117 offset:22528
  s_add_u32 m0, s63, 53248
  v_mfma_f32_16x16x32_bf16 v[108:111], a[124:127], a[172:175], v[108:111]
  buffer_load_dwordx4 v124, s[8:11], s70 offen offset:0 lds
  v_mfma_f32_16x16x32_bf16 v[108:111], a[104:107], a[148:151], v[108:111]
  v_mfma_f32_16x16x32_bf16 v[104:107], a[100:103], a[148:151], v[104:107]
  v_mfma_f32_16x16x32_bf16 v[104:107], a[120:123], a[172:175], v[104:107]
  v_mfma_f32_16x16x32_bf16 v[100:103], a[116:119], a[172:175], v[100:103]
  buffer_load_dwordx4 v125, s[8:11], s70 offen offset:1024 lds
  v_mfma_f32_16x16x32_bf16 v[100:103], a[96:99], a[148:151], v[100:103]
  v_mfma_f32_16x16x32_bf16 v[96:99], a[92:95], a[148:151], v[96:99]
  v_mfma_f32_16x16x32_bf16 v[96:99], a[112:115], a[172:175], v[96:99]
  v_mfma_f32_16x16x32_bf16 v[92:95], a[108:111], a[172:175], v[92:95]
  v_mfma_f32_16x16x32_bf16 v[92:95], a[88:91], a[148:151], v[92:95]
  s_sub_u32 s56, s56, 1
  s_cmp_lg_u32 s56, 0
  s_cbranch_scc1 Lp1_loop
  s_waitcnt lgkmcnt(15)
  v_mfma_f32_16x16x32_bf16 v[0:3], a[40:43], a[4:7], v[0:3]
  s_and_b32 s44, s66, 3
  v_mfma_f32_16x16x32_bf16 v[0:3], a[64:67], a[24:27], v[0:3]
  s_cmp_eq_u32 s44, s67
  s_cselect_b32 s44, 4, 0
  v_mfma_f32_16x16x32_bf16 v[4:7], a[64:67], a[28:31], v[4:7]
  s_add_u32 s44, s44, s66
  v_mfma_f32_16x16x32_bf16 v[4:7], a[40:43], a[8:11], v[4:7]
  s_and_b32 s44, s44, 15
  v_mfma_f32_16x16x32_bf16 v[8:11], a[40:43], a[12:15], v[8:11]
  s_add_u32 s66, s66, 1
  v_mfma_f32_16x16x32_bf16 v[8:11], a[64:67], a[32:35], v[8:11]
  s_mul_i32 s45, s44, s61
  v_mfma_f32_16x16x32_bf16 v[12:15], a[64:67], a[36:39], v[12:15]
  s_add_u32 s68, s45, s59
  v_mfma_f32_16x16x32_bf16 v[12:15], a[40:43], a[16:19], v[12:15]
  s_mul_i32 s45, s44, 393216
  v_mfma_f32_16x16x32_bf16 v[28:31], a[44:47], a[16:19], v[28:31]
  s_add_u32 s69, s45, s60
  v_mfma_f32_16x16x32_bf16 v[28:31], a[68:71], a[36:39], v[28:31]
  s_add_u32 s70, s69, 4096
  v_mfma_f32_16x16x32_bf16 v[24:27], a[68:71], a[32:35], v[24:27]
  v_mfma_f32_16x16x32_bf16 v[24:27], a[44:47], a[12:15], v[24:27]
  v_mfma_f32_16x16x32_bf16 v[20:23], a[44:47], a[8:11], v[20:23]
  s_waitcnt vmcnt(10) lgkmcnt(0)
  s_barrier
  ds_read_b64_tr_b16 a[128:129], v116 offset:24576
  v_mfma_f32_16x16x32_bf16 v[20:23], a[68:71], a[28:31], v[20:23]
  ds_read_b64_tr_b16 a[130:131], v116 offset:30720
  s_add_u32 m0, s62, 73728
  v_mfma_f32_16x16x32_bf16 v[16:19], a[68:71], a[24:27], v[16:19]
  ds_read_b64_tr_b16 a[152:153], v116 offset:36864
  buffer_load_dwordx4 v120, s[28:31], s68 offen offset:0 sc1 lds
  v_mfma_f32_16x16x32_bf16 v[16:19], a[44:47], a[4:7], v[16:19]
  ds_read_b64_tr_b16 a[154:155], v116 offset:43008
  v_mfma_f32_16x16x32_bf16 v[32:35], a[48:51], a[0:3], v[32:35]
  ds_read_b128 a[92:95], v112 offset:16384
  v_mfma_f32_16x16x32_bf16 v[32:35], a[72:75], a[20:23], v[32:35]
  ds_read_b128 a[112:115], v113 offset:16384
  v_mfma_f32_16x16x32_bf16 v[36:39], a[72:75], a[24:27], v[36:39]
  ds_read_b128 a[96:99], v112 offset:18432
  buffer_load_dwordx4 v121, s[28:31], s68 offen offset:1024 sc1 lds
  v_mfma_f32_16x16x32_bf16 v[36:39], a[48:51], a[4:7], v[36:39]
  ds_read_b128 a[116:119], v113 offset:18432
  v_mfma_f32_16x16x32_bf16 v[40:43], a[48:51], a[8:11], v[40:43]
  ds_read_b128 a[100:103], v112 offset:20480
  v_mfma_f32_16x16x32_bf16 v[40:43], a[72:75], a[28:31], v[40:43]
  ds_read_b128 a[120:123], v113 offset:20480
  v_mfma_f32_16x16x32_bf16 v[44:47], a[72:75], a[32:35], v[44:47]
  ds_read_b128 a[104:107], v112 offset:22528
  buffer_load_dwordx4 v122, s[28:31], s68 offen offset:2048 sc1 lds
  v_mfma_f32_16x16x32_bf16 v[44:47], a[48:51], a[12:15], v[44:47]
  ds_read_b128 a[124:127], v113 offset:22528
  v_mfma_f32_16x16x32_bf16 v[48:51], a[48:51], a[16:19], v[48:51]
  ds_read_b64_tr_b16 a[132:133], v117 offset:24576
  v_mfma_f32_16x16x32_bf16 v[48:51], a[72:75], a[36:39], v[48:51]
  ds_read_b64_tr_b16 a[134:135], v117 offset:30720
  v_mfma_f32_16x16x32_bf16 v[68:71], a[76:79], a[36:39], v[68:71]
  ds_read_b64_tr_b16 a[156:157], v117 offset:36864
  buffer_load_dwordx4 v123, s[28:31], s68 offen offset:3072 sc1 lds
  v_mfma_f32_16x16x32_bf16 v[68:71], a[52:55], a[16:19], v[68:71]
  ds_read_b64_tr_b16 a[158:159], v117 offset:43008
  v_mfma_f32_16x16x32_bf16 v[64:67], a[52:55], a[12:15], v[64:67]
  ds_read_b128 a[88:91], v114
  v_add_u32 v114, s64, v114
  v_mfma_f32_16x16x32_bf16 v[64:67], a[76:79], a[32:35], v[64:67]
  ds_read_b128 a[108:111], v115
  v_add_u32 v115, s64, v115
  s_add_u32 m0, s63, 0
  v_mfma_f32_16x16x32_bf16 v[60:63], a[76:79], a[28:31], v[60:63]
  ds_read_b64_tr_b16 a[136:137], v116 offset:26624
  buffer_load_dwordx4 v124, s[8:11], s69 offen offset:0 lds
  v_mfma_f32_16x16x32_bf16 v[60:63], a[52:55], a[8:11], v[60:63]
  ds_read_b64_tr_b16 a[138:139], v116 offset:32768
  v_mfma_f32_16x16x32_bf16 v[56:59], a[52:55], a[4:7], v[56:59]
  ds_read_b64_tr_b16 a[160:161], v116 offset:38912
  v_mfma_f32_16x16x32_bf16 v[56:59], a[76:79], a[24:27], v[56:59]
  ds_read_b64_tr_b16 a[162:163], v116 offset:45056
  v_mfma_f32_16x16x32_bf16 v[52:55], a[76:79], a[20:23], v[52:55]
  ds_read_b64_tr_b16 a[140:141], v117 offset:26624
  buffer_load_dwordx4 v125, s[8:11], s69 offen offset:1024 lds
  v_mfma_f32_16x16x32_bf16 v[52:55], a[52:55], a[0:3], v[52:55]
  ds_read_b64_tr_b16 a[142:143], v117 offset:32768
  v_mfma_f32_16x16x32_bf16 v[72:75], a[0:3], a[56:59], v[72:75]
  ds_read_b64_tr_b16 a[164:165], v117 offset:38912
  v_mfma_f32_16x16x32_bf16 v[72:75], a[20:23], a[80:83], v[72:75]
  ds_read_b64_tr_b16 a[166:167], v117 offset:45056
  v_mfma_f32_16x16x32_bf16 v[76:79], a[24:27], a[80:83], v[76:79]
  ds_read_b64_tr_b16 a[144:145], v116 offset:28672
  buffer_load_dwordx4 v124, s[8:11], s69 offen offset:2048 lds
  v_mfma_f32_16x16x32_bf16 v[76:79], a[4:7], a[56:59], v[76:79]
  ds_read_b64_tr_b16 a[146:147], v116 offset:34816
  v_mfma_f32_16x16x32_bf16 v[80:83], a[8:11], a[56:59], v[80:83]
  ds_read_b64_tr_b16 a[168:169], v116 offset:40960
  v_mfma_f32_16x16x32_bf16 v[80:83], a[28:31], a[80:83], v[80:83]
  ds_read_b64_tr_b16 a[170:171], v116 offset:47104
  v_mfma_f32_16x16x32_bf16 v[84:87], a[32:35], a[80:83], v[84:87]
  ds_read_b64_tr_b16 a[148:149], v117 offset:28672
  buffer_load_dwordx4 v125, s[8:11], s69 offen offset:3072 lds
  v_mfma_f32_16x16x32_bf16 v[84:87], a[12:15], a[56:59], v[84:87]
  ds_read_b64_tr_b16 a[150:151], v117 offset:34816
  v_mfma_f32_16x16x32_bf16 v[88:91], a[16:19], a[56:59], v[88:91]
  ds_read_b64_tr_b16 a[172:173], v117 offset:40960
  v_mfma_f32_16x16x32_bf16 v[88:91], a[36:39], a[80:83], v[88:91]
  ds_read_b64_tr_b16 a[174:175], v117 offset:47104
  s_add_u32 m0, s63, 4096
  v_mfma_f32_16x16x32_bf16 v[108:111], a[36:39], a[84:87], v[108:111]
  buffer_load_dwordx4 v124, s[8:11], s70 offen offset:0 lds
  v_mfma_f32_16x16x32_bf16 v[108:111], a[16:19], a[60:63], v[108:111]
  v_mfma_f32_16x16x32_bf16 v[104:107], a[12:15], a[60:63], v[104:107]
  v_mfma_f32_16x16x32_bf16 v[104:107], a[32:35], a[84:87], v[104:107]
  v_mfma_f32_16x16x32_bf16 v[100:103], a[28:31], a[84:87], v[100:103]
  buffer_load_dwordx4 v125, s[8:11], s70 offen offset:1024 lds
  v_mfma_f32_16x16x32_bf16 v[100:103], a[8:11], a[60:63], v[100:103]
  v_mfma_f32_16x16x32_bf16 v[96:99], a[4:7], a[60:63], v[96:99]
  v_mfma_f32_16x16x32_bf16 v[96:99], a[24:27], a[84:87], v[96:99]
  v_mfma_f32_16x16x32_bf16 v[92:95], a[20:23], a[84:87], v[92:95]
  buffer_load_dword v127, v251, s[36:39], 0 offen sc1
  v_mfma_f32_16x16x32_bf16 v[92:95], a[0:3], a[60:63], v[92:95]
  s_waitcnt lgkmcnt(15)
  v_mfma_f32_16x16x32_bf16 v[0:3], a[128:131], a[92:95], v[0:3]
  s_lshl_b32 s43, s57, 2
  v_mfma_f32_16x16x32_bf16 v[0:3], a[152:155], a[112:115], v[0:3]
  s_add_u32 s74, s71, s43
  v_mfma_f32_16x16x32_bf16 v[4:7], a[152:155], a[116:119], v[4:7]
  s_sub_u32 s44, s74, 1
  v_mfma_f32_16x16x32_bf16 v[4:7], a[128:131], a[96:99], v[4:7]
  s_cmp_eq_u32 s57, 0
  s_cselect_b32 s44, s72, s44
  v_mfma_f32_16x16x32_bf16 v[8:11], a[128:131], a[100:103], v[8:11]
  s_add_u32 s45, s42, 27262976
  v_mfma_f32_16x16x32_bf16 v[8:11], a[152:155], a[120:123], v[8:11]
  s_lshl_b32 s44, s44, 11
  v_mfma_f32_16x16x32_bf16 v[12:15], a[152:155], a[124:127], v[12:15]
  s_add_u32 s77, s44, s45
  v_mfma_f32_16x16x32_bf16 v[12:15], a[128:131], a[104:107], v[12:15]
  s_lshl_b32 s44, s74, 11
  v_mfma_f32_16x16x32_bf16 v[28:31], a[132:135], a[104:107], v[28:31]
  s_add_u32 s78, s44, s45
  v_mfma_f32_16x16x32_bf16 v[28:31], a[156:159], a[124:127], v[28:31]
  s_add_u32 s79, s78, 4096
  v_mfma_f32_16x16x32_bf16 v[24:27], a[156:159], a[120:123], v[24:27]
  v_lshlrev_b32 v121, 3, v253
  v_mfma_f32_16x16x32_bf16 v[24:27], a[132:135], a[100:103], v[24:27]
  s_lshl_b32 s43, s51, 1
  v_mfma_f32_16x16x32_bf16 v[20:23], a[132:135], a[96:99], v[20:23]
  s_waitcnt vmcnt(11) lgkmcnt(0)
  s_barrier
  ds_read_b64_tr_b16 a[40:41], v118 offset:0
  s_add_u32 s75, s43, s58
  v_mfma_f32_16x16x32_bf16 v[20:23], a[156:159], a[116:119], v[20:23]
  ds_read_b64_tr_b16 a[42:43], v118 offset:6144
  s_lshl_b32 s43, s75, 7
  v_mfma_f32_16x16x32_bf16 v[16:19], a[156:159], a[112:115], v[16:19]
  ds_read_b64_tr_b16 a[64:65], v118 offset:12288
  s_add_u32 s46, s43, 27852800
  v_mfma_f32_16x16x32_bf16 v[16:19], a[132:135], a[92:95], v[16:19]
  ds_read_b64_tr_b16 a[66:67], v118 offset:18432
  v_lshrrev_b32 v122, 3, v253
  v_mfma_f32_16x16x32_bf16 v[32:35], a[136:139], a[88:91], v[32:35]
  ds_read_b128 a[4:7], v112 offset:32768
  v_and_b32 v123, 7, v253
  v_mfma_f32_16x16x32_bf16 v[32:35], a[160:163], a[108:111], v[32:35]
  ds_read_b128 a[24:27], v113 offset:32768
  v_lshlrev_b32 v122, 12, v122
  v_mfma_f32_16x16x32_bf16 v[36:39], a[160:163], a[112:115], v[36:39]
  ds_read_b128 a[8:11], v112 offset:34816
  v_lshl_add_u32 v122, v123, 4, v122
  v_mfma_f32_16x16x32_bf16 v[36:39], a[136:139], a[92:95], v[36:39]
  ds_read_b128 a[28:31], v113 offset:34816
  s_add_u32 s47, s46, 31744
  v_mfma_f32_16x16x32_bf16 v[40:43], a[136:139], a[96:99], v[40:43]
  ds_read_b128 a[12:15], v112 offset:36864
  v_mfma_f32_16x16x32_bf16 v[40:43], a[160:163], a[116:119], v[40:43]
  ds_read_b128 a[32:35], v113 offset:36864
  v_mfma_f32_16x16x32_bf16 v[44:47], a[160:163], a[120:123], v[44:47]
  ds_read_b128 a[16:19], v112 offset:38912
  v_mfma_f32_16x16x32_bf16 v[44:47], a[136:139], a[100:103], v[44:47]
  ds_read_b128 a[36:39], v113 offset:38912
  v_mfma_f32_16x16x32_bf16 v[48:51], a[136:139], a[104:107], v[48:51]
  ds_read_b64_tr_b16 a[44:45], v119 offset:0
  v_mfma_f32_16x16x32_bf16 v[48:51], a[160:163], a[124:127], v[48:51]
  ds_read_b64_tr_b16 a[46:47], v119 offset:6144
  v_mfma_f32_16x16x32_bf16 v[68:71], a[164:167], a[124:127], v[68:71]
  ds_read_b64_tr_b16 a[68:69], v119 offset:12288
  v_mfma_f32_16x16x32_bf16 v[68:71], a[140:143], a[104:107], v[68:71]
  ds_read_b64_tr_b16 a[70:71], v119 offset:18432
  v_mfma_f32_16x16x32_bf16 v[64:67], a[140:143], a[100:103], v[64:67]
  ds_read_b128 a[0:3], v114
  v_add_u32 v114, s65, v114
  v_mfma_f32_16x16x32_bf16 v[64:67], a[164:167], a[120:123], v[64:67]
  ds_read_b128 a[20:23], v115
  v_add_u32 v115, s65, v115
  v_mfma_f32_16x16x32_bf16 v[60:63], a[164:167], a[116:119], v[60:63]
  ds_read_b64_tr_b16 a[48:49], v118 offset:2048
  v_mfma_f32_16x16x32_bf16 v[60:63], a[140:143], a[96:99], v[60:63]
  ds_read_b64_tr_b16 a[50:51], v118 offset:8192
  v_mfma_f32_16x16x32_bf16 v[56:59], a[140:143], a[92:95], v[56:59]
  ds_read_b64_tr_b16 a[72:73], v118 offset:14336
  v_mfma_f32_16x16x32_bf16 v[56:59], a[164:167], a[112:115], v[56:59]
  ds_read_b64_tr_b16 a[74:75], v118 offset:20480
  v_mfma_f32_16x16x32_bf16 v[52:55], a[164:167], a[108:111], v[52:55]
  ds_read_b64_tr_b16 a[52:53], v119 offset:2048
  v_mfma_f32_16x16x32_bf16 v[52:55], a[140:143], a[88:91], v[52:55]
  ds_read_b64_tr_b16 a[54:55], v119 offset:8192
  v_mfma_f32_16x16x32_bf16 v[72:75], a[88:91], a[144:147], v[72:75]
  ds_read_b64_tr_b16 a[76:77], v119 offset:14336
  v_mfma_f32_16x16x32_bf16 v[72:75], a[108:111], a[168:171], v[72:75]
  ds_read_b64_tr_b16 a[78:79], v119 offset:20480
  v_mfma_f32_16x16x32_bf16 v[76:79], a[112:115], a[168:171], v[76:79]
  ds_read_b64_tr_b16 a[56:57], v118 offset:4096
  v_mfma_f32_16x16x32_bf16 v[76:79], a[92:95], a[144:147], v[76:79]
  ds_read_b64_tr_b16 a[58:59], v118 offset:10240
  v_mfma_f32_16x16x32_bf16 v[80:83], a[96:99], a[144:147], v[80:83]
  ds_read_b64_tr_b16 a[80:81], v118 offset:16384
  s_waitcnt vmcnt(0)
  v_cmp_gt_u32 vcc, 256, v127
  s_cbranch_vccz Lcdn6
  s_mov_b32 s43, 0x40000
Lchk5:
  buffer_load_dword v127, v251, s[36:39], 0 offen offset:0 sc1
  s_waitcnt vmcnt(0)
  v_cmp_gt_u32 vcc, 256, v127
  s_cbranch_vccz Lcdn6
  s_sub_u32 s43, s43, 1
  s_cmp_lg_u32 s43, 0
  s_cbranch_scc1 Lchk5
Lcdn6:
  v_mfma_f32_16x16x32_bf16 v[80:83], a[116:119], a[168:171], v[80:83]
  ds_read_b64_tr_b16 a[82:83], v118 offset:22528
  s_add_u32 m0, s76, 1024
  v_mfma_f32_16x16x32_bf16 v[84:87], a[120:123], a[168:171], v[84:87]
  ds_read_b64_tr_b16 a[60:61], v119 offset:4096
  buffer_load_dwordx4 v122, s[4:7], s46 offen sc1 lds
  v_mfma_f32_16x16x32_bf16 v[84:87], a[100:103], a[144:147], v[84:87]
  ds_read_b64_tr_b16 a[62:63], v119 offset:10240
  v_mfma_f32_16x16x32_bf16 v[88:91], a[104:107], a[144:147], v[88:91]
  ds_read_b64_tr_b16 a[84:85], v119 offset:16384
  buffer_load_dwordx4 v122, s[4:7], s47 offen offset:1024 sc1 lds
  v_mfma_f32_16x16x32_bf16 v[88:91], a[124:127], a[168:171], v[88:91]
  ds_read_b64_tr_b16 a[86:87], v119 offset:22528
  v_mfma_f32_16x16x32_bf16 v[108:111], a[124:127], a[172:175], v[108:111]
  buffer_load_dwordx2 v[128:129], v121, s[4:7], s77 offen offset:0 sc1
  v_mfma_f32_16x16x32_bf16 v[108:111], a[104:107], a[148:151], v[108:111]
  v_mfma_f32_16x16x32_bf16 v[104:107], a[100:103], a[148:151], v[104:107]
  buffer_load_dwordx2 v[130:131], v121, s[4:7], s77 offen offset:512 sc1
  v_mfma_f32_16x16x32_bf16 v[104:107], a[120:123], a[172:175], v[104:107]
  v_mfma_f32_16x16x32_bf16 v[100:103], a[116:119], a[172:175], v[100:103]
  buffer_load_dwordx2 v[132:133], v121, s[4:7], s77 offen offset:1024 sc1
  v_mfma_f32_16x16x32_bf16 v[100:103], a[96:99], a[148:151], v[100:103]
  v_mfma_f32_16x16x32_bf16 v[96:99], a[92:95], a[148:151], v[96:99]
  buffer_load_dwordx2 v[134:135], v121, s[4:7], s77 offen offset:1536 sc1
  v_mfma_f32_16x16x32_bf16 v[96:99], a[112:115], a[172:175], v[96:99]
  v_mfma_f32_16x16x32_bf16 v[92:95], a[108:111], a[172:175], v[92:95]
  buffer_load_dwordx2 v[136:137], v121, s[4:7], s78 offen offset:0 sc1
  v_mfma_f32_16x16x32_bf16 v[92:95], a[88:91], a[148:151], v[92:95]
  s_waitcnt lgkmcnt(15)
  v_mfma_f32_16x16x32_bf16 v[0:3], a[40:43], a[4:7], v[0:3]
  buffer_load_dwordx2 v[138:139], v121, s[4:7], s78 offen offset:512 sc1
  v_mfma_f32_16x16x32_bf16 v[0:3], a[64:67], a[24:27], v[0:3]
  v_mfma_f32_16x16x32_bf16 v[4:7], a[64:67], a[28:31], v[4:7]
  buffer_load_dwordx2 v[140:141], v121, s[4:7], s78 offen offset:1024 sc1
  v_mfma_f32_16x16x32_bf16 v[4:7], a[40:43], a[8:11], v[4:7]
  v_mfma_f32_16x16x32_bf16 v[8:11], a[40:43], a[12:15], v[8:11]
  buffer_load_dwordx2 v[142:143], v121, s[4:7], s78 offen offset:1536 sc1
  v_mfma_f32_16x16x32_bf16 v[8:11], a[64:67], a[32:35], v[8:11]
  v_mfma_f32_16x16x32_bf16 v[12:15], a[64:67], a[36:39], v[12:15]
  buffer_load_dwordx2 v[144:145], v121, s[4:7], s78 offen offset:2048 sc1
  v_mfma_f32_16x16x32_bf16 v[12:15], a[40:43], a[16:19], v[12:15]
  v_mfma_f32_16x16x32_bf16 v[28:31], a[44:47], a[16:19], v[28:31]
  buffer_load_dwordx2 v[146:147], v121, s[4:7], s78 offen offset:2560 sc1
  v_mfma_f32_16x16x32_bf16 v[28:31], a[68:71], a[36:39], v[28:31]
  v_mfma_f32_16x16x32_bf16 v[24:27], a[68:71], a[32:35], v[24:27]
  buffer_load_dwordx2 v[148:149], v121, s[4:7], s78 offen offset:3072 sc1
  v_mfma_f32_16x16x32_bf16 v[24:27], a[44:47], a[12:15], v[24:27]
  v_mfma_f32_16x16x32_bf16 v[20:23], a[44:47], a[8:11], v[20:23]
  s_waitcnt lgkmcnt(0)
  s_barrier
  ds_read_b64_tr_b16 a[128:129], v116 offset:0
  buffer_load_dwordx2 v[150:151], v121, s[4:7], s78 offen offset:3584 sc1
  v_mfma_f32_16x16x32_bf16 v[20:23], a[68:71], a[28:31], v[20:23]
  ds_read_b64_tr_b16 a[130:131], v116 offset:6144
  v_mfma_f32_16x16x32_bf16 v[16:19], a[68:71], a[24:27], v[16:19]
  ds_read_b64_tr_b16 a[152:153], v116 offset:12288
  buffer_load_dwordx2 v[152:153], v121, s[4:7], s79 offen offset:0 sc1
  v_mfma_f32_16x16x32_bf16 v[16:19], a[44:47], a[4:7], v[16:19]
  ds_read_b64_tr_b16 a[154:155], v116 offset:18432
  v_mfma_f32_16x16x32_bf16 v[32:35], a[48:51], a[0:3], v[32:35]
  ds_read_b128 a[92:95], v112 offset:0
  buffer_load_dwordx2 v[154:155], v121, s[4:7], s79 offen offset:512 sc1
  v_mfma_f32_16x16x32_bf16 v[32:35], a[72:75], a[20:23], v[32:35]
  ds_read_b128 a[112:115], v113 offset:0
  v_mfma_f32_16x16x32_bf16 v[36:39], a[72:75], a[24:27], v[36:39]
  ds_read_b128 a[96:99], v112 offset:2048
  buffer_load_dwordx2 v[156:157], v121, s[4:7], s79 offen offset:1024 sc1
  v_mfma_f32_16x16x32_bf16 v[36:39], a[48:51], a[4:7], v[36:39]
  ds_read_b128 a[116:119], v113 offset:2048
  v_mfma_f32_16x16x32_bf16 v[40:43], a[48:51], a[8:11], v[40:43]
  ds_read_b128 a[100:103], v112 offset:4096
  buffer_load_dwordx2 v[158:159], v121, s[4:7], s79 offen offset:1536 sc1
  v_mfma_f32_16x16x32_bf16 v[40:43], a[72:75], a[28:31], v[40:43]
  ds_read_b128 a[120:123], v113 offset:4096
  v_mfma_f32_16x16x32_bf16 v[44:47], a[72:75], a[32:35], v[44:47]
  ds_read_b128 a[104:107], v112 offset:6144
  buffer_load_dwordx2 v[160:161], v121, s[4:7], s79 offen offset:2048 sc1
  v_mfma_f32_16x16x32_bf16 v[44:47], a[48:51], a[12:15], v[44:47]
  ds_read_b128 a[124:127], v113 offset:6144
  v_mfma_f32_16x16x32_bf16 v[48:51], a[48:51], a[16:19], v[48:51]
  ds_read_b64_tr_b16 a[132:133], v117 offset:0
  buffer_load_dwordx2 v[162:163], v121, s[4:7], s79 offen offset:2560 sc1
  v_mfma_f32_16x16x32_bf16 v[48:51], a[72:75], a[36:39], v[48:51]
  ds_read_b64_tr_b16 a[134:135], v117 offset:6144
  v_mfma_f32_16x16x32_bf16 v[68:71], a[76:79], a[36:39], v[68:71]
  ds_read_b64_tr_b16 a[156:157], v117 offset:12288
  buffer_load_dwordx2 v[164:165], v121, s[4:7], s79 offen offset:3072 sc1
  v_mfma_f32_16x16x32_bf16 v[68:71], a[52:55], a[16:19], v[68:71]
  ds_read_b64_tr_b16 a[158:159], v117 offset:18432
  v_mfma_f32_16x16x32_bf16 v[64:67], a[52:55], a[12:15], v[64:67]
  ds_read_b128 a[88:91], v114
  v_add_u32 v114, s64, v114
  buffer_load_dwordx2 v[166:167], v121, s[4:7], s79 offen offset:3584 sc1
  v_mfma_f32_16x16x32_bf16 v[64:67], a[76:79], a[32:35], v[64:67]
  ds_read_b128 a[108:111], v115
  v_add_u32 v115, s64, v115
  v_mfma_f32_16x16x32_bf16 v[60:63], a[76:79], a[28:31], v[60:63]
  ds_read_b64_tr_b16 a[136:137], v116 offset:2048
  v_mfma_f32_16x16x32_bf16 v[60:63], a[52:55], a[8:11], v[60:63]
  ds_read_b64_tr_b16 a[138:139], v116 offset:8192
  v_mfma_f32_16x16x32_bf16 v[56:59], a[52:55], a[4:7], v[56:59]
  ds_read_b64_tr_b16 a[160:161], v116 offset:14336
  v_mfma_f32_16x16x32_bf16 v[56:59], a[76:79], a[24:27], v[56:59]
  ds_read_b64_tr_b16 a[162:163], v116 offset:20480
  v_mfma_f32_16x16x32_bf16 v[52:55], a[76:79], a[20:23], v[52:55]
  ds_read_b64_tr_b16 a[140:141], v117 offset:2048
  v_mfma_f32_16x16x32_bf16 v[52:55], a[52:55], a[0:3], v[52:55]
  ds_read_b64_tr_b16 a[142:143], v117 offset:8192
  v_mfma_f32_16x16x32_bf16 v[72:75], a[0:3], a[56:59], v[72:75]
  ds_read_b64_tr_b16 a[164:165], v117 offset:14336
  v_mfma_f32_16x16x32_bf16 v[72:75], a[20:23], a[80:83], v[72:75]
  ds_read_b64_tr_b16 a[166:167], v117 offset:20480
  v_mfma_f32_16x16x32_bf16 v[76:79], a[24:27], a[80:83], v[76:79]
  ds_read_b64_tr_b16 a[144:145], v116 offset:4096
  v_mfma_f32_16x16x32_bf16 v[76:79], a[4:7], a[56:59], v[76:79]
  ds_read_b64_tr_b16 a[146:147], v116 offset:10240
  v_mfma_f32_16x16x32_bf16 v[80:83], a[8:11], a[56:59], v[80:83]
  ds_read_b64_tr_b16 a[168:169], v116 offset:16384
  v_mfma_f32_16x16x32_bf16 v[80:83], a[28:31], a[80:83], v[80:83]
  ds_read_b64_tr_b16 a[170:171], v116 offset:22528
  v_mfma_f32_16x16x32_bf16 v[84:87], a[32:35], a[80:83], v[84:87]
  ds_read_b64_tr_b16 a[148:149], v117 offset:4096
  v_mfma_f32_16x16x32_bf16 v[84:87], a[12:15], a[56:59], v[84:87]
  ds_read_b64_tr_b16 a[150:151], v117 offset:10240
  v_mfma_f32_16x16x32_bf16 v[88:91], a[16:19], a[56:59], v[88:91]
  ds_read_b64_tr_b16 a[172:173], v117 offset:16384
  v_mfma_f32_16x16x32_bf16 v[88:91], a[36:39], a[80:83], v[88:91]
  ds_read_b64_tr_b16 a[174:175], v117 offset:22528
  v_mfma_f32_16x16x32_bf16 v[108:111], a[36:39], a[84:87], v[108:111]
  v_mfma_f32_16x16x32_bf16 v[108:111], a[16:19], a[60:63], v[108:111]
  v_mfma_f32_16x16x32_bf16 v[104:107], a[12:15], a[60:63], v[104:107]
  v_mfma_f32_16x16x32_bf16 v[104:107], a[32:35], a[84:87], v[104:107]
  v_mfma_f32_16x16x32_bf16 v[100:103], a[28:31], a[84:87], v[100:103]
  v_mfma_f32_16x16x32_bf16 v[100:103], a[8:11], a[60:63], v[100:103]
  v_mfma_f32_16x16x32_bf16 v[96:99], a[4:7], a[60:63], v[96:99]
  v_mfma_f32_16x16x32_bf16 v[96:99], a[24:27], a[84:87], v[96:99]
  v_mfma_f32_16x16x32_bf16 v[92:95], a[20:23], a[84:87], v[92:95]
  v_mfma_f32_16x16x32_bf16 v[92:95], a[0:3], a[60:63], v[92:95]
  s_waitcnt lgkmcnt(15)
  v_mfma_f32_16x16x32_bf16 v[0:3], a[128:131], a[92:95], v[0:3]
  s_lshl_b32 s88, s53, 7
  v_mfma_f32_16x16x32_bf16 v[0:3], a[152:155], a[112:115], v[0:3]
  s_lshl_b32 s92, s40, 14
  v_mfma_f32_16x16x32_bf16 v[4:7], a[152:155], a[116:119], v[4:7]
  s_add_u32 s88, s88, s92
  v_mfma_f32_16x16x32_bf16 v[4:7], a[128:131], a[96:99], v[4:7]
  s_lshl_b32 s89, s40, 10
  v_mfma_f32_16x16x32_bf16 v[8:11], a[128:131], a[100:103], v[8:11]
  s_and_b32 s92, s52, 3
  v_mfma_f32_16x16x32_bf16 v[8:11], a[152:155], a[120:123], v[8:11]
  s_lshl_b32 s91, s92, 15
  v_mfma_f32_16x16x32_bf16 v[12:15], a[152:155], a[124:127], v[12:15]
  s_mul_i32 s92, s92, 0
  v_mfma_f32_16x16x32_bf16 v[12:15], a[128:131], a[104:107], v[12:15]
  s_and_b32 s93, s53, 7
  v_mfma_f32_16x16x32_bf16 v[28:31], a[132:135], a[104:107], v[28:31]
  s_add_u32 s92, s92, s93
  v_mfma_f32_16x16x32_bf16 v[28:31], a[156:159], a[124:127], v[28:31]
  s_cmp_ge_u32 s92, 8
  s_cselect_b32 s93, 8, 0
  s_sub_u32 s92, s92, s93
  v_mfma_f32_16x16x32_bf16 v[24:27], a[156:159], a[120:123], v[24:27]
  s_cmp_ge_u32 s92, 8
  s_cselect_b32 s93, 8, 0
  s_sub_u32 s92, s92, s93
  v_mfma_f32_16x16x32_bf16 v[24:27], a[132:135], a[100:103], v[24:27]
  s_lshl_b32 s93, 1, s92
  v_mfma_f32_16x16x32_bf16 v[20:23], a[132:135], a[96:99], v[20:23]
  s_waitcnt lgkmcnt(0)
  s_barrier
  s_lshr_b32 s92, s93, 8
  s_or_b32 s93, s93, s92
  s_bitcmp1_b32 s93, 0
  s_cselect_b32 s80, 524288, 0
  s_bitcmp1_b32 s93, 1
  s_cselect_b32 s81, 524288, 0
  s_bitcmp1_b32 s93, 2
  s_cselect_b32 s82, 524288, 0
  s_bitcmp1_b32 s93, 3
  s_cselect_b32 s83, 524288, 0
  s_bitcmp1_b32 s93, 4
  s_cselect_b32 s84, 524288, 0
  s_bitcmp1_b32 s93, 5
  s_cselect_b32 s85, 524288, 0
  s_bitcmp1_b32 s93, 6
  s_cselect_b32 s86, 524288, 0
  s_bitcmp1_b32 s93, 7
  s_cselect_b32 s87, 524288, 0
  v_mfma_f32_16x16x32_bf16 v[20:23], a[156:159], a[116:119], v[20:23]
  s_add_u32 m0, s91, s89
  s_lshl_b32 s92, s91, 4
  v_mfma_f32_16x16x32_bf16 v[16:19], a[156:159], a[112:115], v[16:19]
  s_add_u32 s92, s92, s80
  s_and_b32 s92, s92, 0x1fffff
  v_mfma_f32_16x16x32_bf16 v[16:19], a[132:135], a[92:95], v[16:19]
  s_add_u32 s92, s92, s88
  buffer_load_dwordx4 v252, s[12:15], s92 offen lds
  v_mfma_f32_16x16x32_bf16 v[32:35], a[136:139], a[88:91], v[32:35]
  s_add_u32 s91, s91, 4096
  s_and_b32 s91, s91, 0x1ffff
  v_mfma_f32_16x16x32_bf16 v[32:35], a[160:163], a[108:111], v[32:35]
  v_mfma_f32_16x16x32_bf16 v[36:39], a[160:163], a[112:115], v[36:39]
  s_add_u32 m0, s91, s89
  s_lshl_b32 s92, s91, 4
  v_mfma_f32_16x16x32_bf16 v[36:39], a[136:139], a[92:95], v[36:39]
  s_add_u32 s92, s92, s81
  s_and_b32 s92, s92, 0x1fffff
  v_mfma_f32_16x16x32_bf16 v[40:43], a[136:139], a[96:99], v[40:43]
  s_add_u32 s92, s92, s88
  buffer_load_dwordx4 v252, s[12:15], s92 offen lds
  v_mfma_f32_16x16x32_bf16 v[40:43], a[160:163], a[116:119], v[40:43]
  s_add_u32 s91, s91, 4096
  s_and_b32 s91, s91, 0x1ffff
  v_mfma_f32_16x16x32_bf16 v[44:47], a[160:163], a[120:123], v[44:47]
  v_mfma_f32_16x16x32_bf16 v[44:47], a[136:139], a[100:103], v[44:47]
  s_add_u32 m0, s91, s89
  s_lshl_b32 s92, s91, 4
  v_mfma_f32_16x16x32_bf16 v[48:51], a[136:139], a[104:107], v[48:51]
  s_add_u32 s92, s92, s82
  s_and_b32 s92, s92, 0x1fffff
  v_mfma_f32_16x16x32_bf16 v[48:51], a[160:163], a[124:127], v[48:51]
  s_add_u32 s92, s92, s88
  buffer_load_dwordx4 v252, s[12:15], s92 offen lds
  v_mfma_f32_16x16x32_bf16 v[68:71], a[164:167], a[124:127], v[68:71]
  s_add_u32 s91, s91, 4096
  s_and_b32 s91, s91, 0x1ffff
  v_mfma_f32_16x16x32_bf16 v[68:71], a[140:143], a[104:107], v[68:71]
  v_mfma_f32_16x16x32_bf16 v[64:67], a[140:143], a[100:103], v[64:67]
  s_add_u32 m0, s91, s89
  s_lshl_b32 s92, s91, 4
  v_mfma_f32_16x16x32_bf16 v[64:67], a[164:167], a[120:123], v[64:67]
  s_add_u32 s92, s92, s83
  s_and_b32 s92, s92, 0x1fffff
  v_mfma_f32_16x16x32_bf16 v[60:63], a[164:167], a[116:119], v[60:63]
  s_add_u32 s92, s92, s88
  buffer_load_dwordx4 v252, s[12:15], s92 offen lds
  v_mfma_f32_16x16x32_bf16 v[60:63], a[140:143], a[96:99], v[60:63]
  s_add_u32 s91, s91, 4096
  s_and_b32 s91, s91, 0x1ffff
  v_mfma_f32_16x16x32_bf16 v[56:59], a[140:143], a[92:95], v[56:59]
  v_mfma_f32_16x16x32_bf16 v[56:59], a[164:167], a[112:115], v[56:59]
  s_add_u32 m0, s91, s89
  s_lshl_b32 s92, s91, 4
  v_mfma_f32_16x16x32_bf16 v[52:55], a[164:167], a[108:111], v[52:55]
  s_add_u32 s92, s92, s84
  s_and_b32 s92, s92, 0x1fffff
  v_mfma_f32_16x16x32_bf16 v[52:55], a[140:143], a[88:91], v[52:55]
  s_add_u32 s92, s92, s88
  buffer_load_dwordx4 v252, s[12:15], s92 offen lds
  v_mfma_f32_16x16x32_bf16 v[72:75], a[88:91], a[144:147], v[72:75]
  s_add_u32 s91, s91, 4096
  s_and_b32 s91, s91, 0x1ffff
  v_mfma_f32_16x16x32_bf16 v[72:75], a[108:111], a[168:171], v[72:75]
  v_mfma_f32_16x16x32_bf16 v[76:79], a[112:115], a[168:171], v[76:79]
  s_add_u32 m0, s91, s89
  s_lshl_b32 s92, s91, 4
  v_mfma_f32_16x16x32_bf16 v[76:79], a[92:95], a[144:147], v[76:79]
  s_add_u32 s92, s92, s85
  s_and_b32 s92, s92, 0x1fffff
  v_mfma_f32_16x16x32_bf16 v[80:83], a[96:99], a[144:147], v[80:83]
  s_add_u32 s92, s92, s88
  buffer_load_dwordx4 v252, s[12:15], s92 offen lds
  v_mfma_f32_16x16x32_bf16 v[80:83], a[116:119], a[168:171], v[80:83]
  s_add_u32 s91, s91, 4096
  s_and_b32 s91, s91, 0x1ffff
  v_mfma_f32_16x16x32_bf16 v[84:87], a[120:123], a[168:171], v[84:87]
  v_mfma_f32_16x16x32_bf16 v[84:87], a[100:103], a[144:147], v[84:87]
  s_add_u32 m0, s91, s89
  s_lshl_b32 s92, s91, 4
  v_mfma_f32_16x16x32_bf16 v[88:91], a[104:107], a[144:147], v[88:91]
  s_add_u32 s92, s92, s86
  s_and_b32 s92, s92, 0x1fffff
  v_mfma_f32_16x16x32_bf16 v[88:91], a[124:127], a[168:171], v[88:91]
  s_add_u32 s92, s92, s88
  buffer_load_dwordx4 v252, s[12:15], s92 offen lds
  v_mfma_f32_16x16x32_bf16 v[108:111], a[124:127], a[172:175], v[108:111]
  s_add_u32 s91, s91, 4096
  s_and_b32 s91, s91, 0x1ffff
  v_mfma_f32_16x16x32_bf16 v[108:111], a[104:107], a[148:151], v[108:111]
  v_mfma_f32_16x16x32_bf16 v[104:107], a[100:103], a[148:151], v[104:107]
  s_add_u32 m0, s91, s89
  s_lshl_b32 s92, s91, 4
  v_mfma_f32_16x16x32_bf16 v[104:107], a[120:123], a[172:175], v[104:107]
  s_add_u32 s92, s92, s87
  s_and_b32 s92, s92, 0x1fffff
  v_mfma_f32_16x16x32_bf16 v[100:103], a[116:119], a[172:175], v[100:103]
  s_add_u32 s92, s92, s88
  buffer_load_dwordx4 v252, s[12:15], s92 offen lds
  v_mfma_f32_16x16x32_bf16 v[100:103], a[96:99], a[148:151], v[100:103]
  s_add_u32 s91, s91, 4096
  s_and_b32 s91, s91, 0x1ffff
  v_mfma_f32_16x16x32_bf16 v[96:99], a[92:95], a[148:151], v[96:99]
  v_mfma_f32_16x16x32_bf16 v[96:99], a[112:115], a[172:175], v[96:99]
  v_mfma_f32_16x16x32_bf16 v[92:95], a[108:111], a[172:175], v[92:95]
  v_mfma_f32_16x16x32_bf16 v[92:95], a[88:91], a[148:151], v[92:95]
  v_lshrrev_b32 v124, 4, v253
  v_lshlrev_b32 v124, 4, v124
  v_and_b32 v125, 15, v253
  v_lshlrev_b32 v125, 2, v125
  v_add_u32 v124, s76, v124
  v_add_u32 v125, s76, v125
  v_lshlrev_b32 v120, 4, v253
  s_waitcnt vmcnt(8)
  ds_read_b128 v[168:171], v124 offset:1024
  ds_read_b128 v[172:175], v124 offset:1088
  ds_read_b128 v[176:179], v124 offset:1152
  ds_read_b128 v[180:183], v124 offset:1216
  ds_read_b32 v184, v125 offset:1280
  ds_read_b32 v185, v125 offset:1344
  ds_read_b128 v[200:203], v124 offset:1408
  ds_read_b128 v[204:207], v124 offset:1472
  ds_read_b128 v[208:211], v124 offset:1536
  ds_read_b128 v[212:215], v124 offset:1600
  ds_read_b32 v216, v125 offset:1664
  ds_read_b32 v217, v125 offset:1728
  ds_read_b128 v[220:223], v124 offset:1792
  ds_read_b128 v[224:227], v124 offset:1856
  ds_read_b128 v[228:231], v124 offset:1920
  ds_read_b128 v[232:235], v124 offset:1984
  ds_read_b32 v236, v125 offset:2048
  ds_read_b32 v237, v125 offset:2112
  v_pk_add_f32 v[128:129], v[128:129], v[130:131]
  v_pk_add_f32 v[132:133], v[132:133], v[134:135]
  v_add_f32 v188, v128, v132
  v_add_f32 v194, v129, v133
  v_pk_add_f32 v[136:137], v[136:137], v[138:139]
  v_pk_add_f32 v[140:141], v[140:141], v[142:143]
  v_add_f32 v189, v136, v140
  v_add_f32 v195, v137, v141
  v_pk_add_f32 v[144:145], v[144:145], v[146:147]
  v_pk_add_f32 v[148:149], v[148:149], v[150:151]
  v_add_f32 v190, v144, v148
  v_add_f32 v196, v145, v149
  v_pk_add_f32 v[152:153], v[152:153], v[154:155]
  v_pk_add_f32 v[156:157], v[156:157], v[158:159]
  v_add_f32 v191, v152, v156
  v_add_f32 v197, v153, v157
  v_pk_add_f32 v[160:161], v[160:161], v[162:163]
  v_pk_add_f32 v[164:165], v[164:165], v[166:167]
  v_add_f32 v192, v160, v164
  v_add_f32 v198, v161, v165
  ds_read_b128 v[128:131], v124 offset:2176
  ds_read_b128 v[132:135], v124 offset:2240
  ds_read_b128 v[136:139], v124 offset:2304
  ds_read_b128 v[140:143], v124 offset:2368
  ds_read_b32 v144, v125 offset:2432
  ds_read_b32 v145, v125 offset:2496
  s_add_u32 m0, s91, s89
  s_lshl_b32 s92, s91, 4
  s_add_u32 s92, s92, s80
  s_and_b32 s92, s92, 0x1fffff
  s_add_u32 s92, s92, s88
  buffer_load_dwordx4 v252, s[12:15], s92 offen lds
  s_add_u32 s91, s91, 4096
  s_and_b32 s91, s91, 0x1ffff
  v_mov_b32 v240, v188
  v_mov_b32 v241, v189
  v_mov_b32 v242, v190
  v_mov_b32 v243, v191
  v_mov_b32 v244, v192
  v_mov_b32 v245, v194
  v_mov_b32 v246, v195
  v_mov_b32 v247, v196
  v_mov_b32 v248, v197
  v_mov_b32 v249, v198
  v_permlane32_swap_b32 v188, v240
  v_permlane32_swap_b32 v189, v241
  v_permlane32_swap_b32 v190, v242
  v_permlane32_swap_b32 v191, v243
  v_permlane32_swap_b32 v192, v244
  v_permlane32_swap_b32 v194, v245
  v_permlane32_swap_b32 v195, v246
  v_permlane32_swap_b32 v196, v247
  v_permlane32_swap_b32 v197, v248
  v_permlane32_swap_b32 v198, v249
  v_add_f32 v188, v188, v240
  v_add_f32 v189, v189, v241
  v_add_f32 v190, v190, v242
  v_add_f32 v191, v191, v243
  v_add_f32 v192, v192, v244
  v_add_f32 v194, v194, v245
  v_add_f32 v195, v195, v246
  v_add_f32 v196, v196, v247
  v_add_f32 v197, v197, v248
  v_add_f32 v198, v198, v249
  v_mov_b32 v240, v188
  v_mov_b32 v241, v189
  v_mov_b32 v242, v190
  v_mov_b32 v243, v191
  v_mov_b32 v244, v192
  v_mov_b32 v245, v194
  v_mov_b32 v246, v195
  v_mov_b32 v247, v196
  v_mov_b32 v248, v197
  v_mov_b32 v249, v198
  v_permlane16_swap_b32 v188, v240
  v_permlane16_swap_b32 v189, v241
  v_permlane16_swap_b32 v190, v242
  v_permlane16_swap_b32 v191, v243
  v_permlane16_swap_b32 v192, v244
  v_permlane16_swap_b32 v194, v245
  v_permlane16_swap_b32 v195, v246
  v_permlane16_swap_b32 v196, v247
  v_permlane16_swap_b32 v197, v248
  v_permlane16_swap_b32 v198, v249
  v_add_f32 v188, v188, v240
  v_add_f32 v189, v189, v241
  v_add_f32 v190, v190, v242
  v_add_f32 v191, v191, v243
  v_add_f32 v192, v192, v244
  v_add_f32 v194, v194, v245
  v_add_f32 v195, v195, v246
  v_add_f32 v196, v196, v247
  v_add_f32 v197, v197, v248
  v_add_f32 v198, v198, v249
  s_add_u32 m0, s91, s89
  s_lshl_b32 s92, s91, 4
  s_add_u32 s92, s92, s81
  s_and_b32 s92, s92, 0x1fffff
  s_add_u32 s92, s92, s88
  buffer_load_dwordx4 v252, s[12:15], s92 offen lds
  s_add_u32 s91, s91, 4096
  s_and_b32 s91, s91, 0x1ffff
  s_waitcnt lgkmcnt(0)
  v_pk_add_f32 v[168:169], v[168:169], v[200:201]
  v_pk_add_f32 v[128:129], v[128:129], v[220:221]
  v_pk_add_f32 v[170:171], v[170:171], v[202:203]
  v_pk_add_f32 v[130:131], v[130:131], v[222:223]
  v_pk_add_f32 v[172:173], v[172:173], v[204:205]
  v_pk_add_f32 v[132:133], v[132:133], v[224:225]
  v_pk_add_f32 v[174:175], v[174:175], v[206:207]
  v_pk_add_f32 v[134:135], v[134:135], v[226:227]
  v_pk_add_f32 v[176:177], v[176:177], v[208:209]
  v_pk_add_f32 v[136:137], v[136:137], v[228:229]
  v_pk_add_f32 v[178:179], v[178:179], v[210:211]
  v_pk_add_f32 v[138:139], v[138:139], v[230:231]
  v_pk_add_f32 v[180:181], v[180:181], v[212:213]
  v_pk_add_f32 v[140:141], v[140:141], v[232:233]
  v_pk_add_f32 v[182:183], v[182:183], v[214:215]
  v_pk_add_f32 v[142:143], v[142:143], v[234:235]
  v_pk_add_f32 v[184:185], v[184:185], v[216:217]
  v_pk_add_f32 v[144:145], v[144:145], v[236:237]
  v_pk_add_f32 v[168:169], v[168:169], v[128:129]
  v_pk_add_f32 v[170:171], v[170:171], v[130:131]
  v_pk_add_f32 v[172:173], v[172:173], v[132:133]
  v_pk_add_f32 v[174:175], v[174:175], v[134:135]
  v_pk_add_f32 v[176:177], v[176:177], v[136:137]
  v_pk_add_f32 v[178:179], v[178:179], v[138:139]
  v_pk_add_f32 v[180:181], v[180:181], v[140:141]
  v_pk_add_f32 v[182:183], v[182:183], v[142:143]
  v_pk_add_f32 v[184:185], v[184:185], v[144:145]
  s_add_u32 m0, s91, s89
  s_lshl_b32 s92, s91, 4
  s_add_u32 s92, s92, s82
  s_and_b32 s92, s92, 0x1fffff
  s_add_u32 s92, s92, s88
  buffer_load_dwordx4 v252, s[12:15], s92 offen lds
  s_add_u32 s91, s91, 4096
  s_and_b32 s91, s91, 0x1ffff
  s_mov_b32 s43, 0x3a800000
  v_mov_b32 v240, 0x3727c5ac
  v_mul_f32 v188, 0xba800000, v188
  v_fma_f32 v194, v194, s43, v240
  v_fma_f32 v194, -v188, v188, v194
  v_max_f32 v194, v194, v240
  v_rsq_f32 v194, v194
  ds_write_b32 v125, v188 offset:0
  ds_write_b32 v125, v194 offset:64
  v_mul_f32 v189, 0xba800000, v189
  v_fma_f32 v195, v195, s43, v240
  v_fma_f32 v195, -v189, v189, v195
  v_max_f32 v195, v195, v240
  v_rsq_f32 v195, v195
  ds_write_b32 v125, v189 offset:128
  ds_write_b32 v125, v195 offset:192
  v_mul_f32 v190, 0xba800000, v190
  v_fma_f32 v196, v196, s43, v240
  v_fma_f32 v196, -v190, v190, v196
  v_max_f32 v196, v196, v240
  v_rsq_f32 v196, v196
  ds_write_b32 v125, v190 offset:256
  ds_write_b32 v125, v196 offset:320
  v_mul_f32 v191, 0xba800000, v191
  v_fma_f32 v197, v197, s43, v240
  v_fma_f32 v197, -v191, v191, v197
  v_max_f32 v197, v197, v240
  v_rsq_f32 v197, v197
  ds_write_b32 v125, v191 offset:384
  ds_write_b32 v125, v197 offset:448
  v_mul_f32 v192, 0xba800000, v192
  v_fma_f32 v198, v198, s43, v240
  v_fma_f32 v198, -v192, v192, v198
  v_max_f32 v198, v198, v240
  v_rsq_f32 v198, v198
  ds_write_b32 v125, v192 offset:512
  ds_write_b32 v125, v198 offset:576
  ds_read_b128 v[200:203], v124 offset:0
  ds_read_b128 v[220:223], v124 offset:64
  ds_read_b128 v[204:207], v124 offset:128
  ds_read_b128 v[224:227], v124 offset:192
  ds_read_b128 v[208:211], v124 offset:256
  ds_read_b128 v[228:231], v124 offset:320
  ds_read_b128 v[212:215], v124 offset:384
  ds_read_b128 v[232:235], v124 offset:448
  ds_read_b128 v[216:219], v124 offset:512
  ds_read_b128 v[236:239], v124 offset:576
  s_add_u32 m0, s91, s89
  s_lshl_b32 s92, s91, 4
  s_add_u32 s92, s92, s83
  s_and_b32 s92, s92, 0x1fffff
  s_add_u32 s92, s92, s88
  buffer_load_dwordx4 v252, s[12:15], s92 offen lds
  s_add_u32 s91, s91, 4096
  s_and_b32 s91, s91, 0x1ffff
  v_and_b32 v243, 15, v253
  v_lshrrev_b32 v244, 4, v253
  v_lshlrev_b32 v244, 2, v244
  v_sub_u32 v243, v243, v244
  v_mov_b32 v245, 0xf149f2ca
  s_and_b32 s43, s50, 7
  s_or_b32 s43, s43, s57
  s_cmp_eq_u32 s43, 0
  s_cselect_b64 s[46:47], 0, -1
  v_subrev_u32 v246, 0, v243
  v_cmp_gt_u32 vcc, 8, v246
  v_add_u32 v246, 16, v246
  v_cmp_gt_u32 s[78:79], 8, v246
  v_cndmask_b32 v128, v245, 0, vcc
  s_nop 0
  v_cndmask_b32 v132, v245, 0, s[78:79]
  v_cndmask_b32 v136, v245, v132, s[46:47]
  v_subrev_u32 v246, 1, v243
  v_cmp_gt_u32 vcc, 8, v246
  v_add_u32 v246, 16, v246
  v_cmp_gt_u32 s[78:79], 8, v246
  v_cndmask_b32 v129, v245, 0, vcc
  s_nop 0
  v_cndmask_b32 v133, v245, 0, s[78:79]
  v_cndmask_b32 v137, v245, v133, s[46:47]
  v_subrev_u32 v246, 2, v243
  v_cmp_gt_u32 vcc, 8, v246
  v_add_u32 v246, 16, v246
  v_cmp_gt_u32 s[78:79], 8, v246
  v_cndmask_b32 v130, v245, 0, vcc
  s_nop 0
  v_cndmask_b32 v134, v245, 0, s[78:79]
  v_cndmask_b32 v138, v245, v134, s[46:47]
  v_subrev_u32 v246, 3, v243
  v_cmp_gt_u32 vcc, 8, v246
  v_add_u32 v246, 16, v246
  v_cmp_gt_u32 s[78:79], 8, v246
  v_cndmask_b32 v131, v245, 0, vcc
  s_nop 0
  v_cndmask_b32 v135, v245, 0, s[78:79]
  v_cndmask_b32 v139, v245, v135, s[46:47]
  v_pk_fma_f32 v[32:33], v[176:177], v[188:189], v[32:33] op_sel:[0,0,0] op_sel_hi:[1,0,1]
  v_pk_fma_f32 v[34:35], v[178:179], v[188:189], v[34:35] op_sel:[0,0,0] op_sel_hi:[1,0,1]
  v_pk_fma_f32 v[52:53], v[180:181], v[188:189], v[52:53] op_sel:[0,0,0] op_sel_hi:[1,0,1]
  v_pk_fma_f32 v[54:55], v[182:183], v[188:189], v[54:55] op_sel:[0,0,0] op_sel_hi:[1,0,1]
  v_pk_mul_f32 v[32:33], v[32:33], v[194:195] op_sel:[0,0] op_sel_hi:[1,0]
  v_pk_mul_f32 v[34:35], v[34:35], v[194:195] op_sel:[0,0] op_sel_hi:[1,0]
  v_pk_mul_f32 v[52:53], v[52:53], v[194:195] op_sel:[0,0] op_sel_hi:[1,0]
  v_pk_mul_f32 v[54:55], v[54:55], v[194:195] op_sel:[0,0] op_sel_hi:[1,0]
  v_cvt_pk_bf16_f32 v32, v32, v33
  v_cvt_pk_bf16_f32 v33, v34, v35
  v_cvt_pk_bf16_f32 v34, v52, v53
  v_cvt_pk_bf16_f32 v35, v54, v55
  s_add_u32 m0, s91, s89
  s_lshl_b32 s92, s91, 4
  s_add_u32 s92, s92, s84
  s_and_b32 s92, s92, 0x1fffff
  s_add_u32 s92, s92, s88
  buffer_load_dwordx4 v252, s[12:15], s92 offen lds
  s_add_u32 s91, s91, 4096
  s_and_b32 s91, s91, 0x1ffff
  v_pk_fma_f32 v[36:37], v[176:177], v[188:189], v[36:37] op_sel:[0,1,0] op_sel_hi:[1,1,1]
  v_pk_fma_f32 v[38:39], v[178:179], v[188:189], v[38:39] op_sel:[0,1,0] op_sel_hi:[1,1,1]
  v_pk_fma_f32 v[56:57], v[180:181], v[188:189], v[56:57] op_sel:[0,1,0] op_sel_hi:[1,1,1]
  v_pk_fma_f32 v[58:59], v[182:183], v[188:189], v[58:59] op_sel:[0,1,0] op_sel_hi:[1,1,1]
  v_pk_mul_f32 v[36:37], v[36:37], v[194:195] op_sel:[0,1] op_sel_hi:[1,1]
  v_pk_mul_f32 v[38:39], v[38:39], v[194:195] op_sel:[0,1] op_sel_hi:[1,1]
  v_pk_mul_f32 v[56:57], v[56:57], v[194:195] op_sel:[0,1] op_sel_hi:[1,1]
  v_pk_mul_f32 v[58:59], v[58:59], v[194:195] op_sel:[0,1] op_sel_hi:[1,1]
  v_cvt_pk_bf16_f32 v36, v36, v37
  v_cvt_pk_bf16_f32 v37, v38, v39
  v_cvt_pk_bf16_f32 v38, v56, v57
  v_cvt_pk_bf16_f32 v39, v58, v59
  v_pk_fma_f32 v[40:41], v[176:177], v[190:191], v[40:41] op_sel:[0,0,0] op_sel_hi:[1,0,1]
  v_pk_fma_f32 v[42:43], v[178:179], v[190:191], v[42:43] op_sel:[0,0,0] op_sel_hi:[1,0,1]
  v_pk_fma_f32 v[60:61], v[180:181], v[190:191], v[60:61] op_sel:[0,0,0] op_sel_hi:[1,0,1]
  v_pk_fma_f32 v[62:63], v[182:183], v[190:191], v[62:63] op_sel:[0,0,0] op_sel_hi:[1,0,1]
  v_pk_mul_f32 v[40:41], v[40:41], v[196:197] op_sel:[0,0] op_sel_hi:[1,0]
  v_pk_mul_f32 v[42:43], v[42:43], v[196:197] op_sel:[0,0] op_sel_hi:[1,0]
  v_pk_mul_f32 v[60:61], v[60:61], v[196:197] op_sel:[0,0] op_sel_hi:[1,0]
  v_pk_mul_f32 v[62:63], v[62:63], v[196:197] op_sel:[0,0] op_sel_hi:[1,0]
  v_cvt_pk_bf16_f32 v40, v40, v41
  v_cvt_pk_bf16_f32 v41, v42, v43
  v_cvt_pk_bf16_f32 v42, v60, v61
  v_cvt_pk_bf16_f32 v43, v62, v63
  s_add_u32 m0, s91, s89
  s_lshl_b32 s92, s91, 4
  s_add_u32 s92, s92, s85
  s_and_b32 s92, s92, 0x1fffff
  s_add_u32 s92, s92, s88
  buffer_load_dwordx4 v252, s[12:15], s92 offen lds
  s_add_u32 s91, s91, 4096
  s_and_b32 s91, s91, 0x1ffff
  v_pk_fma_f32 v[44:45], v[176:177], v[190:191], v[44:45] op_sel:[0,1,0] op_sel_hi:[1,1,1]
  v_pk_fma_f32 v[46:47], v[178:179], v[190:191], v[46:47] op_sel:[0,1,0] op_sel_hi:[1,1,1]
  v_pk_fma_f32 v[64:65], v[180:181], v[190:191], v[64:65] op_sel:[0,1,0] op_sel_hi:[1,1,1]
  v_pk_fma_f32 v[66:67], v[182:183], v[190:191], v[66:67] op_sel:[0,1,0] op_sel_hi:[1,1,1]
  v_pk_mul_f32 v[44:45], v[44:45], v[196:197] op_sel:[0,1] op_sel_hi:[1,1]
  v_pk_mul_f32 v[46:47], v[46:47], v[196:197] op_sel:[0,1] op_sel_hi:[1,1]
  v_pk_mul_f32 v[64:65], v[64:65], v[196:197] op_sel:[0,1] op_sel_hi:[1,1]
  v_pk_mul_f32 v[66:67], v[66:67], v[196:197] op_sel:[0,1] op_sel_hi:[1,1]
  v_cvt_pk_bf16_f32 v44, v44, v45
  v_cvt_pk_bf16_f32 v45, v46, v47
  v_cvt_pk_bf16_f32 v46, v64, v65
  v_cvt_pk_bf16_f32 v47, v66, v67
  v_pk_fma_f32 v[48:49], v[176:177], v[192:193], v[48:49] op_sel:[0,0,0] op_sel_hi:[1,0,1]
  v_pk_fma_f32 v[50:51], v[178:179], v[192:193], v[50:51] op_sel:[0,0,0] op_sel_hi:[1,0,1]
  v_pk_fma_f32 v[68:69], v[180:181], v[192:193], v[68:69] op_sel:[0,0,0] op_sel_hi:[1,0,1]
  v_pk_fma_f32 v[70:71], v[182:183], v[192:193], v[70:71] op_sel:[0,0,0] op_sel_hi:[1,0,1]
  v_pk_mul_f32 v[48:49], v[48:49], v[198:199] op_sel:[0,0] op_sel_hi:[1,0]
  v_pk_mul_f32 v[50:51], v[50:51], v[198:199] op_sel:[0,0] op_sel_hi:[1,0]
  v_pk_mul_f32 v[68:69], v[68:69], v[198:199] op_sel:[0,0] op_sel_hi:[1,0]
  v_pk_mul_f32 v[70:71], v[70:71], v[198:199] op_sel:[0,0] op_sel_hi:[1,0]
  v_cvt_pk_bf16_f32 v48, v48, v49
  v_cvt_pk_bf16_f32 v49, v50, v51
  v_cvt_pk_bf16_f32 v50, v68, v69
  v_cvt_pk_bf16_f32 v51, v70, v71
  s_add_u32 m0, s91, s89
  s_lshl_b32 s92, s91, 4
  s_add_u32 s92, s92, s86
  s_and_b32 s92, s92, 0x1fffff
  s_add_u32 s92, s92, s88
  buffer_load_dwordx4 v252, s[12:15], s92 offen lds
  s_add_u32 s91, s91, 4096
  s_and_b32 s91, s91, 0x1ffff
  v_pk_fma_f32 v[0:1], v[168:169], v[188:189], v[0:1] op_sel:[0,1,0] op_sel_hi:[1,1,1]
  v_pk_fma_f32 v[2:3], v[170:171], v[188:189], v[2:3] op_sel:[0,1,0] op_sel_hi:[1,1,1]
  v_pk_fma_f32 v[16:17], v[172:173], v[188:189], v[16:17] op_sel:[0,1,0] op_sel_hi:[1,1,1]
  v_pk_fma_f32 v[18:19], v[174:175], v[188:189], v[18:19] op_sel:[0,1,0] op_sel_hi:[1,1,1]
  v_pk_mul_f32 v[0:1], v[0:1], v[194:195] op_sel:[0,1] op_sel_hi:[1,1]
  v_pk_mul_f32 v[2:3], v[2:3], v[194:195] op_sel:[0,1] op_sel_hi:[1,1]
  v_pk_mul_f32 v[16:17], v[16:17], v[194:195] op_sel:[0,1] op_sel_hi:[1,1]
  v_pk_mul_f32 v[18:19], v[18:19], v[194:195] op_sel:[0,1] op_sel_hi:[1,1]
  v_cvt_pk_bf16_f32 v0, v0, v1
  v_cvt_pk_bf16_f32 v1, v2, v3
  v_cvt_pk_bf16_f32 v2, v16, v17
  v_cvt_pk_bf16_f32 v3, v18, v19
  s_add_u32 m0, s91, s89
  s_lshl_b32 s92, s91, 4
  s_add_u32 s92, s92, s87
  s_and_b32 s92, s92, 0x1fffff
  s_add_u32 s92, s92, s88
  buffer_load_dwordx4 v252, s[12:15], s92 offen lds
  s_add_u32 s91, s91, 4096
  s_and_b32 s91, s91, 0x1ffff
  v_pk_fma_f32 v[4:5], v[168:169], v[190:191], v[4:5] op_sel:[0,0,0] op_sel_hi:[1,0,1]
  v_pk_fma_f32 v[6:7], v[170:171], v[190:191], v[6:7] op_sel:[0,0,0] op_sel_hi:[1,0,1]
  v_pk_fma_f32 v[20:21], v[172:173], v[190:191], v[20:21] op_sel:[0,0,0] op_sel_hi:[1,0,1]
  v_pk_fma_f32 v[22:23], v[174:175], v[190:191], v[22:23] op_sel:[0,0,0] op_sel_hi:[1,0,1]
  v_pk_mul_f32 v[4:5], v[4:5], v[196:197] op_sel:[0,0] op_sel_hi:[1,0]
  v_pk_mul_f32 v[6:7], v[6:7], v[196:197] op_sel:[0,0] op_sel_hi:[1,0]
  v_pk_mul_f32 v[20:21], v[20:21], v[196:197] op_sel:[0,0] op_sel_hi:[1,0]
  v_pk_mul_f32 v[22:23], v[22:23], v[196:197] op_sel:[0,0] op_sel_hi:[1,0]
  v_cvt_pk_bf16_f32 v4, v4, v5
  v_cvt_pk_bf16_f32 v5, v6, v7
  v_cvt_pk_bf16_f32 v6, v20, v21
  v_cvt_pk_bf16_f32 v7, v22, v23
  v_pk_fma_f32 v[8:9], v[168:169], v[190:191], v[8:9] op_sel:[0,1,0] op_sel_hi:[1,1,1]
  v_pk_fma_f32 v[10:11], v[170:171], v[190:191], v[10:11] op_sel:[0,1,0] op_sel_hi:[1,1,1]
  v_pk_fma_f32 v[24:25], v[172:173], v[190:191], v[24:25] op_sel:[0,1,0] op_sel_hi:[1,1,1]
  v_pk_fma_f32 v[26:27], v[174:175], v[190:191], v[26:27] op_sel:[0,1,0] op_sel_hi:[1,1,1]
  v_pk_mul_f32 v[8:9], v[8:9], v[196:197] op_sel:[0,1] op_sel_hi:[1,1]
  v_pk_mul_f32 v[10:11], v[10:11], v[196:197] op_sel:[0,1] op_sel_hi:[1,1]
  v_pk_mul_f32 v[24:25], v[24:25], v[196:197] op_sel:[0,1] op_sel_hi:[1,1]
  v_pk_mul_f32 v[26:27], v[26:27], v[196:197] op_sel:[0,1] op_sel_hi:[1,1]
  v_cvt_pk_bf16_f32 v8, v8, v9
  v_cvt_pk_bf16_f32 v9, v10, v11
  v_cvt_pk_bf16_f32 v10, v24, v25
  v_cvt_pk_bf16_f32 v11, v26, v27
  s_add_u32 m0, s91, s89
  s_lshl_b32 s92, s91, 4
  s_add_u32 s92, s92, s80
  s_and_b32 s92, s92, 0x1fffff
  s_add_u32 s92, s92, s88
  buffer_load_dwordx4 v252, s[12:15], s92 offen lds
  s_add_u32 s91, s91, 4096
  s_and_b32 s91, s91, 0x1ffff
  v_pk_fma_f32 v[12:13], v[168:169], v[192:193], v[12:13] op_sel:[0,0,0] op_sel_hi:[1,0,1]
  v_pk_fma_f32 v[14:15], v[170:171], v[192:193], v[14:15] op_sel:[0,0,0] op_sel_hi:[1,0,1]
  v_pk_fma_f32 v[28:29], v[172:173], v[192:193], v[28:29] op_sel:[0,0,0] op_sel_hi:[1,0,1]
  v_pk_fma_f32 v[30:31], v[174:175], v[192:193], v[30:31] op_sel:[0,0,0] op_sel_hi:[1,0,1]
  v_pk_mul_f32 v[12:13], v[12:13], v[198:199] op_sel:[0,0] op_sel_hi:[1,0]
  v_pk_mul_f32 v[14:15], v[14:15], v[198:199] op_sel:[0,0] op_sel_hi:[1,0]
  v_pk_mul_f32 v[28:29], v[28:29], v[198:199] op_sel:[0,0] op_sel_hi:[1,0]
  v_pk_mul_f32 v[30:31], v[30:31], v[198:199] op_sel:[0,0] op_sel_hi:[1,0]
  v_cvt_pk_bf16_f32 v12, v12, v13
  v_cvt_pk_bf16_f32 v13, v14, v15
  v_cvt_pk_bf16_f32 v14, v28, v29
  v_cvt_pk_bf16_f32 v15, v30, v31
  s_nop 1
  v_mfma_f32_16x16x32_bf16 v[16:19], v[32:35], v[0:3], v[136:139]
  v_mfma_f32_16x16x32_bf16 v[56:59], v[36:39], v[0:3], v[128:131]
  v_mfma_f32_16x16x32_bf16 v[20:23], v[36:39], v[4:7], v[132:135]
  v_mfma_f32_16x16x32_bf16 v[60:63], v[40:43], v[4:7], v[128:131]
  v_mfma_f32_16x16x32_bf16 v[24:27], v[40:43], v[8:11], v[132:135]
  v_mfma_f32_16x16x32_bf16 v[64:67], v[44:47], v[8:11], v[128:131]
  v_mfma_f32_16x16x32_bf16 v[28:31], v[44:47], v[12:15], v[132:135]
  v_mfma_f32_16x16x32_bf16 v[68:71], v[48:51], v[12:15], v[128:131]
  s_waitcnt lgkmcnt(0)
  v_pk_fma_f32 v[72:73], v[200:201], v[184:185], v[72:73] op_sel:[0,0,0] op_sel_hi:[1,0,1]
  v_pk_fma_f32 v[74:75], v[202:203], v[184:185], v[74:75] op_sel:[0,0,0] op_sel_hi:[1,0,1]
  v_pk_fma_f32 v[92:93], v[200:201], v[184:185], v[92:93] op_sel:[0,1,0] op_sel_hi:[1,1,1]
  v_pk_fma_f32 v[94:95], v[202:203], v[184:185], v[94:95] op_sel:[0,1,0] op_sel_hi:[1,1,1]
  v_pk_mul_f32 v[72:73], v[72:73], v[220:221]
  v_pk_mul_f32 v[74:75], v[74:75], v[222:223]
  v_pk_mul_f32 v[92:93], v[92:93], v[220:221]
  v_pk_mul_f32 v[94:95], v[94:95], v[222:223]
  v_cvt_pk_bf16_f32 v140, v72, v73
  v_cvt_pk_bf16_f32 v141, v74, v75
  v_cvt_pk_bf16_f32 v150, v92, v93
  v_cvt_pk_bf16_f32 v151, v94, v95
  s_add_u32 m0, s91, s89
  s_lshl_b32 s92, s91, 4
  s_add_u32 s92, s92, s81
  s_and_b32 s92, s92, 0x1fffff
  s_add_u32 s92, s92, s88
  buffer_load_dwordx4 v252, s[12:15], s92 offen lds
  s_add_u32 s91, s91, 4096
  s_and_b32 s91, s91, 0x1ffff
  v_pk_fma_f32 v[76:77], v[204:205], v[184:185], v[76:77] op_sel:[0,0,0] op_sel_hi:[1,0,1]
  v_pk_fma_f32 v[78:79], v[206:207], v[184:185], v[78:79] op_sel:[0,0,0] op_sel_hi:[1,0,1]
  v_pk_fma_f32 v[96:97], v[204:205], v[184:185], v[96:97] op_sel:[0,1,0] op_sel_hi:[1,1,1]
  v_pk_fma_f32 v[98:99], v[206:207], v[184:185], v[98:99] op_sel:[0,1,0] op_sel_hi:[1,1,1]
  v_pk_mul_f32 v[76:77], v[76:77], v[224:225]
  v_pk_mul_f32 v[78:79], v[78:79], v[226:227]
  v_pk_mul_f32 v[96:97], v[96:97], v[224:225]
  v_pk_mul_f32 v[98:99], v[98:99], v[226:227]
  v_cvt_pk_bf16_f32 v142, v76, v77
  v_cvt_pk_bf16_f32 v143, v78, v79
  v_cvt_pk_bf16_f32 v152, v96, v97
  v_cvt_pk_bf16_f32 v153, v98, v99
  v_pk_fma_f32 v[80:81], v[208:209], v[184:185], v[80:81] op_sel:[0,0,0] op_sel_hi:[1,0,1]
  v_pk_fma_f32 v[82:83], v[210:211], v[184:185], v[82:83] op_sel:[0,0,0] op_sel_hi:[1,0,1]
  v_pk_fma_f32 v[100:101], v[208:209], v[184:185], v[100:101] op_sel:[0,1,0] op_sel_hi:[1,1,1]
  v_pk_fma_f32 v[102:103], v[210:211], v[184:185], v[102:103] op_sel:[0,1,0] op_sel_hi:[1,1,1]
  v_pk_mul_f32 v[80:81], v[80:81], v[228:229]
  v_pk_mul_f32 v[82:83], v[82:83], v[230:231]
  v_pk_mul_f32 v[100:101], v[100:101], v[228:229]
  v_pk_mul_f32 v[102:103], v[102:103], v[230:231]
  v_cvt_pk_bf16_f32 v144, v80, v81
  v_cvt_pk_bf16_f32 v145, v82, v83
  v_cvt_pk_bf16_f32 v154, v100, v101
  v_cvt_pk_bf16_f32 v155, v102, v103
  s_add_u32 m0, s91, s89
  s_lshl_b32 s92, s91, 4
  s_add_u32 s92, s92, s82
  s_and_b32 s92, s92, 0x1fffff
  s_add_u32 s92, s92, s88
  buffer_load_dwordx4 v252, s[12:15], s92 offen lds
  s_add_u32 s91, s91, 4096
  s_and_b32 s91, s91, 0x1ffff
  v_pk_fma_f32 v[84:85], v[212:213], v[184:185], v[84:85] op_sel:[0,0,0] op_sel_hi:[1,0,1]
  v_pk_fma_f32 v[86:87], v[214:215], v[184:185], v[86:87] op_sel:[0,0,0] op_sel_hi:[1,0,1]
  v_pk_fma_f32 v[104:105], v[212:213], v[184:185], v[104:105] op_sel:[0,1,0] op_sel_hi:[1,1,1]
  v_pk_fma_f32 v[106:107], v[214:215], v[184:185], v[106:107] op_sel:[0,1,0] op_sel_hi:[1,1,1]
  v_pk_mul_f32 v[84:85], v[84:85], v[232:233]
  v_pk_mul_f32 v[86:87], v[86:87], v[234:235]
  v_pk_mul_f32 v[104:105], v[104:105], v[232:233]
  v_pk_mul_f32 v[106:107], v[106:107], v[234:235]
  v_cvt_pk_bf16_f32 v146, v84, v85
  v_cvt_pk_bf16_f32 v147, v86, v87
  v_cvt_pk_bf16_f32 v156, v104, v105
  v_cvt_pk_bf16_f32 v157, v106, v107
  v_pk_fma_f32 v[88:89], v[216:217], v[184:185], v[88:89] op_sel:[0,0,0] op_sel_hi:[1,0,1]
  v_pk_fma_f32 v[90:91], v[218:219], v[184:185], v[90:91] op_sel:[0,0,0] op_sel_hi:[1,0,1]
  v_pk_fma_f32 v[108:109], v[216:217], v[184:185], v[108:109] op_sel:[0,1,0] op_sel_hi:[1,1,1]
  v_pk_fma_f32 v[110:111], v[218:219], v[184:185], v[110:111] op_sel:[0,1,0] op_sel_hi:[1,1,1]
  v_pk_mul_f32 v[88:89], v[88:89], v[236:237]
  v_pk_mul_f32 v[90:91], v[90:91], v[238:239]
  v_pk_mul_f32 v[108:109], v[108:109], v[236:237]
  v_pk_mul_f32 v[110:111], v[110:111], v[238:239]
  v_cvt_pk_bf16_f32 v148, v88, v89
  v_cvt_pk_bf16_f32 v149, v90, v91
  v_cvt_pk_bf16_f32 v158, v108, v109
  v_cvt_pk_bf16_f32 v159, v110, v111
  s_add_u32 m0, s91, s89
  s_lshl_b32 s92, s91, 4
  s_add_u32 s92, s92, s83
  s_and_b32 s92, s92, 0x1fffff
  s_add_u32 s92, s92, s88
  buffer_load_dwordx4 v252, s[12:15], s92 offen lds
  s_add_u32 s91, s91, 4096
  s_and_b32 s91, s91, 0x1ffff
  v_max3_f32 v240, v16, v17, v18
  v_max3_f32 v241, v20, v21, v22
  v_max3_f32 v242, v24, v25, v26
  v_max3_f32 v243, v28, v29, v30
  v_max3_f32 v240, v240, v19, v56
  v_max3_f32 v241, v241, v23, v60
  v_max3_f32 v242, v242, v27, v64
  v_max3_f32 v243, v243, v31, v68
  v_max3_f32 v240, v240, v57, v58
  v_max3_f32 v241, v241, v61, v62
  v_max3_f32 v242, v242, v65, v66
  v_max3_f32 v243, v243, v69, v70
  v_max_f32 v240, v240, v59
  v_max_f32 v241, v241, v63
  v_max_f32 v242, v242, v67
  v_max_f32 v243, v243, v71
  v_mov_b32 v244, v240
  v_mov_b32 v245, v241
  v_mov_b32 v246, v242
  v_mov_b32 v247, v243
  v_permlane32_swap_b32 v240, v244
  v_permlane32_swap_b32 v241, v245
  v_permlane32_swap_b32 v242, v246
  v_permlane32_swap_b32 v243, v247
  v_max_f32 v240, v240, v244
  v_max_f32 v241, v241, v245
  v_max_f32 v242, v242, v246
  v_max_f32 v243, v243, v247
  v_mov_b32 v244, v240
  v_mov_b32 v245, v241
  v_mov_b32 v246, v242
  v_mov_b32 v247, v243
  v_permlane16_swap_b32 v240, v244
  v_permlane16_swap_b32 v241, v245
  v_permlane16_swap_b32 v242, v246
  v_permlane16_swap_b32 v243, v247
  v_max_f32 v240, v240, v244
  v_max_f32 v241, v241, v245
  v_max_f32 v242, v242, v246
  v_max_f32 v243, v243, v247
  s_add_u32 m0, s91, s89
  s_lshl_b32 s92, s91, 4
  s_add_u32 s92, s92, s84
  s_and_b32 s92, s92, 0x1fffff
  s_add_u32 s92, s92, s88
  buffer_load_dwordx4 v252, s[12:15], s92 offen lds
  s_add_u32 s91, s91, 4096
  s_and_b32 s91, s91, 0x1ffff
  s_mov_b32 s46, 0x3e8293ee
  v_mul_f32 v240, 0xbe8293ee, v240
  v_mul_f32 v241, 0xbe8293ee, v241
  v_mul_f32 v242, 0xbe8293ee, v242
  v_mul_f32 v243, 0xbe8293ee, v243
  v_mov_b32 v160, 0x3f803f80
  v_mov_b32 v161, 0x3f803f80
  v_mov_b32 v162, 0x3f803f80
  v_mov_b32 v163, 0x3f803f80
  v_fma_f32 v16, v16, s46, v240
  v_fma_f32 v17, v17, s46, v240
  v_fma_f32 v18, v18, s46, v240
  v_fma_f32 v19, v19, s46, v240
  v_fma_f32 v56, v56, s46, v240
  v_fma_f32 v57, v57, s46, v240
  v_fma_f32 v58, v58, s46, v240
  v_fma_f32 v59, v59, s46, v240
  v_exp_f32 v16, v16
  v_exp_f32 v17, v17
  v_exp_f32 v18, v18
  v_exp_f32 v19, v19
  v_exp_f32 v56, v56
  v_exp_f32 v57, v57
  v_exp_f32 v58, v58
  v_exp_f32 v59, v59
  v_cvt_pk_bf16_f32 v0, v16, v17
  v_cvt_pk_bf16_f32 v1, v18, v19
  v_cvt_pk_bf16_f32 v2, v56, v57
  v_cvt_pk_bf16_f32 v3, v58, v59
  s_add_u32 m0, s91, s89
  s_lshl_b32 s92, s91, 4
  s_add_u32 s92, s92, s85
  s_and_b32 s92, s92, 0x1fffff
  s_add_u32 s92, s92, s88
  buffer_load_dwordx4 v252, s[12:15], s92 offen lds
  s_add_u32 s91, s91, 4096
  s_and_b32 s91, s91, 0x1ffff
  v_fma_f32 v20, v20, s46, v241
  v_fma_f32 v21, v21, s46, v241
  v_fma_f32 v22, v22, s46, v241
  v_fma_f32 v23, v23, s46, v241
  v_fma_f32 v60, v60, s46, v241
  v_fma_f32 v61, v61, s46, v241
  v_fma_f32 v62, v62, s46, v241
  v_fma_f32 v63, v63, s46, v241
  v_exp_f32 v20, v20
  v_exp_f32 v21, v21
  v_exp_f32 v22, v22
  v_exp_f32 v23, v23
  v_exp_f32 v60, v60
  v_exp_f32 v61, v61
  v_exp_f32 v62, v62
  v_exp_f32 v63, v63
  v_cvt_pk_bf16_f32 v4, v20, v21
  v_cvt_pk_bf16_f32 v5, v22, v23
  v_cvt_pk_bf16_f32 v6, v60, v61
  v_cvt_pk_bf16_f32 v7, v62, v63
  v_fma_f32 v24, v24, s46, v242
  v_fma_f32 v25, v25, s46, v242
  v_fma_f32 v26, v26, s46, v242
  v_fma_f32 v27, v27, s46, v242
  v_fma_f32 v64, v64, s46, v242
  v_fma_f32 v65, v65, s46, v242
  v_fma_f32 v66, v66, s46, v242
  v_fma_f32 v67, v67, s46, v242
  v_exp_f32 v24, v24
  v_exp_f32 v25, v25
  v_exp_f32 v26, v26
  v_exp_f32 v27, v27
  v_exp_f32 v64, v64
  v_exp_f32 v65, v65
  v_exp_f32 v66, v66
  v_exp_f32 v67, v67
  v_cvt_pk_bf16_f32 v8, v24, v25
  v_cvt_pk_bf16_f32 v9, v26, v27
  v_cvt_pk_bf16_f32 v10, v64, v65
  v_cvt_pk_bf16_f32 v11, v66, v67
  v_fma_f32 v28, v28, s46, v243
  v_fma_f32 v29, v29, s46, v243
  v_fma_f32 v30, v30, s46, v243
  v_fma_f32 v31, v31, s46, v243
  v_fma_f32 v68, v68, s46, v243
  v_fma_f32 v69, v69, s46, v243
  v_fma_f32 v70, v70, s46, v243
  v_fma_f32 v71, v71, s46, v243
  v_exp_f32 v28, v28
  v_exp_f32 v29, v29
  v_exp_f32 v30, v30
  v_exp_f32 v31, v31
  v_exp_f32 v68, v68
  v_exp_f32 v69, v69
  v_exp_f32 v70, v70
  v_exp_f32 v71, v71
  v_cvt_pk_bf16_f32 v12, v28, v29
  v_cvt_pk_bf16_f32 v13, v30, v31
  v_cvt_pk_bf16_f32 v14, v68, v69
  v_cvt_pk_bf16_f32 v15, v70, v71
  s_nop 1
  v_mfma_f32_16x16x32_bf16 v[36:39], v[160:163], v[0:3], 0
  v_mfma_f32_16x16x32_bf16 v[76:79], v[140:143], v[0:3], 0
  v_mfma_f32_16x16x32_bf16 v[96:99], v[150:153], v[0:3], 0
  v_mfma_f32_16x16x32_bf16 v[40:43], v[160:163], v[4:7], 0
  v_mfma_f32_16x16x32_bf16 v[80:83], v[142:145], v[4:7], 0
  v_mfma_f32_16x16x32_bf16 v[100:103], v[152:155], v[4:7], 0
  v_mfma_f32_16x16x32_bf16 v[44:47], v[160:163], v[8:11], 0
  v_mfma_f32_16x16x32_bf16 v[84:87], v[144:147], v[8:11], 0
  v_mfma_f32_16x16x32_bf16 v[104:107], v[154:157], v[8:11], 0
  v_mfma_f32_16x16x32_bf16 v[48:51], v[160:163], v[12:15], 0
  v_mfma_f32_16x16x32_bf16 v[88:91], v[146:149], v[12:15], 0
  v_mfma_f32_16x16x32_bf16 v[108:111], v[156:159], v[12:15], 0
  s_lshl_b32 s43, s74, 15
  s_lshl_b32 s44, s75, 10
  s_add_u32 s43, s43, s44
  s_add_u32 s43, s43, s42
  s_add_u32 s46, s43, 8388608
  s_add_u32 s47, s46, 32768
  s_add_u32 s48, s47, 32768
  s_add_u32 s49, s48, 32768
  v_rcp_f32 v36, v36
  v_rcp_f32 v40, v40
  v_rcp_f32 v44, v44
  v_rcp_f32 v48, v48
  v_pk_mul_f32 v[76:77], v[76:77], v[36:37] op_sel:[0,0] op_sel_hi:[1,0]
  v_pk_mul_f32 v[78:79], v[78:79], v[36:37] op_sel:[0,0] op_sel_hi:[1,0]
  v_pk_mul_f32 v[96:97], v[96:97], v[36:37] op_sel:[0,0] op_sel_hi:[1,0]
  v_pk_mul_f32 v[98:99], v[98:99], v[36:37] op_sel:[0,0] op_sel_hi:[1,0]
  v_cvt_pk_bf16_f32 v16, v76, v77
  v_cvt_pk_bf16_f32 v17, v78, v79
  v_cvt_pk_bf16_f32 v18, v96, v97
  v_cvt_pk_bf16_f32 v19, v98, v99
  buffer_store_dwordx4 v[16:19], v120, s[4:7], s46 offen sc1
  v_pk_mul_f32 v[80:81], v[80:81], v[40:41] op_sel:[0,0] op_sel_hi:[1,0]
  v_pk_mul_f32 v[82:83], v[82:83], v[40:41] op_sel:[0,0] op_sel_hi:[1,0]
  v_pk_mul_f32 v[100:101], v[100:101], v[40:41] op_sel:[0,0] op_sel_hi:[1,0]
  v_pk_mul_f32 v[102:103], v[102:103], v[40:41] op_sel:[0,0] op_sel_hi:[1,0]
  v_cvt_pk_bf16_f32 v20, v80, v81
  v_cvt_pk_bf16_f32 v21, v82, v83
  v_cvt_pk_bf16_f32 v22, v100, v101
  v_cvt_pk_bf16_f32 v23, v102, v103
  buffer_store_dwordx4 v[20:23], v120, s[4:7], s47 offen sc1
  v_pk_mul_f32 v[84:85], v[84:85], v[44:45] op_sel:[0,0] op_sel_hi:[1,0]
  v_pk_mul_f32 v[86:87], v[86:87], v[44:45] op_sel:[0,0] op_sel_hi:[1,0]
  v_pk_mul_f32 v[104:105], v[104:105], v[44:45] op_sel:[0,0] op_sel_hi:[1,0]
  v_pk_mul_f32 v[106:107], v[106:107], v[44:45] op_sel:[0,0] op_sel_hi:[1,0]
  v_cvt_pk_bf16_f32 v24, v84, v85
  v_cvt_pk_bf16_f32 v25, v86, v87
  v_cvt_pk_bf16_f32 v26, v104, v105
  v_cvt_pk_bf16_f32 v27, v106, v107
  buffer_store_dwordx4 v[24:27], v120, s[4:7], s48 offen sc1
  v_pk_mul_f32 v[88:89], v[88:89], v[48:49] op_sel:[0,0] op_sel_hi:[1,0]
  v_pk_mul_f32 v[90:91], v[90:91], v[48:49] op_sel:[0,0] op_sel_hi:[1,0]
  v_pk_mul_f32 v[108:109], v[108:109], v[48:49] op_sel:[0,0] op_sel_hi:[1,0]
  v_pk_mul_f32 v[110:111], v[110:111], v[48:49] op_sel:[0,0] op_sel_hi:[1,0]
  v_cvt_pk_bf16_f32 v28, v88, v89
  v_cvt_pk_bf16_f32 v29, v90, v91
  v_cvt_pk_bf16_f32 v30, v108, v109
  v_cvt_pk_bf16_f32 v31, v110, v111
  buffer_store_dwordx4 v[28:31], v120, s[4:7], s49 offen sc1
  s_lshl_b32 s77, s50, 7
  s_add_u32 s77, s77, s42
  s_add_u32 s77, s77, 27787264
  s_waitcnt vmcnt(0)
  s_barrier
  s_cmp_lg_u32 s40, 0
  s_cbranch_scc1 Lsig7
  v_mov_b32 v250, 1
  s_mov_b64 exec, 1
  buffer_atomic_add v250, v251, s[4:7], s77 offen sc1
  s_mov_b64 exec, -1
Lsig7:
  s_lshl_b32 s58, s52, 3
  s_lshl_b32 s43, s40, 1
  s_add_u32 s58, s58, s43
  s_lshl_b32 s59, s58, 15
  s_lshl_b32 s43, s53, 11
  s_add_u32 s59, s59, s43
  s_add_u32 s59, s59, s42
  s_add_u32 s46, s59, 0
  s_add_u32 s47, s46, 32768
  v_lshlrev_b32 v48, 4, v253
  v_add_u32 v49, 32768, v48
  buffer_load_dwordx4 v[52:55], v48, s[4:7], s46 offen offset:0 sc1
  buffer_load_dwordx4 v[56:59], v48, s[4:7], s46 offen offset:1024 sc1
  buffer_load_dwordx4 v[60:63], v48, s[4:7], s47 offen offset:0 sc1
  buffer_load_dwordx4 v[64:67], v48, s[4:7], s47 offen offset:1024 sc1
  s_add_u32 m0, s91, s89
  s_lshl_b32 s92, s91, 4
  s_add_u32 s92, s92, s86
  s_and_b32 s92, s92, 0x1fffff
  s_add_u32 s92, s92, s88
  buffer_load_dwordx4 v252, s[12:15], s92 offen lds
  s_add_u32 s91, s91, 4096
  s_and_b32 s91, s91, 0x1ffff
  s_add_u32 m0, s91, s89
  s_lshl_b32 s92, s91, 4
  s_add_u32 s92, s92, s87
  s_and_b32 s92, s92, 0x1fffff
  s_add_u32 s92, s92, s88
  buffer_load_dwordx4 v252, s[12:15], s92 offen lds
  s_add_u32 s91, s91, 4096
  s_and_b32 s91, s91, 0x1ffff
  s_add_u32 m0, s91, s89
  s_lshl_b32 s92, s91, 4
  s_add_u32 s92, s92, s80
  s_and_b32 s92, s92, 0x1fffff
  s_add_u32 s92, s92, s88
  buffer_load_dwordx4 v252, s[12:15], s92 offen lds
  s_add_u32 s91, s91, 4096
  s_and_b32 s91, s91, 0x1ffff
  s_add_u32 m0, s91, s89
  s_lshl_b32 s92, s91, 4
  s_add_u32 s92, s92, s81
  s_and_b32 s92, s92, 0x1fffff
  s_add_u32 s92, s92, s88
  buffer_load_dwordx4 v252, s[12:15], s92 offen lds
  s_add_u32 s91, s91, 4096
  s_and_b32 s91, s91, 0x1ffff
  s_add_u32 m0, s91, s89
  s_lshl_b32 s92, s91, 4
  s_add_u32 s92, s92, s82
  s_and_b32 s92, s92, 0x1fffff
  s_add_u32 s92, s92, s88
  buffer_load_dwordx4 v252, s[12:15], s92 offen lds
  s_add_u32 s91, s91, 4096
  s_and_b32 s91, s91, 0x1ffff
  s_add_u32 m0, s91, s89
  s_lshl_b32 s92, s91, 4
  s_add_u32 s92, s92, s83
  s_and_b32 s92, s92, 0x1fffff
  s_add_u32 s92, s92, s88
  buffer_load_dwordx4 v252, s[12:15], s92 offen lds
  s_add_u32 s91, s91, 4096
  s_and_b32 s91, s91, 0x1ffff
  s_add_u32 m0, s91, s89
  s_lshl_b32 s92, s91, 4
  s_add_u32 s92, s92, s84
  s_and_b32 s92, s92, 0x1fffff
  s_add_u32 s92, s92, s88
  buffer_load_dwordx4 v252, s[12:15], s92 offen lds
  s_add_u32 s91, s91, 4096
  s_and_b32 s91, s91, 0x1ffff
  s_add_u32 m0, s91, s89
  s_lshl_b32 s92, s91, 4
  s_add_u32 s92, s92, s85
  s_and_b32 s92, s92, 0x1fffff
  s_add_u32 s92, s92, s88
  buffer_load_dwordx4 v252, s[12:15], s92 offen lds
  s_add_u32 s91, s91, 4096
  s_and_b32 s91, s91, 0x1ffff
  s_add_u32 m0, s91, s89
  s_lshl_b32 s92, s91, 4
  s_add_u32 s92, s92, s86
  s_and_b32 s92, s92, 0x1fffff
  s_add_u32 s92, s92, s88
  buffer_load_dwordx4 v252, s[12:15], s92 offen lds
  s_add_u32 s91, s91, 4096
  s_and_b32 s91, s91, 0x1ffff
  s_add_u32 m0, s91, s89
  s_lshl_b32 s92, s91, 4
  s_add_u32 s92, s92, s87
  s_and_b32 s92, s92, 0x1fffff
  s_add_u32 s92, s92, s88
  buffer_load_dwordx4 v252, s[12:15], s92 offen lds
  s_add_u32 s91, s91, 4096
  s_and_b32 s91, s91, 0x1ffff
  s_lshr_b32 s46, s2, 3
  s_cmp_ge_u32 s46, 14
  s_cselect_b32 s44, 14, 0
  s_cselect_b32 s45, 1, 0
  s_cselect_b32 s28, s20, s16
  s_cselect_b32 s29, s21, s17
  s_mov_b32 s30, 7340032
  s_sub_u32 s44, s46, s44
  s_bfe_u32 s47, s2, 0x20001
  s_mul_i32 s47, s47, 14
  s_add_u32 s44, s44, s47
  s_and_b32 s47, s2, 1
  s_lshl_b32 s48, s47, 1
  s_add_u32 s48, s48, s45
  s_mul_i32 s48, s48, 14336
  s_lshl_b32 s49, s44, 8
  s_add_u32 s48, s48, s49
  s_add_u32 s62, s48, 27918336
  s_lshl_b32 s47, s47, 2
  s_add_u32 s47, s47, s40
  s_mul_i32 s47, s47, 458752
  s_lshl_b32 s44, s44, 7
  s_add_u32 s61, s47, s44
  s_cmp_lt_u32 s46, 28
  s_cselect_b32 s63, 1, 0
  s_cmp_eq_u32 s41, 0
  s_cselect_b32 s63, s63, 0
  v_lshrrev_b32 v140, 3, v253
  v_mul_u32_u24 v140, 7168, v140
  v_and_b32 v141, 7, v253
  v_lshl_add_u32 v140, v141, 4, v140
  s_cmp_eq_u32 s63, 0
  s_cbranch_scc1 Lsl8
  buffer_load_dwordx4 v[100:103], v140, s[28:31], s61 offen
  s_add_u32 s61, s61, 57344
  buffer_load_dwordx4 v[104:107], v140, s[28:31], s61 offen
  s_add_u32 s61, s61, 57344
  buffer_load_dwordx4 v[108:111], v140, s[28:31], s61 offen
  s_add_u32 s61, s61, 57344
  buffer_load_dwordx4 v[112:115], v140, s[28:31], s61 offen
  s_add_u32 s61, s61, 57344
  buffer_load_dwordx4 v[116:119], v140, s[28:31], s61 offen
  s_add_u32 s61, s61, 57344
  buffer_load_dwordx4 v[120:123], v140, s[28:31], s61 offen
  s_add_u32 s61, s61, 57344
  buffer_load_dwordx4 v[124:127], v140, s[28:31], s61 offen
  s_add_u32 s61, s61, 57344
  buffer_load_dwordx4 v[128:131], v140, s[28:31], s61 offen
  s_add_u32 s61, s61, 57344
  s_add_u32 s61, s61, 3211264
Lsl8:
  s_mul_i32 s57, s58, 32768
  s_add_u32 s57, s57, s42
  s_add_u32 s57, s57, 8388608
  s_mov_b32 s60, 0
  v_lshrrev_b32 v2, 2, v253
  v_bfe_u32 v3, v253, 3, 2
  v_and_b32 v4, 3, v253
  v_lshlrev_b32 v4, 3, v4
  v_lshl_add_u32 v4, v2, 7, v4
  v_xor_b32 v5, 0, v3
  v_lshl_add_u32 v40, v5, 5, v4
  v_xor_b32 v5, 1, v3
  v_lshl_add_u32 v41, v5, 5, v4
  v_xor_b32 v5, 2, v3
  v_lshl_add_u32 v42, v5, 5, v4
  v_xor_b32 v5, 3, v3
  v_lshl_add_u32 v43, v5, 5, v4
  s_waitcnt vmcnt(10)
  v_lshlrev_b32 v0, 16, v52
  v_and_b32 v1, 0xffff0000, v52
  v_lshlrev_b32 v2, 16, v53
  v_and_b32 v3, 0xffff0000, v53
  v_lshlrev_b32 v8, 16, v54
  v_and_b32 v9, 0xffff0000, v54
  v_lshlrev_b32 v10, 16, v55
  v_and_b32 v11, 0xffff0000, v55
  v_lshlrev_b32 v16, 16, v56
  v_and_b32 v17, 0xffff0000, v56
  v_lshlrev_b32 v18, 16, v57
  v_and_b32 v19, 0xffff0000, v57
  v_lshlrev_b32 v24, 16, v58
  v_and_b32 v25, 0xffff0000, v58
  v_lshlrev_b32 v26, 16, v59
  v_and_b32 v27, 0xffff0000, v59
  v_lshlrev_b32 v4, 16, v60
  v_and_b32 v5, 0xffff0000, v60
  v_lshlrev_b32 v6, 16, v61
  v_and_b32 v7, 0xffff0000, v61
  v_lshlrev_b32 v12, 16, v62
  v_and_b32 v13, 0xffff0000, v62
  v_lshlrev_b32 v14, 16, v63
  v_and_b32 v15, 0xffff0000, v63
  v_lshlrev_b32 v20, 16, v64
  v_and_b32 v21, 0xffff0000, v64
  v_lshlrev_b32 v22, 16, v65
  v_and_b32 v23, 0xffff0000, v65
  v_lshlrev_b32 v28, 16, v66
  v_and_b32 v29, 0xffff0000, v66
  v_lshlrev_b32 v30, 16, v67
  v_and_b32 v31, 0xffff0000, v67
  s_cmp_eq_u32 s63, 0
  s_cbranch_scc1 Lsa9
  s_waitcnt vmcnt(0)
  v_lshlrev_b32 v132, 16, v100
  v_and_b32 v133, 0xffff0000, v100
  v_lshlrev_b32 v134, 16, v101
  v_and_b32 v135, 0xffff0000, v101
  v_lshlrev_b32 v136, 16, v102
  v_and_b32 v137, 0xffff0000, v102
  v_lshlrev_b32 v138, 16, v103
  v_and_b32 v139, 0xffff0000, v103
  v_lshlrev_b32 v142, 16, v104
  v_and_b32 v143, 0xffff0000, v104
  v_pk_add_f32 v[132:133], v[132:133], v[142:143]
  v_lshlrev_b32 v142, 16, v105
  v_and_b32 v143, 0xffff0000, v105
  v_pk_add_f32 v[134:135], v[134:135], v[142:143]
  v_lshlrev_b32 v142, 16, v106
  v_and_b32 v143, 0xffff0000, v106
  v_pk_add_f32 v[136:137], v[136:137], v[142:143]
  v_lshlrev_b32 v142, 16, v107
  v_and_b32 v143, 0xffff0000, v107
  v_pk_add_f32 v[138:139], v[138:139], v[142:143]
  v_lshlrev_b32 v142, 16, v108
  v_and_b32 v143, 0xffff0000, v108
  v_pk_add_f32 v[132:133], v[132:133], v[142:143]
  v_lshlrev_b32 v142, 16, v109
  v_and_b32 v143, 0xffff0000, v109
  v_pk_add_f32 v[134:135], v[134:135], v[142:143]
  v_lshlrev_b32 v142, 16, v110
  v_and_b32 v143, 0xffff0000, v110
  v_pk_add_f32 v[136:137], v[136:137], v[142:143]
  v_lshlrev_b32 v142, 16, v111
  v_and_b32 v143, 0xffff0000, v111
  v_pk_add_f32 v[138:139], v[138:139], v[142:143]
  v_lshlrev_b32 v142, 16, v112
  v_and_b32 v143, 0xffff0000, v112
  v_pk_add_f32 v[132:133], v[132:133], v[142:143]
  v_lshlrev_b32 v142, 16, v113
  v_and_b32 v143, 0xffff0000, v113
  v_pk_add_f32 v[134:135], v[134:135], v[142:143]
  v_lshlrev_b32 v142, 16, v114
  v_and_b32 v143, 0xffff0000, v114
  v_pk_add_f32 v[136:137], v[136:137], v[142:143]
  v_lshlrev_b32 v142, 16, v115
  v_and_b32 v143, 0xffff0000, v115
  v_pk_add_f32 v[138:139], v[138:139], v[142:143]
  v_lshlrev_b32 v142, 16, v116
  v_and_b32 v143, 0xffff0000, v116
  v_pk_add_f32 v[132:133], v[132:133], v[142:143]
  v_lshlrev_b32 v142, 16, v117
  v_and_b32 v143, 0xffff0000, v117
  v_pk_add_f32 v[134:135], v[134:135], v[142:143]
  v_lshlrev_b32 v142, 16, v118
  v_and_b32 v143, 0xffff0000, v118
  v_pk_add_f32 v[136:137], v[136:137], v[142:143]
  v_lshlrev_b32 v142, 16, v119
  v_and_b32 v143, 0xffff0000, v119
  v_pk_add_f32 v[138:139], v[138:139], v[142:143]
  v_lshlrev_b32 v142, 16, v120
  v_and_b32 v143, 0xffff0000, v120
  v_pk_add_f32 v[132:133], v[132:133], v[142:143]
  v_lshlrev_b32 v142, 16, v121
  v_and_b32 v143, 0xffff0000, v121
  v_pk_add_f32 v[134:135], v[134:135], v[142:143]
  v_lshlrev_b32 v142, 16, v122
  v_and_b32 v143, 0xffff0000, v122
  v_pk_add_f32 v[136:137], v[136:137], v[142:143]
  v_lshlrev_b32 v142, 16, v123
  v_and_b32 v143, 0xffff0000, v123
  v_pk_add_f32 v[138:139], v[138:139], v[142:143]
  v_lshlrev_b32 v142, 16, v124
  v_and_b32 v143, 0xffff0000, v124
  v_pk_add_f32 v[132:133], v[132:133], v[142:143]
  v_lshlrev_b32 v142, 16, v125
  v_and_b32 v143, 0xffff0000, v125
  v_pk_add_f32 v[134:135], v[134:135], v[142:143]
  v_lshlrev_b32 v142, 16, v126
  v_and_b32 v143, 0xffff0000, v126
  v_pk_add_f32 v[136:137], v[136:137], v[142:143]
  v_lshlrev_b32 v142, 16, v127
  v_and_b32 v143, 0xffff0000, v127
  v_pk_add_f32 v[138:139], v[138:139], v[142:143]
  v_lshlrev_b32 v142, 16, v128
  v_and_b32 v143, 0xffff0000, v128
  v_pk_add_f32 v[132:133], v[132:133], v[142:143]
  v_lshlrev_b32 v142, 16, v129
  v_and_b32 v143, 0xffff0000, v129
  v_pk_add_f32 v[134:135], v[134:135], v[142:143]
  v_lshlrev_b32 v142, 16, v130
  v_and_b32 v143, 0xffff0000, v130
  v_pk_add_f32 v[136:137], v[136:137], v[142:143]
  v_lshlrev_b32 v142, 16, v131
  v_and_b32 v143, 0xffff0000, v131
  v_pk_add_f32 v[138:139], v[138:139], v[142:143]
Lsa9:
  s_lshl_b32 s77, s52, 7
  s_add_u32 s77, s77, 27787264
  s_add_u32 s77, s77, s42
  s_cmp_lg_u32 s40, 0
  s_cbranch_scc1 Lpdn11
  s_mov_b32 s43, 0x40000
  s_mov_b64 exec, 1
Lpol10:
  buffer_load_dword v250, v251, s[4:7], s77 offen sc1
  s_waitcnt vmcnt(0)
  v_cmp_gt_u32 vcc, 16, v250
  s_cbranch_vccz Lpdn11
  s_sub_u32 s43, s43, 1
  s_cmp_lg_u32 s43, 0
  s_cbranch_scc1 Lpol10
Lpdn11:
  s_mov_b64 exec, -1
  s_waitcnt vmcnt(0) lgkmcnt(0)
  s_barrier
  s_lshr_b32 s93, s80, 6
  s_add_u32 s93, s93, s60
  s_and_b32 s93, s93, 0x7fff
  s_add_u32 s93, s93, s57
  buffer_load_dwordx4 a[0:3], v48, s[4:7], s93 offen sc1
  buffer_load_dwordx4 a[4:7], v49, s[4:7], s93 offen sc1
  s_add_u32 s60, s60, 1024
  s_lshr_b32 s93, s81, 6
  s_add_u32 s93, s93, s60
  s_and_b32 s93, s93, 0x7fff
  s_add_u32 s93, s93, s57
  buffer_load_dwordx4 a[8:11], v48, s[4:7], s93 offen sc1
  buffer_load_dwordx4 a[12:15], v49, s[4:7], s93 offen sc1
  s_add_u32 s60, s60, 1024
  s_lshr_b32 s93, s82, 6
  s_add_u32 s93, s93, s60
  s_and_b32 s93, s93, 0x7fff
  s_add_u32 s93, s93, s57
  buffer_load_dwordx4 a[16:19], v48, s[4:7], s93 offen sc1
  buffer_load_dwordx4 a[20:23], v49, s[4:7], s93 offen sc1
  s_add_u32 s60, s60, 1024
  s_lshr_b32 s93, s83, 6
  s_add_u32 s93, s93, s60
  s_and_b32 s93, s93, 0x7fff
  s_add_u32 s93, s93, s57
  buffer_load_dwordx4 a[24:27], v48, s[4:7], s93 offen sc1
  buffer_load_dwordx4 a[28:31], v49, s[4:7], s93 offen sc1
  s_add_u32 s60, s60, 1024
  s_lshr_b32 s93, s84, 6
  s_add_u32 s93, s93, s60
  s_and_b32 s93, s93, 0x7fff
  s_add_u32 s93, s93, s57
  buffer_load_dwordx4 a[32:35], v48, s[4:7], s93 offen sc1
  buffer_load_dwordx4 a[36:39], v49, s[4:7], s93 offen sc1
  s_add_u32 s60, s60, 1024
  ds_read_b64_tr_b16 a[112:113], v40 offset:0
  ds_read_b64_tr_b16 a[114:115], v40 offset:2048
  ds_read_b64_tr_b16 a[128:129], v40 offset:4096
  ds_read_b64_tr_b16 a[130:131], v40 offset:6144
  ds_read_b64_tr_b16 a[116:117], v41 offset:0
  ds_read_b64_tr_b16 a[118:119], v41 offset:2048
  ds_read_b64_tr_b16 a[132:133], v41 offset:4096
  ds_read_b64_tr_b16 a[134:135], v41 offset:6144
  ds_read_b64_tr_b16 a[120:121], v42 offset:0
  ds_read_b64_tr_b16 a[122:123], v42 offset:2048
  ds_read_b64_tr_b16 a[136:137], v42 offset:4096
  ds_read_b64_tr_b16 a[138:139], v42 offset:6144
  ds_read_b64_tr_b16 a[124:125], v43 offset:0
  ds_read_b64_tr_b16 a[126:127], v43 offset:2048
  ds_read_b64_tr_b16 a[140:141], v43 offset:4096
  ds_read_b64_tr_b16 a[142:143], v43 offset:6144
  s_mov_b32 s56, 3
.p2align 3
Lp2_loop:
  s_waitcnt vmcnt(6) lgkmcnt(12)
  v_mfma_f32_16x16x32_bf16 v[0:3], a[112:115], a[0:3], v[0:3]
  ds_read_b64_tr_b16 a[144:145], v40 offset:8192
  v_mfma_f32_16x16x32_bf16 v[0:3], a[128:131], a[8:11], v[0:3]
  ds_read_b64_tr_b16 a[146:147], v40 offset:10240
  s_lshr_b32 s93, s85, 6
  s_add_u32 s93, s93, s60
  s_and_b32 s93, s93, 0x7fff
  s_add_u32 s93, s93, s57
  buffer_load_dwordx4 a[40:43], v48, s[4:7], s93 offen sc1
  v_mfma_f32_16x16x32_bf16 v[4:7], a[128:131], a[12:15], v[4:7]
  ds_read_b64_tr_b16 a[160:161], v40 offset:12288
  v_mfma_f32_16x16x32_bf16 v[4:7], a[112:115], a[4:7], v[4:7]
  ds_read_b64_tr_b16 a[162:163], v40 offset:14336
  s_waitcnt lgkmcnt(12)
  v_mfma_f32_16x16x32_bf16 v[12:15], a[116:119], a[4:7], v[12:15]
  ds_read_b64_tr_b16 a[148:149], v41 offset:8192
  buffer_load_dwordx4 a[44:47], v49, s[4:7], s93 offen sc1
  s_add_u32 s60, s60, 1024
  v_mfma_f32_16x16x32_bf16 v[12:15], a[132:135], a[12:15], v[12:15]
  ds_read_b64_tr_b16 a[150:151], v41 offset:10240
  v_mfma_f32_16x16x32_bf16 v[8:11], a[132:135], a[8:11], v[8:11]
  ds_read_b64_tr_b16 a[164:165], v41 offset:12288
  v_mfma_f32_16x16x32_bf16 v[8:11], a[116:119], a[0:3], v[8:11]
  ds_read_b64_tr_b16 a[166:167], v41 offset:14336
  s_waitcnt lgkmcnt(12)
  v_mfma_f32_16x16x32_bf16 v[16:19], a[120:123], a[0:3], v[16:19]
  ds_read_b64_tr_b16 a[152:153], v42 offset:8192
  s_lshr_b32 s93, s86, 6
  s_add_u32 s93, s93, s60
  s_and_b32 s93, s93, 0x7fff
  s_add_u32 s93, s93, s57
  buffer_load_dwordx4 a[48:51], v48, s[4:7], s93 offen sc1
  v_mfma_f32_16x16x32_bf16 v[16:19], a[136:139], a[8:11], v[16:19]
  ds_read_b64_tr_b16 a[154:155], v42 offset:10240
  v_mfma_f32_16x16x32_bf16 v[20:23], a[136:139], a[12:15], v[20:23]
  ds_read_b64_tr_b16 a[168:169], v42 offset:12288
  v_mfma_f32_16x16x32_bf16 v[20:23], a[120:123], a[4:7], v[20:23]
  ds_read_b64_tr_b16 a[170:171], v42 offset:14336
  buffer_load_dwordx4 a[52:55], v49, s[4:7], s93 offen sc1
  s_add_u32 s60, s60, 1024
  s_waitcnt lgkmcnt(12)
  v_mfma_f32_16x16x32_bf16 v[28:31], a[124:127], a[4:7], v[28:31]
  ds_read_b64_tr_b16 a[156:157], v43 offset:8192
  v_mfma_f32_16x16x32_bf16 v[28:31], a[140:143], a[12:15], v[28:31]
  ds_read_b64_tr_b16 a[158:159], v43 offset:10240
  v_mfma_f32_16x16x32_bf16 v[24:27], a[140:143], a[8:11], v[24:27]
  ds_read_b64_tr_b16 a[172:173], v43 offset:12288
  v_mfma_f32_16x16x32_bf16 v[24:27], a[124:127], a[0:3], v[24:27]
  ds_read_b64_tr_b16 a[174:175], v43 offset:14336
  s_waitcnt vmcnt(6) lgkmcnt(12)
  v_mfma_f32_16x16x32_bf16 v[0:3], a[144:147], a[16:19], v[0:3]
  ds_read_b64_tr_b16 a[112:113], v40 offset:16384
  v_mfma_f32_16x16x32_bf16 v[0:3], a[160:163], a[24:27], v[0:3]
  ds_read_b64_tr_b16 a[114:115], v40 offset:18432
  s_lshr_b32 s93, s87, 6
  s_add_u32 s93, s93, s60
  s_and_b32 s93, s93, 0x7fff
  s_add_u32 s93, s93, s57
  buffer_load_dwordx4 a[56:59], v48, s[4:7], s93 offen sc1
  v_mfma_f32_16x16x32_bf16 v[4:7], a[160:163], a[28:31], v[4:7]
  ds_read_b64_tr_b16 a[128:129], v40 offset:20480
  v_mfma_f32_16x16x32_bf16 v[4:7], a[144:147], a[20:23], v[4:7]
  ds_read_b64_tr_b16 a[130:131], v40 offset:22528
  s_waitcnt lgkmcnt(12)
  v_mfma_f32_16x16x32_bf16 v[12:15], a[148:151], a[20:23], v[12:15]
  ds_read_b64_tr_b16 a[116:117], v41 offset:16384
  buffer_load_dwordx4 a[60:63], v49, s[4:7], s93 offen sc1
  s_add_u32 s60, s60, 1024
  v_mfma_f32_16x16x32_bf16 v[12:15], a[164:167], a[28:31], v[12:15]
  ds_read_b64_tr_b16 a[118:119], v41 offset:18432
  v_mfma_f32_16x16x32_bf16 v[8:11], a[164:167], a[24:27], v[8:11]
  ds_read_b64_tr_b16 a[132:133], v41 offset:20480
  v_mfma_f32_16x16x32_bf16 v[8:11], a[148:151], a[16:19], v[8:11]
  ds_read_b64_tr_b16 a[134:135], v41 offset:22528
  s_waitcnt lgkmcnt(12)
  v_mfma_f32_16x16x32_bf16 v[16:19], a[152:155], a[16:19], v[16:19]
  ds_read_b64_tr_b16 a[120:121], v42 offset:16384
  s_lshr_b32 s93, s80, 6
  s_add_u32 s93, s93, s60
  s_and_b32 s93, s93, 0x7fff
  s_add_u32 s93, s93, s57
  buffer_load_dwordx4 a[0:3], v48, s[4:7], s93 offen sc1
  v_mfma_f32_16x16x32_bf16 v[16:19], a[168:171], a[24:27], v[16:19]
  ds_read_b64_tr_b16 a[122:123], v42 offset:18432
  v_mfma_f32_16x16x32_bf16 v[20:23], a[168:171], a[28:31], v[20:23]
  ds_read_b64_tr_b16 a[136:137], v42 offset:20480
  v_mfma_f32_16x16x32_bf16 v[20:23], a[152:155], a[20:23], v[20:23]
  ds_read_b64_tr_b16 a[138:139], v42 offset:22528
  buffer_load_dwordx4 a[4:7], v49, s[4:7], s93 offen sc1
  s_add_u32 s60, s60, 1024
  s_waitcnt lgkmcnt(12)
  v_mfma_f32_16x16x32_bf16 v[28:31], a[156:159], a[20:23], v[28:31]
  ds_read_b64_tr_b16 a[124:125], v43 offset:16384
  v_mfma_f32_16x16x32_bf16 v[28:31], a[172:175], a[28:31], v[28:31]
  ds_read_b64_tr_b16 a[126:127], v43 offset:18432
  v_mfma_f32_16x16x32_bf16 v[24:27], a[172:175], a[24:27], v[24:27]
  ds_read_b64_tr_b16 a[140:141], v43 offset:20480
  v_mfma_f32_16x16x32_bf16 v[24:27], a[156:159], a[16:19], v[24:27]
  ds_read_b64_tr_b16 a[142:143], v43 offset:22528
  s_waitcnt vmcnt(6) lgkmcnt(12)
  v_mfma_f32_16x16x32_bf16 v[0:3], a[112:115], a[32:35], v[0:3]
  ds_read_b64_tr_b16 a[144:145], v40 offset:24576
  v_mfma_f32_16x16x32_bf16 v[0:3], a[128:131], a[40:43], v[0:3]
  ds_read_b64_tr_b16 a[146:147], v40 offset:26624
  s_lshr_b32 s93, s81, 6
  s_add_u32 s93, s93, s60
  s_and_b32 s93, s93, 0x7fff
  s_add_u32 s93, s93, s57
  buffer_load_dwordx4 a[8:11], v48, s[4:7], s93 offen sc1
  v_mfma_f32_16x16x32_bf16 v[4:7], a[128:131], a[44:47], v[4:7]
  ds_read_b64_tr_b16 a[160:161], v40 offset:28672
  v_mfma_f32_16x16x32_bf16 v[4:7], a[112:115], a[36:39], v[4:7]
  ds_read_b64_tr_b16 a[162:163], v40 offset:30720
  v_add_u32 v40, 32768, v40
  s_waitcnt lgkmcnt(12)
  v_mfma_f32_16x16x32_bf16 v[12:15], a[116:119], a[36:39], v[12:15]
  ds_read_b64_tr_b16 a[148:149], v41 offset:24576
  buffer_load_dwordx4 a[12:15], v49, s[4:7], s93 offen sc1
  s_add_u32 s60, s60, 1024
  v_mfma_f32_16x16x32_bf16 v[12:15], a[132:135], a[44:47], v[12:15]
  ds_read_b64_tr_b16 a[150:151], v41 offset:26624
  v_mfma_f32_16x16x32_bf16 v[8:11], a[132:135], a[40:43], v[8:11]
  ds_read_b64_tr_b16 a[164:165], v41 offset:28672
  v_mfma_f32_16x16x32_bf16 v[8:11], a[116:119], a[32:35], v[8:11]
  ds_read_b64_tr_b16 a[166:167], v41 offset:30720
  v_add_u32 v41, 32768, v41
  s_waitcnt lgkmcnt(12)
  v_mfma_f32_16x16x32_bf16 v[16:19], a[120:123], a[32:35], v[16:19]
  ds_read_b64_tr_b16 a[152:153], v42 offset:24576
  s_lshr_b32 s93, s82, 6
  s_add_u32 s93, s93, s60
  s_and_b32 s93, s93, 0x7fff
  s_add_u32 s93, s93, s57
  buffer_load_dwordx4 a[16:19], v48, s[4:7], s93 offen sc1
  v_mfma_f32_16x16x32_bf16 v[16:19], a[136:139], a[40:43], v[16:19]
  ds_read_b64_tr_b16 a[154:155], v42 offset:26624
  v_mfma_f32_16x16x32_bf16 v[20:23], a[136:139], a[44:47], v[20:23]
  ds_read_b64_tr_b16 a[168:169], v42 offset:28672
  v_mfma_f32_16x16x32_bf16 v[20:23], a[120:123], a[36:39], v[20:23]
  ds_read_b64_tr_b16 a[170:171], v42 offset:30720
  v_add_u32 v42, 32768, v42
  buffer_load_dwordx4 a[20:23], v49, s[4:7], s93 offen sc1
  s_add_u32 s60, s60, 1024
  s_waitcnt lgkmcnt(12)
  v_mfma_f32_16x16x32_bf16 v[28:31], a[124:127], a[36:39], v[28:31]
  ds_read_b64_tr_b16 a[156:157], v43 offset:24576
  v_mfma_f32_16x16x32_bf16 v[28:31], a[140:143], a[44:47], v[28:31]
  ds_read_b64_tr_b16 a[158:159], v43 offset:26624
  v_mfma_f32_16x16x32_bf16 v[24:27], a[140:143], a[40:43], v[24:27]
  ds_read_b64_tr_b16 a[172:173], v43 offset:28672
  v_mfma_f32_16x16x32_bf16 v[24:27], a[124:127], a[32:35], v[24:27]
  ds_read_b64_tr_b16 a[174:175], v43 offset:30720
  v_add_u32 v43, 32768, v43
  s_waitcnt vmcnt(6) lgkmcnt(12)
  v_mfma_f32_16x16x32_bf16 v[0:3], a[144:147], a[48:51], v[0:3]
  ds_read_b64_tr_b16 a[112:113], v40 offset:0
  v_mfma_f32_16x16x32_bf16 v[0:3], a[160:163], a[56:59], v[0:3]
  ds_read_b64_tr_b16 a[114:115], v40 offset:2048
  s_lshr_b32 s93, s83, 6
  s_add_u32 s93, s93, s60
  s_and_b32 s93, s93, 0x7fff
  s_add_u32 s93, s93, s57
  buffer_load_dwordx4 a[24:27], v48, s[4:7], s93 offen sc1
  v_mfma_f32_16x16x32_bf16 v[4:7], a[160:163], a[60:63], v[4:7]
  ds_read_b64_tr_b16 a[128:129], v40 offset:4096
  v_mfma_f32_16x16x32_bf16 v[4:7], a[144:147], a[52:55], v[4:7]
  ds_read_b64_tr_b16 a[130:131], v40 offset:6144
  s_waitcnt lgkmcnt(12)
  v_mfma_f32_16x16x32_bf16 v[12:15], a[148:151], a[52:55], v[12:15]
  ds_read_b64_tr_b16 a[116:117], v41 offset:0
  buffer_load_dwordx4 a[28:31], v49, s[4:7], s93 offen sc1
  s_add_u32 s60, s60, 1024
  v_mfma_f32_16x16x32_bf16 v[12:15], a[164:167], a[60:63], v[12:15]
  ds_read_b64_tr_b16 a[118:119], v41 offset:2048
  v_mfma_f32_16x16x32_bf16 v[8:11], a[164:167], a[56:59], v[8:11]
  ds_read_b64_tr_b16 a[132:133], v41 offset:4096
  v_mfma_f32_16x16x32_bf16 v[8:11], a[148:151], a[48:51], v[8:11]
  ds_read_b64_tr_b16 a[134:135], v41 offset:6144
  s_waitcnt lgkmcnt(12)
  v_mfma_f32_16x16x32_bf16 v[16:19], a[152:155], a[48:51], v[16:19]
  ds_read_b64_tr_b16 a[120:121], v42 offset:0
  s_lshr_b32 s93, s84, 6
  s_add_u32 s93, s93, s60
  s_and_b32 s93, s93, 0x7fff
  s_add_u32 s93, s93, s57
  buffer_load_dwordx4 a[32:35], v48, s[4:7], s93 offen sc1
  v_mfma_f32_16x16x32_bf16 v[16:19], a[168:171], a[56:59], v[16:19]
  ds_read_b64_tr_b16 a[122:123], v42 offset:2048
  v_mfma_f32_16x16x32_bf16 v[20:23], a[168:171], a[60:63], v[20:23]
  ds_read_b64_tr_b16 a[136:137], v42 offset:4096
  v_mfma_f32_16x16x32_bf16 v[20:23], a[152:155], a[52:55], v[20:23]
  ds_read_b64_tr_b16 a[138:139], v42 offset:6144
  buffer_load_dwordx4 a[36:39], v49, s[4:7], s93 offen sc1
  s_add_u32 s60, s60, 1024
  s_waitcnt lgkmcnt(12)
  v_mfma_f32_16x16x32_bf16 v[28:31], a[156:159], a[52:55], v[28:31]
  ds_read_b64_tr_b16 a[124:125], v43 offset:0
  v_mfma_f32_16x16x32_bf16 v[28:31], a[172:175], a[60:63], v[28:31]
  ds_read_b64_tr_b16 a[126:127], v43 offset:2048
  v_mfma_f32_16x16x32_bf16 v[24:27], a[172:175], a[56:59], v[24:27]
  ds_read_b64_tr_b16 a[140:141], v43 offset:4096
  v_mfma_f32_16x16x32_bf16 v[24:27], a[156:159], a[48:51], v[24:27]
  ds_read_b64_tr_b16 a[142:143], v43 offset:6144
  s_sub_u32 s56, s56, 1
  s_cmp_lg_u32 s56, 0
  s_cbranch_scc1 Lp2_loop
  s_waitcnt vmcnt(6) lgkmcnt(12)
  v_mfma_f32_16x16x32_bf16 v[0:3], a[112:115], a[0:3], v[0:3]
  ds_read_b64_tr_b16 a[144:145], v40 offset:8192
  v_mfma_f32_16x16x32_bf16 v[0:3], a[128:131], a[8:11], v[0:3]
  ds_read_b64_tr_b16 a[146:147], v40 offset:10240
  s_lshr_b32 s93, s85, 6
  s_add_u32 s93, s93, s60
  s_and_b32 s93, s93, 0x7fff
  s_add_u32 s93, s93, s57
  buffer_load_dwordx4 a[40:43], v48, s[4:7], s93 offen sc1
  v_mfma_f32_16x16x32_bf16 v[4:7], a[128:131], a[12:15], v[4:7]
  ds_read_b64_tr_b16 a[160:161], v40 offset:12288
  v_mfma_f32_16x16x32_bf16 v[4:7], a[112:115], a[4:7], v[4:7]
  ds_read_b64_tr_b16 a[162:163], v40 offset:14336
  s_waitcnt lgkmcnt(12)
  v_mfma_f32_16x16x32_bf16 v[12:15], a[116:119], a[4:7], v[12:15]
  ds_read_b64_tr_b16 a[148:149], v41 offset:8192
  buffer_load_dwordx4 a[44:47], v49, s[4:7], s93 offen sc1
  s_add_u32 s60, s60, 1024
  v_mfma_f32_16x16x32_bf16 v[12:15], a[132:135], a[12:15], v[12:15]
  ds_read_b64_tr_b16 a[150:151], v41 offset:10240
  v_mfma_f32_16x16x32_bf16 v[8:11], a[132:135], a[8:11], v[8:11]
  ds_read_b64_tr_b16 a[164:165], v41 offset:12288
  v_mfma_f32_16x16x32_bf16 v[8:11], a[116:119], a[0:3], v[8:11]
  ds_read_b64_tr_b16 a[166:167], v41 offset:14336
  s_waitcnt lgkmcnt(12)
  v_mfma_f32_16x16x32_bf16 v[16:19], a[120:123], a[0:3], v[16:19]
  ds_read_b64_tr_b16 a[152:153], v42 offset:8192
  s_lshr_b32 s93, s86, 6
  s_add_u32 s93, s93, s60
  s_and_b32 s93, s93, 0x7fff
  s_add_u32 s93, s93, s57
  buffer_load_dwordx4 a[48:51], v48, s[4:7], s93 offen sc1
  v_mfma_f32_16x16x32_bf16 v[16:19], a[136:139], a[8:11], v[16:19]
  ds_read_b64_tr_b16 a[154:155], v42 offset:10240
  v_mfma_f32_16x16x32_bf16 v[20:23], a[136:139], a[12:15], v[20:23]
  ds_read_b64_tr_b16 a[168:169], v42 offset:12288
  v_mfma_f32_16x16x32_bf16 v[20:23], a[120:123], a[4:7], v[20:23]
  ds_read_b64_tr_b16 a[170:171], v42 offset:14336
  buffer_load_dwordx4 a[52:55], v49, s[4:7], s93 offen sc1
  s_add_u32 s60, s60, 1024
  s_waitcnt lgkmcnt(12)
  v_mfma_f32_16x16x32_bf16 v[28:31], a[124:127], a[4:7], v[28:31]
  ds_read_b64_tr_b16 a[156:157], v43 offset:8192
  v_mfma_f32_16x16x32_bf16 v[28:31], a[140:143], a[12:15], v[28:31]
  ds_read_b64_tr_b16 a[158:159], v43 offset:10240
  v_mfma_f32_16x16x32_bf16 v[24:27], a[140:143], a[8:11], v[24:27]
  ds_read_b64_tr_b16 a[172:173], v43 offset:12288
  v_mfma_f32_16x16x32_bf16 v[24:27], a[124:127], a[0:3], v[24:27]
  ds_read_b64_tr_b16 a[174:175], v43 offset:14336
  s_waitcnt vmcnt(6) lgkmcnt(12)
  v_mfma_f32_16x16x32_bf16 v[0:3], a[144:147], a[16:19], v[0:3]
  ds_read_b64_tr_b16 a[112:113], v40 offset:16384
  v_mfma_f32_16x16x32_bf16 v[0:3], a[160:163], a[24:27], v[0:3]
  ds_read_b64_tr_b16 a[114:115], v40 offset:18432
  s_lshr_b32 s93, s87, 6
  s_add_u32 s93, s93, s60
  s_and_b32 s93, s93, 0x7fff
  s_add_u32 s93, s93, s57
  buffer_load_dwordx4 a[56:59], v48, s[4:7], s93 offen sc1
  v_mfma_f32_16x16x32_bf16 v[4:7], a[160:163], a[28:31], v[4:7]
  ds_read_b64_tr_b16 a[128:129], v40 offset:20480
  v_mfma_f32_16x16x32_bf16 v[4:7], a[144:147], a[20:23], v[4:7]
  ds_read_b64_tr_b16 a[130:131], v40 offset:22528
  s_waitcnt lgkmcnt(12)
  v_mfma_f32_16x16x32_bf16 v[12:15], a[148:151], a[20:23], v[12:15]
  ds_read_b64_tr_b16 a[116:117], v41 offset:16384
  v_mfma_f32_16x16x32_bf16 v[12:15], a[164:167], a[28:31], v[12:15]
  ds_read_b64_tr_b16 a[118:119], v41 offset:18432
  v_mfma_f32_16x16x32_bf16 v[8:11], a[164:167], a[24:27], v[8:11]
  ds_read_b64_tr_b16 a[132:133], v41 offset:20480
  v_mfma_f32_16x16x32_bf16 v[8:11], a[148:151], a[16:19], v[8:11]
  ds_read_b64_tr_b16 a[134:135], v41 offset:22528
  s_waitcnt lgkmcnt(12)
  v_mfma_f32_16x16x32_bf16 v[16:19], a[152:155], a[16:19], v[16:19]
  ds_read_b64_tr_b16 a[120:121], v42 offset:16384
  buffer_load_dwordx4 a[60:63], v49, s[4:7], s93 offen sc1
  s_add_u32 s60, s60, 1024
  v_mfma_f32_16x16x32_bf16 v[16:19], a[168:171], a[24:27], v[16:19]
  ds_read_b64_tr_b16 a[122:123], v42 offset:18432
  v_mfma_f32_16x16x32_bf16 v[20:23], a[168:171], a[28:31], v[20:23]
  ds_read_b64_tr_b16 a[136:137], v42 offset:20480
  v_mfma_f32_16x16x32_bf16 v[20:23], a[152:155], a[20:23], v[20:23]
  ds_read_b64_tr_b16 a[138:139], v42 offset:22528
  s_waitcnt lgkmcnt(12)
  v_mfma_f32_16x16x32_bf16 v[28:31], a[156:159], a[20:23], v[28:31]
  ds_read_b64_tr_b16 a[124:125], v43 offset:16384
  v_mfma_f32_16x16x32_bf16 v[28:31], a[172:175], a[28:31], v[28:31]
  ds_read_b64_tr_b16 a[126:127], v43 offset:18432
  v_mfma_f32_16x16x32_bf16 v[24:27], a[172:175], a[24:27], v[24:27]
  ds_read_b64_tr_b16 a[140:141], v43 offset:20480
  v_mfma_f32_16x16x32_bf16 v[24:27], a[156:159], a[16:19], v[24:27]
  ds_read_b64_tr_b16 a[142:143], v43 offset:22528
  s_waitcnt vmcnt(4) lgkmcnt(12)
  v_mfma_f32_16x16x32_bf16 v[0:3], a[112:115], a[32:35], v[0:3]
  ds_read_b64_tr_b16 a[144:145], v40 offset:24576
  v_mfma_f32_16x16x32_bf16 v[0:3], a[128:131], a[40:43], v[0:3]
  ds_read_b64_tr_b16 a[146:147], v40 offset:26624
  v_mfma_f32_16x16x32_bf16 v[4:7], a[128:131], a[44:47], v[4:7]
  ds_read_b64_tr_b16 a[160:161], v40 offset:28672
  v_mfma_f32_16x16x32_bf16 v[4:7], a[112:115], a[36:39], v[4:7]
  ds_read_b64_tr_b16 a[162:163], v40 offset:30720
  v_add_u32 v40, 32768, v40
  s_waitcnt lgkmcnt(12)
  v_mfma_f32_16x16x32_bf16 v[12:15], a[116:119], a[36:39], v[12:15]
  ds_read_b64_tr_b16 a[148:149], v41 offset:24576
  v_mfma_f32_16x16x32_bf16 v[12:15], a[132:135], a[44:47], v[12:15]
  ds_read_b64_tr_b16 a[150:151], v41 offset:26624
  v_mfma_f32_16x16x32_bf16 v[8:11], a[132:135], a[40:43], v[8:11]
  ds_read_b64_tr_b16 a[164:165], v41 offset:28672
  v_mfma_f32_16x16x32_bf16 v[8:11], a[116:119], a[32:35], v[8:11]
  ds_read_b64_tr_b16 a[166:167], v41 offset:30720
  v_add_u32 v41, 32768, v41
  s_waitcnt lgkmcnt(12)
  v_mfma_f32_16x16x32_bf16 v[16:19], a[120:123], a[32:35], v[16:19]
  ds_read_b64_tr_b16 a[152:153], v42 offset:24576
  v_mfma_f32_16x16x32_bf16 v[16:19], a[136:139], a[40:43], v[16:19]
  ds_read_b64_tr_b16 a[154:155], v42 offset:26624
  v_mfma_f32_16x16x32_bf16 v[20:23], a[136:139], a[44:47], v[20:23]
  ds_read_b64_tr_b16 a[168:169], v42 offset:28672
  v_mfma_f32_16x16x32_bf16 v[20:23], a[120:123], a[36:39], v[20:23]
  ds_read_b64_tr_b16 a[170:171], v42 offset:30720
  v_add_u32 v42, 32768, v42
  s_waitcnt lgkmcnt(12)
  v_mfma_f32_16x16x32_bf16 v[28:31], a[124:127], a[36:39], v[28:31]
  ds_read_b64_tr_b16 a[156:157], v43 offset:24576
  v_mfma_f32_16x16x32_bf16 v[28:31], a[140:143], a[44:47], v[28:31]
  ds_read_b64_tr_b16 a[158:159], v43 offset:26624
  v_mfma_f32_16x16x32_bf16 v[24:27], a[140:143], a[40:43], v[24:27]
  ds_read_b64_tr_b16 a[172:173], v43 offset:28672
  v_mfma_f32_16x16x32_bf16 v[24:27], a[124:127], a[32:35], v[24:27]
  ds_read_b64_tr_b16 a[174:175], v43 offset:30720
  v_add_u32 v43, 32768, v43
  s_waitcnt vmcnt(0) lgkmcnt(12)
  v_mfma_f32_16x16x32_bf16 v[0:3], a[144:147], a[48:51], v[0:3]
  v_mfma_f32_16x16x32_bf16 v[0:3], a[160:163], a[56:59], v[0:3]
  v_mfma_f32_16x16x32_bf16 v[4:7], a[160:163], a[60:63], v[4:7]
  v_mfma_f32_16x16x32_bf16 v[4:7], a[144:147], a[52:55], v[4:7]
  s_waitcnt lgkmcnt(8)
  v_mfma_f32_16x16x32_bf16 v[12:15], a[148:151], a[52:55], v[12:15]
  v_mfma_f32_16x16x32_bf16 v[12:15], a[164:167], a[60:63], v[12:15]
  v_mfma_f32_16x16x32_bf16 v[8:11], a[164:167], a[56:59], v[8:11]
  v_mfma_f32_16x16x32_bf16 v[8:11], a[148:151], a[48:51], v[8:11]
  s_waitcnt lgkmcnt(4)
  v_mfma_f32_16x16x32_bf16 v[16:19], a[152:155], a[48:51], v[16:19]
  v_mfma_f32_16x16x32_bf16 v[16:19], a[168:171], a[56:59], v[16:19]
  v_mfma_f32_16x16x32_bf16 v[20:23], a[168:171], a[60:63], v[20:23]
  v_mfma_f32_16x16x32_bf16 v[20:23], a[152:155], a[52:55], v[20:23]
  s_waitcnt lgkmcnt(0)
  v_mfma_f32_16x16x32_bf16 v[28:31], a[156:159], a[52:55], v[28:31]
  v_mfma_f32_16x16x32_bf16 v[28:31], a[172:175], a[60:63], v[28:31]
  v_mfma_f32_16x16x32_bf16 v[24:27], a[172:175], a[56:59], v[24:27]
  v_mfma_f32_16x16x32_bf16 v[24:27], a[156:159], a[48:51], v[24:27]
  s_add_u32 s46, s59, 4194304
  s_add_u32 s47, s46, 32768
  s_lshl_b32 s48, s58, 11
  s_lshl_b32 s43, s53, 7
  s_add_u32 s48, s48, s43
  s_add_u32 s48, s48, s42
  s_add_u32 s48, s48, 27525120
  s_nop 0
  v_cvt_pk_bf16_f32 v52, v0, v1
  v_cvt_pk_bf16_f32 v53, v2, v3
  v_cvt_pk_bf16_f32 v54, v8, v9
  v_cvt_pk_bf16_f32 v55, v10, v11
  buffer_store_dwordx4 v[52:55], v48, s[4:7], s46 offen offset:0 sc1
  v_cvt_pk_bf16_f32 v60, v4, v5
  v_cvt_pk_bf16_f32 v61, v6, v7
  v_cvt_pk_bf16_f32 v62, v12, v13
  v_cvt_pk_bf16_f32 v63, v14, v15
  buffer_store_dwordx4 v[60:63], v48, s[4:7], s47 offen offset:0 sc1
  v_cvt_pk_bf16_f32 v56, v16, v17
  v_cvt_pk_bf16_f32 v57, v18, v19
  v_cvt_pk_bf16_f32 v58, v24, v25
  v_cvt_pk_bf16_f32 v59, v26, v27
  buffer_store_dwordx4 v[56:59], v48, s[4:7], s46 offen offset:1024 sc1
  v_cvt_pk_bf16_f32 v64, v20, v21
  v_cvt_pk_bf16_f32 v65, v22, v23
  v_cvt_pk_bf16_f32 v66, v28, v29
  v_cvt_pk_bf16_f32 v67, v30, v31
  buffer_store_dwordx4 v[64:67], v48, s[4:7], s47 offen offset:1024 sc1
  v_mov_b32 v72, 0x3f803f80
  v_mov_b32 v73, 0x3f803f80
  v_mov_b32 v74, 0x3f803f80
  v_mov_b32 v75, 0x3f803f80
  v_and_b32 v92, 15, v253
  v_lshrrev_b32 v93, 4, v253
  v_mfma_f32_16x16x32_bf16 v[76:79], v[72:75], v[52:55], 0
  v_mfma_f32_16x16x32_bf16 v[80:83], v[52:55], v[52:55], 0
  v_mfma_f32_16x16x32_bf16 v[84:87], v[72:75], v[60:63], 0
  v_mfma_f32_16x16x32_bf16 v[88:91], v[60:63], v[60:63], 0
  v_mfma_f32_16x16x32_bf16 v[76:79], v[72:75], v[56:59], v[76:79]
  v_mfma_f32_16x16x32_bf16 v[80:83], v[56:59], v[56:59], v[80:83]
  v_mfma_f32_16x16x32_bf16 v[84:87], v[72:75], v[64:67], v[84:87]
  v_mfma_f32_16x16x32_bf16 v[88:91], v[64:67], v[64:67], v[88:91]
  v_lshrrev_b32 v72, 2, v92
  v_cmp_eq_u32 s[64:65], v72, v93
  v_and_b32 v72, 3, v92
  v_cmp_eq_u32 s[66:67], 1, v72
  v_cmp_eq_u32 s[68:69], 2, v72
  v_cmp_eq_u32 s[70:71], 3, v72
  v_lshlrev_b32 v92, 3, v92
  v_mov_b32 v93, 0x7ffffff0
  s_nop 0
  v_cndmask_b32 v92, v93, v92, s[64:65]
  v_cndmask_b32 v77, v80, v81, s[66:67]
  v_cndmask_b32 v77, v77, v82, s[68:69]
  v_cndmask_b32 v77, v77, v83, s[70:71]
  buffer_store_dwordx2 v[76:77], v92, s[4:7], s48 offen offset:0 sc1
  v_cndmask_b32 v85, v88, v89, s[66:67]
  v_cndmask_b32 v85, v85, v90, s[68:69]
  v_cndmask_b32 v85, v85, v91, s[70:71]
  buffer_store_dwordx2 v[84:85], v92, s[4:7], s48 offen offset:2048 sc1
  s_lshr_b32 s77, s52, 1
  s_lshl_b32 s77, s77, 7
  s_add_u32 s77, s77, s42
  s_add_u32 s77, s77, 27789312
  s_waitcnt vmcnt(0)
  s_barrier
  s_cmp_lg_u32 s40, 0
  s_cbranch_scc1 Lsig12
  v_mov_b32 v250, 1
  s_mov_b64 exec, 1
  buffer_atomic_add v250, v251, s[4:7], s77 offen sc1
  s_mov_b64 exec, -1
Lsig12:
  s_and_b32 s66, s55, 1
  v_lshrrev_b32 v2, 4, v253
  v_bfe_u32 v3, v253, 1, 3
  v_and_b32 v4, 1, v253
  v_lshlrev_b32 v4, 4, v4
  v_mul_u32_u24 v5, 7168, v2
  v_add_u32 v5, v5, v4
  s_cmp_eq_u32 s66, 0
  s_cselect_b32 s44, 7, 0
  v_mov_b32 v7, 0x40000000
  v_add_u32 v6, 0, v2
  v_xor_b32 v6, v6, v3
  v_cmp_eq_u32 vcc, s44, v6
  v_lshl_add_u32 v6, v6, 5, v5
  v_add_u32 v6, 0, v6
  v_cndmask_b32 v231, v6, v7, vcc
  v_add_u32 v6, 4, v2
  v_xor_b32 v6, v6, v3
  v_cmp_eq_u32 vcc, s44, v6
  v_lshl_add_u32 v6, v6, 5, v5
  v_add_u32 v6, 27648, v6
  v_cndmask_b32 v232, v6, v7, vcc
  v_add_u32 v6, 0, v2
  v_xor_b32 v6, v6, v3
  v_cmp_eq_u32 vcc, s44, v6
  v_lshl_add_u32 v6, v6, 5, v5
  v_add_u32 v6, 55296, v6
  v_cndmask_b32 v233, v6, v7, vcc
  v_add_u32 v6, 4, v2
  v_xor_b32 v6, v6, v3
  v_cmp_eq_u32 vcc, s44, v6
  v_lshl_add_u32 v6, v6, 5, v5
  v_add_u32 v6, 82944, v6
  v_cndmask_b32 v234, v6, v7, vcc
  s_mul_i32 s68, s55, 224
  s_and_b32 s68, s68, 0xffffffc0
  s_mul_i32 s43, s40, 114688
  s_add_u32 s68, s68, s43
  s_lshl_b32 s69, s40, 12
  s_add_u32 m0, s69, 0
  s_nop 0
  buffer_load_dwordx4 v231, s[16:19], s68 offen offset:0 lds
  buffer_load_dwordx4 v232, s[16:19], s68 offen offset:1024 lds
  buffer_load_dwordx4 v233, s[16:19], s68 offen offset:2048 lds
  buffer_load_dwordx4 v234, s[16:19], s68 offen offset:3072 lds
  s_add_u32 m0, s69, 16384
  s_nop 0
  buffer_load_dwordx4 v231, s[20:23], s68 offen offset:0 lds
  buffer_load_dwordx4 v232, s[20:23], s68 offen offset:1024 lds
  buffer_load_dwordx4 v233, s[20:23], s68 offen offset:2048 lds
  buffer_load_dwordx4 v234, s[20:23], s68 offen offset:3072 lds
  s_add_u32 s68, s68, 458752
  s_add_u32 m0, s69, 32768
  s_nop 0
  buffer_load_dwordx4 v231, s[16:19], s68 offen offset:0 lds
  buffer_load_dwordx4 v232, s[16:19], s68 offen offset:1024 lds
  buffer_load_dwordx4 v233, s[16:19], s68 offen offset:2048 lds
  buffer_load_dwordx4 v234, s[16:19], s68 offen offset:3072 lds
  s_add_u32 m0, s69, 49152
  s_nop 0
  buffer_load_dwordx4 v231, s[20:23], s68 offen offset:0 lds
  buffer_load_dwordx4 v232, s[20:23], s68 offen offset:1024 lds
  buffer_load_dwordx4 v233, s[20:23], s68 offen offset:2048 lds
  buffer_load_dwordx4 v234, s[20:23], s68 offen offset:3072 lds
  s_add_u32 s68, s68, 458752
  s_xor_b32 s69, s69, 0x10000
  s_cmp_eq_u32 s63, 0
  s_cbranch_scc1 Lsl13
  buffer_load_dwordx4 v[100:103], v140, s[28:31], s61 offen
  s_add_u32 s61, s61, 57344
  buffer_load_dwordx4 v[104:107], v140, s[28:31], s61 offen
  s_add_u32 s61, s61, 57344
  buffer_load_dwordx4 v[108:111], v140, s[28:31], s61 offen
  s_add_u32 s61, s61, 57344
  buffer_load_dwordx4 v[112:115], v140, s[28:31], s61 offen
  s_add_u32 s61, s61, 57344
  buffer_load_dwordx4 v[116:119], v140, s[28:31], s61 offen
  s_add_u32 s61, s61, 57344
  buffer_load_dwordx4 v[120:123], v140, s[28:31], s61 offen
  s_add_u32 s61, s61, 57344
  buffer_load_dwordx4 v[124:127], v140, s[28:31], s61 offen
  s_add_u32 s61, s61, 57344
  buffer_load_dwordx4 v[128:131], v140, s[28:31], s61 offen
  s_add_u32 s61, s61, 57344
  s_add_u32 s61, s61, 3211264
Lsl13:
  v_lshlrev_b32 v6, 4, v253
  v_add_u32 v235, 0, v6
  v_lshlrev_b32 v6, 4, v253
  v_add_u32 v236, 32768, v6
  v_lshlrev_b32 v6, 4, v253
  v_add_u32 v237, 65536, v6
  v_lshlrev_b32 v6, 4, v253
  v_add_u32 v238, 98304, v6
  s_lshl_b32 s43, s41, 30
  v_or_b32 v239, s43, v6
  s_lshl_b32 s43, s2, 2
  s_add_u32 s43, s43, s40
  s_mul_i32 s71, s43, 7168
  s_lshl_b32 s70, s54, 2
  s_add_u32 s70, s70, s40
  s_lshl_b32 s67, s70, 17
  s_add_u32 s67, s67, s42
  s_add_u32 s67, s67, 4194304
  s_lshl_b32 s72, s40, 11
  s_add_u32 s72, s72, 131072
  v_lshrrev_b32 v2, 2, v253
  v_and_b32 v3, 7, v2
  v_and_b32 v4, 3, v253
  v_lshlrev_b32 v4, 3, v4
  v_lshl_add_u32 v4, v2, 8, v4
  s_lshl_b32 s43, s66, 1
  s_cmp_eq_u32 s66, 0
  s_cselect_b32 s45, 6, 1
  s_add_u32 s46, s43, 0
  v_xor_b32 v5, s46, v3
  v_lshl_add_u32 v224, v5, 5, v4
  s_add_u32 s46, s43, 1
  v_xor_b32 v5, s46, v3
  v_lshl_add_u32 v225, v5, 5, v4
  s_add_u32 s46, s43, 2
  v_xor_b32 v5, s46, v3
  v_lshl_add_u32 v226, v5, 5, v4
  s_add_u32 s46, s43, 3
  v_xor_b32 v5, s46, v3
  v_lshl_add_u32 v227, v5, 5, v4
  s_add_u32 s46, s43, 4
  v_xor_b32 v5, s46, v3
  v_lshl_add_u32 v228, v5, 5, v4
  s_add_u32 s46, s43, 5
  v_xor_b32 v5, s46, v3
  v_lshl_add_u32 v229, v5, 5, v4
  v_xor_b32 v5, s45, v3
  v_lshl_add_u32 v230, v5, 5, v4
  v_mov_b32 v0, 0
  v_mov_b32 v1, 0
  v_mov_b32 v2, 0
  v_mov_b32 v3, 0
  v_mov_b32 v4, 0
  v_mov_b32 v5, 0
  v_mov_b32 v6, 0
  v_mov_b32 v7, 0
  v_mov_b32 v8, 0
  v_mov_b32 v9, 0
  v_mov_b32 v10, 0
  v_mov_b32 v11, 0
  v_mov_b32 v12, 0
  v_mov_b32 v13, 0
  v_mov_b32 v14, 0
  v_mov_b32 v15, 0
  v_mov_b32 v16, 0
  v_mov_b32 v17, 0
  v_mov_b32 v18, 0
  v_mov_b32 v19, 0
  v_mov_b32 v20, 0
  v_mov_b32 v21, 0
  v_mov_b32 v22, 0
  v_mov_b32 v23, 0
  v_mov_b32 v24, 0
  v_mov_b32 v25, 0
  v_mov_b32 v26, 0
  v_mov_b32 v27, 0
  v_mov_b32 v28, 0
  v_mov_b32 v29, 0
  v_mov_b32 v30, 0
  v_mov_b32 v31, 0
  v_mov_b32 v32, 0
  v_mov_b32 v33, 0
  v_mov_b32 v34, 0
  v_mov_b32 v35, 0
  v_mov_b32 v36, 0
  v_mov_b32 v37, 0
  v_mov_b32 v38, 0
  v_mov_b32 v39, 0
  v_mov_b32 v40, 0
  v_mov_b32 v41, 0
  v_mov_b32 v42, 0
  v_mov_b32 v43, 0
  v_mov_b32 v44, 0
  v_mov_b32 v45, 0
  v_mov_b32 v46, 0
  v_mov_b32 v47, 0
  v_mov_b32 v48, 0
  v_mov_b32 v49, 0
  v_mov_b32 v50, 0
  v_mov_b32 v51, 0
  v_mov_b32 v52, 0
  v_mov_b32 v53, 0
  v_mov_b32 v54, 0
  v_mov_b32 v55, 0
  v_mov_b32 v56, 0
  v_mov_b32 v57, 0
  v_mov_b32 v58, 0
  v_mov_b32 v59, 0
  v_mov_b32 v60, 0
  v_mov_b32 v61, 0
  v_mov_b32 v62, 0
  v_mov_b32 v63, 0
  v_mov_b32 v64, 0
  v_mov_b32 v65, 0
  v_mov_b32 v66, 0
  v_mov_b32 v67, 0
  v_mov_b32 v68, 0
  v_mov_b32 v69, 0
  v_mov_b32 v70, 0
  v_mov_b32 v71, 0
  v_mov_b32 v72, 0
  v_mov_b32 v73, 0
  v_mov_b32 v74, 0
  v_mov_b32 v75, 0
  v_mov_b32 v76, 0
  v_mov_b32 v77, 0
  v_mov_b32 v78, 0
  v_mov_b32 v79, 0
  v_mov_b32 v80, 0
  v_mov_b32 v81, 0
  v_mov_b32 v82, 0
  v_mov_b32 v83, 0
  v_mov_b32 v84, 0
  v_mov_b32 v85, 0
  v_mov_b32 v86, 0
  v_mov_b32 v87, 0
  v_mov_b32 v88, 0
  v_mov_b32 v89, 0
  v_mov_b32 v90, 0
  v_mov_b32 v91, 0
  v_mov_b32 v92, 0
  v_mov_b32 v93, 0
  v_mov_b32 v94, 0
  v_mov_b32 v95, 0
  v_mov_b32 v96, 0
  v_mov_b32 v97, 0
  v_mov_b32 v98, 0
  v_mov_b32 v99, 0
  v_mov_b32 v144, 0
  v_mov_b32 v145, 0
  v_mov_b32 v146, 0
  v_mov_b32 v147, 0
  v_mov_b32 v148, 0
  v_mov_b32 v149, 0
  v_mov_b32 v150, 0
  v_mov_b32 v151, 0
  v_mov_b32 v152, 0
  v_mov_b32 v153, 0
  v_mov_b32 v154, 0
  v_mov_b32 v155, 0
  v_mov_b32 v156, 0
  v_mov_b32 v157, 0
  v_mov_b32 v158, 0
  v_mov_b32 v159, 0
  v_mov_b32 v160, 0
  v_mov_b32 v161, 0
  v_mov_b32 v162, 0
  v_mov_b32 v163, 0
  v_mov_b32 v164, 0
  v_mov_b32 v165, 0
  v_mov_b32 v166, 0
  v_mov_b32 v167, 0
  v_mov_b32 v168, 0
  v_mov_b32 v169, 0
  v_mov_b32 v170, 0
  v_mov_b32 v171, 0
  v_mov_b32 v172, 0
  v_mov_b32 v173, 0
  v_mov_b32 v174, 0
  v_mov_b32 v175, 0
  v_mov_b32 v176, 0
  v_mov_b32 v177, 0
  v_mov_b32 v178, 0
  v_mov_b32 v179, 0
  v_mov_b32 v180, 0
  v_mov_b32 v181, 0
  v_mov_b32 v182, 0
  v_mov_b32 v183, 0
  v_mov_b32 v184, 0
  v_mov_b32 v185, 0
  v_mov_b32 v186, 0
  v_mov_b32 v187, 0
  v_mov_b32 v188, 0
  v_mov_b32 v189, 0
  v_mov_b32 v190, 0
  v_mov_b32 v191, 0
  v_mov_b32 v192, 0
  v_mov_b32 v193, 0
  v_mov_b32 v194, 0
  v_mov_b32 v195, 0
  v_mov_b32 v196, 0
  v_mov_b32 v197, 0
  v_mov_b32 v198, 0
  v_mov_b32 v199, 0
  v_mov_b32 v200, 0
  v_mov_b32 v201, 0
  v_mov_b32 v202, 0
  v_mov_b32 v203, 0
  v_mov_b32 v204, 0
  v_mov_b32 v205, 0
  v_mov_b32 v206, 0
  v_mov_b32 v207, 0
  v_mov_b32 v208, 0
  v_mov_b32 v209, 0
  v_mov_b32 v210, 0
  v_mov_b32 v211, 0
  v_mov_b32 v212, 0
  v_mov_b32 v213, 0
  v_mov_b32 v214, 0
  v_mov_b32 v215, 0
  v_mov_b32 v216, 0
  v_mov_b32 v217, 0
  v_mov_b32 v218, 0
  v_mov_b32 v219, 0
  v_mov_b32 v220, 0
  v_mov_b32 v221, 0
  v_mov_b32 v222, 0
  v_mov_b32 v223, 0
  s_cmp_eq_u32 s63, 0
  s_cbranch_scc1 Lsa14
  s_waitcnt vmcnt(0)
  v_lshlrev_b32 v142, 16, v100
  v_and_b32 v143, 0xffff0000, v100
  v_pk_add_f32 v[132:133], v[132:133], v[142:143]
  v_lshlrev_b32 v142, 16, v101
  v_and_b32 v143, 0xffff0000, v101
  v_pk_add_f32 v[134:135], v[134:135], v[142:143]
  v_lshlrev_b32 v142, 16, v102
  v_and_b32 v143, 0xffff0000, v102
  v_pk_add_f32 v[136:137], v[136:137], v[142:143]
  v_lshlrev_b32 v142, 16, v103
  v_and_b32 v143, 0xffff0000, v103
  v_pk_add_f32 v[138:139], v[138:139], v[142:143]
  v_lshlrev_b32 v142, 16, v104
  v_and_b32 v143, 0xffff0000, v104
  v_pk_add_f32 v[132:133], v[132:133], v[142:143]
  v_lshlrev_b32 v142, 16, v105
  v_and_b32 v143, 0xffff0000, v105
  v_pk_add_f32 v[134:135], v[134:135], v[142:143]
  v_lshlrev_b32 v142, 16, v106
  v_and_b32 v143, 0xffff0000, v106
  v_pk_add_f32 v[136:137], v[136:137], v[142:143]
  v_lshlrev_b32 v142, 16, v107
  v_and_b32 v143, 0xffff0000, v107
  v_pk_add_f32 v[138:139], v[138:139], v[142:143]
  v_lshlrev_b32 v142, 16, v108
  v_and_b32 v143, 0xffff0000, v108
  v_pk_add_f32 v[132:133], v[132:133], v[142:143]
  v_lshlrev_b32 v142, 16, v109
  v_and_b32 v143, 0xffff0000, v109
  v_pk_add_f32 v[134:135], v[134:135], v[142:143]
  v_lshlrev_b32 v142, 16, v110
  v_and_b32 v143, 0xffff0000, v110
  v_pk_add_f32 v[136:137], v[136:137], v[142:143]
  v_lshlrev_b32 v142, 16, v111
  v_and_b32 v143, 0xffff0000, v111
  v_pk_add_f32 v[138:139], v[138:139], v[142:143]
  v_lshlrev_b32 v142, 16, v112
  v_and_b32 v143, 0xffff0000, v112
  v_pk_add_f32 v[132:133], v[132:133], v[142:143]
  v_lshlrev_b32 v142, 16, v113
  v_and_b32 v143, 0xffff0000, v113
  v_pk_add_f32 v[134:135], v[134:135], v[142:143]
  v_lshlrev_b32 v142, 16, v114
  v_and_b32 v143, 0xffff0000, v114
  v_pk_add_f32 v[136:137], v[136:137], v[142:143]
  v_lshlrev_b32 v142, 16, v115
  v_and_b32 v143, 0xffff0000, v115
  v_pk_add_f32 v[138:139], v[138:139], v[142:143]
  v_lshlrev_b32 v142, 16, v116
  v_and_b32 v143, 0xffff0000, v116
  v_pk_add_f32 v[132:133], v[132:133], v[142:143]
  v_lshlrev_b32 v142, 16, v117
  v_and_b32 v143, 0xffff0000, v117
  v_pk_add_f32 v[134:135], v[134:135], v[142:143]
  v_lshlrev_b32 v142, 16, v118
  v_and_b32 v143, 0xffff0000, v118
  v_pk_add_f32 v[136:137], v[136:137], v[142:143]
  v_lshlrev_b32 v142, 16, v119
  v_and_b32 v143, 0xffff0000, v119
  v_pk_add_f32 v[138:139], v[138:139], v[142:143]
  v_lshlrev_b32 v142, 16, v120
  v_and_b32 v143, 0xffff0000, v120
  v_pk_add_f32 v[132:133], v[132:133], v[142:143]
  v_lshlrev_b32 v142, 16, v121
  v_and_b32 v143, 0xffff0000, v121
  v_pk_add_f32 v[134:135], v[134:135], v[142:143]
  v_lshlrev_b32 v142, 16, v122
  v_and_b32 v143, 0xffff0000, v122
  v_pk_add_f32 v[136:137], v[136:137], v[142:143]
  v_lshlrev_b32 v142, 16, v123
  v_and_b32 v143, 0xffff0000, v123
  v_pk_add_f32 v[138:139], v[138:139], v[142:143]
  v_lshlrev_b32 v142, 16, v124
  v_and_b32 v143, 0xffff0000, v124
  v_pk_add_f32 v[132:133], v[132:133], v[142:143]
  v_lshlrev_b32 v142, 16, v125
  v_and_b32 v143, 0xffff0000, v125
  v_pk_add_f32 v[134:135], v[134:135], v[142:143]
  v_lshlrev_b32 v142, 16, v126
  v_and_b32 v143, 0xffff0000, v126
  v_pk_add_f32 v[136:137], v[136:137], v[142:143]
  v_lshlrev_b32 v142, 16, v127
  v_and_b32 v143, 0xffff0000, v127
  v_pk_add_f32 v[138:139], v[138:139], v[142:143]
  v_lshlrev_b32 v142, 16, v128
  v_and_b32 v143, 0xffff0000, v128
  v_pk_add_f32 v[132:133], v[132:133], v[142:143]
  v_lshlrev_b32 v142, 16, v129
  v_and_b32 v143, 0xffff0000, v129
  v_pk_add_f32 v[134:135], v[134:135], v[142:143]
  v_lshlrev_b32 v142, 16, v130
  v_and_b32 v143, 0xffff0000, v130
  v_pk_add_f32 v[136:137], v[136:137], v[142:143]
  v_lshlrev_b32 v142, 16, v131
  v_and_b32 v143, 0xffff0000, v131
  v_pk_add_f32 v[138:139], v[138:139], v[142:143]
  v_mov_b32 v100, v132
  v_mov_b32 v101, v133
  v_mov_b32 v102, v134
  v_mov_b32 v103, v135
  v_mov_b32 v104, v136
  v_mov_b32 v105, v137
  v_mov_b32 v106, v138
  v_mov_b32 v107, v139
  v_permlane32_swap_b32 v132, v100
  v_permlane32_swap_b32 v133, v101
  v_permlane32_swap_b32 v134, v102
  v_permlane32_swap_b32 v135, v103
  v_permlane32_swap_b32 v136, v104
  v_permlane32_swap_b32 v137, v105
  v_permlane32_swap_b32 v138, v106
  v_permlane32_swap_b32 v139, v107
  v_add_f32 v132, v132, v100
  v_add_f32 v133, v133, v101
  v_add_f32 v134, v134, v102
  v_add_f32 v135, v135, v103
  v_add_f32 v136, v136, v104
  v_add_f32 v137, v137, v105
  v_add_f32 v138, v138, v106
  v_add_f32 v139, v139, v107
  v_mov_b32 v100, v132
  v_mov_b32 v101, v133
  v_mov_b32 v102, v134
  v_mov_b32 v103, v135
  v_mov_b32 v104, v136
  v_mov_b32 v105, v137
  v_mov_b32 v106, v138
  v_mov_b32 v107, v139
  v_permlane16_swap_b32 v132, v100
  v_permlane16_swap_b32 v133, v101
  v_permlane16_swap_b32 v134, v102
  v_permlane16_swap_b32 v135, v103
  v_permlane16_swap_b32 v136, v104
  v_permlane16_swap_b32 v137, v105
  v_permlane16_swap_b32 v138, v106
  v_permlane16_swap_b32 v139, v107
  v_add_f32 v132, v132, v100
  v_add_f32 v133, v133, v101
  v_add_f32 v134, v134, v102
  v_add_f32 v135, v135, v103
  v_add_f32 v136, v136, v104
  v_add_f32 v137, v137, v105
  v_add_f32 v138, v138, v106
  v_add_f32 v139, v139, v107
  v_and_b32 v100, 7, v253
  s_lshl_b32 s43, s40, 8
  s_add_u32 s43, s43, 143360
  v_add_f32_dpp v132, v132, v132 row_ror:8 row_mask:0xf bank_mask:0xf
  v_add_f32_dpp v133, v133, v133 row_ror:8 row_mask:0xf bank_mask:0xf
  v_add_f32_dpp v134, v134, v134 row_ror:8 row_mask:0xf bank_mask:0xf
  v_add_f32_dpp v135, v135, v135 row_ror:8 row_mask:0xf bank_mask:0xf
  v_add_f32_dpp v136, v136, v136 row_ror:8 row_mask:0xf bank_mask:0xf
  v_add_f32_dpp v137, v137, v137 row_ror:8 row_mask:0xf bank_mask:0xf
  v_add_f32_dpp v138, v138, v138 row_ror:8 row_mask:0xf bank_mask:0xf
  v_add_f32_dpp v139, v139, v139 row_ror:8 row_mask:0xf bank_mask:0xf
  v_lshl_add_u32 v100, v100, 5, s43
  ds_write_b128 v100, v[132:135]
  ds_write_b128 v100, v[136:139] offset:16
Lsa14:
  v_mov_b32 v100, 0
  v_mov_b32 v101, 0
  v_mov_b32 v102, 0
  v_mov_b32 v103, 0
  v_mov_b32 v104, 0
  v_mov_b32 v105, 0
  v_mov_b32 v106, 0
  v_mov_b32 v107, 0
  v_mov_b32 v108, 0
  v_mov_b32 v109, 0
  v_mov_b32 v110, 0
  v_mov_b32 v111, 0
  v_mov_b32 v112, 0
  v_mov_b32 v113, 0
  v_mov_b32 v114, 0
  v_mov_b32 v115, 0
  v_mov_b32 v116, 0
  v_mov_b32 v117, 0
  v_mov_b32 v118, 0
  v_mov_b32 v119, 0
  v_mov_b32 v120, 0
  v_mov_b32 v121, 0
  v_mov_b32 v122, 0
  v_mov_b32 v123, 0
  v_mov_b32 v124, 0
  v_mov_b32 v125, 0
  v_mov_b32 v126, 0
  v_mov_b32 v127, 0
  v_mov_b32 v128, 0
  v_mov_b32 v129, 0
  v_mov_b32 v130, 0
  v_mov_b32 v131, 0
  v_mov_b32 v132, 0
  v_mov_b32 v133, 0
  v_mov_b32 v134, 0
  v_mov_b32 v135, 0
  v_mov_b32 v136, 0
  v_mov_b32 v137, 0
  v_mov_b32 v138, 0
  v_mov_b32 v139, 0
  v_mov_b32 v140, 0
  v_mov_b32 v141, 0
  v_mov_b32 v142, 0
  v_mov_b32 v143, 0
  s_lshl_b32 s77, s54, 7
  s_add_u32 s77, s77, s42
  s_add_u32 s77, s77, 27789312
  s_cmp_lg_u32 s40, 0
  s_cbranch_scc1 Lpdn16
  s_mov_b32 s43, 0x40000
  s_mov_b64 exec, 1
Lpol15:
  buffer_load_dword v250, v251, s[4:7], s77 offen sc1
  s_waitcnt vmcnt(0)
  v_cmp_gt_u32 vcc, 32, v250
  s_cbranch_vccz Lpdn16
  s_sub_u32 s43, s43, 1
  s_cmp_lg_u32 s43, 0
  s_cbranch_scc1 Lpol15
Lpdn16:
  s_mov_b64 exec, -1
  s_waitcnt vmcnt(0) lgkmcnt(0)
  s_barrier
  buffer_load_dwordx4 a[0:3], v235, s[4:7], s67 offen offset:0 sc1
  buffer_load_dwordx4 a[16:19], v235, s[4:7], s67 offen offset:1024 sc1
  buffer_load_dwordx4 a[4:7], v236, s[4:7], s67 offen offset:0 sc1
  buffer_load_dwordx4 a[20:23], v236, s[4:7], s67 offen offset:1024 sc1
  buffer_load_dwordx4 a[8:11], v237, s[4:7], s67 offen offset:0 sc1
  buffer_load_dwordx4 a[24:27], v237, s[4:7], s67 offen offset:1024 sc1
  buffer_load_dwordx4 a[12:15], v238, s[4:7], s67 offen offset:0 sc1
  buffer_load_dwordx4 a[28:31], v238, s[4:7], s67 offen offset:1024 sc1
  s_cmp_eq_u32 s40, 1
  s_cselect_b32 s63, s63, 0
  s_cmp_eq_u32 s63, 0
  s_cbranch_scc1 Lcf17
  v_lshlrev_b32 v240, 2, v253
  v_add_u32 v241, 143360, v240
  ds_read_b32 v242, v241 offset:0
  ds_read_b32 v243, v241 offset:256
  ds_read_b32 v244, v241 offset:512
  ds_read_b32 v245, v241 offset:768
  s_waitcnt lgkmcnt(0)
  v_add_f32 v242, v242, v243
  v_add_f32 v244, v244, v245
  v_add_f32 v242, v242, v244
  buffer_store_dword v242, v240, s[4:7], s62 offen sc1
  s_waitcnt vmcnt(0)
  v_mov_b32 v250, 1
  s_mov_b64 exec, 1
  buffer_atomic_add v250, v251, s[36:39], 0 offen offset:128 sc1
  s_mov_b64 exec, -1
Lcf17:
  ds_read_b64_tr_b16 a[64:65], v224 offset:0
  ds_read_b64_tr_b16 a[66:67], v224 offset:4096
  ds_read_b64_tr_b16 a[68:69], v224 offset:8192
  ds_read_b64_tr_b16 a[70:71], v224 offset:12288
  ds_read_b64_tr_b16 a[72:73], v224 offset:16384
  ds_read_b64_tr_b16 a[74:75], v224 offset:20480
  ds_read_b64_tr_b16 a[76:77], v224 offset:24576
  ds_read_b64_tr_b16 a[78:79], v224 offset:28672
  s_waitcnt vmcnt(0)
  s_mov_b32 s56, 7
.p2align 3
Lp3_loop:
  s_waitcnt vmcnt(8) lgkmcnt(4)
  v_mfma_f32_16x16x32_bf16 v[0:3], a[64:67], a[0:3], v[0:3]
  ds_read_b64_tr_b16 a[80:81], v225 offset:0
  v_mfma_f32_16x16x32_bf16 v[0:3], a[68:71], a[16:19], v[0:3]
  v_mfma_f32_16x16x32_bf16 v[4:7], a[68:71], a[20:23], v[4:7]
  ds_read_b64_tr_b16 a[82:83], v225 offset:4096
  v_mfma_f32_16x16x32_bf16 v[4:7], a[64:67], a[4:7], v[4:7]
  buffer_load_dwordx4 a[32:35], v235, s[4:7], s67 offen offset:2048 sc1
  v_mfma_f32_16x16x32_bf16 v[8:11], a[64:67], a[8:11], v[8:11]
  ds_read_b64_tr_b16 a[84:85], v225 offset:8192
  v_mfma_f32_16x16x32_bf16 v[8:11], a[68:71], a[24:27], v[8:11]
  v_mfma_f32_16x16x32_bf16 v[12:15], a[68:71], a[28:31], v[12:15]
  ds_read_b64_tr_b16 a[86:87], v225 offset:12288
  v_mfma_f32_16x16x32_bf16 v[12:15], a[64:67], a[12:15], v[12:15]
  s_waitcnt lgkmcnt(4)
  v_mfma_f32_16x16x32_bf16 v[28:31], a[72:75], a[12:15], v[28:31]
  ds_read_b64_tr_b16 a[88:89], v225 offset:16384
  v_mfma_f32_16x16x32_bf16 v[28:31], a[76:79], a[28:31], v[28:31]
  v_mfma_f32_16x16x32_bf16 v[24:27], a[76:79], a[24:27], v[24:27]
  ds_read_b64_tr_b16 a[90:91], v225 offset:20480
  buffer_load_dwordx4 a[48:51], v235, s[4:7], s67 offen offset:3072 sc1
  v_mfma_f32_16x16x32_bf16 v[24:27], a[72:75], a[8:11], v[24:27]
  v_mfma_f32_16x16x32_bf16 v[20:23], a[72:75], a[4:7], v[20:23]
  ds_read_b64_tr_b16 a[92:93], v225 offset:24576
  v_mfma_f32_16x16x32_bf16 v[20:23], a[76:79], a[20:23], v[20:23]
  v_mfma_f32_16x16x32_bf16 v[16:19], a[76:79], a[16:19], v[16:19]
  ds_read_b64_tr_b16 a[94:95], v225 offset:28672
  v_mfma_f32_16x16x32_bf16 v[16:19], a[72:75], a[0:3], v[16:19]
  s_waitcnt lgkmcnt(4)
  v_mfma_f32_16x16x32_bf16 v[32:35], a[80:83], a[0:3], v[32:35]
  ds_read_b64_tr_b16 a[64:65], v226 offset:0
  v_mfma_f32_16x16x32_bf16 v[32:35], a[84:87], a[16:19], v[32:35]
  buffer_load_dwordx4 a[36:39], v236, s[4:7], s67 offen offset:2048 sc1
  v_mfma_f32_16x16x32_bf16 v[36:39], a[84:87], a[20:23], v[36:39]
  ds_read_b64_tr_b16 a[66:67], v226 offset:4096
  v_mfma_f32_16x16x32_bf16 v[36:39], a[80:83], a[4:7], v[36:39]
  v_mfma_f32_16x16x32_bf16 v[40:43], a[80:83], a[8:11], v[40:43]
  ds_read_b64_tr_b16 a[68:69], v226 offset:8192
  v_mfma_f32_16x16x32_bf16 v[40:43], a[84:87], a[24:27], v[40:43]
  v_mfma_f32_16x16x32_bf16 v[44:47], a[84:87], a[28:31], v[44:47]
  ds_read_b64_tr_b16 a[70:71], v226 offset:12288
  v_mfma_f32_16x16x32_bf16 v[44:47], a[80:83], a[12:15], v[44:47]
  s_waitcnt lgkmcnt(4)
  v_mfma_f32_16x16x32_bf16 v[60:63], a[88:91], a[12:15], v[60:63]
  ds_read_b64_tr_b16 a[72:73], v226 offset:16384
  buffer_load_dwordx4 a[52:55], v236, s[4:7], s67 offen offset:3072 sc1
  v_mfma_f32_16x16x32_bf16 v[60:63], a[92:95], a[28:31], v[60:63]
  v_mfma_f32_16x16x32_bf16 v[56:59], a[92:95], a[24:27], v[56:59]
  ds_read_b64_tr_b16 a[74:75], v226 offset:20480
  v_mfma_f32_16x16x32_bf16 v[56:59], a[88:91], a[8:11], v[56:59]
  v_mfma_f32_16x16x32_bf16 v[52:55], a[88:91], a[4:7], v[52:55]
  ds_read_b64_tr_b16 a[76:77], v226 offset:24576
  v_mfma_f32_16x16x32_bf16 v[52:55], a[92:95], a[20:23], v[52:55]
  v_mfma_f32_16x16x32_bf16 v[48:51], a[92:95], a[16:19], v[48:51]
  ds_read_b64_tr_b16 a[78:79], v226 offset:28672
  v_mfma_f32_16x16x32_bf16 v[48:51], a[88:91], a[0:3], v[48:51]
  buffer_load_dwordx4 a[40:43], v237, s[4:7], s67 offen offset:2048 sc1
  s_waitcnt lgkmcnt(4)
  v_mfma_f32_16x16x32_bf16 v[64:67], a[64:67], a[0:3], v[64:67]
  ds_read_b64_tr_b16 a[80:81], v227 offset:0
  v_mfma_f32_16x16x32_bf16 v[64:67], a[68:71], a[16:19], v[64:67]
  v_mfma_f32_16x16x32_bf16 v[68:71], a[68:71], a[20:23], v[68:71]
  ds_read_b64_tr_b16 a[82:83], v227 offset:4096
  v_mfma_f32_16x16x32_bf16 v[68:71], a[64:67], a[4:7], v[68:71]
  v_mfma_f32_16x16x32_bf16 v[72:75], a[64:67], a[8:11], v[72:75]
  ds_read_b64_tr_b16 a[84:85], v227 offset:8192
  v_mfma_f32_16x16x32_bf16 v[72:75], a[68:71], a[24:27], v[72:75]
  v_mfma_f32_16x16x32_bf16 v[76:79], a[68:71], a[28:31], v[76:79]
  ds_read_b64_tr_b16 a[86:87], v227 offset:12288
  buffer_load_dwordx4 a[56:59], v237, s[4:7], s67 offen offset:3072 sc1
  v_mfma_f32_16x16x32_bf16 v[76:79], a[64:67], a[12:15], v[76:79]
  s_waitcnt lgkmcnt(4)
  v_mfma_f32_16x16x32_bf16 v[92:95], a[72:75], a[12:15], v[92:95]
  ds_read_b64_tr_b16 a[88:89], v227 offset:16384
  v_mfma_f32_16x16x32_bf16 v[92:95], a[76:79], a[28:31], v[92:95]
  v_mfma_f32_16x16x32_bf16 v[88:91], a[76:79], a[24:27], v[88:91]
  ds_read_b64_tr_b16 a[90:91], v227 offset:20480
  v_mfma_f32_16x16x32_bf16 v[88:91], a[72:75], a[8:11], v[88:91]
  v_mfma_f32_16x16x32_bf16 v[84:87], a[72:75], a[4:7], v[84:87]
  ds_read_b64_tr_b16 a[92:93], v227 offset:24576
  v_mfma_f32_16x16x32_bf16 v[84:87], a[76:79], a[20:23], v[84:87]
  buffer_load_dwordx4 a[44:47], v238, s[4:7], s67 offen offset:2048 sc1
  v_mfma_f32_16x16x32_bf16 v[80:83], a[76:79], a[16:19], v[80:83]
  ds_read_b64_tr_b16 a[94:95], v227 offset:28672
  v_mfma_f32_16x16x32_bf16 v[80:83], a[72:75], a[0:3], v[80:83]
  s_waitcnt lgkmcnt(4)
  v_mfma_f32_16x16x32_bf16 v[96:99], a[80:83], a[0:3], v[96:99]
  ds_read_b64_tr_b16 a[64:65], v228 offset:0
  v_mfma_f32_16x16x32_bf16 v[96:99], a[84:87], a[16:19], v[96:99]
  v_mfma_f32_16x16x32_bf16 v[100:103], a[84:87], a[20:23], v[100:103]
  ds_read_b64_tr_b16 a[66:67], v228 offset:4096
  v_mfma_f32_16x16x32_bf16 v[100:103], a[80:83], a[4:7], v[100:103]
  v_mfma_f32_16x16x32_bf16 v[104:107], a[80:83], a[8:11], v[104:107]
  ds_read_b64_tr_b16 a[68:69], v228 offset:8192
  buffer_load_dwordx4 a[60:63], v238, s[4:7], s67 offen offset:3072 sc1
  v_mfma_f32_16x16x32_bf16 v[104:107], a[84:87], a[24:27], v[104:107]
  s_add_u32 s67, s67, 4096
  v_mfma_f32_16x16x32_bf16 v[108:111], a[84:87], a[28:31], v[108:111]
  ds_read_b64_tr_b16 a[70:71], v228 offset:12288
  v_mfma_f32_16x16x32_bf16 v[108:111], a[80:83], a[12:15], v[108:111]
  buffer_load_dwordx4 a[96:99], v239, s[24:27], s71 offen
  s_waitcnt lgkmcnt(4)
  v_mfma_f32_16x16x32_bf16 v[124:127], a[88:91], a[12:15], v[124:127]
  ds_read_b64_tr_b16 a[72:73], v228 offset:16384
  s_add_u32 s71, s71, 1024
  v_mfma_f32_16x16x32_bf16 v[124:127], a[92:95], a[28:31], v[124:127]
  v_mfma_f32_16x16x32_bf16 v[120:123], a[92:95], a[24:27], v[120:123]
  ds_read_b64_tr_b16 a[74:75], v228 offset:20480
  s_add_u32 m0, s69, 0
  v_mfma_f32_16x16x32_bf16 v[120:123], a[88:91], a[8:11], v[120:123]
  buffer_load_dwordx4 v231, s[16:19], s68 offen offset:0 lds
  v_mfma_f32_16x16x32_bf16 v[116:119], a[88:91], a[4:7], v[116:119]
  ds_read_b64_tr_b16 a[76:77], v228 offset:24576
  v_mfma_f32_16x16x32_bf16 v[116:119], a[92:95], a[20:23], v[116:119]
  v_mfma_f32_16x16x32_bf16 v[112:115], a[92:95], a[16:19], v[112:115]
  ds_read_b64_tr_b16 a[78:79], v228 offset:28672
  v_mfma_f32_16x16x32_bf16 v[112:115], a[88:91], a[0:3], v[112:115]
  s_waitcnt lgkmcnt(4)
  v_mfma_f32_16x16x32_bf16 v[128:131], a[64:67], a[0:3], v[128:131]
  ds_read_b64_tr_b16 a[80:81], v229 offset:0
  v_mfma_f32_16x16x32_bf16 v[128:131], a[68:71], a[16:19], v[128:131]
  v_mfma_f32_16x16x32_bf16 v[132:135], a[68:71], a[20:23], v[132:135]
  ds_read_b64_tr_b16 a[82:83], v229 offset:4096
  buffer_load_dwordx4 v232, s[16:19], s68 offen offset:1024 lds
  v_mfma_f32_16x16x32_bf16 v[132:135], a[64:67], a[4:7], v[132:135]
  v_mfma_f32_16x16x32_bf16 v[136:139], a[64:67], a[8:11], v[136:139]
  ds_read_b64_tr_b16 a[84:85], v229 offset:8192
  v_mfma_f32_16x16x32_bf16 v[136:139], a[68:71], a[24:27], v[136:139]
  v_mfma_f32_16x16x32_bf16 v[140:143], a[68:71], a[28:31], v[140:143]
  ds_read_b64_tr_b16 a[86:87], v229 offset:12288
  v_mfma_f32_16x16x32_bf16 v[140:143], a[64:67], a[12:15], v[140:143]
  s_waitcnt lgkmcnt(4)
  v_mfma_f32_16x16x32_bf16 v[156:159], a[72:75], a[12:15], v[156:159]
  ds_read_b64_tr_b16 a[88:89], v229 offset:16384
  v_mfma_f32_16x16x32_bf16 v[156:159], a[76:79], a[28:31], v[156:159]
  buffer_load_dwordx4 v233, s[16:19], s68 offen offset:2048 lds
  v_mfma_f32_16x16x32_bf16 v[152:155], a[76:79], a[24:27], v[152:155]
  ds_read_b64_tr_b16 a[90:91], v229 offset:20480
  v_mfma_f32_16x16x32_bf16 v[152:155], a[72:75], a[8:11], v[152:155]
  v_mfma_f32_16x16x32_bf16 v[148:151], a[72:75], a[4:7], v[148:151]
  ds_read_b64_tr_b16 a[92:93], v229 offset:24576
  v_mfma_f32_16x16x32_bf16 v[148:151], a[76:79], a[20:23], v[148:151]
  v_mfma_f32_16x16x32_bf16 v[144:147], a[76:79], a[16:19], v[144:147]
  ds_read_b64_tr_b16 a[94:95], v229 offset:28672
  v_mfma_f32_16x16x32_bf16 v[144:147], a[72:75], a[0:3], v[144:147]
  s_waitcnt lgkmcnt(4)
  v_mfma_f32_16x16x32_bf16 v[160:163], a[80:83], a[0:3], v[160:163]
  ds_read_b64_tr_b16 a[64:65], v230 offset:0
  buffer_load_dwordx4 v234, s[16:19], s68 offen offset:3072 lds
  v_mfma_f32_16x16x32_bf16 v[160:163], a[84:87], a[16:19], v[160:163]
  v_mfma_f32_16x16x32_bf16 v[164:167], a[84:87], a[20:23], v[164:167]
  ds_read_b64_tr_b16 a[66:67], v230 offset:4096
  v_mfma_f32_16x16x32_bf16 v[164:167], a[80:83], a[4:7], v[164:167]
  v_mfma_f32_16x16x32_bf16 v[168:171], a[80:83], a[8:11], v[168:171]
  ds_read_b64_tr_b16 a[68:69], v230 offset:8192
  v_mfma_f32_16x16x32_bf16 v[168:171], a[84:87], a[24:27], v[168:171]
  v_mfma_f32_16x16x32_bf16 v[172:175], a[84:87], a[28:31], v[172:175]
  ds_read_b64_tr_b16 a[70:71], v230 offset:12288
  s_add_u32 m0, s69, 16384
  v_mfma_f32_16x16x32_bf16 v[172:175], a[80:83], a[12:15], v[172:175]
  buffer_load_dwordx4 v231, s[20:23], s68 offen offset:0 lds
  s_waitcnt lgkmcnt(4)
  v_mfma_f32_16x16x32_bf16 v[188:191], a[88:91], a[12:15], v[188:191]
  ds_read_b64_tr_b16 a[72:73], v230 offset:16384
  v_mfma_f32_16x16x32_bf16 v[188:191], a[92:95], a[28:31], v[188:191]
  v_mfma_f32_16x16x32_bf16 v[184:187], a[92:95], a[24:27], v[184:187]
  ds_read_b64_tr_b16 a[74:75], v230 offset:20480
  v_mfma_f32_16x16x32_bf16 v[184:187], a[88:91], a[8:11], v[184:187]
  v_mfma_f32_16x16x32_bf16 v[180:183], a[88:91], a[4:7], v[180:183]
  ds_read_b64_tr_b16 a[76:77], v230 offset:24576
  v_mfma_f32_16x16x32_bf16 v[180:183], a[92:95], a[20:23], v[180:183]
  v_mfma_f32_16x16x32_bf16 v[176:179], a[92:95], a[16:19], v[176:179]
  ds_read_b64_tr_b16 a[78:79], v230 offset:28672
  buffer_load_dwordx4 v232, s[20:23], s68 offen offset:1024 lds
  v_mfma_f32_16x16x32_bf16 v[176:179], a[88:91], a[0:3], v[176:179]
  s_waitcnt lgkmcnt(4)
  v_mfma_f32_16x16x32_bf16 v[192:195], a[64:67], a[0:3], v[192:195]
  s_waitcnt vmcnt(15)
  s_barrier
  ds_read_b64_tr_b16 a[80:81], v224 offset:32768
  v_mfma_f32_16x16x32_bf16 v[192:195], a[68:71], a[16:19], v[192:195]
  v_mfma_f32_16x16x32_bf16 v[196:199], a[68:71], a[20:23], v[196:199]
  ds_read_b64_tr_b16 a[82:83], v224 offset:36864
  v_mfma_f32_16x16x32_bf16 v[196:199], a[64:67], a[4:7], v[196:199]
  v_mfma_f32_16x16x32_bf16 v[200:203], a[64:67], a[8:11], v[200:203]
  ds_read_b64_tr_b16 a[84:85], v224 offset:40960
  v_mfma_f32_16x16x32_bf16 v[200:203], a[68:71], a[24:27], v[200:203]
  buffer_load_dwordx4 v233, s[20:23], s68 offen offset:2048 lds
  v_mfma_f32_16x16x32_bf16 v[204:207], a[68:71], a[28:31], v[204:207]
  ds_read_b64_tr_b16 a[86:87], v224 offset:45056
  v_mfma_f32_16x16x32_bf16 v[204:207], a[64:67], a[12:15], v[204:207]
  s_waitcnt lgkmcnt(4)
  v_mfma_f32_16x16x32_bf16 v[220:223], a[72:75], a[12:15], v[220:223]
  ds_read_b64_tr_b16 a[88:89], v224 offset:49152
  v_mfma_f32_16x16x32_bf16 v[220:223], a[76:79], a[28:31], v[220:223]
  v_mfma_f32_16x16x32_bf16 v[216:219], a[76:79], a[24:27], v[216:219]
  ds_read_b64_tr_b16 a[90:91], v224 offset:53248
  v_mfma_f32_16x16x32_bf16 v[216:219], a[72:75], a[8:11], v[216:219]
  v_mfma_f32_16x16x32_bf16 v[212:215], a[72:75], a[4:7], v[212:215]
  ds_read_b64_tr_b16 a[92:93], v224 offset:57344
  buffer_load_dwordx4 v234, s[20:23], s68 offen offset:3072 lds
  v_mfma_f32_16x16x32_bf16 v[212:215], a[76:79], a[20:23], v[212:215]
  s_add_u32 s68, s68, 458752
  v_mfma_f32_16x16x32_bf16 v[208:211], a[76:79], a[16:19], v[208:211]
  ds_read_b64_tr_b16 a[94:95], v224 offset:61440
  v_xor_b32 v224, 0x10000, v224
  v_mfma_f32_16x16x32_bf16 v[208:211], a[72:75], a[0:3], v[208:211]
  s_waitcnt vmcnt(9) lgkmcnt(4)
  v_mfma_f32_16x16x32_bf16 v[0:3], a[80:83], a[32:35], v[0:3]
  ds_read_b64_tr_b16 a[64:65], v225 offset:32768
  v_mfma_f32_16x16x32_bf16 v[0:3], a[84:87], a[48:51], v[0:3]
  v_mfma_f32_16x16x32_bf16 v[4:7], a[84:87], a[52:55], v[4:7]
  ds_read_b64_tr_b16 a[66:67], v225 offset:36864
  v_mfma_f32_16x16x32_bf16 v[4:7], a[80:83], a[36:39], v[4:7]
  buffer_load_dwordx4 a[0:3], v235, s[4:7], s67 offen offset:0 sc1
  v_mfma_f32_16x16x32_bf16 v[8:11], a[80:83], a[40:43], v[8:11]
  ds_read_b64_tr_b16 a[68:69], v225 offset:40960
  v_mfma_f32_16x16x32_bf16 v[8:11], a[84:87], a[56:59], v[8:11]
  v_mfma_f32_16x16x32_bf16 v[12:15], a[84:87], a[60:63], v[12:15]
  ds_read_b64_tr_b16 a[70:71], v225 offset:45056
  v_mfma_f32_16x16x32_bf16 v[12:15], a[80:83], a[44:47], v[12:15]
  s_waitcnt lgkmcnt(4)
  v_mfma_f32_16x16x32_bf16 v[28:31], a[88:91], a[44:47], v[28:31]
  ds_read_b64_tr_b16 a[72:73], v225 offset:49152
  v_mfma_f32_16x16x32_bf16 v[28:31], a[92:95], a[60:63], v[28:31]
  v_mfma_f32_16x16x32_bf16 v[24:27], a[92:95], a[56:59], v[24:27]
  ds_read_b64_tr_b16 a[74:75], v225 offset:53248
  buffer_load_dwordx4 a[16:19], v235, s[4:7], s67 offen offset:1024 sc1
  v_mfma_f32_16x16x32_bf16 v[24:27], a[88:91], a[40:43], v[24:27]
  v_mfma_f32_16x16x32_bf16 v[20:23], a[88:91], a[36:39], v[20:23]
  ds_read_b64_tr_b16 a[76:77], v225 offset:57344
  v_mfma_f32_16x16x32_bf16 v[20:23], a[92:95], a[52:55], v[20:23]
  v_mfma_f32_16x16x32_bf16 v[16:19], a[92:95], a[48:51], v[16:19]
  ds_read_b64_tr_b16 a[78:79], v225 offset:61440
  v_xor_b32 v225, 0x10000, v225
  v_mfma_f32_16x16x32_bf16 v[16:19], a[88:91], a[32:35], v[16:19]
  s_waitcnt lgkmcnt(4)
  v_mfma_f32_16x16x32_bf16 v[32:35], a[64:67], a[32:35], v[32:35]
  ds_read_b64_tr_b16 a[80:81], v226 offset:32768
  v_mfma_f32_16x16x32_bf16 v[32:35], a[68:71], a[48:51], v[32:35]
  buffer_load_dwordx4 a[4:7], v236, s[4:7], s67 offen offset:0 sc1
  v_mfma_f32_16x16x32_bf16 v[36:39], a[68:71], a[52:55], v[36:39]
  ds_read_b64_tr_b16 a[82:83], v226 offset:36864
  v_mfma_f32_16x16x32_bf16 v[36:39], a[64:67], a[36:39], v[36:39]
  v_mfma_f32_16x16x32_bf16 v[40:43], a[64:67], a[40:43], v[40:43]
  ds_read_b64_tr_b16 a[84:85], v226 offset:40960
  v_mfma_f32_16x16x32_bf16 v[40:43], a[68:71], a[56:59], v[40:43]
  v_mfma_f32_16x16x32_bf16 v[44:47], a[68:71], a[60:63], v[44:47]
  ds_read_b64_tr_b16 a[86:87], v226 offset:45056
  v_mfma_f32_16x16x32_bf16 v[44:47], a[64:67], a[44:47], v[44:47]
  s_waitcnt lgkmcnt(4)
  v_mfma_f32_16x16x32_bf16 v[60:63], a[72:75], a[44:47], v[60:63]
  ds_read_b64_tr_b16 a[88:89], v226 offset:49152
  buffer_load_dwordx4 a[20:23], v236, s[4:7], s67 offen offset:1024 sc1
  v_mfma_f32_16x16x32_bf16 v[60:63], a[76:79], a[60:63], v[60:63]
  v_mfma_f32_16x16x32_bf16 v[56:59], a[76:79], a[56:59], v[56:59]
  ds_read_b64_tr_b16 a[90:91], v226 offset:53248
  v_mfma_f32_16x16x32_bf16 v[56:59], a[72:75], a[40:43], v[56:59]
  v_mfma_f32_16x16x32_bf16 v[52:55], a[72:75], a[36:39], v[52:55]
  ds_read_b64_tr_b16 a[92:93], v226 offset:57344
  v_mfma_f32_16x16x32_bf16 v[52:55], a[76:79], a[52:55], v[52:55]
  v_mfma_f32_16x16x32_bf16 v[48:51], a[76:79], a[48:51], v[48:51]
  ds_read_b64_tr_b16 a[94:95], v226 offset:61440
  v_xor_b32 v226, 0x10000, v226
  v_mfma_f32_16x16x32_bf16 v[48:51], a[72:75], a[32:35], v[48:51]
  buffer_load_dwordx4 a[8:11], v237, s[4:7], s67 offen offset:0 sc1
  s_waitcnt lgkmcnt(4)
  v_mfma_f32_16x16x32_bf16 v[64:67], a[80:83], a[32:35], v[64:67]
  ds_read_b64_tr_b16 a[64:65], v227 offset:32768
  v_mfma_f32_16x16x32_bf16 v[64:67], a[84:87], a[48:51], v[64:67]
  v_mfma_f32_16x16x32_bf16 v[68:71], a[84:87], a[52:55], v[68:71]
  ds_read_b64_tr_b16 a[66:67], v227 offset:36864
  v_mfma_f32_16x16x32_bf16 v[68:71], a[80:83], a[36:39], v[68:71]
  v_mfma_f32_16x16x32_bf16 v[72:75], a[80:83], a[40:43], v[72:75]
  ds_read_b64_tr_b16 a[68:69], v227 offset:40960
  v_mfma_f32_16x16x32_bf16 v[72:75], a[84:87], a[56:59], v[72:75]
  v_mfma_f32_16x16x32_bf16 v[76:79], a[84:87], a[60:63], v[76:79]
  ds_read_b64_tr_b16 a[70:71], v227 offset:45056
  buffer_load_dwordx4 a[24:27], v237, s[4:7], s67 offen offset:1024 sc1
  v_mfma_f32_16x16x32_bf16 v[76:79], a[80:83], a[44:47], v[76:79]
  s_waitcnt lgkmcnt(4)
  v_mfma_f32_16x16x32_bf16 v[92:95], a[88:91], a[44:47], v[92:95]
  ds_read_b64_tr_b16 a[72:73], v227 offset:49152
  v_mfma_f32_16x16x32_bf16 v[92:95], a[92:95], a[60:63], v[92:95]
  v_mfma_f32_16x16x32_bf16 v[88:91], a[92:95], a[56:59], v[88:91]
  ds_read_b64_tr_b16 a[74:75], v227 offset:53248
  v_mfma_f32_16x16x32_bf16 v[88:91], a[88:91], a[40:43], v[88:91]
  v_mfma_f32_16x16x32_bf16 v[84:87], a[88:91], a[36:39], v[84:87]
  ds_read_b64_tr_b16 a[76:77], v227 offset:57344
  v_mfma_f32_16x16x32_bf16 v[84:87], a[92:95], a[52:55], v[84:87]
  buffer_load_dwordx4 a[12:15], v238, s[4:7], s67 offen offset:0 sc1
  v_mfma_f32_16x16x32_bf16 v[80:83], a[92:95], a[48:51], v[80:83]
  ds_read_b64_tr_b16 a[78:79], v227 offset:61440
  v_xor_b32 v227, 0x10000, v227
  v_mfma_f32_16x16x32_bf16 v[80:83], a[88:91], a[32:35], v[80:83]
  s_waitcnt lgkmcnt(4)
  v_mfma_f32_16x16x32_bf16 v[96:99], a[64:67], a[32:35], v[96:99]
  ds_read_b64_tr_b16 a[80:81], v228 offset:32768
  v_mfma_f32_16x16x32_bf16 v[96:99], a[68:71], a[48:51], v[96:99]
  v_mfma_f32_16x16x32_bf16 v[100:103], a[68:71], a[52:55], v[100:103]
  ds_read_b64_tr_b16 a[82:83], v228 offset:36864
  v_mfma_f32_16x16x32_bf16 v[100:103], a[64:67], a[36:39], v[100:103]
  v_mfma_f32_16x16x32_bf16 v[104:107], a[64:67], a[40:43], v[104:107]
  ds_read_b64_tr_b16 a[84:85], v228 offset:40960
  buffer_load_dwordx4 a[28:31], v238, s[4:7], s67 offen offset:1024 sc1
  v_mfma_f32_16x16x32_bf16 v[104:107], a[68:71], a[56:59], v[104:107]
  v_mfma_f32_16x16x32_bf16 v[108:111], a[68:71], a[60:63], v[108:111]
  ds_read_b64_tr_b16 a[86:87], v228 offset:45056
  v_mfma_f32_16x16x32_bf16 v[108:111], a[64:67], a[44:47], v[108:111]
  s_waitcnt lgkmcnt(4)
  v_mfma_f32_16x16x32_bf16 v[124:127], a[72:75], a[44:47], v[124:127]
  ds_read_b64_tr_b16 a[88:89], v228 offset:49152
  v_mfma_f32_16x16x32_bf16 v[124:127], a[76:79], a[60:63], v[124:127]
  v_mfma_f32_16x16x32_bf16 v[120:123], a[76:79], a[56:59], v[120:123]
  ds_read_b64_tr_b16 a[90:91], v228 offset:53248
  s_add_u32 m0, s69, 32768
  v_mfma_f32_16x16x32_bf16 v[120:123], a[72:75], a[40:43], v[120:123]
  buffer_load_dwordx4 v231, s[16:19], s68 offen offset:0 lds
  v_mfma_f32_16x16x32_bf16 v[116:119], a[72:75], a[36:39], v[116:119]
  ds_read_b64_tr_b16 a[92:93], v228 offset:57344
  v_mfma_f32_16x16x32_bf16 v[116:119], a[76:79], a[52:55], v[116:119]
  v_mfma_f32_16x16x32_bf16 v[112:115], a[76:79], a[48:51], v[112:115]
  ds_read_b64_tr_b16 a[94:95], v228 offset:61440
  v_xor_b32 v228, 0x10000, v228
  v_mfma_f32_16x16x32_bf16 v[112:115], a[72:75], a[32:35], v[112:115]
  s_waitcnt lgkmcnt(4)
  v_mfma_f32_16x16x32_bf16 v[128:131], a[80:83], a[32:35], v[128:131]
  ds_read_b64_tr_b16 a[64:65], v229 offset:32768
  v_mfma_f32_16x16x32_bf16 v[128:131], a[84:87], a[48:51], v[128:131]
  v_mfma_f32_16x16x32_bf16 v[132:135], a[84:87], a[52:55], v[132:135]
  ds_read_b64_tr_b16 a[66:67], v229 offset:36864
  buffer_load_dwordx4 v232, s[16:19], s68 offen offset:1024 lds
  v_mfma_f32_16x16x32_bf16 v[132:135], a[80:83], a[36:39], v[132:135]
  v_mfma_f32_16x16x32_bf16 v[136:139], a[80:83], a[40:43], v[136:139]
  ds_read_b64_tr_b16 a[68:69], v229 offset:40960
  v_mfma_f32_16x16x32_bf16 v[136:139], a[84:87], a[56:59], v[136:139]
  v_mfma_f32_16x16x32_bf16 v[140:143], a[84:87], a[60:63], v[140:143]
  ds_read_b64_tr_b16 a[70:71], v229 offset:45056
  v_mfma_f32_16x16x32_bf16 v[140:143], a[80:83], a[44:47], v[140:143]
  s_waitcnt lgkmcnt(4)
  v_mfma_f32_16x16x32_bf16 v[156:159], a[88:91], a[44:47], v[156:159]
  ds_read_b64_tr_b16 a[72:73], v229 offset:49152
  v_mfma_f32_16x16x32_bf16 v[156:159], a[92:95], a[60:63], v[156:159]
  buffer_load_dwordx4 v233, s[16:19], s68 offen offset:2048 lds
  v_mfma_f32_16x16x32_bf16 v[152:155], a[92:95], a[56:59], v[152:155]
  ds_read_b64_tr_b16 a[74:75], v229 offset:53248
  v_mfma_f32_16x16x32_bf16 v[152:155], a[88:91], a[40:43], v[152:155]
  v_mfma_f32_16x16x32_bf16 v[148:151], a[88:91], a[36:39], v[148:151]
  ds_read_b64_tr_b16 a[76:77], v229 offset:57344
  v_mfma_f32_16x16x32_bf16 v[148:151], a[92:95], a[52:55], v[148:151]
  v_mfma_f32_16x16x32_bf16 v[144:147], a[92:95], a[48:51], v[144:147]
  ds_read_b64_tr_b16 a[78:79], v229 offset:61440
  v_xor_b32 v229, 0x10000, v229
  v_mfma_f32_16x16x32_bf16 v[144:147], a[88:91], a[32:35], v[144:147]
  s_waitcnt lgkmcnt(4)
  v_mfma_f32_16x16x32_bf16 v[160:163], a[64:67], a[32:35], v[160:163]
  ds_read_b64_tr_b16 a[80:81], v230 offset:32768
  buffer_load_dwordx4 v234, s[16:19], s68 offen offset:3072 lds
  v_mfma_f32_16x16x32_bf16 v[160:163], a[68:71], a[48:51], v[160:163]
  v_mfma_f32_16x16x32_bf16 v[164:167], a[68:71], a[52:55], v[164:167]
  ds_read_b64_tr_b16 a[82:83], v230 offset:36864
  v_mfma_f32_16x16x32_bf16 v[164:167], a[64:67], a[36:39], v[164:167]
  v_mfma_f32_16x16x32_bf16 v[168:171], a[64:67], a[40:43], v[168:171]
  ds_read_b64_tr_b16 a[84:85], v230 offset:40960
  v_mfma_f32_16x16x32_bf16 v[168:171], a[68:71], a[56:59], v[168:171]
  v_mfma_f32_16x16x32_bf16 v[172:175], a[68:71], a[60:63], v[172:175]
  ds_read_b64_tr_b16 a[86:87], v230 offset:45056
  s_add_u32 m0, s69, 49152
  v_mfma_f32_16x16x32_bf16 v[172:175], a[64:67], a[44:47], v[172:175]
  buffer_load_dwordx4 v231, s[20:23], s68 offen offset:0 lds
  s_waitcnt lgkmcnt(4)
  v_mfma_f32_16x16x32_bf16 v[188:191], a[72:75], a[44:47], v[188:191]
  ds_read_b64_tr_b16 a[88:89], v230 offset:49152
  v_mfma_f32_16x16x32_bf16 v[188:191], a[76:79], a[60:63], v[188:191]
  v_mfma_f32_16x16x32_bf16 v[184:187], a[76:79], a[56:59], v[184:187]
  ds_read_b64_tr_b16 a[90:91], v230 offset:53248
  v_mfma_f32_16x16x32_bf16 v[184:187], a[72:75], a[40:43], v[184:187]
  v_mfma_f32_16x16x32_bf16 v[180:183], a[72:75], a[36:39], v[180:183]
  ds_read_b64_tr_b16 a[92:93], v230 offset:57344
  v_mfma_f32_16x16x32_bf16 v[180:183], a[76:79], a[52:55], v[180:183]
  v_mfma_f32_16x16x32_bf16 v[176:179], a[76:79], a[48:51], v[176:179]
  ds_read_b64_tr_b16 a[94:95], v230 offset:61440
  v_xor_b32 v230, 0x10000, v230
  buffer_load_dwordx4 v232, s[20:23], s68 offen offset:1024 lds
  v_mfma_f32_16x16x32_bf16 v[176:179], a[72:75], a[32:35], v[176:179]
  s_waitcnt lgkmcnt(4)
  v_mfma_f32_16x16x32_bf16 v[192:195], a[80:83], a[32:35], v[192:195]
  s_waitcnt vmcnt(14)
  s_barrier
  ds_read_b64_tr_b16 a[64:65], v224 offset:0
  v_mfma_f32_16x16x32_bf16 v[192:195], a[84:87], a[48:51], v[192:195]
  v_mfma_f32_16x16x32_bf16 v[196:199], a[84:87], a[52:55], v[196:199]
  ds_read_b64_tr_b16 a[66:67], v224 offset:4096
  v_mfma_f32_16x16x32_bf16 v[196:199], a[80:83], a[36:39], v[196:199]
  v_mfma_f32_16x16x32_bf16 v[200:203], a[80:83], a[40:43], v[200:203]
  ds_read_b64_tr_b16 a[68:69], v224 offset:8192
  v_mfma_f32_16x16x32_bf16 v[200:203], a[84:87], a[56:59], v[200:203]
  buffer_load_dwordx4 v233, s[20:23], s68 offen offset:2048 lds
  v_mfma_f32_16x16x32_bf16 v[204:207], a[84:87], a[60:63], v[204:207]
  ds_read_b64_tr_b16 a[70:71], v224 offset:12288
  v_mfma_f32_16x16x32_bf16 v[204:207], a[80:83], a[44:47], v[204:207]
  s_waitcnt lgkmcnt(4)
  v_mfma_f32_16x16x32_bf16 v[220:223], a[88:91], a[44:47], v[220:223]
  ds_read_b64_tr_b16 a[72:73], v224 offset:16384
  v_mfma_f32_16x16x32_bf16 v[220:223], a[92:95], a[60:63], v[220:223]
  v_mfma_f32_16x16x32_bf16 v[216:219], a[92:95], a[56:59], v[216:219]
  ds_read_b64_tr_b16 a[74:75], v224 offset:20480
  v_mfma_f32_16x16x32_bf16 v[216:219], a[88:91], a[40:43], v[216:219]
  v_mfma_f32_16x16x32_bf16 v[212:215], a[88:91], a[36:39], v[212:215]
  ds_read_b64_tr_b16 a[76:77], v224 offset:24576
  buffer_load_dwordx4 v234, s[20:23], s68 offen offset:3072 lds
  v_mfma_f32_16x16x32_bf16 v[212:215], a[92:95], a[52:55], v[212:215]
  s_add_u32 s68, s68, 458752
  s_xor_b32 s69, s69, 0x10000
  v_mfma_f32_16x16x32_bf16 v[208:211], a[92:95], a[48:51], v[208:211]
  ds_read_b64_tr_b16 a[78:79], v224 offset:28672
  v_mfma_f32_16x16x32_bf16 v[208:211], a[88:91], a[32:35], v[208:211]
  s_sub_u32 s56, s56, 1
  s_cmp_lg_u32 s56, 0
  s_cbranch_scc1 Lp3_loop
  s_waitcnt vmcnt(8) lgkmcnt(4)
  v_mfma_f32_16x16x32_bf16 v[0:3], a[64:67], a[0:3], v[0:3]
  ds_read_b64_tr_b16 a[80:81], v225 offset:0
  v_mfma_f32_16x16x32_bf16 v[0:3], a[68:71], a[16:19], v[0:3]
  buffer_load_dword v250, v251, s[36:39], 0 offen offset:128 sc1
  v_mfma_f32_16x16x32_bf16 v[4:7], a[68:71], a[20:23], v[4:7]
  ds_read_b64_tr_b16 a[82:83], v225 offset:4096
  v_mfma_f32_16x16x32_bf16 v[4:7], a[64:67], a[4:7], v[4:7]
  buffer_load_dwordx4 a[32:35], v235, s[4:7], s67 offen offset:2048 sc1
  v_mfma_f32_16x16x32_bf16 v[8:11], a[64:67], a[8:11], v[8:11]
  ds_read_b64_tr_b16 a[84:85], v225 offset:8192
  v_mfma_f32_16x16x32_bf16 v[8:11], a[68:71], a[24:27], v[8:11]
  s_lshl_b32 s88, s53, 7
  v_mfma_f32_16x16x32_bf16 v[12:15], a[68:71], a[28:31], v[12:15]
  ds_read_b64_tr_b16 a[86:87], v225 offset:12288
  v_mfma_f32_16x16x32_bf16 v[12:15], a[64:67], a[12:15], v[12:15]
  s_lshl_b32 s92, s40, 14
  s_waitcnt lgkmcnt(4)
  v_mfma_f32_16x16x32_bf16 v[28:31], a[72:75], a[12:15], v[28:31]
  ds_read_b64_tr_b16 a[88:89], v225 offset:16384
  v_mfma_f32_16x16x32_bf16 v[28:31], a[76:79], a[28:31], v[28:31]
  s_add_u32 s88, s88, s92
  v_mfma_f32_16x16x32_bf16 v[24:27], a[76:79], a[24:27], v[24:27]
  ds_read_b64_tr_b16 a[90:91], v225 offset:20480
  buffer_load_dwordx4 a[48:51], v235, s[4:7], s67 offen offset:3072 sc1
  v_mfma_f32_16x16x32_bf16 v[24:27], a[72:75], a[8:11], v[24:27]
  s_lshl_b32 s89, s40, 10
  v_mfma_f32_16x16x32_bf16 v[20:23], a[72:75], a[4:7], v[20:23]
  ds_read_b64_tr_b16 a[92:93], v225 offset:24576
  v_mfma_f32_16x16x32_bf16 v[20:23], a[76:79], a[20:23], v[20:23]
  s_and_b32 s92, s52, 3
  v_mfma_f32_16x16x32_bf16 v[16:19], a[76:79], a[16:19], v[16:19]
  ds_read_b64_tr_b16 a[94:95], v225 offset:28672
  v_mfma_f32_16x16x32_bf16 v[16:19], a[72:75], a[0:3], v[16:19]
  s_lshl_b32 s91, s92, 15
  s_waitcnt lgkmcnt(4)
  v_mfma_f32_16x16x32_bf16 v[32:35], a[80:83], a[0:3], v[32:35]
  ds_read_b64_tr_b16 a[64:65], v226 offset:0
  v_mfma_f32_16x16x32_bf16 v[32:35], a[84:87], a[16:19], v[32:35]
  buffer_load_dwordx4 a[36:39], v236, s[4:7], s67 offen offset:2048 sc1
  s_mul_i32 s92, s92, 2
  v_mfma_f32_16x16x32_bf16 v[36:39], a[84:87], a[20:23], v[36:39]
  ds_read_b64_tr_b16 a[66:67], v226 offset:4096
  v_mfma_f32_16x16x32_bf16 v[36:39], a[80:83], a[4:7], v[36:39]
  s_and_b32 s93, s53, 7
  v_mfma_f32_16x16x32_bf16 v[40:43], a[80:83], a[8:11], v[40:43]
  ds_read_b64_tr_b16 a[68:69], v226 offset:8192
  v_mfma_f32_16x16x32_bf16 v[40:43], a[84:87], a[24:27], v[40:43]
  s_add_u32 s92, s92, s93
  v_mfma_f32_16x16x32_bf16 v[44:47], a[84:87], a[28:31], v[44:47]
  ds_read_b64_tr_b16 a[70:71], v226 offset:12288
  v_mfma_f32_16x16x32_bf16 v[44:47], a[80:83], a[12:15], v[44:47]
  s_cmp_ge_u32 s92, 7
  s_cselect_b32 s93, 7, 0
  s_sub_u32 s92, s92, s93
  s_waitcnt lgkmcnt(4)
  v_mfma_f32_16x16x32_bf16 v[60:63], a[88:91], a[12:15], v[60:63]
  ds_read_b64_tr_b16 a[72:73], v226 offset:16384
  buffer_load_dwordx4 a[52:55], v236, s[4:7], s67 offen offset:3072 sc1
  v_mfma_f32_16x16x32_bf16 v[60:63], a[92:95], a[28:31], v[60:63]
  s_cmp_ge_u32 s92, 7
  s_cselect_b32 s93, 7, 0
  s_sub_u32 s92, s92, s93
  v_mfma_f32_16x16x32_bf16 v[56:59], a[92:95], a[24:27], v[56:59]
  ds_read_b64_tr_b16 a[74:75], v226 offset:20480
  v_mfma_f32_16x16x32_bf16 v[56:59], a[88:91], a[8:11], v[56:59]
  s_lshl_b32 s93, 3, s92
  v_mfma_f32_16x16x32_bf16 v[52:55], a[88:91], a[4:7], v[52:55]
  ds_read_b64_tr_b16 a[76:77], v226 offset:24576
  v_mfma_f32_16x16x32_bf16 v[52:55], a[92:95], a[20:23], v[52:55]
  s_lshr_b32 s92, s93, 7
  v_mfma_f32_16x16x32_bf16 v[48:51], a[92:95], a[16:19], v[48:51]
  ds_read_b64_tr_b16 a[78:79], v226 offset:28672
  v_mfma_f32_16x16x32_bf16 v[48:51], a[88:91], a[0:3], v[48:51]
  buffer_load_dwordx4 a[40:43], v237, s[4:7], s67 offen offset:2048 sc1
  s_or_b32 s93, s93, s92
  s_waitcnt lgkmcnt(4)
  v_mfma_f32_16x16x32_bf16 v[64:67], a[64:67], a[0:3], v[64:67]
  ds_read_b64_tr_b16 a[80:81], v227 offset:0
  v_mfma_f32_16x16x32_bf16 v[64:67], a[68:71], a[16:19], v[64:67]
  s_bitcmp1_b32 s93, 0
  s_cselect_b32 s80, 458752, 0
  v_mfma_f32_16x16x32_bf16 v[68:71], a[68:71], a[20:23], v[68:71]
  ds_read_b64_tr_b16 a[82:83], v227 offset:4096
  v_mfma_f32_16x16x32_bf16 v[68:71], a[64:67], a[4:7], v[68:71]
  s_bitcmp1_b32 s93, 1
  s_cselect_b32 s81, 458752, 0
  v_mfma_f32_16x16x32_bf16 v[72:75], a[64:67], a[8:11], v[72:75]
  ds_read_b64_tr_b16 a[84:85], v227 offset:8192
  v_mfma_f32_16x16x32_bf16 v[72:75], a[68:71], a[24:27], v[72:75]
  s_bitcmp1_b32 s93, 2
  s_cselect_b32 s82, 458752, 0
  v_mfma_f32_16x16x32_bf16 v[76:79], a[68:71], a[28:31], v[76:79]
  ds_read_b64_tr_b16 a[86:87], v227 offset:12288
  buffer_load_dwordx4 a[56:59], v237, s[4:7], s67 offen offset:3072 sc1
  v_mfma_f32_16x16x32_bf16 v[76:79], a[64:67], a[12:15], v[76:79]
  s_bitcmp1_b32 s93, 3
  s_cselect_b32 s83, 458752, 0
  s_waitcnt lgkmcnt(4)
  v_mfma_f32_16x16x32_bf16 v[92:95], a[72:75], a[12:15], v[92:95]
  ds_read_b64_tr_b16 a[88:89], v227 offset:16384
  v_mfma_f32_16x16x32_bf16 v[92:95], a[76:79], a[28:31], v[92:95]
  s_bitcmp1_b32 s93, 4
  s_cselect_b32 s84, 458752, 0
  v_mfma_f32_16x16x32_bf16 v[88:91], a[76:79], a[24:27], v[88:91]
  ds_read_b64_tr_b16 a[90:91], v227 offset:20480
  v_mfma_f32_16x16x32_bf16 v[88:91], a[72:75], a[8:11], v[88:91]
  s_bitcmp1_b32 s93, 5
  s_cselect_b32 s85, 458752, 0
  v_mfma_f32_16x16x32_bf16 v[84:87], a[72:75], a[4:7], v[84:87]
  ds_read_b64_tr_b16 a[92:93], v227 offset:24576
  v_mfma_f32_16x16x32_bf16 v[84:87], a[76:79], a[20:23], v[84:87]
  buffer_load_dwordx4 a[44:47], v238, s[4:7], s67 offen offset:2048 sc1
  s_bitcmp1_b32 s93, 6
  s_cselect_b32 s86, 458752, 0
  v_mfma_f32_16x16x32_bf16 v[80:83], a[76:79], a[16:19], v[80:83]
  ds_read_b64_tr_b16 a[94:95], v227 offset:28672
  v_mfma_f32_16x16x32_bf16 v[80:83], a[72:75], a[0:3], v[80:83]
  s_cmp_eq_u32 s40, 1
  s_cselect_b32 s90, 16384, 0
  s_waitcnt lgkmcnt(4)
  v_mfma_f32_16x16x32_bf16 v[96:99], a[80:83], a[0:3], v[96:99]
  ds_read_b64_tr_b16 a[64:65], v228 offset:0
  v_mfma_f32_16x16x32_bf16 v[96:99], a[84:87], a[16:19], v[96:99]
  s_cmp_eq_u32 s40, 2
  s_cselect_b32 s90, -16384, s90
  v_mfma_f32_16x16x32_bf16 v[100:103], a[84:87], a[20:23], v[100:103]
  ds_read_b64_tr_b16 a[66:67], v228 offset:4096
  v_mfma_f32_16x16x32_bf16 v[100:103], a[80:83], a[4:7], v[100:103]
  v_mfma_f32_16x16x32_bf16 v[104:107], a[80:83], a[8:11], v[104:107]
  ds_read_b64_tr_b16 a[68:69], v228 offset:8192
  buffer_load_dwordx4 a[60:63], v238, s[4:7], s67 offen offset:3072 sc1
  v_mfma_f32_16x16x32_bf16 v[104:107], a[84:87], a[24:27], v[104:107]
  s_add_u32 s67, s67, 4096
  v_mfma_f32_16x16x32_bf16 v[108:111], a[84:87], a[28:31], v[108:111]
  ds_read_b64_tr_b16 a[70:71], v228 offset:12288
  v_mfma_f32_16x16x32_bf16 v[108:111], a[80:83], a[12:15], v[108:111]
  s_waitcnt lgkmcnt(4)
  v_mfma_f32_16x16x32_bf16 v[124:127], a[88:91], a[12:15], v[124:127]
  ds_read_b64_tr_b16 a[72:73], v228 offset:16384
  v_mfma_f32_16x16x32_bf16 v[124:127], a[92:95], a[28:31], v[124:127]
  s_add_u32 m0, s89, 0
  s_lshl_b32 s44, s70, 13
  v_mfma_f32_16x16x32_bf16 v[120:123], a[92:95], a[24:27], v[120:123]
  ds_read_b64_tr_b16 a[74:75], v228 offset:20480
  s_add_u32 s92, s88, s80
  v_mfma_f32_16x16x32_bf16 v[120:123], a[88:91], a[8:11], v[120:123]
  buffer_load_dwordx4 v252, s[24:27], s92 offen lds
  v_mfma_f32_16x16x32_bf16 v[116:119], a[88:91], a[4:7], v[116:119]
  ds_read_b64_tr_b16 a[76:77], v228 offset:24576
  s_add_u32 s88, s88, 65536
  s_add_u32 s44, s44, s42
  v_mfma_f32_16x16x32_bf16 v[116:119], a[92:95], a[20:23], v[116:119]
  v_mfma_f32_16x16x32_bf16 v[112:115], a[92:95], a[16:19], v[112:115]
  ds_read_b64_tr_b16 a[78:79], v228 offset:28672
  v_mfma_f32_16x16x32_bf16 v[112:115], a[88:91], a[0:3], v[112:115]
  s_add_u32 s44, s44, 27525120
  s_waitcnt lgkmcnt(4)
  v_mfma_f32_16x16x32_bf16 v[128:131], a[64:67], a[0:3], v[128:131]
  ds_read_b64_tr_b16 a[80:81], v229 offset:0
  s_add_u32 m0, s89, 4096
  v_mfma_f32_16x16x32_bf16 v[128:131], a[68:71], a[16:19], v[128:131]
  s_add_u32 s92, s88, s81
  v_mfma_f32_16x16x32_bf16 v[132:135], a[68:71], a[20:23], v[132:135]
  ds_read_b64_tr_b16 a[82:83], v229 offset:4096
  buffer_load_dwordx4 v252, s[24:27], s92 offen lds
  s_add_u32 s45, s44, 4096
  v_mfma_f32_16x16x32_bf16 v[132:135], a[64:67], a[4:7], v[132:135]
  s_add_u32 s88, s88, 65536
  v_mfma_f32_16x16x32_bf16 v[136:139], a[64:67], a[8:11], v[136:139]
  ds_read_b64_tr_b16 a[84:85], v229 offset:8192
  v_mfma_f32_16x16x32_bf16 v[136:139], a[68:71], a[24:27], v[136:139]
  v_lshlrev_b32 v231, 3, v253
  v_mfma_f32_16x16x32_bf16 v[140:143], a[68:71], a[28:31], v[140:143]
  ds_read_b64_tr_b16 a[86:87], v229 offset:12288
  v_mfma_f32_16x16x32_bf16 v[140:143], a[64:67], a[12:15], v[140:143]
  s_add_u32 m0, s89, 8192
  s_waitcnt lgkmcnt(4)
  v_mfma_f32_16x16x32_bf16 v[156:159], a[72:75], a[12:15], v[156:159]
  ds_read_b64_tr_b16 a[88:89], v229 offset:16384
  s_add_u32 s92, s88, s82
  v_lshrrev_b32 v232, 3, v253
  v_mfma_f32_16x16x32_bf16 v[156:159], a[76:79], a[28:31], v[156:159]
  buffer_load_dwordx4 v252, s[24:27], s92 offen lds
  v_mfma_f32_16x16x32_bf16 v[152:155], a[76:79], a[24:27], v[152:155]
  ds_read_b64_tr_b16 a[90:91], v229 offset:20480
  s_add_u32 s88, s88, 65536
  v_mfma_f32_16x16x32_bf16 v[152:155], a[72:75], a[8:11], v[152:155]
  v_add_u32 v232, s66, v232
  v_mfma_f32_16x16x32_bf16 v[148:151], a[72:75], a[4:7], v[148:151]
  ds_read_b64_tr_b16 a[92:93], v229 offset:24576
  v_mfma_f32_16x16x32_bf16 v[148:151], a[76:79], a[20:23], v[148:151]
  v_mfma_f32_16x16x32_bf16 v[144:147], a[76:79], a[16:19], v[144:147]
  ds_read_b64_tr_b16 a[94:95], v229 offset:28672
  s_add_u32 m0, s89, 12288
  v_cmp_ne_u32 vcc, 7, v232
  v_mfma_f32_16x16x32_bf16 v[144:147], a[72:75], a[0:3], v[144:147]
  s_add_u32 s92, s88, s83
  s_waitcnt lgkmcnt(4)
  v_mfma_f32_16x16x32_bf16 v[160:163], a[80:83], a[0:3], v[160:163]
  ds_read_b64_tr_b16 a[64:65], v230 offset:0
  s_add_u32 s92, s92, s90
  v_mfma_f32_16x16x32_bf16 v[160:163], a[84:87], a[16:19], v[160:163]
  buffer_load_dwordx4 v252, s[24:27], s92 offen lds
  v_bfe_u32 v233, v253, 2, 1
  v_mfma_f32_16x16x32_bf16 v[164:167], a[84:87], a[20:23], v[164:167]
  ds_read_b64_tr_b16 a[66:67], v230 offset:4096
  s_add_u32 s88, s88, 65536
  v_mfma_f32_16x16x32_bf16 v[164:167], a[80:83], a[4:7], v[164:167]
  v_mfma_f32_16x16x32_bf16 v[168:171], a[80:83], a[8:11], v[168:171]
  ds_read_b64_tr_b16 a[68:69], v230 offset:8192
  v_cndmask_b32 v232, 0, v232, vcc
  v_mfma_f32_16x16x32_bf16 v[168:171], a[84:87], a[24:27], v[168:171]
  s_add_u32 m0, s89, 16384
  v_mfma_f32_16x16x32_bf16 v[172:175], a[84:87], a[28:31], v[172:175]
  ds_read_b64_tr_b16 a[70:71], v230 offset:12288
  s_add_u32 s92, s88, s84
  v_mfma_f32_16x16x32_bf16 v[172:175], a[80:83], a[12:15], v[172:175]
  buffer_load_dwordx4 v252, s[24:27], s92 offen lds
  v_mul_u32_u24 v233, 14336, v233
  s_waitcnt lgkmcnt(4)
  v_mfma_f32_16x16x32_bf16 v[188:191], a[88:91], a[12:15], v[188:191]
  ds_read_b64_tr_b16 a[72:73], v230 offset:16384
  s_add_u32 s88, s88, 65536
  v_mfma_f32_16x16x32_bf16 v[188:191], a[92:95], a[28:31], v[188:191]
  v_mfma_f32_16x16x32_bf16 v[184:187], a[92:95], a[24:27], v[184:187]
  ds_read_b64_tr_b16 a[74:75], v230 offset:20480
  v_lshl_add_u32 v232, v232, 6, v233
  v_mfma_f32_16x16x32_bf16 v[184:187], a[88:91], a[8:11], v[184:187]
  v_mfma_f32_16x16x32_bf16 v[180:183], a[88:91], a[4:7], v[180:183]
  ds_read_b64_tr_b16 a[76:77], v230 offset:24576
  s_add_u32 m0, s89, 20480
  v_mfma_f32_16x16x32_bf16 v[180:183], a[92:95], a[20:23], v[180:183]
  s_add_u32 s92, s88, s85
  v_and_b32 v233, 3, v253
  v_mfma_f32_16x16x32_bf16 v[176:179], a[92:95], a[16:19], v[176:179]
  ds_read_b64_tr_b16 a[78:79], v230 offset:28672
  buffer_load_dwordx4 v252, s[24:27], s92 offen lds
  v_mfma_f32_16x16x32_bf16 v[176:179], a[88:91], a[0:3], v[176:179]
  s_add_u32 s88, s88, 65536
  s_waitcnt lgkmcnt(4)
  v_mfma_f32_16x16x32_bf16 v[192:195], a[64:67], a[0:3], v[192:195]
  s_waitcnt vmcnt(15)
  s_barrier
  ds_read_b64_tr_b16 a[80:81], v224 offset:32768
  v_lshl_add_u32 v232, v233, 4, v232
  v_mfma_f32_16x16x32_bf16 v[192:195], a[68:71], a[16:19], v[192:195]
  v_mfma_f32_16x16x32_bf16 v[196:199], a[68:71], a[20:23], v[196:199]
  ds_read_b64_tr_b16 a[82:83], v224 offset:36864
  v_mfma_f32_16x16x32_bf16 v[196:199], a[64:67], a[4:7], v[196:199]
  s_add_u32 m0, s89, 24576
  s_mul_i32 s46, s55, 448
  v_mfma_f32_16x16x32_bf16 v[200:203], a[64:67], a[8:11], v[200:203]
  ds_read_b64_tr_b16 a[84:85], v224 offset:40960
  s_add_u32 s92, s88, s86
  v_mfma_f32_16x16x32_bf16 v[200:203], a[68:71], a[24:27], v[200:203]
  buffer_load_dwordx4 v252, s[24:27], s92 offen lds
  v_mfma_f32_16x16x32_bf16 v[204:207], a[68:71], a[28:31], v[204:207]
  ds_read_b64_tr_b16 a[86:87], v224 offset:45056
  s_add_u32 s88, s88, 65536
  s_add_u32 s46, s46, 27918336
  v_mfma_f32_16x16x32_bf16 v[204:207], a[64:67], a[12:15], v[204:207]
  s_waitcnt lgkmcnt(4)
  v_mfma_f32_16x16x32_bf16 v[220:223], a[72:75], a[12:15], v[220:223]
  ds_read_b64_tr_b16 a[88:89], v224 offset:49152
  v_mfma_f32_16x16x32_bf16 v[220:223], a[76:79], a[28:31], v[220:223]
  s_add_u32 s47, s46, 27648
  v_mfma_f32_16x16x32_bf16 v[216:219], a[76:79], a[24:27], v[216:219]
  ds_read_b64_tr_b16 a[90:91], v224 offset:53248
  s_add_u32 m0, s89, 28672
  v_mfma_f32_16x16x32_bf16 v[216:219], a[72:75], a[8:11], v[216:219]
  s_add_u32 s92, s88, s80
  v_mfma_f32_16x16x32_bf16 v[212:215], a[72:75], a[4:7], v[212:215]
  ds_read_b64_tr_b16 a[92:93], v224 offset:57344
  buffer_load_dwordx4 v252, s[24:27], s92 offen lds
  v_add_u32 v233, s72, v235
  v_mfma_f32_16x16x32_bf16 v[212:215], a[76:79], a[20:23], v[212:215]
  s_add_u32 s88, s88, 65536
  v_mfma_f32_16x16x32_bf16 v[208:211], a[76:79], a[16:19], v[208:211]
  ds_read_b64_tr_b16 a[94:95], v224 offset:61440
  v_xor_b32 v224, 0x10000, v224
  v_mfma_f32_16x16x32_bf16 v[208:211], a[72:75], a[0:3], v[208:211]
  s_waitcnt vmcnt(8) lgkmcnt(4)
  v_mfma_f32_16x16x32_bf16 v[0:3], a[80:83], a[32:35], v[0:3]
  ds_read_b64_tr_b16 a[64:65], v225 offset:32768
  v_mfma_f32_16x16x32_bf16 v[0:3], a[84:87], a[48:51], v[0:3]
  v_cmp_gt_u32 vcc, 224, v250
  s_cbranch_vccz Lcdn19
  s_mov_b32 s43, 0x40000
Lchk18:
  buffer_load_dword v250, v251, s[36:39], 0 offen offset:128 sc1
  s_waitcnt vmcnt(0)
  v_cmp_gt_u32 vcc, 224, v250
  s_cbranch_vccz Lcdn19
  s_sub_u32 s43, s43, 1
  s_cmp_lg_u32 s43, 0
  s_cbranch_scc1 Lchk18
Lcdn19:
  v_mfma_f32_16x16x32_bf16 v[4:7], a[84:87], a[52:55], v[4:7]
  ds_read_b64_tr_b16 a[66:67], v225 offset:36864
  s_mov_b32 m0, s72
  v_mfma_f32_16x16x32_bf16 v[4:7], a[80:83], a[36:39], v[4:7]
  buffer_load_dwordx4 v232, s[4:7], s46 offen sc1 lds
  v_mfma_f32_16x16x32_bf16 v[8:11], a[80:83], a[40:43], v[8:11]
  ds_read_b64_tr_b16 a[68:69], v225 offset:40960
  v_mfma_f32_16x16x32_bf16 v[8:11], a[84:87], a[56:59], v[8:11]
  buffer_load_dwordx4 v232, s[4:7], s47 offen offset:1024 sc1 lds
  v_mfma_f32_16x16x32_bf16 v[12:15], a[84:87], a[60:63], v[12:15]
  ds_read_b64_tr_b16 a[70:71], v225 offset:45056
  v_mfma_f32_16x16x32_bf16 v[12:15], a[80:83], a[44:47], v[12:15]
  s_waitcnt lgkmcnt(4)
  v_mfma_f32_16x16x32_bf16 v[28:31], a[88:91], a[44:47], v[28:31]
  ds_read_b64_tr_b16 a[72:73], v225 offset:49152
  v_mfma_f32_16x16x32_bf16 v[28:31], a[92:95], a[60:63], v[28:31]
  buffer_load_dwordx2 a[128:129], v231, s[4:7], s44 offen offset:0 sc1
  v_mfma_f32_16x16x32_bf16 v[24:27], a[92:95], a[56:59], v[24:27]
  ds_read_b64_tr_b16 a[74:75], v225 offset:53248
  v_mfma_f32_16x16x32_bf16 v[24:27], a[88:91], a[40:43], v[24:27]
  v_mfma_f32_16x16x32_bf16 v[20:23], a[88:91], a[36:39], v[20:23]
  ds_read_b64_tr_b16 a[76:77], v225 offset:57344
  buffer_load_dwordx2 a[130:131], v231, s[4:7], s44 offen offset:512 sc1
  v_mfma_f32_16x16x32_bf16 v[20:23], a[92:95], a[52:55], v[20:23]
  v_mfma_f32_16x16x32_bf16 v[16:19], a[92:95], a[48:51], v[16:19]
  ds_read_b64_tr_b16 a[78:79], v225 offset:61440
  v_xor_b32 v225, 0x10000, v225
  v_mfma_f32_16x16x32_bf16 v[16:19], a[88:91], a[32:35], v[16:19]
  buffer_load_dwordx2 a[132:133], v231, s[4:7], s44 offen offset:1024 sc1
  s_waitcnt lgkmcnt(4)
  v_mfma_f32_16x16x32_bf16 v[32:35], a[64:67], a[32:35], v[32:35]
  ds_read_b64_tr_b16 a[80:81], v226 offset:32768
  v_mfma_f32_16x16x32_bf16 v[32:35], a[68:71], a[48:51], v[32:35]
  v_mfma_f32_16x16x32_bf16 v[36:39], a[68:71], a[52:55], v[36:39]
  ds_read_b64_tr_b16 a[82:83], v226 offset:36864
  buffer_load_dwordx2 a[134:135], v231, s[4:7], s44 offen offset:1536 sc1
  v_mfma_f32_16x16x32_bf16 v[36:39], a[64:67], a[36:39], v[36:39]
  v_mfma_f32_16x16x32_bf16 v[40:43], a[64:67], a[40:43], v[40:43]
  ds_read_b64_tr_b16 a[84:85], v226 offset:40960
  v_mfma_f32_16x16x32_bf16 v[40:43], a[68:71], a[56:59], v[40:43]
  buffer_load_dwordx2 a[136:137], v231, s[4:7], s44 offen offset:2048 sc1
  v_mfma_f32_16x16x32_bf16 v[44:47], a[68:71], a[60:63], v[44:47]
  ds_read_b64_tr_b16 a[86:87], v226 offset:45056
  v_mfma_f32_16x16x32_bf16 v[44:47], a[64:67], a[44:47], v[44:47]
  s_waitcnt lgkmcnt(4)
  v_mfma_f32_16x16x32_bf16 v[60:63], a[72:75], a[44:47], v[60:63]
  ds_read_b64_tr_b16 a[88:89], v226 offset:49152
  buffer_load_dwordx2 a[138:139], v231, s[4:7], s44 offen offset:2560 sc1
  v_mfma_f32_16x16x32_bf16 v[60:63], a[76:79], a[60:63], v[60:63]
  v_mfma_f32_16x16x32_bf16 v[56:59], a[76:79], a[56:59], v[56:59]
  ds_read_b64_tr_b16 a[90:91], v226 offset:53248
  v_mfma_f32_16x16x32_bf16 v[56:59], a[72:75], a[40:43], v[56:59]
  buffer_load_dwordx2 a[140:141], v231, s[4:7], s44 offen offset:3072 sc1
  v_mfma_f32_16x16x32_bf16 v[52:55], a[72:75], a[36:39], v[52:55]
  ds_read_b64_tr_b16 a[92:93], v226 offset:57344
  v_mfma_f32_16x16x32_bf16 v[52:55], a[76:79], a[52:55], v[52:55]
  v_mfma_f32_16x16x32_bf16 v[48:51], a[76:79], a[48:51], v[48:51]
  ds_read_b64_tr_b16 a[94:95], v226 offset:61440
  v_xor_b32 v226, 0x10000, v226
  buffer_load_dwordx2 a[142:143], v231, s[4:7], s44 offen offset:3584 sc1
  v_mfma_f32_16x16x32_bf16 v[48:51], a[72:75], a[32:35], v[48:51]
  s_waitcnt lgkmcnt(4)
  v_mfma_f32_16x16x32_bf16 v[64:67], a[80:83], a[32:35], v[64:67]
  ds_read_b64_tr_b16 a[64:65], v227 offset:32768
  v_mfma_f32_16x16x32_bf16 v[64:67], a[84:87], a[48:51], v[64:67]
  buffer_load_dwordx2 a[144:145], v231, s[4:7], s45 offen offset:0 sc1
  v_mfma_f32_16x16x32_bf16 v[68:71], a[84:87], a[52:55], v[68:71]
  ds_read_b64_tr_b16 a[66:67], v227 offset:36864
  v_mfma_f32_16x16x32_bf16 v[68:71], a[80:83], a[36:39], v[68:71]
  v_mfma_f32_16x16x32_bf16 v[72:75], a[80:83], a[40:43], v[72:75]
  ds_read_b64_tr_b16 a[68:69], v227 offset:40960
  buffer_load_dwordx2 a[146:147], v231, s[4:7], s45 offen offset:512 sc1
  v_mfma_f32_16x16x32_bf16 v[72:75], a[84:87], a[56:59], v[72:75]
  v_mfma_f32_16x16x32_bf16 v[76:79], a[84:87], a[60:63], v[76:79]
  ds_read_b64_tr_b16 a[70:71], v227 offset:45056
  v_mfma_f32_16x16x32_bf16 v[76:79], a[80:83], a[44:47], v[76:79]
  buffer_load_dwordx2 a[148:149], v231, s[4:7], s45 offen offset:1024 sc1
  s_waitcnt lgkmcnt(4)
  v_mfma_f32_16x16x32_bf16 v[92:95], a[88:91], a[44:47], v[92:95]
  ds_read_b64_tr_b16 a[72:73], v227 offset:49152
  v_mfma_f32_16x16x32_bf16 v[92:95], a[92:95], a[60:63], v[92:95]
  v_mfma_f32_16x16x32_bf16 v[88:91], a[92:95], a[56:59], v[88:91]
  ds_read_b64_tr_b16 a[74:75], v227 offset:53248
  buffer_load_dwordx2 a[150:151], v231, s[4:7], s45 offen offset:1536 sc1
  v_mfma_f32_16x16x32_bf16 v[88:91], a[88:91], a[40:43], v[88:91]
  v_mfma_f32_16x16x32_bf16 v[84:87], a[88:91], a[36:39], v[84:87]
  ds_read_b64_tr_b16 a[76:77], v227 offset:57344
  v_mfma_f32_16x16x32_bf16 v[84:87], a[92:95], a[52:55], v[84:87]
  buffer_load_dwordx2 a[152:153], v231, s[4:7], s45 offen offset:2048 sc1
  v_mfma_f32_16x16x32_bf16 v[80:83], a[92:95], a[48:51], v[80:83]
  ds_read_b64_tr_b16 a[78:79], v227 offset:61440
  v_xor_b32 v227, 0x10000, v227
  v_mfma_f32_16x16x32_bf16 v[80:83], a[88:91], a[32:35], v[80:83]
  s_waitcnt lgkmcnt(4)
  v_mfma_f32_16x16x32_bf16 v[96:99], a[64:67], a[32:35], v[96:99]
  ds_read_b64_tr_b16 a[80:81], v228 offset:32768
  buffer_load_dwordx2 a[154:155], v231, s[4:7], s45 offen offset:2560 sc1
  v_mfma_f32_16x16x32_bf16 v[96:99], a[68:71], a[48:51], v[96:99]
  v_mfma_f32_16x16x32_bf16 v[100:103], a[68:71], a[52:55], v[100:103]
  ds_read_b64_tr_b16 a[82:83], v228 offset:36864
  v_mfma_f32_16x16x32_bf16 v[100:103], a[64:67], a[36:39], v[100:103]
  buffer_load_dwordx2 a[156:157], v231, s[4:7], s45 offen offset:3072 sc1
  v_mfma_f32_16x16x32_bf16 v[104:107], a[64:67], a[40:43], v[104:107]
  ds_read_b64_tr_b16 a[84:85], v228 offset:40960
  v_mfma_f32_16x16x32_bf16 v[104:107], a[68:71], a[56:59], v[104:107]
  v_mfma_f32_16x16x32_bf16 v[108:111], a[68:71], a[60:63], v[108:111]
  ds_read_b64_tr_b16 a[86:87], v228 offset:45056
  buffer_load_dwordx2 a[158:159], v231, s[4:7], s45 offen offset:3584 sc1
  v_mfma_f32_16x16x32_bf16 v[108:111], a[64:67], a[44:47], v[108:111]
  s_waitcnt lgkmcnt(4)
  v_mfma_f32_16x16x32_bf16 v[124:127], a[72:75], a[44:47], v[124:127]
  ds_read_b64_tr_b16 a[88:89], v228 offset:49152
  v_mfma_f32_16x16x32_bf16 v[124:127], a[76:79], a[60:63], v[124:127]
  s_add_u32 m0, s89, 32768
  v_mfma_f32_16x16x32_bf16 v[120:123], a[76:79], a[56:59], v[120:123]
  ds_read_b64_tr_b16 a[90:91], v228 offset:53248
  s_add_u32 s92, s88, s81
  v_mfma_f32_16x16x32_bf16 v[120:123], a[72:75], a[40:43], v[120:123]
  buffer_load_dwordx4 v252, s[24:27], s92 offen lds
  v_mfma_f32_16x16x32_bf16 v[116:119], a[72:75], a[36:39], v[116:119]
  ds_read_b64_tr_b16 a[92:93], v228 offset:57344
  s_add_u32 s88, s88, 65536
  v_mfma_f32_16x16x32_bf16 v[116:119], a[76:79], a[52:55], v[116:119]
  v_mfma_f32_16x16x32_bf16 v[112:115], a[76:79], a[48:51], v[112:115]
  ds_read_b64_tr_b16 a[94:95], v228 offset:61440
  v_xor_b32 v228, 0x10000, v228
  v_mfma_f32_16x16x32_bf16 v[112:115], a[72:75], a[32:35], v[112:115]
  s_waitcnt lgkmcnt(4)
  v_mfma_f32_16x16x32_bf16 v[128:131], a[80:83], a[32:35], v[128:131]
  ds_read_b64_tr_b16 a[64:65], v229 offset:32768
  s_add_u32 m0, s89, 36864
  v_mfma_f32_16x16x32_bf16 v[128:131], a[84:87], a[48:51], v[128:131]
  s_add_u32 s92, s88, s82
  v_mfma_f32_16x16x32_bf16 v[132:135], a[84:87], a[52:55], v[132:135]
  ds_read_b64_tr_b16 a[66:67], v229 offset:36864
  buffer_load_dwordx4 v252, s[24:27], s92 offen lds
  v_mfma_f32_16x16x32_bf16 v[132:135], a[80:83], a[36:39], v[132:135]
  s_add_u32 s88, s88, 65536
  v_mfma_f32_16x16x32_bf16 v[136:139], a[80:83], a[40:43], v[136:139]
  ds_read_b64_tr_b16 a[68:69], v229 offset:40960
  v_mfma_f32_16x16x32_bf16 v[136:139], a[84:87], a[56:59], v[136:139]
  v_mfma_f32_16x16x32_bf16 v[140:143], a[84:87], a[60:63], v[140:143]
  ds_read_b64_tr_b16 a[70:71], v229 offset:45056
  v_mfma_f32_16x16x32_bf16 v[140:143], a[80:83], a[44:47], v[140:143]
  s_add_u32 m0, s89, 40960
  s_waitcnt lgkmcnt(4)
  v_mfma_f32_16x16x32_bf16 v[156:159], a[88:91], a[44:47], v[156:159]
  ds_read_b64_tr_b16 a[72:73], v229 offset:49152
  s_add_u32 s92, s88, s83
  v_mfma_f32_16x16x32_bf16 v[156:159], a[92:95], a[60:63], v[156:159]
  s_add_u32 s92, s92, s90
  v_mfma_f32_16x16x32_bf16 v[152:155], a[92:95], a[56:59], v[152:155]
  ds_read_b64_tr_b16 a[74:75], v229 offset:53248
  buffer_load_dwordx4 v252, s[24:27], s92 offen lds
  v_mfma_f32_16x16x32_bf16 v[152:155], a[88:91], a[40:43], v[152:155]
  s_add_u32 s88, s88, 65536
  v_mfma_f32_16x16x32_bf16 v[148:151], a[88:91], a[36:39], v[148:151]
  ds_read_b64_tr_b16 a[76:77], v229 offset:57344
  v_mfma_f32_16x16x32_bf16 v[148:151], a[92:95], a[52:55], v[148:151]
  v_mfma_f32_16x16x32_bf16 v[144:147], a[92:95], a[48:51], v[144:147]
  ds_read_b64_tr_b16 a[78:79], v229 offset:61440
  v_xor_b32 v229, 0x10000, v229
  s_add_u32 m0, s89, 45056
  v_mfma_f32_16x16x32_bf16 v[144:147], a[88:91], a[32:35], v[144:147]
  s_add_u32 s92, s88, s84
  s_waitcnt lgkmcnt(4)
  v_mfma_f32_16x16x32_bf16 v[160:163], a[64:67], a[32:35], v[160:163]
  ds_read_b64_tr_b16 a[80:81], v230 offset:32768
  buffer_load_dwordx4 v252, s[24:27], s92 offen lds
  v_mfma_f32_16x16x32_bf16 v[160:163], a[68:71], a[48:51], v[160:163]
  s_add_u32 s88, s88, 65536
  v_mfma_f32_16x16x32_bf16 v[164:167], a[68:71], a[52:55], v[164:167]
  ds_read_b64_tr_b16 a[82:83], v230 offset:36864
  v_mfma_f32_16x16x32_bf16 v[164:167], a[64:67], a[36:39], v[164:167]
  v_mfma_f32_16x16x32_bf16 v[168:171], a[64:67], a[40:43], v[168:171]
  ds_read_b64_tr_b16 a[84:85], v230 offset:40960
  v_mfma_f32_16x16x32_bf16 v[168:171], a[68:71], a[56:59], v[168:171]
  s_add_u32 m0, s89, 49152
  v_mfma_f32_16x16x32_bf16 v[172:175], a[68:71], a[60:63], v[172:175]
  ds_read_b64_tr_b16 a[86:87], v230 offset:45056
  s_add_u32 s92, s88, s85
  v_mfma_f32_16x16x32_bf16 v[172:175], a[64:67], a[44:47], v[172:175]
  buffer_load_dwordx4 v252, s[24:27], s92 offen lds
  s_waitcnt lgkmcnt(4)
  v_mfma_f32_16x16x32_bf16 v[188:191], a[72:75], a[44:47], v[188:191]
  ds_read_b64_tr_b16 a[88:89], v230 offset:49152
  s_add_u32 s88, s88, 65536
  v_mfma_f32_16x16x32_bf16 v[188:191], a[76:79], a[60:63], v[188:191]
  v_mfma_f32_16x16x32_bf16 v[184:187], a[76:79], a[56:59], v[184:187]
  ds_read_b64_tr_b16 a[90:91], v230 offset:53248
  v_mfma_f32_16x16x32_bf16 v[184:187], a[72:75], a[40:43], v[184:187]
  v_mfma_f32_16x16x32_bf16 v[180:183], a[72:75], a[36:39], v[180:183]
  ds_read_b64_tr_b16 a[92:93], v230 offset:57344
  s_add_u32 m0, s89, 53248
  v_mfma_f32_16x16x32_bf16 v[180:183], a[76:79], a[52:55], v[180:183]
  s_add_u32 s92, s88, s86
  v_mfma_f32_16x16x32_bf16 v[176:179], a[76:79], a[48:51], v[176:179]
  ds_read_b64_tr_b16 a[94:95], v230 offset:61440
  v_xor_b32 v230, 0x10000, v230
  buffer_load_dwordx4 v252, s[24:27], s92 offen lds
  v_mfma_f32_16x16x32_bf16 v[176:179], a[72:75], a[32:35], v[176:179]
  s_add_u32 s88, s88, 65536
  s_waitcnt lgkmcnt(4)
  v_mfma_f32_16x16x32_bf16 v[192:195], a[80:83], a[32:35], v[192:195]
  v_mfma_f32_16x16x32_bf16 v[192:195], a[84:87], a[48:51], v[192:195]
  s_waitcnt vmcnt(22)
  ds_read_b128 v[240:243], v233
  ds_read_b128 v[244:247], v233 offset:1024
  v_mfma_f32_16x16x32_bf16 v[196:199], a[84:87], a[52:55], v[196:199]
  v_mfma_f32_16x16x32_bf16 v[196:199], a[80:83], a[36:39], v[196:199]
  s_add_u32 m0, s89, 57344
  v_mfma_f32_16x16x32_bf16 v[200:203], a[80:83], a[40:43], v[200:203]
  s_add_u32 s92, s88, s80
  v_mfma_f32_16x16x32_bf16 v[200:203], a[84:87], a[56:59], v[200:203]
  buffer_load_dwordx4 v252, s[24:27], s92 offen lds
  v_mfma_f32_16x16x32_bf16 v[204:207], a[84:87], a[60:63], v[204:207]
  s_add_u32 s88, s88, 65536
  v_mfma_f32_16x16x32_bf16 v[204:207], a[80:83], a[44:47], v[204:207]
  s_waitcnt lgkmcnt(2)
  v_mfma_f32_16x16x32_bf16 v[220:223], a[88:91], a[44:47], v[220:223]
  v_mfma_f32_16x16x32_bf16 v[220:223], a[92:95], a[60:63], v[220:223]
  s_waitcnt lgkmcnt(0)
  v_add_f32 v240, v240, v244
  v_add_f32 v241, v241, v245
  v_mfma_f32_16x16x32_bf16 v[216:219], a[92:95], a[56:59], v[216:219]
  s_add_u32 m0, s89, 61440
  v_add_f32 v242, v242, v246
  v_add_f32 v243, v243, v247
  v_mfma_f32_16x16x32_bf16 v[216:219], a[88:91], a[40:43], v[216:219]
  s_add_u32 s92, s88, s81
  ds_write_b128 v233, v[240:243]
  v_mfma_f32_16x16x32_bf16 v[212:215], a[88:91], a[36:39], v[212:215]
  buffer_load_dwordx4 v252, s[24:27], s92 offen lds
  v_mfma_f32_16x16x32_bf16 v[212:215], a[92:95], a[52:55], v[212:215]
  s_add_u32 s88, s88, 65536
  v_mfma_f32_16x16x32_bf16 v[208:211], a[92:95], a[48:51], v[208:211]
  v_mfma_f32_16x16x32_bf16 v[208:211], a[88:91], a[32:35], v[208:211]
  v_lshrrev_b32 v250, 4, v253
  v_lshlrev_b32 v250, 4, v250
  v_add_u32 v250, s72, v250
  s_waitcnt vmcnt(8) lgkmcnt(0)
  v_accvgpr_read_b32 v224, a128
  v_accvgpr_read_b32 v225, a129
  v_accvgpr_read_b32 v226, a130
  v_accvgpr_read_b32 v227, a131
  v_accvgpr_read_b32 v228, a132
  v_accvgpr_read_b32 v229, a133
  v_accvgpr_read_b32 v230, a134
  v_accvgpr_read_b32 v231, a135
  v_pk_add_f32 v[224:225], v[224:225], v[226:227]
  v_pk_add_f32 v[228:229], v[228:229], v[230:231]
  v_add_f32 v240, v224, v228
  v_add_f32 v236, v225, v229
  v_accvgpr_read_b32 v224, a136
  v_accvgpr_read_b32 v225, a137
  v_accvgpr_read_b32 v226, a138
  v_accvgpr_read_b32 v227, a139
  v_accvgpr_read_b32 v228, a140
  v_accvgpr_read_b32 v229, a141
  v_accvgpr_read_b32 v230, a142
  v_accvgpr_read_b32 v231, a143
  v_pk_add_f32 v[224:225], v[224:225], v[226:227]
  v_pk_add_f32 v[228:229], v[228:229], v[230:231]
  v_add_f32 v241, v224, v228
  v_add_f32 v237, v225, v229
  v_accvgpr_read_b32 v224, a144
  v_accvgpr_read_b32 v225, a145
  v_accvgpr_read_b32 v226, a146
  v_accvgpr_read_b32 v227, a147
  v_accvgpr_read_b32 v228, a148
  v_accvgpr_read_b32 v229, a149
  v_accvgpr_read_b32 v230, a150
  v_accvgpr_read_b32 v231, a151
  v_pk_add_f32 v[224:225], v[224:225], v[226:227]
  v_pk_add_f32 v[228:229], v[228:229], v[230:231]
  v_add_f32 v242, v224, v228
  v_add_f32 v238, v225, v229
  v_accvgpr_read_b32 v224, a152
  v_accvgpr_read_b32 v225, a153
  v_accvgpr_read_b32 v226, a154
  v_accvgpr_read_b32 v227, a155
  v_accvgpr_read_b32 v228, a156
  v_accvgpr_read_b32 v229, a157
  v_accvgpr_read_b32 v230, a158
  v_accvgpr_read_b32 v231, a159
  v_pk_add_f32 v[224:225], v[224:225], v[226:227]
  v_pk_add_f32 v[228:229], v[228:229], v[230:231]
  v_add_f32 v243, v224, v228
  v_add_f32 v239, v225, v229
  v_mov_b32 v224, v240
  v_mov_b32 v225, v241
  v_mov_b32 v226, v242
  v_mov_b32 v227, v243
  v_mov_b32 v228, v236
  v_mov_b32 v229, v237
  v_mov_b32 v230, v238
  v_mov_b32 v231, v239
  v_permlane32_swap_b32 v240, v224
  v_permlane32_swap_b32 v241, v225
  v_permlane32_swap_b32 v242, v226
  v_permlane32_swap_b32 v243, v227
  v_permlane32_swap_b32 v236, v228
  v_permlane32_swap_b32 v237, v229
  v_permlane32_swap_b32 v238, v230
  v_permlane32_swap_b32 v239, v231
  v_add_f32 v240, v240, v224
  v_add_f32 v241, v241, v225
  v_add_f32 v242, v242, v226
  v_add_f32 v243, v243, v227
  v_add_f32 v236, v236, v228
  v_add_f32 v237, v237, v229
  v_add_f32 v238, v238, v230
  v_add_f32 v239, v239, v231
  v_mov_b32 v224, v240
  v_mov_b32 v225, v241
  v_mov_b32 v226, v242
  v_mov_b32 v227, v243
  v_mov_b32 v228, v236
  v_mov_b32 v229, v237
  v_mov_b32 v230, v238
  v_mov_b32 v231, v239
  v_permlane16_swap_b32 v240, v224
  v_permlane16_swap_b32 v241, v225
  v_permlane16_swap_b32 v242, v226
  v_permlane16_swap_b32 v243, v227
  v_permlane16_swap_b32 v236, v228
  v_permlane16_swap_b32 v237, v229
  v_permlane16_swap_b32 v238, v230
  v_permlane16_swap_b32 v239, v231
  v_add_f32 v240, v240, v224
  v_add_f32 v241, v241, v225
  v_add_f32 v242, v242, v226
  v_add_f32 v243, v243, v227
  v_add_f32 v236, v236, v228
  v_add_f32 v237, v237, v229
  v_add_f32 v238, v238, v230
  v_add_f32 v239, v239, v231
  ds_read_b128 v[224:227], v250 offset:0
  ds_read_b128 v[228:231], v250 offset:64
  s_mov_b32 s43, 0x3a800000
  v_mov_b32 v232, 0x3727c5ac
  v_mul_f32 v240, 0xba800000, v240
  v_fma_f32 v236, v236, s43, v232
  v_fma_f32 v236, -v240, v240, v236
  v_max_f32 v236, v236, v232
  v_rsq_f32 v244, v236
  v_mul_f32 v241, 0xba800000, v241
  v_fma_f32 v237, v237, s43, v232
  v_fma_f32 v237, -v241, v241, v237
  v_max_f32 v237, v237, v232
  v_rsq_f32 v245, v237
  v_mul_f32 v242, 0xba800000, v242
  v_fma_f32 v238, v238, s43, v232
  v_fma_f32 v238, -v242, v242, v238
  v_max_f32 v238, v238, v232
  v_rsq_f32 v246, v238
  v_mul_f32 v243, 0xba800000, v243
  v_fma_f32 v239, v239, s43, v232
  v_fma_f32 v239, -v243, v243, v239
  v_max_f32 v239, v239, v232
  v_rsq_f32 v247, v239
  v_lshlrev_b32 v248, 4, v253
  v_and_b32 v249, 31, v253
  v_lshlrev_b32 v249, 4, v249
  v_lshrrev_b32 v232, 5, v253
  v_mul_f32 v244, 0xbfb8aa3b, v244
  v_mul_f32 v245, 0xbfb8aa3b, v245
  v_mul_f32 v246, 0xbfb8aa3b, v246
  v_mul_f32 v247, 0xbfb8aa3b, v247
  s_mov_b32 s43, 114688
  v_mad_u32_u24 v249, v232, s43, v249
  s_mul_i32 s43, s70, 458752
  s_lshr_b32 s45, s55, 1
  s_mul_i32 s45, s45, 7168
  s_add_u32 s43, s43, s45
  s_add_u32 s43, s43, s42
  s_add_u32 s43, s43, 12582912
  s_lshl_b32 s45, s66, 12
  s_add_u32 s57, s43, s45
  s_lshl_b32 s45, s66, 9
  s_add_u32 s61, s43, s45
  s_add_u32 s61, s61, 3072
  s_add_u32 s62, s61, 229376
  s_add_u32 s58, s57, 114688
  s_add_u32 s59, s58, 114688
  s_add_u32 s60, s59, 114688
  s_waitcnt lgkmcnt(0)
  v_pk_fma_f32 v[0:1], v[224:225], v[240:241], v[0:1] op_sel:[0,0,0] op_sel_hi:[1,0,1]
  v_pk_fma_f32 v[2:3], v[226:227], v[240:241], v[2:3] op_sel:[0,0,0] op_sel_hi:[1,0,1]
  v_pk_fma_f32 v[16:17], v[228:229], v[240:241], v[16:17] op_sel:[0,0,0] op_sel_hi:[1,0,1]
  v_pk_fma_f32 v[18:19], v[230:231], v[240:241], v[18:19] op_sel:[0,0,0] op_sel_hi:[1,0,1]
  v_pk_mul_f32 v[232:233], v[0:1], v[244:245] op_sel:[0,0] op_sel_hi:[1,0]
  v_pk_mul_f32 v[234:235], v[2:3], v[244:245] op_sel:[0,0] op_sel_hi:[1,0]
  v_pk_mul_f32 v[0:1], v[0:1], v[16:17]
  v_pk_mul_f32 v[2:3], v[2:3], v[18:19]
  v_exp_f32 v232, v232
  v_exp_f32 v233, v233
  v_exp_f32 v234, v234
  v_exp_f32 v235, v235
  s_nop 0
  v_pk_fma_f32 v[232:233], v[232:233], v[236:237], v[236:237] op_sel:[0,0,0] op_sel_hi:[1,0,0]
  v_pk_fma_f32 v[234:235], v[234:235], v[236:237], v[236:237] op_sel:[0,0,0] op_sel_hi:[1,0,0]
  v_rcp_f32 v232, v232
  v_rcp_f32 v233, v233
  v_rcp_f32 v234, v234
  v_rcp_f32 v235, v235
  s_nop 0
  v_pk_mul_f32 v[0:1], v[0:1], v[232:233]
  v_pk_mul_f32 v[2:3], v[2:3], v[234:235]
  v_cvt_pk_bf16_f32 v16, v0, v1
  v_cvt_pk_bf16_f32 v17, v2, v3
  v_pk_fma_f32 v[4:5], v[224:225], v[240:241], v[4:5] op_sel:[0,1,0] op_sel_hi:[1,1,1]
  v_pk_fma_f32 v[6:7], v[226:227], v[240:241], v[6:7] op_sel:[0,1,0] op_sel_hi:[1,1,1]
  v_pk_fma_f32 v[20:21], v[228:229], v[240:241], v[20:21] op_sel:[0,1,0] op_sel_hi:[1,1,1]
  v_pk_fma_f32 v[22:23], v[230:231], v[240:241], v[22:23] op_sel:[0,1,0] op_sel_hi:[1,1,1]
  v_pk_mul_f32 v[232:233], v[4:5], v[244:245] op_sel:[0,1] op_sel_hi:[1,1]
  v_pk_mul_f32 v[234:235], v[6:7], v[244:245] op_sel:[0,1] op_sel_hi:[1,1]
  v_pk_mul_f32 v[4:5], v[4:5], v[20:21]
  v_pk_mul_f32 v[6:7], v[6:7], v[22:23]
  v_exp_f32 v232, v232
  v_exp_f32 v233, v233
  v_exp_f32 v234, v234
  v_exp_f32 v235, v235
  s_nop 0
  v_pk_fma_f32 v[232:233], v[232:233], v[236:237], v[236:237] op_sel:[0,1,1] op_sel_hi:[1,1,1]
  v_pk_fma_f32 v[234:235], v[234:235], v[236:237], v[236:237] op_sel:[0,1,1] op_sel_hi:[1,1,1]
  v_rcp_f32 v232, v232
  v_rcp_f32 v233, v233
  v_rcp_f32 v234, v234
  v_rcp_f32 v235, v235
  s_nop 0
  v_pk_mul_f32 v[4:5], v[4:5], v[232:233]
  v_pk_mul_f32 v[6:7], v[6:7], v[234:235]
  v_cvt_pk_bf16_f32 v20, v4, v5
  v_cvt_pk_bf16_f32 v21, v6, v7
  ds_read_b128 v[0:3], v250 offset:128
  ds_read_b128 v[4:7], v250 offset:192
  v_pk_fma_f32 v[8:9], v[224:225], v[242:243], v[8:9] op_sel:[0,0,0] op_sel_hi:[1,0,1]
  v_pk_fma_f32 v[10:11], v[226:227], v[242:243], v[10:11] op_sel:[0,0,0] op_sel_hi:[1,0,1]
  v_pk_fma_f32 v[24:25], v[228:229], v[242:243], v[24:25] op_sel:[0,0,0] op_sel_hi:[1,0,1]
  v_pk_fma_f32 v[26:27], v[230:231], v[242:243], v[26:27] op_sel:[0,0,0] op_sel_hi:[1,0,1]
  v_pk_mul_f32 v[232:233], v[8:9], v[246:247] op_sel:[0,0] op_sel_hi:[1,0]
  v_pk_mul_f32 v[234:235], v[10:11], v[246:247] op_sel:[0,0] op_sel_hi:[1,0]
  v_pk_mul_f32 v[8:9], v[8:9], v[24:25]
  v_pk_mul_f32 v[10:11], v[10:11], v[26:27]
  v_exp_f32 v232, v232
  v_exp_f32 v233, v233
  v_exp_f32 v234, v234
  v_exp_f32 v235, v235
  s_nop 0
  v_pk_fma_f32 v[232:233], v[232:233], v[238:239], v[238:239] op_sel:[0,0,0] op_sel_hi:[1,0,0]
  v_pk_fma_f32 v[234:235], v[234:235], v[238:239], v[238:239] op_sel:[0,0,0] op_sel_hi:[1,0,0]
  v_rcp_f32 v232, v232
  v_rcp_f32 v233, v233
  v_rcp_f32 v234, v234
  v_rcp_f32 v235, v235
  s_nop 0
  v_pk_mul_f32 v[8:9], v[8:9], v[232:233]
  v_pk_mul_f32 v[10:11], v[10:11], v[234:235]
  v_cvt_pk_bf16_f32 v24, v8, v9
  v_cvt_pk_bf16_f32 v25, v10, v11
  v_pk_fma_f32 v[12:13], v[224:225], v[242:243], v[12:13] op_sel:[0,1,0] op_sel_hi:[1,1,1]
  v_pk_fma_f32 v[14:15], v[226:227], v[242:243], v[14:15] op_sel:[0,1,0] op_sel_hi:[1,1,1]
  v_pk_fma_f32 v[28:29], v[228:229], v[242:243], v[28:29] op_sel:[0,1,0] op_sel_hi:[1,1,1]
  v_pk_fma_f32 v[30:31], v[230:231], v[242:243], v[30:31] op_sel:[0,1,0] op_sel_hi:[1,1,1]
  v_pk_mul_f32 v[232:233], v[12:13], v[246:247] op_sel:[0,1] op_sel_hi:[1,1]
  v_pk_mul_f32 v[234:235], v[14:15], v[246:247] op_sel:[0,1] op_sel_hi:[1,1]
  v_pk_mul_f32 v[12:13], v[12:13], v[28:29]
  v_pk_mul_f32 v[14:15], v[14:15], v[30:31]
  v_exp_f32 v232, v232
  v_exp_f32 v233, v233
  v_exp_f32 v234, v234
  v_exp_f32 v235, v235
  s_nop 0
  v_pk_fma_f32 v[232:233], v[232:233], v[238:239], v[238:239] op_sel:[0,1,1] op_sel_hi:[1,1,1]
  v_pk_fma_f32 v[234:235], v[234:235], v[238:239], v[238:239] op_sel:[0,1,1] op_sel_hi:[1,1,1]
  v_rcp_f32 v232, v232
  v_rcp_f32 v233, v233
  v_rcp_f32 v234, v234
  v_rcp_f32 v235, v235
  s_nop 0
  v_pk_mul_f32 v[12:13], v[12:13], v[232:233]
  v_pk_mul_f32 v[14:15], v[14:15], v[234:235]
  v_cvt_pk_bf16_f32 v28, v12, v13
  v_cvt_pk_bf16_f32 v29, v14, v15
  s_waitcnt lgkmcnt(0)
  v_pk_fma_f32 v[32:33], v[0:1], v[240:241], v[32:33] op_sel:[0,0,0] op_sel_hi:[1,0,1]
  v_pk_fma_f32 v[34:35], v[2:3], v[240:241], v[34:35] op_sel:[0,0,0] op_sel_hi:[1,0,1]
  v_pk_fma_f32 v[48:49], v[4:5], v[240:241], v[48:49] op_sel:[0,0,0] op_sel_hi:[1,0,1]
  v_pk_fma_f32 v[50:51], v[6:7], v[240:241], v[50:51] op_sel:[0,0,0] op_sel_hi:[1,0,1]
  v_pk_mul_f32 v[232:233], v[32:33], v[244:245] op_sel:[0,0] op_sel_hi:[1,0]
  v_pk_mul_f32 v[234:235], v[34:35], v[244:245] op_sel:[0,0] op_sel_hi:[1,0]
  v_pk_mul_f32 v[32:33], v[32:33], v[48:49]
  v_pk_mul_f32 v[34:35], v[34:35], v[50:51]
  v_exp_f32 v232, v232
  v_exp_f32 v233, v233
  v_exp_f32 v234, v234
  v_exp_f32 v235, v235
  s_nop 0
  v_pk_fma_f32 v[232:233], v[232:233], v[236:237], v[236:237] op_sel:[0,0,0] op_sel_hi:[1,0,0]
  v_pk_fma_f32 v[234:235], v[234:235], v[236:237], v[236:237] op_sel:[0,0,0] op_sel_hi:[1,0,0]
  v_rcp_f32 v232, v232
  v_rcp_f32 v233, v233
  v_rcp_f32 v234, v234
  v_rcp_f32 v235, v235
  s_nop 0
  v_pk_mul_f32 v[32:33], v[32:33], v[232:233]
  v_pk_mul_f32 v[34:35], v[34:35], v[234:235]
  v_cvt_pk_bf16_f32 v18, v32, v33
  v_cvt_pk_bf16_f32 v19, v34, v35
  buffer_store_dwordx4 v[16:19], v248, s[4:7], s57 offen offset:0 sc1
  v_pk_fma_f32 v[36:37], v[0:1], v[240:241], v[36:37] op_sel:[0,1,0] op_sel_hi:[1,1,1]
  v_pk_fma_f32 v[38:39], v[2:3], v[240:241], v[38:39] op_sel:[0,1,0] op_sel_hi:[1,1,1]
  v_pk_fma_f32 v[52:53], v[4:5], v[240:241], v[52:53] op_sel:[0,1,0] op_sel_hi:[1,1,1]
  v_pk_fma_f32 v[54:55], v[6:7], v[240:241], v[54:55] op_sel:[0,1,0] op_sel_hi:[1,1,1]
  v_pk_mul_f32 v[232:233], v[36:37], v[244:245] op_sel:[0,1] op_sel_hi:[1,1]
  v_pk_mul_f32 v[234:235], v[38:39], v[244:245] op_sel:[0,1] op_sel_hi:[1,1]
  v_pk_mul_f32 v[36:37], v[36:37], v[52:53]
  v_pk_mul_f32 v[38:39], v[38:39], v[54:55]
  v_exp_f32 v232, v232
  v_exp_f32 v233, v233
  v_exp_f32 v234, v234
  v_exp_f32 v235, v235
  s_nop 0
  v_pk_fma_f32 v[232:233], v[232:233], v[236:237], v[236:237] op_sel:[0,1,1] op_sel_hi:[1,1,1]
  v_pk_fma_f32 v[234:235], v[234:235], v[236:237], v[236:237] op_sel:[0,1,1] op_sel_hi:[1,1,1]
  v_rcp_f32 v232, v232
  v_rcp_f32 v233, v233
  v_rcp_f32 v234, v234
  v_rcp_f32 v235, v235
  s_nop 0
  v_pk_mul_f32 v[36:37], v[36:37], v[232:233]
  v_pk_mul_f32 v[38:39], v[38:39], v[234:235]
  v_cvt_pk_bf16_f32 v22, v36, v37
  v_cvt_pk_bf16_f32 v23, v38, v39
  ds_read_b128 v[32:35], v250 offset:256
  ds_read_b128 v[36:39], v250 offset:320
  buffer_store_dwordx4 v[20:23], v248, s[4:7], s58 offen offset:0 sc1
  v_pk_fma_f32 v[40:41], v[0:1], v[242:243], v[40:41] op_sel:[0,0,0] op_sel_hi:[1,0,1]
  v_pk_fma_f32 v[42:43], v[2:3], v[242:243], v[42:43] op_sel:[0,0,0] op_sel_hi:[1,0,1]
  v_pk_fma_f32 v[56:57], v[4:5], v[242:243], v[56:57] op_sel:[0,0,0] op_sel_hi:[1,0,1]
  v_pk_fma_f32 v[58:59], v[6:7], v[242:243], v[58:59] op_sel:[0,0,0] op_sel_hi:[1,0,1]
  v_pk_mul_f32 v[232:233], v[40:41], v[246:247] op_sel:[0,0] op_sel_hi:[1,0]
  v_pk_mul_f32 v[234:235], v[42:43], v[246:247] op_sel:[0,0] op_sel_hi:[1,0]
  v_pk_mul_f32 v[40:41], v[40:41], v[56:57]
  v_pk_mul_f32 v[42:43], v[42:43], v[58:59]
  v_exp_f32 v232, v232
  v_exp_f32 v233, v233
  v_exp_f32 v234, v234
  v_exp_f32 v235, v235
  s_nop 0
  v_pk_fma_f32 v[232:233], v[232:233], v[238:239], v[238:239] op_sel:[0,0,0] op_sel_hi:[1,0,0]
  v_pk_fma_f32 v[234:235], v[234:235], v[238:239], v[238:239] op_sel:[0,0,0] op_sel_hi:[1,0,0]
  v_rcp_f32 v232, v232
  v_rcp_f32 v233, v233
  v_rcp_f32 v234, v234
  v_rcp_f32 v235, v235
  s_nop 0
  v_pk_mul_f32 v[40:41], v[40:41], v[232:233]
  v_pk_mul_f32 v[42:43], v[42:43], v[234:235]
  v_cvt_pk_bf16_f32 v26, v40, v41
  v_cvt_pk_bf16_f32 v27, v42, v43
  buffer_store_dwordx4 v[24:27], v248, s[4:7], s59 offen offset:0 sc1
  v_pk_fma_f32 v[44:45], v[0:1], v[242:243], v[44:45] op_sel:[0,1,0] op_sel_hi:[1,1,1]
  v_pk_fma_f32 v[46:47], v[2:3], v[242:243], v[46:47] op_sel:[0,1,0] op_sel_hi:[1,1,1]
  v_pk_fma_f32 v[60:61], v[4:5], v[242:243], v[60:61] op_sel:[0,1,0] op_sel_hi:[1,1,1]
  v_pk_fma_f32 v[62:63], v[6:7], v[242:243], v[62:63] op_sel:[0,1,0] op_sel_hi:[1,1,1]
  v_pk_mul_f32 v[232:233], v[44:45], v[246:247] op_sel:[0,1] op_sel_hi:[1,1]
  v_pk_mul_f32 v[234:235], v[46:47], v[246:247] op_sel:[0,1] op_sel_hi:[1,1]
  v_pk_mul_f32 v[44:45], v[44:45], v[60:61]
  v_pk_mul_f32 v[46:47], v[46:47], v[62:63]
  v_exp_f32 v232, v232
  v_exp_f32 v233, v233
  v_exp_f32 v234, v234
  v_exp_f32 v235, v235
  s_nop 0
  v_pk_fma_f32 v[232:233], v[232:233], v[238:239], v[238:239] op_sel:[0,1,1] op_sel_hi:[1,1,1]
  v_pk_fma_f32 v[234:235], v[234:235], v[238:239], v[238:239] op_sel:[0,1,1] op_sel_hi:[1,1,1]
  v_rcp_f32 v232, v232
  v_rcp_f32 v233, v233
  v_rcp_f32 v234, v234
  v_rcp_f32 v235, v235
  s_nop 0
  v_pk_mul_f32 v[44:45], v[44:45], v[232:233]
  v_pk_mul_f32 v[46:47], v[46:47], v[234:235]
  v_cvt_pk_bf16_f32 v30, v44, v45
  v_cvt_pk_bf16_f32 v31, v46, v47
  buffer_store_dwordx4 v[28:31], v248, s[4:7], s60 offen offset:0 sc1
  s_waitcnt lgkmcnt(0)
  v_pk_fma_f32 v[64:65], v[32:33], v[240:241], v[64:65] op_sel:[0,0,0] op_sel_hi:[1,0,1]
  v_pk_fma_f32 v[66:67], v[34:35], v[240:241], v[66:67] op_sel:[0,0,0] op_sel_hi:[1,0,1]
  v_pk_fma_f32 v[80:81], v[36:37], v[240:241], v[80:81] op_sel:[0,0,0] op_sel_hi:[1,0,1]
  v_pk_fma_f32 v[82:83], v[38:39], v[240:241], v[82:83] op_sel:[0,0,0] op_sel_hi:[1,0,1]
  v_pk_mul_f32 v[232:233], v[64:65], v[244:245] op_sel:[0,0] op_sel_hi:[1,0]
  v_pk_mul_f32 v[234:235], v[66:67], v[244:245] op_sel:[0,0] op_sel_hi:[1,0]
  v_pk_mul_f32 v[64:65], v[64:65], v[80:81]
  v_pk_mul_f32 v[66:67], v[66:67], v[82:83]
  v_exp_f32 v232, v232
  v_exp_f32 v233, v233
  v_exp_f32 v234, v234
  v_exp_f32 v235, v235
  s_nop 0
  v_pk_fma_f32 v[232:233], v[232:233], v[236:237], v[236:237] op_sel:[0,0,0] op_sel_hi:[1,0,0]
  v_pk_fma_f32 v[234:235], v[234:235], v[236:237], v[236:237] op_sel:[0,0,0] op_sel_hi:[1,0,0]
  v_rcp_f32 v232, v232
  v_rcp_f32 v233, v233
  v_rcp_f32 v234, v234
  v_rcp_f32 v235, v235
  s_nop 0
  v_pk_mul_f32 v[64:65], v[64:65], v[232:233]
  v_pk_mul_f32 v[66:67], v[66:67], v[234:235]
  v_cvt_pk_bf16_f32 v80, v64, v65
  v_cvt_pk_bf16_f32 v81, v66, v67
  v_pk_fma_f32 v[68:69], v[32:33], v[240:241], v[68:69] op_sel:[0,1,0] op_sel_hi:[1,1,1]
  v_pk_fma_f32 v[70:71], v[34:35], v[240:241], v[70:71] op_sel:[0,1,0] op_sel_hi:[1,1,1]
  v_pk_fma_f32 v[84:85], v[36:37], v[240:241], v[84:85] op_sel:[0,1,0] op_sel_hi:[1,1,1]
  v_pk_fma_f32 v[86:87], v[38:39], v[240:241], v[86:87] op_sel:[0,1,0] op_sel_hi:[1,1,1]
  v_pk_mul_f32 v[232:233], v[68:69], v[244:245] op_sel:[0,1] op_sel_hi:[1,1]
  v_pk_mul_f32 v[234:235], v[70:71], v[244:245] op_sel:[0,1] op_sel_hi:[1,1]
  v_pk_mul_f32 v[68:69], v[68:69], v[84:85]
  v_pk_mul_f32 v[70:71], v[70:71], v[86:87]
  v_exp_f32 v232, v232
  v_exp_f32 v233, v233
  v_exp_f32 v234, v234
  v_exp_f32 v235, v235
  s_nop 0
  v_pk_fma_f32 v[232:233], v[232:233], v[236:237], v[236:237] op_sel:[0,1,1] op_sel_hi:[1,1,1]
  v_pk_fma_f32 v[234:235], v[234:235], v[236:237], v[236:237] op_sel:[0,1,1] op_sel_hi:[1,1,1]
  v_rcp_f32 v232, v232
  v_rcp_f32 v233, v233
  v_rcp_f32 v234, v234
  v_rcp_f32 v235, v235
  s_nop 0
  v_pk_mul_f32 v[68:69], v[68:69], v[232:233]
  v_pk_mul_f32 v[70:71], v[70:71], v[234:235]
  v_cvt_pk_bf16_f32 v84, v68, v69
  v_cvt_pk_bf16_f32 v85, v70, v71
  ds_read_b128 v[64:67], v250 offset:384
  ds_read_b128 v[68:71], v250 offset:448
  v_pk_fma_f32 v[72:73], v[32:33], v[242:243], v[72:73] op_sel:[0,0,0] op_sel_hi:[1,0,1]
  v_pk_fma_f32 v[74:75], v[34:35], v[242:243], v[74:75] op_sel:[0,0,0] op_sel_hi:[1,0,1]
  v_pk_fma_f32 v[88:89], v[36:37], v[242:243], v[88:89] op_sel:[0,0,0] op_sel_hi:[1,0,1]
  v_pk_fma_f32 v[90:91], v[38:39], v[242:243], v[90:91] op_sel:[0,0,0] op_sel_hi:[1,0,1]
  v_pk_mul_f32 v[232:233], v[72:73], v[246:247] op_sel:[0,0] op_sel_hi:[1,0]
  v_pk_mul_f32 v[234:235], v[74:75], v[246:247] op_sel:[0,0] op_sel_hi:[1,0]
  v_pk_mul_f32 v[72:73], v[72:73], v[88:89]
  v_pk_mul_f32 v[74:75], v[74:75], v[90:91]
  v_exp_f32 v232, v232
  v_exp_f32 v233, v233
  v_exp_f32 v234, v234
  v_exp_f32 v235, v235
  s_nop 0
  v_pk_fma_f32 v[232:233], v[232:233], v[238:239], v[238:239] op_sel:[0,0,0] op_sel_hi:[1,0,0]
  v_pk_fma_f32 v[234:235], v[234:235], v[238:239], v[238:239] op_sel:[0,0,0] op_sel_hi:[1,0,0]
  v_rcp_f32 v232, v232
  v_rcp_f32 v233, v233
  v_rcp_f32 v234, v234
  v_rcp_f32 v235, v235
  s_nop 0
  v_pk_mul_f32 v[72:73], v[72:73], v[232:233]
  v_pk_mul_f32 v[74:75], v[74:75], v[234:235]
  v_cvt_pk_bf16_f32 v88, v72, v73
  v_cvt_pk_bf16_f32 v89, v74, v75
  v_pk_fma_f32 v[76:77], v[32:33], v[242:243], v[76:77] op_sel:[0,1,0] op_sel_hi:[1,1,1]
  v_pk_fma_f32 v[78:79], v[34:35], v[242:243], v[78:79] op_sel:[0,1,0] op_sel_hi:[1,1,1]
  v_pk_fma_f32 v[92:93], v[36:37], v[242:243], v[92:93] op_sel:[0,1,0] op_sel_hi:[1,1,1]
  v_pk_fma_f32 v[94:95], v[38:39], v[242:243], v[94:95] op_sel:[0,1,0] op_sel_hi:[1,1,1]
  v_pk_mul_f32 v[232:233], v[76:77], v[246:247] op_sel:[0,1] op_sel_hi:[1,1]
  v_pk_mul_f32 v[234:235], v[78:79], v[246:247] op_sel:[0,1] op_sel_hi:[1,1]
  v_pk_mul_f32 v[76:77], v[76:77], v[92:93]
  v_pk_mul_f32 v[78:79], v[78:79], v[94:95]
  v_exp_f32 v232, v232
  v_exp_f32 v233, v233
  v_exp_f32 v234, v234
  v_exp_f32 v235, v235
  s_nop 0
  v_pk_fma_f32 v[232:233], v[232:233], v[238:239], v[238:239] op_sel:[0,1,1] op_sel_hi:[1,1,1]
  v_pk_fma_f32 v[234:235], v[234:235], v[238:239], v[238:239] op_sel:[0,1,1] op_sel_hi:[1,1,1]
  v_rcp_f32 v232, v232
  v_rcp_f32 v233, v233
  v_rcp_f32 v234, v234
  v_rcp_f32 v235, v235
  s_nop 0
  v_pk_mul_f32 v[76:77], v[76:77], v[232:233]
  v_pk_mul_f32 v[78:79], v[78:79], v[234:235]
  v_cvt_pk_bf16_f32 v92, v76, v77
  v_cvt_pk_bf16_f32 v93, v78, v79
  s_waitcnt lgkmcnt(0)
  v_pk_fma_f32 v[96:97], v[64:65], v[240:241], v[96:97] op_sel:[0,0,0] op_sel_hi:[1,0,1]
  v_pk_fma_f32 v[98:99], v[66:67], v[240:241], v[98:99] op_sel:[0,0,0] op_sel_hi:[1,0,1]
  v_pk_fma_f32 v[112:113], v[68:69], v[240:241], v[112:113] op_sel:[0,0,0] op_sel_hi:[1,0,1]
  v_pk_fma_f32 v[114:115], v[70:71], v[240:241], v[114:115] op_sel:[0,0,0] op_sel_hi:[1,0,1]
  v_pk_mul_f32 v[232:233], v[96:97], v[244:245] op_sel:[0,0] op_sel_hi:[1,0]
  v_pk_mul_f32 v[234:235], v[98:99], v[244:245] op_sel:[0,0] op_sel_hi:[1,0]
  v_pk_mul_f32 v[96:97], v[96:97], v[112:113]
  v_pk_mul_f32 v[98:99], v[98:99], v[114:115]
  v_exp_f32 v232, v232
  v_exp_f32 v233, v233
  v_exp_f32 v234, v234
  v_exp_f32 v235, v235
  s_nop 0
  v_pk_fma_f32 v[232:233], v[232:233], v[236:237], v[236:237] op_sel:[0,0,0] op_sel_hi:[1,0,0]
  v_pk_fma_f32 v[234:235], v[234:235], v[236:237], v[236:237] op_sel:[0,0,0] op_sel_hi:[1,0,0]
  v_rcp_f32 v232, v232
  v_rcp_f32 v233, v233
  v_rcp_f32 v234, v234
  v_rcp_f32 v235, v235
  s_nop 0
  v_pk_mul_f32 v[96:97], v[96:97], v[232:233]
  v_pk_mul_f32 v[98:99], v[98:99], v[234:235]
  v_cvt_pk_bf16_f32 v82, v96, v97
  v_cvt_pk_bf16_f32 v83, v98, v99
  buffer_store_dwordx4 v[80:83], v248, s[4:7], s57 offen offset:1024 sc1
  v_pk_fma_f32 v[100:101], v[64:65], v[240:241], v[100:101] op_sel:[0,1,0] op_sel_hi:[1,1,1]
  v_pk_fma_f32 v[102:103], v[66:67], v[240:241], v[102:103] op_sel:[0,1,0] op_sel_hi:[1,1,1]
  v_pk_fma_f32 v[116:117], v[68:69], v[240:241], v[116:117] op_sel:[0,1,0] op_sel_hi:[1,1,1]
  v_pk_fma_f32 v[118:119], v[70:71], v[240:241], v[118:119] op_sel:[0,1,0] op_sel_hi:[1,1,1]
  v_pk_mul_f32 v[232:233], v[100:101], v[244:245] op_sel:[0,1] op_sel_hi:[1,1]
  v_pk_mul_f32 v[234:235], v[102:103], v[244:245] op_sel:[0,1] op_sel_hi:[1,1]
  v_pk_mul_f32 v[100:101], v[100:101], v[116:117]
  v_pk_mul_f32 v[102:103], v[102:103], v[118:119]
  v_exp_f32 v232, v232
  v_exp_f32 v233, v233
  v_exp_f32 v234, v234
  v_exp_f32 v235, v235
  s_nop 0
  v_pk_fma_f32 v[232:233], v[232:233], v[236:237], v[236:237] op_sel:[0,1,1] op_sel_hi:[1,1,1]
  v_pk_fma_f32 v[234:235], v[234:235], v[236:237], v[236:237] op_sel:[0,1,1] op_sel_hi:[1,1,1]
  v_rcp_f32 v232, v232
  v_rcp_f32 v233, v233
  v_rcp_f32 v234, v234
  v_rcp_f32 v235, v235
  s_nop 0
  v_pk_mul_f32 v[100:101], v[100:101], v[232:233]
  v_pk_mul_f32 v[102:103], v[102:103], v[234:235]
  v_cvt_pk_bf16_f32 v86, v100, v101
  v_cvt_pk_bf16_f32 v87, v102, v103
  ds_read_b128 v[96:99], v250 offset:512
  ds_read_b128 v[100:103], v250 offset:576
  buffer_store_dwordx4 v[84:87], v248, s[4:7], s58 offen offset:1024 sc1
  v_pk_fma_f32 v[104:105], v[64:65], v[242:243], v[104:105] op_sel:[0,0,0] op_sel_hi:[1,0,1]
  v_pk_fma_f32 v[106:107], v[66:67], v[242:243], v[106:107] op_sel:[0,0,0] op_sel_hi:[1,0,1]
  v_pk_fma_f32 v[120:121], v[68:69], v[242:243], v[120:121] op_sel:[0,0,0] op_sel_hi:[1,0,1]
  v_pk_fma_f32 v[122:123], v[70:71], v[242:243], v[122:123] op_sel:[0,0,0] op_sel_hi:[1,0,1]
  v_pk_mul_f32 v[232:233], v[104:105], v[246:247] op_sel:[0,0] op_sel_hi:[1,0]
  v_pk_mul_f32 v[234:235], v[106:107], v[246:247] op_sel:[0,0] op_sel_hi:[1,0]
  v_pk_mul_f32 v[104:105], v[104:105], v[120:121]
  v_pk_mul_f32 v[106:107], v[106:107], v[122:123]
  v_exp_f32 v232, v232
  v_exp_f32 v233, v233
  v_exp_f32 v234, v234
  v_exp_f32 v235, v235
  s_nop 0
  v_pk_fma_f32 v[232:233], v[232:233], v[238:239], v[238:239] op_sel:[0,0,0] op_sel_hi:[1,0,0]
  v_pk_fma_f32 v[234:235], v[234:235], v[238:239], v[238:239] op_sel:[0,0,0] op_sel_hi:[1,0,0]
  v_rcp_f32 v232, v232
  v_rcp_f32 v233, v233
  v_rcp_f32 v234, v234
  v_rcp_f32 v235, v235
  s_nop 0
  v_pk_mul_f32 v[104:105], v[104:105], v[232:233]
  v_pk_mul_f32 v[106:107], v[106:107], v[234:235]
  v_cvt_pk_bf16_f32 v90, v104, v105
  v_cvt_pk_bf16_f32 v91, v106, v107
  buffer_store_dwordx4 v[88:91], v248, s[4:7], s59 offen offset:1024 sc1
  v_pk_fma_f32 v[108:109], v[64:65], v[242:243], v[108:109] op_sel:[0,1,0] op_sel_hi:[1,1,1]
  v_pk_fma_f32 v[110:111], v[66:67], v[242:243], v[110:111] op_sel:[0,1,0] op_sel_hi:[1,1,1]
  v_pk_fma_f32 v[124:125], v[68:69], v[242:243], v[124:125] op_sel:[0,1,0] op_sel_hi:[1,1,1]
  v_pk_fma_f32 v[126:127], v[70:71], v[242:243], v[126:127] op_sel:[0,1,0] op_sel_hi:[1,1,1]
  v_pk_mul_f32 v[232:233], v[108:109], v[246:247] op_sel:[0,1] op_sel_hi:[1,1]
  v_pk_mul_f32 v[234:235], v[110:111], v[246:247] op_sel:[0,1] op_sel_hi:[1,1]
  v_pk_mul_f32 v[108:109], v[108:109], v[124:125]
  v_pk_mul_f32 v[110:111], v[110:111], v[126:127]
  v_exp_f32 v232, v232
  v_exp_f32 v233, v233
  v_exp_f32 v234, v234
  v_exp_f32 v235, v235
  s_nop 0
  v_pk_fma_f32 v[232:233], v[232:233], v[238:239], v[238:239] op_sel:[0,1,1] op_sel_hi:[1,1,1]
  v_pk_fma_f32 v[234:235], v[234:235], v[238:239], v[238:239] op_sel:[0,1,1] op_sel_hi:[1,1,1]
  v_rcp_f32 v232, v232
  v_rcp_f32 v233, v233
  v_rcp_f32 v234, v234
  v_rcp_f32 v235, v235
  s_nop 0
  v_pk_mul_f32 v[108:109], v[108:109], v[232:233]
  v_pk_mul_f32 v[110:111], v[110:111], v[234:235]
  v_cvt_pk_bf16_f32 v94, v108, v109
  v_cvt_pk_bf16_f32 v95, v110, v111
  buffer_store_dwordx4 v[92:95], v248, s[4:7], s60 offen offset:1024 sc1
  s_waitcnt lgkmcnt(0)
  v_pk_fma_f32 v[128:129], v[96:97], v[240:241], v[128:129] op_sel:[0,0,0] op_sel_hi:[1,0,1]
  v_pk_fma_f32 v[130:131], v[98:99], v[240:241], v[130:131] op_sel:[0,0,0] op_sel_hi:[1,0,1]
  v_pk_fma_f32 v[144:145], v[100:101], v[240:241], v[144:145] op_sel:[0,0,0] op_sel_hi:[1,0,1]
  v_pk_fma_f32 v[146:147], v[102:103], v[240:241], v[146:147] op_sel:[0,0,0] op_sel_hi:[1,0,1]
  v_pk_mul_f32 v[232:233], v[128:129], v[244:245] op_sel:[0,0] op_sel_hi:[1,0]
  v_pk_mul_f32 v[234:235], v[130:131], v[244:245] op_sel:[0,0] op_sel_hi:[1,0]
  v_pk_mul_f32 v[128:129], v[128:129], v[144:145]
  v_pk_mul_f32 v[130:131], v[130:131], v[146:147]
  v_exp_f32 v232, v232
  v_exp_f32 v233, v233
  v_exp_f32 v234, v234
  v_exp_f32 v235, v235
  s_nop 0
  v_pk_fma_f32 v[232:233], v[232:233], v[236:237], v[236:237] op_sel:[0,0,0] op_sel_hi:[1,0,0]
  v_pk_fma_f32 v[234:235], v[234:235], v[236:237], v[236:237] op_sel:[0,0,0] op_sel_hi:[1,0,0]
  v_rcp_f32 v232, v232
  v_rcp_f32 v233, v233
  v_rcp_f32 v234, v234
  v_rcp_f32 v235, v235
  s_nop 0
  v_pk_mul_f32 v[128:129], v[128:129], v[232:233]
  v_pk_mul_f32 v[130:131], v[130:131], v[234:235]
  v_cvt_pk_bf16_f32 v144, v128, v129
  v_cvt_pk_bf16_f32 v145, v130, v131
  v_pk_fma_f32 v[132:133], v[96:97], v[240:241], v[132:133] op_sel:[0,1,0] op_sel_hi:[1,1,1]
  v_pk_fma_f32 v[134:135], v[98:99], v[240:241], v[134:135] op_sel:[0,1,0] op_sel_hi:[1,1,1]
  v_pk_fma_f32 v[148:149], v[100:101], v[240:241], v[148:149] op_sel:[0,1,0] op_sel_hi:[1,1,1]
  v_pk_fma_f32 v[150:151], v[102:103], v[240:241], v[150:151] op_sel:[0,1,0] op_sel_hi:[1,1,1]
  v_pk_mul_f32 v[232:233], v[132:133], v[244:245] op_sel:[0,1] op_sel_hi:[1,1]
  v_pk_mul_f32 v[234:235], v[134:135], v[244:245] op_sel:[0,1] op_sel_hi:[1,1]
  v_pk_mul_f32 v[132:133], v[132:133], v[148:149]
  v_pk_mul_f32 v[134:135], v[134:135], v[150:151]
  v_exp_f32 v232, v232
  v_exp_f32 v233, v233
  v_exp_f32 v234, v234
  v_exp_f32 v235, v235
  s_nop 0
  v_pk_fma_f32 v[232:233], v[232:233], v[236:237], v[236:237] op_sel:[0,1,1] op_sel_hi:[1,1,1]
  v_pk_fma_f32 v[234:235], v[234:235], v[236:237], v[236:237] op_sel:[0,1,1] op_sel_hi:[1,1,1]
  v_rcp_f32 v232, v232
  v_rcp_f32 v233, v233
  v_rcp_f32 v234, v234
  v_rcp_f32 v235, v235
  s_nop 0
  v_pk_mul_f32 v[132:133], v[132:133], v[232:233]
  v_pk_mul_f32 v[134:135], v[134:135], v[234:235]
  v_cvt_pk_bf16_f32 v148, v132, v133
  v_cvt_pk_bf16_f32 v149, v134, v135
  ds_read_b128 v[128:131], v250 offset:640
  ds_read_b128 v[132:135], v250 offset:704
  v_pk_fma_f32 v[136:137], v[96:97], v[242:243], v[136:137] op_sel:[0,0,0] op_sel_hi:[1,0,1]
  v_pk_fma_f32 v[138:139], v[98:99], v[242:243], v[138:139] op_sel:[0,0,0] op_sel_hi:[1,0,1]
  v_pk_fma_f32 v[152:153], v[100:101], v[242:243], v[152:153] op_sel:[0,0,0] op_sel_hi:[1,0,1]
  v_pk_fma_f32 v[154:155], v[102:103], v[242:243], v[154:155] op_sel:[0,0,0] op_sel_hi:[1,0,1]
  v_pk_mul_f32 v[232:233], v[136:137], v[246:247] op_sel:[0,0] op_sel_hi:[1,0]
  v_pk_mul_f32 v[234:235], v[138:139], v[246:247] op_sel:[0,0] op_sel_hi:[1,0]
  v_pk_mul_f32 v[136:137], v[136:137], v[152:153]
  v_pk_mul_f32 v[138:139], v[138:139], v[154:155]
  v_exp_f32 v232, v232
  v_exp_f32 v233, v233
  v_exp_f32 v234, v234
  v_exp_f32 v235, v235
  s_nop 0
  v_pk_fma_f32 v[232:233], v[232:233], v[238:239], v[238:239] op_sel:[0,0,0] op_sel_hi:[1,0,0]
  v_pk_fma_f32 v[234:235], v[234:235], v[238:239], v[238:239] op_sel:[0,0,0] op_sel_hi:[1,0,0]
  v_rcp_f32 v232, v232
  v_rcp_f32 v233, v233
  v_rcp_f32 v234, v234
  v_rcp_f32 v235, v235
  s_nop 0
  v_pk_mul_f32 v[136:137], v[136:137], v[232:233]
  v_pk_mul_f32 v[138:139], v[138:139], v[234:235]
  v_cvt_pk_bf16_f32 v152, v136, v137
  v_cvt_pk_bf16_f32 v153, v138, v139
  v_pk_fma_f32 v[140:141], v[96:97], v[242:243], v[140:141] op_sel:[0,1,0] op_sel_hi:[1,1,1]
  v_pk_fma_f32 v[142:143], v[98:99], v[242:243], v[142:143] op_sel:[0,1,0] op_sel_hi:[1,1,1]
  v_pk_fma_f32 v[156:157], v[100:101], v[242:243], v[156:157] op_sel:[0,1,0] op_sel_hi:[1,1,1]
  v_pk_fma_f32 v[158:159], v[102:103], v[242:243], v[158:159] op_sel:[0,1,0] op_sel_hi:[1,1,1]
  v_pk_mul_f32 v[232:233], v[140:141], v[246:247] op_sel:[0,1] op_sel_hi:[1,1]
  v_pk_mul_f32 v[234:235], v[142:143], v[246:247] op_sel:[0,1] op_sel_hi:[1,1]
  v_pk_mul_f32 v[140:141], v[140:141], v[156:157]
  v_pk_mul_f32 v[142:143], v[142:143], v[158:159]
  v_exp_f32 v232, v232
  v_exp_f32 v233, v233
  v_exp_f32 v234, v234
  v_exp_f32 v235, v235
  s_nop 0
  v_pk_fma_f32 v[232:233], v[232:233], v[238:239], v[238:239] op_sel:[0,1,1] op_sel_hi:[1,1,1]
  v_pk_fma_f32 v[234:235], v[234:235], v[238:239], v[238:239] op_sel:[0,1,1] op_sel_hi:[1,1,1]
  v_rcp_f32 v232, v232
  v_rcp_f32 v233, v233
  v_rcp_f32 v234, v234
  v_rcp_f32 v235, v235
  s_nop 0
  v_pk_mul_f32 v[140:141], v[140:141], v[232:233]
  v_pk_mul_f32 v[142:143], v[142:143], v[234:235]
  v_cvt_pk_bf16_f32 v156, v140, v141
  v_cvt_pk_bf16_f32 v157, v142, v143
  s_waitcnt lgkmcnt(0)
  v_pk_fma_f32 v[160:161], v[128:129], v[240:241], v[160:161] op_sel:[0,0,0] op_sel_hi:[1,0,1]
  v_pk_fma_f32 v[162:163], v[130:131], v[240:241], v[162:163] op_sel:[0,0,0] op_sel_hi:[1,0,1]
  v_pk_fma_f32 v[176:177], v[132:133], v[240:241], v[176:177] op_sel:[0,0,0] op_sel_hi:[1,0,1]
  v_pk_fma_f32 v[178:179], v[134:135], v[240:241], v[178:179] op_sel:[0,0,0] op_sel_hi:[1,0,1]
  v_pk_mul_f32 v[232:233], v[160:161], v[244:245] op_sel:[0,0] op_sel_hi:[1,0]
  v_pk_mul_f32 v[234:235], v[162:163], v[244:245] op_sel:[0,0] op_sel_hi:[1,0]
  v_pk_mul_f32 v[160:161], v[160:161], v[176:177]
  v_pk_mul_f32 v[162:163], v[162:163], v[178:179]
  v_exp_f32 v232, v232
  v_exp_f32 v233, v233
  v_exp_f32 v234, v234
  v_exp_f32 v235, v235
  s_nop 0
  v_pk_fma_f32 v[232:233], v[232:233], v[236:237], v[236:237] op_sel:[0,0,0] op_sel_hi:[1,0,0]
  v_pk_fma_f32 v[234:235], v[234:235], v[236:237], v[236:237] op_sel:[0,0,0] op_sel_hi:[1,0,0]
  v_rcp_f32 v232, v232
  v_rcp_f32 v233, v233
  v_rcp_f32 v234, v234
  v_rcp_f32 v235, v235
  s_nop 0
  v_pk_mul_f32 v[160:161], v[160:161], v[232:233]
  v_pk_mul_f32 v[162:163], v[162:163], v[234:235]
  v_cvt_pk_bf16_f32 v146, v160, v161
  v_cvt_pk_bf16_f32 v147, v162, v163
  buffer_store_dwordx4 v[144:147], v248, s[4:7], s57 offen offset:2048 sc1
  v_pk_fma_f32 v[164:165], v[128:129], v[240:241], v[164:165] op_sel:[0,1,0] op_sel_hi:[1,1,1]
  v_pk_fma_f32 v[166:167], v[130:131], v[240:241], v[166:167] op_sel:[0,1,0] op_sel_hi:[1,1,1]
  v_pk_fma_f32 v[180:181], v[132:133], v[240:241], v[180:181] op_sel:[0,1,0] op_sel_hi:[1,1,1]
  v_pk_fma_f32 v[182:183], v[134:135], v[240:241], v[182:183] op_sel:[0,1,0] op_sel_hi:[1,1,1]
  v_pk_mul_f32 v[232:233], v[164:165], v[244:245] op_sel:[0,1] op_sel_hi:[1,1]
  v_pk_mul_f32 v[234:235], v[166:167], v[244:245] op_sel:[0,1] op_sel_hi:[1,1]
  v_pk_mul_f32 v[164:165], v[164:165], v[180:181]
  v_pk_mul_f32 v[166:167], v[166:167], v[182:183]
  v_exp_f32 v232, v232
  v_exp_f32 v233, v233
  v_exp_f32 v234, v234
  v_exp_f32 v235, v235
  s_nop 0
  v_pk_fma_f32 v[232:233], v[232:233], v[236:237], v[236:237] op_sel:[0,1,1] op_sel_hi:[1,1,1]
  v_pk_fma_f32 v[234:235], v[234:235], v[236:237], v[236:237] op_sel:[0,1,1] op_sel_hi:[1,1,1]
  v_rcp_f32 v232, v232
  v_rcp_f32 v233, v233
  v_rcp_f32 v234, v234
  v_rcp_f32 v235, v235
  s_nop 0
  v_pk_mul_f32 v[164:165], v[164:165], v[232:233]
  v_pk_mul_f32 v[166:167], v[166:167], v[234:235]
  v_cvt_pk_bf16_f32 v150, v164, v165
  v_cvt_pk_bf16_f32 v151, v166, v167
  ds_read_b128 v[160:163], v250 offset:768
  ds_read_b128 v[164:167], v250 offset:832
  buffer_store_dwordx4 v[148:151], v248, s[4:7], s58 offen offset:2048 sc1
  v_pk_fma_f32 v[168:169], v[128:129], v[242:243], v[168:169] op_sel:[0,0,0] op_sel_hi:[1,0,1]
  v_pk_fma_f32 v[170:171], v[130:131], v[242:243], v[170:171] op_sel:[0,0,0] op_sel_hi:[1,0,1]
  v_pk_fma_f32 v[184:185], v[132:133], v[242:243], v[184:185] op_sel:[0,0,0] op_sel_hi:[1,0,1]
  v_pk_fma_f32 v[186:187], v[134:135], v[242:243], v[186:187] op_sel:[0,0,0] op_sel_hi:[1,0,1]
  v_pk_mul_f32 v[232:233], v[168:169], v[246:247] op_sel:[0,0] op_sel_hi:[1,0]
  v_pk_mul_f32 v[234:235], v[170:171], v[246:247] op_sel:[0,0] op_sel_hi:[1,0]
  v_pk_mul_f32 v[168:169], v[168:169], v[184:185]
  v_pk_mul_f32 v[170:171], v[170:171], v[186:187]
  v_exp_f32 v232, v232
  v_exp_f32 v233, v233
  v_exp_f32 v234, v234
  v_exp_f32 v235, v235
  s_nop 0
  v_pk_fma_f32 v[232:233], v[232:233], v[238:239], v[238:239] op_sel:[0,0,0] op_sel_hi:[1,0,0]
  v_pk_fma_f32 v[234:235], v[234:235], v[238:239], v[238:239] op_sel:[0,0,0] op_sel_hi:[1,0,0]
  v_rcp_f32 v232, v232
  v_rcp_f32 v233, v233
  v_rcp_f32 v234, v234
  v_rcp_f32 v235, v235
  s_nop 0
  v_pk_mul_f32 v[168:169], v[168:169], v[232:233]
  v_pk_mul_f32 v[170:171], v[170:171], v[234:235]
  v_cvt_pk_bf16_f32 v154, v168, v169
  v_cvt_pk_bf16_f32 v155, v170, v171
  buffer_store_dwordx4 v[152:155], v248, s[4:7], s59 offen offset:2048 sc1
  v_pk_fma_f32 v[172:173], v[128:129], v[242:243], v[172:173] op_sel:[0,1,0] op_sel_hi:[1,1,1]
  v_pk_fma_f32 v[174:175], v[130:131], v[242:243], v[174:175] op_sel:[0,1,0] op_sel_hi:[1,1,1]
  v_pk_fma_f32 v[188:189], v[132:133], v[242:243], v[188:189] op_sel:[0,1,0] op_sel_hi:[1,1,1]
  v_pk_fma_f32 v[190:191], v[134:135], v[242:243], v[190:191] op_sel:[0,1,0] op_sel_hi:[1,1,1]
  v_pk_mul_f32 v[232:233], v[172:173], v[246:247] op_sel:[0,1] op_sel_hi:[1,1]
  v_pk_mul_f32 v[234:235], v[174:175], v[246:247] op_sel:[0,1] op_sel_hi:[1,1]
  v_pk_mul_f32 v[172:173], v[172:173], v[188:189]
  v_pk_mul_f32 v[174:175], v[174:175], v[190:191]
  v_exp_f32 v232, v232
  v_exp_f32 v233, v233
  v_exp_f32 v234, v234
  v_exp_f32 v235, v235
  s_nop 0
  v_pk_fma_f32 v[232:233], v[232:233], v[238:239], v[238:239] op_sel:[0,1,1] op_sel_hi:[1,1,1]
  v_pk_fma_f32 v[234:235], v[234:235], v[238:239], v[238:239] op_sel:[0,1,1] op_sel_hi:[1,1,1]
  v_rcp_f32 v232, v232
  v_rcp_f32 v233, v233
  v_rcp_f32 v234, v234
  v_rcp_f32 v235, v235
  s_nop 0
  v_pk_mul_f32 v[172:173], v[172:173], v[232:233]
  v_pk_mul_f32 v[174:175], v[174:175], v[234:235]
  v_cvt_pk_bf16_f32 v158, v172, v173
  v_cvt_pk_bf16_f32 v159, v174, v175
  buffer_store_dwordx4 v[156:159], v248, s[4:7], s60 offen offset:2048 sc1
  s_waitcnt lgkmcnt(0)
  v_pk_fma_f32 v[192:193], v[160:161], v[240:241], v[192:193] op_sel:[0,0,0] op_sel_hi:[1,0,1]
  v_pk_fma_f32 v[194:195], v[162:163], v[240:241], v[194:195] op_sel:[0,0,0] op_sel_hi:[1,0,1]
  v_pk_fma_f32 v[208:209], v[164:165], v[240:241], v[208:209] op_sel:[0,0,0] op_sel_hi:[1,0,1]
  v_pk_fma_f32 v[210:211], v[166:167], v[240:241], v[210:211] op_sel:[0,0,0] op_sel_hi:[1,0,1]
  v_pk_mul_f32 v[232:233], v[192:193], v[244:245] op_sel:[0,0] op_sel_hi:[1,0]
  v_pk_mul_f32 v[234:235], v[194:195], v[244:245] op_sel:[0,0] op_sel_hi:[1,0]
  v_pk_mul_f32 v[192:193], v[192:193], v[208:209]
  v_pk_mul_f32 v[194:195], v[194:195], v[210:211]
  v_exp_f32 v232, v232
  v_exp_f32 v233, v233
  v_exp_f32 v234, v234
  v_exp_f32 v235, v235
  s_nop 0
  v_pk_fma_f32 v[232:233], v[232:233], v[236:237], v[236:237] op_sel:[0,0,0] op_sel_hi:[1,0,0]
  v_pk_fma_f32 v[234:235], v[234:235], v[236:237], v[236:237] op_sel:[0,0,0] op_sel_hi:[1,0,0]
  v_rcp_f32 v232, v232
  v_rcp_f32 v233, v233
  v_rcp_f32 v234, v234
  v_rcp_f32 v235, v235
  s_nop 0
  v_pk_mul_f32 v[192:193], v[192:193], v[232:233]
  v_pk_mul_f32 v[194:195], v[194:195], v[234:235]
  v_cvt_pk_bf16_f32 v208, v192, v193
  v_cvt_pk_bf16_f32 v209, v194, v195
  v_pk_fma_f32 v[196:197], v[160:161], v[240:241], v[196:197] op_sel:[0,1,0] op_sel_hi:[1,1,1]
  v_pk_fma_f32 v[198:199], v[162:163], v[240:241], v[198:199] op_sel:[0,1,0] op_sel_hi:[1,1,1]
  v_pk_fma_f32 v[212:213], v[164:165], v[240:241], v[212:213] op_sel:[0,1,0] op_sel_hi:[1,1,1]
  v_pk_fma_f32 v[214:215], v[166:167], v[240:241], v[214:215] op_sel:[0,1,0] op_sel_hi:[1,1,1]
  v_pk_mul_f32 v[232:233], v[196:197], v[244:245] op_sel:[0,1] op_sel_hi:[1,1]
  v_pk_mul_f32 v[234:235], v[198:199], v[244:245] op_sel:[0,1] op_sel_hi:[1,1]
  v_pk_mul_f32 v[196:197], v[196:197], v[212:213]
  v_pk_mul_f32 v[198:199], v[198:199], v[214:215]
  v_exp_f32 v232, v232
  v_exp_f32 v233, v233
  v_exp_f32 v234, v234
  v_exp_f32 v235, v235
  s_nop 0
  v_pk_fma_f32 v[232:233], v[232:233], v[236:237], v[236:237] op_sel:[0,1,1] op_sel_hi:[1,1,1]
  v_pk_fma_f32 v[234:235], v[234:235], v[236:237], v[236:237] op_sel:[0,1,1] op_sel_hi:[1,1,1]
  v_rcp_f32 v232, v232
  v_rcp_f32 v233, v233
  v_rcp_f32 v234, v234
  v_rcp_f32 v235, v235
  s_nop 0
  v_pk_mul_f32 v[196:197], v[196:197], v[232:233]
  v_pk_mul_f32 v[198:199], v[198:199], v[234:235]
  v_cvt_pk_bf16_f32 v210, v196, v197
  v_cvt_pk_bf16_f32 v211, v198, v199
  s_nop 1
  v_permlane32_swap_b32 v208, v210
  v_permlane32_swap_b32 v209, v211
  buffer_store_dwordx4 v[208:211], v249, s[4:7], s61 offen sc1
  v_pk_fma_f32 v[200:201], v[160:161], v[242:243], v[200:201] op_sel:[0,0,0] op_sel_hi:[1,0,1]
  v_pk_fma_f32 v[202:203], v[162:163], v[242:243], v[202:203] op_sel:[0,0,0] op_sel_hi:[1,0,1]
  v_pk_fma_f32 v[216:217], v[164:165], v[242:243], v[216:217] op_sel:[0,0,0] op_sel_hi:[1,0,1]
  v_pk_fma_f32 v[218:219], v[166:167], v[242:243], v[218:219] op_sel:[0,0,0] op_sel_hi:[1,0,1]
  v_pk_mul_f32 v[232:233], v[200:201], v[246:247] op_sel:[0,0] op_sel_hi:[1,0]
  v_pk_mul_f32 v[234:235], v[202:203], v[246:247] op_sel:[0,0] op_sel_hi:[1,0]
  v_pk_mul_f32 v[200:201], v[200:201], v[216:217]
  v_pk_mul_f32 v[202:203], v[202:203], v[218:219]
  v_exp_f32 v232, v232
  v_exp_f32 v233, v233
  v_exp_f32 v234, v234
  v_exp_f32 v235, v235
  s_nop 0
  v_pk_fma_f32 v[232:233], v[232:233], v[238:239], v[238:239] op_sel:[0,0,0] op_sel_hi:[1,0,0]
  v_pk_fma_f32 v[234:235], v[234:235], v[238:239], v[238:239] op_sel:[0,0,0] op_sel_hi:[1,0,0]
  v_rcp_f32 v232, v232
  v_rcp_f32 v233, v233
  v_rcp_f32 v234, v234
  v_rcp_f32 v235, v235
  s_nop 0
  v_pk_mul_f32 v[200:201], v[200:201], v[232:233]
  v_pk_mul_f32 v[202:203], v[202:203], v[234:235]
  v_cvt_pk_bf16_f32 v216, v200, v201
  v_cvt_pk_bf16_f32 v217, v202, v203
  v_pk_fma_f32 v[204:205], v[160:161], v[242:243], v[204:205] op_sel:[0,1,0] op_sel_hi:[1,1,1]
  v_pk_fma_f32 v[206:207], v[162:163], v[242:243], v[206:207] op_sel:[0,1,0] op_sel_hi:[1,1,1]
  v_pk_fma_f32 v[220:221], v[164:165], v[242:243], v[220:221] op_sel:[0,1,0] op_sel_hi:[1,1,1]
  v_pk_fma_f32 v[222:223], v[166:167], v[242:243], v[222:223] op_sel:[0,1,0] op_sel_hi:[1,1,1]
  v_pk_mul_f32 v[232:233], v[204:205], v[246:247] op_sel:[0,1] op_sel_hi:[1,1]
  v_pk_mul_f32 v[234:235], v[206:207], v[246:247] op_sel:[0,1] op_sel_hi:[1,1]
  v_pk_mul_f32 v[204:205], v[204:205], v[220:221]
  v_pk_mul_f32 v[206:207], v[206:207], v[222:223]
  v_exp_f32 v232, v232
  v_exp_f32 v233, v233
  v_exp_f32 v234, v234
  v_exp_f32 v235, v235
  s_nop 0
  v_pk_fma_f32 v[232:233], v[232:233], v[238:239], v[238:239] op_sel:[0,1,1] op_sel_hi:[1,1,1]
  v_pk_fma_f32 v[234:235], v[234:235], v[238:239], v[238:239] op_sel:[0,1,1] op_sel_hi:[1,1,1]
  v_rcp_f32 v232, v232
  v_rcp_f32 v233, v233
  v_rcp_f32 v234, v234
  v_rcp_f32 v235, v235
  s_nop 0
  v_pk_mul_f32 v[204:205], v[204:205], v[232:233]
  v_pk_mul_f32 v[206:207], v[206:207], v[234:235]
  v_cvt_pk_bf16_f32 v218, v204, v205
  v_cvt_pk_bf16_f32 v219, v206, v207
  s_nop 1
  v_permlane32_swap_b32 v216, v218
  v_permlane32_swap_b32 v217, v219
  buffer_store_dwordx4 v[216:219], v249, s[4:7], s62 offen sc1
  s_lshl_b32 s77, s54, 7
  s_add_u32 s77, s77, s42
  s_add_u32 s77, s77, 27790336
  s_waitcnt vmcnt(0)
  s_barrier
  s_cmp_lg_u32 s40, 0
  s_cbranch_scc1 Lsig20
  v_mov_b32 v250, 1
  s_mov_b64 exec, 1
  buffer_atomic_add v250, v251, s[4:7], s77 offen sc1
  s_mov_b64 exec, -1
Lsig20:
  s_lshl_b32 s58, s52, 3
  s_lshl_b32 s43, s40, 1
  s_add_u32 s58, s58, s43
  s_lshl_b32 s59, s58, 15
  s_lshl_b32 s43, s53, 11
  s_add_u32 s59, s59, s43
  s_add_u32 s59, s59, s42
  s_add_u32 s46, s59, 4194304
  s_add_u32 s47, s46, 32768
  v_lshlrev_b32 v48, 4, v253
  v_add_u32 v49, 114688, v48
  buffer_load_dwordx4 v[52:55], v48, s[4:7], s46 offen offset:0 sc1
  buffer_load_dwordx4 v[56:59], v48, s[4:7], s46 offen offset:1024 sc1
  buffer_load_dwordx4 v[60:63], v48, s[4:7], s47 offen offset:0 sc1
  buffer_load_dwordx4 v[64:67], v48, s[4:7], s47 offen offset:1024 sc1
  s_mul_i32 s57, s58, 114688
  s_add_u32 s57, s57, s42
  s_add_u32 s57, s57, 12582912
  s_mov_b32 s60, 0
  v_lshrrev_b32 v2, 2, v253
  v_bfe_u32 v3, v253, 3, 2
  v_and_b32 v4, 3, v253
  v_lshlrev_b32 v4, 3, v4
  v_lshl_add_u32 v4, v2, 7, v4
  v_xor_b32 v5, 0, v3
  v_lshl_add_u32 v40, v5, 5, v4
  v_add_u32 v44, 57344, v40
  v_xor_b32 v5, 1, v3
  v_lshl_add_u32 v41, v5, 5, v4
  v_add_u32 v45, 57344, v41
  v_xor_b32 v5, 2, v3
  v_lshl_add_u32 v42, v5, 5, v4
  v_add_u32 v46, 57344, v42
  v_xor_b32 v5, 3, v3
  v_lshl_add_u32 v43, v5, 5, v4
  v_add_u32 v47, 57344, v43
  s_waitcnt vmcnt(0)
  v_lshlrev_b32 v0, 16, v52
  v_and_b32 v1, 0xffff0000, v52
  v_lshlrev_b32 v2, 16, v53
  v_and_b32 v3, 0xffff0000, v53
  v_lshlrev_b32 v8, 16, v54
  v_and_b32 v9, 0xffff0000, v54
  v_lshlrev_b32 v10, 16, v55
  v_and_b32 v11, 0xffff0000, v55
  v_lshlrev_b32 v16, 16, v56
  v_and_b32 v17, 0xffff0000, v56
  v_lshlrev_b32 v18, 16, v57
  v_and_b32 v19, 0xffff0000, v57
  v_lshlrev_b32 v24, 16, v58
  v_and_b32 v25, 0xffff0000, v58
  v_lshlrev_b32 v26, 16, v59
  v_and_b32 v27, 0xffff0000, v59
  v_lshlrev_b32 v4, 16, v60
  v_and_b32 v5, 0xffff0000, v60
  v_lshlrev_b32 v6, 16, v61
  v_and_b32 v7, 0xffff0000, v61
  v_lshlrev_b32 v12, 16, v62
  v_and_b32 v13, 0xffff0000, v62
  v_lshlrev_b32 v14, 16, v63
  v_and_b32 v15, 0xffff0000, v63
  v_lshlrev_b32 v20, 16, v64
  v_and_b32 v21, 0xffff0000, v64
  v_lshlrev_b32 v22, 16, v65
  v_and_b32 v23, 0xffff0000, v65
  v_lshlrev_b32 v28, 16, v66
  v_and_b32 v29, 0xffff0000, v66
  v_lshlrev_b32 v30, 16, v67
  v_and_b32 v31, 0xffff0000, v67
  s_lshr_b32 s77, s52, 1
  s_lshl_b32 s77, s77, 7
  s_add_u32 s77, s77, 27790336
  s_add_u32 s77, s77, s42
  s_cmp_lg_u32 s40, 0
  s_cbranch_scc1 Lpdn22
  s_mov_b32 s43, 0x40000
  s_mov_b64 exec, 1
Lpol21:
  buffer_load_dword v250, v251, s[4:7], s77 offen sc1
  s_waitcnt vmcnt(0)
  v_cmp_gt_u32 vcc, 32, v250
  s_cbranch_vccz Lpdn22
  s_sub_u32 s43, s43, 1
  s_cmp_lg_u32 s43, 0
  s_cbranch_scc1 Lpol21
Lpdn22:
  s_mov_b64 exec, -1
  s_waitcnt vmcnt(0) lgkmcnt(0)
  s_barrier
  s_add_u32 m0, s89, 65536
  s_add_u32 s92, s88, s82
  buffer_load_dwordx4 v252, s[24:27], s92 offen lds
  s_add_u32 s88, s88, 65536
  s_lshr_b32 s93, s80, 6
  s_add_u32 s93, s93, s57
  buffer_load_dwordx4 a[0:3], v48, s[4:7], s93 offen sc1
  buffer_load_dwordx4 a[4:7], v49, s[4:7], s93 offen sc1
  s_add_u32 s57, s57, 1024
  s_add_u32 m0, s89, 69632
  s_add_u32 s92, s88, s83
  s_add_u32 s92, s92, s90
  buffer_load_dwordx4 v252, s[24:27], s92 offen lds
  s_add_u32 s88, s88, 65536
  s_lshr_b32 s93, s81, 6
  s_add_u32 s93, s93, s57
  buffer_load_dwordx4 a[8:11], v48, s[4:7], s93 offen sc1
  buffer_load_dwordx4 a[12:15], v49, s[4:7], s93 offen sc1
  s_add_u32 s57, s57, 1024
  s_add_u32 m0, s89, 73728
  s_add_u32 s92, s88, s84
  buffer_load_dwordx4 v252, s[24:27], s92 offen lds
  s_add_u32 s88, s88, 65536
  s_lshr_b32 s93, s82, 6
  s_add_u32 s93, s93, s57
  buffer_load_dwordx4 a[16:19], v48, s[4:7], s93 offen sc1
  buffer_load_dwordx4 a[20:23], v49, s[4:7], s93 offen sc1
  s_add_u32 s57, s57, 1024
  s_add_u32 m0, s89, 77824
  s_add_u32 s92, s88, s85
  buffer_load_dwordx4 v252, s[24:27], s92 offen lds
  s_add_u32 s88, s88, 65536
  s_lshr_b32 s93, s83, 6
  s_add_u32 s93, s93, s57
  buffer_load_dwordx4 a[24:27], v48, s[4:7], s93 offen sc1
  buffer_load_dwordx4 a[28:31], v49, s[4:7], s93 offen sc1
  s_add_u32 s57, s57, 1024
  s_add_u32 m0, s89, 81920
  s_add_u32 s92, s88, s86
  buffer_load_dwordx4 v252, s[24:27], s92 offen lds
  s_add_u32 s88, s88, 65536
  s_lshr_b32 s93, s84, 6
  s_add_u32 s93, s93, s57
  buffer_load_dwordx4 a[32:35], v48, s[4:7], s93 offen sc1
  buffer_load_dwordx4 a[36:39], v49, s[4:7], s93 offen sc1
  s_add_u32 s57, s57, 1024
  ds_read_b64_tr_b16 a[112:113], v40 offset:0
  ds_read_b64_tr_b16 a[114:115], v40 offset:2048
  ds_read_b64_tr_b16 a[128:129], v40 offset:4096
  ds_read_b64_tr_b16 a[130:131], v40 offset:6144
  ds_read_b64_tr_b16 a[116:117], v41 offset:0
  ds_read_b64_tr_b16 a[118:119], v41 offset:2048
  ds_read_b64_tr_b16 a[132:133], v41 offset:4096
  ds_read_b64_tr_b16 a[134:135], v41 offset:6144
  ds_read_b64_tr_b16 a[120:121], v42 offset:0
  ds_read_b64_tr_b16 a[122:123], v42 offset:2048
  ds_read_b64_tr_b16 a[136:137], v42 offset:4096
  ds_read_b64_tr_b16 a[138:139], v42 offset:6144
  ds_read_b64_tr_b16 a[124:125], v43 offset:0
  ds_read_b64_tr_b16 a[126:127], v43 offset:2048
  ds_read_b64_tr_b16 a[140:141], v43 offset:4096
  ds_read_b64_tr_b16 a[142:143], v43 offset:6144
  s_mov_b32 s56, 3
.p2align 3
Lp4_loop:
  s_waitcnt vmcnt(9) lgkmcnt(12)
  v_mfma_f32_16x16x32_bf16 v[0:3], a[112:115], a[0:3], v[0:3]
  s_barrier
  ds_read_b64_tr_b16 a[144:145], v40 offset:8192
  v_mfma_f32_16x16x32_bf16 v[0:3], a[128:131], a[8:11], v[0:3]
  ds_read_b64_tr_b16 a[146:147], v40 offset:10240
  s_add_u32 m0, s89, 86016
  s_add_u32 s92, s88, s80
  buffer_load_dwordx4 v252, s[24:27], s92 offen lds
  s_add_u32 s88, s88, 65536
  v_mfma_f32_16x16x32_bf16 v[4:7], a[128:131], a[12:15], v[4:7]
  ds_read_b64_tr_b16 a[160:161], v40 offset:12288
  v_mfma_f32_16x16x32_bf16 v[4:7], a[112:115], a[4:7], v[4:7]
  ds_read_b64_tr_b16 a[162:163], v40 offset:14336
  s_lshr_b32 s93, s85, 6
  s_add_u32 s93, s93, s57
  buffer_load_dwordx4 a[40:43], v48, s[4:7], s93 offen sc1
  s_waitcnt lgkmcnt(12)
  v_mfma_f32_16x16x32_bf16 v[12:15], a[116:119], a[4:7], v[12:15]
  ds_read_b64_tr_b16 a[148:149], v41 offset:8192
  v_mfma_f32_16x16x32_bf16 v[12:15], a[132:135], a[12:15], v[12:15]
  ds_read_b64_tr_b16 a[150:151], v41 offset:10240
  buffer_load_dwordx4 a[44:47], v49, s[4:7], s93 offen sc1
  s_add_u32 s57, s57, 1024
  v_mfma_f32_16x16x32_bf16 v[8:11], a[132:135], a[8:11], v[8:11]
  ds_read_b64_tr_b16 a[164:165], v41 offset:12288
  v_mfma_f32_16x16x32_bf16 v[8:11], a[116:119], a[0:3], v[8:11]
  ds_read_b64_tr_b16 a[166:167], v41 offset:14336
  s_waitcnt lgkmcnt(12)
  v_mfma_f32_16x16x32_bf16 v[16:19], a[120:123], a[0:3], v[16:19]
  ds_read_b64_tr_b16 a[152:153], v42 offset:8192
  s_add_u32 m0, s89, 90112
  s_add_u32 s92, s88, s81
  buffer_load_dwordx4 v252, s[24:27], s92 offen lds
  s_add_u32 s88, s88, 65536
  v_mfma_f32_16x16x32_bf16 v[16:19], a[136:139], a[8:11], v[16:19]
  ds_read_b64_tr_b16 a[154:155], v42 offset:10240
  v_mfma_f32_16x16x32_bf16 v[20:23], a[136:139], a[12:15], v[20:23]
  ds_read_b64_tr_b16 a[168:169], v42 offset:12288
  s_lshr_b32 s93, s86, 6
  s_add_u32 s93, s93, s57
  buffer_load_dwordx4 a[48:51], v48, s[4:7], s93 offen sc1
  v_mfma_f32_16x16x32_bf16 v[20:23], a[120:123], a[4:7], v[20:23]
  ds_read_b64_tr_b16 a[170:171], v42 offset:14336
  s_waitcnt lgkmcnt(12)
  v_mfma_f32_16x16x32_bf16 v[28:31], a[124:127], a[4:7], v[28:31]
  ds_read_b64_tr_b16 a[156:157], v43 offset:8192
  buffer_load_dwordx4 a[52:55], v49, s[4:7], s93 offen sc1
  s_add_u32 s57, s57, 1024
  v_mfma_f32_16x16x32_bf16 v[28:31], a[140:143], a[12:15], v[28:31]
  ds_read_b64_tr_b16 a[158:159], v43 offset:10240
  v_mfma_f32_16x16x32_bf16 v[24:27], a[140:143], a[8:11], v[24:27]
  ds_read_b64_tr_b16 a[172:173], v43 offset:12288
  v_mfma_f32_16x16x32_bf16 v[24:27], a[124:127], a[0:3], v[24:27]
  ds_read_b64_tr_b16 a[174:175], v43 offset:14336
  s_waitcnt vmcnt(9) lgkmcnt(12)
  v_mfma_f32_16x16x32_bf16 v[0:3], a[144:147], a[16:19], v[0:3]
  ds_read_b64_tr_b16 a[112:113], v40 offset:16384
  v_mfma_f32_16x16x32_bf16 v[0:3], a[160:163], a[24:27], v[0:3]
  ds_read_b64_tr_b16 a[114:115], v40 offset:18432
  s_add_u32 m0, s89, 94208
  s_add_u32 s92, s88, s82
  buffer_load_dwordx4 v252, s[24:27], s92 offen lds
  s_add_u32 s88, s88, 65536
  v_mfma_f32_16x16x32_bf16 v[4:7], a[160:163], a[28:31], v[4:7]
  ds_read_b64_tr_b16 a[128:129], v40 offset:20480
  v_mfma_f32_16x16x32_bf16 v[4:7], a[144:147], a[20:23], v[4:7]
  ds_read_b64_tr_b16 a[130:131], v40 offset:22528
  s_lshr_b32 s93, s80, 6
  s_add_u32 s93, s93, s57
  buffer_load_dwordx4 a[56:59], v48, s[4:7], s93 offen sc1
  s_waitcnt lgkmcnt(12)
  v_mfma_f32_16x16x32_bf16 v[12:15], a[148:151], a[20:23], v[12:15]
  ds_read_b64_tr_b16 a[116:117], v41 offset:16384
  v_mfma_f32_16x16x32_bf16 v[12:15], a[164:167], a[28:31], v[12:15]
  ds_read_b64_tr_b16 a[118:119], v41 offset:18432
  buffer_load_dwordx4 a[60:63], v49, s[4:7], s93 offen sc1
  s_add_u32 s57, s57, 1024
  v_mfma_f32_16x16x32_bf16 v[8:11], a[164:167], a[24:27], v[8:11]
  ds_read_b64_tr_b16 a[132:133], v41 offset:20480
  v_mfma_f32_16x16x32_bf16 v[8:11], a[148:151], a[16:19], v[8:11]
  ds_read_b64_tr_b16 a[134:135], v41 offset:22528
  s_waitcnt lgkmcnt(12)
  v_mfma_f32_16x16x32_bf16 v[16:19], a[152:155], a[16:19], v[16:19]
  ds_read_b64_tr_b16 a[120:121], v42 offset:16384
  s_add_u32 m0, s89, 98304
  s_add_u32 s92, s88, s83
  s_add_u32 s92, s92, s90
  buffer_load_dwordx4 v252, s[24:27], s92 offen lds
  s_add_u32 s88, s88, 65536
  v_mfma_f32_16x16x32_bf16 v[16:19], a[168:171], a[24:27], v[16:19]
  ds_read_b64_tr_b16 a[122:123], v42 offset:18432
  v_mfma_f32_16x16x32_bf16 v[20:23], a[168:171], a[28:31], v[20:23]
  ds_read_b64_tr_b16 a[136:137], v42 offset:20480
  s_lshr_b32 s93, s81, 6
  s_add_u32 s93, s93, s57
  buffer_load_dwordx4 a[64:67], v48, s[4:7], s93 offen sc1
  v_mfma_f32_16x16x32_bf16 v[20:23], a[152:155], a[20:23], v[20:23]
  ds_read_b64_tr_b16 a[138:139], v42 offset:22528
  s_waitcnt lgkmcnt(12)
  v_mfma_f32_16x16x32_bf16 v[28:31], a[156:159], a[20:23], v[28:31]
  ds_read_b64_tr_b16 a[124:125], v43 offset:16384
  buffer_load_dwordx4 a[68:71], v49, s[4:7], s93 offen sc1
  s_add_u32 s57, s57, 1024
  v_mfma_f32_16x16x32_bf16 v[28:31], a[172:175], a[28:31], v[28:31]
  ds_read_b64_tr_b16 a[126:127], v43 offset:18432
  v_mfma_f32_16x16x32_bf16 v[24:27], a[172:175], a[24:27], v[24:27]
  ds_read_b64_tr_b16 a[140:141], v43 offset:20480
  v_mfma_f32_16x16x32_bf16 v[24:27], a[156:159], a[16:19], v[24:27]
  ds_read_b64_tr_b16 a[142:143], v43 offset:22528
  s_waitcnt vmcnt(9) lgkmcnt(12)
  v_mfma_f32_16x16x32_bf16 v[0:3], a[112:115], a[32:35], v[0:3]
  s_barrier
  ds_read_b64_tr_b16 a[144:145], v40 offset:24576
  v_mfma_f32_16x16x32_bf16 v[0:3], a[128:131], a[40:43], v[0:3]
  ds_read_b64_tr_b16 a[146:147], v40 offset:26624
  s_add_u32 m0, s89, 102400
  s_add_u32 s92, s88, s84
  buffer_load_dwordx4 v252, s[24:27], s92 offen lds
  s_add_u32 s88, s88, 65536
  v_mfma_f32_16x16x32_bf16 v[4:7], a[128:131], a[44:47], v[4:7]
  ds_read_b64_tr_b16 a[160:161], v40 offset:28672
  v_mfma_f32_16x16x32_bf16 v[4:7], a[112:115], a[36:39], v[4:7]
  ds_read_b64_tr_b16 a[162:163], v40 offset:30720
  s_lshr_b32 s93, s82, 6
  s_add_u32 s93, s93, s57
  buffer_load_dwordx4 a[72:75], v48, s[4:7], s93 offen sc1
  s_waitcnt lgkmcnt(12)
  v_mfma_f32_16x16x32_bf16 v[12:15], a[116:119], a[36:39], v[12:15]
  ds_read_b64_tr_b16 a[148:149], v41 offset:24576
  v_mfma_f32_16x16x32_bf16 v[12:15], a[132:135], a[44:47], v[12:15]
  ds_read_b64_tr_b16 a[150:151], v41 offset:26624
  buffer_load_dwordx4 a[76:79], v49, s[4:7], s93 offen sc1
  s_add_u32 s57, s57, 1024
  v_mfma_f32_16x16x32_bf16 v[8:11], a[132:135], a[40:43], v[8:11]
  ds_read_b64_tr_b16 a[164:165], v41 offset:28672
  v_mfma_f32_16x16x32_bf16 v[8:11], a[116:119], a[32:35], v[8:11]
  ds_read_b64_tr_b16 a[166:167], v41 offset:30720
  s_waitcnt lgkmcnt(12)
  v_mfma_f32_16x16x32_bf16 v[16:19], a[120:123], a[32:35], v[16:19]
  ds_read_b64_tr_b16 a[152:153], v42 offset:24576
  s_add_u32 m0, s89, 106496
  s_add_u32 s92, s88, s85
  buffer_load_dwordx4 v252, s[24:27], s92 offen lds
  s_add_u32 s88, s88, 65536
  v_mfma_f32_16x16x32_bf16 v[16:19], a[136:139], a[40:43], v[16:19]
  ds_read_b64_tr_b16 a[154:155], v42 offset:26624
  v_mfma_f32_16x16x32_bf16 v[20:23], a[136:139], a[44:47], v[20:23]
  ds_read_b64_tr_b16 a[168:169], v42 offset:28672
  s_lshr_b32 s93, s83, 6
  s_add_u32 s93, s93, s57
  buffer_load_dwordx4 a[80:83], v48, s[4:7], s93 offen sc1
  v_mfma_f32_16x16x32_bf16 v[20:23], a[120:123], a[36:39], v[20:23]
  ds_read_b64_tr_b16 a[170:171], v42 offset:30720
  s_waitcnt lgkmcnt(12)
  v_mfma_f32_16x16x32_bf16 v[28:31], a[124:127], a[36:39], v[28:31]
  ds_read_b64_tr_b16 a[156:157], v43 offset:24576
  buffer_load_dwordx4 a[84:87], v49, s[4:7], s93 offen sc1
  s_add_u32 s57, s57, 1024
  v_mfma_f32_16x16x32_bf16 v[28:31], a[140:143], a[44:47], v[28:31]
  ds_read_b64_tr_b16 a[158:159], v43 offset:26624
  v_mfma_f32_16x16x32_bf16 v[24:27], a[140:143], a[40:43], v[24:27]
  ds_read_b64_tr_b16 a[172:173], v43 offset:28672
  v_mfma_f32_16x16x32_bf16 v[24:27], a[124:127], a[32:35], v[24:27]
  ds_read_b64_tr_b16 a[174:175], v43 offset:30720
  s_waitcnt vmcnt(9) lgkmcnt(12)
  v_mfma_f32_16x16x32_bf16 v[0:3], a[144:147], a[48:51], v[0:3]
  ds_read_b64_tr_b16 a[112:113], v40 offset:32768
  v_mfma_f32_16x16x32_bf16 v[0:3], a[160:163], a[56:59], v[0:3]
  ds_read_b64_tr_b16 a[114:115], v40 offset:34816
  s_add_u32 m0, s89, 110592
  s_add_u32 s92, s88, s86
  buffer_load_dwordx4 v252, s[24:27], s92 offen lds
  s_add_u32 s88, s88, 65536
  v_mfma_f32_16x16x32_bf16 v[4:7], a[160:163], a[60:63], v[4:7]
  ds_read_b64_tr_b16 a[128:129], v40 offset:36864
  v_mfma_f32_16x16x32_bf16 v[4:7], a[144:147], a[52:55], v[4:7]
  ds_read_b64_tr_b16 a[130:131], v40 offset:38912
  s_lshr_b32 s93, s84, 6
  s_add_u32 s93, s93, s57
  buffer_load_dwordx4 a[88:91], v48, s[4:7], s93 offen sc1
  s_waitcnt lgkmcnt(12)
  v_mfma_f32_16x16x32_bf16 v[12:15], a[148:151], a[52:55], v[12:15]
  ds_read_b64_tr_b16 a[116:117], v41 offset:32768
  v_mfma_f32_16x16x32_bf16 v[12:15], a[164:167], a[60:63], v[12:15]
  ds_read_b64_tr_b16 a[118:119], v41 offset:34816
  buffer_load_dwordx4 a[92:95], v49, s[4:7], s93 offen sc1
  s_add_u32 s57, s57, 1024
  v_mfma_f32_16x16x32_bf16 v[8:11], a[164:167], a[56:59], v[8:11]
  ds_read_b64_tr_b16 a[132:133], v41 offset:36864
  v_mfma_f32_16x16x32_bf16 v[8:11], a[148:151], a[48:51], v[8:11]
  ds_read_b64_tr_b16 a[134:135], v41 offset:38912
  s_waitcnt lgkmcnt(12)
  v_mfma_f32_16x16x32_bf16 v[16:19], a[152:155], a[48:51], v[16:19]
  ds_read_b64_tr_b16 a[120:121], v42 offset:32768
  s_add_u32 m0, s89, 0
  s_add_u32 s92, s88, s80
  buffer_load_dwordx4 v252, s[24:27], s92 offen lds
  s_add_u32 s88, s88, 65536
  v_mfma_f32_16x16x32_bf16 v[16:19], a[168:171], a[56:59], v[16:19]
  ds_read_b64_tr_b16 a[122:123], v42 offset:34816
  v_mfma_f32_16x16x32_bf16 v[20:23], a[168:171], a[60:63], v[20:23]
  ds_read_b64_tr_b16 a[136:137], v42 offset:36864
  s_lshr_b32 s93, s85, 6
  s_add_u32 s93, s93, s57
  buffer_load_dwordx4 a[96:99], v48, s[4:7], s93 offen sc1
  v_mfma_f32_16x16x32_bf16 v[20:23], a[152:155], a[52:55], v[20:23]
  ds_read_b64_tr_b16 a[138:139], v42 offset:38912
  s_waitcnt lgkmcnt(12)
  v_mfma_f32_16x16x32_bf16 v[28:31], a[156:159], a[52:55], v[28:31]
  ds_read_b64_tr_b16 a[124:125], v43 offset:32768
  buffer_load_dwordx4 a[100:103], v49, s[4:7], s93 offen sc1
  s_add_u32 s57, s57, 1024
  v_mfma_f32_16x16x32_bf16 v[28:31], a[172:175], a[60:63], v[28:31]
  ds_read_b64_tr_b16 a[126:127], v43 offset:34816
  v_mfma_f32_16x16x32_bf16 v[24:27], a[172:175], a[56:59], v[24:27]
  ds_read_b64_tr_b16 a[140:141], v43 offset:36864
  v_mfma_f32_16x16x32_bf16 v[24:27], a[156:159], a[48:51], v[24:27]
  ds_read_b64_tr_b16 a[142:143], v43 offset:38912
  s_waitcnt vmcnt(9) lgkmcnt(12)
  v_mfma_f32_16x16x32_bf16 v[0:3], a[112:115], a[64:67], v[0:3]
  s_barrier
  ds_read_b64_tr_b16 a[144:145], v40 offset:40960
  v_mfma_f32_16x16x32_bf16 v[0:3], a[128:131], a[72:75], v[0:3]
  ds_read_b64_tr_b16 a[146:147], v40 offset:43008
  s_add_u32 m0, s89, 4096
  s_add_u32 s92, s88, s81
  buffer_load_dwordx4 v252, s[24:27], s92 offen lds
  s_add_u32 s88, s88, 65536
  v_mfma_f32_16x16x32_bf16 v[4:7], a[128:131], a[76:79], v[4:7]
  ds_read_b64_tr_b16 a[160:161], v40 offset:45056
  v_mfma_f32_16x16x32_bf16 v[4:7], a[112:115], a[68:71], v[4:7]
  ds_read_b64_tr_b16 a[162:163], v40 offset:47104
  s_lshr_b32 s93, s86, 6
  s_add_u32 s93, s93, s57
  buffer_load_dwordx4 a[104:107], v48, s[4:7], s93 offen sc1
  s_waitcnt lgkmcnt(12)
  v_mfma_f32_16x16x32_bf16 v[12:15], a[116:119], a[68:71], v[12:15]
  ds_read_b64_tr_b16 a[148:149], v41 offset:40960
  v_mfma_f32_16x16x32_bf16 v[12:15], a[132:135], a[76:79], v[12:15]
  ds_read_b64_tr_b16 a[150:151], v41 offset:43008
  buffer_load_dwordx4 a[108:111], v49, s[4:7], s93 offen sc1
  s_add_u32 s57, s57, 1024
  v_mfma_f32_16x16x32_bf16 v[8:11], a[132:135], a[72:75], v[8:11]
  ds_read_b64_tr_b16 a[164:165], v41 offset:45056
  v_mfma_f32_16x16x32_bf16 v[8:11], a[116:119], a[64:67], v[8:11]
  ds_read_b64_tr_b16 a[166:167], v41 offset:47104
  s_waitcnt lgkmcnt(12)
  v_mfma_f32_16x16x32_bf16 v[16:19], a[120:123], a[64:67], v[16:19]
  ds_read_b64_tr_b16 a[152:153], v42 offset:40960
  s_add_u32 m0, s89, 8192
  s_add_u32 s92, s88, s82
  buffer_load_dwordx4 v252, s[24:27], s92 offen lds
  s_add_u32 s88, s88, 65536
  v_mfma_f32_16x16x32_bf16 v[16:19], a[136:139], a[72:75], v[16:19]
  ds_read_b64_tr_b16 a[154:155], v42 offset:43008
  v_mfma_f32_16x16x32_bf16 v[20:23], a[136:139], a[76:79], v[20:23]
  ds_read_b64_tr_b16 a[168:169], v42 offset:45056
  s_lshr_b32 s93, s80, 6
  s_add_u32 s93, s93, s57
  buffer_load_dwordx4 a[0:3], v48, s[4:7], s93 offen sc1
  v_mfma_f32_16x16x32_bf16 v[20:23], a[120:123], a[68:71], v[20:23]
  ds_read_b64_tr_b16 a[170:171], v42 offset:47104
  s_waitcnt lgkmcnt(12)
  v_mfma_f32_16x16x32_bf16 v[28:31], a[124:127], a[68:71], v[28:31]
  ds_read_b64_tr_b16 a[156:157], v43 offset:40960
  buffer_load_dwordx4 a[4:7], v49, s[4:7], s93 offen sc1
  s_add_u32 s57, s57, 1024
  v_mfma_f32_16x16x32_bf16 v[28:31], a[140:143], a[76:79], v[28:31]
  ds_read_b64_tr_b16 a[158:159], v43 offset:43008
  v_mfma_f32_16x16x32_bf16 v[24:27], a[140:143], a[72:75], v[24:27]
  ds_read_b64_tr_b16 a[172:173], v43 offset:45056
  v_mfma_f32_16x16x32_bf16 v[24:27], a[124:127], a[64:67], v[24:27]
  ds_read_b64_tr_b16 a[174:175], v43 offset:47104
  s_waitcnt vmcnt(9) lgkmcnt(12)
  v_mfma_f32_16x16x32_bf16 v[0:3], a[144:147], a[80:83], v[0:3]
  ds_read_b64_tr_b16 a[112:113], v40 offset:49152
  v_mfma_f32_16x16x32_bf16 v[0:3], a[160:163], a[88:91], v[0:3]
  ds_read_b64_tr_b16 a[114:115], v40 offset:51200
  s_add_u32 m0, s89, 12288
  s_add_u32 s92, s88, s83
  s_add_u32 s92, s92, s90
  buffer_load_dwordx4 v252, s[24:27], s92 offen lds
  s_add_u32 s88, s88, 65536
  v_mfma_f32_16x16x32_bf16 v[4:7], a[160:163], a[92:95], v[4:7]
  ds_read_b64_tr_b16 a[128:129], v40 offset:53248
  v_mfma_f32_16x16x32_bf16 v[4:7], a[144:147], a[84:87], v[4:7]
  ds_read_b64_tr_b16 a[130:131], v40 offset:55296
  s_lshr_b32 s93, s81, 6
  s_add_u32 s93, s93, s57
  buffer_load_dwordx4 a[8:11], v48, s[4:7], s93 offen sc1
  s_waitcnt lgkmcnt(12)
  v_mfma_f32_16x16x32_bf16 v[12:15], a[148:151], a[84:87], v[12:15]
  ds_read_b64_tr_b16 a[116:117], v41 offset:49152
  v_mfma_f32_16x16x32_bf16 v[12:15], a[164:167], a[92:95], v[12:15]
  ds_read_b64_tr_b16 a[118:119], v41 offset:51200
  buffer_load_dwordx4 a[12:15], v49, s[4:7], s93 offen sc1
  s_add_u32 s57, s57, 1024
  v_mfma_f32_16x16x32_bf16 v[8:11], a[164:167], a[88:91], v[8:11]
  ds_read_b64_tr_b16 a[132:133], v41 offset:53248
  v_mfma_f32_16x16x32_bf16 v[8:11], a[148:151], a[80:83], v[8:11]
  ds_read_b64_tr_b16 a[134:135], v41 offset:55296
  s_waitcnt lgkmcnt(12)
  v_mfma_f32_16x16x32_bf16 v[16:19], a[152:155], a[80:83], v[16:19]
  ds_read_b64_tr_b16 a[120:121], v42 offset:49152
  s_add_u32 m0, s89, 16384
  s_add_u32 s92, s88, s84
  buffer_load_dwordx4 v252, s[24:27], s92 offen lds
  s_add_u32 s88, s88, 65536
  v_mfma_f32_16x16x32_bf16 v[16:19], a[168:171], a[88:91], v[16:19]
  ds_read_b64_tr_b16 a[122:123], v42 offset:51200
  v_mfma_f32_16x16x32_bf16 v[20:23], a[168:171], a[92:95], v[20:23]
  ds_read_b64_tr_b16 a[136:137], v42 offset:53248
  s_lshr_b32 s93, s82, 6
  s_add_u32 s93, s93, s57
  buffer_load_dwordx4 a[16:19], v48, s[4:7], s93 offen sc1
  v_mfma_f32_16x16x32_bf16 v[20:23], a[152:155], a[84:87], v[20:23]
  ds_read_b64_tr_b16 a[138:139], v42 offset:55296
  s_waitcnt lgkmcnt(12)
  v_mfma_f32_16x16x32_bf16 v[28:31], a[156:159], a[84:87], v[28:31]
  ds_read_b64_tr_b16 a[124:125], v43 offset:49152
  buffer_load_dwordx4 a[20:23], v49, s[4:7], s93 offen sc1
  s_add_u32 s57, s57, 1024
  v_mfma_f32_16x16x32_bf16 v[28:31], a[172:175], a[92:95], v[28:31]
  ds_read_b64_tr_b16 a[126:127], v43 offset:51200
  v_mfma_f32_16x16x32_bf16 v[24:27], a[172:175], a[88:91], v[24:27]
  ds_read_b64_tr_b16 a[140:141], v43 offset:53248
  v_mfma_f32_16x16x32_bf16 v[24:27], a[156:159], a[80:83], v[24:27]
  ds_read_b64_tr_b16 a[142:143], v43 offset:55296
  s_waitcnt vmcnt(9) lgkmcnt(12)
  v_mfma_f32_16x16x32_bf16 v[0:3], a[112:115], a[96:99], v[0:3]
  s_barrier
  ds_read_b64_tr_b16 a[144:145], v44 offset:0
  v_mfma_f32_16x16x32_bf16 v[0:3], a[128:131], a[104:107], v[0:3]
  ds_read_b64_tr_b16 a[146:147], v44 offset:2048
  s_add_u32 m0, s89, 20480
  s_add_u32 s92, s88, s85
  buffer_load_dwordx4 v252, s[24:27], s92 offen lds
  s_add_u32 s88, s88, 65536
  v_mfma_f32_16x16x32_bf16 v[4:7], a[128:131], a[108:111], v[4:7]
  ds_read_b64_tr_b16 a[160:161], v44 offset:4096
  v_mfma_f32_16x16x32_bf16 v[4:7], a[112:115], a[100:103], v[4:7]
  ds_read_b64_tr_b16 a[162:163], v44 offset:6144
  s_lshr_b32 s93, s83, 6
  s_add_u32 s93, s93, s57
  buffer_load_dwordx4 a[24:27], v48, s[4:7], s93 offen sc1
  s_waitcnt lgkmcnt(12)
  v_mfma_f32_16x16x32_bf16 v[12:15], a[116:119], a[100:103], v[12:15]
  ds_read_b64_tr_b16 a[148:149], v45 offset:0
  v_mfma_f32_16x16x32_bf16 v[12:15], a[132:135], a[108:111], v[12:15]
  ds_read_b64_tr_b16 a[150:151], v45 offset:2048
  buffer_load_dwordx4 a[28:31], v49, s[4:7], s93 offen sc1
  s_add_u32 s57, s57, 1024
  v_mfma_f32_16x16x32_bf16 v[8:11], a[132:135], a[104:107], v[8:11]
  ds_read_b64_tr_b16 a[164:165], v45 offset:4096
  v_mfma_f32_16x16x32_bf16 v[8:11], a[116:119], a[96:99], v[8:11]
  ds_read_b64_tr_b16 a[166:167], v45 offset:6144
  s_waitcnt lgkmcnt(12)
  v_mfma_f32_16x16x32_bf16 v[16:19], a[120:123], a[96:99], v[16:19]
  ds_read_b64_tr_b16 a[152:153], v46 offset:0
  s_add_u32 m0, s89, 24576
  s_add_u32 s92, s88, s86
  buffer_load_dwordx4 v252, s[24:27], s92 offen lds
  s_add_u32 s88, s88, 65536
  v_mfma_f32_16x16x32_bf16 v[16:19], a[136:139], a[104:107], v[16:19]
  ds_read_b64_tr_b16 a[154:155], v46 offset:2048
  v_mfma_f32_16x16x32_bf16 v[20:23], a[136:139], a[108:111], v[20:23]
  ds_read_b64_tr_b16 a[168:169], v46 offset:4096
  s_lshr_b32 s93, s84, 6
  s_add_u32 s93, s93, s57
  buffer_load_dwordx4 a[32:35], v48, s[4:7], s93 offen sc1
  v_mfma_f32_16x16x32_bf16 v[20:23], a[120:123], a[100:103], v[20:23]
  ds_read_b64_tr_b16 a[170:171], v46 offset:6144
  s_waitcnt lgkmcnt(12)
  v_mfma_f32_16x16x32_bf16 v[28:31], a[124:127], a[100:103], v[28:31]
  ds_read_b64_tr_b16 a[156:157], v47 offset:0
  buffer_load_dwordx4 a[36:39], v49, s[4:7], s93 offen sc1
  s_add_u32 s57, s57, 1024
  v_mfma_f32_16x16x32_bf16 v[28:31], a[140:143], a[108:111], v[28:31]
  ds_read_b64_tr_b16 a[158:159], v47 offset:2048
  v_mfma_f32_16x16x32_bf16 v[24:27], a[140:143], a[104:107], v[24:27]
  ds_read_b64_tr_b16 a[172:173], v47 offset:4096
  v_mfma_f32_16x16x32_bf16 v[24:27], a[124:127], a[96:99], v[24:27]
  ds_read_b64_tr_b16 a[174:175], v47 offset:6144
  s_waitcnt vmcnt(9) lgkmcnt(12)
  v_mfma_f32_16x16x32_bf16 v[0:3], a[144:147], a[0:3], v[0:3]
  ds_read_b64_tr_b16 a[112:113], v44 offset:8192
  v_mfma_f32_16x16x32_bf16 v[0:3], a[160:163], a[8:11], v[0:3]
  ds_read_b64_tr_b16 a[114:115], v44 offset:10240
  s_add_u32 m0, s89, 28672
  s_add_u32 s92, s88, s80
  buffer_load_dwordx4 v252, s[24:27], s92 offen lds
  s_add_u32 s88, s88, 65536
  v_mfma_f32_16x16x32_bf16 v[4:7], a[160:163], a[12:15], v[4:7]
  ds_read_b64_tr_b16 a[128:129], v44 offset:12288
  v_mfma_f32_16x16x32_bf16 v[4:7], a[144:147], a[4:7], v[4:7]
  ds_read_b64_tr_b16 a[130:131], v44 offset:14336
  s_lshr_b32 s93, s85, 6
  s_add_u32 s93, s93, s57
  buffer_load_dwordx4 a[40:43], v48, s[4:7], s93 offen sc1
  s_waitcnt lgkmcnt(12)
  v_mfma_f32_16x16x32_bf16 v[12:15], a[148:151], a[4:7], v[12:15]
  ds_read_b64_tr_b16 a[116:117], v45 offset:8192
  v_mfma_f32_16x16x32_bf16 v[12:15], a[164:167], a[12:15], v[12:15]
  ds_read_b64_tr_b16 a[118:119], v45 offset:10240
  buffer_load_dwordx4 a[44:47], v49, s[4:7], s93 offen sc1
  s_add_u32 s57, s57, 1024
  v_mfma_f32_16x16x32_bf16 v[8:11], a[164:167], a[8:11], v[8:11]
  ds_read_b64_tr_b16 a[132:133], v45 offset:12288
  v_mfma_f32_16x16x32_bf16 v[8:11], a[148:151], a[0:3], v[8:11]
  ds_read_b64_tr_b16 a[134:135], v45 offset:14336
  s_waitcnt lgkmcnt(12)
  v_mfma_f32_16x16x32_bf16 v[16:19], a[152:155], a[0:3], v[16:19]
  ds_read_b64_tr_b16 a[120:121], v46 offset:8192
  s_add_u32 m0, s89, 32768
  s_add_u32 s92, s88, s81
  buffer_load_dwordx4 v252, s[24:27], s92 offen lds
  s_add_u32 s88, s88, 65536
  v_mfma_f32_16x16x32_bf16 v[16:19], a[168:171], a[8:11], v[16:19]
  ds_read_b64_tr_b16 a[122:123], v46 offset:10240
  v_mfma_f32_16x16x32_bf16 v[20:23], a[168:171], a[12:15], v[20:23]
  ds_read_b64_tr_b16 a[136:137], v46 offset:12288
  s_lshr_b32 s93, s86, 6
  s_add_u32 s93, s93, s57
  buffer_load_dwordx4 a[48:51], v48, s[4:7], s93 offen sc1
  v_mfma_f32_16x16x32_bf16 v[20:23], a[152:155], a[4:7], v[20:23]
  ds_read_b64_tr_b16 a[138:139], v46 offset:14336
  s_waitcnt lgkmcnt(12)
  v_mfma_f32_16x16x32_bf16 v[28:31], a[156:159], a[4:7], v[28:31]
  ds_read_b64_tr_b16 a[124:125], v47 offset:8192
  buffer_load_dwordx4 a[52:55], v49, s[4:7], s93 offen sc1
  s_add_u32 s57, s57, 1024
  v_mfma_f32_16x16x32_bf16 v[28:31], a[172:175], a[12:15], v[28:31]
  ds_read_b64_tr_b16 a[126:127], v47 offset:10240
  v_mfma_f32_16x16x32_bf16 v[24:27], a[172:175], a[8:11], v[24:27]
  ds_read_b64_tr_b16 a[140:141], v47 offset:12288
  v_mfma_f32_16x16x32_bf16 v[24:27], a[156:159], a[0:3], v[24:27]
  ds_read_b64_tr_b16 a[142:143], v47 offset:14336
  s_waitcnt vmcnt(9) lgkmcnt(12)
  v_mfma_f32_16x16x32_bf16 v[0:3], a[112:115], a[16:19], v[0:3]
  s_barrier
  ds_read_b64_tr_b16 a[144:145], v44 offset:16384
  v_mfma_f32_16x16x32_bf16 v[0:3], a[128:131], a[24:27], v[0:3]
  ds_read_b64_tr_b16 a[146:147], v44 offset:18432
  s_add_u32 m0, s89, 36864
  s_add_u32 s92, s88, s82
  buffer_load_dwordx4 v252, s[24:27], s92 offen lds
  s_add_u32 s88, s88, 65536
  v_mfma_f32_16x16x32_bf16 v[4:7], a[128:131], a[28:31], v[4:7]
  ds_read_b64_tr_b16 a[160:161], v44 offset:20480
  v_mfma_f32_16x16x32_bf16 v[4:7], a[112:115], a[20:23], v[4:7]
  ds_read_b64_tr_b16 a[162:163], v44 offset:22528
  s_lshr_b32 s93, s80, 6
  s_add_u32 s93, s93, s57
  buffer_load_dwordx4 a[56:59], v48, s[4:7], s93 offen sc1
  s_waitcnt lgkmcnt(12)
  v_mfma_f32_16x16x32_bf16 v[12:15], a[116:119], a[20:23], v[12:15]
  ds_read_b64_tr_b16 a[148:149], v45 offset:16384
  v_mfma_f32_16x16x32_bf16 v[12:15], a[132:135], a[28:31], v[12:15]
  ds_read_b64_tr_b16 a[150:151], v45 offset:18432
  buffer_load_dwordx4 a[60:63], v49, s[4:7], s93 offen sc1
  s_add_u32 s57, s57, 1024
  v_mfma_f32_16x16x32_bf16 v[8:11], a[132:135], a[24:27], v[8:11]
  ds_read_b64_tr_b16 a[164:165], v45 offset:20480
  v_mfma_f32_16x16x32_bf16 v[8:11], a[116:119], a[16:19], v[8:11]
  ds_read_b64_tr_b16 a[166:167], v45 offset:22528
  s_waitcnt lgkmcnt(12)
  v_mfma_f32_16x16x32_bf16 v[16:19], a[120:123], a[16:19], v[16:19]
  ds_read_b64_tr_b16 a[152:153], v46 offset:16384
  s_add_u32 m0, s89, 40960
  s_add_u32 s92, s88, s83
  s_add_u32 s92, s92, s90
  buffer_load_dwordx4 v252, s[24:27], s92 offen lds
  s_add_u32 s88, s88, 65536
  v_mfma_f32_16x16x32_bf16 v[16:19], a[136:139], a[24:27], v[16:19]
  ds_read_b64_tr_b16 a[154:155], v46 offset:18432
  v_mfma_f32_16x16x32_bf16 v[20:23], a[136:139], a[28:31], v[20:23]
  ds_read_b64_tr_b16 a[168:169], v46 offset:20480
  s_lshr_b32 s93, s81, 6
  s_add_u32 s93, s93, s57
  buffer_load_dwordx4 a[64:67], v48, s[4:7], s93 offen sc1
  v_mfma_f32_16x16x32_bf16 v[20:23], a[120:123], a[20:23], v[20:23]
  ds_read_b64_tr_b16 a[170:171], v46 offset:22528
  s_waitcnt lgkmcnt(12)
  v_mfma_f32_16x16x32_bf16 v[28:31], a[124:127], a[20:23], v[28:31]
  ds_read_b64_tr_b16 a[156:157], v47 offset:16384
  buffer_load_dwordx4 a[68:71], v49, s[4:7], s93 offen sc1
  s_add_u32 s57, s57, 1024
  v_mfma_f32_16x16x32_bf16 v[28:31], a[140:143], a[28:31], v[28:31]
  ds_read_b64_tr_b16 a[158:159], v47 offset:18432
  v_mfma_f32_16x16x32_bf16 v[24:27], a[140:143], a[24:27], v[24:27]
  ds_read_b64_tr_b16 a[172:173], v47 offset:20480
  v_mfma_f32_16x16x32_bf16 v[24:27], a[124:127], a[16:19], v[24:27]
  ds_read_b64_tr_b16 a[174:175], v47 offset:22528
  s_waitcnt vmcnt(9) lgkmcnt(12)
  v_mfma_f32_16x16x32_bf16 v[0:3], a[144:147], a[32:35], v[0:3]
  ds_read_b64_tr_b16 a[112:113], v44 offset:24576
  v_mfma_f32_16x16x32_bf16 v[0:3], a[160:163], a[40:43], v[0:3]
  ds_read_b64_tr_b16 a[114:115], v44 offset:26624
  s_add_u32 m0, s89, 45056
  s_add_u32 s92, s88, s84
  buffer_load_dwordx4 v252, s[24:27], s92 offen lds
  s_add_u32 s88, s88, 65536
  v_mfma_f32_16x16x32_bf16 v[4:7], a[160:163], a[44:47], v[4:7]
  ds_read_b64_tr_b16 a[128:129], v44 offset:28672
  v_mfma_f32_16x16x32_bf16 v[4:7], a[144:147], a[36:39], v[4:7]
  ds_read_b64_tr_b16 a[130:131], v44 offset:30720
  s_lshr_b32 s93, s82, 6
  s_add_u32 s93, s93, s57
  buffer_load_dwordx4 a[72:75], v48, s[4:7], s93 offen sc1
  s_waitcnt lgkmcnt(12)
  v_mfma_f32_16x16x32_bf16 v[12:15], a[148:151], a[36:39], v[12:15]
  ds_read_b64_tr_b16 a[116:117], v45 offset:24576
  v_mfma_f32_16x16x32_bf16 v[12:15], a[164:167], a[44:47], v[12:15]
  ds_read_b64_tr_b16 a[118:119], v45 offset:26624
  buffer_load_dwordx4 a[76:79], v49, s[4:7], s93 offen sc1
  s_add_u32 s57, s57, 1024
  v_mfma_f32_16x16x32_bf16 v[8:11], a[164:167], a[40:43], v[8:11]
  ds_read_b64_tr_b16 a[132:133], v45 offset:28672
  v_mfma_f32_16x16x32_bf16 v[8:11], a[148:151], a[32:35], v[8:11]
  ds_read_b64_tr_b16 a[134:135], v45 offset:30720
  s_waitcnt lgkmcnt(12)
  v_mfma_f32_16x16x32_bf16 v[16:19], a[152:155], a[32:35], v[16:19]
  ds_read_b64_tr_b16 a[120:121], v46 offset:24576
  s_add_u32 m0, s89, 49152
  s_add_u32 s92, s88, s85
  buffer_load_dwordx4 v252, s[24:27], s92 offen lds
  s_add_u32 s88, s88, 65536
  v_mfma_f32_16x16x32_bf16 v[16:19], a[168:171], a[40:43], v[16:19]
  ds_read_b64_tr_b16 a[122:123], v46 offset:26624
  v_mfma_f32_16x16x32_bf16 v[20:23], a[168:171], a[44:47], v[20:23]
  ds_read_b64_tr_b16 a[136:137], v46 offset:28672
  s_lshr_b32 s93, s83, 6
  s_add_u32 s93, s93, s57
  buffer_load_dwordx4 a[80:83], v48, s[4:7], s93 offen sc1
  v_mfma_f32_16x16x32_bf16 v[20:23], a[152:155], a[36:39], v[20:23]
  ds_read_b64_tr_b16 a[138:139], v46 offset:30720
  s_waitcnt lgkmcnt(12)
  v_mfma_f32_16x16x32_bf16 v[28:31], a[156:159], a[36:39], v[28:31]
  ds_read_b64_tr_b16 a[124:125], v47 offset:24576
  buffer_load_dwordx4 a[84:87], v49, s[4:7], s93 offen sc1
  s_add_u32 s57, s57, 1024
  v_mfma_f32_16x16x32_bf16 v[28:31], a[172:175], a[44:47], v[28:31]
  ds_read_b64_tr_b16 a[126:127], v47 offset:26624
  v_mfma_f32_16x16x32_bf16 v[24:27], a[172:175], a[40:43], v[24:27]
  ds_read_b64_tr_b16 a[140:141], v47 offset:28672
  v_mfma_f32_16x16x32_bf16 v[24:27], a[156:159], a[32:35], v[24:27]
  ds_read_b64_tr_b16 a[142:143], v47 offset:30720
  s_waitcnt vmcnt(9) lgkmcnt(12)
  v_mfma_f32_16x16x32_bf16 v[0:3], a[112:115], a[48:51], v[0:3]
  s_barrier
  ds_read_b64_tr_b16 a[144:145], v44 offset:32768
  v_mfma_f32_16x16x32_bf16 v[0:3], a[128:131], a[56:59], v[0:3]
  ds_read_b64_tr_b16 a[146:147], v44 offset:34816
  s_add_u32 m0, s89, 53248
  s_add_u32 s92, s88, s86
  buffer_load_dwordx4 v252, s[24:27], s92 offen lds
  s_add_u32 s88, s88, 65536
  v_mfma_f32_16x16x32_bf16 v[4:7], a[128:131], a[60:63], v[4:7]
  ds_read_b64_tr_b16 a[160:161], v44 offset:36864
  v_mfma_f32_16x16x32_bf16 v[4:7], a[112:115], a[52:55], v[4:7]
  ds_read_b64_tr_b16 a[162:163], v44 offset:38912
  s_lshr_b32 s93, s84, 6
  s_add_u32 s93, s93, s57
  buffer_load_dwordx4 a[88:91], v48, s[4:7], s93 offen sc1
  s_waitcnt lgkmcnt(12)
  v_mfma_f32_16x16x32_bf16 v[12:15], a[116:119], a[52:55], v[12:15]
  ds_read_b64_tr_b16 a[148:149], v45 offset:32768
  v_mfma_f32_16x16x32_bf16 v[12:15], a[132:135], a[60:63], v[12:15]
  ds_read_b64_tr_b16 a[150:151], v45 offset:34816
  buffer_load_dwordx4 a[92:95], v49, s[4:7], s93 offen sc1
  s_add_u32 s57, s57, 1024
  v_mfma_f32_16x16x32_bf16 v[8:11], a[132:135], a[56:59], v[8:11]
  ds_read_b64_tr_b16 a[164:165], v45 offset:36864
  v_mfma_f32_16x16x32_bf16 v[8:11], a[116:119], a[48:51], v[8:11]
  ds_read_b64_tr_b16 a[166:167], v45 offset:38912
  s_waitcnt lgkmcnt(12)
  v_mfma_f32_16x16x32_bf16 v[16:19], a[120:123], a[48:51], v[16:19]
  ds_read_b64_tr_b16 a[152:153], v46 offset:32768
  s_add_u32 m0, s89, 57344
  s_add_u32 s92, s88, s80
  buffer_load_dwordx4 v252, s[24:27], s92 offen lds
  s_add_u32 s88, s88, 65536
  v_mfma_f32_16x16x32_bf16 v[16:19], a[136:139], a[56:59], v[16:19]
  ds_read_b64_tr_b16 a[154:155], v46 offset:34816
  v_mfma_f32_16x16x32_bf16 v[20:23], a[136:139], a[60:63], v[20:23]
  ds_read_b64_tr_b16 a[168:169], v46 offset:36864
  s_lshr_b32 s93, s85, 6
  s_add_u32 s93, s93, s57
  buffer_load_dwordx4 a[96:99], v48, s[4:7], s93 offen sc1
  v_mfma_f32_16x16x32_bf16 v[20:23], a[120:123], a[52:55], v[20:23]
  ds_read_b64_tr_b16 a[170:171], v46 offset:38912
  s_waitcnt lgkmcnt(12)
  v_mfma_f32_16x16x32_bf16 v[28:31], a[124:127], a[52:55], v[28:31]
  ds_read_b64_tr_b16 a[156:157], v47 offset:32768
  buffer_load_dwordx4 a[100:103], v49, s[4:7], s93 offen sc1
  s_add_u32 s57, s57, 1024
  v_mfma_f32_16x16x32_bf16 v[28:31], a[140:143], a[60:63], v[28:31]
  ds_read_b64_tr_b16 a[158:159], v47 offset:34816
  v_mfma_f32_16x16x32_bf16 v[24:27], a[140:143], a[56:59], v[24:27]
  ds_read_b64_tr_b16 a[172:173], v47 offset:36864
  v_mfma_f32_16x16x32_bf16 v[24:27], a[124:127], a[48:51], v[24:27]
  ds_read_b64_tr_b16 a[174:175], v47 offset:38912
  s_waitcnt vmcnt(9) lgkmcnt(12)
  v_mfma_f32_16x16x32_bf16 v[0:3], a[144:147], a[64:67], v[0:3]
  ds_read_b64_tr_b16 a[112:113], v44 offset:40960
  v_mfma_f32_16x16x32_bf16 v[0:3], a[160:163], a[72:75], v[0:3]
  ds_read_b64_tr_b16 a[114:115], v44 offset:43008
  s_add_u32 m0, s89, 61440
  s_add_u32 s92, s88, s81
  buffer_load_dwordx4 v252, s[24:27], s92 offen lds
  s_add_u32 s88, s88, 65536
  v_mfma_f32_16x16x32_bf16 v[4:7], a[160:163], a[76:79], v[4:7]
  ds_read_b64_tr_b16 a[128:129], v44 offset:45056
  v_mfma_f32_16x16x32_bf16 v[4:7], a[144:147], a[68:71], v[4:7]
  ds_read_b64_tr_b16 a[130:131], v44 offset:47104
  s_lshr_b32 s93, s86, 6
  s_add_u32 s93, s93, s57
  buffer_load_dwordx4 a[104:107], v48, s[4:7], s93 offen sc1
  s_waitcnt lgkmcnt(12)
  v_mfma_f32_16x16x32_bf16 v[12:15], a[148:151], a[68:71], v[12:15]
  ds_read_b64_tr_b16 a[116:117], v45 offset:40960
  v_mfma_f32_16x16x32_bf16 v[12:15], a[164:167], a[76:79], v[12:15]
  ds_read_b64_tr_b16 a[118:119], v45 offset:43008
  buffer_load_dwordx4 a[108:111], v49, s[4:7], s93 offen sc1
  s_add_u32 s57, s57, 1024
  v_mfma_f32_16x16x32_bf16 v[8:11], a[164:167], a[72:75], v[8:11]
  ds_read_b64_tr_b16 a[132:133], v45 offset:45056
  v_mfma_f32_16x16x32_bf16 v[8:11], a[148:151], a[64:67], v[8:11]
  ds_read_b64_tr_b16 a[134:135], v45 offset:47104
  s_waitcnt lgkmcnt(12)
  v_mfma_f32_16x16x32_bf16 v[16:19], a[152:155], a[64:67], v[16:19]
  ds_read_b64_tr_b16 a[120:121], v46 offset:40960
  s_add_u32 m0, s89, 65536
  s_add_u32 s92, s88, s82
  buffer_load_dwordx4 v252, s[24:27], s92 offen lds
  s_add_u32 s88, s88, 65536
  v_mfma_f32_16x16x32_bf16 v[16:19], a[168:171], a[72:75], v[16:19]
  ds_read_b64_tr_b16 a[122:123], v46 offset:43008
  v_mfma_f32_16x16x32_bf16 v[20:23], a[168:171], a[76:79], v[20:23]
  ds_read_b64_tr_b16 a[136:137], v46 offset:45056
  s_lshr_b32 s93, s80, 6
  s_add_u32 s93, s93, s57
  buffer_load_dwordx4 a[0:3], v48, s[4:7], s93 offen sc1
  v_mfma_f32_16x16x32_bf16 v[20:23], a[152:155], a[68:71], v[20:23]
  ds_read_b64_tr_b16 a[138:139], v46 offset:47104
  s_waitcnt lgkmcnt(12)
  v_mfma_f32_16x16x32_bf16 v[28:31], a[156:159], a[68:71], v[28:31]
  ds_read_b64_tr_b16 a[124:125], v47 offset:40960
  buffer_load_dwordx4 a[4:7], v49, s[4:7], s93 offen sc1
  s_add_u32 s57, s57, 1024
  v_mfma_f32_16x16x32_bf16 v[28:31], a[172:175], a[76:79], v[28:31]
  ds_read_b64_tr_b16 a[126:127], v47 offset:43008
  v_mfma_f32_16x16x32_bf16 v[24:27], a[172:175], a[72:75], v[24:27]
  ds_read_b64_tr_b16 a[140:141], v47 offset:45056
  v_mfma_f32_16x16x32_bf16 v[24:27], a[156:159], a[64:67], v[24:27]
  ds_read_b64_tr_b16 a[142:143], v47 offset:47104
  s_waitcnt vmcnt(9) lgkmcnt(12)
  v_mfma_f32_16x16x32_bf16 v[0:3], a[112:115], a[80:83], v[0:3]
  s_barrier
  ds_read_b64_tr_b16 a[144:145], v44 offset:49152
  v_mfma_f32_16x16x32_bf16 v[0:3], a[128:131], a[88:91], v[0:3]
  ds_read_b64_tr_b16 a[146:147], v44 offset:51200
  s_add_u32 m0, s89, 69632
  s_add_u32 s92, s88, s83
  s_add_u32 s92, s92, s90
  buffer_load_dwordx4 v252, s[24:27], s92 offen lds
  s_add_u32 s88, s88, 65536
  v_mfma_f32_16x16x32_bf16 v[4:7], a[128:131], a[92:95], v[4:7]
  ds_read_b64_tr_b16 a[160:161], v44 offset:53248
  v_mfma_f32_16x16x32_bf16 v[4:7], a[112:115], a[84:87], v[4:7]
  ds_read_b64_tr_b16 a[162:163], v44 offset:55296
  s_lshr_b32 s93, s81, 6
  s_add_u32 s93, s93, s57
  buffer_load_dwordx4 a[8:11], v48, s[4:7], s93 offen sc1
  s_waitcnt lgkmcnt(12)
  v_mfma_f32_16x16x32_bf16 v[12:15], a[116:119], a[84:87], v[12:15]
  ds_read_b64_tr_b16 a[148:149], v45 offset:49152
  v_mfma_f32_16x16x32_bf16 v[12:15], a[132:135], a[92:95], v[12:15]
  ds_read_b64_tr_b16 a[150:151], v45 offset:51200
  buffer_load_dwordx4 a[12:15], v49, s[4:7], s93 offen sc1
  s_add_u32 s57, s57, 1024
  v_mfma_f32_16x16x32_bf16 v[8:11], a[132:135], a[88:91], v[8:11]
  ds_read_b64_tr_b16 a[164:165], v45 offset:53248
  v_mfma_f32_16x16x32_bf16 v[8:11], a[116:119], a[80:83], v[8:11]
  ds_read_b64_tr_b16 a[166:167], v45 offset:55296
  s_waitcnt lgkmcnt(12)
  v_mfma_f32_16x16x32_bf16 v[16:19], a[120:123], a[80:83], v[16:19]
  ds_read_b64_tr_b16 a[152:153], v46 offset:49152
  s_add_u32 m0, s89, 73728
  s_add_u32 s92, s88, s84
  buffer_load_dwordx4 v252, s[24:27], s92 offen lds
  s_add_u32 s88, s88, 65536
  v_mfma_f32_16x16x32_bf16 v[16:19], a[136:139], a[88:91], v[16:19]
  ds_read_b64_tr_b16 a[154:155], v46 offset:51200
  v_mfma_f32_16x16x32_bf16 v[20:23], a[136:139], a[92:95], v[20:23]
  ds_read_b64_tr_b16 a[168:169], v46 offset:53248
  s_lshr_b32 s93, s82, 6
  s_add_u32 s93, s93, s57
  buffer_load_dwordx4 a[16:19], v48, s[4:7], s93 offen sc1
  v_mfma_f32_16x16x32_bf16 v[20:23], a[120:123], a[84:87], v[20:23]
  ds_read_b64_tr_b16 a[170:171], v46 offset:55296
  s_waitcnt lgkmcnt(12)
  v_mfma_f32_16x16x32_bf16 v[28:31], a[124:127], a[84:87], v[28:31]
  ds_read_b64_tr_b16 a[156:157], v47 offset:49152
  buffer_load_dwordx4 a[20:23], v49, s[4:7], s93 offen sc1
  s_add_u32 s57, s57, 1024
  v_mfma_f32_16x16x32_bf16 v[28:31], a[140:143], a[92:95], v[28:31]
  ds_read_b64_tr_b16 a[158:159], v47 offset:51200
  v_mfma_f32_16x16x32_bf16 v[24:27], a[140:143], a[88:91], v[24:27]
  ds_read_b64_tr_b16 a[172:173], v47 offset:53248
  v_mfma_f32_16x16x32_bf16 v[24:27], a[124:127], a[80:83], v[24:27]
  ds_read_b64_tr_b16 a[174:175], v47 offset:55296
  s_waitcnt vmcnt(9) lgkmcnt(12)
  v_mfma_f32_16x16x32_bf16 v[0:3], a[144:147], a[96:99], v[0:3]
  ds_read_b64_tr_b16 a[112:113], v40 offset:0
  v_mfma_f32_16x16x32_bf16 v[0:3], a[160:163], a[104:107], v[0:3]
  ds_read_b64_tr_b16 a[114:115], v40 offset:2048
  s_add_u32 m0, s89, 77824
  s_add_u32 s92, s88, s85
  buffer_load_dwordx4 v252, s[24:27], s92 offen lds
  s_add_u32 s88, s88, 65536
  v_mfma_f32_16x16x32_bf16 v[4:7], a[160:163], a[108:111], v[4:7]
  ds_read_b64_tr_b16 a[128:129], v40 offset:4096
  v_mfma_f32_16x16x32_bf16 v[4:7], a[144:147], a[100:103], v[4:7]
  ds_read_b64_tr_b16 a[130:131], v40 offset:6144
  s_lshr_b32 s93, s83, 6
  s_add_u32 s93, s93, s57
  buffer_load_dwordx4 a[24:27], v48, s[4:7], s93 offen sc1
  s_waitcnt lgkmcnt(12)
  v_mfma_f32_16x16x32_bf16 v[12:15], a[148:151], a[100:103], v[12:15]
  ds_read_b64_tr_b16 a[116:117], v41 offset:0
  v_mfma_f32_16x16x32_bf16 v[12:15], a[164:167], a[108:111], v[12:15]
  ds_read_b64_tr_b16 a[118:119], v41 offset:2048
  buffer_load_dwordx4 a[28:31], v49, s[4:7], s93 offen sc1
  s_add_u32 s57, s57, 1024
  v_mfma_f32_16x16x32_bf16 v[8:11], a[164:167], a[104:107], v[8:11]
  ds_read_b64_tr_b16 a[132:133], v41 offset:4096
  v_mfma_f32_16x16x32_bf16 v[8:11], a[148:151], a[96:99], v[8:11]
  ds_read_b64_tr_b16 a[134:135], v41 offset:6144
  s_waitcnt lgkmcnt(12)
  v_mfma_f32_16x16x32_bf16 v[16:19], a[152:155], a[96:99], v[16:19]
  ds_read_b64_tr_b16 a[120:121], v42 offset:0
  s_add_u32 m0, s89, 81920
  s_add_u32 s92, s88, s86
  buffer_load_dwordx4 v252, s[24:27], s92 offen lds
  s_add_u32 s88, s88, 65536
  v_mfma_f32_16x16x32_bf16 v[16:19], a[168:171], a[104:107], v[16:19]
  ds_read_b64_tr_b16 a[122:123], v42 offset:2048
  v_mfma_f32_16x16x32_bf16 v[20:23], a[168:171], a[108:111], v[20:23]
  ds_read_b64_tr_b16 a[136:137], v42 offset:4096
  s_lshr_b32 s93, s84, 6
  s_add_u32 s93, s93, s57
  buffer_load_dwordx4 a[32:35], v48, s[4:7], s93 offen sc1
  v_mfma_f32_16x16x32_bf16 v[20:23], a[152:155], a[100:103], v[20:23]
  ds_read_b64_tr_b16 a[138:139], v42 offset:6144
  s_waitcnt lgkmcnt(12)
  v_mfma_f32_16x16x32_bf16 v[28:31], a[156:159], a[100:103], v[28:31]
  ds_read_b64_tr_b16 a[124:125], v43 offset:0
  buffer_load_dwordx4 a[36:39], v49, s[4:7], s93 offen sc1
  s_add_u32 s57, s57, 1024
  v_mfma_f32_16x16x32_bf16 v[28:31], a[172:175], a[108:111], v[28:31]
  ds_read_b64_tr_b16 a[126:127], v43 offset:2048
  v_mfma_f32_16x16x32_bf16 v[24:27], a[172:175], a[104:107], v[24:27]
  ds_read_b64_tr_b16 a[140:141], v43 offset:4096
  v_mfma_f32_16x16x32_bf16 v[24:27], a[156:159], a[96:99], v[24:27]
  ds_read_b64_tr_b16 a[142:143], v43 offset:6144
  s_sub_u32 s56, s56, 1
  s_cmp_lg_u32 s56, 0
  s_cbranch_scc1 Lp4_loop
  s_waitcnt vmcnt(9) lgkmcnt(12)
  v_mfma_f32_16x16x32_bf16 v[0:3], a[112:115], a[0:3], v[0:3]
  s_barrier
  ds_read_b64_tr_b16 a[144:145], v40 offset:8192
  v_mfma_f32_16x16x32_bf16 v[0:3], a[128:131], a[8:11], v[0:3]
  ds_read_b64_tr_b16 a[146:147], v40 offset:10240
  s_add_u32 m0, s89, 86016
  s_mul_i32 s92, s80, -15
  s_add_u32 s92, s92, s88
  buffer_load_dwordx4 v252, s[24:27], s92 offen lds
  s_add_u32 s88, s88, 65536
  v_mfma_f32_16x16x32_bf16 v[4:7], a[128:131], a[12:15], v[4:7]
  ds_read_b64_tr_b16 a[160:161], v40 offset:12288
  v_mfma_f32_16x16x32_bf16 v[4:7], a[112:115], a[4:7], v[4:7]
  ds_read_b64_tr_b16 a[162:163], v40 offset:14336
  s_lshr_b32 s93, s85, 6
  s_add_u32 s93, s93, s57
  buffer_load_dwordx4 a[40:43], v48, s[4:7], s93 offen sc1
  s_waitcnt lgkmcnt(12)
  v_mfma_f32_16x16x32_bf16 v[12:15], a[116:119], a[4:7], v[12:15]
  ds_read_b64_tr_b16 a[148:149], v41 offset:8192
  v_mfma_f32_16x16x32_bf16 v[12:15], a[132:135], a[12:15], v[12:15]
  ds_read_b64_tr_b16 a[150:151], v41 offset:10240
  buffer_load_dwordx4 a[44:47], v49, s[4:7], s93 offen sc1
  s_add_u32 s57, s57, 1024
  v_mfma_f32_16x16x32_bf16 v[8:11], a[132:135], a[8:11], v[8:11]
  ds_read_b64_tr_b16 a[164:165], v41 offset:12288
  v_mfma_f32_16x16x32_bf16 v[8:11], a[116:119], a[0:3], v[8:11]
  ds_read_b64_tr_b16 a[166:167], v41 offset:14336
  s_waitcnt lgkmcnt(12)
  v_mfma_f32_16x16x32_bf16 v[16:19], a[120:123], a[0:3], v[16:19]
  ds_read_b64_tr_b16 a[152:153], v42 offset:8192
  s_add_u32 m0, s89, 90112
  s_mul_i32 s92, s81, -15
  s_add_u32 s92, s92, s88
  buffer_load_dwordx4 v252, s[24:27], s92 offen lds
  s_add_u32 s88, s88, 65536
  v_mfma_f32_16x16x32_bf16 v[16:19], a[136:139], a[8:11], v[16:19]
  ds_read_b64_tr_b16 a[154:155], v42 offset:10240
  v_mfma_f32_16x16x32_bf16 v[20:23], a[136:139], a[12:15], v[20:23]
  ds_read_b64_tr_b16 a[168:169], v42 offset:12288
  s_lshr_b32 s93, s86, 6
  s_add_u32 s93, s93, s57
  buffer_load_dwordx4 a[48:51], v48, s[4:7], s93 offen sc1
  v_mfma_f32_16x16x32_bf16 v[20:23], a[120:123], a[4:7], v[20:23]
  ds_read_b64_tr_b16 a[170:171], v42 offset:14336
  s_waitcnt lgkmcnt(12)
  v_mfma_f32_16x16x32_bf16 v[28:31], a[124:127], a[4:7], v[28:31]
  ds_read_b64_tr_b16 a[156:157], v43 offset:8192
  buffer_load_dwordx4 a[52:55], v49, s[4:7], s93 offen sc1
  s_add_u32 s57, s57, 1024
  v_mfma_f32_16x16x32_bf16 v[28:31], a[140:143], a[12:15], v[28:31]
  ds_read_b64_tr_b16 a[158:159], v43 offset:10240
  v_mfma_f32_16x16x32_bf16 v[24:27], a[140:143], a[8:11], v[24:27]
  ds_read_b64_tr_b16 a[172:173], v43 offset:12288
  v_mfma_f32_16x16x32_bf16 v[24:27], a[124:127], a[0:3], v[24:27]
  ds_read_b64_tr_b16 a[174:175], v43 offset:14336
  s_waitcnt vmcnt(9) lgkmcnt(12)
  v_mfma_f32_16x16x32_bf16 v[0:3], a[144:147], a[16:19], v[0:3]
  ds_read_b64_tr_b16 a[112:113], v40 offset:16384
  v_mfma_f32_16x16x32_bf16 v[0:3], a[160:163], a[24:27], v[0:3]
  ds_read_b64_tr_b16 a[114:115], v40 offset:18432
  s_add_u32 m0, s89, 94208
  s_mul_i32 s92, s82, -15
  s_add_u32 s92, s92, s88
  buffer_load_dwordx4 v252, s[24:27], s92 offen lds
  s_add_u32 s88, s88, 65536
  v_mfma_f32_16x16x32_bf16 v[4:7], a[160:163], a[28:31], v[4:7]
  ds_read_b64_tr_b16 a[128:129], v40 offset:20480
  v_mfma_f32_16x16x32_bf16 v[4:7], a[144:147], a[20:23], v[4:7]
  ds_read_b64_tr_b16 a[130:131], v40 offset:22528
  s_lshr_b32 s93, s80, 6
  s_add_u32 s93, s93, s57
  buffer_load_dwordx4 a[56:59], v48, s[4:7], s93 offen sc1
  s_waitcnt lgkmcnt(12)
  v_mfma_f32_16x16x32_bf16 v[12:15], a[148:151], a[20:23], v[12:15]
  ds_read_b64_tr_b16 a[116:117], v41 offset:16384
  v_mfma_f32_16x16x32_bf16 v[12:15], a[164:167], a[28:31], v[12:15]
  ds_read_b64_tr_b16 a[118:119], v41 offset:18432
  buffer_load_dwordx4 a[60:63], v49, s[4:7], s93 offen sc1
  s_add_u32 s57, s57, 1024
  v_mfma_f32_16x16x32_bf16 v[8:11], a[164:167], a[24:27], v[8:11]
  ds_read_b64_tr_b16 a[132:133], v41 offset:20480
  v_mfma_f32_16x16x32_bf16 v[8:11], a[148:151], a[16:19], v[8:11]
  ds_read_b64_tr_b16 a[134:135], v41 offset:22528
  s_waitcnt lgkmcnt(12)
  v_mfma_f32_16x16x32_bf16 v[16:19], a[152:155], a[16:19], v[16:19]
  ds_read_b64_tr_b16 a[120:121], v42 offset:16384
  s_add_u32 m0, s89, 98304
  s_mul_i32 s92, s83, -15
  s_add_u32 s92, s92, s88
  s_add_u32 s92, s92, s90
  buffer_load_dwordx4 v252, s[24:27], s92 offen lds
  s_add_u32 s88, s88, 65536
  v_mfma_f32_16x16x32_bf16 v[16:19], a[168:171], a[24:27], v[16:19]
  ds_read_b64_tr_b16 a[122:123], v42 offset:18432
  v_mfma_f32_16x16x32_bf16 v[20:23], a[168:171], a[28:31], v[20:23]
  ds_read_b64_tr_b16 a[136:137], v42 offset:20480
  s_lshr_b32 s93, s81, 6
  s_add_u32 s93, s93, s57
  buffer_load_dwordx4 a[64:67], v48, s[4:7], s93 offen sc1
  v_mfma_f32_16x16x32_bf16 v[20:23], a[152:155], a[20:23], v[20:23]
  ds_read_b64_tr_b16 a[138:139], v42 offset:22528
  s_waitcnt lgkmcnt(12)
  v_mfma_f32_16x16x32_bf16 v[28:31], a[156:159], a[20:23], v[28:31]
  ds_read_b64_tr_b16 a[124:125], v43 offset:16384
  buffer_load_dwordx4 a[68:71], v49, s[4:7], s93 offen sc1
  s_add_u32 s57, s57, 1024
  v_mfma_f32_16x16x32_bf16 v[28:31], a[172:175], a[28:31], v[28:31]
  ds_read_b64_tr_b16 a[126:127], v43 offset:18432
  v_mfma_f32_16x16x32_bf16 v[24:27], a[172:175], a[24:27], v[24:27]
  ds_read_b64_tr_b16 a[140:141], v43 offset:20480
  v_mfma_f32_16x16x32_bf16 v[24:27], a[156:159], a[16:19], v[24:27]
  ds_read_b64_tr_b16 a[142:143], v43 offset:22528
  s_waitcnt vmcnt(9) lgkmcnt(12)
  v_mfma_f32_16x16x32_bf16 v[0:3], a[112:115], a[32:35], v[0:3]
  s_barrier
  ds_read_b64_tr_b16 a[144:145], v40 offset:24576
  v_mfma_f32_16x16x32_bf16 v[0:3], a[128:131], a[40:43], v[0:3]
  ds_read_b64_tr_b16 a[146:147], v40 offset:26624
  s_add_u32 m0, s89, 102400
  s_mul_i32 s92, s84, -15
  s_add_u32 s92, s92, s88
  buffer_load_dwordx4 v252, s[24:27], s92 offen lds
  s_add_u32 s88, s88, 65536
  v_mfma_f32_16x16x32_bf16 v[4:7], a[128:131], a[44:47], v[4:7]
  ds_read_b64_tr_b16 a[160:161], v40 offset:28672
  v_mfma_f32_16x16x32_bf16 v[4:7], a[112:115], a[36:39], v[4:7]
  ds_read_b64_tr_b16 a[162:163], v40 offset:30720
  s_lshr_b32 s93, s82, 6
  s_add_u32 s93, s93, s57
  buffer_load_dwordx4 a[72:75], v48, s[4:7], s93 offen sc1
  s_waitcnt lgkmcnt(12)
  v_mfma_f32_16x16x32_bf16 v[12:15], a[116:119], a[36:39], v[12:15]
  ds_read_b64_tr_b16 a[148:149], v41 offset:24576
  v_mfma_f32_16x16x32_bf16 v[12:15], a[132:135], a[44:47], v[12:15]
  ds_read_b64_tr_b16 a[150:151], v41 offset:26624
  buffer_load_dwordx4 a[76:79], v49, s[4:7], s93 offen sc1
  s_add_u32 s57, s57, 1024
  v_mfma_f32_16x16x32_bf16 v[8:11], a[132:135], a[40:43], v[8:11]
  ds_read_b64_tr_b16 a[164:165], v41 offset:28672
  v_mfma_f32_16x16x32_bf16 v[8:11], a[116:119], a[32:35], v[8:11]
  ds_read_b64_tr_b16 a[166:167], v41 offset:30720
  s_waitcnt lgkmcnt(12)
  v_mfma_f32_16x16x32_bf16 v[16:19], a[120:123], a[32:35], v[16:19]
  ds_read_b64_tr_b16 a[152:153], v42 offset:24576
  s_add_u32 m0, s89, 106496
  s_mul_i32 s92, s85, -15
  s_add_u32 s92, s92, s88
  buffer_load_dwordx4 v252, s[24:27], s92 offen lds
  s_add_u32 s88, s88, 65536
  v_mfma_f32_16x16x32_bf16 v[16:19], a[136:139], a[40:43], v[16:19]
  ds_read_b64_tr_b16 a[154:155], v42 offset:26624
  v_mfma_f32_16x16x32_bf16 v[20:23], a[136:139], a[44:47], v[20:23]
  ds_read_b64_tr_b16 a[168:169], v42 offset:28672
  s_lshr_b32 s93, s83, 6
  s_add_u32 s93, s93, s57
  buffer_load_dwordx4 a[80:83], v48, s[4:7], s93 offen sc1
  v_mfma_f32_16x16x32_bf16 v[20:23], a[120:123], a[36:39], v[20:23]
  ds_read_b64_tr_b16 a[170:171], v42 offset:30720
  s_waitcnt lgkmcnt(12)
  v_mfma_f32_16x16x32_bf16 v[28:31], a[124:127], a[36:39], v[28:31]
  ds_read_b64_tr_b16 a[156:157], v43 offset:24576
  buffer_load_dwordx4 a[84:87], v49, s[4:7], s93 offen sc1
  s_add_u32 s57, s57, 1024
  v_mfma_f32_16x16x32_bf16 v[28:31], a[140:143], a[44:47], v[28:31]
  ds_read_b64_tr_b16 a[158:159], v43 offset:26624
  v_mfma_f32_16x16x32_bf16 v[24:27], a[140:143], a[40:43], v[24:27]
  ds_read_b64_tr_b16 a[172:173], v43 offset:28672
  v_mfma_f32_16x16x32_bf16 v[24:27], a[124:127], a[32:35], v[24:27]
  ds_read_b64_tr_b16 a[174:175], v43 offset:30720
  s_waitcnt vmcnt(9) lgkmcnt(12)
  v_mfma_f32_16x16x32_bf16 v[0:3], a[144:147], a[48:51], v[0:3]
  ds_read_b64_tr_b16 a[112:113], v40 offset:32768
  v_mfma_f32_16x16x32_bf16 v[0:3], a[160:163], a[56:59], v[0:3]
  ds_read_b64_tr_b16 a[114:115], v40 offset:34816
  s_add_u32 m0, s89, 110592
  s_mul_i32 s92, s86, -15
  s_add_u32 s92, s92, s88
  buffer_load_dwordx4 v252, s[24:27], s92 offen lds
  s_add_u32 s88, s88, 65536
  v_mfma_f32_16x16x32_bf16 v[4:7], a[160:163], a[60:63], v[4:7]
  ds_read_b64_tr_b16 a[128:129], v40 offset:36864
  v_mfma_f32_16x16x32_bf16 v[4:7], a[144:147], a[52:55], v[4:7]
  ds_read_b64_tr_b16 a[130:131], v40 offset:38912
  s_lshr_b32 s93, s84, 6
  s_add_u32 s93, s93, s57
  buffer_load_dwordx4 a[88:91], v48, s[4:7], s93 offen sc1
  s_waitcnt lgkmcnt(12)
  v_mfma_f32_16x16x32_bf16 v[12:15], a[148:151], a[52:55], v[12:15]
  ds_read_b64_tr_b16 a[116:117], v41 offset:32768
  v_mfma_f32_16x16x32_bf16 v[12:15], a[164:167], a[60:63], v[12:15]
  ds_read_b64_tr_b16 a[118:119], v41 offset:34816
  v_mfma_f32_16x16x32_bf16 v[8:11], a[164:167], a[56:59], v[8:11]
  ds_read_b64_tr_b16 a[132:133], v41 offset:36864
  buffer_load_dwordx4 a[92:95], v49, s[4:7], s93 offen sc1
  s_add_u32 s57, s57, 1024
  v_mfma_f32_16x16x32_bf16 v[8:11], a[148:151], a[48:51], v[8:11]
  ds_read_b64_tr_b16 a[134:135], v41 offset:38912
  s_waitcnt lgkmcnt(12)
  v_mfma_f32_16x16x32_bf16 v[16:19], a[152:155], a[48:51], v[16:19]
  ds_read_b64_tr_b16 a[120:121], v42 offset:32768
  v_mfma_f32_16x16x32_bf16 v[16:19], a[168:171], a[56:59], v[16:19]
  ds_read_b64_tr_b16 a[122:123], v42 offset:34816
  s_lshr_b32 s93, s85, 6
  s_add_u32 s93, s93, s57
  buffer_load_dwordx4 a[96:99], v48, s[4:7], s93 offen sc1
  v_mfma_f32_16x16x32_bf16 v[20:23], a[168:171], a[60:63], v[20:23]
  ds_read_b64_tr_b16 a[136:137], v42 offset:36864
  v_mfma_f32_16x16x32_bf16 v[20:23], a[152:155], a[52:55], v[20:23]
  ds_read_b64_tr_b16 a[138:139], v42 offset:38912
  s_waitcnt lgkmcnt(12)
  v_mfma_f32_16x16x32_bf16 v[28:31], a[156:159], a[52:55], v[28:31]
  ds_read_b64_tr_b16 a[124:125], v43 offset:32768
  buffer_load_dwordx4 a[100:103], v49, s[4:7], s93 offen sc1
  s_add_u32 s57, s57, 1024
  v_mfma_f32_16x16x32_bf16 v[28:31], a[172:175], a[60:63], v[28:31]
  ds_read_b64_tr_b16 a[126:127], v43 offset:34816
  v_mfma_f32_16x16x32_bf16 v[24:27], a[172:175], a[56:59], v[24:27]
  ds_read_b64_tr_b16 a[140:141], v43 offset:36864
  v_mfma_f32_16x16x32_bf16 v[24:27], a[156:159], a[48:51], v[24:27]
  ds_read_b64_tr_b16 a[142:143], v43 offset:38912
  s_waitcnt vmcnt(8) lgkmcnt(12)
  v_mfma_f32_16x16x32_bf16 v[0:3], a[112:115], a[64:67], v[0:3]
  s_barrier
  ds_read_b64_tr_b16 a[144:145], v40 offset:40960
  v_mfma_f32_16x16x32_bf16 v[0:3], a[128:131], a[72:75], v[0:3]
  ds_read_b64_tr_b16 a[146:147], v40 offset:43008
  s_lshr_b32 s93, s86, 6
  s_add_u32 s93, s93, s57
  buffer_load_dwordx4 a[104:107], v48, s[4:7], s93 offen sc1
  v_mfma_f32_16x16x32_bf16 v[4:7], a[128:131], a[76:79], v[4:7]
  ds_read_b64_tr_b16 a[160:161], v40 offset:45056
  v_mfma_f32_16x16x32_bf16 v[4:7], a[112:115], a[68:71], v[4:7]
  ds_read_b64_tr_b16 a[162:163], v40 offset:47104
  s_waitcnt lgkmcnt(12)
  v_mfma_f32_16x16x32_bf16 v[12:15], a[116:119], a[68:71], v[12:15]
  ds_read_b64_tr_b16 a[148:149], v41 offset:40960
  buffer_load_dwordx4 a[108:111], v49, s[4:7], s93 offen sc1
  s_add_u32 s57, s57, 1024
  v_mfma_f32_16x16x32_bf16 v[12:15], a[132:135], a[76:79], v[12:15]
  ds_read_b64_tr_b16 a[150:151], v41 offset:43008
  v_mfma_f32_16x16x32_bf16 v[8:11], a[132:135], a[72:75], v[8:11]
  ds_read_b64_tr_b16 a[164:165], v41 offset:45056
  v_mfma_f32_16x16x32_bf16 v[8:11], a[116:119], a[64:67], v[8:11]
  ds_read_b64_tr_b16 a[166:167], v41 offset:47104
  s_waitcnt lgkmcnt(12)
  v_mfma_f32_16x16x32_bf16 v[16:19], a[120:123], a[64:67], v[16:19]
  ds_read_b64_tr_b16 a[152:153], v42 offset:40960
  s_lshr_b32 s93, s80, 6
  s_add_u32 s93, s93, s57
  buffer_load_dwordx4 a[0:3], v48, s[4:7], s93 offen sc1
  v_mfma_f32_16x16x32_bf16 v[16:19], a[136:139], a[72:75], v[16:19]
  ds_read_b64_tr_b16 a[154:155], v42 offset:43008
  v_mfma_f32_16x16x32_bf16 v[20:23], a[136:139], a[76:79], v[20:23]
  ds_read_b64_tr_b16 a[168:169], v42 offset:45056
  v_mfma_f32_16x16x32_bf16 v[20:23], a[120:123], a[68:71], v[20:23]
  ds_read_b64_tr_b16 a[170:171], v42 offset:47104
  buffer_load_dwordx4 a[4:7], v49, s[4:7], s93 offen sc1
  s_add_u32 s57, s57, 1024
  s_waitcnt lgkmcnt(12)
  v_mfma_f32_16x16x32_bf16 v[28:31], a[124:127], a[68:71], v[28:31]
  ds_read_b64_tr_b16 a[156:157], v43 offset:40960
  v_mfma_f32_16x16x32_bf16 v[28:31], a[140:143], a[76:79], v[28:31]
  ds_read_b64_tr_b16 a[158:159], v43 offset:43008
  v_mfma_f32_16x16x32_bf16 v[24:27], a[140:143], a[72:75], v[24:27]
  ds_read_b64_tr_b16 a[172:173], v43 offset:45056
  v_mfma_f32_16x16x32_bf16 v[24:27], a[124:127], a[64:67], v[24:27]
  ds_read_b64_tr_b16 a[174:175], v43 offset:47104
  s_waitcnt vmcnt(6) lgkmcnt(12)
  v_mfma_f32_16x16x32_bf16 v[0:3], a[144:147], a[80:83], v[0:3]
  ds_read_b64_tr_b16 a[112:113], v40 offset:49152
  v_mfma_f32_16x16x32_bf16 v[0:3], a[160:163], a[88:91], v[0:3]
  ds_read_b64_tr_b16 a[114:115], v40 offset:51200
  s_lshr_b32 s93, s81, 6
  s_add_u32 s93, s93, s57
  buffer_load_dwordx4 a[8:11], v48, s[4:7], s93 offen sc1
  v_mfma_f32_16x16x32_bf16 v[4:7], a[160:163], a[92:95], v[4:7]
  ds_read_b64_tr_b16 a[128:129], v40 offset:53248
  v_mfma_f32_16x16x32_bf16 v[4:7], a[144:147], a[84:87], v[4:7]
  ds_read_b64_tr_b16 a[130:131], v40 offset:55296
  s_waitcnt lgkmcnt(12)
  v_mfma_f32_16x16x32_bf16 v[12:15], a[148:151], a[84:87], v[12:15]
  ds_read_b64_tr_b16 a[116:117], v41 offset:49152
  buffer_load_dwordx4 a[12:15], v49, s[4:7], s93 offen sc1
  s_add_u32 s57, s57, 1024
  v_mfma_f32_16x16x32_bf16 v[12:15], a[164:167], a[92:95], v[12:15]
  ds_read_b64_tr_b16 a[118:119], v41 offset:51200
  v_mfma_f32_16x16x32_bf16 v[8:11], a[164:167], a[88:91], v[8:11]
  ds_read_b64_tr_b16 a[132:133], v41 offset:53248
  v_mfma_f32_16x16x32_bf16 v[8:11], a[148:151], a[80:83], v[8:11]
  ds_read_b64_tr_b16 a[134:135], v41 offset:55296
  s_waitcnt lgkmcnt(12)
  v_mfma_f32_16x16x32_bf16 v[16:19], a[152:155], a[80:83], v[16:19]
  ds_read_b64_tr_b16 a[120:121], v42 offset:49152
  s_lshr_b32 s93, s82, 6
  s_add_u32 s93, s93, s57
  buffer_load_dwordx4 a[16:19], v48, s[4:7], s93 offen sc1
  v_mfma_f32_16x16x32_bf16 v[16:19], a[168:171], a[88:91], v[16:19]
  ds_read_b64_tr_b16 a[122:123], v42 offset:51200
  v_mfma_f32_16x16x32_bf16 v[20:23], a[168:171], a[92:95], v[20:23]
  ds_read_b64_tr_b16 a[136:137], v42 offset:53248
  v_mfma_f32_16x16x32_bf16 v[20:23], a[152:155], a[84:87], v[20:23]
  ds_read_b64_tr_b16 a[138:139], v42 offset:55296
  buffer_load_dwordx4 a[20:23], v49, s[4:7], s93 offen sc1
  s_add_u32 s57, s57, 1024
  s_waitcnt lgkmcnt(12)
  v_mfma_f32_16x16x32_bf16 v[28:31], a[156:159], a[84:87], v[28:31]
  ds_read_b64_tr_b16 a[124:125], v43 offset:49152
  v_mfma_f32_16x16x32_bf16 v[28:31], a[172:175], a[92:95], v[28:31]
  ds_read_b64_tr_b16 a[126:127], v43 offset:51200
  v_mfma_f32_16x16x32_bf16 v[24:27], a[172:175], a[88:91], v[24:27]
  ds_read_b64_tr_b16 a[140:141], v43 offset:53248
  v_mfma_f32_16x16x32_bf16 v[24:27], a[156:159], a[80:83], v[24:27]
  ds_read_b64_tr_b16 a[142:143], v43 offset:55296
  s_waitcnt vmcnt(6) lgkmcnt(12)
  v_mfma_f32_16x16x32_bf16 v[0:3], a[112:115], a[96:99], v[0:3]
  s_barrier
  ds_read_b64_tr_b16 a[144:145], v44 offset:0
  v_mfma_f32_16x16x32_bf16 v[0:3], a[128:131], a[104:107], v[0:3]
  ds_read_b64_tr_b16 a[146:147], v44 offset:2048
  s_lshr_b32 s93, s83, 6
  s_add_u32 s93, s93, s57
  buffer_load_dwordx4 a[24:27], v48, s[4:7], s93 offen sc1
  v_mfma_f32_16x16x32_bf16 v[4:7], a[128:131], a[108:111], v[4:7]
  ds_read_b64_tr_b16 a[160:161], v44 offset:4096
  v_mfma_f32_16x16x32_bf16 v[4:7], a[112:115], a[100:103], v[4:7]
  ds_read_b64_tr_b16 a[162:163], v44 offset:6144
  s_waitcnt lgkmcnt(12)
  v_mfma_f32_16x16x32_bf16 v[12:15], a[116:119], a[100:103], v[12:15]
  ds_read_b64_tr_b16 a[148:149], v45 offset:0
  buffer_load_dwordx4 a[28:31], v49, s[4:7], s93 offen sc1
  s_add_u32 s57, s57, 1024
  v_mfma_f32_16x16x32_bf16 v[12:15], a[132:135], a[108:111], v[12:15]
  ds_read_b64_tr_b16 a[150:151], v45 offset:2048
  v_mfma_f32_16x16x32_bf16 v[8:11], a[132:135], a[104:107], v[8:11]
  ds_read_b64_tr_b16 a[164:165], v45 offset:4096
  v_mfma_f32_16x16x32_bf16 v[8:11], a[116:119], a[96:99], v[8:11]
  ds_read_b64_tr_b16 a[166:167], v45 offset:6144
  s_waitcnt lgkmcnt(12)
  v_mfma_f32_16x16x32_bf16 v[16:19], a[120:123], a[96:99], v[16:19]
  ds_read_b64_tr_b16 a[152:153], v46 offset:0
  s_lshr_b32 s93, s84, 6
  s_add_u32 s93, s93, s57
  buffer_load_dwordx4 a[32:35], v48, s[4:7], s93 offen sc1
  v_mfma_f32_16x16x32_bf16 v[16:19], a[136:139], a[104:107], v[16:19]
  ds_read_b64_tr_b16 a[154:155], v46 offset:2048
  v_mfma_f32_16x16x32_bf16 v[20:23], a[136:139], a[108:111], v[20:23]
  ds_read_b64_tr_b16 a[168:169], v46 offset:4096
  v_mfma_f32_16x16x32_bf16 v[20:23], a[120:123], a[100:103], v[20:23]
  ds_read_b64_tr_b16 a[170:171], v46 offset:6144
  buffer_load_dwordx4 a[36:39], v49, s[4:7], s93 offen sc1
  s_add_u32 s57, s57, 1024
  s_waitcnt lgkmcnt(12)
  v_mfma_f32_16x16x32_bf16 v[28:31], a[124:127], a[100:103], v[28:31]
  ds_read_b64_tr_b16 a[156:157], v47 offset:0
  v_mfma_f32_16x16x32_bf16 v[28:31], a[140:143], a[108:111], v[28:31]
  ds_read_b64_tr_b16 a[158:159], v47 offset:2048
  v_mfma_f32_16x16x32_bf16 v[24:27], a[140:143], a[104:107], v[24:27]
  ds_read_b64_tr_b16 a[172:173], v47 offset:4096
  v_mfma_f32_16x16x32_bf16 v[24:27], a[124:127], a[96:99], v[24:27]
  ds_read_b64_tr_b16 a[174:175], v47 offset:6144
  s_waitcnt vmcnt(6) lgkmcnt(12)
  v_mfma_f32_16x16x32_bf16 v[0:3], a[144:147], a[0:3], v[0:3]
  ds_read_b64_tr_b16 a[112:113], v44 offset:8192
  v_mfma_f32_16x16x32_bf16 v[0:3], a[160:163], a[8:11], v[0:3]
  ds_read_b64_tr_b16 a[114:115], v44 offset:10240
  s_lshr_b32 s93, s85, 6
  s_add_u32 s93, s93, s57
  buffer_load_dwordx4 a[40:43], v48, s[4:7], s93 offen sc1
  v_mfma_f32_16x16x32_bf16 v[4:7], a[160:163], a[12:15], v[4:7]
  ds_read_b64_tr_b16 a[128:129], v44 offset:12288
  v_mfma_f32_16x16x32_bf16 v[4:7], a[144:147], a[4:7], v[4:7]
  ds_read_b64_tr_b16 a[130:131], v44 offset:14336
  s_waitcnt lgkmcnt(12)
  v_mfma_f32_16x16x32_bf16 v[12:15], a[148:151], a[4:7], v[12:15]
  ds_read_b64_tr_b16 a[116:117], v45 offset:8192
  buffer_load_dwordx4 a[44:47], v49, s[4:7], s93 offen sc1
  s_add_u32 s57, s57, 1024
  v_mfma_f32_16x16x32_bf16 v[12:15], a[164:167], a[12:15], v[12:15]
  ds_read_b64_tr_b16 a[118:119], v45 offset:10240
  v_mfma_f32_16x16x32_bf16 v[8:11], a[164:167], a[8:11], v[8:11]
  ds_read_b64_tr_b16 a[132:133], v45 offset:12288
  v_mfma_f32_16x16x32_bf16 v[8:11], a[148:151], a[0:3], v[8:11]
  ds_read_b64_tr_b16 a[134:135], v45 offset:14336
  s_waitcnt lgkmcnt(12)
  v_mfma_f32_16x16x32_bf16 v[16:19], a[152:155], a[0:3], v[16:19]
  ds_read_b64_tr_b16 a[120:121], v46 offset:8192
  s_lshr_b32 s93, s86, 6
  s_add_u32 s93, s93, s57
  buffer_load_dwordx4 a[48:51], v48, s[4:7], s93 offen sc1
  v_mfma_f32_16x16x32_bf16 v[16:19], a[168:171], a[8:11], v[16:19]
  ds_read_b64_tr_b16 a[122:123], v46 offset:10240
  v_mfma_f32_16x16x32_bf16 v[20:23], a[168:171], a[12:15], v[20:23]
  ds_read_b64_tr_b16 a[136:137], v46 offset:12288
  v_mfma_f32_16x16x32_bf16 v[20:23], a[152:155], a[4:7], v[20:23]
  ds_read_b64_tr_b16 a[138:139], v46 offset:14336
  buffer_load_dwordx4 a[52:55], v49, s[4:7], s93 offen sc1
  s_add_u32 s57, s57, 1024
  s_waitcnt lgkmcnt(12)
  v_mfma_f32_16x16x32_bf16 v[28:31], a[156:159], a[4:7], v[28:31]
  ds_read_b64_tr_b16 a[124:125], v47 offset:8192
  v_mfma_f32_16x16x32_bf16 v[28:31], a[172:175], a[12:15], v[28:31]
  ds_read_b64_tr_b16 a[126:127], v47 offset:10240
  v_mfma_f32_16x16x32_bf16 v[24:27], a[172:175], a[8:11], v[24:27]
  ds_read_b64_tr_b16 a[140:141], v47 offset:12288
  v_mfma_f32_16x16x32_bf16 v[24:27], a[156:159], a[0:3], v[24:27]
  ds_read_b64_tr_b16 a[142:143], v47 offset:14336
  s_waitcnt vmcnt(6) lgkmcnt(12)
  v_mfma_f32_16x16x32_bf16 v[0:3], a[112:115], a[16:19], v[0:3]
  s_barrier
  ds_read_b64_tr_b16 a[144:145], v44 offset:16384
  v_mfma_f32_16x16x32_bf16 v[0:3], a[128:131], a[24:27], v[0:3]
  ds_read_b64_tr_b16 a[146:147], v44 offset:18432
  s_lshr_b32 s93, s80, 6
  s_mul_i32 s93, s93, -15
  s_add_u32 s93, s93, s57
  buffer_load_dwordx4 a[56:59], v48, s[4:7], s93 offen sc1
  v_mfma_f32_16x16x32_bf16 v[4:7], a[128:131], a[28:31], v[4:7]
  ds_read_b64_tr_b16 a[160:161], v44 offset:20480
  v_mfma_f32_16x16x32_bf16 v[4:7], a[112:115], a[20:23], v[4:7]
  ds_read_b64_tr_b16 a[162:163], v44 offset:22528
  s_waitcnt lgkmcnt(12)
  v_mfma_f32_16x16x32_bf16 v[12:15], a[116:119], a[20:23], v[12:15]
  ds_read_b64_tr_b16 a[148:149], v45 offset:16384
  buffer_load_dwordx4 a[60:63], v49, s[4:7], s93 offen sc1
  s_add_u32 s57, s57, 1024
  v_mfma_f32_16x16x32_bf16 v[12:15], a[132:135], a[28:31], v[12:15]
  ds_read_b64_tr_b16 a[150:151], v45 offset:18432
  v_mfma_f32_16x16x32_bf16 v[8:11], a[132:135], a[24:27], v[8:11]
  ds_read_b64_tr_b16 a[164:165], v45 offset:20480
  v_mfma_f32_16x16x32_bf16 v[8:11], a[116:119], a[16:19], v[8:11]
  ds_read_b64_tr_b16 a[166:167], v45 offset:22528
  s_waitcnt lgkmcnt(12)
  v_mfma_f32_16x16x32_bf16 v[16:19], a[120:123], a[16:19], v[16:19]
  ds_read_b64_tr_b16 a[152:153], v46 offset:16384
  s_lshr_b32 s93, s81, 6
  s_mul_i32 s93, s93, -15
  s_add_u32 s93, s93, s57
  buffer_load_dwordx4 a[64:67], v48, s[4:7], s93 offen sc1
  v_mfma_f32_16x16x32_bf16 v[16:19], a[136:139], a[24:27], v[16:19]
  ds_read_b64_tr_b16 a[154:155], v46 offset:18432
  v_mfma_f32_16x16x32_bf16 v[20:23], a[136:139], a[28:31], v[20:23]
  ds_read_b64_tr_b16 a[168:169], v46 offset:20480
  v_mfma_f32_16x16x32_bf16 v[20:23], a[120:123], a[20:23], v[20:23]
  ds_read_b64_tr_b16 a[170:171], v46 offset:22528
  buffer_load_dwordx4 a[68:71], v49, s[4:7], s93 offen sc1
  s_add_u32 s57, s57, 1024
  s_waitcnt lgkmcnt(12)
  v_mfma_f32_16x16x32_bf16 v[28:31], a[124:127], a[20:23], v[28:31]
  ds_read_b64_tr_b16 a[156:157], v47 offset:16384
  v_mfma_f32_16x16x32_bf16 v[28:31], a[140:143], a[28:31], v[28:31]
  ds_read_b64_tr_b16 a[158:159], v47 offset:18432
  v_mfma_f32_16x16x32_bf16 v[24:27], a[140:143], a[24:27], v[24:27]
  ds_read_b64_tr_b16 a[172:173], v47 offset:20480
  v_mfma_f32_16x16x32_bf16 v[24:27], a[124:127], a[16:19], v[24:27]
  ds_read_b64_tr_b16 a[174:175], v47 offset:22528
  s_waitcnt vmcnt(6) lgkmcnt(12)
  v_mfma_f32_16x16x32_bf16 v[0:3], a[144:147], a[32:35], v[0:3]
  ds_read_b64_tr_b16 a[112:113], v44 offset:24576
  v_mfma_f32_16x16x32_bf16 v[0:3], a[160:163], a[40:43], v[0:3]
  ds_read_b64_tr_b16 a[114:115], v44 offset:26624
  s_lshr_b32 s93, s82, 6
  s_mul_i32 s93, s93, -15
  s_add_u32 s93, s93, s57
  buffer_load_dwordx4 a[72:75], v48, s[4:7], s93 offen sc1
  v_mfma_f32_16x16x32_bf16 v[4:7], a[160:163], a[44:47], v[4:7]
  ds_read_b64_tr_b16 a[128:129], v44 offset:28672
  v_mfma_f32_16x16x32_bf16 v[4:7], a[144:147], a[36:39], v[4:7]
  ds_read_b64_tr_b16 a[130:131], v44 offset:30720
  s_waitcnt lgkmcnt(12)
  v_mfma_f32_16x16x32_bf16 v[12:15], a[148:151], a[36:39], v[12:15]
  ds_read_b64_tr_b16 a[116:117], v45 offset:24576
  buffer_load_dwordx4 a[76:79], v49, s[4:7], s93 offen sc1
  s_add_u32 s57, s57, 1024
  v_mfma_f32_16x16x32_bf16 v[12:15], a[164:167], a[44:47], v[12:15]
  ds_read_b64_tr_b16 a[118:119], v45 offset:26624
  v_mfma_f32_16x16x32_bf16 v[8:11], a[164:167], a[40:43], v[8:11]
  ds_read_b64_tr_b16 a[132:133], v45 offset:28672
  v_mfma_f32_16x16x32_bf16 v[8:11], a[148:151], a[32:35], v[8:11]
  ds_read_b64_tr_b16 a[134:135], v45 offset:30720
  s_waitcnt lgkmcnt(12)
  v_mfma_f32_16x16x32_bf16 v[16:19], a[152:155], a[32:35], v[16:19]
  ds_read_b64_tr_b16 a[120:121], v46 offset:24576
  s_lshr_b32 s93, s83, 6
  s_mul_i32 s93, s93, -15
  s_add_u32 s93, s93, s57
  buffer_load_dwordx4 a[80:83], v48, s[4:7], s93 offen sc1
  v_mfma_f32_16x16x32_bf16 v[16:19], a[168:171], a[40:43], v[16:19]
  ds_read_b64_tr_b16 a[122:123], v46 offset:26624
  v_mfma_f32_16x16x32_bf16 v[20:23], a[168:171], a[44:47], v[20:23]
  ds_read_b64_tr_b16 a[136:137], v46 offset:28672
  v_mfma_f32_16x16x32_bf16 v[20:23], a[152:155], a[36:39], v[20:23]
  ds_read_b64_tr_b16 a[138:139], v46 offset:30720
  buffer_load_dwordx4 a[84:87], v49, s[4:7], s93 offen sc1
  s_add_u32 s57, s57, 1024
  s_waitcnt lgkmcnt(12)
  v_mfma_f32_16x16x32_bf16 v[28:31], a[156:159], a[36:39], v[28:31]
  ds_read_b64_tr_b16 a[124:125], v47 offset:24576
  v_mfma_f32_16x16x32_bf16 v[28:31], a[172:175], a[44:47], v[28:31]
  ds_read_b64_tr_b16 a[126:127], v47 offset:26624
  v_mfma_f32_16x16x32_bf16 v[24:27], a[172:175], a[40:43], v[24:27]
  ds_read_b64_tr_b16 a[140:141], v47 offset:28672
  v_mfma_f32_16x16x32_bf16 v[24:27], a[156:159], a[32:35], v[24:27]
  ds_read_b64_tr_b16 a[142:143], v47 offset:30720
  s_waitcnt vmcnt(6) lgkmcnt(12)
  v_mfma_f32_16x16x32_bf16 v[0:3], a[112:115], a[48:51], v[0:3]
  s_barrier
  ds_read_b64_tr_b16 a[144:145], v44 offset:32768
  v_mfma_f32_16x16x32_bf16 v[0:3], a[128:131], a[56:59], v[0:3]
  ds_read_b64_tr_b16 a[146:147], v44 offset:34816
  s_lshr_b32 s93, s84, 6
  s_mul_i32 s93, s93, -15
  s_add_u32 s93, s93, s57
  buffer_load_dwordx4 a[88:91], v48, s[4:7], s93 offen sc1
  v_mfma_f32_16x16x32_bf16 v[4:7], a[128:131], a[60:63], v[4:7]
  ds_read_b64_tr_b16 a[160:161], v44 offset:36864
  v_mfma_f32_16x16x32_bf16 v[4:7], a[112:115], a[52:55], v[4:7]
  ds_read_b64_tr_b16 a[162:163], v44 offset:38912
  s_waitcnt lgkmcnt(12)
  v_mfma_f32_16x16x32_bf16 v[12:15], a[116:119], a[52:55], v[12:15]
  ds_read_b64_tr_b16 a[148:149], v45 offset:32768
  buffer_load_dwordx4 a[92:95], v49, s[4:7], s93 offen sc1
  s_add_u32 s57, s57, 1024
  v_mfma_f32_16x16x32_bf16 v[12:15], a[132:135], a[60:63], v[12:15]
  ds_read_b64_tr_b16 a[150:151], v45 offset:34816
  v_mfma_f32_16x16x32_bf16 v[8:11], a[132:135], a[56:59], v[8:11]
  ds_read_b64_tr_b16 a[164:165], v45 offset:36864
  v_mfma_f32_16x16x32_bf16 v[8:11], a[116:119], a[48:51], v[8:11]
  ds_read_b64_tr_b16 a[166:167], v45 offset:38912
  s_waitcnt lgkmcnt(12)
  v_mfma_f32_16x16x32_bf16 v[16:19], a[120:123], a[48:51], v[16:19]
  ds_read_b64_tr_b16 a[152:153], v46 offset:32768
  s_lshr_b32 s93, s85, 6
  s_mul_i32 s93, s93, -15
  s_add_u32 s93, s93, s57
  buffer_load_dwordx4 a[96:99], v48, s[4:7], s93 offen sc1
  v_mfma_f32_16x16x32_bf16 v[16:19], a[136:139], a[56:59], v[16:19]
  ds_read_b64_tr_b16 a[154:155], v46 offset:34816
  v_mfma_f32_16x16x32_bf16 v[20:23], a[136:139], a[60:63], v[20:23]
  ds_read_b64_tr_b16 a[168:169], v46 offset:36864
  v_mfma_f32_16x16x32_bf16 v[20:23], a[120:123], a[52:55], v[20:23]
  ds_read_b64_tr_b16 a[170:171], v46 offset:38912
  buffer_load_dwordx4 a[100:103], v49, s[4:7], s93 offen sc1
  s_add_u32 s57, s57, 1024
  s_waitcnt lgkmcnt(12)
  v_mfma_f32_16x16x32_bf16 v[28:31], a[124:127], a[52:55], v[28:31]
  ds_read_b64_tr_b16 a[156:157], v47 offset:32768
  v_mfma_f32_16x16x32_bf16 v[28:31], a[140:143], a[60:63], v[28:31]
  ds_read_b64_tr_b16 a[158:159], v47 offset:34816
  v_mfma_f32_16x16x32_bf16 v[24:27], a[140:143], a[56:59], v[24:27]
  ds_read_b64_tr_b16 a[172:173], v47 offset:36864
  v_mfma_f32_16x16x32_bf16 v[24:27], a[124:127], a[48:51], v[24:27]
  ds_read_b64_tr_b16 a[174:175], v47 offset:38912
  s_waitcnt vmcnt(6) lgkmcnt(12)
  v_mfma_f32_16x16x32_bf16 v[0:3], a[144:147], a[64:67], v[0:3]
  ds_read_b64_tr_b16 a[112:113], v44 offset:40960
  v_mfma_f32_16x16x32_bf16 v[0:3], a[160:163], a[72:75], v[0:3]
  ds_read_b64_tr_b16 a[114:115], v44 offset:43008
  s_lshr_b32 s93, s86, 6
  s_mul_i32 s93, s93, -15
  s_add_u32 s93, s93, s57
  buffer_load_dwordx4 a[104:107], v48, s[4:7], s93 offen sc1
  v_mfma_f32_16x16x32_bf16 v[4:7], a[160:163], a[76:79], v[4:7]
  ds_read_b64_tr_b16 a[128:129], v44 offset:45056
  v_mfma_f32_16x16x32_bf16 v[4:7], a[144:147], a[68:71], v[4:7]
  ds_read_b64_tr_b16 a[130:131], v44 offset:47104
  s_waitcnt lgkmcnt(12)
  v_mfma_f32_16x16x32_bf16 v[12:15], a[148:151], a[68:71], v[12:15]
  ds_read_b64_tr_b16 a[116:117], v45 offset:40960
  v_mfma_f32_16x16x32_bf16 v[12:15], a[164:167], a[76:79], v[12:15]
  ds_read_b64_tr_b16 a[118:119], v45 offset:43008
  v_mfma_f32_16x16x32_bf16 v[8:11], a[164:167], a[72:75], v[8:11]
  ds_read_b64_tr_b16 a[132:133], v45 offset:45056
  v_mfma_f32_16x16x32_bf16 v[8:11], a[148:151], a[64:67], v[8:11]
  ds_read_b64_tr_b16 a[134:135], v45 offset:47104
  s_waitcnt lgkmcnt(12)
  v_mfma_f32_16x16x32_bf16 v[16:19], a[152:155], a[64:67], v[16:19]
  ds_read_b64_tr_b16 a[120:121], v46 offset:40960
  buffer_load_dwordx4 a[108:111], v49, s[4:7], s93 offen sc1
  s_add_u32 s57, s57, 1024
  v_mfma_f32_16x16x32_bf16 v[16:19], a[168:171], a[72:75], v[16:19]
  ds_read_b64_tr_b16 a[122:123], v46 offset:43008
  v_mfma_f32_16x16x32_bf16 v[20:23], a[168:171], a[76:79], v[20:23]
  ds_read_b64_tr_b16 a[136:137], v46 offset:45056
  v_mfma_f32_16x16x32_bf16 v[20:23], a[152:155], a[68:71], v[20:23]
  ds_read_b64_tr_b16 a[138:139], v46 offset:47104
  s_waitcnt lgkmcnt(12)
  v_mfma_f32_16x16x32_bf16 v[28:31], a[156:159], a[68:71], v[28:31]
  ds_read_b64_tr_b16 a[124:125], v47 offset:40960
  v_mfma_f32_16x16x32_bf16 v[28:31], a[172:175], a[76:79], v[28:31]
  ds_read_b64_tr_b16 a[126:127], v47 offset:43008
  v_mfma_f32_16x16x32_bf16 v[24:27], a[172:175], a[72:75], v[24:27]
  ds_read_b64_tr_b16 a[140:141], v47 offset:45056
  v_mfma_f32_16x16x32_bf16 v[24:27], a[156:159], a[64:67], v[24:27]
  ds_read_b64_tr_b16 a[142:143], v47 offset:47104
  s_waitcnt vmcnt(4) lgkmcnt(12)
  v_mfma_f32_16x16x32_bf16 v[0:3], a[112:115], a[80:83], v[0:3]
  s_barrier
  ds_read_b64_tr_b16 a[144:145], v44 offset:49152
  v_mfma_f32_16x16x32_bf16 v[0:3], a[128:131], a[88:91], v[0:3]
  ds_read_b64_tr_b16 a[146:147], v44 offset:51200
  v_mfma_f32_16x16x32_bf16 v[4:7], a[128:131], a[92:95], v[4:7]
  ds_read_b64_tr_b16 a[160:161], v44 offset:53248
  v_mfma_f32_16x16x32_bf16 v[4:7], a[112:115], a[84:87], v[4:7]
  ds_read_b64_tr_b16 a[162:163], v44 offset:55296
  s_waitcnt lgkmcnt(12)
  v_mfma_f32_16x16x32_bf16 v[12:15], a[116:119], a[84:87], v[12:15]
  ds_read_b64_tr_b16 a[148:149], v45 offset:49152
  v_mfma_f32_16x16x32_bf16 v[12:15], a[132:135], a[92:95], v[12:15]
  ds_read_b64_tr_b16 a[150:151], v45 offset:51200
  v_mfma_f32_16x16x32_bf16 v[8:11], a[132:135], a[88:91], v[8:11]
  ds_read_b64_tr_b16 a[164:165], v45 offset:53248
  v_mfma_f32_16x16x32_bf16 v[8:11], a[116:119], a[80:83], v[8:11]
  ds_read_b64_tr_b16 a[166:167], v45 offset:55296
  s_waitcnt lgkmcnt(12)
  v_mfma_f32_16x16x32_bf16 v[16:19], a[120:123], a[80:83], v[16:19]
  ds_read_b64_tr_b16 a[152:153], v46 offset:49152
  v_mfma_f32_16x16x32_bf16 v[16:19], a[136:139], a[88:91], v[16:19]
  ds_read_b64_tr_b16 a[154:155], v46 offset:51200
  v_mfma_f32_16x16x32_bf16 v[20:23], a[136:139], a[92:95], v[20:23]
  ds_read_b64_tr_b16 a[168:169], v46 offset:53248
  v_mfma_f32_16x16x32_bf16 v[20:23], a[120:123], a[84:87], v[20:23]
  ds_read_b64_tr_b16 a[170:171], v46 offset:55296
  s_waitcnt lgkmcnt(12)
  v_mfma_f32_16x16x32_bf16 v[28:31], a[124:127], a[84:87], v[28:31]
  ds_read_b64_tr_b16 a[156:157], v47 offset:49152
  v_mfma_f32_16x16x32_bf16 v[28:31], a[140:143], a[92:95], v[28:31]
  ds_read_b64_tr_b16 a[158:159], v47 offset:51200
  v_mfma_f32_16x16x32_bf16 v[24:27], a[140:143], a[88:91], v[24:27]
  ds_read_b64_tr_b16 a[172:173], v47 offset:53248
  v_mfma_f32_16x16x32_bf16 v[24:27], a[124:127], a[80:83], v[24:27]
  ds_read_b64_tr_b16 a[174:175], v47 offset:55296
  s_waitcnt vmcnt(0) lgkmcnt(12)
  v_mfma_f32_16x16x32_bf16 v[0:3], a[144:147], a[96:99], v[0:3]
  v_mfma_f32_16x16x32_bf16 v[0:3], a[160:163], a[104:107], v[0:3]
  v_mfma_f32_16x16x32_bf16 v[4:7], a[160:163], a[108:111], v[4:7]
  v_mfma_f32_16x16x32_bf16 v[4:7], a[144:147], a[100:103], v[4:7]
  s_waitcnt lgkmcnt(8)
  v_mfma_f32_16x16x32_bf16 v[12:15], a[148:151], a[100:103], v[12:15]
  v_mfma_f32_16x16x32_bf16 v[12:15], a[164:167], a[108:111], v[12:15]
  v_mfma_f32_16x16x32_bf16 v[8:11], a[164:167], a[104:107], v[8:11]
  v_mfma_f32_16x16x32_bf16 v[8:11], a[148:151], a[96:99], v[8:11]
  s_waitcnt lgkmcnt(4)
  v_mfma_f32_16x16x32_bf16 v[16:19], a[152:155], a[96:99], v[16:19]
  v_mfma_f32_16x16x32_bf16 v[16:19], a[168:171], a[104:107], v[16:19]
  v_mfma_f32_16x16x32_bf16 v[20:23], a[168:171], a[108:111], v[20:23]
  v_mfma_f32_16x16x32_bf16 v[20:23], a[152:155], a[100:103], v[20:23]
  s_waitcnt lgkmcnt(0)
  v_mfma_f32_16x16x32_bf16 v[28:31], a[156:159], a[100:103], v[28:31]
  v_mfma_f32_16x16x32_bf16 v[28:31], a[172:175], a[108:111], v[28:31]
  v_mfma_f32_16x16x32_bf16 v[24:27], a[172:175], a[104:107], v[24:27]
  v_mfma_f32_16x16x32_bf16 v[24:27], a[156:159], a[96:99], v[24:27]
  s_add_u32 s46, s59, 33554432
  s_add_u32 s47, s46, 32768
  s_lshl_b32 s48, s58, 11
  s_lshl_b32 s43, s53, 7
  s_add_u32 s48, s48, s43
  s_add_u32 s48, s48, s42
  s_add_u32 s48, s48, 60817408
  s_nop 0
  s_cmp_lg_u32 s41, 0
  s_cbranch_scc1 Lfinal
  v_cvt_pk_bf16_f32 v52, v0, v1
  v_cvt_pk_bf16_f32 v53, v2, v3
  v_cvt_pk_bf16_f32 v54, v8, v9
  v_cvt_pk_bf16_f32 v55, v10, v11
  buffer_store_dwordx4 v[52:55], v48, s[4:7], s46 offen offset:0 sc1
  v_cvt_pk_bf16_f32 v60, v4, v5
  v_cvt_pk_bf16_f32 v61, v6, v7
  v_cvt_pk_bf16_f32 v62, v12, v13
  v_cvt_pk_bf16_f32 v63, v14, v15
  buffer_store_dwordx4 v[60:63], v48, s[4:7], s47 offen offset:0 sc1
  v_cvt_pk_bf16_f32 v56, v16, v17
  v_cvt_pk_bf16_f32 v57, v18, v19
  v_cvt_pk_bf16_f32 v58, v24, v25
  v_cvt_pk_bf16_f32 v59, v26, v27
  buffer_store_dwordx4 v[56:59], v48, s[4:7], s46 offen offset:1024 sc1
  v_cvt_pk_bf16_f32 v64, v20, v21
  v_cvt_pk_bf16_f32 v65, v22, v23
  v_cvt_pk_bf16_f32 v66, v28, v29
  v_cvt_pk_bf16_f32 v67, v30, v31
  buffer_store_dwordx4 v[64:67], v48, s[4:7], s47 offen offset:1024 sc1
  v_mov_b32 v72, 0x3f803f80
  v_mov_b32 v73, 0x3f803f80
  v_mov_b32 v74, 0x3f803f80
  v_mov_b32 v75, 0x3f803f80
  v_and_b32 v92, 15, v253
  v_lshrrev_b32 v93, 4, v253
  v_mfma_f32_16x16x32_bf16 v[76:79], v[72:75], v[52:55], 0
  v_mfma_f32_16x16x32_bf16 v[80:83], v[52:55], v[52:55], 0
  v_mfma_f32_16x16x32_bf16 v[84:87], v[72:75], v[60:63], 0
  v_mfma_f32_16x16x32_bf16 v[88:91], v[60:63], v[60:63], 0
  v_mfma_f32_16x16x32_bf16 v[76:79], v[72:75], v[56:59], v[76:79]
  v_mfma_f32_16x16x32_bf16 v[80:83], v[56:59], v[56:59], v[80:83]
  v_mfma_f32_16x16x32_bf16 v[84:87], v[72:75], v[64:67], v[84:87]
  v_mfma_f32_16x16x32_bf16 v[88:91], v[64:67], v[64:67], v[88:91]
  v_lshrrev_b32 v72, 2, v92
  v_cmp_eq_u32 s[64:65], v72, v93
  v_and_b32 v72, 3, v92
  v_cmp_eq_u32 s[66:67], 1, v72
  v_cmp_eq_u32 s[68:69], 2, v72
  v_cmp_eq_u32 s[70:71], 3, v72
  v_lshlrev_b32 v92, 3, v92
  v_mov_b32 v93, 0x7ffffff0
  s_nop 0
  v_cndmask_b32 v92, v93, v92, s[64:65]
  v_cndmask_b32 v77, v80, v81, s[66:67]
  v_cndmask_b32 v77, v77, v82, s[68:69]
  v_cndmask_b32 v77, v77, v83, s[70:71]
  buffer_store_dwordx2 v[76:77], v92, s[4:7], s48 offen offset:0 sc1
  v_cndmask_b32 v85, v88, v89, s[66:67]
  v_cndmask_b32 v85, v85, v90, s[68:69]
  v_cndmask_b32 v85, v85, v91, s[70:71]
  buffer_store_dwordx2 v[84:85], v92, s[4:7], s48 offen offset:2048 sc1
  s_lshl_b32 s77, s52, 7
  s_add_u32 s77, s77, 27791360
  s_waitcnt vmcnt(0)
  s_barrier
  s_cmp_lg_u32 s40, 0
  s_cbranch_scc1 Lsig23
  v_mov_b32 v250, 1
  s_mov_b64 exec, 1
  buffer_atomic_add v250, v251, s[4:7], s77 offen sc1
  s_mov_b64 exec, -1
Lsig23:
  s_mov_b32 s41, 1
  s_mov_b32 s42, 0x2000000
  s_mov_b32 s28, s4
  s_mov_b32 s29, s5
  s_mov_b32 s30, 0x10000000
  s_lshr_b32 s57, s40, 1
  s_and_b32 s58, s40, 1
  s_lshl_b32 s71, s50, 3
  s_add_u32 s67, s50, s51
  s_and_b32 s67, s67, 3
  s_lshl_b32 s62, s40, 12
  s_mul_i32 s63, s40, 6144
  s_add_u32 s76, s63, 139264
  s_and_b32 s43, s50, 7
  s_cmp_lg_u32 s43, 0
  s_cselect_b32 s43, 1, 0
  s_sub_u32 s72, s71, s43
  v_lshrrev_b32 v2, 3, v253
  v_bfe_u32 v3, v253, 1, 2
  v_lshrrev_b32 v4, 4, v253
  v_xor_b32 v3, v3, v4
  v_and_b32 v5, 1, v253
  v_mov_b32 v6, v2
  s_lshl_b32 s43, s40, 4
  v_mul_u32_u24 v6, 6144, v6
  v_lshl_add_u32 v6, v3, 5, v6
  v_lshl_add_u32 v124, v5, 4, v6
  v_add_u32 v125, 48128, v124
  s_mul_i32 s43, s43, 6144
  s_lshl_b32 s60, s51, 7
  s_add_u32 s60, s60, s43
  v_and_b32 v3, 7, v253
  s_lshl_b32 s43, s40, 1
  s_add_u32 s43, s43, s71
  v_lshlrev_b32 v120, 4, v253
  v_mov_b32 v121, v120
  v_add_u32 v122, 30720, v120
  v_add_u32 v123, 30720, v120
  v_lshlrev_b32 v5, 8, v2
  v_lshl_add_u32 v5, v3, 4, v5
  v_add_u32 v126, 128, v5
  s_lshl_b32 s43, s43, 15
  s_add_u32 s44, s42, 0
  s_add_u32 s59, s43, s44
  s_lshl_b32 s43, s72, 15
  s_add_u32 s73, s43, s44
  s_movk_i32 s61, 2048
  s_cmp_eq_u32 s67, 0
  s_cselect_b32 s44, 4, 0
  s_mul_i32 s45, s44, 393216
  s_add_u32 s69, s45, s60
  s_add_u32 s70, s69, 4096
  s_add_u32 m0, s63, 0
  s_nop 0
  buffer_load_dwordx4 v124, s[8:11], s69 offen offset:0 lds
  buffer_load_dwordx4 v125, s[8:11], s69 offen offset:1024 lds
  buffer_load_dwordx4 v124, s[8:11], s69 offen offset:2048 lds
  buffer_load_dwordx4 v125, s[8:11], s69 offen offset:3072 lds
  s_add_u32 m0, s63, 4096
  s_nop 0
  buffer_load_dwordx4 v124, s[8:11], s70 offen offset:0 lds
  buffer_load_dwordx4 v125, s[8:11], s70 offen offset:1024 lds
  s_cmp_eq_u32 s67, 1
  s_cselect_b32 s44, 5, 1
  s_mul_i32 s45, s44, 393216
  s_add_u32 s69, s45, s60
  s_add_u32 s70, s69, 4096
  s_add_u32 m0, s63, 24576
  s_nop 0
  buffer_load_dwordx4 v124, s[8:11], s69 offen offset:0 lds
  buffer_load_dwordx4 v125, s[8:11], s69 offen offset:1024 lds
  buffer_load_dwordx4 v124, s[8:11], s69 offen offset:2048 lds
  buffer_load_dwordx4 v125, s[8:11], s69 offen offset:3072 lds
  s_add_u32 m0, s63, 28672
  s_nop 0
  buffer_load_dwordx4 v124, s[8:11], s70 offen offset:0 lds
  buffer_load_dwordx4 v125, s[8:11], s70 offen offset:1024 lds
  v_and_b32 v2, 15, v253
  v_lshrrev_b32 v3, 4, v253
  v_and_b32 v4, 7, v253
  v_lshlrev_b32 v6, 4, v253
  v_add_u32 v7, 1024, v6
  v_lshlrev_b32 v5, 7, v3
  v_lshl_add_u32 v8, v4, 4, v5
  v_add_u32 v9, 512, v8
  s_lshl_b32 s43, s57, 13
  s_add_u32 s43, s43, 73728
  v_add_u32 v112, s43, v6
  v_add_u32 v113, s43, v7
  s_cmp_eq_u32 s57, 0
  s_cselect_b64 vcc, 0, -1
  s_movk_i32 s43, 1024
  s_cselect_b32 s64, s43, 16384
  s_cselect_b32 s65, s43, -32768
  s_mov_b32 s43, 122880
  s_cselect_b32 s43, s43, 79872
  v_cndmask_b32 v8, v8, v6, vcc
  v_cndmask_b32 v9, v9, v7, vcc
  v_add_u32 v114, s43, v8
  v_add_u32 v115, s43, v9
  v_lshrrev_b32 v2, 2, v253
  v_bfe_u32 v3, v253, 3, 2
  v_and_b32 v4, 3, v253
  v_lshlrev_b32 v4, 3, v4
  v_lshl_add_u32 v4, v2, 7, v4
  s_lshl_b32 s43, s58, 1
  v_xor_b32 v5, s43, v3
  v_lshl_add_u32 v116, v5, 5, v4
  v_xor_b32 v5, 1, v5
  v_lshl_add_u32 v117, v5, 5, v4
  v_add_u32 v118, 49152, v116
  v_add_u32 v119, 49152, v117
  v_mov_b32 v0, 0
  v_mov_b32 v1, 0
  v_mov_b32 v2, 0
  v_mov_b32 v3, 0
  v_mov_b32 v4, 0
  v_mov_b32 v5, 0
  v_mov_b32 v6, 0
  v_mov_b32 v7, 0
  v_mov_b32 v8, 0
  v_mov_b32 v9, 0
  v_mov_b32 v10, 0
  v_mov_b32 v11, 0
  v_mov_b32 v12, 0
  v_mov_b32 v13, 0
  v_mov_b32 v14, 0
  v_mov_b32 v15, 0
  v_mov_b32 v16, 0
  v_mov_b32 v17, 0
  v_mov_b32 v18, 0
  v_mov_b32 v19, 0
  v_mov_b32 v20, 0
  v_mov_b32 v21, 0
  v_mov_b32 v22, 0
  v_mov_b32 v23, 0
  v_mov_b32 v24, 0
  v_mov_b32 v25, 0
  v_mov_b32 v26, 0
  v_mov_b32 v27, 0
  v_mov_b32 v28, 0
  v_mov_b32 v29, 0
  v_mov_b32 v30, 0
  v_mov_b32 v31, 0
  v_mov_b32 v32, 0
  v_mov_b32 v33, 0
  v_mov_b32 v34, 0
  v_mov_b32 v35, 0
  v_mov_b32 v36, 0
  v_mov_b32 v37, 0
  v_mov_b32 v38, 0
  v_mov_b32 v39, 0
  v_mov_b32 v40, 0
  v_mov_b32 v41, 0
  v_mov_b32 v42, 0
  v_mov_b32 v43, 0
  v_mov_b32 v44, 0
  v_mov_b32 v45, 0
  v_mov_b32 v46, 0
  v_mov_b32 v47, 0
  v_mov_b32 v48, 0
  v_mov_b32 v49, 0
  v_mov_b32 v50, 0
  v_mov_b32 v51, 0
  v_mov_b32 v52, 0
  v_mov_b32 v53, 0
  v_mov_b32 v54, 0
  v_mov_b32 v55, 0
  v_mov_b32 v56, 0
  v_mov_b32 v57, 0
  v_mov_b32 v58, 0
  v_mov_b32 v59, 0
  v_mov_b32 v60, 0
  v_mov_b32 v61, 0
  v_mov_b32 v62, 0
  v_mov_b32 v63, 0
  v_mov_b32 v64, 0
  v_mov_b32 v65, 0
  v_mov_b32 v66, 0
  v_mov_b32 v67, 0
  v_mov_b32 v68, 0
  v_mov_b32 v69, 0
  v_mov_b32 v70, 0
  v_mov_b32 v71, 0
  v_mov_b32 v72, 0
  v_mov_b32 v73, 0
  v_mov_b32 v74, 0
  v_mov_b32 v75, 0
  v_mov_b32 v76, 0
  v_mov_b32 v77, 0
  v_mov_b32 v78, 0
  v_mov_b32 v79, 0
  v_mov_b32 v80, 0
  v_mov_b32 v81, 0
  v_mov_b32 v82, 0
  v_mov_b32 v83, 0
  v_mov_b32 v84, 0
  v_mov_b32 v85, 0
  v_mov_b32 v86, 0
  v_mov_b32 v87, 0
  v_mov_b32 v88, 0
  v_mov_b32 v89, 0
  v_mov_b32 v90, 0
  v_mov_b32 v91, 0
  v_mov_b32 v92, 0
  v_mov_b32 v93, 0
  v_mov_b32 v94, 0
  v_mov_b32 v95, 0
  v_mov_b32 v96, 0
  v_mov_b32 v97, 0
  v_mov_b32 v98, 0
  v_mov_b32 v99, 0
  v_mov_b32 v100, 0
  v_mov_b32 v101, 0
  v_mov_b32 v102, 0
  v_mov_b32 v103, 0
  v_mov_b32 v104, 0
  v_mov_b32 v105, 0
  v_mov_b32 v106, 0
  v_mov_b32 v107, 0
  v_mov_b32 v108, 0
  v_mov_b32 v109, 0
  v_mov_b32 v110, 0
  v_mov_b32 v111, 0
  s_lshl_b32 s77, s50, 7
  s_add_u32 s77, s77, 27791232
  s_and_b32 s43, s50, 7
  s_cmp_eq_u32 s43, 0
  s_cselect_b32 s43, 0x80, 0
  v_lshlrev_b32 v249, 7, v253
  v_or_b32 v249, s43, v249
  s_branch Llayer
Lfinal:
  v_and_b32 v72, 15, v253
  v_lshlrev_b32 v72, 12, v72
  v_bfe_u32 v73, v253, 4, 1
  v_lshl_add_u32 v72, v73, 5, v72
  v_lshrrev_b32 v73, 5, v253
  v_lshl_add_u32 v72, v73, 4, v72
  s_and_b32 s43, s58, 63
  s_lshl_b32 s43, s43, 16
  s_lshr_b32 s46, s58, 6
  s_lshl_b32 s46, s46, 11
  s_add_u32 s46, s46, s43
  s_lshl_b32 s43, s53, 7
  s_add_u32 s46, s46, s43
  s_add_u32 s47, s46, 65536
  v_cvt_pk_bf16_f32 v52, v0, v1
  v_cvt_pk_bf16_f32 v53, v2, v3
  v_cvt_pk_bf16_f32 v54, v8, v9
  v_cvt_pk_bf16_f32 v55, v10, v11
  v_cvt_pk_bf16_f32 v60, v4, v5
  v_cvt_pk_bf16_f32 v61, v6, v7
  v_cvt_pk_bf16_f32 v62, v12, v13
  v_cvt_pk_bf16_f32 v63, v14, v15
  v_permlane16_swap_b32 v52, v54
  v_permlane16_swap_b32 v53, v55
  buffer_store_dwordx4 v[52:55], v72, s[32:35], s46 offen offset:0
  s_nop 0
  v_permlane16_swap_b32 v60, v62
  v_permlane16_swap_b32 v61, v63
  buffer_store_dwordx4 v[60:63], v72, s[32:35], s47 offen offset:0
  v_cvt_pk_bf16_f32 v56, v16, v17
  v_cvt_pk_bf16_f32 v57, v18, v19
  v_cvt_pk_bf16_f32 v58, v24, v25
  v_cvt_pk_bf16_f32 v59, v26, v27
  v_cvt_pk_bf16_f32 v64, v20, v21
  v_cvt_pk_bf16_f32 v65, v22, v23
  v_cvt_pk_bf16_f32 v66, v28, v29
  v_cvt_pk_bf16_f32 v67, v30, v31
  v_permlane16_swap_b32 v56, v58
  v_permlane16_swap_b32 v57, v59
  buffer_store_dwordx4 v[56:59], v72, s[32:35], s46 offen offset:64
  s_nop 0
  v_permlane16_swap_b32 v64, v66
  v_permlane16_swap_b32 v65, v67
  buffer_store_dwordx4 v[64:67], v72, s[32:35], s47 offen offset:64
Lend:
  s_endpgm
.section .rodata,"a"
.p2align 6
.amdhsa_kernel interleave_layers__sliding_local_dilated__swiglu_ffn__prompt_kernel
  .amdhsa_next_free_vgpr 512
  .amdhsa_next_free_sgpr 102
  .amdhsa_accum_offset 256
  .amdhsa_group_segment_fixed_size 0
  .amdhsa_kernarg_size 80
  .amdhsa_user_sgpr_count 2
  .amdhsa_user_sgpr_kernarg_segment_ptr 1
  .amdhsa_system_sgpr_workgroup_id_x 1
  .amdhsa_float_denorm_mode_32 3
.end_amdhsa_kernel
```

```asm
; @launch grid=(256,1,1) block=(256,1,1) lds=163840
.amdgcn_target "amdgcn-amd-amdhsa--gfx950"
.text
.globl interleave_layers__sliding_local_dilated__swiglu_ffn__prompt_kernel
.p2align 8
.type interleave_layers__sliding_local_dilated__swiglu_ffn__prompt_kernel,@function
interleave_layers__sliding_local_dilated__swiglu_ffn__prompt_kernel:
  s_cmp_lt_u32 s2, 256
  s_cbranch_scc1 Lgo
  s_endpgm
Lgo:
  s_load_dwordx16 s[60:75], s[0:1], 0
  s_load_dwordx4 s[76:79], s[0:1], 64
  v_lshrrev_b32 v1, 6, v0
  v_and_b32 v253, 63, v0
  v_readfirstlane_b32 s40, v1
  v_mov_b32 v251, 0
  s_mov_b32 s41, 0
  s_mov_b32 s42, 0
  s_and_b32 s44, s2, 1
  s_bfe_u32 s45, s2, 0x20001
  s_lshr_b32 s46, s2, 3
  s_lshl_b32 s47, s44, 3
  s_and_b32 s43, s46, 7
  s_add_u32 s50, s47, s43
  s_lshl_b32 s43, s45, 2
  s_lshr_b32 s51, s46, 3
  s_add_u32 s51, s51, s43
  s_and_b32 s43, s45, 1
  s_lshl_b32 s43, s43, 2
  s_add_u32 s52, s47, s43
  s_and_b32 s48, s46, 3
  s_add_u32 s52, s52, s48
  s_lshr_b32 s43, s45, 1
  s_lshl_b32 s43, s43, 3
  s_lshr_b32 s49, s46, 2
  s_add_u32 s53, s43, s49
  s_lshl_b32 s43, s44, 2
  s_add_u32 s54, s43, s48
  s_lshl_b32 s43, s45, 3
  s_add_u32 s55, s43, s49
  v_lshrrev_b32 v2, 3, v253
  v_bfe_u32 v3, v253, 1, 2
  v_lshrrev_b32 v4, 4, v253
  v_xor_b32 v3, v3, v4
  v_and_b32 v4, 1, v253
  v_lshlrev_b32 v2, 11, v2
  v_lshl_add_u32 v2, v3, 5, v2
  v_lshl_add_u32 v252, v4, 4, v2
  s_waitcnt lgkmcnt(0)
  s_mov_b32 s28, s60
  s_mov_b32 s29, s61
  s_mov_b32 s30, 0x400000
  s_mov_b32 s31, 0x20000
  s_mov_b32 s8, s62
  s_mov_b32 s9, s63
  s_mov_b32 s10, 0x600000
  s_mov_b32 s11, 0x20000
  s_mov_b32 s4, s78
  s_mov_b32 s5, s79
  s_mov_b32 s6, 0x10000000
  s_mov_b32 s7, 0x20000
  s_mov_b32 s12, s64
  s_mov_b32 s13, s65
  s_mov_b32 s14, 0x200000
  s_mov_b32 s15, 0x20000
  s_mov_b32 s16, s68
  s_mov_b32 s17, s69
  s_mov_b32 s18, 0x700000
  s_mov_b32 s19, 0x20000
  s_mov_b32 s20, s70
  s_mov_b32 s21, s71
  s_mov_b32 s22, 0x700000
  s_mov_b32 s23, 0x20000
  s_mov_b32 s24, s72
  s_mov_b32 s25, s73
  s_mov_b32 s26, 0x700000
  s_mov_b32 s27, 0x20000
  s_mov_b32 s32, s74
  s_mov_b32 s33, s75
  s_mov_b32 s34, 0x400000
  s_mov_b32 s35, 0x20000
  s_mov_b32 s36, s76
  s_mov_b32 s37, s77
  s_mov_b32 s38, 0x100
  s_mov_b32 s39, 0x20000
  s_getpc_b64 s[0:1]
Lpc0:
  s_lshr_b32 s43, s2, 3
  s_lshl_b32 s43, s43, 2
  s_add_u32 s43, s43, s40
  s_and_b32 s43, s43, 63
  s_lshl_b32 s43, s43, 10
  s_add_u32 s0, s0, s43
  s_addc_u32 s1, s1, 0
  s_and_b32 s0, s0, 0xffffff80
  v_lshlrev_b32 v2, 4, v253
  global_load_dwordx4 a[240:243], v2, s[0:1]
  s_mul_i32 s76, s40, 6144
  s_add_u32 s76, s76, 139264
  s_mov_b32 m0, s76
  s_lshr_b32 s80, s2, 2
  s_bfe_u32 s81, s2, 0x10001
  s_lshl_b32 s81, s81, 2
  s_add_u32 s81, s81, s40
  s_and_b32 s82, s2, 1
  s_lshl_b32 s43, s80, 16
  s_lshl_b32 s44, s82, 11
  s_add_u32 s43, s43, s44
  s_lshl_b32 s44, s81, 8
  s_add_u32 s43, s43, s44
  v_lshrrev_b32 v2, 4, v253
  v_and_b32 v3, 15, v253
  v_add_u32 v4, 0, v2
  v_xor_b32 v5, v4, v3
  v_lshlrev_b32 v5, 4, v5
  v_lshl_add_u32 v5, v2, 12, v5
  v_add_u32 v5, 0, v5
  buffer_load_dwordx4 v5, s[28:31], s43 offen offset:0 lds
  v_add_u32 v4, 4, v2
  v_xor_b32 v5, v4, v3
  v_lshlrev_b32 v5, 4, v5
  v_lshl_add_u32 v5, v2, 12, v5
  v_add_u32 v5, 15360, v5
  buffer_load_dwordx4 v5, s[28:31], s43 offen offset:1024 lds
  v_add_u32 v4, 8, v2
  v_xor_b32 v5, v4, v3
  v_lshlrev_b32 v5, 4, v5
  v_lshl_add_u32 v5, v2, 12, v5
  v_add_u32 v5, 30720, v5
  buffer_load_dwordx4 v5, s[28:31], s43 offen offset:2048 lds
  v_add_u32 v4, 12, v2
  v_xor_b32 v5, v4, v3
  v_lshlrev_b32 v5, 4, v5
  v_lshl_add_u32 v5, v2, 12, v5
  v_add_u32 v5, 46080, v5
  buffer_load_dwordx4 v5, s[28:31], s43 offen offset:3072 lds
  s_lshr_b32 s46, s2, 3
  s_cmp_ge_u32 s46, 12
  s_cselect_b32 s44, 12, 0
  s_cselect_b32 s45, 2, 0
  s_sub_u32 s44, s46, s44
  s_add_u32 s45, s45, s82
  s_lshr_b32 s47, s44, 2
  s_lshl_b32 s47, s47, 4
  s_and_b32 s44, s44, 3
  s_add_u32 s44, s44, s47
  s_bfe_u32 s47, s2, 0x20001
  s_lshl_b32 s47, s47, 2
  s_add_u32 s44, s44, s47
  s_mul_i32 s83, s45, 12288
  s_lshl_b32 s47, s44, 8
  s_add_u32 s83, s83, s47
  s_add_u32 s83, s83, 27852800
  s_lshl_b32 s45, s45, 2
  s_add_u32 s45, s45, s40
  s_mul_i32 s45, s45, 393216
  s_lshl_b32 s44, s44, 7
  s_add_u32 s45, s45, s44
  s_cmp_ge_u32 s46, 24
  s_cselect_b32 s92, 0x40000000, 0
  s_cselect_b32 s45, 0, s45
  v_lshrrev_b32 v4, 3, v253
  v_mul_u32_u24 v4, 6144, v4
  v_and_b32 v5, 7, v253
  v_lshl_add_u32 v4, v5, 4, v4
  v_or_b32 v4, s92, v4
  buffer_load_dwordx4 v[160:163], v4, s[8:11], s45 offen
  s_add_u32 s45, s45, 49152
  buffer_load_dwordx4 v[164:167], v4, s[8:11], s45 offen
  s_add_u32 s45, s45, 49152
  buffer_load_dwordx4 v[168:171], v4, s[8:11], s45 offen
  s_add_u32 s45, s45, 49152
  buffer_load_dwordx4 v[172:175], v4, s[8:11], s45 offen
  s_add_u32 s45, s45, 49152
  buffer_load_dwordx4 v[176:179], v4, s[8:11], s45 offen
  s_add_u32 s45, s45, 49152
  buffer_load_dwordx4 v[180:183], v4, s[8:11], s45 offen
  s_add_u32 s45, s45, 49152
  buffer_load_dwordx4 v[184:187], v4, s[8:11], s45 offen
  s_add_u32 s45, s45, 49152
  buffer_load_dwordx4 v[188:191], v4, s[8:11], s45 offen
  s_add_u32 s45, s45, 49152
  s_lshr_b32 s43, s2, 7
  s_mul_i32 s43, s43, 33554432
  s_and_b32 s44, s2, 127
  s_lshl_b32 s44, s44, 7
  s_add_u32 s43, s43, s44
  s_add_u32 s43, s43, 27787264
  buffer_store_dword v251, v251, s[4:7], s43 offen sc1
  s_lshr_b32 s57, s40, 1
  s_and_b32 s58, s40, 1
  s_lshl_b32 s71, s50, 3
  s_add_u32 s67, s50, s51
  s_and_b32 s67, s67, 3
  s_lshl_b32 s62, s40, 12
  s_mul_i32 s63, s40, 6144
  s_add_u32 s76, s63, 139264
  s_and_b32 s43, s50, 7
  s_cmp_lg_u32 s43, 0
  s_cselect_b32 s43, 1, 0
  s_sub_u32 s72, s71, s43
  v_lshrrev_b32 v2, 3, v253
  v_bfe_u32 v3, v253, 1, 2
  v_lshrrev_b32 v4, 4, v253
  v_xor_b32 v3, v3, v4
  v_and_b32 v5, 1, v253
  v_lshrrev_b32 v6, 5, v253
  v_lshl_add_u32 v6, v6, 2, v2
  s_lshl_b32 s43, s57, 5
  s_lshl_b32 s44, s58, 2
  s_add_u32 s43, s43, s44
  v_mul_u32_u24 v6, 6144, v6
  v_lshl_add_u32 v6, v3, 5, v6
  v_lshl_add_u32 v124, v5, 4, v6
  v_add_u32 v125, 97280, v124
  s_mul_i32 s43, s43, 6144
  s_lshl_b32 s60, s51, 7
  s_add_u32 s60, s60, s43
  v_and_b32 v3, 7, v253
  s_lshl_b32 s43, s40, 1
  s_add_u32 s43, s43, s71
  v_add_u32 v5, 0, v4
  v_xor_b32 v5, v5, v3
  v_lshlrev_b32 v5, 4, v5
  v_lshl_add_u32 v5, v2, 12, v5
  v_add_u32 v120, 0, v5
  v_add_u32 v5, 4, v4
  v_xor_b32 v5, v5, v3
  v_lshlrev_b32 v5, 4, v5
  v_lshl_add_u32 v5, v2, 12, v5
  v_add_u32 v121, 31744, v5
  v_add_u32 v5, 0, v4
  v_xor_b32 v5, v5, v3
  v_lshlrev_b32 v5, 4, v5
  v_lshl_add_u32 v5, v2, 12, v5
  v_add_u32 v122, 63488, v5
  v_add_u32 v5, 4, v4
  v_xor_b32 v5, v5, v3
  v_lshlrev_b32 v5, 4, v5
  v_lshl_add_u32 v5, v2, 12, v5
  v_add_u32 v123, 95232, v5
  v_and_b32 v5, 6, v2
  v_xor_b32 v5, v5, v3
  v_lshlrev_b32 v5, 4, v5
  v_lshl_add_u32 v5, v2, 12, v5
  v_add_u32 v126, 32768, v5
  s_lshr_b32 s44, s50, 3
  s_lshl_b32 s44, s44, 11
  s_and_b32 s43, s43, 63
  s_lshl_b32 s43, s43, 16
  s_add_u32 s59, s43, s44
  s_and_b32 s43, s72, 63
  s_lshl_b32 s43, s43, 16
  s_add_u32 s73, s43, s44
  s_movk_i32 s61, 128
  v_and_b32 v2, 15, v253
  v_lshrrev_b32 v3, 4, v253
  v_and_b32 v4, 7, v253
  v_lshrrev_b32 v5, 1, v2
  v_xor_b32 v5, v5, v3
  v_lshlrev_b32 v5, 4, v5
  v_lshl_add_u32 v6, v2, 7, v5
  v_xor_b32 v7, 64, v6
  v_and_b32 v5, 6, v4
  v_xor_b32 v5, v5, v3
  v_lshlrev_b32 v5, 4, v5
  v_lshl_add_u32 v8, v4, 7, v5
  v_xor_b32 v9, 64, v8
  s_lshl_b32 s43, s57, 13
  s_add_u32 s43, s43, 73728
  v_add_u32 v112, s43, v6
  v_add_u32 v113, s43, v7
  s_cmp_eq_u32 s57, 0
  s_cselect_b64 vcc, 0, -1
  s_movk_i32 s43, 1024
  s_cselect_b32 s64, s43, 16384
  s_cselect_b32 s65, s43, -32768
  s_mov_b32 s43, 122880
  s_cselect_b32 s43, s43, 79872
  v_cndmask_b32 v8, v8, v6, vcc
  v_cndmask_b32 v9, v9, v7, vcc
  v_add_u32 v114, s43, v8
  v_add_u32 v115, s43, v9
  v_lshrrev_b32 v2, 2, v253
  v_bfe_u32 v3, v253, 3, 2
  v_and_b32 v4, 3, v253
  v_lshlrev_b32 v4, 3, v4
  v_lshl_add_u32 v4, v2, 7, v4
  s_lshl_b32 s43, s58, 1
  v_xor_b32 v5, s43, v3
  v_lshl_add_u32 v116, v5, 5, v4
  v_xor_b32 v5, 1, v5
  v_lshl_add_u32 v117, v5, 5, v4
  v_add_u32 v118, 49152, v116
  v_add_u32 v119, 49152, v117
  v_mov_b32 v0, 0
  v_mov_b32 v1, 0
  v_mov_b32 v2, 0
  v_mov_b32 v3, 0
  v_mov_b32 v4, 0
  v_mov_b32 v5, 0
  v_mov_b32 v6, 0
  v_mov_b32 v7, 0
  v_mov_b32 v8, 0
  v_mov_b32 v9, 0
  v_mov_b32 v10, 0
  v_mov_b32 v11, 0
  v_mov_b32 v12, 0
  v_mov_b32 v13, 0
  v_mov_b32 v14, 0
  v_mov_b32 v15, 0
  v_mov_b32 v16, 0
  v_mov_b32 v17, 0
  v_mov_b32 v18, 0
  v_mov_b32 v19, 0
  v_mov_b32 v20, 0
  v_mov_b32 v21, 0
  v_mov_b32 v22, 0
  v_mov_b32 v23, 0
  v_mov_b32 v24, 0
  v_mov_b32 v25, 0
  v_mov_b32 v26, 0
  v_mov_b32 v27, 0
  v_mov_b32 v28, 0
  v_mov_b32 v29, 0
  v_mov_b32 v30, 0
  v_mov_b32 v31, 0
  v_mov_b32 v32, 0
  v_mov_b32 v33, 0
  v_mov_b32 v34, 0
  v_mov_b32 v35, 0
  v_mov_b32 v36, 0
  v_mov_b32 v37, 0
  v_mov_b32 v38, 0
  v_mov_b32 v39, 0
  v_mov_b32 v40, 0
  v_mov_b32 v41, 0
  v_mov_b32 v42, 0
  v_mov_b32 v43, 0
  v_mov_b32 v44, 0
  v_mov_b32 v45, 0
  v_mov_b32 v46, 0
  v_mov_b32 v47, 0
  v_mov_b32 v48, 0
  v_mov_b32 v49, 0
  v_mov_b32 v50, 0
  v_mov_b32 v51, 0
  v_mov_b32 v52, 0
  v_mov_b32 v53, 0
  v_mov_b32 v54, 0
  v_mov_b32 v55, 0
  v_mov_b32 v56, 0
  v_mov_b32 v57, 0
  v_mov_b32 v58, 0
  v_mov_b32 v59, 0
  v_mov_b32 v60, 0
  v_mov_b32 v61, 0
  v_mov_b32 v62, 0
  v_mov_b32 v63, 0
  v_mov_b32 v64, 0
  v_mov_b32 v65, 0
  v_mov_b32 v66, 0
  v_mov_b32 v67, 0
  v_mov_b32 v68, 0
  v_mov_b32 v69, 0
  v_mov_b32 v70, 0
  v_mov_b32 v71, 0
  v_mov_b32 v72, 0
  v_mov_b32 v73, 0
  v_mov_b32 v74, 0
  v_mov_b32 v75, 0
  v_mov_b32 v76, 0
  v_mov_b32 v77, 0
  v_mov_b32 v78, 0
  v_mov_b32 v79, 0
  v_mov_b32 v80, 0
  v_mov_b32 v81, 0
  v_mov_b32 v82, 0
  v_mov_b32 v83, 0
  v_mov_b32 v84, 0
  v_mov_b32 v85, 0
  v_mov_b32 v86, 0
  v_mov_b32 v87, 0
  v_mov_b32 v88, 0
  v_mov_b32 v89, 0
  v_mov_b32 v90, 0
  v_mov_b32 v91, 0
  v_mov_b32 v92, 0
  v_mov_b32 v93, 0
  v_mov_b32 v94, 0
  v_mov_b32 v95, 0
  v_mov_b32 v96, 0
  v_mov_b32 v97, 0
  v_mov_b32 v98, 0
  v_mov_b32 v99, 0
  v_mov_b32 v100, 0
  v_mov_b32 v101, 0
  v_mov_b32 v102, 0
  v_mov_b32 v103, 0
  v_mov_b32 v104, 0
  v_mov_b32 v105, 0
  v_mov_b32 v106, 0
  v_mov_b32 v107, 0
  v_mov_b32 v108, 0
  v_mov_b32 v109, 0
  v_mov_b32 v110, 0
  v_mov_b32 v111, 0
  v_and_b32 v235, 15, v253
  v_lshrrev_b32 v236, 4, v253
  v_lshlrev_b32 v236, 2, v236
  v_sub_u32 v235, v235, v236
  v_mov_b32 v237, 0xf149f2ca
  v_subrev_u32 v238, 0, v235
  v_cmp_gt_u32 vcc, 8, v238
  v_add_u32 v238, 16, v238
  v_cmp_gt_u32 s[78:79], 8, v238
  v_cndmask_b32 v132, v237, 0, vcc
  s_nop 0
  v_cndmask_b32 v136, v237, 0, s[78:79]
  v_subrev_u32 v238, 1, v235
  v_cmp_gt_u32 vcc, 8, v238
  v_add_u32 v238, 16, v238
  v_cmp_gt_u32 s[78:79], 8, v238
  v_cndmask_b32 v133, v237, 0, vcc
  s_nop 0
  v_cndmask_b32 v137, v237, 0, s[78:79]
  v_subrev_u32 v238, 2, v235
  v_cmp_gt_u32 vcc, 8, v238
  v_add_u32 v238, 16, v238
  v_cmp_gt_u32 s[78:79], 8, v238
  v_cndmask_b32 v134, v237, 0, vcc
  s_nop 0
  v_cndmask_b32 v138, v237, 0, s[78:79]
  v_subrev_u32 v238, 3, v235
  v_cmp_gt_u32 vcc, 8, v238
  v_add_u32 v238, 16, v238
  v_cmp_gt_u32 s[78:79], 8, v238
  v_cndmask_b32 v135, v237, 0, vcc
  s_nop 0
  v_cndmask_b32 v139, v237, 0, s[78:79]
  v_lshlrev_b32 v232, 4, v253
  v_add_u32 v232, 149504, v232
  ds_write_b128 v232, v[132:135]
  ds_write_b128 v232, v[136:139] offset:1024
  v_and_b32 v128, 15, v253
  v_lshrrev_b32 v129, 5, v253
  v_bfe_u32 v130, v253, 4, 1
  v_lshlrev_b32 v130, 3, v130
  v_lshl_add_u32 v130, v128, 8, v130
  v_add_u32 v130, s76, v130
  s_waitcnt vmcnt(9)
  v_add_u32 v131, 0, v129
  v_xor_b32 v131, v131, v128
  v_lshl_add_u32 v131, v131, 4, v130
  ds_read_b64 v[140:141], v131
  v_add_u32 v131, 2, v129
  v_xor_b32 v131, v131, v128
  v_lshl_add_u32 v131, v131, 4, v130
  ds_read_b64 v[142:143], v131
  v_add_u32 v131, 4, v129
  v_xor_b32 v131, v131, v128
  v_lshl_add_u32 v131, v131, 4, v130
  ds_read_b64 v[144:145], v131
  v_add_u32 v131, 6, v129
  v_xor_b32 v131, v131, v128
  v_lshl_add_u32 v131, v131, 4, v130
  ds_read_b64 v[146:147], v131
  v_add_u32 v131, 8, v129
  v_xor_b32 v131, v131, v128
  v_lshl_add_u32 v131, v131, 4, v130
  ds_read_b64 v[148:149], v131
  v_add_u32 v131, 10, v129
  v_xor_b32 v131, v131, v128
  v_lshl_add_u32 v131, v131, 4, v130
  ds_read_b64 v[150:151], v131
  v_add_u32 v131, 12, v129
  v_xor_b32 v131, v131, v128
  v_lshl_add_u32 v131, v131, 4, v130
  ds_read_b64 v[152:153], v131
  v_add_u32 v131, 14, v129
  v_xor_b32 v131, v131, v128
  v_lshl_add_u32 v131, v131, 4, v130
  ds_read_b64 v[154:155], v131
  s_lshl_b32 s43, s82, 6
  s_add_u32 s80, s80, s43
  s_lshl_b32 s43, s80, 15
  s_lshl_b32 s44, s81, 12
  s_add_u32 s43, s43, s44
  s_add_u32 s46, s43, 0
  s_lshl_b32 s43, s80, 11
  s_lshl_b32 s44, s81, 8
  s_add_u32 s43, s43, s44
  s_add_u32 s47, s43, 27262976
  v_lshlrev_b32 v128, 4, v253
  s_waitcnt lgkmcnt(0)
  buffer_store_dwordx4 v[140:143], v128, s[4:7], s46 offen offset:0 sc1
  buffer_store_dwordx4 v[144:147], v128, s[4:7], s46 offen offset:1024 sc1
  buffer_store_dwordx4 v[148:151], v128, s[4:7], s46 offen offset:2048 sc1
  buffer_store_dwordx4 v[152:155], v128, s[4:7], s46 offen offset:3072 sc1
  v_mov_b32 v192, 0x3f803f80
  v_mov_b32 v193, 0x3f803f80
  v_mov_b32 v194, 0x3f803f80
  v_mov_b32 v195, 0x3f803f80
  v_and_b32 v212, 15, v253
  v_lshrrev_b32 v213, 4, v253
  v_mfma_f32_16x16x32_bf16 v[196:199], v[192:195], v[140:143], 0
  v_mfma_f32_16x16x32_bf16 v[200:203], v[140:143], v[140:143], 0
  v_mfma_f32_16x16x32_bf16 v[204:207], v[192:195], v[148:151], 0
  v_mfma_f32_16x16x32_bf16 v[208:211], v[148:151], v[148:151], 0
  v_mfma_f32_16x16x32_bf16 v[196:199], v[192:195], v[144:147], v[196:199]
  v_mfma_f32_16x16x32_bf16 v[200:203], v[144:147], v[144:147], v[200:203]
  v_mfma_f32_16x16x32_bf16 v[204:207], v[192:195], v[152:155], v[204:207]
  v_mfma_f32_16x16x32_bf16 v[208:211], v[152:155], v[152:155], v[208:211]
  v_lshrrev_b32 v192, 2, v212
  v_cmp_eq_u32 s[84:85], v192, v213
  v_and_b32 v192, 3, v212
  v_cmp_eq_u32 s[86:87], 1, v192
  v_cmp_eq_u32 s[88:89], 2, v192
  v_cmp_eq_u32 s[90:91], 3, v192
  v_lshlrev_b32 v212, 3, v212
  v_mov_b32 v213, 0x7ffffff0
  s_nop 0
  v_cndmask_b32 v212, v213, v212, s[84:85]
  v_cndmask_b32 v197, v200, v201, s[86:87]
  v_cndmask_b32 v197, v197, v202, s[88:89]
  v_cndmask_b32 v197, v197, v203, s[90:91]
  buffer_store_dwordx2 v[196:197], v212, s[4:7], s47 offen offset:0 sc1
  v_cndmask_b32 v205, v208, v209, s[86:87]
  v_cndmask_b32 v205, v205, v210, s[88:89]
  v_cndmask_b32 v205, v205, v211, s[90:91]
  buffer_store_dwordx2 v[204:205], v212, s[4:7], s47 offen offset:128 sc1
  s_lshr_b32 s46, s2, 3
  s_cmp_ge_u32 s46, 14
  s_cselect_b32 s44, 14, 0
  s_cselect_b32 s45, 1, 0
  s_cselect_b32 s84, s20, s16
  s_cselect_b32 s85, s21, s17
  s_mov_b32 s86, 7340032
  s_mov_b32 s87, 0x20000
  s_sub_u32 s44, s46, s44
  s_bfe_u32 s47, s2, 0x20001
  s_mul_i32 s47, s47, 14
  s_add_u32 s44, s44, s47
  s_and_b32 s47, s2, 1
  s_lshl_b32 s48, s47, 1
  s_add_u32 s48, s48, s45
  s_mul_i32 s48, s48, 14336
  s_lshl_b32 s49, s44, 8
  s_add_u32 s48, s48, s49
  s_add_u32 s101, s48, 27918336
  s_lshl_b32 s47, s47, 2
  s_add_u32 s47, s47, s40
  s_mul_i32 s47, s47, 458752
  s_lshl_b32 s44, s44, 7
  s_add_u32 s100, s47, s44
  s_cmp_lt_u32 s46, 28
  s_cselect_b32 s3, 1, 0
  s_cmp_eq_u32 s41, 0
  s_cselect_b32 s3, s3, 0
  v_lshrrev_b32 v238, 3, v253
  v_mul_u32_u24 v238, 7168, v238
  v_and_b32 v239, 7, v253
  v_lshl_add_u32 v238, v239, 4, v238
  s_cmp_eq_u32 s3, 0
  s_cselect_b32 s43, 0x40000000, 0
  v_or_b32 v238, s43, v238
  v_lshlrev_b32 v239, 4, v253
  s_lshl_b32 s43, s2, 2
  s_add_u32 s43, s43, s40
  s_lshl_b32 s89, s43, 11
  s_mul_i32 s43, s46, 43
  s_lshr_b32 s43, s43, 8
  s_mul_i32 s43, s43, 6
  s_sub_u32 s43, s46, s43
  s_add_u32 s43, s43, 4
  s_cmp_eq_u32 s41, 0
  s_cselect_b32 s88, s43, 63
  s_cmp_eq_u32 s67, 0
  s_cselect_b32 s44, 4, 0
  s_mul_i32 s45, s44, 393216
  s_add_u32 s69, s45, s60
  s_add_u32 s70, s69, 4096
  s_add_u32 m0, s63, 0
  s_nop 0
  buffer_load_dwordx4 v124, s[8:11], s69 offen offset:0 lds
  buffer_load_dwordx4 v125, s[8:11], s69 offen offset:1024 lds
  buffer_load_dwordx4 v124, s[8:11], s69 offen offset:2048 lds
  buffer_load_dwordx4 v125, s[8:11], s69 offen offset:3072 lds
  s_add_u32 m0, s63, 4096
  s_nop 0
  buffer_load_dwordx4 v124, s[8:11], s70 offen offset:0 lds
  buffer_load_dwordx4 v125, s[8:11], s70 offen offset:1024 lds
  s_cmp_eq_u32 s67, s40
  s_cselect_b32 s44, 4, 0
  s_add_u32 s44, s44, s40
  s_mul_i32 s44, s44, s61
  s_lshl_b32 s45, s40, 10
  s_add_u32 m0, s45, 122880
  s_add_u32 s44, s44, s73
  buffer_load_dwordx4 v126, s[28:31], s44 offen sc1 lds
  s_cmp_eq_u32 s67, 0
  s_cselect_b32 s44, 4, 0
  s_mul_i32 s45, s44, s61
  s_add_u32 s68, s45, s59
  s_add_u32 m0, s62, 73728
  s_nop 0
  buffer_load_dwordx4 v120, s[28:31], s68 offen offset:0 sc1 lds
  buffer_load_dwordx4 v121, s[28:31], s68 offen offset:1024 sc1 lds
  buffer_load_dwordx4 v122, s[28:31], s68 offen offset:2048 sc1 lds
  buffer_load_dwordx4 v123, s[28:31], s68 offen offset:3072 sc1 lds
  s_waitcnt vmcnt(18)
  v_lshlrev_b32 v216, 16, v160
  v_and_b32 v217, 0xffff0000, v160
  v_lshlrev_b32 v218, 16, v161
  v_and_b32 v219, 0xffff0000, v161
  v_lshlrev_b32 v220, 16, v162
  v_and_b32 v221, 0xffff0000, v162
  v_lshlrev_b32 v222, 16, v163
  v_and_b32 v223, 0xffff0000, v163
  v_lshlrev_b32 v224, 16, v164
  v_and_b32 v225, 0xffff0000, v164
  v_pk_add_f32 v[216:217], v[216:217], v[224:225]
  v_lshlrev_b32 v224, 16, v165
  v_and_b32 v225, 0xffff0000, v165
  v_pk_add_f32 v[218:219], v[218:219], v[224:225]
  v_lshlrev_b32 v224, 16, v166
  v_and_b32 v225, 0xffff0000, v166
  v_pk_add_f32 v[220:221], v[220:221], v[224:225]
  v_lshlrev_b32 v224, 16, v167
  v_and_b32 v225, 0xffff0000, v167
  v_pk_add_f32 v[222:223], v[222:223], v[224:225]
  v_lshlrev_b32 v224, 16, v168
  v_and_b32 v225, 0xffff0000, v168
  v_pk_add_f32 v[216:217], v[216:217], v[224:225]
  v_lshlrev_b32 v224, 16, v169
  v_and_b32 v225, 0xffff0000, v169
  v_pk_add_f32 v[218:219], v[218:219], v[224:225]
  v_lshlrev_b32 v224, 16, v170
  v_and_b32 v225, 0xffff0000, v170
  v_pk_add_f32 v[220:221], v[220:221], v[224:225]
  v_lshlrev_b32 v224, 16, v171
  v_and_b32 v225, 0xffff0000, v171
  v_pk_add_f32 v[222:223], v[222:223], v[224:225]
  v_lshlrev_b32 v224, 16, v172
  v_and_b32 v225, 0xffff0000, v172
  v_pk_add_f32 v[216:217], v[216:217], v[224:225]
  v_lshlrev_b32 v224, 16, v173
  v_and_b32 v225, 0xffff0000, v173
  v_pk_add_f32 v[218:219], v[218:219], v[224:225]
  v_lshlrev_b32 v224, 16, v174
  v_and_b32 v225, 0xffff0000, v174
  v_pk_add_f32 v[220:221], v[220:221], v[224:225]
  v_lshlrev_b32 v224, 16, v175
  v_and_b32 v225, 0xffff0000, v175
  v_pk_add_f32 v[222:223], v[222:223], v[224:225]
  v_lshlrev_b32 v224, 16, v176
  v_and_b32 v225, 0xffff0000, v176
  v_pk_add_f32 v[216:217], v[216:217], v[224:225]
  v_lshlrev_b32 v224, 16, v177
  v_and_b32 v225, 0xffff0000, v177
  v_pk_add_f32 v[218:219], v[218:219], v[224:225]
  v_lshlrev_b32 v224, 16, v178
  v_and_b32 v225, 0xffff0000, v178
  v_pk_add_f32 v[220:221], v[220:221], v[224:225]
  v_lshlrev_b32 v224, 16, v179
  v_and_b32 v225, 0xffff0000, v179
  v_pk_add_f32 v[222:223], v[222:223], v[224:225]
  v_lshlrev_b32 v224, 16, v180
  v_and_b32 v225, 0xffff0000, v180
  v_pk_add_f32 v[216:217], v[216:217], v[224:225]
  v_lshlrev_b32 v224, 16, v181
  v_and_b32 v225, 0xffff0000, v181
  v_pk_add_f32 v[218:219], v[218:219], v[224:225]
  v_lshlrev_b32 v224, 16, v182
  v_and_b32 v225, 0xffff0000, v182
  v_pk_add_f32 v[220:221], v[220:221], v[224:225]
  v_lshlrev_b32 v224, 16, v183
  v_and_b32 v225, 0xffff0000, v183
  v_pk_add_f32 v[222:223], v[222:223], v[224:225]
  v_lshlrev_b32 v224, 16, v184
  v_and_b32 v225, 0xffff0000, v184
  v_pk_add_f32 v[216:217], v[216:217], v[224:225]
  v_lshlrev_b32 v224, 16, v185
  v_and_b32 v225, 0xffff0000, v185
  v_pk_add_f32 v[218:219], v[218:219], v[224:225]
  v_lshlrev_b32 v224, 16, v186
  v_and_b32 v225, 0xffff0000, v186
  v_pk_add_f32 v[220:221], v[220:221], v[224:225]
  v_lshlrev_b32 v224, 16, v187
  v_and_b32 v225, 0xffff0000, v187
  v_pk_add_f32 v[222:223], v[222:223], v[224:225]
  v_lshlrev_b32 v224, 16, v188
  v_and_b32 v225, 0xffff0000, v188
  v_pk_add_f32 v[216:217], v[216:217], v[224:225]
  v_lshlrev_b32 v224, 16, v189
  v_and_b32 v225, 0xffff0000, v189
  v_pk_add_f32 v[218:219], v[218:219], v[224:225]
  v_lshlrev_b32 v224, 16, v190
  v_and_b32 v225, 0xffff0000, v190
  v_pk_add_f32 v[220:221], v[220:221], v[224:225]
  v_lshlrev_b32 v224, 16, v191
  v_and_b32 v225, 0xffff0000, v191
  v_pk_add_f32 v[222:223], v[222:223], v[224:225]
  v_mov_b32 v224, v216
  v_mov_b32 v225, v217
  v_mov_b32 v226, v218
  v_mov_b32 v227, v219
  v_mov_b32 v228, v220
  v_mov_b32 v229, v221
  v_mov_b32 v230, v222
  v_mov_b32 v231, v223
  v_permlane32_swap_b32 v216, v224
  v_permlane32_swap_b32 v217, v225
  v_permlane32_swap_b32 v218, v226
  v_permlane32_swap_b32 v219, v227
  v_permlane32_swap_b32 v220, v228
  v_permlane32_swap_b32 v221, v229
  v_permlane32_swap_b32 v222, v230
  v_permlane32_swap_b32 v223, v231
  v_add_f32 v216, v216, v224
  v_add_f32 v217, v217, v225
  v_add_f32 v218, v218, v226
  v_add_f32 v219, v219, v227
  v_add_f32 v220, v220, v228
  v_add_f32 v221, v221, v229
  v_add_f32 v222, v222, v230
  v_add_f32 v223, v223, v231
  v_mov_b32 v224, v216
  v_mov_b32 v225, v217
  v_mov_b32 v226, v218
  v_mov_b32 v227, v219
  v_mov_b32 v228, v220
  v_mov_b32 v229, v221
  v_mov_b32 v230, v222
  v_mov_b32 v231, v223
  v_permlane16_swap_b32 v216, v224
  v_permlane16_swap_b32 v217, v225
  v_permlane16_swap_b32 v218, v226
  v_permlane16_swap_b32 v219, v227
  v_permlane16_swap_b32 v220, v228
  v_permlane16_swap_b32 v221, v229
  v_permlane16_swap_b32 v222, v230
  v_permlane16_swap_b32 v223, v231
  v_add_f32 v216, v216, v224
  v_add_f32 v217, v217, v225
  v_add_f32 v218, v218, v226
  v_add_f32 v219, v219, v227
  v_add_f32 v220, v220, v228
  v_add_f32 v221, v221, v229
  v_add_f32 v222, v222, v230
  v_add_f32 v223, v223, v231
  v_and_b32 v224, 7, v253
  s_lshl_b32 s43, s40, 8
  s_add_u32 s43, s43, 143360
  v_add_f32_dpp v216, v216, v216 row_ror:8 row_mask:0xf bank_mask:0xf
  v_add_f32_dpp v217, v217, v217 row_ror:8 row_mask:0xf bank_mask:0xf
  v_add_f32_dpp v218, v218, v218 row_ror:8 row_mask:0xf bank_mask:0xf
  v_add_f32_dpp v219, v219, v219 row_ror:8 row_mask:0xf bank_mask:0xf
  v_add_f32_dpp v220, v220, v220 row_ror:8 row_mask:0xf bank_mask:0xf
  v_add_f32_dpp v221, v221, v221 row_ror:8 row_mask:0xf bank_mask:0xf
  v_add_f32_dpp v222, v222, v222 row_ror:8 row_mask:0xf bank_mask:0xf
  v_add_f32_dpp v223, v223, v223 row_ror:8 row_mask:0xf bank_mask:0xf
  v_lshl_add_u32 v224, v224, 5, s43
  ds_write_b128 v224, v[216:219]
  ds_write_b128 v224, v[220:223] offset:16
  s_waitcnt lgkmcnt(0)
  s_barrier
  s_or_b32 s43, s40, s92
  s_cbranch_scc1 Lpf1
  v_lshlrev_b32 v224, 2, v253
  v_add_u32 v225, 143360, v224
  ds_read_b32 v226, v225 offset:0
  ds_read_b32 v227, v225 offset:256
  ds_read_b32 v228, v225 offset:512
  ds_read_b32 v229, v225 offset:768
  s_waitcnt lgkmcnt(0)
  v_add_f32 v226, v226, v227
  v_add_f32 v228, v228, v229
  v_add_f32 v226, v226, v228
  buffer_store_dword v226, v224, s[4:7], s83 offen sc1
Lpf1:
  s_cmp_eq_u32 s67, 1
  s_cselect_b32 s44, 5, 1
  s_mul_i32 s45, s44, 393216
  s_add_u32 s69, s45, s60
  s_add_u32 s70, s69, 4096
  s_add_u32 m0, s63, 24576
  s_nop 0
  buffer_load_dwordx4 v124, s[8:11], s69 offen offset:0 lds
  buffer_load_dwordx4 v125, s[8:11], s69 offen offset:1024 lds
  buffer_load_dwordx4 v124, s[8:11], s69 offen offset:2048 lds
  buffer_load_dwordx4 v125, s[8:11], s69 offen offset:3072 lds
  s_add_u32 m0, s63, 28672
  s_nop 0
  buffer_load_dwordx4 v124, s[8:11], s70 offen offset:0 lds
  buffer_load_dwordx4 v125, s[8:11], s70 offen offset:1024 lds
  s_cmp_eq_u32 s67, 1
  s_cselect_b32 s44, 5, 1
  s_mul_i32 s45, s44, s61
  s_add_u32 s68, s45, s59
  s_add_u32 m0, s62, 90112
  s_nop 0
  buffer_load_dwordx4 v120, s[28:31], s68 offen offset:0 sc1 lds
  buffer_load_dwordx4 v121, s[28:31], s68 offen offset:1024 sc1 lds
  buffer_load_dwordx4 v122, s[28:31], s68 offen offset:2048 sc1 lds
  buffer_load_dwordx4 v123, s[28:31], s68 offen offset:3072 sc1 lds
  s_waitcnt vmcnt(10)
  s_barrier
  ds_read_b64_tr_b16 a[40:41], v116 offset:0
  ds_read_b64_tr_b16 a[42:43], v116 offset:6144
  ds_read_b64_tr_b16 a[64:65], v116 offset:12288
  ds_read_b64_tr_b16 a[66:67], v116 offset:18432
  ds_read_b128 a[4:7], v112 offset:0
  ds_read_b128 a[24:27], v113 offset:0
  ds_read_b128 a[8:11], v112 offset:2048
  ds_read_b128 a[28:31], v113 offset:2048
  ds_read_b128 a[12:15], v112 offset:4096
  ds_read_b128 a[32:35], v113 offset:4096
  ds_read_b128 a[16:19], v112 offset:6144
  ds_read_b128 a[36:39], v113 offset:6144
  ds_read_b64_tr_b16 a[44:45], v117 offset:0
  ds_read_b64_tr_b16 a[46:47], v117 offset:6144
  ds_read_b64_tr_b16 a[68:69], v117 offset:12288
  ds_read_b64_tr_b16 a[70:71], v117 offset:18432
  ds_read_b128 a[0:3], v114
  v_add_u32 v114, s64, v114
  ds_read_b128 a[20:23], v115
  v_add_u32 v115, s64, v115
  ds_read_b64_tr_b16 a[48:49], v116 offset:2048
  ds_read_b64_tr_b16 a[50:51], v116 offset:8192
  ds_read_b64_tr_b16 a[72:73], v116 offset:14336
  ds_read_b64_tr_b16 a[74:75], v116 offset:20480
  ds_read_b64_tr_b16 a[52:53], v117 offset:2048
  ds_read_b64_tr_b16 a[54:55], v117 offset:8192
  ds_read_b64_tr_b16 a[76:77], v117 offset:14336
  ds_read_b64_tr_b16 a[78:79], v117 offset:20480
  ds_read_b64_tr_b16 a[56:57], v116 offset:4096
  ds_read_b64_tr_b16 a[58:59], v116 offset:10240
  ds_read_b64_tr_b16 a[80:81], v116 offset:16384
  ds_read_b64_tr_b16 a[82:83], v116 offset:22528
  ds_read_b64_tr_b16 a[60:61], v117 offset:4096
  ds_read_b64_tr_b16 a[62:63], v117 offset:10240
  ds_read_b64_tr_b16 a[84:85], v117 offset:16384
  ds_read_b64_tr_b16 a[86:87], v117 offset:22528
  s_cmp_eq_u32 s67, s40
  s_cselect_b32 s44, 8, 4
  s_add_u32 s44, s44, s40
  s_mul_i32 s44, s44, s61
  s_lshl_b32 s45, s40, 10
  s_add_u32 m0, s45, 126976
  s_add_u32 s44, s44, s73
  buffer_load_dwordx4 v126, s[28:31], s44 offen sc1 lds
  s_cmp_eq_u32 s67, s40
  s_cselect_b32 s44, 12, 8
  s_add_u32 s44, s44, s40
  s_mul_i32 s44, s44, s61
  s_lshl_b32 s45, s40, 10
  s_add_u32 m0, s45, 131072
  s_add_u32 s44, s44, s73
  buffer_load_dwordx4 v126, s[28:31], s44 offen sc1 lds
  s_cmp_eq_u32 s67, s40
  s_cselect_b32 s44, 0, 12
  s_add_u32 s44, s44, s40
  s_mul_i32 s44, s44, s61
  s_lshl_b32 s45, s40, 10
  s_add_u32 m0, s45, 135168
  s_add_u32 s44, s44, s73
  buffer_load_dwordx4 v126, s[28:31], s44 offen sc1 lds
  s_cmp_eq_u32 s67, 2
  s_cselect_b32 s44, 6, 2
  s_mul_i32 s45, s44, 393216
  s_add_u32 s69, s45, s60
  s_add_u32 s70, s69, 4096
  s_add_u32 m0, s63, 49152
  s_nop 0
  buffer_load_dwordx4 v124, s[8:11], s69 offen offset:0 lds
  buffer_load_dwordx4 v125, s[8:11], s69 offen offset:1024 lds
  buffer_load_dwordx4 v124, s[8:11], s69 offen offset:2048 lds
  buffer_load_dwordx4 v125, s[8:11], s69 offen offset:3072 lds
  s_add_u32 m0, s63, 53248
  s_nop 0
  buffer_load_dwordx4 v124, s[8:11], s70 offen offset:0 lds
  buffer_load_dwordx4 v125, s[8:11], s70 offen offset:1024 lds
  s_cmp_eq_u32 s67, 2
  s_cselect_b32 s44, 6, 2
  s_mul_i32 s45, s44, s61
  s_add_u32 s68, s45, s59
  s_add_u32 m0, s62, 106496
  s_nop 0
  buffer_load_dwordx4 v120, s[28:31], s68 offen offset:0 sc1 lds
  buffer_load_dwordx4 v121, s[28:31], s68 offen offset:1024 sc1 lds
  buffer_load_dwordx4 v122, s[28:31], s68 offen offset:2048 sc1 lds
  buffer_load_dwordx4 v123, s[28:31], s68 offen offset:3072 sc1 lds
  s_branch Lp1_common
Llayer:
  s_cmp_lg_u32 s40, 0
  s_cbranch_scc1 Lpdn3
  s_mov_b32 s43, 0x40000
  s_mov_b64 exec, 3
Lpol2:
  buffer_load_dword v250, v249, s[4:7], s77 offen sc1
  s_waitcnt vmcnt(0)
  v_cmp_gt_u32 vcc, 16, v250
  s_cbranch_vccz Lpdn3
  s_sub_u32 s43, s43, 1
  s_cmp_lg_u32 s43, 0
  s_cbranch_scc1 Lpol2
Lpdn3:
  s_mov_b64 exec, -1
  s_waitcnt vmcnt(0) lgkmcnt(0)
  s_barrier
  s_cmp_eq_u32 s67, s40
  s_cselect_b32 s44, 4, 0
  s_add_u32 s44, s44, s40
  s_mul_i32 s44, s44, s61
  s_lshl_b32 s45, s40, 10
  s_add_u32 m0, s45, 122880
  s_add_u32 s44, s44, s73
  buffer_load_dwordx4 v126, s[28:31], s44 offen sc1 lds
  s_cmp_eq_u32 s67, 0
  s_cselect_b32 s44, 4, 0
  s_mul_i32 s45, s44, s61
  s_add_u32 s68, s45, s59
  s_add_u32 m0, s62, 73728
  s_nop 0
  buffer_load_dwordx4 v120, s[28:31], s68 offen offset:0 sc1 lds
  buffer_load_dwordx4 v121, s[28:31], s68 offen offset:1024 sc1 lds
  buffer_load_dwordx4 v122, s[28:31], s68 offen offset:2048 sc1 lds
  buffer_load_dwordx4 v123, s[28:31], s68 offen offset:3072 sc1 lds
  s_cmp_eq_u32 s67, 1
  s_cselect_b32 s44, 5, 1
  s_mul_i32 s45, s44, s61
  s_add_u32 s68, s45, s59
  s_add_u32 m0, s62, 90112
  s_nop 0
  buffer_load_dwordx4 v120, s[28:31], s68 offen offset:0 sc1 lds
  buffer_load_dwordx4 v121, s[28:31], s68 offen offset:1024 sc1 lds
  buffer_load_dwordx4 v122, s[28:31], s68 offen offset:2048 sc1 lds
  buffer_load_dwordx4 v123, s[28:31], s68 offen offset:3072 sc1 lds
  s_waitcnt vmcnt(4)
  s_barrier
  ds_read_b64_tr_b16 a[40:41], v116 offset:0
  ds_read_b64_tr_b16 a[42:43], v116 offset:6144
  ds_read_b64_tr_b16 a[64:65], v116 offset:12288
  ds_read_b64_tr_b16 a[66:67], v116 offset:18432
  ds_read_b128 a[4:7], v112 offset:0
  ds_read_b128 a[24:27], v113 offset:0
  ds_read_b128 a[8:11], v112 offset:2048
  ds_read_b128 a[28:31], v113 offset:2048
  ds_read_b128 a[12:15], v112 offset:4096
  ds_read_b128 a[32:35], v113 offset:4096
  ds_read_b128 a[16:19], v112 offset:6144
  ds_read_b128 a[36:39], v113 offset:6144
  ds_read_b64_tr_b16 a[44:45], v117 offset:0
  ds_read_b64_tr_b16 a[46:47], v117 offset:6144
  ds_read_b64_tr_b16 a[68:69], v117 offset:12288
  ds_read_b64_tr_b16 a[70:71], v117 offset:18432
  ds_read_b128 a[0:3], v114
  v_add_u32 v114, s64, v114
  ds_read_b128 a[20:23], v115
  v_add_u32 v115, s64, v115
  ds_read_b64_tr_b16 a[48:49], v116 offset:2048
  ds_read_b64_tr_b16 a[50:51], v116 offset:8192
  ds_read_b64_tr_b16 a[72:73], v116 offset:14336
  ds_read_b64_tr_b16 a[74:75], v116 offset:20480
  ds_read_b64_tr_b16 a[52:53], v117 offset:2048
  ds_read_b64_tr_b16 a[54:55], v117 offset:8192
  ds_read_b64_tr_b16 a[76:77], v117 offset:14336
  ds_read_b64_tr_b16 a[78:79], v117 offset:20480
  ds_read_b64_tr_b16 a[56:57], v116 offset:4096
  ds_read_b64_tr_b16 a[58:59], v116 offset:10240
  ds_read_b64_tr_b16 a[80:81], v116 offset:16384
  ds_read_b64_tr_b16 a[82:83], v116 offset:22528
  ds_read_b64_tr_b16 a[60:61], v117 offset:4096
  ds_read_b64_tr_b16 a[62:63], v117 offset:10240
  ds_read_b64_tr_b16 a[84:85], v117 offset:16384
  ds_read_b64_tr_b16 a[86:87], v117 offset:22528
  s_cmp_eq_u32 s67, s40
  s_cselect_b32 s44, 8, 4
  s_add_u32 s44, s44, s40
  s_mul_i32 s44, s44, s61
  s_lshl_b32 s45, s40, 10
  s_add_u32 m0, s45, 126976
  s_add_u32 s44, s44, s73
  buffer_load_dwordx4 v126, s[28:31], s44 offen sc1 lds
  s_cmp_eq_u32 s67, s40
  s_cselect_b32 s44, 12, 8
  s_add_u32 s44, s44, s40
  s_mul_i32 s44, s44, s61
  s_lshl_b32 s45, s40, 10
  s_add_u32 m0, s45, 131072
  s_add_u32 s44, s44, s73
  buffer_load_dwordx4 v126, s[28:31], s44 offen sc1 lds
  s_cmp_eq_u32 s67, s40
  s_cselect_b32 s44, 0, 12
  s_add_u32 s44, s44, s40
  s_mul_i32 s44, s44, s61
  s_lshl_b32 s45, s40, 10
  s_add_u32 m0, s45, 135168
  s_add_u32 s44, s44, s73
  buffer_load_dwordx4 v126, s[28:31], s44 offen sc1 lds
  s_cmp_eq_u32 s67, 2
  s_cselect_b32 s44, 6, 2
  s_mul_i32 s45, s44, s61
  s_add_u32 s68, s45, s59
  s_add_u32 m0, s62, 106496
  s_nop 0
  buffer_load_dwordx4 v120, s[28:31], s68 offen offset:0 sc1 lds
  buffer_load_dwordx4 v121, s[28:31], s68 offen offset:1024 sc1 lds
  buffer_load_dwordx4 v122, s[28:31], s68 offen offset:2048 sc1 lds
  buffer_load_dwordx4 v123, s[28:31], s68 offen offset:3072 sc1 lds
Lp1_common:
  s_mov_b32 s66, 3
  s_mov_b32 s56, 2
.p2align 3
Lp1_loop:
  s_waitcnt lgkmcnt(15)
  v_mfma_f32_16x16x32_bf16 v[0:3], a[40:43], a[4:7], v[0:3]
  s_and_b32 s44, s66, 3
  v_mfma_f32_16x16x32_bf16 v[0:3], a[64:67], a[24:27], v[0:3]
  s_cmp_eq_u32 s44, s67
  s_cselect_b32 s44, 4, 0
  v_mfma_f32_16x16x32_bf16 v[4:7], a[64:67], a[28:31], v[4:7]
  s_add_u32 s44, s44, s66
  v_mfma_f32_16x16x32_bf16 v[4:7], a[40:43], a[8:11], v[4:7]
  s_and_b32 s44, s44, 15
  v_mfma_f32_16x16x32_bf16 v[8:11], a[40:43], a[12:15], v[8:11]
  s_add_u32 s66, s66, 1
  v_mfma_f32_16x16x32_bf16 v[8:11], a[64:67], a[32:35], v[8:11]
  s_mul_i32 s45, s44, s61
  v_mfma_f32_16x16x32_bf16 v[12:15], a[64:67], a[36:39], v[12:15]
  s_add_u32 s68, s45, s59
  v_mfma_f32_16x16x32_bf16 v[12:15], a[40:43], a[16:19], v[12:15]
  s_mul_i32 s45, s44, 393216
  v_mfma_f32_16x16x32_bf16 v[28:31], a[44:47], a[16:19], v[28:31]
  s_add_u32 s69, s45, s60
  v_mfma_f32_16x16x32_bf16 v[28:31], a[68:71], a[36:39], v[28:31]
  s_add_u32 s70, s69, 4096
  v_mfma_f32_16x16x32_bf16 v[24:27], a[68:71], a[32:35], v[24:27]
  v_mfma_f32_16x16x32_bf16 v[24:27], a[44:47], a[12:15], v[24:27]
  v_mfma_f32_16x16x32_bf16 v[20:23], a[44:47], a[8:11], v[20:23]
  s_waitcnt vmcnt(7) lgkmcnt(0)
  s_barrier
  ds_read_b64_tr_b16 a[128:129], v116 offset:24576
  v_mfma_f32_16x16x32_bf16 v[20:23], a[68:71], a[28:31], v[20:23]
  ds_read_b64_tr_b16 a[130:131], v116 offset:30720
  s_add_u32 m0, s62, 73728
  v_mfma_f32_16x16x32_bf16 v[16:19], a[68:71], a[24:27], v[16:19]
  ds_read_b64_tr_b16 a[152:153], v116 offset:36864
  buffer_load_dwordx4 v120, s[28:31], s68 offen offset:0 sc1 lds
  v_mfma_f32_16x16x32_bf16 v[16:19], a[44:47], a[4:7], v[16:19]
  ds_read_b64_tr_b16 a[154:155], v116 offset:43008
  v_mfma_f32_16x16x32_bf16 v[32:35], a[48:51], a[0:3], v[32:35]
  ds_read_b128 a[92:95], v112 offset:16384
  v_mfma_f32_16x16x32_bf16 v[32:35], a[72:75], a[20:23], v[32:35]
  ds_read_b128 a[112:115], v113 offset:16384
  v_mfma_f32_16x16x32_bf16 v[36:39], a[72:75], a[24:27], v[36:39]
  ds_read_b128 a[96:99], v112 offset:18432
  buffer_load_dwordx4 v121, s[28:31], s68 offen offset:1024 sc1 lds
  v_mfma_f32_16x16x32_bf16 v[36:39], a[48:51], a[4:7], v[36:39]
  ds_read_b128 a[116:119], v113 offset:18432
  v_mfma_f32_16x16x32_bf16 v[40:43], a[48:51], a[8:11], v[40:43]
  ds_read_b128 a[100:103], v112 offset:20480
  v_mfma_f32_16x16x32_bf16 v[40:43], a[72:75], a[28:31], v[40:43]
  ds_read_b128 a[120:123], v113 offset:20480
  v_mfma_f32_16x16x32_bf16 v[44:47], a[72:75], a[32:35], v[44:47]
  ds_read_b128 a[104:107], v112 offset:22528
  buffer_load_dwordx4 v122, s[28:31], s68 offen offset:2048 sc1 lds
  v_mfma_f32_16x16x32_bf16 v[44:47], a[48:51], a[12:15], v[44:47]
  ds_read_b128 a[124:127], v113 offset:22528
  v_mfma_f32_16x16x32_bf16 v[48:51], a[48:51], a[16:19], v[48:51]
  ds_read_b64_tr_b16 a[132:133], v117 offset:24576
  v_mfma_f32_16x16x32_bf16 v[48:51], a[72:75], a[36:39], v[48:51]
  ds_read_b64_tr_b16 a[134:135], v117 offset:30720
  v_mfma_f32_16x16x32_bf16 v[68:71], a[76:79], a[36:39], v[68:71]
  ds_read_b64_tr_b16 a[156:157], v117 offset:36864
  buffer_load_dwordx4 v123, s[28:31], s68 offen offset:3072 sc1 lds
  v_mfma_f32_16x16x32_bf16 v[68:71], a[52:55], a[16:19], v[68:71]
  ds_read_b64_tr_b16 a[158:159], v117 offset:43008
  v_mfma_f32_16x16x32_bf16 v[64:67], a[52:55], a[12:15], v[64:67]
  ds_read_b128 a[88:91], v114
  v_add_u32 v114, s64, v114
  v_mfma_f32_16x16x32_bf16 v[64:67], a[76:79], a[32:35], v[64:67]
  ds_read_b128 a[108:111], v115
  v_add_u32 v115, s64, v115
  s_add_u32 m0, s63, 0
  v_mfma_f32_16x16x32_bf16 v[60:63], a[76:79], a[28:31], v[60:63]
  ds_read_b64_tr_b16 a[136:137], v116 offset:26624
  buffer_load_dwordx4 v124, s[8:11], s69 offen offset:0 lds
  v_mfma_f32_16x16x32_bf16 v[60:63], a[52:55], a[8:11], v[60:63]
  ds_read_b64_tr_b16 a[138:139], v116 offset:32768
  v_mfma_f32_16x16x32_bf16 v[56:59], a[52:55], a[4:7], v[56:59]
  ds_read_b64_tr_b16 a[160:161], v116 offset:38912
  v_mfma_f32_16x16x32_bf16 v[56:59], a[76:79], a[24:27], v[56:59]
  ds_read_b64_tr_b16 a[162:163], v116 offset:45056
  v_mfma_f32_16x16x32_bf16 v[52:55], a[76:79], a[20:23], v[52:55]
  ds_read_b64_tr_b16 a[140:141], v117 offset:26624
  buffer_load_dwordx4 v125, s[8:11], s69 offen offset:1024 lds
  v_mfma_f32_16x16x32_bf16 v[52:55], a[52:55], a[0:3], v[52:55]
  ds_read_b64_tr_b16 a[142:143], v117 offset:32768
  v_mfma_f32_16x16x32_bf16 v[72:75], a[0:3], a[56:59], v[72:75]
  ds_read_b64_tr_b16 a[164:165], v117 offset:38912
  v_mfma_f32_16x16x32_bf16 v[72:75], a[20:23], a[80:83], v[72:75]
  ds_read_b64_tr_b16 a[166:167], v117 offset:45056
  v_mfma_f32_16x16x32_bf16 v[76:79], a[24:27], a[80:83], v[76:79]
  ds_read_b64_tr_b16 a[144:145], v116 offset:28672
  buffer_load_dwordx4 v124, s[8:11], s69 offen offset:2048 lds
  v_mfma_f32_16x16x32_bf16 v[76:79], a[4:7], a[56:59], v[76:79]
  ds_read_b64_tr_b16 a[146:147], v116 offset:34816
  v_mfma_f32_16x16x32_bf16 v[80:83], a[8:11], a[56:59], v[80:83]
  ds_read_b64_tr_b16 a[168:169], v116 offset:40960
  v_mfma_f32_16x16x32_bf16 v[80:83], a[28:31], a[80:83], v[80:83]
  ds_read_b64_tr_b16 a[170:171], v116 offset:47104
  v_mfma_f32_16x16x32_bf16 v[84:87], a[32:35], a[80:83], v[84:87]
  ds_read_b64_tr_b16 a[148:149], v117 offset:28672
  buffer_load_dwordx4 v125, s[8:11], s69 offen offset:3072 lds
  v_mfma_f32_16x16x32_bf16 v[84:87], a[12:15], a[56:59], v[84:87]
  ds_read_b64_tr_b16 a[150:151], v117 offset:34816
  v_mfma_f32_16x16x32_bf16 v[88:91], a[16:19], a[56:59], v[88:91]
  ds_read_b64_tr_b16 a[172:173], v117 offset:40960
  v_mfma_f32_16x16x32_bf16 v[88:91], a[36:39], a[80:83], v[88:91]
  ds_read_b64_tr_b16 a[174:175], v117 offset:47104
  s_add_u32 m0, s63, 4096
  v_mfma_f32_16x16x32_bf16 v[108:111], a[36:39], a[84:87], v[108:111]
  buffer_load_dwordx4 v124, s[8:11], s70 offen offset:0 lds
  v_mfma_f32_16x16x32_bf16 v[108:111], a[16:19], a[60:63], v[108:111]
  v_mfma_f32_16x16x32_bf16 v[104:107], a[12:15], a[60:63], v[104:107]
  v_mfma_f32_16x16x32_bf16 v[104:107], a[32:35], a[84:87], v[104:107]
  v_mfma_f32_16x16x32_bf16 v[100:103], a[28:31], a[84:87], v[100:103]
  buffer_load_dwordx4 v125, s[8:11], s70 offen offset:1024 lds
  v_mfma_f32_16x16x32_bf16 v[100:103], a[8:11], a[60:63], v[100:103]
  v_mfma_f32_16x16x32_bf16 v[96:99], a[4:7], a[60:63], v[96:99]
  v_mfma_f32_16x16x32_bf16 v[96:99], a[24:27], a[84:87], v[96:99]
  v_mfma_f32_16x16x32_bf16 v[92:95], a[20:23], a[84:87], v[92:95]
  v_mfma_f32_16x16x32_bf16 v[92:95], a[0:3], a[60:63], v[92:95]
  s_cmp_eq_u32 s66, s88
  s_cbranch_scc0 Lside_skip0
  s_call_b64 s[78:79], Lside_sub
Lside_skip0:
  s_waitcnt lgkmcnt(15)
  v_mfma_f32_16x16x32_bf16 v[0:3], a[128:131], a[92:95], v[0:3]
  s_and_b32 s44, s66, 3
  v_mfma_f32_16x16x32_bf16 v[0:3], a[152:155], a[112:115], v[0:3]
  s_cmp_eq_u32 s44, s67
  s_cselect_b32 s44, 4, 0
  v_mfma_f32_16x16x32_bf16 v[4:7], a[152:155], a[116:119], v[4:7]
  s_add_u32 s44, s44, s66
  v_mfma_f32_16x16x32_bf16 v[4:7], a[128:131], a[96:99], v[4:7]
  s_and_b32 s44, s44, 15
  v_mfma_f32_16x16x32_bf16 v[8:11], a[128:131], a[100:103], v[8:11]
  s_add_u32 s66, s66, 1
  v_mfma_f32_16x16x32_bf16 v[8:11], a[152:155], a[120:123], v[8:11]
  s_mul_i32 s45, s44, s61
  v_mfma_f32_16x16x32_bf16 v[12:15], a[152:155], a[124:127], v[12:15]
  s_add_u32 s68, s45, s59
  v_mfma_f32_16x16x32_bf16 v[12:15], a[128:131], a[104:107], v[12:15]
  s_mul_i32 s45, s44, 393216
  v_mfma_f32_16x16x32_bf16 v[28:31], a[132:135], a[104:107], v[28:31]
  s_add_u32 s69, s45, s60
  v_mfma_f32_16x16x32_bf16 v[28:31], a[156:159], a[124:127], v[28:31]
  s_add_u32 s70, s69, 4096
  v_mfma_f32_16x16x32_bf16 v[24:27], a[156:159], a[120:123], v[24:27]
  v_mfma_f32_16x16x32_bf16 v[24:27], a[132:135], a[100:103], v[24:27]
  v_mfma_f32_16x16x32_bf16 v[20:23], a[132:135], a[96:99], v[20:23]
  s_waitcnt vmcnt(10) lgkmcnt(0)
  s_barrier
  ds_read_b64_tr_b16 a[40:41], v118 offset:0
  v_mfma_f32_16x16x32_bf16 v[20:23], a[156:159], a[116:119], v[20:23]
  ds_read_b64_tr_b16 a[42:43], v118 offset:6144
  s_add_u32 m0, s62, 90112
  v_mfma_f32_16x16x32_bf16 v[16:19], a[156:159], a[112:115], v[16:19]
  ds_read_b64_tr_b16 a[64:65], v118 offset:12288
  buffer_load_dwordx4 v120, s[28:31], s68 offen offset:0 sc1 lds
  v_mfma_f32_16x16x32_bf16 v[16:19], a[132:135], a[92:95], v[16:19]
  ds_read_b64_tr_b16 a[66:67], v118 offset:18432
  v_mfma_f32_16x16x32_bf16 v[32:35], a[136:139], a[88:91], v[32:35]
  ds_read_b128 a[4:7], v112 offset:32768
  v_mfma_f32_16x16x32_bf16 v[32:35], a[160:163], a[108:111], v[32:35]
  ds_read_b128 a[24:27], v113 offset:32768
  v_mfma_f32_16x16x32_bf16 v[36:39], a[160:163], a[112:115], v[36:39]
  ds_read_b128 a[8:11], v112 offset:34816
  buffer_load_dwordx4 v121, s[28:31], s68 offen offset:1024 sc1 lds
  v_mfma_f32_16x16x32_bf16 v[36:39], a[136:139], a[92:95], v[36:39]
  ds_read_b128 a[28:31], v113 offset:34816
  v_mfma_f32_16x16x32_bf16 v[40:43], a[136:139], a[96:99], v[40:43]
  ds_read_b128 a[12:15], v112 offset:36864
  v_mfma_f32_16x16x32_bf16 v[40:43], a[160:163], a[116:119], v[40:43]
  ds_read_b128 a[32:35], v113 offset:36864
  v_mfma_f32_16x16x32_bf16 v[44:47], a[160:163], a[120:123], v[44:47]
  ds_read_b128 a[16:19], v112 offset:38912
  buffer_load_dwordx4 v122, s[28:31], s68 offen offset:2048 sc1 lds
  v_mfma_f32_16x16x32_bf16 v[44:47], a[136:139], a[100:103], v[44:47]
  ds_read_b128 a[36:39], v113 offset:38912
  v_mfma_f32_16x16x32_bf16 v[48:51], a[136:139], a[104:107], v[48:51]
  ds_read_b64_tr_b16 a[44:45], v119 offset:0
  v_mfma_f32_16x16x32_bf16 v[48:51], a[160:163], a[124:127], v[48:51]
  ds_read_b64_tr_b16 a[46:47], v119 offset:6144
  v_mfma_f32_16x16x32_bf16 v[68:71], a[164:167], a[124:127], v[68:71]
  ds_read_b64_tr_b16 a[68:69], v119 offset:12288
  buffer_load_dwordx4 v123, s[28:31], s68 offen offset:3072 sc1 lds
  v_mfma_f32_16x16x32_bf16 v[68:71], a[140:143], a[104:107], v[68:71]
  ds_read_b64_tr_b16 a[70:71], v119 offset:18432
  v_mfma_f32_16x16x32_bf16 v[64:67], a[140:143], a[100:103], v[64:67]
  ds_read_b128 a[0:3], v114
  v_add_u32 v114, s65, v114
  v_mfma_f32_16x16x32_bf16 v[64:67], a[164:167], a[120:123], v[64:67]
  ds_read_b128 a[20:23], v115
  v_add_u32 v115, s65, v115
  s_add_u32 m0, s63, 24576
  v_mfma_f32_16x16x32_bf16 v[60:63], a[164:167], a[116:119], v[60:63]
  ds_read_b64_tr_b16 a[48:49], v118 offset:2048
  buffer_load_dwordx4 v124, s[8:11], s69 offen offset:0 lds
  v_mfma_f32_16x16x32_bf16 v[60:63], a[140:143], a[96:99], v[60:63]
  ds_read_b64_tr_b16 a[50:51], v118 offset:8192
  v_mfma_f32_16x16x32_bf16 v[56:59], a[140:143], a[92:95], v[56:59]
  ds_read_b64_tr_b16 a[72:73], v118 offset:14336
  v_mfma_f32_16x16x32_bf16 v[56:59], a[164:167], a[112:115], v[56:59]
  ds_read_b64_tr_b16 a[74:75], v118 offset:20480
  v_mfma_f32_16x16x32_bf16 v[52:55], a[164:167], a[108:111], v[52:55]
  ds_read_b64_tr_b16 a[52:53], v119 offset:2048
  buffer_load_dwordx4 v125, s[8:11], s69 offen offset:1024 lds
  v_mfma_f32_16x16x32_bf16 v[52:55], a[140:143], a[88:91], v[52:55]
  ds_read_b64_tr_b16 a[54:55], v119 offset:8192
  v_mfma_f32_16x16x32_bf16 v[72:75], a[88:91], a[144:147], v[72:75]
  ds_read_b64_tr_b16 a[76:77], v119 offset:14336
  v_mfma_f32_16x16x32_bf16 v[72:75], a[108:111], a[168:171], v[72:75]
  ds_read_b64_tr_b16 a[78:79], v119 offset:20480
  v_mfma_f32_16x16x32_bf16 v[76:79], a[112:115], a[168:171], v[76:79]
  ds_read_b64_tr_b16 a[56:57], v118 offset:4096
  buffer_load_dwordx4 v124, s[8:11], s69 offen offset:2048 lds
  v_mfma_f32_16x16x32_bf16 v[76:79], a[92:95], a[144:147], v[76:79]
  ds_read_b64_tr_b16 a[58:59], v118 offset:10240
  v_mfma_f32_16x16x32_bf16 v[80:83], a[96:99], a[144:147], v[80:83]
  ds_read_b64_tr_b16 a[80:81], v118 offset:16384
  v_mfma_f32_16x16x32_bf16 v[80:83], a[116:119], a[168:171], v[80:83]
  ds_read_b64_tr_b16 a[82:83], v118 offset:22528
  v_mfma_f32_16x16x32_bf16 v[84:87], a[120:123], a[168:171], v[84:87]
  ds_read_b64_tr_b16 a[60:61], v119 offset:4096
  buffer_load_dwordx4 v125, s[8:11], s69 offen offset:3072 lds
  v_mfma_f32_16x16x32_bf16 v[84:87], a[100:103], a[144:147], v[84:87]
  ds_read_b64_tr_b16 a[62:63], v119 offset:10240
  v_mfma_f32_16x16x32_bf16 v[88:91], a[104:107], a[144:147], v[88:91]
  ds_read_b64_tr_b16 a[84:85], v119 offset:16384
  v_mfma_f32_16x16x32_bf16 v[88:91], a[124:127], a[168:171], v[88:91]
  ds_read_b64_tr_b16 a[86:87], v119 offset:22528
  s_add_u32 m0, s63, 28672
  v_mfma_f32_16x16x32_bf16 v[108:111], a[124:127], a[172:175], v[108:111]
  buffer_load_dwordx4 v124, s[8:11], s70 offen offset:0 lds
  v_mfma_f32_16x16x32_bf16 v[108:111], a[104:107], a[148:151], v[108:111]
  v_mfma_f32_16x16x32_bf16 v[104:107], a[100:103], a[148:151], v[104:107]
  v_mfma_f32_16x16x32_bf16 v[104:107], a[120:123], a[172:175], v[104:107]
  v_mfma_f32_16x16x32_bf16 v[100:103], a[116:119], a[172:175], v[100:103]
  buffer_load_dwordx4 v125, s[8:11], s70 offen offset:1024 lds
  v_mfma_f32_16x16x32_bf16 v[100:103], a[96:99], a[148:151], v[100:103]
  v_mfma_f32_16x16x32_bf16 v[96:99], a[92:95], a[148:151], v[96:99]
  v_mfma_f32_16x16x32_bf16 v[96:99], a[112:115], a[172:175], v[96:99]
  v_mfma_f32_16x16x32_bf16 v[92:95], a[108:111], a[172:175], v[92:95]
  v_mfma_f32_16x16x32_bf16 v[92:95], a[88:91], a[148:151], v[92:95]
  s_cmp_eq_u32 s66, s88
  s_cbranch_scc0 Lside_skip1
  s_call_b64 s[78:79], Lside_sub
Lside_skip1:
  s_waitcnt lgkmcnt(15)
  v_mfma_f32_16x16x32_bf16 v[0:3], a[40:43], a[4:7], v[0:3]
  s_and_b32 s44, s66, 3
  v_mfma_f32_16x16x32_bf16 v[0:3], a[64:67], a[24:27], v[0:3]
  s_cmp_eq_u32 s44, s67
  s_cselect_b32 s44, 4, 0
  v_mfma_f32_16x16x32_bf16 v[4:7], a[64:67], a[28:31], v[4:7]
  s_add_u32 s44, s44, s66
  v_mfma_f32_16x16x32_bf16 v[4:7], a[40:43], a[8:11], v[4:7]
  s_and_b32 s44, s44, 15
  v_mfma_f32_16x16x32_bf16 v[8:11], a[40:43], a[12:15], v[8:11]
  s_add_u32 s66, s66, 1
  v_mfma_f32_16x16x32_bf16 v[8:11], a[64:67], a[32:35], v[8:11]
  s_mul_i32 s45, s44, s61
  v_mfma_f32_16x16x32_bf16 v[12:15], a[64:67], a[36:39], v[12:15]
  s_add_u32 s68, s45, s59
  v_mfma_f32_16x16x32_bf16 v[12:15], a[40:43], a[16:19], v[12:15]
  s_mul_i32 s45, s44, 393216
  v_mfma_f32_16x16x32_bf16 v[28:31], a[44:47], a[16:19], v[28:31]
  s_add_u32 s69, s45, s60
  v_mfma_f32_16x16x32_bf16 v[28:31], a[68:71], a[36:39], v[28:31]
  s_add_u32 s70, s69, 4096
  v_mfma_f32_16x16x32_bf16 v[24:27], a[68:71], a[32:35], v[24:27]
  v_mfma_f32_16x16x32_bf16 v[24:27], a[44:47], a[12:15], v[24:27]
  v_mfma_f32_16x16x32_bf16 v[20:23], a[44:47], a[8:11], v[20:23]
  s_waitcnt vmcnt(10) lgkmcnt(0)
  s_barrier
  ds_read_b64_tr_b16 a[128:129], v116 offset:0
  v_mfma_f32_16x16x32_bf16 v[20:23], a[68:71], a[28:31], v[20:23]
  ds_read_b64_tr_b16 a[130:131], v116 offset:6144
  s_add_u32 m0, s62, 106496
  v_mfma_f32_16x16x32_bf16 v[16:19], a[68:71], a[24:27], v[16:19]
  ds_read_b64_tr_b16 a[152:153], v116 offset:12288
  buffer_load_dwordx4 v120, s[28:31], s68 offen offset:0 sc1 lds
  v_mfma_f32_16x16x32_bf16 v[16:19], a[44:47], a[4:7], v[16:19]
  ds_read_b64_tr_b16 a[154:155], v116 offset:18432
  v_mfma_f32_16x16x32_bf16 v[32:35], a[48:51], a[0:3], v[32:35]
  ds_read_b128 a[92:95], v112 offset:0
  v_mfma_f32_16x16x32_bf16 v[32:35], a[72:75], a[20:23], v[32:35]
  ds_read_b128 a[112:115], v113 offset:0
  v_mfma_f32_16x16x32_bf16 v[36:39], a[72:75], a[24:27], v[36:39]
  ds_read_b128 a[96:99], v112 offset:2048
  buffer_load_dwordx4 v121, s[28:31], s68 offen offset:1024 sc1 lds
  v_mfma_f32_16x16x32_bf16 v[36:39], a[48:51], a[4:7], v[36:39]
  ds_read_b128 a[116:119], v113 offset:2048
  v_mfma_f32_16x16x32_bf16 v[40:43], a[48:51], a[8:11], v[40:43]
  ds_read_b128 a[100:103], v112 offset:4096
  v_mfma_f32_16x16x32_bf16 v[40:43], a[72:75], a[28:31], v[40:43]
  ds_read_b128 a[120:123], v113 offset:4096
  v_mfma_f32_16x16x32_bf16 v[44:47], a[72:75], a[32:35], v[44:47]
  ds_read_b128 a[104:107], v112 offset:6144
  buffer_load_dwordx4 v122, s[28:31], s68 offen offset:2048 sc1 lds
  v_mfma_f32_16x16x32_bf16 v[44:47], a[48:51], a[12:15], v[44:47]
  ds_read_b128 a[124:127], v113 offset:6144
  v_mfma_f32_16x16x32_bf16 v[48:51], a[48:51], a[16:19], v[48:51]
  ds_read_b64_tr_b16 a[132:133], v117 offset:0
  v_mfma_f32_16x16x32_bf16 v[48:51], a[72:75], a[36:39], v[48:51]
  ds_read_b64_tr_b16 a[134:135], v117 offset:6144
  v_mfma_f32_16x16x32_bf16 v[68:71], a[76:79], a[36:39], v[68:71]
  ds_read_b64_tr_b16 a[156:157], v117 offset:12288
  buffer_load_dwordx4 v123, s[28:31], s68 offen offset:3072 sc1 lds
  v_mfma_f32_16x16x32_bf16 v[68:71], a[52:55], a[16:19], v[68:71]
  ds_read_b64_tr_b16 a[158:159], v117 offset:18432
  v_mfma_f32_16x16x32_bf16 v[64:67], a[52:55], a[12:15], v[64:67]
  ds_read_b128 a[88:91], v114
  v_add_u32 v114, s64, v114
  v_mfma_f32_16x16x32_bf16 v[64:67], a[76:79], a[32:35], v[64:67]
  ds_read_b128 a[108:111], v115
  v_add_u32 v115, s64, v115
  s_add_u32 m0, s63, 49152
  v_mfma_f32_16x16x32_bf16 v[60:63], a[76:79], a[28:31], v[60:63]
  ds_read_b64_tr_b16 a[136:137], v116 offset:2048
  buffer_load_dwordx4 v124, s[8:11], s69 offen offset:0 lds
  v_mfma_f32_16x16x32_bf16 v[60:63], a[52:55], a[8:11], v[60:63]
  ds_read_b64_tr_b16 a[138:139], v116 offset:8192
  v_mfma_f32_16x16x32_bf16 v[56:59], a[52:55], a[4:7], v[56:59]
  ds_read_b64_tr_b16 a[160:161], v116 offset:14336
  v_mfma_f32_16x16x32_bf16 v[56:59], a[76:79], a[24:27], v[56:59]
  ds_read_b64_tr_b16 a[162:163], v116 offset:20480
  v_mfma_f32_16x16x32_bf16 v[52:55], a[76:79], a[20:23], v[52:55]
  ds_read_b64_tr_b16 a[140:141], v117 offset:2048
  buffer_load_dwordx4 v125, s[8:11], s69 offen offset:1024 lds
  v_mfma_f32_16x16x32_bf16 v[52:55], a[52:55], a[0:3], v[52:55]
  ds_read_b64_tr_b16 a[142:143], v117 offset:8192
  v_mfma_f32_16x16x32_bf16 v[72:75], a[0:3], a[56:59], v[72:75]
  ds_read_b64_tr_b16 a[164:165], v117 offset:14336
  v_mfma_f32_16x16x32_bf16 v[72:75], a[20:23], a[80:83], v[72:75]
  ds_read_b64_tr_b16 a[166:167], v117 offset:20480
  v_mfma_f32_16x16x32_bf16 v[76:79], a[24:27], a[80:83], v[76:79]
  ds_read_b64_tr_b16 a[144:145], v116 offset:4096
  buffer_load_dwordx4 v124, s[8:11], s69 offen offset:2048 lds
  v_mfma_f32_16x16x32_bf16 v[76:79], a[4:7], a[56:59], v[76:79]
  ds_read_b64_tr_b16 a[146:147], v116 offset:10240
  v_mfma_f32_16x16x32_bf16 v[80:83], a[8:11], a[56:59], v[80:83]
  ds_read_b64_tr_b16 a[168:169], v116 offset:16384
  v_mfma_f32_16x16x32_bf16 v[80:83], a[28:31], a[80:83], v[80:83]
  ds_read_b64_tr_b16 a[170:171], v116 offset:22528
  v_mfma_f32_16x16x32_bf16 v[84:87], a[32:35], a[80:83], v[84:87]
  ds_read_b64_tr_b16 a[148:149], v117 offset:4096
  buffer_load_dwordx4 v125, s[8:11], s69 offen offset:3072 lds
  v_mfma_f32_16x16x32_bf16 v[84:87], a[12:15], a[56:59], v[84:87]
  ds_read_b64_tr_b16 a[150:151], v117 offset:10240
  v_mfma_f32_16x16x32_bf16 v[88:91], a[16:19], a[56:59], v[88:91]
  ds_read_b64_tr_b16 a[172:173], v117 offset:16384
  v_mfma_f32_16x16x32_bf16 v[88:91], a[36:39], a[80:83], v[88:91]
  ds_read_b64_tr_b16 a[174:175], v117 offset:22528
  s_add_u32 m0, s63, 53248
  v_mfma_f32_16x16x32_bf16 v[108:111], a[36:39], a[84:87], v[108:111]
  buffer_load_dwordx4 v124, s[8:11], s70 offen offset:0 lds
  v_mfma_f32_16x16x32_bf16 v[108:111], a[16:19], a[60:63], v[108:111]
  v_mfma_f32_16x16x32_bf16 v[104:107], a[12:15], a[60:63], v[104:107]
  v_mfma_f32_16x16x32_bf16 v[104:107], a[32:35], a[84:87], v[104:107]
  v_mfma_f32_16x16x32_bf16 v[100:103], a[28:31], a[84:87], v[100:103]
  buffer_load_dwordx4 v125, s[8:11], s70 offen offset:1024 lds
  v_mfma_f32_16x16x32_bf16 v[100:103], a[8:11], a[60:63], v[100:103]
  v_mfma_f32_16x16x32_bf16 v[96:99], a[4:7], a[60:63], v[96:99]
  v_mfma_f32_16x16x32_bf16 v[96:99], a[24:27], a[84:87], v[96:99]
  v_mfma_f32_16x16x32_bf16 v[92:95], a[20:23], a[84:87], v[92:95]
  v_mfma_f32_16x16x32_bf16 v[92:95], a[0:3], a[60:63], v[92:95]
  s_cmp_eq_u32 s66, s88
  s_cbranch_scc0 Lside_skip2
  s_call_b64 s[78:79], Lside_sub
Lside_skip2:
  s_waitcnt lgkmcnt(15)
  v_mfma_f32_16x16x32_bf16 v[0:3], a[128:131], a[92:95], v[0:3]
  s_and_b32 s44, s66, 3
  v_mfma_f32_16x16x32_bf16 v[0:3], a[152:155], a[112:115], v[0:3]
  s_cmp_eq_u32 s44, s67
  s_cselect_b32 s44, 4, 0
  v_mfma_f32_16x16x32_bf16 v[4:7], a[152:155], a[116:119], v[4:7]
  s_add_u32 s44, s44, s66
  v_mfma_f32_16x16x32_bf16 v[4:7], a[128:131], a[96:99], v[4:7]
  s_and_b32 s44, s44, 15
  v_mfma_f32_16x16x32_bf16 v[8:11], a[128:131], a[100:103], v[8:11]
  s_add_u32 s66, s66, 1
  v_mfma_f32_16x16x32_bf16 v[8:11], a[152:155], a[120:123], v[8:11]
  s_mul_i32 s45, s44, s61
  v_mfma_f32_16x16x32_bf16 v[12:15], a[152:155], a[124:127], v[12:15]
  s_add_u32 s68, s45, s59
  v_mfma_f32_16x16x32_bf16 v[12:15], a[128:131], a[104:107], v[12:15]
  s_mul_i32 s45, s44, 393216
  v_mfma_f32_16x16x32_bf16 v[28:31], a[132:135], a[104:107], v[28:31]
  s_add_u32 s69, s45, s60
  v_mfma_f32_16x16x32_bf16 v[28:31], a[156:159], a[124:127], v[28:31]
  s_add_u32 s70, s69, 4096
  v_mfma_f32_16x16x32_bf16 v[24:27], a[156:159], a[120:123], v[24:27]
  v_mfma_f32_16x16x32_bf16 v[24:27], a[132:135], a[100:103], v[24:27]
  v_mfma_f32_16x16x32_bf16 v[20:23], a[132:135], a[96:99], v[20:23]
  s_waitcnt vmcnt(10) lgkmcnt(0)
  s_barrier
  ds_read_b64_tr_b16 a[40:41], v116 offset:24576
  v_mfma_f32_16x16x32_bf16 v[20:23], a[156:159], a[116:119], v[20:23]
  ds_read_b64_tr_b16 a[42:43], v116 offset:30720
  s_add_u32 m0, s62, 73728
  v_mfma_f32_16x16x32_bf16 v[16:19], a[156:159], a[112:115], v[16:19]
  ds_read_b64_tr_b16 a[64:65], v116 offset:36864
  buffer_load_dwordx4 v120, s[28:31], s68 offen offset:0 sc1 lds
  v_mfma_f32_16x16x32_bf16 v[16:19], a[132:135], a[92:95], v[16:19]
  ds_read_b64_tr_b16 a[66:67], v116 offset:43008
  v_mfma_f32_16x16x32_bf16 v[32:35], a[136:139], a[88:91], v[32:35]
  ds_read_b128 a[4:7], v112 offset:16384
  v_mfma_f32_16x16x32_bf16 v[32:35], a[160:163], a[108:111], v[32:35]
  ds_read_b128 a[24:27], v113 offset:16384
  v_mfma_f32_16x16x32_bf16 v[36:39], a[160:163], a[112:115], v[36:39]
  ds_read_b128 a[8:11], v112 offset:18432
  buffer_load_dwordx4 v121, s[28:31], s68 offen offset:1024 sc1 lds
  v_mfma_f32_16x16x32_bf16 v[36:39], a[136:139], a[92:95], v[36:39]
  ds_read_b128 a[28:31], v113 offset:18432
  v_mfma_f32_16x16x32_bf16 v[40:43], a[136:139], a[96:99], v[40:43]
  ds_read_b128 a[12:15], v112 offset:20480
  v_mfma_f32_16x16x32_bf16 v[40:43], a[160:163], a[116:119], v[40:43]
  ds_read_b128 a[32:35], v113 offset:20480
  v_mfma_f32_16x16x32_bf16 v[44:47], a[160:163], a[120:123], v[44:47]
  ds_read_b128 a[16:19], v112 offset:22528
  buffer_load_dwordx4 v122, s[28:31], s68 offen offset:2048 sc1 lds
  v_mfma_f32_16x16x32_bf16 v[44:47], a[136:139], a[100:103], v[44:47]
  ds_read_b128 a[36:39], v113 offset:22528
  v_mfma_f32_16x16x32_bf16 v[48:51], a[136:139], a[104:107], v[48:51]
  ds_read_b64_tr_b16 a[44:45], v117 offset:24576
  v_mfma_f32_16x16x32_bf16 v[48:51], a[160:163], a[124:127], v[48:51]
  ds_read_b64_tr_b16 a[46:47], v117 offset:30720
  v_mfma_f32_16x16x32_bf16 v[68:71], a[164:167], a[124:127], v[68:71]
  ds_read_b64_tr_b16 a[68:69], v117 offset:36864
  buffer_load_dwordx4 v123, s[28:31], s68 offen offset:3072 sc1 lds
  v_mfma_f32_16x16x32_bf16 v[68:71], a[140:143], a[104:107], v[68:71]
  ds_read_b64_tr_b16 a[70:71], v117 offset:43008
  v_mfma_f32_16x16x32_bf16 v[64:67], a[140:143], a[100:103], v[64:67]
  ds_read_b128 a[0:3], v114
  v_add_u32 v114, s64, v114
  v_mfma_f32_16x16x32_bf16 v[64:67], a[164:167], a[120:123], v[64:67]
  ds_read_b128 a[20:23], v115
  v_add_u32 v115, s64, v115
  s_add_u32 m0, s63, 0
  v_mfma_f32_16x16x32_bf16 v[60:63], a[164:167], a[116:119], v[60:63]
  ds_read_b64_tr_b16 a[48:49], v116 offset:26624
  buffer_load_dwordx4 v124, s[8:11], s69 offen offset:0 lds
  v_mfma_f32_16x16x32_bf16 v[60:63], a[140:143], a[96:99], v[60:63]
  ds_read_b64_tr_b16 a[50:51], v116 offset:32768
  v_mfma_f32_16x16x32_bf16 v[56:59], a[140:143], a[92:95], v[56:59]
  ds_read_b64_tr_b16 a[72:73], v116 offset:38912
  v_mfma_f32_16x16x32_bf16 v[56:59], a[164:167], a[112:115], v[56:59]
  ds_read_b64_tr_b16 a[74:75], v116 offset:45056
  v_mfma_f32_16x16x32_bf16 v[52:55], a[164:167], a[108:111], v[52:55]
  ds_read_b64_tr_b16 a[52:53], v117 offset:26624
  buffer_load_dwordx4 v125, s[8:11], s69 offen offset:1024 lds
  v_mfma_f32_16x16x32_bf16 v[52:55], a[140:143], a[88:91], v[52:55]
  ds_read_b64_tr_b16 a[54:55], v117 offset:32768
  v_mfma_f32_16x16x32_bf16 v[72:75], a[88:91], a[144:147], v[72:75]
  ds_read_b64_tr_b16 a[76:77], v117 offset:38912
  v_mfma_f32_16x16x32_bf16 v[72:75], a[108:111], a[168:171], v[72:75]
  ds_read_b64_tr_b16 a[78:79], v117 offset:45056
  v_mfma_f32_16x16x32_bf16 v[76:79], a[112:115], a[168:171], v[76:79]
  ds_read_b64_tr_b16 a[56:57], v116 offset:28672
  buffer_load_dwordx4 v124, s[8:11], s69 offen offset:2048 lds
  v_mfma_f32_16x16x32_bf16 v[76:79], a[92:95], a[144:147], v[76:79]
  ds_read_b64_tr_b16 a[58:59], v116 offset:34816
  v_mfma_f32_16x16x32_bf16 v[80:83], a[96:99], a[144:147], v[80:83]
  ds_read_b64_tr_b16 a[80:81], v116 offset:40960
  v_mfma_f32_16x16x32_bf16 v[80:83], a[116:119], a[168:171], v[80:83]
  ds_read_b64_tr_b16 a[82:83], v116 offset:47104
  v_mfma_f32_16x16x32_bf16 v[84:87], a[120:123], a[168:171], v[84:87]
  ds_read_b64_tr_b16 a[60:61], v117 offset:28672
  buffer_load_dwordx4 v125, s[8:11], s69 offen offset:3072 lds
  v_mfma_f32_16x16x32_bf16 v[84:87], a[100:103], a[144:147], v[84:87]
  ds_read_b64_tr_b16 a[62:63], v117 offset:34816
  v_mfma_f32_16x16x32_bf16 v[88:91], a[104:107], a[144:147], v[88:91]
  ds_read_b64_tr_b16 a[84:85], v117 offset:40960
  v_mfma_f32_16x16x32_bf16 v[88:91], a[124:127], a[168:171], v[88:91]
  ds_read_b64_tr_b16 a[86:87], v117 offset:47104
  s_add_u32 m0, s63, 4096
  v_mfma_f32_16x16x32_bf16 v[108:111], a[124:127], a[172:175], v[108:111]
  buffer_load_dwordx4 v124, s[8:11], s70 offen offset:0 lds
  v_mfma_f32_16x16x32_bf16 v[108:111], a[104:107], a[148:151], v[108:111]
  v_mfma_f32_16x16x32_bf16 v[104:107], a[100:103], a[148:151], v[104:107]
  v_mfma_f32_16x16x32_bf16 v[104:107], a[120:123], a[172:175], v[104:107]
  v_mfma_f32_16x16x32_bf16 v[100:103], a[116:119], a[172:175], v[100:103]
  buffer_load_dwordx4 v125, s[8:11], s70 offen offset:1024 lds
  v_mfma_f32_16x16x32_bf16 v[100:103], a[96:99], a[148:151], v[100:103]
  v_mfma_f32_16x16x32_bf16 v[96:99], a[92:95], a[148:151], v[96:99]
  v_mfma_f32_16x16x32_bf16 v[96:99], a[112:115], a[172:175], v[96:99]
  v_mfma_f32_16x16x32_bf16 v[92:95], a[108:111], a[172:175], v[92:95]
  v_mfma_f32_16x16x32_bf16 v[92:95], a[88:91], a[148:151], v[92:95]
  s_cmp_eq_u32 s66, s88
  s_cbranch_scc0 Lside_skip3
  s_call_b64 s[78:79], Lside_sub
Lside_skip3:
  s_waitcnt lgkmcnt(15)
  v_mfma_f32_16x16x32_bf16 v[0:3], a[40:43], a[4:7], v[0:3]
  s_and_b32 s44, s66, 3
  v_mfma_f32_16x16x32_bf16 v[0:3], a[64:67], a[24:27], v[0:3]
  s_cmp_eq_u32 s44, s67
  s_cselect_b32 s44, 4, 0
  v_mfma_f32_16x16x32_bf16 v[4:7], a[64:67], a[28:31], v[4:7]
  s_add_u32 s44, s44, s66
  v_mfma_f32_16x16x32_bf16 v[4:7], a[40:43], a[8:11], v[4:7]
  s_and_b32 s44, s44, 15
  v_mfma_f32_16x16x32_bf16 v[8:11], a[40:43], a[12:15], v[8:11]
  s_add_u32 s66, s66, 1
  v_mfma_f32_16x16x32_bf16 v[8:11], a[64:67], a[32:35], v[8:11]
  s_mul_i32 s45, s44, s61
  v_mfma_f32_16x16x32_bf16 v[12:15], a[64:67], a[36:39], v[12:15]
  s_add_u32 s68, s45, s59
  v_mfma_f32_16x16x32_bf16 v[12:15], a[40:43], a[16:19], v[12:15]
  s_mul_i32 s45, s44, 393216
  v_mfma_f32_16x16x32_bf16 v[28:31], a[44:47], a[16:19], v[28:31]
  s_add_u32 s69, s45, s60
  v_mfma_f32_16x16x32_bf16 v[28:31], a[68:71], a[36:39], v[28:31]
  s_add_u32 s70, s69, 4096
  v_mfma_f32_16x16x32_bf16 v[24:27], a[68:71], a[32:35], v[24:27]
  v_mfma_f32_16x16x32_bf16 v[24:27], a[44:47], a[12:15], v[24:27]
  v_mfma_f32_16x16x32_bf16 v[20:23], a[44:47], a[8:11], v[20:23]
  s_waitcnt vmcnt(10) lgkmcnt(0)
  s_barrier
  ds_read_b64_tr_b16 a[128:129], v118 offset:0
  v_mfma_f32_16x16x32_bf16 v[20:23], a[68:71], a[28:31], v[20:23]
  ds_read_b64_tr_b16 a[130:131], v118 offset:6144
  s_add_u32 m0, s62, 90112
  v_mfma_f32_16x16x32_bf16 v[16:19], a[68:71], a[24:27], v[16:19]
  ds_read_b64_tr_b16 a[152:153], v118 offset:12288
  buffer_load_dwordx4 v120, s[28:31], s68 offen offset:0 sc1 lds
  v_mfma_f32_16x16x32_bf16 v[16:19], a[44:47], a[4:7], v[16:19]
  ds_read_b64_tr_b16 a[154:155], v118 offset:18432
  v_mfma_f32_16x16x32_bf16 v[32:35], a[48:51], a[0:3], v[32:35]
  ds_read_b128 a[92:95], v112 offset:32768
  v_mfma_f32_16x16x32_bf16 v[32:35], a[72:75], a[20:23], v[32:35]
  ds_read_b128 a[112:115], v113 offset:32768
  v_mfma_f32_16x16x32_bf16 v[36:39], a[72:75], a[24:27], v[36:39]
  ds_read_b128 a[96:99], v112 offset:34816
  buffer_load_dwordx4 v121, s[28:31], s68 offen offset:1024 sc1 lds
  v_mfma_f32_16x16x32_bf16 v[36:39], a[48:51], a[4:7], v[36:39]
  ds_read_b128 a[116:119], v113 offset:34816
  v_mfma_f32_16x16x32_bf16 v[40:43], a[48:51], a[8:11], v[40:43]
  ds_read_b128 a[100:103], v112 offset:36864
  v_mfma_f32_16x16x32_bf16 v[40:43], a[72:75], a[28:31], v[40:43]
  ds_read_b128 a[120:123], v113 offset:36864
  v_mfma_f32_16x16x32_bf16 v[44:47], a[72:75], a[32:35], v[44:47]
  ds_read_b128 a[104:107], v112 offset:38912
  buffer_load_dwordx4 v122, s[28:31], s68 offen offset:2048 sc1 lds
  v_mfma_f32_16x16x32_bf16 v[44:47], a[48:51], a[12:15], v[44:47]
  ds_read_b128 a[124:127], v113 offset:38912
  v_mfma_f32_16x16x32_bf16 v[48:51], a[48:51], a[16:19], v[48:51]
  ds_read_b64_tr_b16 a[132:133], v119 offset:0
  v_mfma_f32_16x16x32_bf16 v[48:51], a[72:75], a[36:39], v[48:51]
  ds_read_b64_tr_b16 a[134:135], v119 offset:6144
  v_mfma_f32_16x16x32_bf16 v[68:71], a[76:79], a[36:39], v[68:71]
  ds_read_b64_tr_b16 a[156:157], v119 offset:12288
  buffer_load_dwordx4 v123, s[28:31], s68 offen offset:3072 sc1 lds
  v_mfma_f32_16x16x32_bf16 v[68:71], a[52:55], a[16:19], v[68:71]
  ds_read_b64_tr_b16 a[158:159], v119 offset:18432
  v_mfma_f32_16x16x32_bf16 v[64:67], a[52:55], a[12:15], v[64:67]
  ds_read_b128 a[88:91], v114
  v_add_u32 v114, s65, v114
  v_mfma_f32_16x16x32_bf16 v[64:67], a[76:79], a[32:35], v[64:67]
  ds_read_b128 a[108:111], v115
  v_add_u32 v115, s65, v115
  s_add_u32 m0, s63, 24576
  v_mfma_f32_16x16x32_bf16 v[60:63], a[76:79], a[28:31], v[60:63]
  ds_read_b64_tr_b16 a[136:137], v118 offset:2048
  buffer_load_dwordx4 v124, s[8:11], s69 offen offset:0 lds
  v_mfma_f32_16x16x32_bf16 v[60:63], a[52:55], a[8:11], v[60:63]
  ds_read_b64_tr_b16 a[138:139], v118 offset:8192
  v_mfma_f32_16x16x32_bf16 v[56:59], a[52:55], a[4:7], v[56:59]
  ds_read_b64_tr_b16 a[160:161], v118 offset:14336
  v_mfma_f32_16x16x32_bf16 v[56:59], a[76:79], a[24:27], v[56:59]
  ds_read_b64_tr_b16 a[162:163], v118 offset:20480
  v_mfma_f32_16x16x32_bf16 v[52:55], a[76:79], a[20:23], v[52:55]
  ds_read_b64_tr_b16 a[140:141], v119 offset:2048
  buffer_load_dwordx4 v125, s[8:11], s69 offen offset:1024 lds
  v_mfma_f32_16x16x32_bf16 v[52:55], a[52:55], a[0:3], v[52:55]
  ds_read_b64_tr_b16 a[142:143], v119 offset:8192
  v_mfma_f32_16x16x32_bf16 v[72:75], a[0:3], a[56:59], v[72:75]
  ds_read_b64_tr_b16 a[164:165], v119 offset:14336
  v_mfma_f32_16x16x32_bf16 v[72:75], a[20:23], a[80:83], v[72:75]
  ds_read_b64_tr_b16 a[166:167], v119 offset:20480
  v_mfma_f32_16x16x32_bf16 v[76:79], a[24:27], a[80:83], v[76:79]
  ds_read_b64_tr_b16 a[144:145], v118 offset:4096
  buffer_load_dwordx4 v124, s[8:11], s69 offen offset:2048 lds
  v_mfma_f32_16x16x32_bf16 v[76:79], a[4:7], a[56:59], v[76:79]
  ds_read_b64_tr_b16 a[146:147], v118 offset:10240
  v_mfma_f32_16x16x32_bf16 v[80:83], a[8:11], a[56:59], v[80:83]
  ds_read_b64_tr_b16 a[168:169], v118 offset:16384
  v_mfma_f32_16x16x32_bf16 v[80:83], a[28:31], a[80:83], v[80:83]
  ds_read_b64_tr_b16 a[170:171], v118 offset:22528
  v_mfma_f32_16x16x32_bf16 v[84:87], a[32:35], a[80:83], v[84:87]
  ds_read_b64_tr_b16 a[148:149], v119 offset:4096
  buffer_load_dwordx4 v125, s[8:11], s69 offen offset:3072 lds
  v_mfma_f32_16x16x32_bf16 v[84:87], a[12:15], a[56:59], v[84:87]
  ds_read_b64_tr_b16 a[150:151], v119 offset:10240
  v_mfma_f32_16x16x32_bf16 v[88:91], a[16:19], a[56:59], v[88:91]
  ds_read_b64_tr_b16 a[172:173], v119 offset:16384
  v_mfma_f32_16x16x32_bf16 v[88:91], a[36:39], a[80:83], v[88:91]
  ds_read_b64_tr_b16 a[174:175], v119 offset:22528
  s_add_u32 m0, s63, 28672
  v_mfma_f32_16x16x32_bf16 v[108:111], a[36:39], a[84:87], v[108:111]
  buffer_load_dwordx4 v124, s[8:11], s70 offen offset:0 lds
  v_mfma_f32_16x16x32_bf16 v[108:111], a[16:19], a[60:63], v[108:111]
  v_mfma_f32_16x16x32_bf16 v[104:107], a[12:15], a[60:63], v[104:107]
  v_mfma_f32_16x16x32_bf16 v[104:107], a[32:35], a[84:87], v[104:107]
  v_mfma_f32_16x16x32_bf16 v[100:103], a[28:31], a[84:87], v[100:103]
  buffer_load_dwordx4 v125, s[8:11], s70 offen offset:1024 lds
  v_mfma_f32_16x16x32_bf16 v[100:103], a[8:11], a[60:63], v[100:103]
  v_mfma_f32_16x16x32_bf16 v[96:99], a[4:7], a[60:63], v[96:99]
  v_mfma_f32_16x16x32_bf16 v[96:99], a[24:27], a[84:87], v[96:99]
  v_mfma_f32_16x16x32_bf16 v[92:95], a[20:23], a[84:87], v[92:95]
  v_mfma_f32_16x16x32_bf16 v[92:95], a[0:3], a[60:63], v[92:95]
  s_cmp_eq_u32 s66, s88
  s_cbranch_scc0 Lside_skip4
  s_call_b64 s[78:79], Lside_sub
Lside_skip4:
  s_waitcnt lgkmcnt(15)
  v_mfma_f32_16x16x32_bf16 v[0:3], a[128:131], a[92:95], v[0:3]
  s_and_b32 s44, s66, 3
  v_mfma_f32_16x16x32_bf16 v[0:3], a[152:155], a[112:115], v[0:3]
  s_cmp_eq_u32 s44, s67
  s_cselect_b32 s44, 4, 0
  v_mfma_f32_16x16x32_bf16 v[4:7], a[152:155], a[116:119], v[4:7]
  s_add_u32 s44, s44, s66
  v_mfma_f32_16x16x32_bf16 v[4:7], a[128:131], a[96:99], v[4:7]
  s_and_b32 s44, s44, 15
  v_mfma_f32_16x16x32_bf16 v[8:11], a[128:131], a[100:103], v[8:11]
  s_add_u32 s66, s66, 1
  v_mfma_f32_16x16x32_bf16 v[8:11], a[152:155], a[120:123], v[8:11]
  s_mul_i32 s45, s44, s61
  v_mfma_f32_16x16x32_bf16 v[12:15], a[152:155], a[124:127], v[12:15]
  s_add_u32 s68, s45, s59
  v_mfma_f32_16x16x32_bf16 v[12:15], a[128:131], a[104:107], v[12:15]
  s_mul_i32 s45, s44, 393216
  v_mfma_f32_16x16x32_bf16 v[28:31], a[132:135], a[104:107], v[28:31]
  s_add_u32 s69, s45, s60
  v_mfma_f32_16x16x32_bf16 v[28:31], a[156:159], a[124:127], v[28:31]
  s_add_u32 s70, s69, 4096
  v_mfma_f32_16x16x32_bf16 v[24:27], a[156:159], a[120:123], v[24:27]
  v_mfma_f32_16x16x32_bf16 v[24:27], a[132:135], a[100:103], v[24:27]
  v_mfma_f32_16x16x32_bf16 v[20:23], a[132:135], a[96:99], v[20:23]
  s_waitcnt vmcnt(10) lgkmcnt(0)
  s_barrier
  ds_read_b64_tr_b16 a[40:41], v116 offset:0
  v_mfma_f32_16x16x32_bf16 v[20:23], a[156:159], a[116:119], v[20:23]
  ds_read_b64_tr_b16 a[42:43], v116 offset:6144
  s_add_u32 m0, s62, 106496
  v_mfma_f32_16x16x32_bf16 v[16:19], a[156:159], a[112:115], v[16:19]
  ds_read_b64_tr_b16 a[64:65], v116 offset:12288
  buffer_load_dwordx4 v120, s[28:31], s68 offen offset:0 sc1 lds
  v_mfma_f32_16x16x32_bf16 v[16:19], a[132:135], a[92:95], v[16:19]
  ds_read_b64_tr_b16 a[66:67], v116 offset:18432
  v_mfma_f32_16x16x32_bf16 v[32:35], a[136:139], a[88:91], v[32:35]
  ds_read_b128 a[4:7], v112 offset:0
  v_mfma_f32_16x16x32_bf16 v[32:35], a[160:163], a[108:111], v[32:35]
  ds_read_b128 a[24:27], v113 offset:0
  v_mfma_f32_16x16x32_bf16 v[36:39], a[160:163], a[112:115], v[36:39]
  ds_read_b128 a[8:11], v112 offset:2048
  buffer_load_dwordx4 v121, s[28:31], s68 offen offset:1024 sc1 lds
  v_mfma_f32_16x16x32_bf16 v[36:39], a[136:139], a[92:95], v[36:39]
  ds_read_b128 a[28:31], v113 offset:2048
  v_mfma_f32_16x16x32_bf16 v[40:43], a[136:139], a[96:99], v[40:43]
  ds_read_b128 a[12:15], v112 offset:4096
  v_mfma_f32_16x16x32_bf16 v[40:43], a[160:163], a[116:119], v[40:43]
  ds_read_b128 a[32:35], v113 offset:4096
  v_mfma_f32_16x16x32_bf16 v[44:47], a[160:163], a[120:123], v[44:47]
  ds_read_b128 a[16:19], v112 offset:6144
  buffer_load_dwordx4 v122, s[28:31], s68 offen offset:2048 sc1 lds
  v_mfma_f32_16x16x32_bf16 v[44:47], a[136:139], a[100:103], v[44:47]
  ds_read_b128 a[36:39], v113 offset:6144
  v_mfma_f32_16x16x32_bf16 v[48:51], a[136:139], a[104:107], v[48:51]
  ds_read_b64_tr_b16 a[44:45], v117 offset:0
  v_mfma_f32_16x16x32_bf16 v[48:51], a[160:163], a[124:127], v[48:51]
  ds_read_b64_tr_b16 a[46:47], v117 offset:6144
  v_mfma_f32_16x16x32_bf16 v[68:71], a[164:167], a[124:127], v[68:71]
  ds_read_b64_tr_b16 a[68:69], v117 offset:12288
  buffer_load_dwordx4 v123, s[28:31], s68 offen offset:3072 sc1 lds
  v_mfma_f32_16x16x32_bf16 v[68:71], a[140:143], a[104:107], v[68:71]
  ds_read_b64_tr_b16 a[70:71], v117 offset:18432
  v_mfma_f32_16x16x32_bf16 v[64:67], a[140:143], a[100:103], v[64:67]
  ds_read_b128 a[0:3], v114
  v_add_u32 v114, s64, v114
  v_mfma_f32_16x16x32_bf16 v[64:67], a[164:167], a[120:123], v[64:67]
  ds_read_b128 a[20:23], v115
  v_add_u32 v115, s64, v115
  s_add_u32 m0, s63, 49152
  v_mfma_f32_16x16x32_bf16 v[60:63], a[164:167], a[116:119], v[60:63]
  ds_read_b64_tr_b16 a[48:49], v116 offset:2048
  buffer_load_dwordx4 v124, s[8:11], s69 offen offset:0 lds
  v_mfma_f32_16x16x32_bf16 v[60:63], a[140:143], a[96:99], v[60:63]
  ds_read_b64_tr_b16 a[50:51], v116 offset:8192
  v_mfma_f32_16x16x32_bf16 v[56:59], a[140:143], a[92:95], v[56:59]
  ds_read_b64_tr_b16 a[72:73], v116 offset:14336
  v_mfma_f32_16x16x32_bf16 v[56:59], a[164:167], a[112:115], v[56:59]
  ds_read_b64_tr_b16 a[74:75], v116 offset:20480
  v_mfma_f32_16x16x32_bf16 v[52:55], a[164:167], a[108:111], v[52:55]
  ds_read_b64_tr_b16 a[52:53], v117 offset:2048
  buffer_load_dwordx4 v125, s[8:11], s69 offen offset:1024 lds
  v_mfma_f32_16x16x32_bf16 v[52:55], a[140:143], a[88:91], v[52:55]
  ds_read_b64_tr_b16 a[54:55], v117 offset:8192
  v_mfma_f32_16x16x32_bf16 v[72:75], a[88:91], a[144:147], v[72:75]
  ds_read_b64_tr_b16 a[76:77], v117 offset:14336
  v_mfma_f32_16x16x32_bf16 v[72:75], a[108:111], a[168:171], v[72:75]
  ds_read_b64_tr_b16 a[78:79], v117 offset:20480
  v_mfma_f32_16x16x32_bf16 v[76:79], a[112:115], a[168:171], v[76:79]
  ds_read_b64_tr_b16 a[56:57], v116 offset:4096
  buffer_load_dwordx4 v124, s[8:11], s69 offen offset:2048 lds
  v_mfma_f32_16x16x32_bf16 v[76:79], a[92:95], a[144:147], v[76:79]
  ds_read_b64_tr_b16 a[58:59], v116 offset:10240
  v_mfma_f32_16x16x32_bf16 v[80:83], a[96:99], a[144:147], v[80:83]
  ds_read_b64_tr_b16 a[80:81], v116 offset:16384
  v_mfma_f32_16x16x32_bf16 v[80:83], a[116:119], a[168:171], v[80:83]
  ds_read_b64_tr_b16 a[82:83], v116 offset:22528
  v_mfma_f32_16x16x32_bf16 v[84:87], a[120:123], a[168:171], v[84:87]
  ds_read_b64_tr_b16 a[60:61], v117 offset:4096
  buffer_load_dwordx4 v125, s[8:11], s69 offen offset:3072 lds
  v_mfma_f32_16x16x32_bf16 v[84:87], a[100:103], a[144:147], v[84:87]
  ds_read_b64_tr_b16 a[62:63], v117 offset:10240
  v_mfma_f32_16x16x32_bf16 v[88:91], a[104:107], a[144:147], v[88:91]
  ds_read_b64_tr_b16 a[84:85], v117 offset:16384
  v_mfma_f32_16x16x32_bf16 v[88:91], a[124:127], a[168:171], v[88:91]
  ds_read_b64_tr_b16 a[86:87], v117 offset:22528
  s_add_u32 m0, s63, 53248
  v_mfma_f32_16x16x32_bf16 v[108:111], a[124:127], a[172:175], v[108:111]
  buffer_load_dwordx4 v124, s[8:11], s70 offen offset:0 lds
  v_mfma_f32_16x16x32_bf16 v[108:111], a[104:107], a[148:151], v[108:111]
  v_mfma_f32_16x16x32_bf16 v[104:107], a[100:103], a[148:151], v[104:107]
  v_mfma_f32_16x16x32_bf16 v[104:107], a[120:123], a[172:175], v[104:107]
  v_mfma_f32_16x16x32_bf16 v[100:103], a[116:119], a[172:175], v[100:103]
  buffer_load_dwordx4 v125, s[8:11], s70 offen offset:1024 lds
  v_mfma_f32_16x16x32_bf16 v[100:103], a[96:99], a[148:151], v[100:103]
  v_mfma_f32_16x16x32_bf16 v[96:99], a[92:95], a[148:151], v[96:99]
  v_mfma_f32_16x16x32_bf16 v[96:99], a[112:115], a[172:175], v[96:99]
  v_mfma_f32_16x16x32_bf16 v[92:95], a[108:111], a[172:175], v[92:95]
  v_mfma_f32_16x16x32_bf16 v[92:95], a[88:91], a[148:151], v[92:95]
  s_cmp_eq_u32 s66, s88
  s_cbranch_scc0 Lside_skip5
  s_call_b64 s[78:79], Lside_sub
Lside_skip5:
  s_sub_u32 s56, s56, 1
  s_cmp_lg_u32 s56, 0
  s_cbranch_scc1 Lp1_loop
  s_waitcnt lgkmcnt(15)
  v_mfma_f32_16x16x32_bf16 v[0:3], a[40:43], a[4:7], v[0:3]
  s_and_b32 s44, s66, 3
  v_and_b32 v187, 1, v253
  v_lshlrev_b32 v187, 7, v187
  v_mfma_f32_16x16x32_bf16 v[0:3], a[64:67], a[24:27], v[0:3]
  s_cmp_eq_u32 s44, s67
  s_cselect_b32 s44, 4, 0
  buffer_load_dword v127, v187, s[36:39], 0 offen sc1
  v_mfma_f32_16x16x32_bf16 v[4:7], a[64:67], a[28:31], v[4:7]
  s_add_u32 s44, s44, s66
  v_mfma_f32_16x16x32_bf16 v[4:7], a[40:43], a[8:11], v[4:7]
  s_and_b32 s44, s44, 15
  v_mfma_f32_16x16x32_bf16 v[8:11], a[40:43], a[12:15], v[8:11]
  s_add_u32 s66, s66, 1
  v_mfma_f32_16x16x32_bf16 v[8:11], a[64:67], a[32:35], v[8:11]
  s_mul_i32 s45, s44, s61
  v_mfma_f32_16x16x32_bf16 v[12:15], a[64:67], a[36:39], v[12:15]
  s_add_u32 s68, s45, s59
  v_mfma_f32_16x16x32_bf16 v[12:15], a[40:43], a[16:19], v[12:15]
  s_mul_i32 s45, s44, 393216
  v_mfma_f32_16x16x32_bf16 v[28:31], a[44:47], a[16:19], v[28:31]
  s_add_u32 s69, s45, s60
  v_mfma_f32_16x16x32_bf16 v[28:31], a[68:71], a[36:39], v[28:31]
  s_add_u32 s70, s69, 4096
  v_mfma_f32_16x16x32_bf16 v[24:27], a[68:71], a[32:35], v[24:27]
  s_lshl_b32 s43, s57, 2
  s_add_u32 s74, s71, s43
  v_mfma_f32_16x16x32_bf16 v[24:27], a[44:47], a[12:15], v[24:27]
  s_sub_u32 s44, s74, 1
  s_cmp_eq_u32 s57, 0
  s_cselect_b32 s44, s72, s44
  v_mfma_f32_16x16x32_bf16 v[20:23], a[44:47], a[8:11], v[20:23]
  s_waitcnt vmcnt(11) lgkmcnt(0)
  s_barrier
  ds_read_b64_tr_b16 a[128:129], v116 offset:24576
  v_mfma_f32_16x16x32_bf16 v[20:23], a[68:71], a[28:31], v[20:23]
  ds_read_b64_tr_b16 a[130:131], v116 offset:30720
  s_add_u32 m0, s62, 73728
  v_mfma_f32_16x16x32_bf16 v[16:19], a[68:71], a[24:27], v[16:19]
  ds_read_b64_tr_b16 a[152:153], v116 offset:36864
  buffer_load_dwordx4 v120, s[28:31], s68 offen offset:0 sc1 lds
  v_mfma_f32_16x16x32_bf16 v[16:19], a[44:47], a[4:7], v[16:19]
  ds_read_b64_tr_b16 a[154:155], v116 offset:43008
  s_add_u32 s45, s42, 27262976
  v_mfma_f32_16x16x32_bf16 v[32:35], a[48:51], a[0:3], v[32:35]
  ds_read_b128 a[92:95], v112 offset:16384
  s_lshl_b32 s44, s44, 11
  v_mfma_f32_16x16x32_bf16 v[32:35], a[72:75], a[20:23], v[32:35]
  ds_read_b128 a[112:115], v113 offset:16384
  s_add_u32 s77, s44, s45
  v_mfma_f32_16x16x32_bf16 v[36:39], a[72:75], a[24:27], v[36:39]
  ds_read_b128 a[96:99], v112 offset:18432
  buffer_load_dwordx4 v121, s[28:31], s68 offen offset:1024 sc1 lds
  v_mfma_f32_16x16x32_bf16 v[36:39], a[48:51], a[4:7], v[36:39]
  ds_read_b128 a[116:119], v113 offset:18432
  s_lshl_b32 s44, s74, 11
  v_mfma_f32_16x16x32_bf16 v[40:43], a[48:51], a[8:11], v[40:43]
  ds_read_b128 a[100:103], v112 offset:20480
  s_add_u32 s78, s44, s45
  v_mfma_f32_16x16x32_bf16 v[40:43], a[72:75], a[28:31], v[40:43]
  ds_read_b128 a[120:123], v113 offset:20480
  s_add_u32 s79, s78, 4096
  v_mfma_f32_16x16x32_bf16 v[44:47], a[72:75], a[32:35], v[44:47]
  ds_read_b128 a[104:107], v112 offset:22528
  buffer_load_dwordx4 v122, s[28:31], s68 offen offset:2048 sc1 lds
  v_mfma_f32_16x16x32_bf16 v[44:47], a[48:51], a[12:15], v[44:47]
  ds_read_b128 a[124:127], v113 offset:22528
  s_lshl_b32 s43, s51, 1
  v_mfma_f32_16x16x32_bf16 v[48:51], a[48:51], a[16:19], v[48:51]
  ds_read_b64_tr_b16 a[132:133], v117 offset:24576
  s_add_u32 s75, s43, s58
  v_mfma_f32_16x16x32_bf16 v[48:51], a[72:75], a[36:39], v[48:51]
  ds_read_b64_tr_b16 a[134:135], v117 offset:30720
  s_lshl_b32 s43, s75, 7
  v_mfma_f32_16x16x32_bf16 v[68:71], a[76:79], a[36:39], v[68:71]
  ds_read_b64_tr_b16 a[156:157], v117 offset:36864
  buffer_load_dwordx4 v123, s[28:31], s68 offen offset:3072 sc1 lds
  v_mfma_f32_16x16x32_bf16 v[68:71], a[52:55], a[16:19], v[68:71]
  ds_read_b64_tr_b16 a[158:159], v117 offset:43008
  s_add_u32 s46, s43, 27852800
  v_mfma_f32_16x16x32_bf16 v[64:67], a[52:55], a[12:15], v[64:67]
  ds_read_b128 a[88:91], v114
  v_add_u32 v114, s64, v114
  v_mfma_f32_16x16x32_bf16 v[64:67], a[76:79], a[32:35], v[64:67]
  ds_read_b128 a[108:111], v115
  v_add_u32 v115, s64, v115
  s_add_u32 m0, s63, 0
  v_mfma_f32_16x16x32_bf16 v[60:63], a[76:79], a[28:31], v[60:63]
  ds_read_b64_tr_b16 a[136:137], v116 offset:26624
  buffer_load_dwordx4 v124, s[8:11], s69 offen offset:0 lds
  v_mfma_f32_16x16x32_bf16 v[60:63], a[52:55], a[8:11], v[60:63]
  ds_read_b64_tr_b16 a[138:139], v116 offset:32768
  v_mfma_f32_16x16x32_bf16 v[56:59], a[52:55], a[4:7], v[56:59]
  ds_read_b64_tr_b16 a[160:161], v116 offset:38912
  v_mfma_f32_16x16x32_bf16 v[56:59], a[76:79], a[24:27], v[56:59]
  ds_read_b64_tr_b16 a[162:163], v116 offset:45056
  v_mfma_f32_16x16x32_bf16 v[52:55], a[76:79], a[20:23], v[52:55]
  ds_read_b64_tr_b16 a[140:141], v117 offset:26624
  buffer_load_dwordx4 v125, s[8:11], s69 offen offset:1024 lds
  v_mfma_f32_16x16x32_bf16 v[52:55], a[52:55], a[0:3], v[52:55]
  ds_read_b64_tr_b16 a[142:143], v117 offset:32768
  v_mfma_f32_16x16x32_bf16 v[72:75], a[0:3], a[56:59], v[72:75]
  ds_read_b64_tr_b16 a[164:165], v117 offset:38912
  v_lshlrev_b32 v121, 3, v253
  v_mfma_f32_16x16x32_bf16 v[72:75], a[20:23], a[80:83], v[72:75]
  ds_read_b64_tr_b16 a[166:167], v117 offset:45056
  v_lshrrev_b32 v122, 3, v253
  v_mfma_f32_16x16x32_bf16 v[76:79], a[24:27], a[80:83], v[76:79]
  ds_read_b64_tr_b16 a[144:145], v116 offset:28672
  buffer_load_dwordx4 v124, s[8:11], s69 offen offset:2048 lds
  v_mfma_f32_16x16x32_bf16 v[76:79], a[4:7], a[56:59], v[76:79]
  ds_read_b64_tr_b16 a[146:147], v116 offset:34816
  v_and_b32 v123, 7, v253
  v_mfma_f32_16x16x32_bf16 v[80:83], a[8:11], a[56:59], v[80:83]
  ds_read_b64_tr_b16 a[168:169], v116 offset:40960
  v_lshlrev_b32 v122, 12, v122
  v_mfma_f32_16x16x32_bf16 v[80:83], a[28:31], a[80:83], v[80:83]
  ds_read_b64_tr_b16 a[170:171], v116 offset:47104
  v_lshl_add_u32 v122, v123, 4, v122
  v_mfma_f32_16x16x32_bf16 v[84:87], a[32:35], a[80:83], v[84:87]
  ds_read_b64_tr_b16 a[148:149], v117 offset:28672
  buffer_load_dwordx4 v125, s[8:11], s69 offen offset:3072 lds
  v_mfma_f32_16x16x32_bf16 v[84:87], a[12:15], a[56:59], v[84:87]
  ds_read_b64_tr_b16 a[150:151], v117 offset:34816
  v_lshlrev_b32 v120, 4, v253
  v_mfma_f32_16x16x32_bf16 v[88:91], a[16:19], a[56:59], v[88:91]
  ds_read_b64_tr_b16 a[172:173], v117 offset:40960
  v_add_u32 v126, s76, v120
  v_mfma_f32_16x16x32_bf16 v[88:91], a[36:39], a[80:83], v[88:91]
  ds_read_b64_tr_b16 a[174:175], v117 offset:47104
  s_add_u32 m0, s63, 4096
  v_mfma_f32_16x16x32_bf16 v[108:111], a[36:39], a[84:87], v[108:111]
  buffer_load_dwordx4 v124, s[8:11], s70 offen offset:0 lds
  v_mfma_f32_16x16x32_bf16 v[108:111], a[16:19], a[60:63], v[108:111]
  s_waitcnt vmcnt(9)
  v_cmp_gt_u32 vcc, 128, v127
  s_cbranch_vccz Lcdn5
  s_mov_b32 s43, 0x40000
Lchk4:
  s_sleep 8
  buffer_load_dword v127, v187, s[36:39], 0 offen sc1
  s_waitcnt vmcnt(0)
  v_cmp_gt_u32 vcc, 128, v127
  s_cbranch_vccz Lcdn5
  s_sub_u32 s43, s43, 1
  s_cmp_lg_u32 s43, 0
  s_cbranch_scc1 Lchk4
Lcdn5:
  v_mfma_f32_16x16x32_bf16 v[104:107], a[12:15], a[60:63], v[104:107]
  buffer_load_dwordx4 v[200:203], v122, s[4:7], s46 offen sc1
  s_add_u32 s46, s46, 12288
  v_mfma_f32_16x16x32_bf16 v[104:107], a[32:35], a[84:87], v[104:107]
  v_mfma_f32_16x16x32_bf16 v[100:103], a[28:31], a[84:87], v[100:103]
  buffer_load_dwordx4 v125, s[8:11], s70 offen offset:1024 lds
  v_mfma_f32_16x16x32_bf16 v[100:103], a[8:11], a[60:63], v[100:103]
  buffer_load_dwordx4 v[204:207], v122, s[4:7], s46 offen sc1
  s_add_u32 s46, s46, 12288
  v_mfma_f32_16x16x32_bf16 v[96:99], a[4:7], a[60:63], v[96:99]
  v_mfma_f32_16x16x32_bf16 v[96:99], a[24:27], a[84:87], v[96:99]
  buffer_load_dwordx4 v[208:211], v122, s[4:7], s46 offen sc1
  s_add_u32 s46, s46, 12288
  v_mfma_f32_16x16x32_bf16 v[92:95], a[20:23], a[84:87], v[92:95]
  v_mfma_f32_16x16x32_bf16 v[92:95], a[0:3], a[60:63], v[92:95]
  buffer_load_dwordx4 v[212:215], v122, s[4:7], s46 offen sc1
  s_add_u32 s46, s46, 12288
  s_waitcnt lgkmcnt(15)
  v_mfma_f32_16x16x32_bf16 v[0:3], a[128:131], a[92:95], v[0:3]
  s_lshl_b32 s88, s53, 7
  s_lshl_b32 s92, s40, 14
  v_mfma_f32_16x16x32_bf16 v[0:3], a[152:155], a[112:115], v[0:3]
  buffer_load_dwordx2 v[128:129], v121, s[4:7], s77 offen offset:0 sc1
  s_add_u32 s88, s88, s92
  v_mfma_f32_16x16x32_bf16 v[4:7], a[152:155], a[116:119], v[4:7]
  s_lshl_b32 s89, s40, 10
  s_and_b32 s92, s52, 3
  v_mfma_f32_16x16x32_bf16 v[4:7], a[128:131], a[96:99], v[4:7]
  buffer_load_dwordx2 v[130:131], v121, s[4:7], s77 offen offset:512 sc1
  s_lshl_b32 s91, s92, 19
  v_mfma_f32_16x16x32_bf16 v[8:11], a[128:131], a[100:103], v[8:11]
  v_add_u32 v186, s88, v252
  s_mul_i32 s92, s92, 0
  v_mfma_f32_16x16x32_bf16 v[8:11], a[152:155], a[120:123], v[8:11]
  buffer_load_dwordx2 v[132:133], v121, s[4:7], s77 offen offset:1024 sc1
  s_and_b32 s93, s53, 7
  v_mfma_f32_16x16x32_bf16 v[12:15], a[152:155], a[124:127], v[12:15]
  s_add_u32 s92, s92, s93
  s_cmp_ge_u32 s92, 8
  s_cselect_b32 s93, 8, 0
  s_sub_u32 s92, s92, s93
  v_mfma_f32_16x16x32_bf16 v[12:15], a[128:131], a[104:107], v[12:15]
  buffer_load_dwordx2 v[134:135], v121, s[4:7], s77 offen offset:1536 sc1
  s_cmp_ge_u32 s92, 8
  s_cselect_b32 s93, 8, 0
  s_sub_u32 s92, s92, s93
  v_mfma_f32_16x16x32_bf16 v[28:31], a[132:135], a[104:107], v[28:31]
  s_lshl_b32 s93, 1, s92
  s_lshr_b32 s92, s93, 8
  v_mfma_f32_16x16x32_bf16 v[28:31], a[156:159], a[124:127], v[28:31]
  buffer_load_dwordx2 v[136:137], v121, s[4:7], s78 offen offset:0 sc1
  s_or_b32 s93, s93, s92
  v_mfma_f32_16x16x32_bf16 v[24:27], a[156:159], a[120:123], v[24:27]
  s_bitcmp1_b32 s93, 0
  s_cselect_b32 s80, 524288, 0
  s_bitcmp1_b32 s93, 1
  s_cselect_b32 s81, 524288, 0
  v_mfma_f32_16x16x32_bf16 v[24:27], a[132:135], a[100:103], v[24:27]
  buffer_load_dwordx2 v[138:139], v121, s[4:7], s78 offen offset:512 sc1
  s_bitcmp1_b32 s93, 2
  s_cselect_b32 s82, 524288, 0
  v_mfma_f32_16x16x32_bf16 v[20:23], a[132:135], a[96:99], v[20:23]
  s_waitcnt lgkmcnt(0)
  s_barrier
  ds_read_b64_tr_b16 a[40:41], v118 offset:0
  v_mfma_f32_16x16x32_bf16 v[20:23], a[156:159], a[116:119], v[20:23]
  ds_read_b64_tr_b16 a[42:43], v118 offset:6144
  buffer_load_dwordx2 v[140:141], v121, s[4:7], s78 offen offset:1024 sc1
  v_mfma_f32_16x16x32_bf16 v[16:19], a[156:159], a[112:115], v[16:19]
  ds_read_b64_tr_b16 a[64:65], v118 offset:12288
  s_bitcmp1_b32 s93, 3
  s_cselect_b32 s83, 524288, 0
  v_mfma_f32_16x16x32_bf16 v[16:19], a[132:135], a[92:95], v[16:19]
  ds_read_b64_tr_b16 a[66:67], v118 offset:18432
  buffer_load_dwordx2 v[142:143], v121, s[4:7], s78 offen offset:1536 sc1
  v_mfma_f32_16x16x32_bf16 v[32:35], a[136:139], a[88:91], v[32:35]
  ds_read_b128 a[4:7], v112 offset:32768
  s_bitcmp1_b32 s93, 4
  s_cselect_b32 s84, 524288, 0
  v_mfma_f32_16x16x32_bf16 v[32:35], a[160:163], a[108:111], v[32:35]
  ds_read_b128 a[24:27], v113 offset:32768
  buffer_load_dwordx2 v[144:145], v121, s[4:7], s78 offen offset:2048 sc1
  v_mfma_f32_16x16x32_bf16 v[36:39], a[160:163], a[112:115], v[36:39]
  ds_read_b128 a[8:11], v112 offset:34816
  s_bitcmp1_b32 s93, 5
  s_cselect_b32 s85, 524288, 0
  v_mfma_f32_16x16x32_bf16 v[36:39], a[136:139], a[92:95], v[36:39]
  ds_read_b128 a[28:31], v113 offset:34816
  buffer_load_dwordx2 v[146:147], v121, s[4:7], s78 offen offset:2560 sc1
  v_mfma_f32_16x16x32_bf16 v[40:43], a[136:139], a[96:99], v[40:43]
  ds_read_b128 a[12:15], v112 offset:36864
  s_bitcmp1_b32 s93, 6
  s_cselect_b32 s86, 524288, 0
  v_mfma_f32_16x16x32_bf16 v[40:43], a[160:163], a[116:119], v[40:43]
  ds_read_b128 a[32:35], v113 offset:36864
  buffer_load_dwordx2 v[148:149], v121, s[4:7], s78 offen offset:3072 sc1
  v_mfma_f32_16x16x32_bf16 v[44:47], a[160:163], a[120:123], v[44:47]
  ds_read_b128 a[16:19], v112 offset:38912
  s_bitcmp1_b32 s93, 7
  s_cselect_b32 s87, 524288, 0
  v_mfma_f32_16x16x32_bf16 v[44:47], a[136:139], a[100:103], v[44:47]
  ds_read_b128 a[36:39], v113 offset:38912
  buffer_load_dwordx2 v[150:151], v121, s[4:7], s78 offen offset:3584 sc1
  v_mfma_f32_16x16x32_bf16 v[48:51], a[136:139], a[104:107], v[48:51]
  ds_read_b64_tr_b16 a[44:45], v119 offset:0
  v_mfma_f32_16x16x32_bf16 v[48:51], a[160:163], a[124:127], v[48:51]
  ds_read_b64_tr_b16 a[46:47], v119 offset:6144
  buffer_load_dwordx2 v[152:153], v121, s[4:7], s79 offen offset:0 sc1
  v_mfma_f32_16x16x32_bf16 v[68:71], a[164:167], a[124:127], v[68:71]
  ds_read_b64_tr_b16 a[68:69], v119 offset:12288
  v_mfma_f32_16x16x32_bf16 v[68:71], a[140:143], a[104:107], v[68:71]
  ds_read_b64_tr_b16 a[70:71], v119 offset:18432
  buffer_load_dwordx2 v[154:155], v121, s[4:7], s79 offen offset:512 sc1
  v_mfma_f32_16x16x32_bf16 v[64:67], a[140:143], a[100:103], v[64:67]
  ds_read_b128 a[0:3], v114
  v_add_u32 v114, s65, v114
  v_mfma_f32_16x16x32_bf16 v[64:67], a[164:167], a[120:123], v[64:67]
  ds_read_b128 a[20:23], v115
  v_add_u32 v115, s65, v115
  buffer_load_dwordx2 v[156:157], v121, s[4:7], s79 offen offset:1024 sc1
  v_mfma_f32_16x16x32_bf16 v[60:63], a[164:167], a[116:119], v[60:63]
  ds_read_b64_tr_b16 a[48:49], v118 offset:2048
  s_lshl_b32 s44, s2, 2
  v_mfma_f32_16x16x32_bf16 v[60:63], a[140:143], a[96:99], v[60:63]
  ds_read_b64_tr_b16 a[50:51], v118 offset:8192
  buffer_load_dwordx2 v[158:159], v121, s[4:7], s79 offen offset:1536 sc1
  v_mfma_f32_16x16x32_bf16 v[56:59], a[140:143], a[92:95], v[56:59]
  ds_read_b64_tr_b16 a[72:73], v118 offset:14336
  s_add_u32 s44, s44, s40
  v_mfma_f32_16x16x32_bf16 v[56:59], a[164:167], a[112:115], v[56:59]
  ds_read_b64_tr_b16 a[74:75], v118 offset:20480
  buffer_load_dwordx2 v[160:161], v121, s[4:7], s79 offen offset:2048 sc1
  v_mfma_f32_16x16x32_bf16 v[52:55], a[164:167], a[108:111], v[52:55]
  ds_read_b64_tr_b16 a[52:53], v119 offset:2048
  s_lshl_b32 s44, s44, 12
  v_mfma_f32_16x16x32_bf16 v[52:55], a[140:143], a[88:91], v[52:55]
  ds_read_b64_tr_b16 a[54:55], v119 offset:8192
  buffer_load_dwordx2 v[162:163], v121, s[4:7], s79 offen offset:2560 sc1
  v_mfma_f32_16x16x32_bf16 v[72:75], a[88:91], a[144:147], v[72:75]
  ds_read_b64_tr_b16 a[76:77], v119 offset:14336
  s_add_u32 s44, s44, s42
  v_mfma_f32_16x16x32_bf16 v[72:75], a[108:111], a[168:171], v[72:75]
  ds_read_b64_tr_b16 a[78:79], v119 offset:20480
  buffer_load_dwordx2 v[164:165], v121, s[4:7], s79 offen offset:3072 sc1
  v_mfma_f32_16x16x32_bf16 v[76:79], a[112:115], a[168:171], v[76:79]
  ds_read_b64_tr_b16 a[56:57], v118 offset:4096
  s_add_u32 s44, s44, 28311552
  v_mfma_f32_16x16x32_bf16 v[76:79], a[92:95], a[144:147], v[76:79]
  ds_read_b64_tr_b16 a[58:59], v118 offset:10240
  buffer_load_dwordx2 v[166:167], v121, s[4:7], s79 offen offset:3584 sc1
  v_mfma_f32_16x16x32_bf16 v[80:83], a[96:99], a[144:147], v[80:83]
  ds_read_b64_tr_b16 a[80:81], v118 offset:16384
  v_mov_b32 v240, -1
  v_mfma_f32_16x16x32_bf16 v[80:83], a[116:119], a[168:171], v[80:83]
  ds_read_b64_tr_b16 a[82:83], v118 offset:22528
  v_mov_b32 v241, -1
  v_mfma_f32_16x16x32_bf16 v[84:87], a[120:123], a[168:171], v[84:87]
  ds_read_b64_tr_b16 a[60:61], v119 offset:4096
  v_mov_b32 v242, -1
  v_mfma_f32_16x16x32_bf16 v[84:87], a[100:103], a[144:147], v[84:87]
  ds_read_b64_tr_b16 a[62:63], v119 offset:10240
  v_mov_b32 v243, -1
  v_mfma_f32_16x16x32_bf16 v[88:91], a[104:107], a[144:147], v[88:91]
  ds_read_b64_tr_b16 a[84:85], v119 offset:16384
  buffer_store_dwordx4 v[240:243], v120, s[4:7], s44 offen offset:0 sc1
  v_mfma_f32_16x16x32_bf16 v[88:91], a[124:127], a[168:171], v[88:91]
  ds_read_b64_tr_b16 a[86:87], v119 offset:22528
  buffer_store_dwordx4 v[240:243], v120, s[4:7], s44 offen offset:1024 sc1
  v_mfma_f32_16x16x32_bf16 v[108:111], a[124:127], a[172:175], v[108:111]
  buffer_store_dwordx4 v[240:243], v120, s[4:7], s44 offen offset:2048 sc1
  buffer_store_dwordx4 v[240:243], v120, s[4:7], s44 offen offset:3072 sc1
  v_mfma_f32_16x16x32_bf16 v[108:111], a[104:107], a[148:151], v[108:111]
  v_mfma_f32_16x16x32_bf16 v[104:107], a[100:103], a[148:151], v[104:107]
  v_lshrrev_b32 v124, 4, v253
  v_lshlrev_b32 v124, 4, v124
  v_mfma_f32_16x16x32_bf16 v[104:107], a[120:123], a[172:175], v[104:107]
  v_and_b32 v125, 15, v253
  v_lshlrev_b32 v125, 2, v125
  v_mfma_f32_16x16x32_bf16 v[100:103], a[116:119], a[172:175], v[100:103]
  v_add_u32 v124, s76, v124
  v_add_u32 v125, s76, v125
  v_mfma_f32_16x16x32_bf16 v[100:103], a[96:99], a[148:151], v[100:103]
  v_add_u32 v123, 149504, v120
  s_waitcnt vmcnt(24)
  v_mfma_f32_16x16x32_bf16 v[96:99], a[92:95], a[148:151], v[96:99]
  v_add_f32 v200, v200, v204
  v_add_f32 v208, v208, v212
  v_mfma_f32_16x16x32_bf16 v[96:99], a[112:115], a[172:175], v[96:99]
  v_add_f32 v201, v201, v205
  v_add_f32 v209, v209, v213
  v_mfma_f32_16x16x32_bf16 v[92:95], a[108:111], a[172:175], v[92:95]
  v_add_f32 v202, v202, v206
  v_add_f32 v210, v210, v214
  v_mfma_f32_16x16x32_bf16 v[92:95], a[88:91], a[148:151], v[92:95]
  v_add_f32 v203, v203, v207
  v_add_f32 v211, v211, v215
  s_waitcnt lgkmcnt(15)
  v_mfma_f32_16x16x32_bf16 v[0:3], a[40:43], a[4:7], v[0:3]
  v_add_f32 v200, v200, v208
  v_add_f32 v201, v201, v209
  v_mfma_f32_16x16x32_bf16 v[0:3], a[64:67], a[24:27], v[0:3]
  v_add_f32 v202, v202, v210
  v_add_f32 v203, v203, v211
  v_mfma_f32_16x16x32_bf16 v[4:7], a[64:67], a[28:31], v[4:7]
  ds_write_b128 v126, v[200:203] offset:1024
  ds_read_b128 v[168:171], v124 offset:1024
  v_mfma_f32_16x16x32_bf16 v[4:7], a[40:43], a[8:11], v[4:7]
  ds_read_b128 v[172:175], v124 offset:1088
  ds_read_b128 v[176:179], v124 offset:1152
  v_mfma_f32_16x16x32_bf16 v[8:11], a[40:43], a[12:15], v[8:11]
  ds_read_b128 v[180:183], v124 offset:1216
  ds_read_b32 v184, v125 offset:1280
  v_mfma_f32_16x16x32_bf16 v[8:11], a[64:67], a[32:35], v[8:11]
  ds_read_b32 v185, v125 offset:1344
  s_waitcnt vmcnt(20)
  v_mfma_f32_16x16x32_bf16 v[12:15], a[64:67], a[36:39], v[12:15]
  v_add_f32 v128, v128, v130
  v_add_f32 v129, v129, v131
  v_mfma_f32_16x16x32_bf16 v[12:15], a[40:43], a[16:19], v[12:15]
  v_add_f32 v132, v132, v134
  v_add_f32 v133, v133, v135
  v_mfma_f32_16x16x32_bf16 v[28:31], a[44:47], a[16:19], v[28:31]
  v_add_f32 v188, v128, v132
  v_add_f32 v194, v129, v133
  v_mfma_f32_16x16x32_bf16 v[28:31], a[68:71], a[36:39], v[28:31]
  s_waitcnt vmcnt(16)
  v_add_f32 v136, v136, v138
  v_mfma_f32_16x16x32_bf16 v[24:27], a[68:71], a[32:35], v[24:27]
  v_add_f32 v137, v137, v139
  v_add_f32 v140, v140, v142
  v_mfma_f32_16x16x32_bf16 v[24:27], a[44:47], a[12:15], v[24:27]
  v_add_f32 v141, v141, v143
  v_add_f32 v189, v136, v140
  v_mfma_f32_16x16x32_bf16 v[20:23], a[44:47], a[8:11], v[20:23]
  s_waitcnt lgkmcnt(0)
  s_barrier
  ds_read_b64_tr_b16 a[128:129], v116 offset:0
  v_mfma_f32_16x16x32_bf16 v[20:23], a[68:71], a[28:31], v[20:23]
  ds_read_b64_tr_b16 a[130:131], v116 offset:6144
  v_add_f32 v195, v137, v141
  v_mfma_f32_16x16x32_bf16 v[16:19], a[68:71], a[24:27], v[16:19]
  ds_read_b64_tr_b16 a[152:153], v116 offset:12288
  s_waitcnt vmcnt(12)
  v_mfma_f32_16x16x32_bf16 v[16:19], a[44:47], a[4:7], v[16:19]
  ds_read_b64_tr_b16 a[154:155], v116 offset:18432
  v_add_f32 v144, v144, v146
  v_mfma_f32_16x16x32_bf16 v[32:35], a[48:51], a[0:3], v[32:35]
  ds_read_b128 a[92:95], v112 offset:0
  v_add_f32 v145, v145, v147
  v_mfma_f32_16x16x32_bf16 v[32:35], a[72:75], a[20:23], v[32:35]
  ds_read_b128 a[112:115], v113 offset:0
  v_add_f32 v148, v148, v150
  v_mfma_f32_16x16x32_bf16 v[36:39], a[72:75], a[24:27], v[36:39]
  ds_read_b128 a[96:99], v112 offset:2048
  v_add_f32 v149, v149, v151
  v_mfma_f32_16x16x32_bf16 v[36:39], a[48:51], a[4:7], v[36:39]
  ds_read_b128 a[116:119], v113 offset:2048
  v_add_f32 v190, v144, v148
  v_mfma_f32_16x16x32_bf16 v[40:43], a[48:51], a[8:11], v[40:43]
  ds_read_b128 a[100:103], v112 offset:4096
  v_add_f32 v196, v145, v149
  v_mfma_f32_16x16x32_bf16 v[40:43], a[72:75], a[28:31], v[40:43]
  ds_read_b128 a[120:123], v113 offset:4096
  s_waitcnt vmcnt(8)
  v_mfma_f32_16x16x32_bf16 v[44:47], a[72:75], a[32:35], v[44:47]
  ds_read_b128 a[104:107], v112 offset:6144
  v_add_f32 v152, v152, v154
  v_mfma_f32_16x16x32_bf16 v[44:47], a[48:51], a[12:15], v[44:47]
  ds_read_b128 a[124:127], v113 offset:6144
  v_add_f32 v153, v153, v155
  v_mfma_f32_16x16x32_bf16 v[48:51], a[48:51], a[16:19], v[48:51]
  ds_read_b64_tr_b16 a[132:133], v117 offset:0
  v_add_f32 v156, v156, v158
  v_mfma_f32_16x16x32_bf16 v[48:51], a[72:75], a[36:39], v[48:51]
  ds_read_b64_tr_b16 a[134:135], v117 offset:6144
  v_add_f32 v157, v157, v159
  v_mfma_f32_16x16x32_bf16 v[68:71], a[76:79], a[36:39], v[68:71]
  ds_read_b64_tr_b16 a[156:157], v117 offset:12288
  v_add_f32 v191, v152, v156
  v_mfma_f32_16x16x32_bf16 v[68:71], a[52:55], a[16:19], v[68:71]
  ds_read_b64_tr_b16 a[158:159], v117 offset:18432
  v_add_f32 v197, v153, v157
  v_mfma_f32_16x16x32_bf16 v[64:67], a[52:55], a[12:15], v[64:67]
  ds_read_b128 a[88:91], v114
  v_add_u32 v114, s64, v114
  s_waitcnt vmcnt(4)
  v_mfma_f32_16x16x32_bf16 v[64:67], a[76:79], a[32:35], v[64:67]
  ds_read_b128 a[108:111], v115
  v_add_u32 v115, s64, v115
  v_add_f32 v160, v160, v162
  v_mfma_f32_16x16x32_bf16 v[60:63], a[76:79], a[28:31], v[60:63]
  ds_read_b64_tr_b16 a[136:137], v116 offset:2048
  v_add_f32 v161, v161, v163
  v_mfma_f32_16x16x32_bf16 v[60:63], a[52:55], a[8:11], v[60:63]
  ds_read_b64_tr_b16 a[138:139], v116 offset:8192
  v_add_f32 v164, v164, v166
  v_mfma_f32_16x16x32_bf16 v[56:59], a[52:55], a[4:7], v[56:59]
  ds_read_b64_tr_b16 a[160:161], v116 offset:14336
  v_add_f32 v165, v165, v167
  v_mfma_f32_16x16x32_bf16 v[56:59], a[76:79], a[24:27], v[56:59]
  ds_read_b64_tr_b16 a[162:163], v116 offset:20480
  v_add_f32 v192, v160, v164
  v_mfma_f32_16x16x32_bf16 v[52:55], a[76:79], a[20:23], v[52:55]
  ds_read_b64_tr_b16 a[140:141], v117 offset:2048
  v_add_f32 v198, v161, v165
  v_mfma_f32_16x16x32_bf16 v[52:55], a[52:55], a[0:3], v[52:55]
  ds_read_b64_tr_b16 a[142:143], v117 offset:8192
  ds_read_b128 v[128:131], v123
  v_mfma_f32_16x16x32_bf16 v[72:75], a[0:3], a[56:59], v[72:75]
  ds_read_b64_tr_b16 a[164:165], v117 offset:14336
  ds_read_b128 v[132:135], v123 offset:1024
  v_mfma_f32_16x16x32_bf16 v[72:75], a[20:23], a[80:83], v[72:75]
  ds_read_b64_tr_b16 a[166:167], v117 offset:20480
  v_mov_b32 v240, v188
  v_mfma_f32_16x16x32_bf16 v[76:79], a[24:27], a[80:83], v[76:79]
  ds_read_b64_tr_b16 a[144:145], v116 offset:4096
  v_mov_b32 v241, v189
  v_mfma_f32_16x16x32_bf16 v[76:79], a[4:7], a[56:59], v[76:79]
  ds_read_b64_tr_b16 a[146:147], v116 offset:10240
  v_mov_b32 v242, v190
  v_mfma_f32_16x16x32_bf16 v[80:83], a[8:11], a[56:59], v[80:83]
  ds_read_b64_tr_b16 a[168:169], v116 offset:16384
  v_mov_b32 v243, v191
  v_mfma_f32_16x16x32_bf16 v[80:83], a[28:31], a[80:83], v[80:83]
  ds_read_b64_tr_b16 a[170:171], v116 offset:22528
  v_mov_b32 v244, v192
  v_mfma_f32_16x16x32_bf16 v[84:87], a[32:35], a[80:83], v[84:87]
  ds_read_b64_tr_b16 a[148:149], v117 offset:4096
  v_mov_b32 v245, v194
  v_mfma_f32_16x16x32_bf16 v[84:87], a[12:15], a[56:59], v[84:87]
  ds_read_b64_tr_b16 a[150:151], v117 offset:10240
  v_mov_b32 v246, v195
  v_mfma_f32_16x16x32_bf16 v[88:91], a[16:19], a[56:59], v[88:91]
  ds_read_b64_tr_b16 a[172:173], v117 offset:16384
  v_mov_b32 v247, v196
  v_mfma_f32_16x16x32_bf16 v[88:91], a[36:39], a[80:83], v[88:91]
  ds_read_b64_tr_b16 a[174:175], v117 offset:22528
  v_mov_b32 v248, v197
  v_mfma_f32_16x16x32_bf16 v[108:111], a[36:39], a[84:87], v[108:111]
  v_mov_b32 v249, v198
  v_permlane32_swap_b32 v188, v240
  v_mfma_f32_16x16x32_bf16 v[108:111], a[16:19], a[60:63], v[108:111]
  v_permlane32_swap_b32 v189, v241
  v_permlane32_swap_b32 v190, v242
  v_mfma_f32_16x16x32_bf16 v[104:107], a[12:15], a[60:63], v[104:107]
  v_permlane32_swap_b32 v191, v243
  v_permlane32_swap_b32 v192, v244
  v_mfma_f32_16x16x32_bf16 v[104:107], a[32:35], a[84:87], v[104:107]
  v_permlane32_swap_b32 v194, v245
  v_permlane32_swap_b32 v195, v246
  v_mfma_f32_16x16x32_bf16 v[100:103], a[28:31], a[84:87], v[100:103]
  v_permlane32_swap_b32 v196, v247
  v_permlane32_swap_b32 v197, v248
  v_mfma_f32_16x16x32_bf16 v[100:103], a[8:11], a[60:63], v[100:103]
  v_permlane32_swap_b32 v198, v249
  v_add_f32 v188, v188, v240
  v_mfma_f32_16x16x32_bf16 v[96:99], a[4:7], a[60:63], v[96:99]
  v_add_f32 v189, v189, v241
  v_add_f32 v190, v190, v242
  v_mfma_f32_16x16x32_bf16 v[96:99], a[24:27], a[84:87], v[96:99]
  v_add_f32 v191, v191, v243
  v_add_f32 v192, v192, v244
  v_mfma_f32_16x16x32_bf16 v[92:95], a[20:23], a[84:87], v[92:95]
  v_add_f32 v194, v194, v245
  v_add_f32 v195, v195, v246
  v_mfma_f32_16x16x32_bf16 v[92:95], a[0:3], a[60:63], v[92:95]
  v_add_f32 v196, v196, v247
  v_add_f32 v197, v197, v248
  s_waitcnt lgkmcnt(15)
  v_mfma_f32_16x16x32_bf16 v[0:3], a[128:131], a[92:95], v[0:3]
  v_add_f32 v198, v198, v249
  v_mov_b32 v240, v188
  v_mfma_f32_16x16x32_bf16 v[0:3], a[152:155], a[112:115], v[0:3]
  v_mov_b32 v241, v189
  v_mov_b32 v242, v190
  v_mfma_f32_16x16x32_bf16 v[4:7], a[152:155], a[116:119], v[4:7]
  v_mov_b32 v243, v191
  v_mov_b32 v244, v192
  v_mfma_f32_16x16x32_bf16 v[4:7], a[128:131], a[96:99], v[4:7]
  v_mov_b32 v245, v194
  v_mov_b32 v246, v195
  v_mfma_f32_16x16x32_bf16 v[8:11], a[128:131], a[100:103], v[8:11]
  v_mov_b32 v247, v196
  v_mov_b32 v248, v197
  v_mfma_f32_16x16x32_bf16 v[8:11], a[152:155], a[120:123], v[8:11]
  v_mov_b32 v249, v198
  v_permlane16_swap_b32 v188, v240
  v_mfma_f32_16x16x32_bf16 v[12:15], a[152:155], a[124:127], v[12:15]
  v_permlane16_swap_b32 v189, v241
  v_permlane16_swap_b32 v190, v242
  v_mfma_f32_16x16x32_bf16 v[12:15], a[128:131], a[104:107], v[12:15]
  v_permlane16_swap_b32 v191, v243
  v_permlane16_swap_b32 v192, v244
  v_mfma_f32_16x16x32_bf16 v[28:31], a[132:135], a[104:107], v[28:31]
  v_permlane16_swap_b32 v194, v245
  v_permlane16_swap_b32 v195, v246
  v_mfma_f32_16x16x32_bf16 v[28:31], a[156:159], a[124:127], v[28:31]
  v_permlane16_swap_b32 v196, v247
  v_permlane16_swap_b32 v197, v248
  v_mfma_f32_16x16x32_bf16 v[24:27], a[156:159], a[120:123], v[24:27]
  v_permlane16_swap_b32 v198, v249
  v_add_f32 v188, v188, v240
  v_mfma_f32_16x16x32_bf16 v[24:27], a[132:135], a[100:103], v[24:27]
  v_add_f32 v189, v189, v241
  v_add_f32 v190, v190, v242
  v_mfma_f32_16x16x32_bf16 v[20:23], a[132:135], a[96:99], v[20:23]
  s_waitcnt lgkmcnt(0)
  s_barrier
  v_add_f32 v191, v191, v243
  v_mfma_f32_16x16x32_bf16 v[20:23], a[156:159], a[116:119], v[20:23]
  s_add_u32 m0, s89, 0
  v_add_f32 v192, v192, v244
  v_mfma_f32_16x16x32_bf16 v[16:19], a[156:159], a[112:115], v[16:19]
  s_add_u32 s92, s91, s80
  v_add_f32 v194, v194, v245
  v_mfma_f32_16x16x32_bf16 v[16:19], a[132:135], a[92:95], v[16:19]
  s_and_b32 s92, s92, 0x1fffff
  v_add_f32 v195, v195, v246
  v_mfma_f32_16x16x32_bf16 v[32:35], a[136:139], a[88:91], v[32:35]
  buffer_load_dwordx4 v186, s[12:15], s92 offen lds
  v_add_f32 v196, v196, v247
  v_mfma_f32_16x16x32_bf16 v[32:35], a[160:163], a[108:111], v[32:35]
  s_add_u32 s91, s91, 65536
  v_add_f32 v197, v197, v248
  v_mfma_f32_16x16x32_bf16 v[36:39], a[160:163], a[112:115], v[36:39]
  s_add_u32 m0, s89, 4096
  v_add_f32 v198, v198, v249
  v_mfma_f32_16x16x32_bf16 v[36:39], a[136:139], a[92:95], v[36:39]
  s_add_u32 s92, s91, s81
  s_mov_b32 s48, 0x3a800000
  v_mfma_f32_16x16x32_bf16 v[40:43], a[136:139], a[96:99], v[40:43]
  s_and_b32 s92, s92, 0x1fffff
  v_mov_b32 v240, 0x3727c5ac
  v_mfma_f32_16x16x32_bf16 v[40:43], a[160:163], a[116:119], v[40:43]
  buffer_load_dwordx4 v186, s[12:15], s92 offen lds
  v_mul_f32 v188, 0xba800000, v188
  v_mfma_f32_16x16x32_bf16 v[44:47], a[160:163], a[120:123], v[44:47]
  s_add_u32 s91, s91, 65536
  v_fma_f32 v194, v194, s48, v240
  v_mfma_f32_16x16x32_bf16 v[44:47], a[136:139], a[100:103], v[44:47]
  s_add_u32 m0, s89, 8192
  v_fma_f32 v194, -v188, v188, v194
  v_mfma_f32_16x16x32_bf16 v[48:51], a[136:139], a[104:107], v[48:51]
  s_add_u32 s92, s91, s82
  v_max_f32 v194, v194, v240
  v_mfma_f32_16x16x32_bf16 v[48:51], a[160:163], a[124:127], v[48:51]
  s_and_b32 s92, s92, 0x1fffff
  v_rsq_f32 v194, v194
  v_mfma_f32_16x16x32_bf16 v[68:71], a[164:167], a[124:127], v[68:71]
  buffer_load_dwordx4 v186, s[12:15], s92 offen lds
  ds_write_b32 v125, v188 offset:0
  v_mfma_f32_16x16x32_bf16 v[68:71], a[140:143], a[104:107], v[68:71]
  s_add_u32 s91, s91, 65536
  ds_write_b32 v125, v194 offset:64
  v_mfma_f32_16x16x32_bf16 v[64:67], a[140:143], a[100:103], v[64:67]
  s_add_u32 m0, s89, 12288
  v_mul_f32 v189, 0xba800000, v189
  v_mfma_f32_16x16x32_bf16 v[64:67], a[164:167], a[120:123], v[64:67]
  s_add_u32 s92, s91, s83
  v_fma_f32 v195, v195, s48, v240
  v_mfma_f32_16x16x32_bf16 v[60:63], a[164:167], a[116:119], v[60:63]
  s_and_b32 s92, s92, 0x1fffff
  v_fma_f32 v195, -v189, v189, v195
  v_mfma_f32_16x16x32_bf16 v[60:63], a[140:143], a[96:99], v[60:63]
  buffer_load_dwordx4 v186, s[12:15], s92 offen lds
  v_max_f32 v195, v195, v240
  v_mfma_f32_16x16x32_bf16 v[56:59], a[140:143], a[92:95], v[56:59]
  s_add_u32 s91, s91, 65536
  v_rsq_f32 v195, v195
  v_mfma_f32_16x16x32_bf16 v[56:59], a[164:167], a[112:115], v[56:59]
  s_add_u32 m0, s89, 16384
  ds_write_b32 v125, v189 offset:128
  v_mfma_f32_16x16x32_bf16 v[52:55], a[164:167], a[108:111], v[52:55]
  s_add_u32 s92, s91, s84
  ds_write_b32 v125, v195 offset:192
  v_mfma_f32_16x16x32_bf16 v[52:55], a[140:143], a[88:91], v[52:55]
  s_and_b32 s92, s92, 0x1fffff
  v_mul_f32 v190, 0xba800000, v190
  v_mfma_f32_16x16x32_bf16 v[72:75], a[88:91], a[144:147], v[72:75]
  buffer_load_dwordx4 v186, s[12:15], s92 offen lds
  v_fma_f32 v196, v196, s48, v240
  v_mfma_f32_16x16x32_bf16 v[72:75], a[108:111], a[168:171], v[72:75]
  s_add_u32 s91, s91, 65536
  v_fma_f32 v196, -v190, v190, v196
  v_mfma_f32_16x16x32_bf16 v[76:79], a[112:115], a[168:171], v[76:79]
  s_add_u32 m0, s89, 20480
  v_max_f32 v196, v196, v240
  v_mfma_f32_16x16x32_bf16 v[76:79], a[92:95], a[144:147], v[76:79]
  s_add_u32 s92, s91, s85
  v_rsq_f32 v196, v196
  v_mfma_f32_16x16x32_bf16 v[80:83], a[96:99], a[144:147], v[80:83]
  s_and_b32 s92, s92, 0x1fffff
  ds_write_b32 v125, v190 offset:256
  v_mfma_f32_16x16x32_bf16 v[80:83], a[116:119], a[168:171], v[80:83]
  buffer_load_dwordx4 v186, s[12:15], s92 offen lds
  ds_write_b32 v125, v196 offset:320
  v_mfma_f32_16x16x32_bf16 v[84:87], a[120:123], a[168:171], v[84:87]
  s_add_u32 s91, s91, 65536
  v_mul_f32 v191, 0xba800000, v191
  v_mfma_f32_16x16x32_bf16 v[84:87], a[100:103], a[144:147], v[84:87]
  s_add_u32 m0, s89, 24576
  v_fma_f32 v197, v197, s48, v240
  v_mfma_f32_16x16x32_bf16 v[88:91], a[104:107], a[144:147], v[88:91]
  s_add_u32 s92, s91, s86
  v_fma_f32 v197, -v191, v191, v197
  v_mfma_f32_16x16x32_bf16 v[88:91], a[124:127], a[168:171], v[88:91]
  s_and_b32 s92, s92, 0x1fffff
  v_max_f32 v197, v197, v240
  v_mfma_f32_16x16x32_bf16 v[108:111], a[124:127], a[172:175], v[108:111]
  buffer_load_dwordx4 v186, s[12:15], s92 offen lds
  v_rsq_f32 v197, v197
  v_mfma_f32_16x16x32_bf16 v[108:111], a[104:107], a[148:151], v[108:111]
  s_add_u32 s91, s91, 65536
  ds_write_b32 v125, v191 offset:384
  v_mfma_f32_16x16x32_bf16 v[104:107], a[100:103], a[148:151], v[104:107]
  s_add_u32 m0, s89, 28672
  ds_write_b32 v125, v197 offset:448
  v_mfma_f32_16x16x32_bf16 v[104:107], a[120:123], a[172:175], v[104:107]
  s_add_u32 s92, s91, s87
  v_mul_f32 v192, 0xba800000, v192
  v_mfma_f32_16x16x32_bf16 v[100:103], a[116:119], a[172:175], v[100:103]
  s_and_b32 s92, s92, 0x1fffff
  v_fma_f32 v198, v198, s48, v240
  v_mfma_f32_16x16x32_bf16 v[100:103], a[96:99], a[148:151], v[100:103]
  buffer_load_dwordx4 v186, s[12:15], s92 offen lds
  v_fma_f32 v198, -v192, v192, v198
  v_mfma_f32_16x16x32_bf16 v[96:99], a[92:95], a[148:151], v[96:99]
  s_add_u32 s91, s91, 65536
  v_max_f32 v198, v198, v240
  v_mfma_f32_16x16x32_bf16 v[96:99], a[112:115], a[172:175], v[96:99]
  v_rsq_f32 v198, v198
  ds_write_b32 v125, v192 offset:512
  v_mfma_f32_16x16x32_bf16 v[92:95], a[108:111], a[172:175], v[92:95]
  ds_write_b32 v125, v198 offset:576
  ds_read_b128 v[200:203], v124 offset:0
  v_mfma_f32_16x16x32_bf16 v[92:95], a[88:91], a[148:151], v[92:95]
  ds_read_b128 v[220:223], v124 offset:64
  ds_read_b128 v[204:207], v124 offset:128
  ds_read_b128 v[224:227], v124 offset:192
  ds_read_b128 v[208:211], v124 offset:256
  ds_read_b128 v[228:231], v124 offset:320
  ds_read_b128 v[212:215], v124 offset:384
  ds_read_b128 v[232:235], v124 offset:448
  ds_read_b128 v[216:219], v124 offset:512
  ds_read_b128 v[236:239], v124 offset:576
  s_and_b32 s43, s50, 7
  s_or_b32 s43, s43, s57
  s_cselect_b64 s[46:47], -1, 0
  v_mov_b32 v245, 0xf149f2ca
  v_cndmask_b32 v136, v245, v132, s[46:47]
  v_mov_b32 v160, 0x3f803f80
  v_cndmask_b32 v137, v245, v133, s[46:47]
  v_mov_b32 v161, 0x3f803f80
  v_cndmask_b32 v138, v245, v134, s[46:47]
  v_mov_b32 v162, 0x3f803f80
  v_cndmask_b32 v139, v245, v135, s[46:47]
  v_mov_b32 v163, 0x3f803f80
  v_pk_fma_f32 v[32:33], v[176:177], v[188:189], v[32:33] op_sel:[0,0,0] op_sel_hi:[1,0,1]
  v_pk_fma_f32 v[34:35], v[178:179], v[188:189], v[34:35] op_sel:[0,0,0] op_sel_hi:[1,0,1]
  v_pk_fma_f32 v[52:53], v[180:181], v[188:189], v[52:53] op_sel:[0,0,0] op_sel_hi:[1,0,1]
  v_pk_fma_f32 v[54:55], v[182:183], v[188:189], v[54:55] op_sel:[0,0,0] op_sel_hi:[1,0,1]
  v_pk_mul_f32 v[32:33], v[32:33], v[194:195] op_sel:[0,0] op_sel_hi:[1,0]
  v_pk_mul_f32 v[34:35], v[34:35], v[194:195] op_sel:[0,0] op_sel_hi:[1,0]
  v_pk_mul_f32 v[52:53], v[52:53], v[194:195] op_sel:[0,0] op_sel_hi:[1,0]
  v_pk_mul_f32 v[54:55], v[54:55], v[194:195] op_sel:[0,0] op_sel_hi:[1,0]
  v_cvt_pk_bf16_f32 v32, v32, v33
  v_cvt_pk_bf16_f32 v33, v34, v35
  v_cvt_pk_bf16_f32 v34, v52, v53
  v_cvt_pk_bf16_f32 v35, v54, v55
  s_add_u32 m0, s89, 32768
  s_add_u32 s92, s91, s80
  s_and_b32 s92, s92, 0x1fffff
  buffer_load_dwordx4 v186, s[12:15], s92 offen lds
  s_add_u32 s91, s91, 65536
  v_pk_fma_f32 v[36:37], v[176:177], v[188:189], v[36:37] op_sel:[0,1,0] op_sel_hi:[1,1,1]
  v_pk_fma_f32 v[38:39], v[178:179], v[188:189], v[38:39] op_sel:[0,1,0] op_sel_hi:[1,1,1]
  v_pk_fma_f32 v[56:57], v[180:181], v[188:189], v[56:57] op_sel:[0,1,0] op_sel_hi:[1,1,1]
  v_pk_fma_f32 v[58:59], v[182:183], v[188:189], v[58:59] op_sel:[0,1,0] op_sel_hi:[1,1,1]
  v_pk_mul_f32 v[36:37], v[36:37], v[194:195] op_sel:[0,1] op_sel_hi:[1,1]
  v_pk_mul_f32 v[38:39], v[38:39], v[194:195] op_sel:[0,1] op_sel_hi:[1,1]
  v_pk_mul_f32 v[56:57], v[56:57], v[194:195] op_sel:[0,1] op_sel_hi:[1,1]
  v_pk_mul_f32 v[58:59], v[58:59], v[194:195] op_sel:[0,1] op_sel_hi:[1,1]
  v_cvt_pk_bf16_f32 v36, v36, v37
  v_cvt_pk_bf16_f32 v37, v38, v39
  v_cvt_pk_bf16_f32 v38, v56, v57
  v_cvt_pk_bf16_f32 v39, v58, v59
  s_add_u32 m0, s89, 36864
  s_add_u32 s92, s91, s81
  s_and_b32 s92, s92, 0x1fffff
  buffer_load_dwordx4 v186, s[12:15], s92 offen lds
  s_add_u32 s91, s91, 65536
  v_pk_fma_f32 v[40:41], v[176:177], v[190:191], v[40:41] op_sel:[0,0,0] op_sel_hi:[1,0,1]
  v_pk_fma_f32 v[42:43], v[178:179], v[190:191], v[42:43] op_sel:[0,0,0] op_sel_hi:[1,0,1]
  v_pk_fma_f32 v[60:61], v[180:181], v[190:191], v[60:61] op_sel:[0,0,0] op_sel_hi:[1,0,1]
  v_pk_fma_f32 v[62:63], v[182:183], v[190:191], v[62:63] op_sel:[0,0,0] op_sel_hi:[1,0,1]
  v_pk_mul_f32 v[40:41], v[40:41], v[196:197] op_sel:[0,0] op_sel_hi:[1,0]
  v_pk_mul_f32 v[42:43], v[42:43], v[196:197] op_sel:[0,0] op_sel_hi:[1,0]
  v_pk_mul_f32 v[60:61], v[60:61], v[196:197] op_sel:[0,0] op_sel_hi:[1,0]
  v_pk_mul_f32 v[62:63], v[62:63], v[196:197] op_sel:[0,0] op_sel_hi:[1,0]
  v_cvt_pk_bf16_f32 v40, v40, v41
  v_cvt_pk_bf16_f32 v41, v42, v43
  v_cvt_pk_bf16_f32 v42, v60, v61
  v_cvt_pk_bf16_f32 v43, v62, v63
  s_add_u32 m0, s89, 40960
  s_add_u32 s92, s91, s82
  s_and_b32 s92, s92, 0x1fffff
  buffer_load_dwordx4 v186, s[12:15], s92 offen lds
  s_add_u32 s91, s91, 65536
  v_pk_fma_f32 v[44:45], v[176:177], v[190:191], v[44:45] op_sel:[0,1,0] op_sel_hi:[1,1,1]
  v_pk_fma_f32 v[46:47], v[178:179], v[190:191], v[46:47] op_sel:[0,1,0] op_sel_hi:[1,1,1]
  v_pk_fma_f32 v[64:65], v[180:181], v[190:191], v[64:65] op_sel:[0,1,0] op_sel_hi:[1,1,1]
  v_pk_fma_f32 v[66:67], v[182:183], v[190:191], v[66:67] op_sel:[0,1,0] op_sel_hi:[1,1,1]
  v_pk_mul_f32 v[44:45], v[44:45], v[196:197] op_sel:[0,1] op_sel_hi:[1,1]
  v_pk_mul_f32 v[46:47], v[46:47], v[196:197] op_sel:[0,1] op_sel_hi:[1,1]
  v_pk_mul_f32 v[64:65], v[64:65], v[196:197] op_sel:[0,1] op_sel_hi:[1,1]
  v_pk_mul_f32 v[66:67], v[66:67], v[196:197] op_sel:[0,1] op_sel_hi:[1,1]
  v_cvt_pk_bf16_f32 v44, v44, v45
  v_cvt_pk_bf16_f32 v45, v46, v47
  v_cvt_pk_bf16_f32 v46, v64, v65
  v_cvt_pk_bf16_f32 v47, v66, v67
  s_add_u32 m0, s89, 45056
  s_add_u32 s92, s91, s83
  s_and_b32 s92, s92, 0x1fffff
  buffer_load_dwordx4 v186, s[12:15], s92 offen lds
  s_add_u32 s91, s91, 65536
  v_pk_fma_f32 v[48:49], v[176:177], v[192:193], v[48:49] op_sel:[0,0,0] op_sel_hi:[1,0,1]
  v_pk_fma_f32 v[50:51], v[178:179], v[192:193], v[50:51] op_sel:[0,0,0] op_sel_hi:[1,0,1]
  v_pk_fma_f32 v[68:69], v[180:181], v[192:193], v[68:69] op_sel:[0,0,0] op_sel_hi:[1,0,1]
  v_pk_fma_f32 v[70:71], v[182:183], v[192:193], v[70:71] op_sel:[0,0,0] op_sel_hi:[1,0,1]
  v_pk_mul_f32 v[48:49], v[48:49], v[198:199] op_sel:[0,0] op_sel_hi:[1,0]
  v_pk_mul_f32 v[50:51], v[50:51], v[198:199] op_sel:[0,0] op_sel_hi:[1,0]
  v_pk_mul_f32 v[68:69], v[68:69], v[198:199] op_sel:[0,0] op_sel_hi:[1,0]
  v_pk_mul_f32 v[70:71], v[70:71], v[198:199] op_sel:[0,0] op_sel_hi:[1,0]
  v_cvt_pk_bf16_f32 v48, v48, v49
  v_cvt_pk_bf16_f32 v49, v50, v51
  v_cvt_pk_bf16_f32 v50, v68, v69
  v_cvt_pk_bf16_f32 v51, v70, v71
  s_add_u32 m0, s89, 49152
  s_add_u32 s92, s91, s84
  s_and_b32 s92, s92, 0x1fffff
  buffer_load_dwordx4 v186, s[12:15], s92 offen lds
  s_add_u32 s91, s91, 65536
  v_pk_fma_f32 v[0:1], v[168:169], v[188:189], v[0:1] op_sel:[0,1,0] op_sel_hi:[1,1,1]
  v_pk_fma_f32 v[2:3], v[170:171], v[188:189], v[2:3] op_sel:[0,1,0] op_sel_hi:[1,1,1]
  v_pk_fma_f32 v[16:17], v[172:173], v[188:189], v[16:17] op_sel:[0,1,0] op_sel_hi:[1,1,1]
  v_pk_fma_f32 v[18:19], v[174:175], v[188:189], v[18:19] op_sel:[0,1,0] op_sel_hi:[1,1,1]
  v_pk_mul_f32 v[0:1], v[0:1], v[194:195] op_sel:[0,1] op_sel_hi:[1,1]
  v_pk_mul_f32 v[2:3], v[2:3], v[194:195] op_sel:[0,1] op_sel_hi:[1,1]
  v_pk_mul_f32 v[16:17], v[16:17], v[194:195] op_sel:[0,1] op_sel_hi:[1,1]
  v_pk_mul_f32 v[18:19], v[18:19], v[194:195] op_sel:[0,1] op_sel_hi:[1,1]
  v_cvt_pk_bf16_f32 v0, v0, v1
  v_cvt_pk_bf16_f32 v1, v2, v3
  v_cvt_pk_bf16_f32 v2, v16, v17
  v_cvt_pk_bf16_f32 v3, v18, v19
  s_add_u32 m0, s89, 53248
  s_add_u32 s92, s91, s85
  s_and_b32 s92, s92, 0x1fffff
  buffer_load_dwordx4 v186, s[12:15], s92 offen lds
  s_add_u32 s91, s91, 65536
  v_pk_fma_f32 v[4:5], v[168:169], v[190:191], v[4:5] op_sel:[0,0,0] op_sel_hi:[1,0,1]
  v_pk_fma_f32 v[6:7], v[170:171], v[190:191], v[6:7] op_sel:[0,0,0] op_sel_hi:[1,0,1]
  v_pk_fma_f32 v[20:21], v[172:173], v[190:191], v[20:21] op_sel:[0,0,0] op_sel_hi:[1,0,1]
  v_pk_fma_f32 v[22:23], v[174:175], v[190:191], v[22:23] op_sel:[0,0,0] op_sel_hi:[1,0,1]
  v_pk_mul_f32 v[4:5], v[4:5], v[196:197] op_sel:[0,0] op_sel_hi:[1,0]
  v_pk_mul_f32 v[6:7], v[6:7], v[196:197] op_sel:[0,0] op_sel_hi:[1,0]
  v_pk_mul_f32 v[20:21], v[20:21], v[196:197] op_sel:[0,0] op_sel_hi:[1,0]
  v_pk_mul_f32 v[22:23], v[22:23], v[196:197] op_sel:[0,0] op_sel_hi:[1,0]
  v_cvt_pk_bf16_f32 v4, v4, v5
  v_cvt_pk_bf16_f32 v5, v6, v7
  v_cvt_pk_bf16_f32 v6, v20, v21
  v_cvt_pk_bf16_f32 v7, v22, v23
  s_add_u32 m0, s89, 57344
  s_add_u32 s92, s91, s86
  s_and_b32 s92, s92, 0x1fffff
  buffer_load_dwordx4 v186, s[12:15], s92 offen lds
  s_add_u32 s91, s91, 65536
  v_pk_fma_f32 v[8:9], v[168:169], v[190:191], v[8:9] op_sel:[0,1,0] op_sel_hi:[1,1,1]
  v_pk_fma_f32 v[10:11], v[170:171], v[190:191], v[10:11] op_sel:[0,1,0] op_sel_hi:[1,1,1]
  v_pk_fma_f32 v[24:25], v[172:173], v[190:191], v[24:25] op_sel:[0,1,0] op_sel_hi:[1,1,1]
  v_pk_fma_f32 v[26:27], v[174:175], v[190:191], v[26:27] op_sel:[0,1,0] op_sel_hi:[1,1,1]
  v_pk_mul_f32 v[8:9], v[8:9], v[196:197] op_sel:[0,1] op_sel_hi:[1,1]
  v_pk_mul_f32 v[10:11], v[10:11], v[196:197] op_sel:[0,1] op_sel_hi:[1,1]
  v_pk_mul_f32 v[24:25], v[24:25], v[196:197] op_sel:[0,1] op_sel_hi:[1,1]
  v_pk_mul_f32 v[26:27], v[26:27], v[196:197] op_sel:[0,1] op_sel_hi:[1,1]
  v_cvt_pk_bf16_f32 v8, v8, v9
  v_cvt_pk_bf16_f32 v9, v10, v11
  v_cvt_pk_bf16_f32 v10, v24, v25
  v_cvt_pk_bf16_f32 v11, v26, v27
  s_add_u32 m0, s89, 61440
  s_add_u32 s92, s91, s87
  s_and_b32 s92, s92, 0x1fffff
  buffer_load_dwordx4 v186, s[12:15], s92 offen lds
  s_add_u32 s91, s91, 65536
  v_pk_fma_f32 v[12:13], v[168:169], v[192:193], v[12:13] op_sel:[0,0,0] op_sel_hi:[1,0,1]
  v_pk_fma_f32 v[14:15], v[170:171], v[192:193], v[14:15] op_sel:[0,0,0] op_sel_hi:[1,0,1]
  v_pk_fma_f32 v[28:29], v[172:173], v[192:193], v[28:29] op_sel:[0,0,0] op_sel_hi:[1,0,1]
  v_pk_fma_f32 v[30:31], v[174:175], v[192:193], v[30:31] op_sel:[0,0,0] op_sel_hi:[1,0,1]
  v_pk_mul_f32 v[12:13], v[12:13], v[198:199] op_sel:[0,0] op_sel_hi:[1,0]
  v_pk_mul_f32 v[14:15], v[14:15], v[198:199] op_sel:[0,0] op_sel_hi:[1,0]
  v_pk_mul_f32 v[28:29], v[28:29], v[198:199] op_sel:[0,0] op_sel_hi:[1,0]
  v_pk_mul_f32 v[30:31], v[30:31], v[198:199] op_sel:[0,0] op_sel_hi:[1,0]
  v_cvt_pk_bf16_f32 v12, v12, v13
  v_cvt_pk_bf16_f32 v13, v14, v15
  v_cvt_pk_bf16_f32 v14, v28, v29
  v_cvt_pk_bf16_f32 v15, v30, v31
  s_add_u32 m0, s89, 65536
  s_add_u32 s92, s91, s80
  s_and_b32 s92, s92, 0x1fffff
  buffer_load_dwordx4 v186, s[12:15], s92 offen lds
  s_add_u32 s91, s91, 65536
  s_nop 1
  v_mfma_f32_16x16x32_bf16 v[16:19], v[32:35], v[0:3], v[136:139]
  v_mfma_f32_16x16x32_bf16 v[56:59], v[36:39], v[0:3], v[128:131]
  v_mfma_f32_16x16x32_bf16 v[20:23], v[36:39], v[4:7], v[132:135]
  v_mfma_f32_16x16x32_bf16 v[60:63], v[40:43], v[4:7], v[128:131]
  v_mfma_f32_16x16x32_bf16 v[24:27], v[40:43], v[8:11], v[132:135]
  v_mfma_f32_16x16x32_bf16 v[64:67], v[44:47], v[8:11], v[128:131]
  v_mfma_f32_16x16x32_bf16 v[28:31], v[44:47], v[12:15], v[132:135]
  v_mfma_f32_16x16x32_bf16 v[68:71], v[48:51], v[12:15], v[128:131]
  s_waitcnt lgkmcnt(0)
  v_pk_fma_f32 v[72:73], v[200:201], v[184:185], v[72:73] op_sel:[0,0,0] op_sel_hi:[1,0,1]
  v_pk_fma_f32 v[74:75], v[202:203], v[184:185], v[74:75] op_sel:[0,0,0] op_sel_hi:[1,0,1]
  v_pk_fma_f32 v[92:93], v[200:201], v[184:185], v[92:93] op_sel:[0,1,0] op_sel_hi:[1,1,1]
  v_pk_fma_f32 v[94:95], v[202:203], v[184:185], v[94:95] op_sel:[0,1,0] op_sel_hi:[1,1,1]
  v_pk_mul_f32 v[72:73], v[72:73], v[220:221]
  v_pk_mul_f32 v[74:75], v[74:75], v[222:223]
  v_pk_mul_f32 v[92:93], v[92:93], v[220:221]
  v_pk_mul_f32 v[94:95], v[94:95], v[222:223]
  v_cvt_pk_bf16_f32 v140, v72, v73
  v_cvt_pk_bf16_f32 v141, v74, v75
  v_cvt_pk_bf16_f32 v150, v92, v93
  v_cvt_pk_bf16_f32 v151, v94, v95
  s_add_u32 m0, s89, 69632
  s_add_u32 s92, s91, s81
  s_and_b32 s92, s92, 0x1fffff
  buffer_load_dwordx4 v186, s[12:15], s92 offen lds
  s_add_u32 s91, s91, 65536
  v_pk_fma_f32 v[76:77], v[204:205], v[184:185], v[76:77] op_sel:[0,0,0] op_sel_hi:[1,0,1]
  v_pk_fma_f32 v[78:79], v[206:207], v[184:185], v[78:79] op_sel:[0,0,0] op_sel_hi:[1,0,1]
  v_pk_fma_f32 v[96:97], v[204:205], v[184:185], v[96:97] op_sel:[0,1,0] op_sel_hi:[1,1,1]
  v_pk_fma_f32 v[98:99], v[206:207], v[184:185], v[98:99] op_sel:[0,1,0] op_sel_hi:[1,1,1]
  v_pk_mul_f32 v[76:77], v[76:77], v[224:225]
  v_pk_mul_f32 v[78:79], v[78:79], v[226:227]
  v_pk_mul_f32 v[96:97], v[96:97], v[224:225]
  v_pk_mul_f32 v[98:99], v[98:99], v[226:227]
  v_cvt_pk_bf16_f32 v142, v76, v77
  v_cvt_pk_bf16_f32 v143, v78, v79
  v_cvt_pk_bf16_f32 v152, v96, v97
  v_cvt_pk_bf16_f32 v153, v98, v99
  v_pk_fma_f32 v[80:81], v[208:209], v[184:185], v[80:81] op_sel:[0,0,0] op_sel_hi:[1,0,1]
  v_pk_fma_f32 v[82:83], v[210:211], v[184:185], v[82:83] op_sel:[0,0,0] op_sel_hi:[1,0,1]
  v_pk_fma_f32 v[100:101], v[208:209], v[184:185], v[100:101] op_sel:[0,1,0] op_sel_hi:[1,1,1]
  v_pk_fma_f32 v[102:103], v[210:211], v[184:185], v[102:103] op_sel:[0,1,0] op_sel_hi:[1,1,1]
  v_pk_mul_f32 v[80:81], v[80:81], v[228:229]
  v_pk_mul_f32 v[82:83], v[82:83], v[230:231]
  v_pk_mul_f32 v[100:101], v[100:101], v[228:229]
  v_pk_mul_f32 v[102:103], v[102:103], v[230:231]
  v_cvt_pk_bf16_f32 v144, v80, v81
  v_cvt_pk_bf16_f32 v145, v82, v83
  v_cvt_pk_bf16_f32 v154, v100, v101
  v_cvt_pk_bf16_f32 v155, v102, v103
  s_add_u32 m0, s89, 73728
  s_add_u32 s92, s91, s82
  s_and_b32 s92, s92, 0x1fffff
  buffer_load_dwordx4 v186, s[12:15], s92 offen lds
  s_add_u32 s91, s91, 65536
  v_pk_fma_f32 v[84:85], v[212:213], v[184:185], v[84:85] op_sel:[0,0,0] op_sel_hi:[1,0,1]
  v_pk_fma_f32 v[86:87], v[214:215], v[184:185], v[86:87] op_sel:[0,0,0] op_sel_hi:[1,0,1]
  v_pk_fma_f32 v[104:105], v[212:213], v[184:185], v[104:105] op_sel:[0,1,0] op_sel_hi:[1,1,1]
  v_pk_fma_f32 v[106:107], v[214:215], v[184:185], v[106:107] op_sel:[0,1,0] op_sel_hi:[1,1,1]
  v_pk_mul_f32 v[84:85], v[84:85], v[232:233]
  v_pk_mul_f32 v[86:87], v[86:87], v[234:235]
  v_pk_mul_f32 v[104:105], v[104:105], v[232:233]
  v_pk_mul_f32 v[106:107], v[106:107], v[234:235]
  v_cvt_pk_bf16_f32 v146, v84, v85
  v_cvt_pk_bf16_f32 v147, v86, v87
  v_cvt_pk_bf16_f32 v156, v104, v105
  v_cvt_pk_bf16_f32 v157, v106, v107
  v_pk_fma_f32 v[88:89], v[216:217], v[184:185], v[88:89] op_sel:[0,0,0] op_sel_hi:[1,0,1]
  v_pk_fma_f32 v[90:91], v[218:219], v[184:185], v[90:91] op_sel:[0,0,0] op_sel_hi:[1,0,1]
  v_pk_fma_f32 v[108:109], v[216:217], v[184:185], v[108:109] op_sel:[0,1,0] op_sel_hi:[1,1,1]
  v_pk_fma_f32 v[110:111], v[218:219], v[184:185], v[110:111] op_sel:[0,1,0] op_sel_hi:[1,1,1]
  v_pk_mul_f32 v[88:89], v[88:89], v[236:237]
  v_pk_mul_f32 v[90:91], v[90:91], v[238:239]
  v_pk_mul_f32 v[108:109], v[108:109], v[236:237]
  v_pk_mul_f32 v[110:111], v[110:111], v[238:239]
  v_cvt_pk_bf16_f32 v148, v88, v89
  v_cvt_pk_bf16_f32 v149, v90, v91
  v_cvt_pk_bf16_f32 v158, v108, v109
  v_cvt_pk_bf16_f32 v159, v110, v111
  s_add_u32 m0, s89, 77824
  s_add_u32 s92, s91, s83
  s_and_b32 s92, s92, 0x1fffff
  buffer_load_dwordx4 v186, s[12:15], s92 offen lds
  s_add_u32 s91, s91, 65536
  v_max3_f32 v240, v16, v17, v18
  v_max3_f32 v241, v20, v21, v22
  v_max3_f32 v242, v24, v25, v26
  v_max3_f32 v243, v28, v29, v30
  v_max3_f32 v240, v240, v19, v56
  v_max3_f32 v241, v241, v23, v60
  v_max3_f32 v242, v242, v27, v64
  v_max3_f32 v243, v243, v31, v68
  v_max3_f32 v240, v240, v57, v58
  v_max3_f32 v241, v241, v61, v62
  v_max3_f32 v242, v242, v65, v66
  v_max3_f32 v243, v243, v69, v70
  v_max_f32 v240, v240, v59
  v_max_f32 v241, v241, v63
  v_max_f32 v242, v242, v67
  v_max_f32 v243, v243, v71
  v_mov_b32 v244, v240
  v_mov_b32 v245, v241
  v_mov_b32 v246, v242
  v_mov_b32 v247, v243
  v_permlane32_swap_b32 v240, v244
  v_permlane32_swap_b32 v241, v245
  v_permlane32_swap_b32 v242, v246
  v_permlane32_swap_b32 v243, v247
  v_max_f32 v240, v240, v244
  v_max_f32 v241, v241, v245
  v_max_f32 v242, v242, v246
  v_max_f32 v243, v243, v247
  v_mov_b32 v244, v240
  v_mov_b32 v245, v241
  v_mov_b32 v246, v242
  v_mov_b32 v247, v243
  v_permlane16_swap_b32 v240, v244
  v_permlane16_swap_b32 v241, v245
  v_permlane16_swap_b32 v242, v246
  v_permlane16_swap_b32 v243, v247
  v_max_f32 v240, v240, v244
  v_max_f32 v241, v241, v245
  v_max_f32 v242, v242, v246
  v_max_f32 v243, v243, v247
  s_add_u32 m0, s89, 81920
  s_add_u32 s92, s91, s84
  s_and_b32 s92, s92, 0x1fffff
  buffer_load_dwordx4 v186, s[12:15], s92 offen lds
  s_add_u32 s91, s91, 65536
  s_mov_b32 s46, 0x3e8293ee
  v_mul_f32 v240, 0xbe8293ee, v240
  v_mul_f32 v241, 0xbe8293ee, v241
  v_mul_f32 v242, 0xbe8293ee, v242
  v_mul_f32 v243, 0xbe8293ee, v243
  v_fma_f32 v16, v16, s46, v240
  v_fma_f32 v17, v17, s46, v240
  v_fma_f32 v18, v18, s46, v240
  v_fma_f32 v19, v19, s46, v240
  v_fma_f32 v56, v56, s46, v240
  v_fma_f32 v57, v57, s46, v240
  v_fma_f32 v58, v58, s46, v240
  v_fma_f32 v59, v59, s46, v240
  v_exp_f32 v16, v16
  v_exp_f32 v17, v17
  v_exp_f32 v18, v18
  v_exp_f32 v19, v19
  v_exp_f32 v56, v56
  v_exp_f32 v57, v57
  v_exp_f32 v58, v58
  v_exp_f32 v59, v59
  v_cvt_pk_bf16_f32 v0, v16, v17
  v_cvt_pk_bf16_f32 v1, v18, v19
  v_cvt_pk_bf16_f32 v2, v56, v57
  v_cvt_pk_bf16_f32 v3, v58, v59
  s_add_u32 m0, s89, 86016
  s_add_u32 s92, s91, s85
  s_and_b32 s92, s92, 0x1fffff
  buffer_load_dwordx4 v186, s[12:15], s92 offen lds
  s_add_u32 s91, s91, 65536
  v_fma_f32 v20, v20, s46, v241
  v_fma_f32 v21, v21, s46, v241
  v_fma_f32 v22, v22, s46, v241
  v_fma_f32 v23, v23, s46, v241
  v_fma_f32 v60, v60, s46, v241
  v_fma_f32 v61, v61, s46, v241
  v_fma_f32 v62, v62, s46, v241
  v_fma_f32 v63, v63, s46, v241
  v_exp_f32 v20, v20
  v_exp_f32 v21, v21
  v_exp_f32 v22, v22
  v_exp_f32 v23, v23
  v_exp_f32 v60, v60
  v_exp_f32 v61, v61
  v_exp_f32 v62, v62
  v_exp_f32 v63, v63
  v_cvt_pk_bf16_f32 v4, v20, v21
  v_cvt_pk_bf16_f32 v5, v22, v23
  v_cvt_pk_bf16_f32 v6, v60, v61
  v_cvt_pk_bf16_f32 v7, v62, v63
  v_fma_f32 v24, v24, s46, v242
  v_fma_f32 v25, v25, s46, v242
  v_fma_f32 v26, v26, s46, v242
  v_fma_f32 v27, v27, s46, v242
  v_fma_f32 v64, v64, s46, v242
  v_fma_f32 v65, v65, s46, v242
  v_fma_f32 v66, v66, s46, v242
  v_fma_f32 v67, v67, s46, v242
  v_exp_f32 v24, v24
  v_exp_f32 v25, v25
  v_exp_f32 v26, v26
  v_exp_f32 v27, v27
  v_exp_f32 v64, v64
  v_exp_f32 v65, v65
  v_exp_f32 v66, v66
  v_exp_f32 v67, v67
  v_cvt_pk_bf16_f32 v8, v24, v25
  v_cvt_pk_bf16_f32 v9, v26, v27
  v_cvt_pk_bf16_f32 v10, v64, v65
  v_cvt_pk_bf16_f32 v11, v66, v67
  v_fma_f32 v28, v28, s46, v243
  v_fma_f32 v29, v29, s46, v243
  v_fma_f32 v30, v30, s46, v243
  v_fma_f32 v31, v31, s46, v243
  v_fma_f32 v68, v68, s46, v243
  v_fma_f32 v69, v69, s46, v243
  v_fma_f32 v70, v70, s46, v243
  v_fma_f32 v71, v71, s46, v243
  v_exp_f32 v28, v28
  v_exp_f32 v29, v29
  v_exp_f32 v30, v30
  v_exp_f32 v31, v31
  v_exp_f32 v68, v68
  v_exp_f32 v69, v69
  v_exp_f32 v70, v70
  v_exp_f32 v71, v71
  v_cvt_pk_bf16_f32 v12, v28, v29
  v_cvt_pk_bf16_f32 v13, v30, v31
  v_cvt_pk_bf16_f32 v14, v68, v69
  v_cvt_pk_bf16_f32 v15, v70, v71
  s_nop 1
  v_mfma_f32_16x16x32_bf16 v[36:39], v[160:163], v[0:3], 0
  v_mfma_f32_16x16x32_bf16 v[76:79], v[140:143], v[0:3], 0
  v_mfma_f32_16x16x32_bf16 v[96:99], v[150:153], v[0:3], 0
  v_mfma_f32_16x16x32_bf16 v[40:43], v[160:163], v[4:7], 0
  v_mfma_f32_16x16x32_bf16 v[80:83], v[142:145], v[4:7], 0
  v_mfma_f32_16x16x32_bf16 v[100:103], v[152:155], v[4:7], 0
  v_mfma_f32_16x16x32_bf16 v[44:47], v[160:163], v[8:11], 0
  v_mfma_f32_16x16x32_bf16 v[84:87], v[144:147], v[8:11], 0
  v_mfma_f32_16x16x32_bf16 v[104:107], v[154:157], v[8:11], 0
  v_mfma_f32_16x16x32_bf16 v[48:51], v[160:163], v[12:15], 0
  v_mfma_f32_16x16x32_bf16 v[88:91], v[146:149], v[12:15], 0
  v_mfma_f32_16x16x32_bf16 v[108:111], v[156:159], v[12:15], 0
  s_lshl_b32 s43, s74, 15
  s_lshl_b32 s44, s75, 10
  s_add_u32 s43, s43, s44
  s_add_u32 s43, s43, s42
  s_add_u32 s46, s43, 8388608
  s_add_u32 s47, s46, 32768
  s_add_u32 s48, s47, 32768
  s_add_u32 s49, s48, 32768
  v_rcp_f32 v36, v36
  v_rcp_f32 v40, v40
  v_rcp_f32 v44, v44
  v_rcp_f32 v48, v48
  v_pk_mul_f32 v[76:77], v[76:77], v[36:37] op_sel:[0,0] op_sel_hi:[1,0]
  v_pk_mul_f32 v[78:79], v[78:79], v[36:37] op_sel:[0,0] op_sel_hi:[1,0]
  v_pk_mul_f32 v[96:97], v[96:97], v[36:37] op_sel:[0,0] op_sel_hi:[1,0]
  v_pk_mul_f32 v[98:99], v[98:99], v[36:37] op_sel:[0,0] op_sel_hi:[1,0]
  v_cvt_pk_bf16_f32 v16, v76, v77
  v_cvt_pk_bf16_f32 v17, v78, v79
  v_cvt_pk_bf16_f32 v18, v96, v97
  v_cvt_pk_bf16_f32 v19, v98, v99
  buffer_store_dwordx4 v[16:19], v120, s[4:7], s46 offen sc1
  v_pk_mul_f32 v[80:81], v[80:81], v[40:41] op_sel:[0,0] op_sel_hi:[1,0]
  v_pk_mul_f32 v[82:83], v[82:83], v[40:41] op_sel:[0,0] op_sel_hi:[1,0]
  v_pk_mul_f32 v[100:101], v[100:101], v[40:41] op_sel:[0,0] op_sel_hi:[1,0]
  v_pk_mul_f32 v[102:103], v[102:103], v[40:41] op_sel:[0,0] op_sel_hi:[1,0]
  v_cvt_pk_bf16_f32 v20, v80, v81
  v_cvt_pk_bf16_f32 v21, v82, v83
  v_cvt_pk_bf16_f32 v22, v100, v101
  v_cvt_pk_bf16_f32 v23, v102, v103
  buffer_store_dwordx4 v[20:23], v120, s[4:7], s47 offen sc1
  v_pk_mul_f32 v[84:85], v[84:85], v[44:45] op_sel:[0,0] op_sel_hi:[1,0]
  v_pk_mul_f32 v[86:87], v[86:87], v[44:45] op_sel:[0,0] op_sel_hi:[1,0]
  v_pk_mul_f32 v[104:105], v[104:105], v[44:45] op_sel:[0,0] op_sel_hi:[1,0]
  v_pk_mul_f32 v[106:107], v[106:107], v[44:45] op_sel:[0,0] op_sel_hi:[1,0]
  v_cvt_pk_bf16_f32 v24, v84, v85
  v_cvt_pk_bf16_f32 v25, v86, v87
  v_cvt_pk_bf16_f32 v26, v104, v105
  v_cvt_pk_bf16_f32 v27, v106, v107
  buffer_store_dwordx4 v[24:27], v120, s[4:7], s48 offen sc1
  v_pk_mul_f32 v[88:89], v[88:89], v[48:49] op_sel:[0,0] op_sel_hi:[1,0]
  v_pk_mul_f32 v[90:91], v[90:91], v[48:49] op_sel:[0,0] op_sel_hi:[1,0]
  v_pk_mul_f32 v[108:109], v[108:109], v[48:49] op_sel:[0,0] op_sel_hi:[1,0]
  v_pk_mul_f32 v[110:111], v[110:111], v[48:49] op_sel:[0,0] op_sel_hi:[1,0]
  v_cvt_pk_bf16_f32 v28, v88, v89
  v_cvt_pk_bf16_f32 v29, v90, v91
  v_cvt_pk_bf16_f32 v30, v108, v109
  v_cvt_pk_bf16_f32 v31, v110, v111
  buffer_store_dwordx4 v[28:31], v120, s[4:7], s49 offen sc1
  s_lshl_b32 s77, s50, 7
  s_add_u32 s77, s77, s42
  s_add_u32 s77, s77, 27787264
  s_lshl_b32 s58, s52, 3
  s_lshl_b32 s43, s40, 1
  s_add_u32 s58, s58, s43
  s_lshl_b32 s59, s58, 15
  s_lshl_b32 s43, s53, 11
  s_add_u32 s59, s59, s43
  s_add_u32 s59, s59, s42
  s_add_u32 s46, s59, 0
  s_add_u32 s47, s46, 32768
  v_lshlrev_b32 v48, 4, v253
  v_add_u32 v49, 32768, v48
  buffer_load_dwordx4 v[52:55], v48, s[4:7], s46 offen offset:0 sc1
  buffer_load_dwordx4 v[56:59], v48, s[4:7], s46 offen offset:1024 sc1
  buffer_load_dwordx4 v[60:63], v48, s[4:7], s47 offen offset:0 sc1
  buffer_load_dwordx4 v[64:67], v48, s[4:7], s47 offen offset:1024 sc1
  s_mul_i32 s57, s58, 32768
  s_add_u32 s57, s57, s42
  s_add_u32 s57, s57, 8388608
  s_and_b32 s60, s52, 3
  s_lshl_b32 s60, s60, 13
  v_lshrrev_b32 v2, 2, v253
  v_bfe_u32 v3, v253, 3, 2
  v_and_b32 v4, 3, v253
  v_lshlrev_b32 v4, 3, v4
  v_lshl_add_u32 v4, v2, 7, v4
  v_xor_b32 v5, 0, v3
  v_lshl_add_u32 v40, v5, 5, v4
  v_xor_b32 v5, 1, v3
  v_lshl_add_u32 v41, v5, 5, v4
  v_xor_b32 v5, 2, v3
  v_lshl_add_u32 v42, v5, 5, v4
  v_xor_b32 v5, 3, v3
  v_lshl_add_u32 v43, v5, 5, v4
  s_cmp_eq_u32 s3, 0
  s_cbranch_scc1 Lsd7
  v_accvgpr_read_b32 v112, a176
  v_accvgpr_read_b32 v113, a177
  v_accvgpr_read_b32 v114, a178
  v_accvgpr_read_b32 v115, a179
  v_lshlrev_b32 v100, 16, v112
  v_and_b32 v101, 0xffff0000, v112
  v_lshlrev_b32 v102, 16, v113
  v_and_b32 v103, 0xffff0000, v113
  v_lshlrev_b32 v104, 16, v114
  v_and_b32 v105, 0xffff0000, v114
  v_lshlrev_b32 v106, 16, v115
  v_and_b32 v107, 0xffff0000, v115
  v_accvgpr_read_b32 v112, a180
  v_accvgpr_read_b32 v113, a181
  v_accvgpr_read_b32 v114, a182
  v_accvgpr_read_b32 v115, a183
  v_lshlrev_b32 v108, 16, v112
  v_and_b32 v109, 0xffff0000, v112
  v_pk_add_f32 v[100:101], v[100:101], v[108:109]
  v_lshlrev_b32 v108, 16, v113
  v_and_b32 v109, 0xffff0000, v113
  v_pk_add_f32 v[102:103], v[102:103], v[108:109]
  v_lshlrev_b32 v108, 16, v114
  v_and_b32 v109, 0xffff0000, v114
  v_pk_add_f32 v[104:105], v[104:105], v[108:109]
  v_lshlrev_b32 v108, 16, v115
  v_and_b32 v109, 0xffff0000, v115
  v_pk_add_f32 v[106:107], v[106:107], v[108:109]
  v_accvgpr_read_b32 v112, a184
  v_accvgpr_read_b32 v113, a185
  v_accvgpr_read_b32 v114, a186
  v_accvgpr_read_b32 v115, a187
  v_lshlrev_b32 v108, 16, v112
  v_and_b32 v109, 0xffff0000, v112
  v_pk_add_f32 v[100:101], v[100:101], v[108:109]
  v_lshlrev_b32 v108, 16, v113
  v_and_b32 v109, 0xffff0000, v113
  v_pk_add_f32 v[102:103], v[102:103], v[108:109]
  v_lshlrev_b32 v108, 16, v114
  v_and_b32 v109, 0xffff0000, v114
  v_pk_add_f32 v[104:105], v[104:105], v[108:109]
  v_lshlrev_b32 v108, 16, v115
  v_and_b32 v109, 0xffff0000, v115
  v_pk_add_f32 v[106:107], v[106:107], v[108:109]
  v_accvgpr_read_b32 v112, a188
  v_accvgpr_read_b32 v113, a189
  v_accvgpr_read_b32 v114, a190
  v_accvgpr_read_b32 v115, a191
  v_lshlrev_b32 v108, 16, v112
  v_and_b32 v109, 0xffff0000, v112
  v_pk_add_f32 v[100:101], v[100:101], v[108:109]
  v_lshlrev_b32 v108, 16, v113
  v_and_b32 v109, 0xffff0000, v113
  v_pk_add_f32 v[102:103], v[102:103], v[108:109]
  v_lshlrev_b32 v108, 16, v114
  v_and_b32 v109, 0xffff0000, v114
  v_pk_add_f32 v[104:105], v[104:105], v[108:109]
  v_lshlrev_b32 v108, 16, v115
  v_and_b32 v109, 0xffff0000, v115
  v_pk_add_f32 v[106:107], v[106:107], v[108:109]
  v_accvgpr_read_b32 v112, a192
  v_accvgpr_read_b32 v113, a193
  v_accvgpr_read_b32 v114, a194
  v_accvgpr_read_b32 v115, a195
  v_lshlrev_b32 v108, 16, v112
  v_and_b32 v109, 0xffff0000, v112
  v_pk_add_f32 v[100:101], v[100:101], v[108:109]
  v_lshlrev_b32 v108, 16, v113
  v_and_b32 v109, 0xffff0000, v113
  v_pk_add_f32 v[102:103], v[102:103], v[108:109]
  v_lshlrev_b32 v108, 16, v114
  v_and_b32 v109, 0xffff0000, v114
  v_pk_add_f32 v[104:105], v[104:105], v[108:109]
  v_lshlrev_b32 v108, 16, v115
  v_and_b32 v109, 0xffff0000, v115
  v_pk_add_f32 v[106:107], v[106:107], v[108:109]
  v_accvgpr_read_b32 v112, a196
  v_accvgpr_read_b32 v113, a197
  v_accvgpr_read_b32 v114, a198
  v_accvgpr_read_b32 v115, a199
  v_lshlrev_b32 v108, 16, v112
  v_and_b32 v109, 0xffff0000, v112
  v_pk_add_f32 v[100:101], v[100:101], v[108:109]
  v_lshlrev_b32 v108, 16, v113
  v_and_b32 v109, 0xffff0000, v113
  v_pk_add_f32 v[102:103], v[102:103], v[108:109]
  v_lshlrev_b32 v108, 16, v114
  v_and_b32 v109, 0xffff0000, v114
  v_pk_add_f32 v[104:105], v[104:105], v[108:109]
  v_lshlrev_b32 v108, 16, v115
  v_and_b32 v109, 0xffff0000, v115
  v_pk_add_f32 v[106:107], v[106:107], v[108:109]
  v_accvgpr_read_b32 v112, a200
  v_accvgpr_read_b32 v113, a201
  v_accvgpr_read_b32 v114, a202
  v_accvgpr_read_b32 v115, a203
  v_lshlrev_b32 v108, 16, v112
  v_and_b32 v109, 0xffff0000, v112
  v_pk_add_f32 v[100:101], v[100:101], v[108:109]
  v_lshlrev_b32 v108, 16, v113
  v_and_b32 v109, 0xffff0000, v113
  v_pk_add_f32 v[102:103], v[102:103], v[108:109]
  v_lshlrev_b32 v108, 16, v114
  v_and_b32 v109, 0xffff0000, v114
  v_pk_add_f32 v[104:105], v[104:105], v[108:109]
  v_lshlrev_b32 v108, 16, v115
  v_and_b32 v109, 0xffff0000, v115
  v_pk_add_f32 v[106:107], v[106:107], v[108:109]
  v_accvgpr_read_b32 v112, a204
  v_accvgpr_read_b32 v113, a205
  v_accvgpr_read_b32 v114, a206
  v_accvgpr_read_b32 v115, a207
  v_lshlrev_b32 v108, 16, v112
  v_and_b32 v109, 0xffff0000, v112
  v_pk_add_f32 v[100:101], v[100:101], v[108:109]
  v_lshlrev_b32 v108, 16, v113
  v_and_b32 v109, 0xffff0000, v113
  v_pk_add_f32 v[102:103], v[102:103], v[108:109]
  v_lshlrev_b32 v108, 16, v114
  v_and_b32 v109, 0xffff0000, v114
  v_pk_add_f32 v[104:105], v[104:105], v[108:109]
  v_lshlrev_b32 v108, 16, v115
  v_and_b32 v109, 0xffff0000, v115
  v_pk_add_f32 v[106:107], v[106:107], v[108:109]
Lsd7:
  s_waitcnt vmcnt(4)
  s_barrier
  s_cmp_lg_u32 s40, 0
  s_cbranch_scc1 Lsig6
  v_mov_b32 v250, 1
  s_mov_b64 exec, 1
  buffer_atomic_add v250, v251, s[4:7], s77 offen sc1
  s_mov_b64 exec, -1
Lsig6:
  s_add_u32 m0, s89, 90112
  s_add_u32 s92, s91, s86
  s_and_b32 s92, s92, 0x1fffff
  buffer_load_dwordx4 v186, s[12:15], s92 offen lds
  s_add_u32 s91, s91, 65536
  s_add_u32 m0, s89, 94208
  s_add_u32 s92, s91, s87
  s_and_b32 s92, s92, 0x1fffff
  buffer_load_dwordx4 v186, s[12:15], s92 offen lds
  s_add_u32 s91, s91, 65536
  s_add_u32 m0, s89, 98304
  s_add_u32 s92, s91, s80
  s_and_b32 s92, s92, 0x1fffff
  buffer_load_dwordx4 v186, s[12:15], s92 offen lds
  s_add_u32 s91, s91, 65536
  s_add_u32 m0, s89, 102400
  s_add_u32 s92, s91, s81
  s_and_b32 s92, s92, 0x1fffff
  buffer_load_dwordx4 v186, s[12:15], s92 offen lds
  s_add_u32 s91, s91, 65536
  s_add_u32 m0, s89, 106496
  s_add_u32 s92, s91, s82
  s_and_b32 s92, s92, 0x1fffff
  buffer_load_dwordx4 v186, s[12:15], s92 offen lds
  s_add_u32 s91, s91, 65536
  s_add_u32 m0, s89, 110592
  s_add_u32 s92, s91, s83
  s_and_b32 s92, s92, 0x1fffff
  buffer_load_dwordx4 v186, s[12:15], s92 offen lds
  s_add_u32 s91, s91, 65536
  s_add_u32 m0, s89, 114688
  s_add_u32 s92, s91, s84
  s_and_b32 s92, s92, 0x1fffff
  buffer_load_dwordx4 v186, s[12:15], s92 offen lds
  s_add_u32 s91, s91, 65536
  s_add_u32 m0, s89, 118784
  s_add_u32 s92, s91, s85
  s_and_b32 s92, s92, 0x1fffff
  buffer_load_dwordx4 v186, s[12:15], s92 offen lds
  s_add_u32 s91, s91, 65536
  s_add_u32 m0, s89, 122880
  s_add_u32 s92, s91, s86
  s_and_b32 s92, s92, 0x1fffff
  buffer_load_dwordx4 v186, s[12:15], s92 offen lds
  s_add_u32 s91, s91, 65536
  s_add_u32 m0, s89, 126976
  s_add_u32 s92, s91, s87
  s_and_b32 s92, s92, 0x1fffff
  buffer_load_dwordx4 v186, s[12:15], s92 offen lds
  s_add_u32 s91, s91, 65536
  s_waitcnt vmcnt(10)
  v_lshlrev_b32 v0, 16, v52
  v_and_b32 v1, 0xffff0000, v52
  v_lshlrev_b32 v2, 16, v53
  v_and_b32 v3, 0xffff0000, v53
  v_lshlrev_b32 v8, 16, v54
  v_and_b32 v9, 0xffff0000, v54
  v_lshlrev_b32 v10, 16, v55
  v_and_b32 v11, 0xffff0000, v55
  v_lshlrev_b32 v16, 16, v56
  v_and_b32 v17, 0xffff0000, v56
  v_lshlrev_b32 v18, 16, v57
  v_and_b32 v19, 0xffff0000, v57
  v_lshlrev_b32 v24, 16, v58
  v_and_b32 v25, 0xffff0000, v58
  v_lshlrev_b32 v26, 16, v59
  v_and_b32 v27, 0xffff0000, v59
  v_lshlrev_b32 v4, 16, v60
  v_and_b32 v5, 0xffff0000, v60
  v_lshlrev_b32 v6, 16, v61
  v_and_b32 v7, 0xffff0000, v61
  v_lshlrev_b32 v12, 16, v62
  v_and_b32 v13, 0xffff0000, v62
  v_lshlrev_b32 v14, 16, v63
  v_and_b32 v15, 0xffff0000, v63
  v_lshlrev_b32 v20, 16, v64
  v_and_b32 v21, 0xffff0000, v64
  v_lshlrev_b32 v22, 16, v65
  v_and_b32 v23, 0xffff0000, v65
  v_lshlrev_b32 v28, 16, v66
  v_and_b32 v29, 0xffff0000, v66
  v_lshlrev_b32 v30, 16, v67
  v_and_b32 v31, 0xffff0000, v67
  s_cmp_eq_u32 s3, 0
  s_cbranch_scc1 Lsd8
  v_accvgpr_read_b32 v112, a208
  v_accvgpr_read_b32 v113, a209
  v_accvgpr_read_b32 v114, a210
  v_accvgpr_read_b32 v115, a211
  v_lshlrev_b32 v108, 16, v112
  v_and_b32 v109, 0xffff0000, v112
  v_pk_add_f32 v[100:101], v[100:101], v[108:109]
  v_lshlrev_b32 v108, 16, v113
  v_and_b32 v109, 0xffff0000, v113
  v_pk_add_f32 v[102:103], v[102:103], v[108:109]
  v_lshlrev_b32 v108, 16, v114
  v_and_b32 v109, 0xffff0000, v114
  v_pk_add_f32 v[104:105], v[104:105], v[108:109]
  v_lshlrev_b32 v108, 16, v115
  v_and_b32 v109, 0xffff0000, v115
  v_pk_add_f32 v[106:107], v[106:107], v[108:109]
  v_accvgpr_read_b32 v112, a212
  v_accvgpr_read_b32 v113, a213
  v_accvgpr_read_b32 v114, a214
  v_accvgpr_read_b32 v115, a215
  v_lshlrev_b32 v108, 16, v112
  v_and_b32 v109, 0xffff0000, v112
  v_pk_add_f32 v[100:101], v[100:101], v[108:109]
  v_lshlrev_b32 v108, 16, v113
  v_and_b32 v109, 0xffff0000, v113
  v_pk_add_f32 v[102:103], v[102:103], v[108:109]
  v_lshlrev_b32 v108, 16, v114
  v_and_b32 v109, 0xffff0000, v114
  v_pk_add_f32 v[104:105], v[104:105], v[108:109]
  v_lshlrev_b32 v108, 16, v115
  v_and_b32 v109, 0xffff0000, v115
  v_pk_add_f32 v[106:107], v[106:107], v[108:109]
  v_accvgpr_read_b32 v112, a216
  v_accvgpr_read_b32 v113, a217
  v_accvgpr_read_b32 v114, a218
  v_accvgpr_read_b32 v115, a219
  v_lshlrev_b32 v108, 16, v112
  v_and_b32 v109, 0xffff0000, v112
  v_pk_add_f32 v[100:101], v[100:101], v[108:109]
  v_lshlrev_b32 v108, 16, v113
  v_and_b32 v109, 0xffff0000, v113
  v_pk_add_f32 v[102:103], v[102:103], v[108:109]
  v_lshlrev_b32 v108, 16, v114
  v_and_b32 v109, 0xffff0000, v114
  v_pk_add_f32 v[104:105], v[104:105], v[108:109]
  v_lshlrev_b32 v108, 16, v115
  v_and_b32 v109, 0xffff0000, v115
  v_pk_add_f32 v[106:107], v[106:107], v[108:109]
  v_accvgpr_read_b32 v112, a220
  v_accvgpr_read_b32 v113, a221
  v_accvgpr_read_b32 v114, a222
  v_accvgpr_read_b32 v115, a223
  v_lshlrev_b32 v108, 16, v112
  v_and_b32 v109, 0xffff0000, v112
  v_pk_add_f32 v[100:101], v[100:101], v[108:109]
  v_lshlrev_b32 v108, 16, v113
  v_and_b32 v109, 0xffff0000, v113
  v_pk_add_f32 v[102:103], v[102:103], v[108:109]
  v_lshlrev_b32 v108, 16, v114
  v_and_b32 v109, 0xffff0000, v114
  v_pk_add_f32 v[104:105], v[104:105], v[108:109]
  v_lshlrev_b32 v108, 16, v115
  v_and_b32 v109, 0xffff0000, v115
  v_pk_add_f32 v[106:107], v[106:107], v[108:109]
  v_accvgpr_read_b32 v112, a224
  v_accvgpr_read_b32 v113, a225
  v_accvgpr_read_b32 v114, a226
  v_accvgpr_read_b32 v115, a227
  v_lshlrev_b32 v108, 16, v112
  v_and_b32 v109, 0xffff0000, v112
  v_pk_add_f32 v[100:101], v[100:101], v[108:109]
  v_lshlrev_b32 v108, 16, v113
  v_and_b32 v109, 0xffff0000, v113
  v_pk_add_f32 v[102:103], v[102:103], v[108:109]
  v_lshlrev_b32 v108, 16, v114
  v_and_b32 v109, 0xffff0000, v114
  v_pk_add_f32 v[104:105], v[104:105], v[108:109]
  v_lshlrev_b32 v108, 16, v115
  v_and_b32 v109, 0xffff0000, v115
  v_pk_add_f32 v[106:107], v[106:107], v[108:109]
  v_accvgpr_read_b32 v112, a228
  v_accvgpr_read_b32 v113, a229
  v_accvgpr_read_b32 v114, a230
  v_accvgpr_read_b32 v115, a231
  v_lshlrev_b32 v108, 16, v112
  v_and_b32 v109, 0xffff0000, v112
  v_pk_add_f32 v[100:101], v[100:101], v[108:109]
  v_lshlrev_b32 v108, 16, v113
  v_and_b32 v109, 0xffff0000, v113
  v_pk_add_f32 v[102:103], v[102:103], v[108:109]
  v_lshlrev_b32 v108, 16, v114
  v_and_b32 v109, 0xffff0000, v114
  v_pk_add_f32 v[104:105], v[104:105], v[108:109]
  v_lshlrev_b32 v108, 16, v115
  v_and_b32 v109, 0xffff0000, v115
  v_pk_add_f32 v[106:107], v[106:107], v[108:109]
  v_accvgpr_read_b32 v112, a232
  v_accvgpr_read_b32 v113, a233
  v_accvgpr_read_b32 v114, a234
  v_accvgpr_read_b32 v115, a235
  v_lshlrev_b32 v108, 16, v112
  v_and_b32 v109, 0xffff0000, v112
  v_pk_add_f32 v[100:101], v[100:101], v[108:109]
  v_lshlrev_b32 v108, 16, v113
  v_and_b32 v109, 0xffff0000, v113
  v_pk_add_f32 v[102:103], v[102:103], v[108:109]
  v_lshlrev_b32 v108, 16, v114
  v_and_b32 v109, 0xffff0000, v114
  v_pk_add_f32 v[104:105], v[104:105], v[108:109]
  v_lshlrev_b32 v108, 16, v115
  v_and_b32 v109, 0xffff0000, v115
  v_pk_add_f32 v[106:107], v[106:107], v[108:109]
  v_accvgpr_read_b32 v112, a236
  v_accvgpr_read_b32 v113, a237
  v_accvgpr_read_b32 v114, a238
  v_accvgpr_read_b32 v115, a239
  v_lshlrev_b32 v108, 16, v112
  v_and_b32 v109, 0xffff0000, v112
  v_pk_add_f32 v[100:101], v[100:101], v[108:109]
  v_lshlrev_b32 v108, 16, v113
  v_and_b32 v109, 0xffff0000, v113
  v_pk_add_f32 v[102:103], v[102:103], v[108:109]
  v_lshlrev_b32 v108, 16, v114
  v_and_b32 v109, 0xffff0000, v114
  v_pk_add_f32 v[104:105], v[104:105], v[108:109]
  v_lshlrev_b32 v108, 16, v115
  v_and_b32 v109, 0xffff0000, v115
  v_pk_add_f32 v[106:107], v[106:107], v[108:109]
  v_mov_b32 v108, v100
  v_mov_b32 v109, v101
  v_mov_b32 v110, v102
  v_mov_b32 v111, v103
  v_mov_b32 v112, v104
  v_mov_b32 v113, v105
  v_mov_b32 v114, v106
  v_mov_b32 v115, v107
  v_permlane32_swap_b32 v100, v108
  v_permlane32_swap_b32 v101, v109
  v_permlane32_swap_b32 v102, v110
  v_permlane32_swap_b32 v103, v111
  v_permlane32_swap_b32 v104, v112
  v_permlane32_swap_b32 v105, v113
  v_permlane32_swap_b32 v106, v114
  v_permlane32_swap_b32 v107, v115
  v_add_f32 v100, v100, v108
  v_add_f32 v101, v101, v109
  v_add_f32 v102, v102, v110
  v_add_f32 v103, v103, v111
  v_add_f32 v104, v104, v112
  v_add_f32 v105, v105, v113
  v_add_f32 v106, v106, v114
  v_add_f32 v107, v107, v115
  v_mov_b32 v108, v100
  v_mov_b32 v109, v101
  v_mov_b32 v110, v102
  v_mov_b32 v111, v103
  v_mov_b32 v112, v104
  v_mov_b32 v113, v105
  v_mov_b32 v114, v106
  v_mov_b32 v115, v107
  v_permlane16_swap_b32 v100, v108
  v_permlane16_swap_b32 v101, v109
  v_permlane16_swap_b32 v102, v110
  v_permlane16_swap_b32 v103, v111
  v_permlane16_swap_b32 v104, v112
  v_permlane16_swap_b32 v105, v113
  v_permlane16_swap_b32 v106, v114
  v_permlane16_swap_b32 v107, v115
  v_add_f32 v100, v100, v108
  v_add_f32 v101, v101, v109
  v_add_f32 v102, v102, v110
  v_add_f32 v103, v103, v111
  v_add_f32 v104, v104, v112
  v_add_f32 v105, v105, v113
  v_add_f32 v106, v106, v114
  v_add_f32 v107, v107, v115
  v_and_b32 v108, 7, v253
  s_lshl_b32 s43, s40, 8
  s_add_u32 s43, s43, 143360
  v_add_f32_dpp v100, v100, v100 row_ror:8 row_mask:0xf bank_mask:0xf
  v_add_f32_dpp v101, v101, v101 row_ror:8 row_mask:0xf bank_mask:0xf
  v_add_f32_dpp v102, v102, v102 row_ror:8 row_mask:0xf bank_mask:0xf
  v_add_f32_dpp v103, v103, v103 row_ror:8 row_mask:0xf bank_mask:0xf
  v_add_f32_dpp v104, v104, v104 row_ror:8 row_mask:0xf bank_mask:0xf
  v_add_f32_dpp v105, v105, v105 row_ror:8 row_mask:0xf bank_mask:0xf
  v_add_f32_dpp v106, v106, v106 row_ror:8 row_mask:0xf bank_mask:0xf
  v_add_f32_dpp v107, v107, v107 row_ror:8 row_mask:0xf bank_mask:0xf
  v_lshl_add_u32 v108, v108, 5, s43
  ds_write_b128 v108, v[100:103]
  ds_write_b128 v108, v[104:107] offset:16
Lsd8:
  s_lshl_b32 s77, s52, 7
  s_add_u32 s77, s77, 27787264
  s_add_u32 s77, s77, s42
  s_cmp_lg_u32 s40, 0
  s_cbranch_scc1 Lpdn10
  s_mov_b32 s43, 0x40000
  s_mov_b64 exec, 1
Lpol9:
  buffer_load_dword v250, v251, s[4:7], s77 offen sc1
  s_waitcnt vmcnt(0)
  v_cmp_gt_u32 vcc, 16, v250
  s_cbranch_vccz Lpdn10
  s_sub_u32 s43, s43, 1
  s_cmp_lg_u32 s43, 0
  s_cbranch_scc1 Lpol9
Lpdn10:
  s_mov_b64 exec, -1
  s_waitcnt vmcnt(0) lgkmcnt(0)
  s_barrier
  s_cmp_eq_u32 s40, 1
  s_cselect_b32 s3, s3, 0
  s_cmp_eq_u32 s3, 0
  s_cbranch_scc1 Lsd11
  v_lshlrev_b32 v108, 2, v253
  v_add_u32 v109, 143360, v108
  ds_read_b32 v110, v109 offset:0
  ds_read_b32 v111, v109 offset:256
  ds_read_b32 v112, v109 offset:512
  ds_read_b32 v113, v109 offset:768
  s_waitcnt lgkmcnt(0)
  v_add_f32 v110, v110, v111
  v_add_f32 v112, v112, v113
  v_add_f32 v110, v110, v112
  buffer_store_dword v110, v108, s[4:7], s101 offen sc1
Lsd11:
  s_lshr_b32 s93, s80, 6
  s_add_u32 s93, s93, s60
  s_and_b32 s93, s93, 0x7fff
  s_add_u32 s93, s93, s57
  buffer_load_dwordx4 a[0:3], v48, s[4:7], s93 offen sc1
  buffer_load_dwordx4 a[4:7], v49, s[4:7], s93 offen sc1
  s_add_u32 s60, s60, 1024
  s_lshr_b32 s93, s81, 6
  s_add_u32 s93, s93, s60
  s_and_b32 s93, s93, 0x7fff
  s_add_u32 s93, s93, s57
  buffer_load_dwordx4 a[8:11], v48, s[4:7], s93 offen sc1
  buffer_load_dwordx4 a[12:15], v49, s[4:7], s93 offen sc1
  s_add_u32 s60, s60, 1024
  s_lshr_b32 s93, s82, 6
  s_add_u32 s93, s93, s60
  s_and_b32 s93, s93, 0x7fff
  s_add_u32 s93, s93, s57
  buffer_load_dwordx4 a[16:19], v48, s[4:7], s93 offen sc1
  buffer_load_dwordx4 a[20:23], v49, s[4:7], s93 offen sc1
  s_add_u32 s60, s60, 1024
  s_lshr_b32 s93, s83, 6
  s_add_u32 s93, s93, s60
  s_and_b32 s93, s93, 0x7fff
  s_add_u32 s93, s93, s57
  buffer_load_dwordx4 a[24:27], v48, s[4:7], s93 offen sc1
  buffer_load_dwordx4 a[28:31], v49, s[4:7], s93 offen sc1
  s_add_u32 s60, s60, 1024
  s_lshr_b32 s93, s84, 6
  s_add_u32 s93, s93, s60
  s_and_b32 s93, s93, 0x7fff
  s_add_u32 s93, s93, s57
  buffer_load_dwordx4 a[32:35], v48, s[4:7], s93 offen sc1
  buffer_load_dwordx4 a[36:39], v49, s[4:7], s93 offen sc1
  s_add_u32 s60, s60, 1024
  s_lshr_b32 s93, s85, 6
  s_add_u32 s93, s93, s60
  s_and_b32 s93, s93, 0x7fff
  s_add_u32 s93, s93, s57
  buffer_load_dwordx4 a[40:43], v48, s[4:7], s93 offen sc1
  buffer_load_dwordx4 a[44:47], v49, s[4:7], s93 offen sc1
  s_add_u32 s60, s60, 1024
  ds_read_b64_tr_b16 a[112:113], v40 offset:0
  ds_read_b64_tr_b16 a[114:115], v40 offset:2048
  ds_read_b64_tr_b16 a[128:129], v40 offset:4096
  ds_read_b64_tr_b16 a[130:131], v40 offset:6144
  ds_read_b64_tr_b16 a[116:117], v41 offset:0
  ds_read_b64_tr_b16 a[118:119], v41 offset:2048
  ds_read_b64_tr_b16 a[132:133], v41 offset:4096
  ds_read_b64_tr_b16 a[134:135], v41 offset:6144
  ds_read_b64_tr_b16 a[120:121], v42 offset:0
  ds_read_b64_tr_b16 a[122:123], v42 offset:2048
  ds_read_b64_tr_b16 a[136:137], v42 offset:4096
  ds_read_b64_tr_b16 a[138:139], v42 offset:6144
  ds_read_b64_tr_b16 a[124:125], v43 offset:0
  ds_read_b64_tr_b16 a[126:127], v43 offset:2048
  ds_read_b64_tr_b16 a[140:141], v43 offset:4096
  ds_read_b64_tr_b16 a[142:143], v43 offset:6144
  s_mov_b32 s56, 3
.p2align 3
Lp2_loop:
  s_waitcnt vmcnt(8) lgkmcnt(12)
  v_mfma_f32_16x16x32_bf16 v[0:3], a[112:115], a[0:3], v[0:3]
  ds_read_b64_tr_b16 a[144:145], v40 offset:8192
  v_mfma_f32_16x16x32_bf16 v[0:3], a[128:131], a[8:11], v[0:3]
  ds_read_b64_tr_b16 a[146:147], v40 offset:10240
  s_lshr_b32 s93, s86, 6
  s_add_u32 s93, s93, s60
  s_and_b32 s93, s93, 0x7fff
  s_add_u32 s93, s93, s57
  buffer_load_dwordx4 a[48:51], v48, s[4:7], s93 offen sc1
  v_mfma_f32_16x16x32_bf16 v[4:7], a[128:131], a[12:15], v[4:7]
  ds_read_b64_tr_b16 a[160:161], v40 offset:12288
  v_mfma_f32_16x16x32_bf16 v[4:7], a[112:115], a[4:7], v[4:7]
  ds_read_b64_tr_b16 a[162:163], v40 offset:14336
  s_waitcnt lgkmcnt(12)
  v_mfma_f32_16x16x32_bf16 v[12:15], a[116:119], a[4:7], v[12:15]
  ds_read_b64_tr_b16 a[148:149], v41 offset:8192
  buffer_load_dwordx4 a[52:55], v49, s[4:7], s93 offen sc1
  s_add_u32 s60, s60, 1024
  v_mfma_f32_16x16x32_bf16 v[12:15], a[132:135], a[12:15], v[12:15]
  ds_read_b64_tr_b16 a[150:151], v41 offset:10240
  v_mfma_f32_16x16x32_bf16 v[8:11], a[132:135], a[8:11], v[8:11]
  ds_read_b64_tr_b16 a[164:165], v41 offset:12288
  v_mfma_f32_16x16x32_bf16 v[8:11], a[116:119], a[0:3], v[8:11]
  ds_read_b64_tr_b16 a[166:167], v41 offset:14336
  s_waitcnt lgkmcnt(12)
  v_mfma_f32_16x16x32_bf16 v[16:19], a[120:123], a[0:3], v[16:19]
  ds_read_b64_tr_b16 a[152:153], v42 offset:8192
  s_lshr_b32 s93, s87, 6
  s_add_u32 s93, s93, s60
  s_and_b32 s93, s93, 0x7fff
  s_add_u32 s93, s93, s57
  buffer_load_dwordx4 a[56:59], v48, s[4:7], s93 offen sc1
  v_mfma_f32_16x16x32_bf16 v[16:19], a[136:139], a[8:11], v[16:19]
  ds_read_b64_tr_b16 a[154:155], v42 offset:10240
  v_mfma_f32_16x16x32_bf16 v[20:23], a[136:139], a[12:15], v[20:23]
  ds_read_b64_tr_b16 a[168:169], v42 offset:12288
  v_mfma_f32_16x16x32_bf16 v[20:23], a[120:123], a[4:7], v[20:23]
  ds_read_b64_tr_b16 a[170:171], v42 offset:14336
  buffer_load_dwordx4 a[60:63], v49, s[4:7], s93 offen sc1
  s_add_u32 s60, s60, 1024
  s_waitcnt lgkmcnt(12)
  v_mfma_f32_16x16x32_bf16 v[28:31], a[124:127], a[4:7], v[28:31]
  ds_read_b64_tr_b16 a[156:157], v43 offset:8192
  v_mfma_f32_16x16x32_bf16 v[28:31], a[140:143], a[12:15], v[28:31]
  ds_read_b64_tr_b16 a[158:159], v43 offset:10240
  v_mfma_f32_16x16x32_bf16 v[24:27], a[140:143], a[8:11], v[24:27]
  ds_read_b64_tr_b16 a[172:173], v43 offset:12288
  v_mfma_f32_16x16x32_bf16 v[24:27], a[124:127], a[0:3], v[24:27]
  ds_read_b64_tr_b16 a[174:175], v43 offset:14336
  s_waitcnt vmcnt(8) lgkmcnt(12)
  v_mfma_f32_16x16x32_bf16 v[0:3], a[144:147], a[16:19], v[0:3]
  ds_read_b64_tr_b16 a[112:113], v40 offset:16384
  v_mfma_f32_16x16x32_bf16 v[0:3], a[160:163], a[24:27], v[0:3]
  ds_read_b64_tr_b16 a[114:115], v40 offset:18432
  s_lshr_b32 s93, s80, 6
  s_add_u32 s93, s93, s60
  s_and_b32 s93, s93, 0x7fff
  s_add_u32 s93, s93, s57
  buffer_load_dwordx4 a[0:3], v48, s[4:7], s93 offen sc1
  v_mfma_f32_16x16x32_bf16 v[4:7], a[160:163], a[28:31], v[4:7]
  ds_read_b64_tr_b16 a[128:129], v40 offset:20480
  v_mfma_f32_16x16x32_bf16 v[4:7], a[144:147], a[20:23], v[4:7]
  ds_read_b64_tr_b16 a[130:131], v40 offset:22528
  s_waitcnt lgkmcnt(12)
  v_mfma_f32_16x16x32_bf16 v[12:15], a[148:151], a[20:23], v[12:15]
  ds_read_b64_tr_b16 a[116:117], v41 offset:16384
  buffer_load_dwordx4 a[4:7], v49, s[4:7], s93 offen sc1
  s_add_u32 s60, s60, 1024
  v_mfma_f32_16x16x32_bf16 v[12:15], a[164:167], a[28:31], v[12:15]
  ds_read_b64_tr_b16 a[118:119], v41 offset:18432
  v_mfma_f32_16x16x32_bf16 v[8:11], a[164:167], a[24:27], v[8:11]
  ds_read_b64_tr_b16 a[132:133], v41 offset:20480
  v_mfma_f32_16x16x32_bf16 v[8:11], a[148:151], a[16:19], v[8:11]
  ds_read_b64_tr_b16 a[134:135], v41 offset:22528
  s_waitcnt lgkmcnt(12)
  v_mfma_f32_16x16x32_bf16 v[16:19], a[152:155], a[16:19], v[16:19]
  ds_read_b64_tr_b16 a[120:121], v42 offset:16384
  s_lshr_b32 s93, s81, 6
  s_add_u32 s93, s93, s60
  s_and_b32 s93, s93, 0x7fff
  s_add_u32 s93, s93, s57
  buffer_load_dwordx4 a[8:11], v48, s[4:7], s93 offen sc1
  v_mfma_f32_16x16x32_bf16 v[16:19], a[168:171], a[24:27], v[16:19]
  ds_read_b64_tr_b16 a[122:123], v42 offset:18432
  v_mfma_f32_16x16x32_bf16 v[20:23], a[168:171], a[28:31], v[20:23]
  ds_read_b64_tr_b16 a[136:137], v42 offset:20480
  v_mfma_f32_16x16x32_bf16 v[20:23], a[152:155], a[20:23], v[20:23]
  ds_read_b64_tr_b16 a[138:139], v42 offset:22528
  buffer_load_dwordx4 a[12:15], v49, s[4:7], s93 offen sc1
  s_add_u32 s60, s60, 1024
  s_waitcnt lgkmcnt(12)
  v_mfma_f32_16x16x32_bf16 v[28:31], a[156:159], a[20:23], v[28:31]
  ds_read_b64_tr_b16 a[124:125], v43 offset:16384
  v_mfma_f32_16x16x32_bf16 v[28:31], a[172:175], a[28:31], v[28:31]
  ds_read_b64_tr_b16 a[126:127], v43 offset:18432
  v_mfma_f32_16x16x32_bf16 v[24:27], a[172:175], a[24:27], v[24:27]
  ds_read_b64_tr_b16 a[140:141], v43 offset:20480
  v_mfma_f32_16x16x32_bf16 v[24:27], a[156:159], a[16:19], v[24:27]
  ds_read_b64_tr_b16 a[142:143], v43 offset:22528
  s_waitcnt vmcnt(8) lgkmcnt(12)
  v_mfma_f32_16x16x32_bf16 v[0:3], a[112:115], a[32:35], v[0:3]
  ds_read_b64_tr_b16 a[144:145], v40 offset:24576
  v_mfma_f32_16x16x32_bf16 v[0:3], a[128:131], a[40:43], v[0:3]
  ds_read_b64_tr_b16 a[146:147], v40 offset:26624
  s_lshr_b32 s93, s82, 6
  s_add_u32 s93, s93, s60
  s_and_b32 s93, s93, 0x7fff
  s_add_u32 s93, s93, s57
  buffer_load_dwordx4 a[16:19], v48, s[4:7], s93 offen sc1
  v_mfma_f32_16x16x32_bf16 v[4:7], a[128:131], a[44:47], v[4:7]
  ds_read_b64_tr_b16 a[160:161], v40 offset:28672
  v_mfma_f32_16x16x32_bf16 v[4:7], a[112:115], a[36:39], v[4:7]
  ds_read_b64_tr_b16 a[162:163], v40 offset:30720
  v_add_u32 v40, 32768, v40
  s_waitcnt lgkmcnt(12)
  v_mfma_f32_16x16x32_bf16 v[12:15], a[116:119], a[36:39], v[12:15]
  ds_read_b64_tr_b16 a[148:149], v41 offset:24576
  buffer_load_dwordx4 a[20:23], v49, s[4:7], s93 offen sc1
  s_add_u32 s60, s60, 1024
  v_mfma_f32_16x16x32_bf16 v[12:15], a[132:135], a[44:47], v[12:15]
  ds_read_b64_tr_b16 a[150:151], v41 offset:26624
  v_mfma_f32_16x16x32_bf16 v[8:11], a[132:135], a[40:43], v[8:11]
  ds_read_b64_tr_b16 a[164:165], v41 offset:28672
  v_mfma_f32_16x16x32_bf16 v[8:11], a[116:119], a[32:35], v[8:11]
  ds_read_b64_tr_b16 a[166:167], v41 offset:30720
  v_add_u32 v41, 32768, v41
  s_waitcnt lgkmcnt(12)
  v_mfma_f32_16x16x32_bf16 v[16:19], a[120:123], a[32:35], v[16:19]
  ds_read_b64_tr_b16 a[152:153], v42 offset:24576
  s_lshr_b32 s93, s83, 6
  s_add_u32 s93, s93, s60
  s_and_b32 s93, s93, 0x7fff
  s_add_u32 s93, s93, s57
  buffer_load_dwordx4 a[24:27], v48, s[4:7], s93 offen sc1
  v_mfma_f32_16x16x32_bf16 v[16:19], a[136:139], a[40:43], v[16:19]
  ds_read_b64_tr_b16 a[154:155], v42 offset:26624
  v_mfma_f32_16x16x32_bf16 v[20:23], a[136:139], a[44:47], v[20:23]
  ds_read_b64_tr_b16 a[168:169], v42 offset:28672
  v_mfma_f32_16x16x32_bf16 v[20:23], a[120:123], a[36:39], v[20:23]
  ds_read_b64_tr_b16 a[170:171], v42 offset:30720
  v_add_u32 v42, 32768, v42
  buffer_load_dwordx4 a[28:31], v49, s[4:7], s93 offen sc1
  s_add_u32 s60, s60, 1024
  s_waitcnt lgkmcnt(12)
  v_mfma_f32_16x16x32_bf16 v[28:31], a[124:127], a[36:39], v[28:31]
  ds_read_b64_tr_b16 a[156:157], v43 offset:24576
  v_mfma_f32_16x16x32_bf16 v[28:31], a[140:143], a[44:47], v[28:31]
  ds_read_b64_tr_b16 a[158:159], v43 offset:26624
  v_mfma_f32_16x16x32_bf16 v[24:27], a[140:143], a[40:43], v[24:27]
  ds_read_b64_tr_b16 a[172:173], v43 offset:28672
  v_mfma_f32_16x16x32_bf16 v[24:27], a[124:127], a[32:35], v[24:27]
  ds_read_b64_tr_b16 a[174:175], v43 offset:30720
  v_add_u32 v43, 32768, v43
  s_waitcnt vmcnt(8) lgkmcnt(12)
  v_mfma_f32_16x16x32_bf16 v[0:3], a[144:147], a[48:51], v[0:3]
  ds_read_b64_tr_b16 a[112:113], v40 offset:0
  v_mfma_f32_16x16x32_bf16 v[0:3], a[160:163], a[56:59], v[0:3]
  ds_read_b64_tr_b16 a[114:115], v40 offset:2048
  s_lshr_b32 s93, s84, 6
  s_add_u32 s93, s93, s60
  s_and_b32 s93, s93, 0x7fff
  s_add_u32 s93, s93, s57
  buffer_load_dwordx4 a[32:35], v48, s[4:7], s93 offen sc1
  v_mfma_f32_16x16x32_bf16 v[4:7], a[160:163], a[60:63], v[4:7]
  ds_read_b64_tr_b16 a[128:129], v40 offset:4096
  v_mfma_f32_16x16x32_bf16 v[4:7], a[144:147], a[52:55], v[4:7]
  ds_read_b64_tr_b16 a[130:131], v40 offset:6144
  s_waitcnt lgkmcnt(12)
  v_mfma_f32_16x16x32_bf16 v[12:15], a[148:151], a[52:55], v[12:15]
  ds_read_b64_tr_b16 a[116:117], v41 offset:0
  buffer_load_dwordx4 a[36:39], v49, s[4:7], s93 offen sc1
  s_add_u32 s60, s60, 1024
  v_mfma_f32_16x16x32_bf16 v[12:15], a[164:167], a[60:63], v[12:15]
  ds_read_b64_tr_b16 a[118:119], v41 offset:2048
  v_mfma_f32_16x16x32_bf16 v[8:11], a[164:167], a[56:59], v[8:11]
  ds_read_b64_tr_b16 a[132:133], v41 offset:4096
  v_mfma_f32_16x16x32_bf16 v[8:11], a[148:151], a[48:51], v[8:11]
  ds_read_b64_tr_b16 a[134:135], v41 offset:6144
  s_waitcnt lgkmcnt(12)
  v_mfma_f32_16x16x32_bf16 v[16:19], a[152:155], a[48:51], v[16:19]
  ds_read_b64_tr_b16 a[120:121], v42 offset:0
  s_lshr_b32 s93, s85, 6
  s_add_u32 s93, s93, s60
  s_and_b32 s93, s93, 0x7fff
  s_add_u32 s93, s93, s57
  buffer_load_dwordx4 a[40:43], v48, s[4:7], s93 offen sc1
  v_mfma_f32_16x16x32_bf16 v[16:19], a[168:171], a[56:59], v[16:19]
  ds_read_b64_tr_b16 a[122:123], v42 offset:2048
  v_mfma_f32_16x16x32_bf16 v[20:23], a[168:171], a[60:63], v[20:23]
  ds_read_b64_tr_b16 a[136:137], v42 offset:4096
  v_mfma_f32_16x16x32_bf16 v[20:23], a[152:155], a[52:55], v[20:23]
  ds_read_b64_tr_b16 a[138:139], v42 offset:6144
  buffer_load_dwordx4 a[44:47], v49, s[4:7], s93 offen sc1
  s_add_u32 s60, s60, 1024
  s_waitcnt lgkmcnt(12)
  v_mfma_f32_16x16x32_bf16 v[28:31], a[156:159], a[52:55], v[28:31]
  ds_read_b64_tr_b16 a[124:125], v43 offset:0
  v_mfma_f32_16x16x32_bf16 v[28:31], a[172:175], a[60:63], v[28:31]
  ds_read_b64_tr_b16 a[126:127], v43 offset:2048
  v_mfma_f32_16x16x32_bf16 v[24:27], a[172:175], a[56:59], v[24:27]
  ds_read_b64_tr_b16 a[140:141], v43 offset:4096
  v_mfma_f32_16x16x32_bf16 v[24:27], a[156:159], a[48:51], v[24:27]
  ds_read_b64_tr_b16 a[142:143], v43 offset:6144
  s_sub_u32 s56, s56, 1
  s_cmp_lg_u32 s56, 0
  s_cbranch_scc1 Lp2_loop
  s_waitcnt vmcnt(8) lgkmcnt(12)
  v_mfma_f32_16x16x32_bf16 v[0:3], a[112:115], a[0:3], v[0:3]
  ds_read_b64_tr_b16 a[144:145], v40 offset:8192
  v_mfma_f32_16x16x32_bf16 v[0:3], a[128:131], a[8:11], v[0:3]
  ds_read_b64_tr_b16 a[146:147], v40 offset:10240
  s_lshr_b32 s93, s86, 6
  s_add_u32 s93, s93, s60
  s_and_b32 s93, s93, 0x7fff
  s_add_u32 s93, s93, s57
  buffer_load_dwordx4 a[48:51], v48, s[4:7], s93 offen sc1
  v_mfma_f32_16x16x32_bf16 v[4:7], a[128:131], a[12:15], v[4:7]
  ds_read_b64_tr_b16 a[160:161], v40 offset:12288
  v_mfma_f32_16x16x32_bf16 v[4:7], a[112:115], a[4:7], v[4:7]
  ds_read_b64_tr_b16 a[162:163], v40 offset:14336
  s_waitcnt lgkmcnt(12)
  v_mfma_f32_16x16x32_bf16 v[12:15], a[116:119], a[4:7], v[12:15]
  ds_read_b64_tr_b16 a[148:149], v41 offset:8192
  buffer_load_dwordx4 a[52:55], v49, s[4:7], s93 offen sc1
  s_add_u32 s60, s60, 1024
  v_mfma_f32_16x16x32_bf16 v[12:15], a[132:135], a[12:15], v[12:15]
  ds_read_b64_tr_b16 a[150:151], v41 offset:10240
  v_mfma_f32_16x16x32_bf16 v[8:11], a[132:135], a[8:11], v[8:11]
  ds_read_b64_tr_b16 a[164:165], v41 offset:12288
  v_mfma_f32_16x16x32_bf16 v[8:11], a[116:119], a[0:3], v[8:11]
  ds_read_b64_tr_b16 a[166:167], v41 offset:14336
  s_waitcnt lgkmcnt(12)
  v_mfma_f32_16x16x32_bf16 v[16:19], a[120:123], a[0:3], v[16:19]
  ds_read_b64_tr_b16 a[152:153], v42 offset:8192
  s_lshr_b32 s93, s87, 6
  s_add_u32 s93, s93, s60
  s_and_b32 s93, s93, 0x7fff
  s_add_u32 s93, s93, s57
  buffer_load_dwordx4 a[56:59], v48, s[4:7], s93 offen sc1
  v_mfma_f32_16x16x32_bf16 v[16:19], a[136:139], a[8:11], v[16:19]
  ds_read_b64_tr_b16 a[154:155], v42 offset:10240
  v_mfma_f32_16x16x32_bf16 v[20:23], a[136:139], a[12:15], v[20:23]
  ds_read_b64_tr_b16 a[168:169], v42 offset:12288
  v_mfma_f32_16x16x32_bf16 v[20:23], a[120:123], a[4:7], v[20:23]
  ds_read_b64_tr_b16 a[170:171], v42 offset:14336
  buffer_load_dwordx4 a[60:63], v49, s[4:7], s93 offen sc1
  s_add_u32 s60, s60, 1024
  s_waitcnt lgkmcnt(12)
  v_mfma_f32_16x16x32_bf16 v[28:31], a[124:127], a[4:7], v[28:31]
  ds_read_b64_tr_b16 a[156:157], v43 offset:8192
  v_mfma_f32_16x16x32_bf16 v[28:31], a[140:143], a[12:15], v[28:31]
  ds_read_b64_tr_b16 a[158:159], v43 offset:10240
  v_mfma_f32_16x16x32_bf16 v[24:27], a[140:143], a[8:11], v[24:27]
  ds_read_b64_tr_b16 a[172:173], v43 offset:12288
  v_mfma_f32_16x16x32_bf16 v[24:27], a[124:127], a[0:3], v[24:27]
  ds_read_b64_tr_b16 a[174:175], v43 offset:14336
  s_waitcnt vmcnt(8) lgkmcnt(12)
  v_mfma_f32_16x16x32_bf16 v[0:3], a[144:147], a[16:19], v[0:3]
  s_barrier
  ds_read_b64_tr_b16 a[112:113], v40 offset:16384
  v_mfma_f32_16x16x32_bf16 v[0:3], a[160:163], a[24:27], v[0:3]
  ds_read_b64_tr_b16 a[114:115], v40 offset:18432
  v_mfma_f32_16x16x32_bf16 v[4:7], a[160:163], a[28:31], v[4:7]
  ds_read_b64_tr_b16 a[128:129], v40 offset:20480
  v_mfma_f32_16x16x32_bf16 v[4:7], a[144:147], a[20:23], v[4:7]
  ds_read_b64_tr_b16 a[130:131], v40 offset:22528
  s_waitcnt lgkmcnt(12)
  v_mfma_f32_16x16x32_bf16 v[12:15], a[148:151], a[20:23], v[12:15]
  ds_read_b64_tr_b16 a[116:117], v41 offset:16384
  v_mfma_f32_16x16x32_bf16 v[12:15], a[164:167], a[28:31], v[12:15]
  ds_read_b64_tr_b16 a[118:119], v41 offset:18432
  v_mfma_f32_16x16x32_bf16 v[8:11], a[164:167], a[24:27], v[8:11]
  ds_read_b64_tr_b16 a[132:133], v41 offset:20480
  v_mfma_f32_16x16x32_bf16 v[8:11], a[148:151], a[16:19], v[8:11]
  ds_read_b64_tr_b16 a[134:135], v41 offset:22528
  s_waitcnt lgkmcnt(12)
  v_mfma_f32_16x16x32_bf16 v[16:19], a[152:155], a[16:19], v[16:19]
  ds_read_b64_tr_b16 a[120:121], v42 offset:16384
  v_mfma_f32_16x16x32_bf16 v[16:19], a[168:171], a[24:27], v[16:19]
  ds_read_b64_tr_b16 a[122:123], v42 offset:18432
  v_mfma_f32_16x16x32_bf16 v[20:23], a[168:171], a[28:31], v[20:23]
  ds_read_b64_tr_b16 a[136:137], v42 offset:20480
  v_mfma_f32_16x16x32_bf16 v[20:23], a[152:155], a[20:23], v[20:23]
  ds_read_b64_tr_b16 a[138:139], v42 offset:22528
  s_waitcnt lgkmcnt(12)
  v_mfma_f32_16x16x32_bf16 v[28:31], a[156:159], a[20:23], v[28:31]
  ds_read_b64_tr_b16 a[124:125], v43 offset:16384
  v_mfma_f32_16x16x32_bf16 v[28:31], a[172:175], a[28:31], v[28:31]
  ds_read_b64_tr_b16 a[126:127], v43 offset:18432
  v_mfma_f32_16x16x32_bf16 v[24:27], a[172:175], a[24:27], v[24:27]
  ds_read_b64_tr_b16 a[140:141], v43 offset:20480
  v_mfma_f32_16x16x32_bf16 v[24:27], a[156:159], a[16:19], v[24:27]
  ds_read_b64_tr_b16 a[142:143], v43 offset:22528
  s_waitcnt vmcnt(4) lgkmcnt(12)
  v_mfma_f32_16x16x32_bf16 v[0:3], a[112:115], a[32:35], v[0:3]
  ds_read_b64_tr_b16 a[144:145], v40 offset:24576
  v_mfma_f32_16x16x32_bf16 v[0:3], a[128:131], a[40:43], v[0:3]
  ds_read_b64_tr_b16 a[146:147], v40 offset:26624
  v_mfma_f32_16x16x32_bf16 v[4:7], a[128:131], a[44:47], v[4:7]
  ds_read_b64_tr_b16 a[160:161], v40 offset:28672
  v_mfma_f32_16x16x32_bf16 v[4:7], a[112:115], a[36:39], v[4:7]
  ds_read_b64_tr_b16 a[162:163], v40 offset:30720
  v_add_u32 v40, 32768, v40
  s_waitcnt lgkmcnt(12)
  v_mfma_f32_16x16x32_bf16 v[12:15], a[116:119], a[36:39], v[12:15]
  ds_read_b64_tr_b16 a[148:149], v41 offset:24576
  v_mfma_f32_16x16x32_bf16 v[12:15], a[132:135], a[44:47], v[12:15]
  ds_read_b64_tr_b16 a[150:151], v41 offset:26624
  v_mfma_f32_16x16x32_bf16 v[8:11], a[132:135], a[40:43], v[8:11]
  ds_read_b64_tr_b16 a[164:165], v41 offset:28672
  v_mfma_f32_16x16x32_bf16 v[8:11], a[116:119], a[32:35], v[8:11]
  ds_read_b64_tr_b16 a[166:167], v41 offset:30720
  v_add_u32 v41, 32768, v41
  s_waitcnt lgkmcnt(12)
  v_mfma_f32_16x16x32_bf16 v[16:19], a[120:123], a[32:35], v[16:19]
  ds_read_b64_tr_b16 a[152:153], v42 offset:24576
  v_mfma_f32_16x16x32_bf16 v[16:19], a[136:139], a[40:43], v[16:19]
  ds_read_b64_tr_b16 a[154:155], v42 offset:26624
  v_mfma_f32_16x16x32_bf16 v[20:23], a[136:139], a[44:47], v[20:23]
  ds_read_b64_tr_b16 a[168:169], v42 offset:28672
  v_mfma_f32_16x16x32_bf16 v[20:23], a[120:123], a[36:39], v[20:23]
  ds_read_b64_tr_b16 a[170:171], v42 offset:30720
  v_add_u32 v42, 32768, v42
  s_waitcnt lgkmcnt(12)
  v_mfma_f32_16x16x32_bf16 v[28:31], a[124:127], a[36:39], v[28:31]
  ds_read_b64_tr_b16 a[156:157], v43 offset:24576
  v_mfma_f32_16x16x32_bf16 v[28:31], a[140:143], a[44:47], v[28:31]
  ds_read_b64_tr_b16 a[158:159], v43 offset:26624
  v_mfma_f32_16x16x32_bf16 v[24:27], a[140:143], a[40:43], v[24:27]
  ds_read_b64_tr_b16 a[172:173], v43 offset:28672
  v_mfma_f32_16x16x32_bf16 v[24:27], a[124:127], a[32:35], v[24:27]
  ds_read_b64_tr_b16 a[174:175], v43 offset:30720
  v_add_u32 v43, 32768, v43
  s_waitcnt vmcnt(0) lgkmcnt(12)
  v_mfma_f32_16x16x32_bf16 v[0:3], a[144:147], a[48:51], v[0:3]
  v_mfma_f32_16x16x32_bf16 v[0:3], a[160:163], a[56:59], v[0:3]
  v_mfma_f32_16x16x32_bf16 v[4:7], a[160:163], a[60:63], v[4:7]
  v_mfma_f32_16x16x32_bf16 v[4:7], a[144:147], a[52:55], v[4:7]
  s_waitcnt lgkmcnt(8)
  v_mfma_f32_16x16x32_bf16 v[12:15], a[148:151], a[52:55], v[12:15]
  v_mfma_f32_16x16x32_bf16 v[12:15], a[164:167], a[60:63], v[12:15]
  v_mfma_f32_16x16x32_bf16 v[8:11], a[164:167], a[56:59], v[8:11]
  v_mfma_f32_16x16x32_bf16 v[8:11], a[148:151], a[48:51], v[8:11]
  s_waitcnt lgkmcnt(4)
  v_mfma_f32_16x16x32_bf16 v[16:19], a[152:155], a[48:51], v[16:19]
  v_mfma_f32_16x16x32_bf16 v[16:19], a[168:171], a[56:59], v[16:19]
  v_mfma_f32_16x16x32_bf16 v[20:23], a[168:171], a[60:63], v[20:23]
  v_mfma_f32_16x16x32_bf16 v[20:23], a[152:155], a[52:55], v[20:23]
  s_waitcnt lgkmcnt(0)
  v_mfma_f32_16x16x32_bf16 v[28:31], a[156:159], a[52:55], v[28:31]
  v_mfma_f32_16x16x32_bf16 v[28:31], a[172:175], a[60:63], v[28:31]
  v_mfma_f32_16x16x32_bf16 v[24:27], a[172:175], a[56:59], v[24:27]
  v_mfma_f32_16x16x32_bf16 v[24:27], a[156:159], a[48:51], v[24:27]
  s_add_u32 s46, s59, 4194304
  s_add_u32 s47, s46, 32768
  s_lshl_b32 s48, s58, 11
  s_lshl_b32 s43, s53, 7
  s_add_u32 s48, s48, s43
  s_add_u32 s48, s48, s42
  s_add_u32 s48, s48, 27525120
  s_nop 0
  v_cvt_pk_bf16_f32 v52, v0, v1
  v_cvt_pk_bf16_f32 v53, v2, v3
  v_cvt_pk_bf16_f32 v54, v8, v9
  v_cvt_pk_bf16_f32 v55, v10, v11
  buffer_store_dwordx4 v[52:55], v48, s[4:7], s46 offen offset:0 sc1
  v_cvt_pk_bf16_f32 v60, v4, v5
  v_cvt_pk_bf16_f32 v61, v6, v7
  v_cvt_pk_bf16_f32 v62, v12, v13
  v_cvt_pk_bf16_f32 v63, v14, v15
  buffer_store_dwordx4 v[60:63], v48, s[4:7], s47 offen offset:0 sc1
  v_cvt_pk_bf16_f32 v56, v16, v17
  v_cvt_pk_bf16_f32 v57, v18, v19
  v_cvt_pk_bf16_f32 v58, v24, v25
  v_cvt_pk_bf16_f32 v59, v26, v27
  buffer_store_dwordx4 v[56:59], v48, s[4:7], s46 offen offset:1024 sc1
  v_cvt_pk_bf16_f32 v64, v20, v21
  v_cvt_pk_bf16_f32 v65, v22, v23
  v_cvt_pk_bf16_f32 v66, v28, v29
  v_cvt_pk_bf16_f32 v67, v30, v31
  buffer_store_dwordx4 v[64:67], v48, s[4:7], s47 offen offset:1024 sc1
  v_mov_b32 v72, 0x3f803f80
  v_mov_b32 v73, 0x3f803f80
  v_mov_b32 v74, 0x3f803f80
  v_mov_b32 v75, 0x3f803f80
  v_and_b32 v92, 15, v253
  v_lshrrev_b32 v93, 4, v253
  v_mfma_f32_16x16x32_bf16 v[76:79], v[72:75], v[52:55], 0
  v_mfma_f32_16x16x32_bf16 v[80:83], v[52:55], v[52:55], 0
  v_mfma_f32_16x16x32_bf16 v[84:87], v[72:75], v[60:63], 0
  v_mfma_f32_16x16x32_bf16 v[88:91], v[60:63], v[60:63], 0
  v_mfma_f32_16x16x32_bf16 v[76:79], v[72:75], v[56:59], v[76:79]
  v_mfma_f32_16x16x32_bf16 v[80:83], v[56:59], v[56:59], v[80:83]
  v_mfma_f32_16x16x32_bf16 v[84:87], v[72:75], v[64:67], v[84:87]
  v_mfma_f32_16x16x32_bf16 v[88:91], v[64:67], v[64:67], v[88:91]
  v_lshrrev_b32 v72, 2, v92
  v_cmp_eq_u32 s[64:65], v72, v93
  v_and_b32 v72, 3, v92
  v_cmp_eq_u32 s[66:67], 1, v72
  v_cmp_eq_u32 s[68:69], 2, v72
  v_cmp_eq_u32 s[70:71], 3, v72
  v_lshlrev_b32 v92, 3, v92
  v_mov_b32 v93, 0x7ffffff0
  s_nop 0
  v_cndmask_b32 v92, v93, v92, s[64:65]
  v_cndmask_b32 v77, v80, v81, s[66:67]
  v_cndmask_b32 v77, v77, v82, s[68:69]
  v_cndmask_b32 v77, v77, v83, s[70:71]
  buffer_store_dwordx2 v[76:77], v92, s[4:7], s48 offen offset:0 sc1
  v_cndmask_b32 v85, v88, v89, s[66:67]
  v_cndmask_b32 v85, v85, v90, s[68:69]
  v_cndmask_b32 v85, v85, v91, s[70:71]
  buffer_store_dwordx2 v[84:85], v92, s[4:7], s48 offen offset:2048 sc1
  s_lshr_b32 s77, s52, 1
  s_lshl_b32 s77, s77, 7
  s_add_u32 s77, s77, s42
  s_add_u32 s77, s77, 27789312
  s_and_b32 s66, s55, 1
  v_lshrrev_b32 v2, 4, v253
  v_bfe_u32 v3, v253, 1, 3
  v_and_b32 v4, 1, v253
  v_lshlrev_b32 v4, 4, v4
  v_mul_u32_u24 v5, 7168, v2
  v_add_u32 v5, v5, v4
  s_cmp_eq_u32 s66, 0
  s_cselect_b32 s44, 7, 0
  v_mov_b32 v7, 0x40000000
  v_add_u32 v6, 0, v2
  v_xor_b32 v6, v6, v3
  v_cmp_eq_u32 vcc, s44, v6
  v_lshl_add_u32 v6, v6, 5, v5
  v_add_u32 v6, 0, v6
  v_cndmask_b32 v232, v6, v7, vcc
  v_add_u32 v6, 4, v2
  v_xor_b32 v6, v6, v3
  v_cmp_eq_u32 vcc, s44, v6
  v_lshl_add_u32 v6, v6, 5, v5
  v_add_u32 v6, 27648, v6
  v_cndmask_b32 v233, v6, v7, vcc
  v_add_u32 v6, 0, v2
  v_xor_b32 v6, v6, v3
  v_cmp_eq_u32 vcc, s44, v6
  v_lshl_add_u32 v6, v6, 5, v5
  v_add_u32 v6, 55296, v6
  v_cndmask_b32 v234, v6, v7, vcc
  v_add_u32 v6, 4, v2
  v_xor_b32 v6, v6, v3
  v_cmp_eq_u32 vcc, s44, v6
  v_lshl_add_u32 v6, v6, 5, v5
  v_add_u32 v6, 82944, v6
  v_cndmask_b32 v235, v6, v7, vcc
  s_mul_i32 s67, s55, 224
  s_and_b32 s67, s67, 0xffffffc0
  s_mul_i32 s43, s40, 114688
  s_add_u32 s67, s67, s43
  s_lshl_b32 s68, s40, 12
  v_lshlrev_b32 v231, 4, v253
  s_lshl_b32 s43, s41, 30
  v_or_b32 v236, s43, v231
  s_lshl_b32 s43, s2, 2
  s_add_u32 s43, s43, s40
  s_mul_i32 s70, s43, 7168
  s_lshl_b32 s69, s54, 2
  s_add_u32 s69, s69, s40
  s_lshl_b32 s72, s69, 17
  s_add_u32 s72, s72, s42
  s_add_u32 s72, s72, 4194304
  s_add_u32 s73, s72, 32768
  s_add_u32 s74, s73, 32768
  s_add_u32 s75, s74, 32768
  s_lshl_b32 s71, s40, 11
  s_add_u32 s71, s71, 131072
  v_lshrrev_b32 v2, 2, v253
  v_and_b32 v3, 7, v2
  v_and_b32 v4, 3, v253
  v_lshlrev_b32 v5, 3, v4
  v_lshl_add_u32 v5, v2, 8, v5
  s_lshl_b32 s43, s66, 1
  s_cmp_eq_u32 s66, 0
  s_cselect_b32 s45, 6, 1
  s_add_u32 s46, s43, 0
  v_xor_b32 v6, s46, v3
  v_lshl_add_u32 v224, v6, 5, v5
  s_add_u32 s46, s43, 1
  v_xor_b32 v6, s46, v3
  v_lshl_add_u32 v225, v6, 5, v5
  s_add_u32 s46, s43, 2
  v_xor_b32 v6, s46, v3
  v_lshl_add_u32 v226, v6, 5, v5
  s_add_u32 s46, s43, 3
  v_xor_b32 v6, s46, v3
  v_lshl_add_u32 v227, v6, 5, v5
  s_add_u32 s46, s43, 4
  v_xor_b32 v6, s46, v3
  v_lshl_add_u32 v228, v6, 5, v5
  s_add_u32 s46, s43, 5
  v_xor_b32 v6, s46, v3
  v_lshl_add_u32 v229, v6, 5, v5
  v_xor_b32 v6, s45, v3
  v_lshl_add_u32 v230, v6, 5, v5
  s_mul_i32 s46, s55, 448
  s_add_u32 s46, s46, 27918336
  s_add_u32 s47, s46, 28672
  s_lshr_b32 s48, s55, 3
  s_lshl_b32 s48, s48, 7
  s_add_u32 s48, s48, 27792384
  s_lshl_b32 s44, s69, 13
  s_add_u32 s44, s44, s42
  s_add_u32 s44, s44, 27525120
  s_add_u32 s45, s44, 4096
  s_waitcnt vmcnt(0)
  s_barrier
  s_cmp_lg_u32 s40, 0
  s_cbranch_scc1 Lsig12
  v_mov_b32 v250, 1
  s_mov_b64 exec, 1
  buffer_atomic_add v250, v251, s[4:7], s77 offen sc1
  s_mov_b64 exec, -1
Lsig12:
  s_cmp_eq_u32 s3, 0
  s_cbranch_scc1 Lsd13
  s_bfe_u32 s43, s2, 0x20001
  s_lshl_b32 s43, s43, 7
  s_add_u32 s43, s43, 27792384
  v_mov_b32 v250, 1
  s_mov_b64 exec, 1
  buffer_atomic_add v250, v251, s[4:7], s43 offen sc1
  s_mov_b64 exec, -1
Lsd13:
  s_add_u32 m0, s68, 0
  s_nop 0
  buffer_load_dwordx4 v232, s[16:19], s67 offen offset:0 lds
  buffer_load_dwordx4 v233, s[16:19], s67 offen offset:1024 lds
  buffer_load_dwordx4 v234, s[16:19], s67 offen offset:2048 lds
  buffer_load_dwordx4 v235, s[16:19], s67 offen offset:3072 lds
  s_add_u32 m0, s68, 16384
  s_nop 0
  buffer_load_dwordx4 v232, s[20:23], s67 offen offset:0 lds
  buffer_load_dwordx4 v233, s[20:23], s67 offen offset:1024 lds
  buffer_load_dwordx4 v234, s[20:23], s67 offen offset:2048 lds
  buffer_load_dwordx4 v235, s[20:23], s67 offen offset:3072 lds
  s_add_u32 s67, s67, 458752
  s_add_u32 m0, s68, 32768
  s_nop 0
  buffer_load_dwordx4 v232, s[16:19], s67 offen offset:0 lds
  buffer_load_dwordx4 v233, s[16:19], s67 offen offset:1024 lds
  buffer_load_dwordx4 v234, s[16:19], s67 offen offset:2048 lds
  buffer_load_dwordx4 v235, s[16:19], s67 offen offset:3072 lds
  s_add_u32 m0, s68, 49152
  s_nop 0
  buffer_load_dwordx4 v232, s[20:23], s67 offen offset:0 lds
  buffer_load_dwordx4 v233, s[20:23], s67 offen offset:1024 lds
  buffer_load_dwordx4 v234, s[20:23], s67 offen offset:2048 lds
  buffer_load_dwordx4 v235, s[20:23], s67 offen offset:3072 lds
  s_add_u32 s67, s67, 458752
  s_xor_b32 s68, s68, 0x10000
  s_add_u32 m0, s68, 0
  s_nop 0
  buffer_load_dwordx4 v232, s[16:19], s67 offen offset:0 lds
  buffer_load_dwordx4 v233, s[16:19], s67 offen offset:1024 lds
  buffer_load_dwordx4 v234, s[16:19], s67 offen offset:2048 lds
  buffer_load_dwordx4 v235, s[16:19], s67 offen offset:3072 lds
  s_add_u32 m0, s68, 16384
  s_nop 0
  buffer_load_dwordx4 v232, s[20:23], s67 offen offset:0 lds
  buffer_load_dwordx4 v233, s[20:23], s67 offen offset:1024 lds
  buffer_load_dwordx4 v234, s[20:23], s67 offen offset:2048 lds
  buffer_load_dwordx4 v235, s[20:23], s67 offen offset:3072 lds
  s_add_u32 s67, s67, 458752
  s_lshl_b32 s77, s54, 7
  s_add_u32 s77, s77, s42
  s_add_u32 s77, s77, 27789312
  s_cmp_lg_u32 s40, 0
  s_cbranch_scc1 Lpdn15
  s_mov_b32 s43, 0x40000
  s_mov_b64 exec, 1
Lpol14:
  buffer_load_dword v250, v251, s[4:7], s77 offen sc1
  s_waitcnt vmcnt(0)
  v_cmp_gt_u32 vcc, 32, v250
  s_cbranch_vccz Lpdn15
  s_sub_u32 s43, s43, 1
  s_cmp_lg_u32 s43, 0
  s_cbranch_scc1 Lpol14
Lpdn15:
  s_mov_b64 exec, -1
  s_waitcnt vmcnt(0) lgkmcnt(0)
  s_barrier
  buffer_load_dwordx4 a[0:3], v231, s[4:7], s72 offen offset:0 sc1
  buffer_load_dwordx4 a[16:19], v231, s[4:7], s72 offen offset:1024 sc1
  buffer_load_dwordx4 a[4:7], v231, s[4:7], s73 offen offset:0 sc1
  buffer_load_dwordx4 a[20:23], v231, s[4:7], s73 offen offset:1024 sc1
  buffer_load_dwordx4 a[8:11], v231, s[4:7], s74 offen offset:0 sc1
  buffer_load_dwordx4 a[24:27], v231, s[4:7], s74 offen offset:1024 sc1
  buffer_load_dwordx4 a[12:15], v231, s[4:7], s75 offen offset:0 sc1
  buffer_load_dwordx4 a[28:31], v231, s[4:7], s75 offen offset:1024 sc1
  ds_read_b64_tr_b16 a[64:65], v224 offset:0
  ds_read_b64_tr_b16 a[66:67], v224 offset:4096
  ds_read_b64_tr_b16 a[68:69], v224 offset:8192
  ds_read_b64_tr_b16 a[70:71], v224 offset:12288
  ds_read_b64_tr_b16 a[72:73], v224 offset:16384
  ds_read_b64_tr_b16 a[74:75], v224 offset:20480
  ds_read_b64_tr_b16 a[76:77], v224 offset:24576
  ds_read_b64_tr_b16 a[78:79], v224 offset:28672
  s_waitcnt vmcnt(6) lgkmcnt(4)
  v_mfma_f32_16x16x32_bf16 v[0:3], a[64:67], a[0:3], 0
  ds_read_b64_tr_b16 a[80:81], v225 offset:0
  v_mfma_f32_16x16x32_bf16 v[0:3], a[68:71], a[16:19], v[0:3]
  s_waitcnt vmcnt(4)
  v_mfma_f32_16x16x32_bf16 v[4:7], a[68:71], a[20:23], 0
  ds_read_b64_tr_b16 a[82:83], v225 offset:4096
  v_mfma_f32_16x16x32_bf16 v[4:7], a[64:67], a[4:7], v[4:7]
  s_waitcnt vmcnt(2)
  v_mfma_f32_16x16x32_bf16 v[8:11], a[64:67], a[8:11], 0
  ds_read_b64_tr_b16 a[84:85], v225 offset:8192
  v_mfma_f32_16x16x32_bf16 v[8:11], a[68:71], a[24:27], v[8:11]
  s_waitcnt vmcnt(0)
  v_mfma_f32_16x16x32_bf16 v[12:15], a[68:71], a[28:31], 0
  ds_read_b64_tr_b16 a[86:87], v225 offset:12288
  v_mfma_f32_16x16x32_bf16 v[12:15], a[64:67], a[12:15], v[12:15]
  s_waitcnt lgkmcnt(4)
  v_mfma_f32_16x16x32_bf16 v[28:31], a[72:75], a[12:15], 0
  ds_read_b64_tr_b16 a[88:89], v225 offset:16384
  v_mfma_f32_16x16x32_bf16 v[28:31], a[76:79], a[28:31], v[28:31]
  buffer_load_dwordx4 a[32:35], v231, s[4:7], s72 offen offset:2048 sc1
  v_mfma_f32_16x16x32_bf16 v[24:27], a[76:79], a[24:27], 0
  ds_read_b64_tr_b16 a[90:91], v225 offset:20480
  v_mfma_f32_16x16x32_bf16 v[24:27], a[72:75], a[8:11], v[24:27]
  v_mfma_f32_16x16x32_bf16 v[20:23], a[72:75], a[4:7], 0
  ds_read_b64_tr_b16 a[92:93], v225 offset:24576
  v_mfma_f32_16x16x32_bf16 v[20:23], a[76:79], a[20:23], v[20:23]
  v_mfma_f32_16x16x32_bf16 v[16:19], a[76:79], a[16:19], 0
  ds_read_b64_tr_b16 a[94:95], v225 offset:28672
  buffer_load_dwordx4 a[48:51], v231, s[4:7], s72 offen offset:3072 sc1
  v_mfma_f32_16x16x32_bf16 v[16:19], a[72:75], a[0:3], v[16:19]
  s_add_u32 s72, s72, 4096
  s_waitcnt lgkmcnt(4)
  v_mfma_f32_16x16x32_bf16 v[32:35], a[80:83], a[0:3], 0
  ds_read_b64_tr_b16 a[64:65], v226 offset:0
  v_mfma_f32_16x16x32_bf16 v[32:35], a[84:87], a[16:19], v[32:35]
  v_mfma_f32_16x16x32_bf16 v[36:39], a[84:87], a[20:23], 0
  ds_read_b64_tr_b16 a[66:67], v226 offset:4096
  v_mfma_f32_16x16x32_bf16 v[36:39], a[80:83], a[4:7], v[36:39]
  buffer_load_dwordx4 a[36:39], v231, s[4:7], s73 offen offset:2048 sc1
  v_mfma_f32_16x16x32_bf16 v[40:43], a[80:83], a[8:11], 0
  ds_read_b64_tr_b16 a[68:69], v226 offset:8192
  v_mfma_f32_16x16x32_bf16 v[40:43], a[84:87], a[24:27], v[40:43]
  v_mfma_f32_16x16x32_bf16 v[44:47], a[84:87], a[28:31], 0
  ds_read_b64_tr_b16 a[70:71], v226 offset:12288
  v_mfma_f32_16x16x32_bf16 v[44:47], a[80:83], a[12:15], v[44:47]
  s_waitcnt lgkmcnt(4)
  v_mfma_f32_16x16x32_bf16 v[60:63], a[88:91], a[12:15], 0
  ds_read_b64_tr_b16 a[72:73], v226 offset:16384
  buffer_load_dwordx4 a[52:55], v231, s[4:7], s73 offen offset:3072 sc1
  v_mfma_f32_16x16x32_bf16 v[60:63], a[92:95], a[28:31], v[60:63]
  s_add_u32 s73, s73, 4096
  v_mfma_f32_16x16x32_bf16 v[56:59], a[92:95], a[24:27], 0
  ds_read_b64_tr_b16 a[74:75], v226 offset:20480
  v_mfma_f32_16x16x32_bf16 v[56:59], a[88:91], a[8:11], v[56:59]
  v_mfma_f32_16x16x32_bf16 v[52:55], a[88:91], a[4:7], 0
  ds_read_b64_tr_b16 a[76:77], v226 offset:24576
  v_mfma_f32_16x16x32_bf16 v[52:55], a[92:95], a[20:23], v[52:55]
  buffer_load_dwordx4 a[40:43], v231, s[4:7], s74 offen offset:2048 sc1
  v_mfma_f32_16x16x32_bf16 v[48:51], a[92:95], a[16:19], 0
  ds_read_b64_tr_b16 a[78:79], v226 offset:28672
  v_mfma_f32_16x16x32_bf16 v[48:51], a[88:91], a[0:3], v[48:51]
  s_waitcnt lgkmcnt(4)
  v_mfma_f32_16x16x32_bf16 v[64:67], a[64:67], a[0:3], 0
  ds_read_b64_tr_b16 a[80:81], v227 offset:0
  v_mfma_f32_16x16x32_bf16 v[64:67], a[68:71], a[16:19], v[64:67]
  v_mfma_f32_16x16x32_bf16 v[68:71], a[68:71], a[20:23], 0
  ds_read_b64_tr_b16 a[82:83], v227 offset:4096
  buffer_load_dwordx4 a[56:59], v231, s[4:7], s74 offen offset:3072 sc1
  v_mfma_f32_16x16x32_bf16 v[68:71], a[64:67], a[4:7], v[68:71]
  s_add_u32 s74, s74, 4096
  v_mfma_f32_16x16x32_bf16 v[72:75], a[64:67], a[8:11], 0
  ds_read_b64_tr_b16 a[84:85], v227 offset:8192
  v_mfma_f32_16x16x32_bf16 v[72:75], a[68:71], a[24:27], v[72:75]
  v_mfma_f32_16x16x32_bf16 v[76:79], a[68:71], a[28:31], 0
  ds_read_b64_tr_b16 a[86:87], v227 offset:12288
  v_mfma_f32_16x16x32_bf16 v[76:79], a[64:67], a[12:15], v[76:79]
  buffer_load_dwordx4 a[44:47], v231, s[4:7], s75 offen offset:2048 sc1
  s_waitcnt lgkmcnt(4)
  v_mfma_f32_16x16x32_bf16 v[92:95], a[72:75], a[12:15], 0
  ds_read_b64_tr_b16 a[88:89], v227 offset:16384
  v_mfma_f32_16x16x32_bf16 v[92:95], a[76:79], a[28:31], v[92:95]
  v_mfma_f32_16x16x32_bf16 v[88:91], a[76:79], a[24:27], 0
  ds_read_b64_tr_b16 a[90:91], v227 offset:20480
  v_mfma_f32_16x16x32_bf16 v[88:91], a[72:75], a[8:11], v[88:91]
  v_mfma_f32_16x16x32_bf16 v[84:87], a[72:75], a[4:7], 0
  ds_read_b64_tr_b16 a[92:93], v227 offset:24576
  buffer_load_dwordx4 a[60:63], v231, s[4:7], s75 offen offset:3072 sc1
  v_mfma_f32_16x16x32_bf16 v[84:87], a[76:79], a[20:23], v[84:87]
  s_add_u32 s75, s75, 4096
  v_mfma_f32_16x16x32_bf16 v[80:83], a[76:79], a[16:19], 0
  ds_read_b64_tr_b16 a[94:95], v227 offset:28672
  v_mfma_f32_16x16x32_bf16 v[80:83], a[72:75], a[0:3], v[80:83]
  s_waitcnt lgkmcnt(4)
  v_mfma_f32_16x16x32_bf16 v[96:99], a[80:83], a[0:3], 0
  ds_read_b64_tr_b16 a[64:65], v228 offset:0
  s_add_u32 m0, s68, 32768
  v_mfma_f32_16x16x32_bf16 v[96:99], a[84:87], a[16:19], v[96:99]
  buffer_load_dwordx4 v231, s[4:7], s44 offen offset:0 sc1 lds
  v_mfma_f32_16x16x32_bf16 v[100:103], a[84:87], a[20:23], 0
  ds_read_b64_tr_b16 a[66:67], v228 offset:4096
  v_mfma_f32_16x16x32_bf16 v[100:103], a[80:83], a[4:7], v[100:103]
  v_mfma_f32_16x16x32_bf16 v[104:107], a[80:83], a[8:11], 0
  ds_read_b64_tr_b16 a[68:69], v228 offset:8192
  v_mfma_f32_16x16x32_bf16 v[104:107], a[84:87], a[24:27], v[104:107]
  v_mfma_f32_16x16x32_bf16 v[108:111], a[84:87], a[28:31], 0
  ds_read_b64_tr_b16 a[70:71], v228 offset:12288
  buffer_load_dwordx4 v231, s[4:7], s44 offen offset:1024 sc1 lds
  v_mfma_f32_16x16x32_bf16 v[108:111], a[80:83], a[12:15], v[108:111]
  s_waitcnt lgkmcnt(4)
  v_mfma_f32_16x16x32_bf16 v[124:127], a[88:91], a[12:15], 0
  ds_read_b64_tr_b16 a[72:73], v228 offset:16384
  v_mfma_f32_16x16x32_bf16 v[124:127], a[92:95], a[28:31], v[124:127]
  v_mfma_f32_16x16x32_bf16 v[120:123], a[92:95], a[24:27], 0
  ds_read_b64_tr_b16 a[74:75], v228 offset:20480
  v_mfma_f32_16x16x32_bf16 v[120:123], a[88:91], a[8:11], v[120:123]
  buffer_load_dwordx4 v231, s[4:7], s44 offen offset:2048 sc1 lds
  v_mfma_f32_16x16x32_bf16 v[116:119], a[88:91], a[4:7], 0
  ds_read_b64_tr_b16 a[76:77], v228 offset:24576
  v_mfma_f32_16x16x32_bf16 v[116:119], a[92:95], a[20:23], v[116:119]
  v_mfma_f32_16x16x32_bf16 v[112:115], a[92:95], a[16:19], 0
  ds_read_b64_tr_b16 a[78:79], v228 offset:28672
  v_mfma_f32_16x16x32_bf16 v[112:115], a[88:91], a[0:3], v[112:115]
  s_waitcnt lgkmcnt(4)
  v_mfma_f32_16x16x32_bf16 v[128:131], a[64:67], a[0:3], 0
  ds_read_b64_tr_b16 a[80:81], v229 offset:0
  buffer_load_dwordx4 v231, s[4:7], s44 offen offset:3072 sc1 lds
  v_mfma_f32_16x16x32_bf16 v[128:131], a[68:71], a[16:19], v[128:131]
  v_mfma_f32_16x16x32_bf16 v[132:135], a[68:71], a[20:23], 0
  ds_read_b64_tr_b16 a[82:83], v229 offset:4096
  v_mfma_f32_16x16x32_bf16 v[132:135], a[64:67], a[4:7], v[132:135]
  v_mfma_f32_16x16x32_bf16 v[136:139], a[64:67], a[8:11], 0
  ds_read_b64_tr_b16 a[84:85], v229 offset:8192
  s_add_u32 m0, s68, 49152
  v_mfma_f32_16x16x32_bf16 v[136:139], a[68:71], a[24:27], v[136:139]
  buffer_load_dwordx4 v231, s[4:7], s45 offen offset:0 sc1 lds
  v_mfma_f32_16x16x32_bf16 v[140:143], a[68:71], a[28:31], 0
  ds_read_b64_tr_b16 a[86:87], v229 offset:12288
  v_mfma_f32_16x16x32_bf16 v[140:143], a[64:67], a[12:15], v[140:143]
  s_waitcnt lgkmcnt(4)
  v_mfma_f32_16x16x32_bf16 v[156:159], a[72:75], a[12:15], 0
  ds_read_b64_tr_b16 a[88:89], v229 offset:16384
  v_mfma_f32_16x16x32_bf16 v[156:159], a[76:79], a[28:31], v[156:159]
  v_mfma_f32_16x16x32_bf16 v[152:155], a[76:79], a[24:27], 0
  ds_read_b64_tr_b16 a[90:91], v229 offset:20480
  buffer_load_dwordx4 v231, s[4:7], s45 offen offset:1024 sc1 lds
  v_mfma_f32_16x16x32_bf16 v[152:155], a[72:75], a[8:11], v[152:155]
  v_mfma_f32_16x16x32_bf16 v[148:151], a[72:75], a[4:7], 0
  ds_read_b64_tr_b16 a[92:93], v229 offset:24576
  v_mfma_f32_16x16x32_bf16 v[148:151], a[76:79], a[20:23], v[148:151]
  v_mfma_f32_16x16x32_bf16 v[144:147], a[76:79], a[16:19], 0
  ds_read_b64_tr_b16 a[94:95], v229 offset:28672
  v_mfma_f32_16x16x32_bf16 v[144:147], a[72:75], a[0:3], v[144:147]
  buffer_load_dwordx4 v231, s[4:7], s45 offen offset:2048 sc1 lds
  s_waitcnt lgkmcnt(4)
  v_mfma_f32_16x16x32_bf16 v[160:163], a[80:83], a[0:3], 0
  ds_read_b64_tr_b16 a[64:65], v230 offset:0
  v_mfma_f32_16x16x32_bf16 v[160:163], a[84:87], a[16:19], v[160:163]
  v_mfma_f32_16x16x32_bf16 v[164:167], a[84:87], a[20:23], 0
  ds_read_b64_tr_b16 a[66:67], v230 offset:4096
  v_mfma_f32_16x16x32_bf16 v[164:167], a[80:83], a[4:7], v[164:167]
  v_mfma_f32_16x16x32_bf16 v[168:171], a[80:83], a[8:11], 0
  ds_read_b64_tr_b16 a[68:69], v230 offset:8192
  buffer_load_dwordx4 v231, s[4:7], s45 offen offset:3072 sc1 lds
  v_mfma_f32_16x16x32_bf16 v[168:171], a[84:87], a[24:27], v[168:171]
  v_mfma_f32_16x16x32_bf16 v[172:175], a[84:87], a[28:31], 0
  ds_read_b64_tr_b16 a[70:71], v230 offset:12288
  v_mfma_f32_16x16x32_bf16 v[172:175], a[80:83], a[12:15], v[172:175]
  s_waitcnt lgkmcnt(4)
  v_mfma_f32_16x16x32_bf16 v[188:191], a[88:91], a[12:15], 0
  ds_read_b64_tr_b16 a[72:73], v230 offset:16384
  v_mfma_f32_16x16x32_bf16 v[188:191], a[92:95], a[28:31], v[188:191]
  v_mfma_f32_16x16x32_bf16 v[184:187], a[92:95], a[24:27], 0
  ds_read_b64_tr_b16 a[74:75], v230 offset:20480
  v_mfma_f32_16x16x32_bf16 v[184:187], a[88:91], a[8:11], v[184:187]
  buffer_load_dwordx4 a[96:99], v236, s[24:27], s70 offen
  v_mfma_f32_16x16x32_bf16 v[180:183], a[88:91], a[4:7], 0
  ds_read_b64_tr_b16 a[76:77], v230 offset:24576
  s_add_u32 s70, s70, 1024
  v_mfma_f32_16x16x32_bf16 v[180:183], a[92:95], a[20:23], v[180:183]
  v_mfma_f32_16x16x32_bf16 v[176:179], a[92:95], a[16:19], 0
  ds_read_b64_tr_b16 a[78:79], v230 offset:28672
  v_mfma_f32_16x16x32_bf16 v[176:179], a[88:91], a[0:3], v[176:179]
  s_waitcnt lgkmcnt(4)
  v_mfma_f32_16x16x32_bf16 v[192:195], a[64:67], a[0:3], 0
  s_barrier
  ds_read_b64_tr_b16 a[80:81], v224 offset:32768
  v_mfma_f32_16x16x32_bf16 v[192:195], a[68:71], a[16:19], v[192:195]
  v_mfma_f32_16x16x32_bf16 v[196:199], a[68:71], a[20:23], 0
  ds_read_b64_tr_b16 a[82:83], v224 offset:36864
  v_mfma_f32_16x16x32_bf16 v[196:199], a[64:67], a[4:7], v[196:199]
  v_mfma_f32_16x16x32_bf16 v[200:203], a[64:67], a[8:11], 0
  ds_read_b64_tr_b16 a[84:85], v224 offset:40960
  v_mfma_f32_16x16x32_bf16 v[200:203], a[68:71], a[24:27], v[200:203]
  v_mfma_f32_16x16x32_bf16 v[204:207], a[68:71], a[28:31], 0
  ds_read_b64_tr_b16 a[86:87], v224 offset:45056
  v_mfma_f32_16x16x32_bf16 v[204:207], a[64:67], a[12:15], v[204:207]
  s_waitcnt lgkmcnt(4)
  v_mfma_f32_16x16x32_bf16 v[220:223], a[72:75], a[12:15], 0
  ds_read_b64_tr_b16 a[88:89], v224 offset:49152
  v_mfma_f32_16x16x32_bf16 v[220:223], a[76:79], a[28:31], v[220:223]
  v_mfma_f32_16x16x32_bf16 v[216:219], a[76:79], a[24:27], 0
  ds_read_b64_tr_b16 a[90:91], v224 offset:53248
  v_mfma_f32_16x16x32_bf16 v[216:219], a[72:75], a[8:11], v[216:219]
  v_mfma_f32_16x16x32_bf16 v[212:215], a[72:75], a[4:7], 0
  ds_read_b64_tr_b16 a[92:93], v224 offset:57344
  v_mfma_f32_16x16x32_bf16 v[212:215], a[76:79], a[20:23], v[212:215]
  v_mfma_f32_16x16x32_bf16 v[208:211], a[76:79], a[16:19], 0
  ds_read_b64_tr_b16 a[94:95], v224 offset:61440
  v_xor_b32 v224, 0x10000, v224
  v_mfma_f32_16x16x32_bf16 v[208:211], a[72:75], a[0:3], v[208:211]
  s_waitcnt vmcnt(9) lgkmcnt(4)
  v_mfma_f32_16x16x32_bf16 v[0:3], a[80:83], a[32:35], v[0:3]
  ds_read_b64_tr_b16 a[64:65], v225 offset:32768
  v_mfma_f32_16x16x32_bf16 v[0:3], a[84:87], a[48:51], v[0:3]
  v_mfma_f32_16x16x32_bf16 v[4:7], a[84:87], a[52:55], v[4:7]
  ds_read_b64_tr_b16 a[66:67], v225 offset:36864
  v_mfma_f32_16x16x32_bf16 v[4:7], a[80:83], a[36:39], v[4:7]
  buffer_load_dwordx4 a[0:3], v231, s[4:7], s72 offen offset:0 sc1
  v_mfma_f32_16x16x32_bf16 v[8:11], a[80:83], a[40:43], v[8:11]
  ds_read_b64_tr_b16 a[68:69], v225 offset:40960
  v_mfma_f32_16x16x32_bf16 v[8:11], a[84:87], a[56:59], v[8:11]
  s_add_u32 s43, s68, 32768
  v_lshlrev_b32 v250, 3, v253
  v_mfma_f32_16x16x32_bf16 v[12:15], a[84:87], a[60:63], v[12:15]
  ds_read_b64_tr_b16 a[70:71], v225 offset:45056
  v_add_u32 v250, s43, v250
  v_mfma_f32_16x16x32_bf16 v[12:15], a[80:83], a[44:47], v[12:15]
  s_waitcnt lgkmcnt(4)
  v_mfma_f32_16x16x32_bf16 v[28:31], a[88:91], a[44:47], v[28:31]
  ds_read_b64_tr_b16 a[72:73], v225 offset:49152
  v_mfma_f32_16x16x32_bf16 v[28:31], a[92:95], a[60:63], v[28:31]
  v_mfma_f32_16x16x32_bf16 v[24:27], a[92:95], a[56:59], v[24:27]
  ds_read_b64_tr_b16 a[74:75], v225 offset:53248
  buffer_load_dwordx4 a[16:19], v231, s[4:7], s72 offen offset:1024 sc1
  v_mfma_f32_16x16x32_bf16 v[24:27], a[88:91], a[40:43], v[24:27]
  v_mfma_f32_16x16x32_bf16 v[20:23], a[88:91], a[36:39], v[20:23]
  ds_read_b64_tr_b16 a[76:77], v225 offset:57344
  v_mfma_f32_16x16x32_bf16 v[20:23], a[92:95], a[52:55], v[20:23]
  s_waitcnt vmcnt(3)
  ds_read_b64 v[238:239], v250 offset:0
  v_mfma_f32_16x16x32_bf16 v[16:19], a[92:95], a[48:51], v[16:19]
  ds_read_b64_tr_b16 a[78:79], v225 offset:61440
  v_xor_b32 v225, 0x10000, v225
  ds_read_b64 v[240:241], v250 offset:2048
  v_mfma_f32_16x16x32_bf16 v[16:19], a[88:91], a[32:35], v[16:19]
  ds_read_b64 v[242:243], v250 offset:16384
  s_waitcnt lgkmcnt(7)
  v_mfma_f32_16x16x32_bf16 v[32:35], a[64:67], a[32:35], v[32:35]
  ds_read_b64_tr_b16 a[80:81], v226 offset:32768
  ds_read_b64 v[244:245], v250 offset:18432
  v_mfma_f32_16x16x32_bf16 v[32:35], a[68:71], a[48:51], v[32:35]
  buffer_load_dwordx4 a[4:7], v231, s[4:7], s73 offen offset:0 sc1
  ds_read_b64 v[246:247], v250 offset:512
  v_mfma_f32_16x16x32_bf16 v[36:39], a[68:71], a[52:55], v[36:39]
  ds_read_b64_tr_b16 a[82:83], v226 offset:36864
  v_mfma_f32_16x16x32_bf16 v[36:39], a[64:67], a[36:39], v[36:39]
  v_mfma_f32_16x16x32_bf16 v[40:43], a[64:67], a[40:43], v[40:43]
  ds_read_b64_tr_b16 a[84:85], v226 offset:40960
  ds_read_b64 v[248:249], v250 offset:2560
  v_mfma_f32_16x16x32_bf16 v[40:43], a[68:71], a[56:59], v[40:43]
  v_mfma_f32_16x16x32_bf16 v[44:47], a[68:71], a[60:63], v[44:47]
  ds_read_b64_tr_b16 a[86:87], v226 offset:45056
  s_waitcnt lgkmcnt(4)
  v_add_f32 v238, v238, v246
  v_add_f32 v239, v239, v247
  v_mfma_f32_16x16x32_bf16 v[44:47], a[64:67], a[44:47], v[44:47]
  ds_read_b64 v[246:247], v250 offset:16896
  v_mfma_f32_16x16x32_bf16 v[60:63], a[72:75], a[44:47], v[60:63]
  ds_read_b64_tr_b16 a[88:89], v226 offset:49152
  buffer_load_dwordx4 a[20:23], v231, s[4:7], s73 offen offset:1024 sc1
  v_mfma_f32_16x16x32_bf16 v[60:63], a[76:79], a[60:63], v[60:63]
  s_waitcnt lgkmcnt(3)
  v_add_f32 v240, v240, v248
  v_add_f32 v241, v241, v249
  v_mfma_f32_16x16x32_bf16 v[56:59], a[76:79], a[56:59], v[56:59]
  ds_read_b64_tr_b16 a[90:91], v226 offset:53248
  ds_read_b64 v[248:249], v250 offset:18944
  v_mfma_f32_16x16x32_bf16 v[56:59], a[72:75], a[40:43], v[56:59]
  v_mfma_f32_16x16x32_bf16 v[52:55], a[72:75], a[36:39], v[52:55]
  ds_read_b64_tr_b16 a[92:93], v226 offset:57344
  s_waitcnt lgkmcnt(4)
  v_add_f32 v242, v242, v246
  v_add_f32 v243, v243, v247
  v_mfma_f32_16x16x32_bf16 v[52:55], a[76:79], a[52:55], v[52:55]
  ds_read_b64 v[246:247], v250 offset:1024
  v_mfma_f32_16x16x32_bf16 v[48:51], a[76:79], a[48:51], v[48:51]
  ds_read_b64_tr_b16 a[94:95], v226 offset:61440
  v_xor_b32 v226, 0x10000, v226
  v_mfma_f32_16x16x32_bf16 v[48:51], a[72:75], a[32:35], v[48:51]
  buffer_load_dwordx4 a[8:11], v231, s[4:7], s74 offen offset:0 sc1
  s_waitcnt lgkmcnt(3)
  v_add_f32 v244, v244, v248
  v_add_f32 v245, v245, v249
  v_mfma_f32_16x16x32_bf16 v[64:67], a[80:83], a[32:35], v[64:67]
  ds_read_b64_tr_b16 a[64:65], v227 offset:32768
  ds_read_b64 v[248:249], v250 offset:3072
  v_mfma_f32_16x16x32_bf16 v[64:67], a[84:87], a[48:51], v[64:67]
  v_mfma_f32_16x16x32_bf16 v[68:71], a[84:87], a[52:55], v[68:71]
  ds_read_b64_tr_b16 a[66:67], v227 offset:36864
  s_waitcnt lgkmcnt(4)
  v_add_f32 v238, v238, v246
  v_add_f32 v239, v239, v247
  v_mfma_f32_16x16x32_bf16 v[68:71], a[80:83], a[36:39], v[68:71]
  ds_read_b64 v[246:247], v250 offset:17408
  v_mfma_f32_16x16x32_bf16 v[72:75], a[80:83], a[40:43], v[72:75]
  ds_read_b64_tr_b16 a[68:69], v227 offset:40960
  v_mfma_f32_16x16x32_bf16 v[72:75], a[84:87], a[56:59], v[72:75]
  s_waitcnt lgkmcnt(3)
  v_add_f32 v240, v240, v248
  v_add_f32 v241, v241, v249
  v_mfma_f32_16x16x32_bf16 v[76:79], a[84:87], a[60:63], v[76:79]
  ds_read_b64_tr_b16 a[70:71], v227 offset:45056
  buffer_load_dwordx4 a[24:27], v231, s[4:7], s74 offen offset:1024 sc1
  ds_read_b64 v[248:249], v250 offset:19456
  v_mfma_f32_16x16x32_bf16 v[76:79], a[80:83], a[44:47], v[76:79]
  v_mfma_f32_16x16x32_bf16 v[92:95], a[88:91], a[44:47], v[92:95]
  ds_read_b64_tr_b16 a[72:73], v227 offset:49152
  s_waitcnt lgkmcnt(4)
  v_add_f32 v242, v242, v246
  v_add_f32 v243, v243, v247
  v_mfma_f32_16x16x32_bf16 v[92:95], a[92:95], a[60:63], v[92:95]
  ds_read_b64 v[246:247], v250 offset:1536
  v_mfma_f32_16x16x32_bf16 v[88:91], a[92:95], a[56:59], v[88:91]
  ds_read_b64_tr_b16 a[74:75], v227 offset:53248
  v_mfma_f32_16x16x32_bf16 v[88:91], a[88:91], a[40:43], v[88:91]
  s_waitcnt lgkmcnt(3)
  v_add_f32 v244, v244, v248
  v_add_f32 v245, v245, v249
  v_mfma_f32_16x16x32_bf16 v[84:87], a[88:91], a[36:39], v[84:87]
  ds_read_b64_tr_b16 a[76:77], v227 offset:57344
  ds_read_b64 v[248:249], v250 offset:3584
  v_mfma_f32_16x16x32_bf16 v[84:87], a[92:95], a[52:55], v[84:87]
  buffer_load_dwordx4 a[12:15], v231, s[4:7], s75 offen offset:0 sc1
  v_mfma_f32_16x16x32_bf16 v[80:83], a[92:95], a[48:51], v[80:83]
  ds_read_b64_tr_b16 a[78:79], v227 offset:61440
  v_xor_b32 v227, 0x10000, v227
  s_waitcnt lgkmcnt(4)
  v_add_f32 v238, v238, v246
  v_add_f32 v239, v239, v247
  v_mfma_f32_16x16x32_bf16 v[80:83], a[88:91], a[32:35], v[80:83]
  ds_read_b64 v[246:247], v250 offset:17920
  v_mfma_f32_16x16x32_bf16 v[96:99], a[64:67], a[32:35], v[96:99]
  ds_read_b64_tr_b16 a[80:81], v228 offset:32768
  v_mfma_f32_16x16x32_bf16 v[96:99], a[68:71], a[48:51], v[96:99]
  s_waitcnt lgkmcnt(3)
  v_add_f32 v240, v240, v248
  v_add_f32 v241, v241, v249
  v_mfma_f32_16x16x32_bf16 v[100:103], a[68:71], a[52:55], v[100:103]
  ds_read_b64_tr_b16 a[82:83], v228 offset:36864
  ds_read_b64 v[248:249], v250 offset:19968
  v_mfma_f32_16x16x32_bf16 v[100:103], a[64:67], a[36:39], v[100:103]
  v_mfma_f32_16x16x32_bf16 v[104:107], a[64:67], a[40:43], v[104:107]
  ds_read_b64_tr_b16 a[84:85], v228 offset:40960
  buffer_load_dwordx4 a[28:31], v231, s[4:7], s75 offen offset:1024 sc1
  s_waitcnt lgkmcnt(4)
  v_add_f32 v242, v242, v246
  v_add_f32 v243, v243, v247
  v_mfma_f32_16x16x32_bf16 v[104:107], a[68:71], a[56:59], v[104:107]
  v_mfma_f32_16x16x32_bf16 v[108:111], a[68:71], a[60:63], v[108:111]
  ds_read_b64_tr_b16 a[86:87], v228 offset:45056
  v_mfma_f32_16x16x32_bf16 v[108:111], a[64:67], a[44:47], v[108:111]
  s_waitcnt lgkmcnt(2)
  v_add_f32 v244, v244, v248
  v_add_f32 v245, v245, v249
  buffer_load_dword v237, v251, s[4:7], s48 offen sc1
  v_mfma_f32_16x16x32_bf16 v[124:127], a[72:75], a[44:47], v[124:127]
  ds_read_b64_tr_b16 a[88:89], v228 offset:49152
  v_mov_b32 v246, v238
  v_mfma_f32_16x16x32_bf16 v[124:127], a[76:79], a[60:63], v[124:127]
  v_mov_b32 v247, v239
  v_mov_b32 v248, v240
  v_mfma_f32_16x16x32_bf16 v[120:123], a[76:79], a[56:59], v[120:123]
  ds_read_b64_tr_b16 a[90:91], v228 offset:53248
  s_add_u32 m0, s68, 32768
  v_mfma_f32_16x16x32_bf16 v[120:123], a[72:75], a[40:43], v[120:123]
  buffer_load_dwordx4 v232, s[16:19], s67 offen offset:0 lds
  v_mov_b32 v249, v241
  v_mfma_f32_16x16x32_bf16 v[116:119], a[72:75], a[36:39], v[116:119]
  ds_read_b64_tr_b16 a[92:93], v228 offset:57344
  v_permlane32_swap_b32 v238, v246
  v_mfma_f32_16x16x32_bf16 v[116:119], a[76:79], a[52:55], v[116:119]
  v_permlane32_swap_b32 v239, v247
  v_permlane32_swap_b32 v240, v248
  v_mfma_f32_16x16x32_bf16 v[112:115], a[76:79], a[48:51], v[112:115]
  ds_read_b64_tr_b16 a[94:95], v228 offset:61440
  v_xor_b32 v228, 0x10000, v228
  v_permlane32_swap_b32 v241, v249
  v_mfma_f32_16x16x32_bf16 v[112:115], a[72:75], a[32:35], v[112:115]
  v_add_f32 v238, v238, v246
  v_add_f32 v239, v239, v247
  s_waitcnt lgkmcnt(4)
  v_mfma_f32_16x16x32_bf16 v[128:131], a[80:83], a[32:35], v[128:131]
  ds_read_b64_tr_b16 a[64:65], v229 offset:32768
  v_add_f32 v240, v240, v248
  v_mfma_f32_16x16x32_bf16 v[128:131], a[84:87], a[48:51], v[128:131]
  v_add_f32 v241, v241, v249
  v_mov_b32 v246, v238
  v_mfma_f32_16x16x32_bf16 v[132:135], a[84:87], a[52:55], v[132:135]
  ds_read_b64_tr_b16 a[66:67], v229 offset:36864
  buffer_load_dwordx4 v233, s[16:19], s67 offen offset:1024 lds
  v_mfma_f32_16x16x32_bf16 v[132:135], a[80:83], a[36:39], v[132:135]
  v_mov_b32 v247, v239
  v_mov_b32 v248, v240
  v_mfma_f32_16x16x32_bf16 v[136:139], a[80:83], a[40:43], v[136:139]
  ds_read_b64_tr_b16 a[68:69], v229 offset:40960
  v_mov_b32 v249, v241
  v_mfma_f32_16x16x32_bf16 v[136:139], a[84:87], a[56:59], v[136:139]
  v_permlane16_swap_b32 v238, v246
  v_permlane16_swap_b32 v239, v247
  v_mfma_f32_16x16x32_bf16 v[140:143], a[84:87], a[60:63], v[140:143]
  ds_read_b64_tr_b16 a[70:71], v229 offset:45056
  v_permlane16_swap_b32 v240, v248
  v_mfma_f32_16x16x32_bf16 v[140:143], a[80:83], a[44:47], v[140:143]
  v_permlane16_swap_b32 v241, v249
  v_add_f32 v238, v238, v246
  s_waitcnt lgkmcnt(4)
  v_mfma_f32_16x16x32_bf16 v[156:159], a[88:91], a[44:47], v[156:159]
  ds_read_b64_tr_b16 a[72:73], v229 offset:49152
  v_add_f32 v239, v239, v247
  v_add_f32 v240, v240, v248
  v_mfma_f32_16x16x32_bf16 v[156:159], a[92:95], a[60:63], v[156:159]
  buffer_load_dwordx4 v234, s[16:19], s67 offen offset:2048 lds
  v_add_f32 v241, v241, v249
  v_mov_b32 v246, v242
  v_mfma_f32_16x16x32_bf16 v[152:155], a[92:95], a[56:59], v[152:155]
  ds_read_b64_tr_b16 a[74:75], v229 offset:53248
  v_mov_b32 v247, v243
  v_mov_b32 v248, v244
  v_mfma_f32_16x16x32_bf16 v[152:155], a[88:91], a[40:43], v[152:155]
  v_mov_b32 v249, v245
  v_permlane32_swap_b32 v242, v246
  v_permlane32_swap_b32 v243, v247
  v_mfma_f32_16x16x32_bf16 v[148:151], a[88:91], a[36:39], v[148:151]
  ds_read_b64_tr_b16 a[76:77], v229 offset:57344
  v_permlane32_swap_b32 v244, v248
  v_permlane32_swap_b32 v245, v249
  v_mfma_f32_16x16x32_bf16 v[148:151], a[92:95], a[52:55], v[148:151]
  v_add_f32 v242, v242, v246
  v_add_f32 v243, v243, v247
  v_add_f32 v244, v244, v248
  v_mfma_f32_16x16x32_bf16 v[144:147], a[92:95], a[48:51], v[144:147]
  ds_read_b64_tr_b16 a[78:79], v229 offset:61440
  v_xor_b32 v229, 0x10000, v229
  v_add_f32 v245, v245, v249
  v_mov_b32 v246, v242
  v_mfma_f32_16x16x32_bf16 v[144:147], a[88:91], a[32:35], v[144:147]
  v_mov_b32 v247, v243
  v_mov_b32 v248, v244
  v_mov_b32 v249, v245
  s_waitcnt lgkmcnt(4)
  v_mfma_f32_16x16x32_bf16 v[160:163], a[64:67], a[32:35], v[160:163]
  ds_read_b64_tr_b16 a[80:81], v230 offset:32768
  buffer_load_dwordx4 v235, s[16:19], s67 offen offset:3072 lds
  v_permlane16_swap_b32 v242, v246
  v_mfma_f32_16x16x32_bf16 v[160:163], a[68:71], a[48:51], v[160:163]
  v_permlane16_swap_b32 v243, v247
  v_permlane16_swap_b32 v244, v248
  v_permlane16_swap_b32 v245, v249
  v_mfma_f32_16x16x32_bf16 v[164:167], a[68:71], a[52:55], v[164:167]
  ds_read_b64_tr_b16 a[82:83], v230 offset:36864
  v_add_f32 v242, v242, v246
  v_add_f32 v243, v243, v247
  v_mfma_f32_16x16x32_bf16 v[164:167], a[64:67], a[36:39], v[164:167]
  v_add_f32 v244, v244, v248
  v_add_f32 v245, v245, v249
  s_mov_b32 s43, 0x3a800000
  v_mfma_f32_16x16x32_bf16 v[168:171], a[64:67], a[40:43], v[168:171]
  ds_read_b64_tr_b16 a[84:85], v230 offset:40960
  v_mov_b32 v250, 0x3727c5ac
  v_mul_f32 v238, 0xba800000, v238
  v_mfma_f32_16x16x32_bf16 v[168:171], a[68:71], a[56:59], v[168:171]
  v_fma_f32 v239, v239, s43, v250
  v_mul_f32 v240, 0xba800000, v240
  v_fma_f32 v241, v241, s43, v250
  v_mfma_f32_16x16x32_bf16 v[172:175], a[68:71], a[60:63], v[172:175]
  ds_read_b64_tr_b16 a[86:87], v230 offset:45056
  s_add_u32 m0, s68, 49152
  v_mul_f32 v242, 0xba800000, v242
  v_mfma_f32_16x16x32_bf16 v[172:175], a[64:67], a[44:47], v[172:175]
  buffer_load_dwordx4 v232, s[20:23], s67 offen offset:0 lds
  v_fma_f32 v243, v243, s43, v250
  v_mul_f32 v244, 0xba800000, v244
  s_waitcnt lgkmcnt(4)
  v_mfma_f32_16x16x32_bf16 v[188:191], a[72:75], a[44:47], v[188:191]
  ds_read_b64_tr_b16 a[88:89], v230 offset:49152
  v_fma_f32 v245, v245, s43, v250
  v_fma_f32 v239, -v238, v238, v239
  v_mfma_f32_16x16x32_bf16 v[188:191], a[76:79], a[60:63], v[188:191]
  v_max_f32 v239, v239, v250
  v_fma_f32 v241, -v240, v240, v241
  v_max_f32 v241, v241, v250
  v_mfma_f32_16x16x32_bf16 v[184:187], a[76:79], a[56:59], v[184:187]
  ds_read_b64_tr_b16 a[90:91], v230 offset:53248
  v_fma_f32 v243, -v242, v242, v243
  v_max_f32 v243, v243, v250
  v_mfma_f32_16x16x32_bf16 v[184:187], a[72:75], a[40:43], v[184:187]
  v_fma_f32 v245, -v244, v244, v245
  v_max_f32 v245, v245, v250
  v_rsq_f32 v246, v239
  v_mfma_f32_16x16x32_bf16 v[180:183], a[72:75], a[36:39], v[180:183]
  ds_read_b64_tr_b16 a[92:93], v230 offset:57344
  v_accvgpr_write_b32 a108, v239
  v_rsq_f32 v247, v241
  v_mfma_f32_16x16x32_bf16 v[180:183], a[76:79], a[52:55], v[180:183]
  v_accvgpr_write_b32 a109, v241
  v_rsq_f32 v248, v243
  v_accvgpr_write_b32 a110, v243
  v_mfma_f32_16x16x32_bf16 v[176:179], a[76:79], a[48:51], v[176:179]
  ds_read_b64_tr_b16 a[94:95], v230 offset:61440
  v_xor_b32 v230, 0x10000, v230
  buffer_load_dwordx4 v233, s[20:23], s67 offen offset:1024 lds
  v_rsq_f32 v249, v245
  v_mfma_f32_16x16x32_bf16 v[176:179], a[72:75], a[32:35], v[176:179]
  v_accvgpr_write_b32 a111, v245
  v_mul_f32 v246, 0xbfb8aa3b, v246
  v_accvgpr_write_b32 a104, v246
  s_waitcnt lgkmcnt(4)
  v_mfma_f32_16x16x32_bf16 v[192:195], a[80:83], a[32:35], v[192:195]
  s_barrier
  ds_read_b64_tr_b16 a[64:65], v224 offset:0
  v_mul_f32 v247, 0xbfb8aa3b, v247
  v_accvgpr_write_b32 a105, v247
  v_mfma_f32_16x16x32_bf16 v[192:195], a[84:87], a[48:51], v[192:195]
  v_mul_f32 v248, 0xbfb8aa3b, v248
  v_accvgpr_write_b32 a106, v248
  v_mul_f32 v249, 0xbfb8aa3b, v249
  v_mfma_f32_16x16x32_bf16 v[196:199], a[84:87], a[52:55], v[196:199]
  ds_read_b64_tr_b16 a[66:67], v224 offset:4096
  v_accvgpr_write_b32 a107, v249
  v_mov_b32 v239, v240
  v_mfma_f32_16x16x32_bf16 v[196:199], a[80:83], a[36:39], v[196:199]
  v_mov_b32 v240, v242
  v_mov_b32 v241, v244
  v_lshrrev_b32 v250, 3, v253
  v_mfma_f32_16x16x32_bf16 v[200:203], a[80:83], a[40:43], v[200:203]
  ds_read_b64_tr_b16 a[68:69], v224 offset:8192
  v_add_u32 v250, s66, v250
  v_cmp_ne_u32 vcc, 7, v250
  v_mfma_f32_16x16x32_bf16 v[200:203], a[84:87], a[56:59], v[200:203]
  buffer_load_dwordx4 v234, s[20:23], s67 offen offset:2048 lds
  v_bfe_u32 v242, v253, 2, 1
  v_mul_u32_u24 v242, 14336, v242
  v_mfma_f32_16x16x32_bf16 v[204:207], a[84:87], a[60:63], v[204:207]
  ds_read_b64_tr_b16 a[70:71], v224 offset:12288
  v_cndmask_b32 v250, 0, v250, vcc
  v_lshl_add_u32 v250, v250, 6, v242
  v_mfma_f32_16x16x32_bf16 v[204:207], a[80:83], a[44:47], v[204:207]
  v_and_b32 v242, 3, v253
  v_lshl_add_u32 v250, v242, 4, v250
  s_waitcnt vmcnt(7)
  v_cmp_gt_u32 vcc, 56, v237
  s_cbranch_vccz Lcdn17
  s_mov_b32 s43, 0x40000
Lchk16:
  s_sleep 8
  buffer_load_dword v237, v251, s[4:7], s48 offen sc1
  s_waitcnt vmcnt(0)
  v_cmp_gt_u32 vcc, 56, v237
  s_cbranch_vccz Lcdn17
  s_sub_u32 s43, s43, 1
  s_cmp_lg_u32 s43, 0
  s_cbranch_scc1 Lchk16
Lcdn17:
  s_waitcnt lgkmcnt(4)
  v_mfma_f32_16x16x32_bf16 v[220:223], a[88:91], a[44:47], v[220:223]
  ds_read_b64_tr_b16 a[72:73], v224 offset:16384
  buffer_load_dwordx4 v[242:245], v250, s[4:7], s46 offen sc1
  buffer_load_dwordx4 v[246:249], v250, s[4:7], s47 offen sc1
  v_mfma_f32_16x16x32_bf16 v[220:223], a[92:95], a[60:63], v[220:223]
  v_lshrrev_b32 v237, 4, v253
  v_lshlrev_b32 v237, 4, v237
  v_add_u32 v237, s71, v237
  v_mfma_f32_16x16x32_bf16 v[216:219], a[92:95], a[56:59], v[216:219]
  ds_read_b64_tr_b16 a[74:75], v224 offset:20480
  v_add_u32 v250, s71, v231
  v_mfma_f32_16x16x32_bf16 v[216:219], a[88:91], a[40:43], v[216:219]
  v_mfma_f32_16x16x32_bf16 v[212:215], a[88:91], a[36:39], v[212:215]
  ds_read_b64_tr_b16 a[76:77], v224 offset:24576
  buffer_load_dwordx4 v235, s[20:23], s67 offen offset:3072 lds
  v_mfma_f32_16x16x32_bf16 v[212:215], a[92:95], a[52:55], v[212:215]
  s_add_u32 s67, s67, 458752
  s_xor_b32 s68, s68, 0x10000
  v_mfma_f32_16x16x32_bf16 v[208:211], a[92:95], a[48:51], v[208:211]
  ds_read_b64_tr_b16 a[78:79], v224 offset:28672
  v_mfma_f32_16x16x32_bf16 v[208:211], a[88:91], a[32:35], v[208:211]
  s_mov_b32 s56, 6
.p2align 3
Lp3_loop:
  s_waitcnt lgkmcnt(4) vmcnt(8)
  v_mfma_f32_16x16x32_bf16 v[0:3], a[64:67], a[0:3], v[0:3]
  ds_read_b64_tr_b16 a[80:81], v225 offset:0
  v_mfma_f32_16x16x32_bf16 v[0:3], a[68:71], a[16:19], v[0:3]
  v_mfma_f32_16x16x32_bf16 v[4:7], a[68:71], a[20:23], v[4:7]
  ds_read_b64_tr_b16 a[82:83], v225 offset:4096
  v_mfma_f32_16x16x32_bf16 v[4:7], a[64:67], a[4:7], v[4:7]
  buffer_load_dwordx4 a[32:35], v231, s[4:7], s72 offen offset:2048 sc1
  v_mfma_f32_16x16x32_bf16 v[8:11], a[64:67], a[8:11], v[8:11]
  ds_read_b64_tr_b16 a[84:85], v225 offset:8192
  v_mfma_f32_16x16x32_bf16 v[8:11], a[68:71], a[24:27], v[8:11]
  v_mfma_f32_16x16x32_bf16 v[12:15], a[68:71], a[28:31], v[12:15]
  ds_read_b64_tr_b16 a[86:87], v225 offset:12288
  v_mfma_f32_16x16x32_bf16 v[12:15], a[64:67], a[12:15], v[12:15]
  s_waitcnt lgkmcnt(4)
  v_mfma_f32_16x16x32_bf16 v[28:31], a[72:75], a[12:15], v[28:31]
  ds_read_b64_tr_b16 a[88:89], v225 offset:16384
  v_mfma_f32_16x16x32_bf16 v[28:31], a[76:79], a[28:31], v[28:31]
  v_mfma_f32_16x16x32_bf16 v[24:27], a[76:79], a[24:27], v[24:27]
  ds_read_b64_tr_b16 a[90:91], v225 offset:20480
  buffer_load_dwordx4 a[48:51], v231, s[4:7], s72 offen offset:3072 sc1
  v_mfma_f32_16x16x32_bf16 v[24:27], a[72:75], a[8:11], v[24:27]
  s_add_u32 s72, s72, 4096
  v_mfma_f32_16x16x32_bf16 v[20:23], a[72:75], a[4:7], v[20:23]
  ds_read_b64_tr_b16 a[92:93], v225 offset:24576
  v_mfma_f32_16x16x32_bf16 v[20:23], a[76:79], a[20:23], v[20:23]
  v_mfma_f32_16x16x32_bf16 v[16:19], a[76:79], a[16:19], v[16:19]
  ds_read_b64_tr_b16 a[94:95], v225 offset:28672
  v_mfma_f32_16x16x32_bf16 v[16:19], a[72:75], a[0:3], v[16:19]
  s_waitcnt lgkmcnt(4)
  v_mfma_f32_16x16x32_bf16 v[32:35], a[80:83], a[0:3], v[32:35]
  ds_read_b64_tr_b16 a[64:65], v226 offset:0
  v_mfma_f32_16x16x32_bf16 v[32:35], a[84:87], a[16:19], v[32:35]
  buffer_load_dwordx4 a[36:39], v231, s[4:7], s73 offen offset:2048 sc1
  v_mfma_f32_16x16x32_bf16 v[36:39], a[84:87], a[20:23], v[36:39]
  ds_read_b64_tr_b16 a[66:67], v226 offset:4096
  v_mfma_f32_16x16x32_bf16 v[36:39], a[80:83], a[4:7], v[36:39]
  v_mfma_f32_16x16x32_bf16 v[40:43], a[80:83], a[8:11], v[40:43]
  ds_read_b64_tr_b16 a[68:69], v226 offset:8192
  v_mfma_f32_16x16x32_bf16 v[40:43], a[84:87], a[24:27], v[40:43]
  v_mfma_f32_16x16x32_bf16 v[44:47], a[84:87], a[28:31], v[44:47]
  ds_read_b64_tr_b16 a[70:71], v226 offset:12288
  v_mfma_f32_16x16x32_bf16 v[44:47], a[80:83], a[12:15], v[44:47]
  s_waitcnt lgkmcnt(4)
  v_mfma_f32_16x16x32_bf16 v[60:63], a[88:91], a[12:15], v[60:63]
  ds_read_b64_tr_b16 a[72:73], v226 offset:16384
  buffer_load_dwordx4 a[52:55], v231, s[4:7], s73 offen offset:3072 sc1
  v_mfma_f32_16x16x32_bf16 v[60:63], a[92:95], a[28:31], v[60:63]
  s_add_u32 s73, s73, 4096
  v_mfma_f32_16x16x32_bf16 v[56:59], a[92:95], a[24:27], v[56:59]
  ds_read_b64_tr_b16 a[74:75], v226 offset:20480
  v_mfma_f32_16x16x32_bf16 v[56:59], a[88:91], a[8:11], v[56:59]
  v_mfma_f32_16x16x32_bf16 v[52:55], a[88:91], a[4:7], v[52:55]
  ds_read_b64_tr_b16 a[76:77], v226 offset:24576
  v_mfma_f32_16x16x32_bf16 v[52:55], a[92:95], a[20:23], v[52:55]
  v_mfma_f32_16x16x32_bf16 v[48:51], a[92:95], a[16:19], v[48:51]
  ds_read_b64_tr_b16 a[78:79], v226 offset:28672
  v_mfma_f32_16x16x32_bf16 v[48:51], a[88:91], a[0:3], v[48:51]
  buffer_load_dwordx4 a[40:43], v231, s[4:7], s74 offen offset:2048 sc1
  s_waitcnt lgkmcnt(4)
  v_mfma_f32_16x16x32_bf16 v[64:67], a[64:67], a[0:3], v[64:67]
  ds_read_b64_tr_b16 a[80:81], v227 offset:0
  v_mfma_f32_16x16x32_bf16 v[64:67], a[68:71], a[16:19], v[64:67]
  v_mfma_f32_16x16x32_bf16 v[68:71], a[68:71], a[20:23], v[68:71]
  ds_read_b64_tr_b16 a[82:83], v227 offset:4096
  v_mfma_f32_16x16x32_bf16 v[68:71], a[64:67], a[4:7], v[68:71]
  v_mfma_f32_16x16x32_bf16 v[72:75], a[64:67], a[8:11], v[72:75]
  ds_read_b64_tr_b16 a[84:85], v227 offset:8192
  v_mfma_f32_16x16x32_bf16 v[72:75], a[68:71], a[24:27], v[72:75]
  v_mfma_f32_16x16x32_bf16 v[76:79], a[68:71], a[28:31], v[76:79]
  ds_read_b64_tr_b16 a[86:87], v227 offset:12288
  buffer_load_dwordx4 a[56:59], v231, s[4:7], s74 offen offset:3072 sc1
  v_mfma_f32_16x16x32_bf16 v[76:79], a[64:67], a[12:15], v[76:79]
  s_add_u32 s74, s74, 4096
  s_waitcnt lgkmcnt(4)
  v_mfma_f32_16x16x32_bf16 v[92:95], a[72:75], a[12:15], v[92:95]
  ds_read_b64_tr_b16 a[88:89], v227 offset:16384
  v_mfma_f32_16x16x32_bf16 v[92:95], a[76:79], a[28:31], v[92:95]
  v_mfma_f32_16x16x32_bf16 v[88:91], a[76:79], a[24:27], v[88:91]
  ds_read_b64_tr_b16 a[90:91], v227 offset:20480
  v_mfma_f32_16x16x32_bf16 v[88:91], a[72:75], a[8:11], v[88:91]
  v_mfma_f32_16x16x32_bf16 v[84:87], a[72:75], a[4:7], v[84:87]
  ds_read_b64_tr_b16 a[92:93], v227 offset:24576
  v_mfma_f32_16x16x32_bf16 v[84:87], a[76:79], a[20:23], v[84:87]
  buffer_load_dwordx4 a[44:47], v231, s[4:7], s75 offen offset:2048 sc1
  v_mfma_f32_16x16x32_bf16 v[80:83], a[76:79], a[16:19], v[80:83]
  ds_read_b64_tr_b16 a[94:95], v227 offset:28672
  v_mfma_f32_16x16x32_bf16 v[80:83], a[72:75], a[0:3], v[80:83]
  s_waitcnt lgkmcnt(4)
  v_mfma_f32_16x16x32_bf16 v[96:99], a[80:83], a[0:3], v[96:99]
  ds_read_b64_tr_b16 a[64:65], v228 offset:0
  v_mfma_f32_16x16x32_bf16 v[96:99], a[84:87], a[16:19], v[96:99]
  v_mfma_f32_16x16x32_bf16 v[100:103], a[84:87], a[20:23], v[100:103]
  ds_read_b64_tr_b16 a[66:67], v228 offset:4096
  v_mfma_f32_16x16x32_bf16 v[100:103], a[80:83], a[4:7], v[100:103]
  v_mfma_f32_16x16x32_bf16 v[104:107], a[80:83], a[8:11], v[104:107]
  ds_read_b64_tr_b16 a[68:69], v228 offset:8192
  buffer_load_dwordx4 a[60:63], v231, s[4:7], s75 offen offset:3072 sc1
  v_mfma_f32_16x16x32_bf16 v[104:107], a[84:87], a[24:27], v[104:107]
  s_add_u32 s75, s75, 4096
  v_mfma_f32_16x16x32_bf16 v[108:111], a[84:87], a[28:31], v[108:111]
  ds_read_b64_tr_b16 a[70:71], v228 offset:12288
  v_mfma_f32_16x16x32_bf16 v[108:111], a[80:83], a[12:15], v[108:111]
  buffer_load_dwordx4 a[96:99], v236, s[24:27], s70 offen
  s_waitcnt lgkmcnt(4)
  v_mfma_f32_16x16x32_bf16 v[124:127], a[88:91], a[12:15], v[124:127]
  ds_read_b64_tr_b16 a[72:73], v228 offset:16384
  s_add_u32 s70, s70, 1024
  v_mfma_f32_16x16x32_bf16 v[124:127], a[92:95], a[28:31], v[124:127]
  v_mfma_f32_16x16x32_bf16 v[120:123], a[92:95], a[24:27], v[120:123]
  ds_read_b64_tr_b16 a[74:75], v228 offset:20480
  s_add_u32 m0, s68, 0
  v_mfma_f32_16x16x32_bf16 v[120:123], a[88:91], a[8:11], v[120:123]
  buffer_load_dwordx4 v232, s[16:19], s67 offen offset:0 lds
  v_mfma_f32_16x16x32_bf16 v[116:119], a[88:91], a[4:7], v[116:119]
  ds_read_b64_tr_b16 a[76:77], v228 offset:24576
  v_mfma_f32_16x16x32_bf16 v[116:119], a[92:95], a[20:23], v[116:119]
  v_mfma_f32_16x16x32_bf16 v[112:115], a[92:95], a[16:19], v[112:115]
  ds_read_b64_tr_b16 a[78:79], v228 offset:28672
  v_mfma_f32_16x16x32_bf16 v[112:115], a[88:91], a[0:3], v[112:115]
  s_waitcnt lgkmcnt(4)
  v_mfma_f32_16x16x32_bf16 v[128:131], a[64:67], a[0:3], v[128:131]
  ds_read_b64_tr_b16 a[80:81], v229 offset:0
  v_mfma_f32_16x16x32_bf16 v[128:131], a[68:71], a[16:19], v[128:131]
  v_mfma_f32_16x16x32_bf16 v[132:135], a[68:71], a[20:23], v[132:135]
  ds_read_b64_tr_b16 a[82:83], v229 offset:4096
  buffer_load_dwordx4 v233, s[16:19], s67 offen offset:1024 lds
  v_mfma_f32_16x16x32_bf16 v[132:135], a[64:67], a[4:7], v[132:135]
  v_mfma_f32_16x16x32_bf16 v[136:139], a[64:67], a[8:11], v[136:139]
  ds_read_b64_tr_b16 a[84:85], v229 offset:8192
  v_mfma_f32_16x16x32_bf16 v[136:139], a[68:71], a[24:27], v[136:139]
  v_mfma_f32_16x16x32_bf16 v[140:143], a[68:71], a[28:31], v[140:143]
  ds_read_b64_tr_b16 a[86:87], v229 offset:12288
  v_mfma_f32_16x16x32_bf16 v[140:143], a[64:67], a[12:15], v[140:143]
  s_waitcnt lgkmcnt(4)
  v_mfma_f32_16x16x32_bf16 v[156:159], a[72:75], a[12:15], v[156:159]
  ds_read_b64_tr_b16 a[88:89], v229 offset:16384
  v_mfma_f32_16x16x32_bf16 v[156:159], a[76:79], a[28:31], v[156:159]
  buffer_load_dwordx4 v234, s[16:19], s67 offen offset:2048 lds
  v_mfma_f32_16x16x32_bf16 v[152:155], a[76:79], a[24:27], v[152:155]
  ds_read_b64_tr_b16 a[90:91], v229 offset:20480
  v_mfma_f32_16x16x32_bf16 v[152:155], a[72:75], a[8:11], v[152:155]
  v_mfma_f32_16x16x32_bf16 v[148:151], a[72:75], a[4:7], v[148:151]
  ds_read_b64_tr_b16 a[92:93], v229 offset:24576
  v_mfma_f32_16x16x32_bf16 v[148:151], a[76:79], a[20:23], v[148:151]
  v_mfma_f32_16x16x32_bf16 v[144:147], a[76:79], a[16:19], v[144:147]
  ds_read_b64_tr_b16 a[94:95], v229 offset:28672
  v_mfma_f32_16x16x32_bf16 v[144:147], a[72:75], a[0:3], v[144:147]
  s_waitcnt lgkmcnt(4)
  v_mfma_f32_16x16x32_bf16 v[160:163], a[80:83], a[0:3], v[160:163]
  ds_read_b64_tr_b16 a[64:65], v230 offset:0
  buffer_load_dwordx4 v235, s[16:19], s67 offen offset:3072 lds
  v_mfma_f32_16x16x32_bf16 v[160:163], a[84:87], a[16:19], v[160:163]
  v_mfma_f32_16x16x32_bf16 v[164:167], a[84:87], a[20:23], v[164:167]
  ds_read_b64_tr_b16 a[66:67], v230 offset:4096
  v_mfma_f32_16x16x32_bf16 v[164:167], a[80:83], a[4:7], v[164:167]
  v_mfma_f32_16x16x32_bf16 v[168:171], a[80:83], a[8:11], v[168:171]
  ds_read_b64_tr_b16 a[68:69], v230 offset:8192
  v_mfma_f32_16x16x32_bf16 v[168:171], a[84:87], a[24:27], v[168:171]
  v_mfma_f32_16x16x32_bf16 v[172:175], a[84:87], a[28:31], v[172:175]
  ds_read_b64_tr_b16 a[70:71], v230 offset:12288
  s_add_u32 m0, s68, 16384
  v_mfma_f32_16x16x32_bf16 v[172:175], a[80:83], a[12:15], v[172:175]
  buffer_load_dwordx4 v232, s[20:23], s67 offen offset:0 lds
  s_waitcnt lgkmcnt(4)
  v_mfma_f32_16x16x32_bf16 v[188:191], a[88:91], a[12:15], v[188:191]
  ds_read_b64_tr_b16 a[72:73], v230 offset:16384
  v_mfma_f32_16x16x32_bf16 v[188:191], a[92:95], a[28:31], v[188:191]
  v_mfma_f32_16x16x32_bf16 v[184:187], a[92:95], a[24:27], v[184:187]
  ds_read_b64_tr_b16 a[74:75], v230 offset:20480
  v_mfma_f32_16x16x32_bf16 v[184:187], a[88:91], a[8:11], v[184:187]
  v_mfma_f32_16x16x32_bf16 v[180:183], a[88:91], a[4:7], v[180:183]
  ds_read_b64_tr_b16 a[76:77], v230 offset:24576
  v_mfma_f32_16x16x32_bf16 v[180:183], a[92:95], a[20:23], v[180:183]
  v_mfma_f32_16x16x32_bf16 v[176:179], a[92:95], a[16:19], v[176:179]
  ds_read_b64_tr_b16 a[78:79], v230 offset:28672
  buffer_load_dwordx4 v233, s[20:23], s67 offen offset:1024 lds
  v_mfma_f32_16x16x32_bf16 v[176:179], a[88:91], a[0:3], v[176:179]
  s_waitcnt lgkmcnt(4)
  v_mfma_f32_16x16x32_bf16 v[192:195], a[64:67], a[0:3], v[192:195]
  s_waitcnt vmcnt(15)
  s_barrier
  ds_read_b64_tr_b16 a[80:81], v224 offset:32768
  v_mfma_f32_16x16x32_bf16 v[192:195], a[68:71], a[16:19], v[192:195]
  v_mfma_f32_16x16x32_bf16 v[196:199], a[68:71], a[20:23], v[196:199]
  ds_read_b64_tr_b16 a[82:83], v224 offset:36864
  v_mfma_f32_16x16x32_bf16 v[196:199], a[64:67], a[4:7], v[196:199]
  v_mfma_f32_16x16x32_bf16 v[200:203], a[64:67], a[8:11], v[200:203]
  ds_read_b64_tr_b16 a[84:85], v224 offset:40960
  v_mfma_f32_16x16x32_bf16 v[200:203], a[68:71], a[24:27], v[200:203]
  buffer_load_dwordx4 v234, s[20:23], s67 offen offset:2048 lds
  v_mfma_f32_16x16x32_bf16 v[204:207], a[68:71], a[28:31], v[204:207]
  ds_read_b64_tr_b16 a[86:87], v224 offset:45056
  v_mfma_f32_16x16x32_bf16 v[204:207], a[64:67], a[12:15], v[204:207]
  s_waitcnt lgkmcnt(4)
  v_mfma_f32_16x16x32_bf16 v[220:223], a[72:75], a[12:15], v[220:223]
  ds_read_b64_tr_b16 a[88:89], v224 offset:49152
  v_mfma_f32_16x16x32_bf16 v[220:223], a[76:79], a[28:31], v[220:223]
  v_mfma_f32_16x16x32_bf16 v[216:219], a[76:79], a[24:27], v[216:219]
  ds_read_b64_tr_b16 a[90:91], v224 offset:53248
  v_mfma_f32_16x16x32_bf16 v[216:219], a[72:75], a[8:11], v[216:219]
  v_mfma_f32_16x16x32_bf16 v[212:215], a[72:75], a[4:7], v[212:215]
  ds_read_b64_tr_b16 a[92:93], v224 offset:57344
  buffer_load_dwordx4 v235, s[20:23], s67 offen offset:3072 lds
  v_mfma_f32_16x16x32_bf16 v[212:215], a[76:79], a[20:23], v[212:215]
  s_add_u32 s67, s67, 458752
  v_mfma_f32_16x16x32_bf16 v[208:211], a[76:79], a[16:19], v[208:211]
  ds_read_b64_tr_b16 a[94:95], v224 offset:61440
  v_xor_b32 v224, 0x10000, v224
  v_mfma_f32_16x16x32_bf16 v[208:211], a[72:75], a[0:3], v[208:211]
  s_waitcnt vmcnt(9) lgkmcnt(4)
  v_mfma_f32_16x16x32_bf16 v[0:3], a[80:83], a[32:35], v[0:3]
  ds_read_b64_tr_b16 a[64:65], v225 offset:32768
  v_mfma_f32_16x16x32_bf16 v[0:3], a[84:87], a[48:51], v[0:3]
  v_mfma_f32_16x16x32_bf16 v[4:7], a[84:87], a[52:55], v[4:7]
  ds_read_b64_tr_b16 a[66:67], v225 offset:36864
  v_mfma_f32_16x16x32_bf16 v[4:7], a[80:83], a[36:39], v[4:7]
  buffer_load_dwordx4 a[0:3], v231, s[4:7], s72 offen offset:0 sc1
  v_mfma_f32_16x16x32_bf16 v[8:11], a[80:83], a[40:43], v[8:11]
  ds_read_b64_tr_b16 a[68:69], v225 offset:40960
  v_mfma_f32_16x16x32_bf16 v[8:11], a[84:87], a[56:59], v[8:11]
  v_mfma_f32_16x16x32_bf16 v[12:15], a[84:87], a[60:63], v[12:15]
  ds_read_b64_tr_b16 a[70:71], v225 offset:45056
  v_mfma_f32_16x16x32_bf16 v[12:15], a[80:83], a[44:47], v[12:15]
  s_waitcnt lgkmcnt(4)
  v_mfma_f32_16x16x32_bf16 v[28:31], a[88:91], a[44:47], v[28:31]
  ds_read_b64_tr_b16 a[72:73], v225 offset:49152
  v_mfma_f32_16x16x32_bf16 v[28:31], a[92:95], a[60:63], v[28:31]
  v_mfma_f32_16x16x32_bf16 v[24:27], a[92:95], a[56:59], v[24:27]
  ds_read_b64_tr_b16 a[74:75], v225 offset:53248
  buffer_load_dwordx4 a[16:19], v231, s[4:7], s72 offen offset:1024 sc1
  v_mfma_f32_16x16x32_bf16 v[24:27], a[88:91], a[40:43], v[24:27]
  v_mfma_f32_16x16x32_bf16 v[20:23], a[88:91], a[36:39], v[20:23]
  ds_read_b64_tr_b16 a[76:77], v225 offset:57344
  v_mfma_f32_16x16x32_bf16 v[20:23], a[92:95], a[52:55], v[20:23]
  v_mfma_f32_16x16x32_bf16 v[16:19], a[92:95], a[48:51], v[16:19]
  ds_read_b64_tr_b16 a[78:79], v225 offset:61440
  v_xor_b32 v225, 0x10000, v225
  v_mfma_f32_16x16x32_bf16 v[16:19], a[88:91], a[32:35], v[16:19]
  s_waitcnt lgkmcnt(4)
  v_mfma_f32_16x16x32_bf16 v[32:35], a[64:67], a[32:35], v[32:35]
  ds_read_b64_tr_b16 a[80:81], v226 offset:32768
  v_mfma_f32_16x16x32_bf16 v[32:35], a[68:71], a[48:51], v[32:35]
  buffer_load_dwordx4 a[4:7], v231, s[4:7], s73 offen offset:0 sc1
  v_mfma_f32_16x16x32_bf16 v[36:39], a[68:71], a[52:55], v[36:39]
  ds_read_b64_tr_b16 a[82:83], v226 offset:36864
  v_mfma_f32_16x16x32_bf16 v[36:39], a[64:67], a[36:39], v[36:39]
  v_mfma_f32_16x16x32_bf16 v[40:43], a[64:67], a[40:43], v[40:43]
  ds_read_b64_tr_b16 a[84:85], v226 offset:40960
  v_mfma_f32_16x16x32_bf16 v[40:43], a[68:71], a[56:59], v[40:43]
  v_mfma_f32_16x16x32_bf16 v[44:47], a[68:71], a[60:63], v[44:47]
  ds_read_b64_tr_b16 a[86:87], v226 offset:45056
  v_mfma_f32_16x16x32_bf16 v[44:47], a[64:67], a[44:47], v[44:47]
  s_waitcnt lgkmcnt(4)
  v_mfma_f32_16x16x32_bf16 v[60:63], a[72:75], a[44:47], v[60:63]
  ds_read_b64_tr_b16 a[88:89], v226 offset:49152
  buffer_load_dwordx4 a[20:23], v231, s[4:7], s73 offen offset:1024 sc1
  v_mfma_f32_16x16x32_bf16 v[60:63], a[76:79], a[60:63], v[60:63]
  v_mfma_f32_16x16x32_bf16 v[56:59], a[76:79], a[56:59], v[56:59]
  ds_read_b64_tr_b16 a[90:91], v226 offset:53248
  v_mfma_f32_16x16x32_bf16 v[56:59], a[72:75], a[40:43], v[56:59]
  v_mfma_f32_16x16x32_bf16 v[52:55], a[72:75], a[36:39], v[52:55]
  ds_read_b64_tr_b16 a[92:93], v226 offset:57344
  v_mfma_f32_16x16x32_bf16 v[52:55], a[76:79], a[52:55], v[52:55]
  v_mfma_f32_16x16x32_bf16 v[48:51], a[76:79], a[48:51], v[48:51]
  ds_read_b64_tr_b16 a[94:95], v226 offset:61440
  v_xor_b32 v226, 0x10000, v226
  v_mfma_f32_16x16x32_bf16 v[48:51], a[72:75], a[32:35], v[48:51]
  buffer_load_dwordx4 a[8:11], v231, s[4:7], s74 offen offset:0 sc1
  s_waitcnt lgkmcnt(4)
  v_mfma_f32_16x16x32_bf16 v[64:67], a[80:83], a[32:35], v[64:67]
  ds_read_b64_tr_b16 a[64:65], v227 offset:32768
  v_mfma_f32_16x16x32_bf16 v[64:67], a[84:87], a[48:51], v[64:67]
  v_mfma_f32_16x16x32_bf16 v[68:71], a[84:87], a[52:55], v[68:71]
  ds_read_b64_tr_b16 a[66:67], v227 offset:36864
  v_mfma_f32_16x16x32_bf16 v[68:71], a[80:83], a[36:39], v[68:71]
  v_mfma_f32_16x16x32_bf16 v[72:75], a[80:83], a[40:43], v[72:75]
  ds_read_b64_tr_b16 a[68:69], v227 offset:40960
  v_mfma_f32_16x16x32_bf16 v[72:75], a[84:87], a[56:59], v[72:75]
  v_mfma_f32_16x16x32_bf16 v[76:79], a[84:87], a[60:63], v[76:79]
  ds_read_b64_tr_b16 a[70:71], v227 offset:45056
  buffer_load_dwordx4 a[24:27], v231, s[4:7], s74 offen offset:1024 sc1
  v_mfma_f32_16x16x32_bf16 v[76:79], a[80:83], a[44:47], v[76:79]
  s_waitcnt lgkmcnt(4)
  v_mfma_f32_16x16x32_bf16 v[92:95], a[88:91], a[44:47], v[92:95]
  ds_read_b64_tr_b16 a[72:73], v227 offset:49152
  v_mfma_f32_16x16x32_bf16 v[92:95], a[92:95], a[60:63], v[92:95]
  v_mfma_f32_16x16x32_bf16 v[88:91], a[92:95], a[56:59], v[88:91]
  ds_read_b64_tr_b16 a[74:75], v227 offset:53248
  v_mfma_f32_16x16x32_bf16 v[88:91], a[88:91], a[40:43], v[88:91]
  v_mfma_f32_16x16x32_bf16 v[84:87], a[88:91], a[36:39], v[84:87]
  ds_read_b64_tr_b16 a[76:77], v227 offset:57344
  v_mfma_f32_16x16x32_bf16 v[84:87], a[92:95], a[52:55], v[84:87]
  buffer_load_dwordx4 a[12:15], v231, s[4:7], s75 offen offset:0 sc1
  v_mfma_f32_16x16x32_bf16 v[80:83], a[92:95], a[48:51], v[80:83]
  ds_read_b64_tr_b16 a[78:79], v227 offset:61440
  v_xor_b32 v227, 0x10000, v227
  v_mfma_f32_16x16x32_bf16 v[80:83], a[88:91], a[32:35], v[80:83]
  s_waitcnt lgkmcnt(4)
  v_mfma_f32_16x16x32_bf16 v[96:99], a[64:67], a[32:35], v[96:99]
  ds_read_b64_tr_b16 a[80:81], v228 offset:32768
  v_mfma_f32_16x16x32_bf16 v[96:99], a[68:71], a[48:51], v[96:99]
  v_mfma_f32_16x16x32_bf16 v[100:103], a[68:71], a[52:55], v[100:103]
  ds_read_b64_tr_b16 a[82:83], v228 offset:36864
  v_mfma_f32_16x16x32_bf16 v[100:103], a[64:67], a[36:39], v[100:103]
  v_mfma_f32_16x16x32_bf16 v[104:107], a[64:67], a[40:43], v[104:107]
  ds_read_b64_tr_b16 a[84:85], v228 offset:40960
  buffer_load_dwordx4 a[28:31], v231, s[4:7], s75 offen offset:1024 sc1
  v_mfma_f32_16x16x32_bf16 v[104:107], a[68:71], a[56:59], v[104:107]
  v_mfma_f32_16x16x32_bf16 v[108:111], a[68:71], a[60:63], v[108:111]
  ds_read_b64_tr_b16 a[86:87], v228 offset:45056
  v_mfma_f32_16x16x32_bf16 v[108:111], a[64:67], a[44:47], v[108:111]
  s_waitcnt lgkmcnt(4)
  v_mfma_f32_16x16x32_bf16 v[124:127], a[72:75], a[44:47], v[124:127]
  ds_read_b64_tr_b16 a[88:89], v228 offset:49152
  v_mfma_f32_16x16x32_bf16 v[124:127], a[76:79], a[60:63], v[124:127]
  v_mfma_f32_16x16x32_bf16 v[120:123], a[76:79], a[56:59], v[120:123]
  ds_read_b64_tr_b16 a[90:91], v228 offset:53248
  s_add_u32 m0, s68, 32768
  v_mfma_f32_16x16x32_bf16 v[120:123], a[72:75], a[40:43], v[120:123]
  buffer_load_dwordx4 v232, s[16:19], s67 offen offset:0 lds
  v_mfma_f32_16x16x32_bf16 v[116:119], a[72:75], a[36:39], v[116:119]
  ds_read_b64_tr_b16 a[92:93], v228 offset:57344
  v_mfma_f32_16x16x32_bf16 v[116:119], a[76:79], a[52:55], v[116:119]
  v_mfma_f32_16x16x32_bf16 v[112:115], a[76:79], a[48:51], v[112:115]
  ds_read_b64_tr_b16 a[94:95], v228 offset:61440
  v_xor_b32 v228, 0x10000, v228
  v_mfma_f32_16x16x32_bf16 v[112:115], a[72:75], a[32:35], v[112:115]
  s_waitcnt lgkmcnt(4)
  v_mfma_f32_16x16x32_bf16 v[128:131], a[80:83], a[32:35], v[128:131]
  ds_read_b64_tr_b16 a[64:65], v229 offset:32768
  v_mfma_f32_16x16x32_bf16 v[128:131], a[84:87], a[48:51], v[128:131]
  v_mfma_f32_16x16x32_bf16 v[132:135], a[84:87], a[52:55], v[132:135]
  ds_read_b64_tr_b16 a[66:67], v229 offset:36864
  buffer_load_dwordx4 v233, s[16:19], s67 offen offset:1024 lds
  v_mfma_f32_16x16x32_bf16 v[132:135], a[80:83], a[36:39], v[132:135]
  v_mfma_f32_16x16x32_bf16 v[136:139], a[80:83], a[40:43], v[136:139]
  ds_read_b64_tr_b16 a[68:69], v229 offset:40960
  v_mfma_f32_16x16x32_bf16 v[136:139], a[84:87], a[56:59], v[136:139]
  v_mfma_f32_16x16x32_bf16 v[140:143], a[84:87], a[60:63], v[140:143]
  ds_read_b64_tr_b16 a[70:71], v229 offset:45056
  v_mfma_f32_16x16x32_bf16 v[140:143], a[80:83], a[44:47], v[140:143]
  s_waitcnt lgkmcnt(4)
  v_mfma_f32_16x16x32_bf16 v[156:159], a[88:91], a[44:47], v[156:159]
  ds_read_b64_tr_b16 a[72:73], v229 offset:49152
  v_mfma_f32_16x16x32_bf16 v[156:159], a[92:95], a[60:63], v[156:159]
  buffer_load_dwordx4 v234, s[16:19], s67 offen offset:2048 lds
  v_mfma_f32_16x16x32_bf16 v[152:155], a[92:95], a[56:59], v[152:155]
  ds_read_b64_tr_b16 a[74:75], v229 offset:53248
  v_mfma_f32_16x16x32_bf16 v[152:155], a[88:91], a[40:43], v[152:155]
  v_mfma_f32_16x16x32_bf16 v[148:151], a[88:91], a[36:39], v[148:151]
  ds_read_b64_tr_b16 a[76:77], v229 offset:57344
  v_mfma_f32_16x16x32_bf16 v[148:151], a[92:95], a[52:55], v[148:151]
  v_mfma_f32_16x16x32_bf16 v[144:147], a[92:95], a[48:51], v[144:147]
  ds_read_b64_tr_b16 a[78:79], v229 offset:61440
  v_xor_b32 v229, 0x10000, v229
  v_mfma_f32_16x16x32_bf16 v[144:147], a[88:91], a[32:35], v[144:147]
  s_waitcnt lgkmcnt(4)
  v_mfma_f32_16x16x32_bf16 v[160:163], a[64:67], a[32:35], v[160:163]
  ds_read_b64_tr_b16 a[80:81], v230 offset:32768
  buffer_load_dwordx4 v235, s[16:19], s67 offen offset:3072 lds
  v_mfma_f32_16x16x32_bf16 v[160:163], a[68:71], a[48:51], v[160:163]
  v_mfma_f32_16x16x32_bf16 v[164:167], a[68:71], a[52:55], v[164:167]
  ds_read_b64_tr_b16 a[82:83], v230 offset:36864
  v_mfma_f32_16x16x32_bf16 v[164:167], a[64:67], a[36:39], v[164:167]
  v_mfma_f32_16x16x32_bf16 v[168:171], a[64:67], a[40:43], v[168:171]
  ds_read_b64_tr_b16 a[84:85], v230 offset:40960
  v_mfma_f32_16x16x32_bf16 v[168:171], a[68:71], a[56:59], v[168:171]
  v_mfma_f32_16x16x32_bf16 v[172:175], a[68:71], a[60:63], v[172:175]
  ds_read_b64_tr_b16 a[86:87], v230 offset:45056
  s_add_u32 m0, s68, 49152
  v_mfma_f32_16x16x32_bf16 v[172:175], a[64:67], a[44:47], v[172:175]
  buffer_load_dwordx4 v232, s[20:23], s67 offen offset:0 lds
  s_waitcnt lgkmcnt(4)
  v_mfma_f32_16x16x32_bf16 v[188:191], a[72:75], a[44:47], v[188:191]
  ds_read_b64_tr_b16 a[88:89], v230 offset:49152
  v_mfma_f32_16x16x32_bf16 v[188:191], a[76:79], a[60:63], v[188:191]
  v_mfma_f32_16x16x32_bf16 v[184:187], a[76:79], a[56:59], v[184:187]
  ds_read_b64_tr_b16 a[90:91], v230 offset:53248
  v_mfma_f32_16x16x32_bf16 v[184:187], a[72:75], a[40:43], v[184:187]
  v_mfma_f32_16x16x32_bf16 v[180:183], a[72:75], a[36:39], v[180:183]
  ds_read_b64_tr_b16 a[92:93], v230 offset:57344
  v_mfma_f32_16x16x32_bf16 v[180:183], a[76:79], a[52:55], v[180:183]
  v_mfma_f32_16x16x32_bf16 v[176:179], a[76:79], a[48:51], v[176:179]
  ds_read_b64_tr_b16 a[94:95], v230 offset:61440
  v_xor_b32 v230, 0x10000, v230
  buffer_load_dwordx4 v233, s[20:23], s67 offen offset:1024 lds
  v_mfma_f32_16x16x32_bf16 v[176:179], a[72:75], a[32:35], v[176:179]
  s_waitcnt lgkmcnt(4)
  v_mfma_f32_16x16x32_bf16 v[192:195], a[80:83], a[32:35], v[192:195]
  s_waitcnt vmcnt(14)
  s_barrier
  ds_read_b64_tr_b16 a[64:65], v224 offset:0
  v_mfma_f32_16x16x32_bf16 v[192:195], a[84:87], a[48:51], v[192:195]
  v_mfma_f32_16x16x32_bf16 v[196:199], a[84:87], a[52:55], v[196:199]
  ds_read_b64_tr_b16 a[66:67], v224 offset:4096
  v_mfma_f32_16x16x32_bf16 v[196:199], a[80:83], a[36:39], v[196:199]
  v_mfma_f32_16x16x32_bf16 v[200:203], a[80:83], a[40:43], v[200:203]
  ds_read_b64_tr_b16 a[68:69], v224 offset:8192
  v_mfma_f32_16x16x32_bf16 v[200:203], a[84:87], a[56:59], v[200:203]
  buffer_load_dwordx4 v234, s[20:23], s67 offen offset:2048 lds
  v_mfma_f32_16x16x32_bf16 v[204:207], a[84:87], a[60:63], v[204:207]
  ds_read_b64_tr_b16 a[70:71], v224 offset:12288
  v_mfma_f32_16x16x32_bf16 v[204:207], a[80:83], a[44:47], v[204:207]
  s_waitcnt lgkmcnt(4)
  v_mfma_f32_16x16x32_bf16 v[220:223], a[88:91], a[44:47], v[220:223]
  ds_read_b64_tr_b16 a[72:73], v224 offset:16384
  v_mfma_f32_16x16x32_bf16 v[220:223], a[92:95], a[60:63], v[220:223]
  v_mfma_f32_16x16x32_bf16 v[216:219], a[92:95], a[56:59], v[216:219]
  ds_read_b64_tr_b16 a[74:75], v224 offset:20480
  v_mfma_f32_16x16x32_bf16 v[216:219], a[88:91], a[40:43], v[216:219]
  v_mfma_f32_16x16x32_bf16 v[212:215], a[88:91], a[36:39], v[212:215]
  ds_read_b64_tr_b16 a[76:77], v224 offset:24576
  buffer_load_dwordx4 v235, s[20:23], s67 offen offset:3072 lds
  v_mfma_f32_16x16x32_bf16 v[212:215], a[92:95], a[52:55], v[212:215]
  s_add_u32 s67, s67, 458752
  s_xor_b32 s68, s68, 0x10000
  v_mfma_f32_16x16x32_bf16 v[208:211], a[92:95], a[48:51], v[208:211]
  ds_read_b64_tr_b16 a[78:79], v224 offset:28672
  v_mfma_f32_16x16x32_bf16 v[208:211], a[88:91], a[32:35], v[208:211]
  s_sub_u32 s56, s56, 1
  s_cmp_lg_u32 s56, 0
  s_cbranch_scc1 Lp3_loop
  s_waitcnt vmcnt(8) lgkmcnt(4)
  v_mfma_f32_16x16x32_bf16 v[0:3], a[64:67], a[0:3], v[0:3]
  ds_read_b64_tr_b16 a[80:81], v225 offset:0
  v_add_f32 v242, v242, v246
  v_add_f32 v243, v243, v247
  v_mfma_f32_16x16x32_bf16 v[0:3], a[68:71], a[16:19], v[0:3]
  s_xor_b32 s93, s53, 1
  v_add_f32 v244, v244, v248
  v_add_f32 v245, v245, v249
  v_mfma_f32_16x16x32_bf16 v[4:7], a[68:71], a[20:23], v[4:7]
  ds_read_b64_tr_b16 a[82:83], v225 offset:4096
  ds_write_b128 v250, v[242:245]
  v_mfma_f32_16x16x32_bf16 v[4:7], a[64:67], a[4:7], v[4:7]
  buffer_load_dwordx4 a[32:35], v231, s[4:7], s72 offen offset:2048 sc1
  s_lshl_b32 s93, s93, 7
  ds_read_b128 v[246:249], v237 offset:448
  v_mfma_f32_16x16x32_bf16 v[8:11], a[64:67], a[8:11], v[8:11]
  ds_read_b64_tr_b16 a[84:85], v225 offset:8192
  v_mfma_f32_16x16x32_bf16 v[8:11], a[68:71], a[24:27], v[8:11]
  s_add_u32 s80, s24, s93
  s_addc_u32 s81, s25, 0
  v_mfma_f32_16x16x32_bf16 v[12:15], a[68:71], a[28:31], v[12:15]
  ds_read_b64_tr_b16 a[86:87], v225 offset:12288
  v_mfma_f32_16x16x32_bf16 v[12:15], a[64:67], a[12:15], v[12:15]
  s_sub_u32 s82, 7340032, s93
  s_waitcnt lgkmcnt(6)
  v_mfma_f32_16x16x32_bf16 v[28:31], a[72:75], a[12:15], v[28:31]
  s_waitcnt lgkmcnt(2)
  ds_read_b64_tr_b16 a[88:89], v225 offset:16384
  ds_read_b128 v[242:245], v237 offset:512
  v_fmac_f32 v112, v246, v238
  v_fmac_f32 v113, v247, v238
  v_mfma_f32_16x16x32_bf16 v[28:31], a[76:79], a[28:31], v[28:31]
  s_mov_b32 s83, 0x20000
  v_fmac_f32 v114, v248, v238
  v_fmac_f32 v115, v249, v238
  v_mfma_f32_16x16x32_bf16 v[24:27], a[76:79], a[24:27], v[24:27]
  ds_read_b64_tr_b16 a[90:91], v225 offset:20480
  buffer_load_dwordx4 a[48:51], v231, s[4:7], s72 offen offset:3072 sc1
  v_fmac_f32 v116, v246, v239
  v_fmac_f32 v117, v247, v239
  v_mfma_f32_16x16x32_bf16 v[24:27], a[72:75], a[8:11], v[24:27]
  s_add_u32 s72, s72, 4096
  s_lshl_b32 s93, s53, 7
  v_fmac_f32 v118, v248, v239
  v_fmac_f32 v119, v249, v239
  v_mfma_f32_16x16x32_bf16 v[20:23], a[72:75], a[4:7], v[20:23]
  ds_read_b64_tr_b16 a[92:93], v225 offset:24576
  v_fmac_f32 v120, v246, v240
  v_fmac_f32 v121, v247, v240
  v_mfma_f32_16x16x32_bf16 v[20:23], a[76:79], a[20:23], v[20:23]
  s_add_u32 s84, s24, s93
  s_addc_u32 s85, s25, 0
  v_fmac_f32 v122, v248, v240
  v_fmac_f32 v123, v249, v240
  v_mfma_f32_16x16x32_bf16 v[16:19], a[76:79], a[16:19], v[16:19]
  ds_read_b64_tr_b16 a[94:95], v225 offset:28672
  v_fmac_f32 v124, v246, v241
  v_fmac_f32 v125, v247, v241
  v_mfma_f32_16x16x32_bf16 v[16:19], a[72:75], a[0:3], v[16:19]
  s_sub_u32 s84, s84, 1024
  s_subb_u32 s85, s85, 0
  v_fmac_f32 v126, v248, v241
  v_fmac_f32 v127, v249, v241
  s_waitcnt lgkmcnt(5)
  v_mfma_f32_16x16x32_bf16 v[32:35], a[80:83], a[0:3], v[32:35]
  s_waitcnt lgkmcnt(3)
  ds_read_b64_tr_b16 a[64:65], v226 offset:0
  ds_read_b128 v[246:249], v237 offset:576
  v_fmac_f32 v128, v242, v238
  v_fmac_f32 v129, v243, v238
  v_mfma_f32_16x16x32_bf16 v[32:35], a[84:87], a[16:19], v[32:35]
  buffer_load_dwordx4 a[36:39], v231, s[4:7], s73 offen offset:2048 sc1
  s_sub_u32 s86, 7341056, s93
  v_fmac_f32 v130, v244, v238
  v_fmac_f32 v131, v245, v238
  v_mfma_f32_16x16x32_bf16 v[36:39], a[84:87], a[20:23], v[36:39]
  ds_read_b64_tr_b16 a[66:67], v226 offset:4096
  v_fmac_f32 v132, v242, v239
  v_fmac_f32 v133, v243, v239
  v_mfma_f32_16x16x32_bf16 v[36:39], a[80:83], a[4:7], v[36:39]
  s_mov_b32 s87, 0x20000
  v_fmac_f32 v134, v244, v239
  v_fmac_f32 v135, v245, v239
  v_mfma_f32_16x16x32_bf16 v[40:43], a[80:83], a[8:11], v[40:43]
  ds_read_b64_tr_b16 a[68:69], v226 offset:8192
  v_fmac_f32 v136, v242, v240
  v_fmac_f32 v137, v243, v240
  v_mfma_f32_16x16x32_bf16 v[40:43], a[84:87], a[24:27], v[40:43]
  s_and_b32 s93, s53, 1
  v_fmac_f32 v138, v244, v240
  v_fmac_f32 v139, v245, v240
  v_mfma_f32_16x16x32_bf16 v[44:47], a[84:87], a[28:31], v[44:47]
  ds_read_b64_tr_b16 a[70:71], v226 offset:12288
  v_fmac_f32 v140, v242, v241
  v_fmac_f32 v141, v243, v241
  v_mfma_f32_16x16x32_bf16 v[44:47], a[80:83], a[12:15], v[44:47]
  s_mul_i32 s92, s93, 3670016
  v_fmac_f32 v142, v244, v241
  v_fmac_f32 v143, v245, v241
  s_waitcnt lgkmcnt(5)
  v_mfma_f32_16x16x32_bf16 v[60:63], a[88:91], a[12:15], v[60:63]
  s_waitcnt lgkmcnt(3)
  ds_read_b64_tr_b16 a[72:73], v226 offset:16384
  buffer_load_dwordx4 a[52:55], v231, s[4:7], s73 offen offset:3072 sc1
  ds_read_b128 v[242:245], v237 offset:640
  v_fmac_f32 v144, v246, v238
  v_fmac_f32 v145, v247, v238
  v_mfma_f32_16x16x32_bf16 v[60:63], a[92:95], a[28:31], v[60:63]
  s_add_u32 s73, s73, 4096
  s_lshl_b32 s93, s40, 14
  v_fmac_f32 v146, v248, v238
  v_fmac_f32 v147, v249, v238
  v_mfma_f32_16x16x32_bf16 v[56:59], a[92:95], a[24:27], v[56:59]
  ds_read_b64_tr_b16 a[74:75], v226 offset:20480
  v_fmac_f32 v148, v246, v239
  v_fmac_f32 v149, v247, v239
  v_mfma_f32_16x16x32_bf16 v[56:59], a[88:91], a[8:11], v[56:59]
  s_add_u32 s92, s92, s93
  v_fmac_f32 v150, v248, v239
  v_fmac_f32 v151, v249, v239
  v_mfma_f32_16x16x32_bf16 v[52:55], a[88:91], a[4:7], v[52:55]
  ds_read_b64_tr_b16 a[76:77], v226 offset:24576
  v_fmac_f32 v152, v246, v240
  v_fmac_f32 v153, v247, v240
  v_mfma_f32_16x16x32_bf16 v[52:55], a[92:95], a[20:23], v[52:55]
  s_lshl_b32 s79, s40, 11
  v_fmac_f32 v154, v248, v240
  v_fmac_f32 v155, v249, v240
  v_mfma_f32_16x16x32_bf16 v[48:51], a[92:95], a[16:19], v[48:51]
  ds_read_b64_tr_b16 a[78:79], v226 offset:28672
  v_fmac_f32 v156, v246, v241
  v_fmac_f32 v157, v247, v241
  v_mfma_f32_16x16x32_bf16 v[48:51], a[88:91], a[0:3], v[48:51]
  buffer_load_dwordx4 a[40:43], v231, s[4:7], s74 offen offset:2048 sc1
  s_lshr_b32 s93, s53, 1
  v_fmac_f32 v158, v248, v241
  v_fmac_f32 v159, v249, v241
  s_waitcnt lgkmcnt(5)
  v_mfma_f32_16x16x32_bf16 v[64:67], a[64:67], a[0:3], v[64:67]
  s_waitcnt lgkmcnt(3)
  ds_read_b64_tr_b16 a[80:81], v227 offset:0
  ds_read_b128 v[246:249], v237 offset:704
  v_fmac_f32 v160, v242, v238
  v_fmac_f32 v161, v243, v238
  v_mfma_f32_16x16x32_bf16 v[64:67], a[68:71], a[16:19], v[64:67]
  s_add_u32 s93, s93, s52
  v_fmac_f32 v162, v244, v238
  v_fmac_f32 v163, v245, v238
  v_mfma_f32_16x16x32_bf16 v[68:71], a[68:71], a[20:23], v[68:71]
  ds_read_b64_tr_b16 a[82:83], v227 offset:4096
  v_fmac_f32 v164, v242, v239
  v_fmac_f32 v165, v243, v239
  v_mfma_f32_16x16x32_bf16 v[68:71], a[64:67], a[4:7], v[68:71]
  s_and_b32 s93, s93, 3
  v_fmac_f32 v166, v244, v239
  v_fmac_f32 v167, v245, v239
  v_mfma_f32_16x16x32_bf16 v[72:75], a[64:67], a[8:11], v[72:75]
  ds_read_b64_tr_b16 a[84:85], v227 offset:8192
  v_fmac_f32 v168, v242, v240
  v_fmac_f32 v169, v243, v240
  v_mfma_f32_16x16x32_bf16 v[72:75], a[68:71], a[24:27], v[72:75]
  s_cmp_eq_u32 s93, 0
  s_cselect_b32 s88, 917504, 0
  v_fmac_f32 v170, v244, v240
  v_fmac_f32 v171, v245, v240
  v_mfma_f32_16x16x32_bf16 v[76:79], a[68:71], a[28:31], v[76:79]
  ds_read_b64_tr_b16 a[86:87], v227 offset:12288
  buffer_load_dwordx4 a[56:59], v231, s[4:7], s74 offen offset:3072 sc1
  v_fmac_f32 v172, v242, v241
  v_fmac_f32 v173, v243, v241
  v_mfma_f32_16x16x32_bf16 v[76:79], a[64:67], a[12:15], v[76:79]
  s_add_u32 s74, s74, 4096
  s_cmp_eq_u32 s93, 1
  s_cselect_b32 s89, 917504, 0
  v_fmac_f32 v174, v244, v241
  v_fmac_f32 v175, v245, v241
  s_waitcnt lgkmcnt(5)
  v_mfma_f32_16x16x32_bf16 v[92:95], a[72:75], a[12:15], v[92:95]
  s_waitcnt lgkmcnt(3)
  ds_read_b64_tr_b16 a[88:89], v227 offset:16384
  ds_read_b128 v[242:245], v237 offset:768
  v_fmac_f32 v176, v246, v238
  v_fmac_f32 v177, v247, v238
  v_mfma_f32_16x16x32_bf16 v[92:95], a[76:79], a[28:31], v[92:95]
  s_cmp_eq_u32 s93, 2
  s_cselect_b32 s90, 917504, 0
  v_fmac_f32 v178, v248, v238
  v_fmac_f32 v179, v249, v238
  v_mfma_f32_16x16x32_bf16 v[88:91], a[76:79], a[24:27], v[88:91]
  ds_read_b64_tr_b16 a[90:91], v227 offset:20480
  v_fmac_f32 v180, v246, v239
  v_fmac_f32 v181, v247, v239
  v_mfma_f32_16x16x32_bf16 v[88:91], a[72:75], a[8:11], v[88:91]
  s_cmp_eq_u32 s93, 3
  s_cselect_b32 s91, 917504, 0
  v_fmac_f32 v182, v248, v239
  v_fmac_f32 v183, v249, v239
  v_mfma_f32_16x16x32_bf16 v[84:87], a[72:75], a[4:7], v[84:87]
  ds_read_b64_tr_b16 a[92:93], v227 offset:24576
  v_fmac_f32 v184, v246, v240
  v_fmac_f32 v185, v247, v240
  v_mfma_f32_16x16x32_bf16 v[84:87], a[76:79], a[20:23], v[84:87]
  buffer_load_dwordx4 a[44:47], v231, s[4:7], s75 offen offset:2048 sc1
  s_cmp_eq_u32 s40, 1
  s_cselect_b32 s78, 16384, 0
  v_fmac_f32 v186, v248, v240
  v_fmac_f32 v187, v249, v240
  v_mfma_f32_16x16x32_bf16 v[80:83], a[76:79], a[16:19], v[80:83]
  ds_read_b64_tr_b16 a[94:95], v227 offset:28672
  v_fmac_f32 v188, v246, v241
  v_fmac_f32 v189, v247, v241
  v_mfma_f32_16x16x32_bf16 v[80:83], a[72:75], a[0:3], v[80:83]
  s_cmp_eq_u32 s40, 2
  s_cselect_b32 s78, -16384, s78
  v_fmac_f32 v190, v248, v241
  v_fmac_f32 v191, v249, v241
  s_waitcnt lgkmcnt(5)
  v_mfma_f32_16x16x32_bf16 v[96:99], a[80:83], a[0:3], v[96:99]
  s_waitcnt lgkmcnt(3)
  ds_read_b64_tr_b16 a[64:65], v228 offset:0
  ds_read_b128 v[246:249], v237 offset:832
  v_fmac_f32 v192, v242, v238
  v_fmac_f32 v193, v243, v238
  v_mfma_f32_16x16x32_bf16 v[96:99], a[84:87], a[16:19], v[96:99]
  v_fmac_f32 v194, v244, v238
  v_fmac_f32 v195, v245, v238
  v_mfma_f32_16x16x32_bf16 v[100:103], a[84:87], a[20:23], v[100:103]
  ds_read_b64_tr_b16 a[66:67], v228 offset:4096
  v_fmac_f32 v196, v242, v239
  v_fmac_f32 v197, v243, v239
  v_mfma_f32_16x16x32_bf16 v[100:103], a[80:83], a[4:7], v[100:103]
  v_fmac_f32 v198, v244, v239
  v_fmac_f32 v199, v245, v239
  v_mfma_f32_16x16x32_bf16 v[104:107], a[80:83], a[8:11], v[104:107]
  ds_read_b64_tr_b16 a[68:69], v228 offset:8192
  buffer_load_dwordx4 a[60:63], v231, s[4:7], s75 offen offset:3072 sc1
  v_fmac_f32 v200, v242, v240
  v_fmac_f32 v201, v243, v240
  v_mfma_f32_16x16x32_bf16 v[104:107], a[84:87], a[24:27], v[104:107]
  s_add_u32 s75, s75, 4096
  v_fmac_f32 v202, v244, v240
  v_fmac_f32 v203, v245, v240
  v_mfma_f32_16x16x32_bf16 v[108:111], a[84:87], a[28:31], v[108:111]
  ds_read_b64_tr_b16 a[70:71], v228 offset:12288
  v_fmac_f32 v204, v242, v241
  v_fmac_f32 v205, v243, v241
  v_mfma_f32_16x16x32_bf16 v[108:111], a[80:83], a[12:15], v[108:111]
  v_fmac_f32 v206, v244, v241
  v_fmac_f32 v207, v245, v241
  s_waitcnt lgkmcnt(5)
  v_mfma_f32_16x16x32_bf16 v[124:127], a[88:91], a[12:15], v[124:127]
  s_waitcnt lgkmcnt(3)
  ds_read_b64_tr_b16 a[72:73], v228 offset:16384
  ds_read_b128 v[242:245], v237 offset:0
  v_fmac_f32 v208, v246, v238
  v_fmac_f32 v209, v247, v238
  v_mfma_f32_16x16x32_bf16 v[124:127], a[92:95], a[28:31], v[124:127]
  s_add_u32 m0, s79, 0
  v_fmac_f32 v210, v248, v238
  v_fmac_f32 v211, v249, v238
  v_mfma_f32_16x16x32_bf16 v[120:123], a[92:95], a[24:27], v[120:123]
  ds_read_b64_tr_b16 a[74:75], v228 offset:20480
  v_fmac_f32 v212, v246, v239
  v_fmac_f32 v213, v247, v239
  v_mfma_f32_16x16x32_bf16 v[120:123], a[88:91], a[8:11], v[120:123]
  s_add_u32 s93, s92, s88
  v_fmac_f32 v214, v248, v239
  v_fmac_f32 v215, v249, v239
  v_mfma_f32_16x16x32_bf16 v[116:119], a[88:91], a[4:7], v[116:119]
  ds_read_b64_tr_b16 a[76:77], v228 offset:24576
  v_fmac_f32 v216, v246, v240
  v_fmac_f32 v217, v247, v240
  v_mfma_f32_16x16x32_bf16 v[116:119], a[92:95], a[20:23], v[116:119]
  buffer_load_dwordx4 v252, s[80:83], s93 offen lds
  v_fmac_f32 v218, v248, v240
  v_fmac_f32 v219, v249, v240
  v_mfma_f32_16x16x32_bf16 v[112:115], a[92:95], a[16:19], v[112:115]
  ds_read_b64_tr_b16 a[78:79], v228 offset:28672
  v_fmac_f32 v220, v246, v241
  v_fmac_f32 v221, v247, v241
  v_mfma_f32_16x16x32_bf16 v[112:115], a[88:91], a[0:3], v[112:115]
  buffer_load_dwordx4 v252, s[84:87], s93 offen offset:1024 lds
  v_fmac_f32 v222, v248, v241
  v_fmac_f32 v223, v249, v241
  s_waitcnt lgkmcnt(5)
  v_mfma_f32_16x16x32_bf16 v[128:131], a[64:67], a[0:3], v[128:131]
  s_waitcnt lgkmcnt(3)
  ds_read_b64_tr_b16 a[80:81], v229 offset:0
  ds_read_b128 v[246:249], v237 offset:64
  v_fmac_f32 v0, v242, v238
  v_fmac_f32 v1, v243, v238
  v_mfma_f32_16x16x32_bf16 v[128:131], a[68:71], a[16:19], v[128:131]
  s_add_u32 s92, s92, 262144
  v_fmac_f32 v2, v244, v238
  v_fmac_f32 v3, v245, v238
  v_mfma_f32_16x16x32_bf16 v[132:135], a[68:71], a[20:23], v[132:135]
  ds_read_b64_tr_b16 a[82:83], v229 offset:4096
  v_fmac_f32 v4, v242, v239
  v_fmac_f32 v5, v243, v239
  v_mfma_f32_16x16x32_bf16 v[132:135], a[64:67], a[4:7], v[132:135]
  v_fmac_f32 v6, v244, v239
  v_fmac_f32 v7, v245, v239
  v_mfma_f32_16x16x32_bf16 v[136:139], a[64:67], a[8:11], v[136:139]
  ds_read_b64_tr_b16 a[84:85], v229 offset:8192
  v_fmac_f32 v8, v242, v240
  v_fmac_f32 v9, v243, v240
  v_mfma_f32_16x16x32_bf16 v[136:139], a[68:71], a[24:27], v[136:139]
  v_fmac_f32 v10, v244, v240
  v_fmac_f32 v11, v245, v240
  v_mfma_f32_16x16x32_bf16 v[140:143], a[68:71], a[28:31], v[140:143]
  ds_read_b64_tr_b16 a[86:87], v229 offset:12288
  v_fmac_f32 v12, v242, v241
  v_fmac_f32 v13, v243, v241
  v_mfma_f32_16x16x32_bf16 v[140:143], a[64:67], a[12:15], v[140:143]
  s_add_u32 m0, s79, 8192
  v_fmac_f32 v14, v244, v241
  v_fmac_f32 v15, v245, v241
  s_waitcnt lgkmcnt(5)
  v_mfma_f32_16x16x32_bf16 v[156:159], a[72:75], a[12:15], v[156:159]
  s_waitcnt lgkmcnt(3)
  ds_read_b64_tr_b16 a[88:89], v229 offset:16384
  ds_read_b128 v[242:245], v237 offset:128
  v_fmac_f32 v16, v246, v238
  v_fmac_f32 v17, v247, v238
  v_mfma_f32_16x16x32_bf16 v[156:159], a[76:79], a[28:31], v[156:159]
  s_add_u32 s93, s92, s89
  v_fmac_f32 v18, v248, v238
  v_fmac_f32 v19, v249, v238
  v_mfma_f32_16x16x32_bf16 v[152:155], a[76:79], a[24:27], v[152:155]
  ds_read_b64_tr_b16 a[90:91], v229 offset:20480
  v_fmac_f32 v20, v246, v239
  v_fmac_f32 v21, v247, v239
  v_mfma_f32_16x16x32_bf16 v[152:155], a[72:75], a[8:11], v[152:155]
  buffer_load_dwordx4 v252, s[80:83], s93 offen lds
  v_fmac_f32 v22, v248, v239
  v_fmac_f32 v23, v249, v239
  v_mfma_f32_16x16x32_bf16 v[148:151], a[72:75], a[4:7], v[148:151]
  ds_read_b64_tr_b16 a[92:93], v229 offset:24576
  v_fmac_f32 v24, v246, v240
  v_fmac_f32 v25, v247, v240
  v_mfma_f32_16x16x32_bf16 v[148:151], a[76:79], a[20:23], v[148:151]
  buffer_load_dwordx4 v252, s[84:87], s93 offen offset:1024 lds
  v_fmac_f32 v26, v248, v240
  v_fmac_f32 v27, v249, v240
  v_mfma_f32_16x16x32_bf16 v[144:147], a[76:79], a[16:19], v[144:147]
  ds_read_b64_tr_b16 a[94:95], v229 offset:28672
  v_fmac_f32 v28, v246, v241
  v_fmac_f32 v29, v247, v241
  v_mfma_f32_16x16x32_bf16 v[144:147], a[72:75], a[0:3], v[144:147]
  s_add_u32 s92, s92, 196608
  v_fmac_f32 v30, v248, v241
  v_fmac_f32 v31, v249, v241
  s_waitcnt lgkmcnt(5)
  v_mfma_f32_16x16x32_bf16 v[160:163], a[80:83], a[0:3], v[160:163]
  s_waitcnt lgkmcnt(3)
  ds_read_b64_tr_b16 a[64:65], v230 offset:0
  ds_read_b128 v[246:249], v237 offset:192
  v_fmac_f32 v32, v242, v238
  v_fmac_f32 v33, v243, v238
  v_mfma_f32_16x16x32_bf16 v[160:163], a[84:87], a[16:19], v[160:163]
  v_fmac_f32 v34, v244, v238
  v_fmac_f32 v35, v245, v238
  v_mfma_f32_16x16x32_bf16 v[164:167], a[84:87], a[20:23], v[164:167]
  ds_read_b64_tr_b16 a[66:67], v230 offset:4096
  v_fmac_f32 v36, v242, v239
  v_fmac_f32 v37, v243, v239
  v_mfma_f32_16x16x32_bf16 v[164:167], a[80:83], a[4:7], v[164:167]
  v_fmac_f32 v38, v244, v239
  v_fmac_f32 v39, v245, v239
  v_mfma_f32_16x16x32_bf16 v[168:171], a[80:83], a[8:11], v[168:171]
  ds_read_b64_tr_b16 a[68:69], v230 offset:8192
  v_fmac_f32 v40, v242, v240
  v_fmac_f32 v41, v243, v240
  v_mfma_f32_16x16x32_bf16 v[168:171], a[84:87], a[24:27], v[168:171]
  s_add_u32 m0, s79, 16384
  v_fmac_f32 v42, v244, v240
  v_fmac_f32 v43, v245, v240
  v_mfma_f32_16x16x32_bf16 v[172:175], a[84:87], a[28:31], v[172:175]
  ds_read_b64_tr_b16 a[70:71], v230 offset:12288
  v_fmac_f32 v44, v242, v241
  v_fmac_f32 v45, v243, v241
  v_mfma_f32_16x16x32_bf16 v[172:175], a[80:83], a[12:15], v[172:175]
  s_add_u32 s93, s92, s90
  v_fmac_f32 v46, v244, v241
  v_fmac_f32 v47, v245, v241
  s_waitcnt lgkmcnt(5)
  v_mfma_f32_16x16x32_bf16 v[188:191], a[88:91], a[12:15], v[188:191]
  s_waitcnt lgkmcnt(3)
  ds_read_b64_tr_b16 a[72:73], v230 offset:16384
  ds_read_b128 v[242:245], v237 offset:256
  v_fmac_f32 v48, v246, v238
  v_fmac_f32 v49, v247, v238
  v_mfma_f32_16x16x32_bf16 v[188:191], a[92:95], a[28:31], v[188:191]
  buffer_load_dwordx4 v252, s[80:83], s93 offen lds
  v_fmac_f32 v50, v248, v238
  v_fmac_f32 v51, v249, v238
  v_mfma_f32_16x16x32_bf16 v[184:187], a[92:95], a[24:27], v[184:187]
  ds_read_b64_tr_b16 a[74:75], v230 offset:20480
  v_fmac_f32 v52, v246, v239
  v_fmac_f32 v53, v247, v239
  v_mfma_f32_16x16x32_bf16 v[184:187], a[88:91], a[8:11], v[184:187]
  buffer_load_dwordx4 v252, s[84:87], s93 offen offset:1024 lds
  v_fmac_f32 v54, v248, v239
  v_fmac_f32 v55, v249, v239
  v_mfma_f32_16x16x32_bf16 v[180:183], a[88:91], a[4:7], v[180:183]
  ds_read_b64_tr_b16 a[76:77], v230 offset:24576
  v_fmac_f32 v56, v246, v240
  v_fmac_f32 v57, v247, v240
  v_mfma_f32_16x16x32_bf16 v[180:183], a[92:95], a[20:23], v[180:183]
  s_add_u32 s92, s92, 262144
  v_fmac_f32 v58, v248, v240
  v_fmac_f32 v59, v249, v240
  v_mfma_f32_16x16x32_bf16 v[176:179], a[92:95], a[16:19], v[176:179]
  ds_read_b64_tr_b16 a[78:79], v230 offset:28672
  v_fmac_f32 v60, v246, v241
  v_fmac_f32 v61, v247, v241
  v_mfma_f32_16x16x32_bf16 v[176:179], a[88:91], a[0:3], v[176:179]
  v_fmac_f32 v62, v248, v241
  v_fmac_f32 v63, v249, v241
  s_waitcnt lgkmcnt(5)
  v_mfma_f32_16x16x32_bf16 v[192:195], a[64:67], a[0:3], v[192:195]
  s_waitcnt lgkmcnt(3)
  s_waitcnt vmcnt(14)
  s_barrier
  ds_read_b64_tr_b16 a[80:81], v224 offset:32768
  ds_read_b128 v[246:249], v237 offset:320
  v_fmac_f32 v64, v242, v238
  v_fmac_f32 v65, v243, v238
  v_mfma_f32_16x16x32_bf16 v[192:195], a[68:71], a[16:19], v[192:195]
  v_fmac_f32 v66, v244, v238
  v_fmac_f32 v67, v245, v238
  v_mfma_f32_16x16x32_bf16 v[196:199], a[68:71], a[20:23], v[196:199]
  ds_read_b64_tr_b16 a[82:83], v224 offset:36864
  v_fmac_f32 v68, v242, v239
  v_fmac_f32 v69, v243, v239
  v_mfma_f32_16x16x32_bf16 v[196:199], a[64:67], a[4:7], v[196:199]
  s_add_u32 m0, s79, 24576
  v_fmac_f32 v70, v244, v239
  v_fmac_f32 v71, v245, v239
  v_mfma_f32_16x16x32_bf16 v[200:203], a[64:67], a[8:11], v[200:203]
  ds_read_b64_tr_b16 a[84:85], v224 offset:40960
  v_fmac_f32 v72, v242, v240
  v_fmac_f32 v73, v243, v240
  v_mfma_f32_16x16x32_bf16 v[200:203], a[68:71], a[24:27], v[200:203]
  s_add_u32 s93, s92, s91
  v_fmac_f32 v74, v244, v240
  v_fmac_f32 v75, v245, v240
  v_mfma_f32_16x16x32_bf16 v[204:207], a[68:71], a[28:31], v[204:207]
  ds_read_b64_tr_b16 a[86:87], v224 offset:45056
  v_fmac_f32 v76, v242, v241
  v_fmac_f32 v77, v243, v241
  v_mfma_f32_16x16x32_bf16 v[204:207], a[64:67], a[12:15], v[204:207]
  buffer_load_dwordx4 v252, s[80:83], s93 offen lds
  v_fmac_f32 v78, v244, v241
  v_fmac_f32 v79, v245, v241
  s_waitcnt lgkmcnt(5)
  v_mfma_f32_16x16x32_bf16 v[220:223], a[72:75], a[12:15], v[220:223]
  s_waitcnt lgkmcnt(3)
  ds_read_b64_tr_b16 a[88:89], v224 offset:49152
  ds_read_b128 v[242:245], v237 offset:384
  v_fmac_f32 v80, v246, v238
  v_fmac_f32 v81, v247, v238
  v_mfma_f32_16x16x32_bf16 v[220:223], a[76:79], a[28:31], v[220:223]
  buffer_load_dwordx4 v252, s[84:87], s93 offen offset:1024 lds
  v_fmac_f32 v82, v248, v238
  v_fmac_f32 v83, v249, v238
  v_mfma_f32_16x16x32_bf16 v[216:219], a[76:79], a[24:27], v[216:219]
  ds_read_b64_tr_b16 a[90:91], v224 offset:53248
  v_fmac_f32 v84, v246, v239
  v_fmac_f32 v85, v247, v239
  v_mfma_f32_16x16x32_bf16 v[216:219], a[72:75], a[8:11], v[216:219]
  s_add_u32 s92, s92, 196608
  v_fmac_f32 v86, v248, v239
  v_fmac_f32 v87, v249, v239
  v_mfma_f32_16x16x32_bf16 v[212:215], a[72:75], a[4:7], v[212:215]
  ds_read_b64_tr_b16 a[92:93], v224 offset:57344
  v_fmac_f32 v88, v246, v240
  v_fmac_f32 v89, v247, v240
  v_mfma_f32_16x16x32_bf16 v[212:215], a[76:79], a[20:23], v[212:215]
  v_fmac_f32 v90, v248, v240
  v_fmac_f32 v91, v249, v240
  v_mfma_f32_16x16x32_bf16 v[208:211], a[76:79], a[16:19], v[208:211]
  ds_read_b64_tr_b16 a[94:95], v224 offset:61440
  v_xor_b32 v224, 0x10000, v224
  v_fmac_f32 v92, v246, v241
  v_fmac_f32 v93, v247, v241
  v_mfma_f32_16x16x32_bf16 v[208:211], a[72:75], a[0:3], v[208:211]
  v_fmac_f32 v94, v248, v241
  v_fmac_f32 v95, v249, v241
  s_waitcnt vmcnt(8) lgkmcnt(5)
  v_mfma_f32_16x16x32_bf16 v[0:3], a[80:83], a[32:35], v[0:3]
  ds_read_b64_tr_b16 a[64:65], v225 offset:32768
  s_waitcnt lgkmcnt(4)
  v_fmac_f32 v96, v242, v238
  v_mfma_f32_16x16x32_bf16 v[0:3], a[84:87], a[48:51], v[0:3]
  v_fmac_f32 v97, v243, v238
  v_fmac_f32 v98, v244, v238
  v_fmac_f32 v99, v245, v238
  v_mfma_f32_16x16x32_bf16 v[4:7], a[84:87], a[52:55], v[4:7]
  ds_read_b64_tr_b16 a[66:67], v225 offset:36864
  v_fmac_f32 v100, v242, v239
  v_fmac_f32 v101, v243, v239
  v_mfma_f32_16x16x32_bf16 v[4:7], a[80:83], a[36:39], v[4:7]
  v_fmac_f32 v102, v244, v239
  v_fmac_f32 v103, v245, v239
  v_fmac_f32 v104, v242, v240
  v_mfma_f32_16x16x32_bf16 v[8:11], a[80:83], a[40:43], v[8:11]
  ds_read_b64_tr_b16 a[68:69], v225 offset:40960
  v_fmac_f32 v105, v243, v240
  v_fmac_f32 v106, v244, v240
  v_mfma_f32_16x16x32_bf16 v[8:11], a[84:87], a[56:59], v[8:11]
  v_fmac_f32 v107, v245, v240
  v_fmac_f32 v108, v242, v241
  v_fmac_f32 v109, v243, v241
  v_mfma_f32_16x16x32_bf16 v[12:15], a[84:87], a[60:63], v[12:15]
  ds_read_b64_tr_b16 a[70:71], v225 offset:45056
  v_fmac_f32 v110, v244, v241
  v_fmac_f32 v111, v245, v241
  v_mfma_f32_16x16x32_bf16 v[12:15], a[80:83], a[44:47], v[12:15]
  v_accvgpr_read_b32 v238, a104
  v_accvgpr_read_b32 v232, a108
  v_accvgpr_read_b32 v239, a105
  s_waitcnt lgkmcnt(4)
  v_mfma_f32_16x16x32_bf16 v[28:31], a[88:91], a[44:47], v[28:31]
  ds_read_b64_tr_b16 a[72:73], v225 offset:49152
  v_accvgpr_read_b32 v233, a109
  v_accvgpr_read_b32 v240, a106
  v_mfma_f32_16x16x32_bf16 v[28:31], a[92:95], a[60:63], v[28:31]
  v_accvgpr_read_b32 v234, a110
  v_accvgpr_read_b32 v241, a107
  v_accvgpr_read_b32 v235, a111
  v_mfma_f32_16x16x32_bf16 v[24:27], a[92:95], a[56:59], v[24:27]
  ds_read_b64_tr_b16 a[74:75], v225 offset:53248
  v_and_b32 v236, 31, v253
  v_lshlrev_b32 v236, 4, v236
  v_mfma_f32_16x16x32_bf16 v[24:27], a[88:91], a[40:43], v[24:27]
  v_lshrrev_b32 v250, 5, v253
  s_mov_b32 s43, 114688
  v_mad_u32_u24 v236, v250, s43, v236
  v_mfma_f32_16x16x32_bf16 v[20:23], a[88:91], a[36:39], v[20:23]
  ds_read_b64_tr_b16 a[76:77], v225 offset:57344
  s_mul_i32 s43, s69, 458752
  s_lshr_b32 s45, s55, 4
  v_mfma_f32_16x16x32_bf16 v[20:23], a[92:95], a[52:55], v[20:23]
  s_mul_i32 s45, s45, 57344
  s_add_u32 s43, s43, s45
  s_add_u32 s43, s43, 0
  v_mfma_f32_16x16x32_bf16 v[16:19], a[92:95], a[48:51], v[16:19]
  ds_read_b64_tr_b16 a[78:79], v225 offset:61440
  v_xor_b32 v225, 0x10000, v225
  s_add_u32 s43, s43, 12582912
  s_and_b32 s44, s55, 15
  v_mfma_f32_16x16x32_bf16 v[16:19], a[88:91], a[32:35], v[16:19]
  s_lshl_b32 s45, s44, 10
  s_add_u32 s57, s43, s45
  s_lshl_b32 s45, s44, 9
  s_waitcnt lgkmcnt(4)
  v_mfma_f32_16x16x32_bf16 v[32:35], a[64:67], a[32:35], v[32:35]
  ds_read_b64_tr_b16 a[80:81], v226 offset:32768
  s_add_u32 s61, s43, s45
  s_add_u32 s61, s61, 49152
  v_mfma_f32_16x16x32_bf16 v[32:35], a[68:71], a[48:51], v[32:35]
  s_add_u32 s62, s61, 229376
  s_add_u32 s58, s57, 114688
  s_add_u32 s59, s58, 114688
  v_mfma_f32_16x16x32_bf16 v[36:39], a[68:71], a[52:55], v[36:39]
  ds_read_b64_tr_b16 a[82:83], v226 offset:36864
  s_add_u32 s60, s59, 114688
  s_lshl_b32 s77, s54, 1
  v_mfma_f32_16x16x32_bf16 v[36:39], a[64:67], a[36:39], v[36:39]
  s_lshr_b32 s43, s55, 4
  s_add_u32 s77, s77, s43
  s_lshl_b32 s77, s77, 7
  s_add_u32 s77, s77, s42
  s_add_u32 s77, s77, 27795456
  v_mfma_f32_16x16x32_bf16 v[40:43], a[64:67], a[40:43], v[40:43]
  ds_read_b64_tr_b16 a[84:85], v226 offset:40960
  v_mfma_f32_16x16x32_bf16 v[40:43], a[68:71], a[56:59], v[40:43]
  s_add_u32 m0, s79, 32768
  v_pk_mul_f32 v[242:243], v[0:1], v[238:239] op_sel:[0,0] op_sel_hi:[1,0]
  v_pk_mul_f32 v[244:245], v[2:3], v[238:239] op_sel:[0,0] op_sel_hi:[1,0]
  v_pk_mul_f32 v[0:1], v[0:1], v[16:17]
  v_pk_mul_f32 v[2:3], v[2:3], v[18:19]
  v_mfma_f32_16x16x32_bf16 v[44:47], a[68:71], a[60:63], v[44:47]
  ds_read_b64_tr_b16 a[86:87], v226 offset:45056
  s_add_u32 s93, s92, s88
  v_mfma_f32_16x16x32_bf16 v[44:47], a[64:67], a[44:47], v[44:47]
  buffer_load_dwordx4 v252, s[80:83], s93 offen lds
  s_waitcnt lgkmcnt(4)
  v_mfma_f32_16x16x32_bf16 v[60:63], a[72:75], a[44:47], v[60:63]
  ds_read_b64_tr_b16 a[88:89], v226 offset:49152
  buffer_load_dwordx4 v252, s[84:87], s93 offen offset:1024 lds
  v_exp_f32 v242, v242
  v_exp_f32 v243, v243
  v_mfma_f32_16x16x32_bf16 v[60:63], a[76:79], a[60:63], v[60:63]
  s_add_u32 s92, s92, 262144
  v_exp_f32 v244, v244
  v_exp_f32 v245, v245
  v_pk_mul_f32 v[246:247], v[4:5], v[238:239] op_sel:[0,1] op_sel_hi:[1,1]
  v_pk_mul_f32 v[248:249], v[6:7], v[238:239] op_sel:[0,1] op_sel_hi:[1,1]
  v_pk_fma_f32 v[242:243], v[242:243], v[232:233], v[232:233] op_sel:[0,0,0] op_sel_hi:[1,0,0]
  v_pk_fma_f32 v[244:245], v[244:245], v[232:233], v[232:233] op_sel:[0,0,0] op_sel_hi:[1,0,0]
  v_pk_mul_f32 v[4:5], v[4:5], v[20:21]
  v_pk_mul_f32 v[6:7], v[6:7], v[22:23]
  v_mfma_f32_16x16x32_bf16 v[56:59], a[76:79], a[56:59], v[56:59]
  ds_read_b64_tr_b16 a[90:91], v226 offset:53248
  v_rcp_f32 v242, v242
  v_rcp_f32 v243, v243
  v_mfma_f32_16x16x32_bf16 v[56:59], a[72:75], a[40:43], v[56:59]
  s_add_u32 m0, s79, 40960
  v_rcp_f32 v244, v244
  v_rcp_f32 v245, v245
  v_mfma_f32_16x16x32_bf16 v[52:55], a[72:75], a[36:39], v[52:55]
  ds_read_b64_tr_b16 a[92:93], v226 offset:57344
  s_add_u32 s93, s92, s89
  v_exp_f32 v246, v246
  v_exp_f32 v247, v247
  v_mfma_f32_16x16x32_bf16 v[52:55], a[76:79], a[52:55], v[52:55]
  buffer_load_dwordx4 v252, s[80:83], s93 offen lds
  v_exp_f32 v248, v248
  v_exp_f32 v249, v249
  v_pk_mul_f32 v[0:1], v[0:1], v[242:243]
  v_pk_mul_f32 v[2:3], v[2:3], v[244:245]
  v_pk_mul_f32 v[242:243], v[8:9], v[240:241] op_sel:[0,0] op_sel_hi:[1,0]
  v_pk_mul_f32 v[244:245], v[10:11], v[240:241] op_sel:[0,0] op_sel_hi:[1,0]
  v_cvt_pk_bf16_f32 v16, v0, v1
  v_cvt_pk_bf16_f32 v17, v2, v3
  v_pk_fma_f32 v[246:247], v[246:247], v[232:233], v[232:233] op_sel:[0,1,1] op_sel_hi:[1,1,1]
  v_pk_fma_f32 v[248:249], v[248:249], v[232:233], v[232:233] op_sel:[0,1,1] op_sel_hi:[1,1,1]
  v_pk_mul_f32 v[8:9], v[8:9], v[24:25]
  v_pk_mul_f32 v[10:11], v[10:11], v[26:27]
  v_mfma_f32_16x16x32_bf16 v[48:51], a[76:79], a[48:51], v[48:51]
  ds_read_b64_tr_b16 a[94:95], v226 offset:61440
  v_xor_b32 v226, 0x10000, v226
  buffer_load_dwordx4 v252, s[84:87], s93 offen offset:1024 lds
  v_rcp_f32 v246, v246
  v_rcp_f32 v247, v247
  v_mfma_f32_16x16x32_bf16 v[48:51], a[72:75], a[32:35], v[48:51]
  s_add_u32 s92, s92, 196608
  v_rcp_f32 v248, v248
  v_rcp_f32 v249, v249
  s_waitcnt lgkmcnt(4)
  v_mfma_f32_16x16x32_bf16 v[64:67], a[80:83], a[32:35], v[64:67]
  ds_read_b64_tr_b16 a[64:65], v227 offset:32768
  v_exp_f32 v242, v242
  v_exp_f32 v243, v243
  v_mfma_f32_16x16x32_bf16 v[64:67], a[84:87], a[48:51], v[64:67]
  s_add_u32 m0, s79, 49152
  v_exp_f32 v244, v244
  v_exp_f32 v245, v245
  v_pk_mul_f32 v[4:5], v[4:5], v[246:247]
  v_pk_mul_f32 v[6:7], v[6:7], v[248:249]
  v_pk_mul_f32 v[246:247], v[12:13], v[240:241] op_sel:[0,1] op_sel_hi:[1,1]
  v_pk_mul_f32 v[248:249], v[14:15], v[240:241] op_sel:[0,1] op_sel_hi:[1,1]
  v_cvt_pk_bf16_f32 v20, v4, v5
  v_cvt_pk_bf16_f32 v21, v6, v7
  v_pk_fma_f32 v[242:243], v[242:243], v[234:235], v[234:235] op_sel:[0,0,0] op_sel_hi:[1,0,0]
  v_pk_fma_f32 v[244:245], v[244:245], v[234:235], v[234:235] op_sel:[0,0,0] op_sel_hi:[1,0,0]
  v_pk_mul_f32 v[12:13], v[12:13], v[28:29]
  v_pk_mul_f32 v[14:15], v[14:15], v[30:31]
  v_mfma_f32_16x16x32_bf16 v[68:71], a[84:87], a[52:55], v[68:71]
  ds_read_b64_tr_b16 a[66:67], v227 offset:36864
  s_add_u32 s93, s92, s90
  v_rcp_f32 v242, v242
  v_rcp_f32 v243, v243
  v_mfma_f32_16x16x32_bf16 v[68:71], a[80:83], a[36:39], v[68:71]
  buffer_load_dwordx4 v252, s[80:83], s93 offen lds
  v_rcp_f32 v244, v244
  v_rcp_f32 v245, v245
  v_mfma_f32_16x16x32_bf16 v[72:75], a[80:83], a[40:43], v[72:75]
  ds_read_b64_tr_b16 a[68:69], v227 offset:40960
  buffer_load_dwordx4 v252, s[84:87], s93 offen offset:1024 lds
  v_exp_f32 v246, v246
  v_exp_f32 v247, v247
  v_mfma_f32_16x16x32_bf16 v[72:75], a[84:87], a[56:59], v[72:75]
  s_add_u32 s92, s92, 262144
  v_exp_f32 v248, v248
  v_exp_f32 v249, v249
  v_pk_mul_f32 v[8:9], v[8:9], v[242:243]
  v_pk_mul_f32 v[10:11], v[10:11], v[244:245]
  v_pk_mul_f32 v[242:243], v[32:33], v[238:239] op_sel:[0,0] op_sel_hi:[1,0]
  v_pk_mul_f32 v[244:245], v[34:35], v[238:239] op_sel:[0,0] op_sel_hi:[1,0]
  v_cvt_pk_bf16_f32 v24, v8, v9
  v_cvt_pk_bf16_f32 v25, v10, v11
  v_pk_fma_f32 v[246:247], v[246:247], v[234:235], v[234:235] op_sel:[0,1,1] op_sel_hi:[1,1,1]
  v_pk_fma_f32 v[248:249], v[248:249], v[234:235], v[234:235] op_sel:[0,1,1] op_sel_hi:[1,1,1]
  v_pk_mul_f32 v[32:33], v[32:33], v[48:49]
  v_pk_mul_f32 v[34:35], v[34:35], v[50:51]
  v_mfma_f32_16x16x32_bf16 v[76:79], a[84:87], a[60:63], v[76:79]
  ds_read_b64_tr_b16 a[70:71], v227 offset:45056
  v_rcp_f32 v246, v246
  v_rcp_f32 v247, v247
  v_mfma_f32_16x16x32_bf16 v[76:79], a[80:83], a[44:47], v[76:79]
  s_add_u32 m0, s79, 57344
  v_rcp_f32 v248, v248
  v_rcp_f32 v249, v249
  s_waitcnt lgkmcnt(4)
  v_mfma_f32_16x16x32_bf16 v[92:95], a[88:91], a[44:47], v[92:95]
  ds_read_b64_tr_b16 a[72:73], v227 offset:49152
  s_add_u32 s93, s92, s91
  v_exp_f32 v242, v242
  v_exp_f32 v243, v243
  v_mfma_f32_16x16x32_bf16 v[92:95], a[92:95], a[60:63], v[92:95]
  buffer_load_dwordx4 v252, s[80:83], s93 offen lds
  v_exp_f32 v244, v244
  v_exp_f32 v245, v245
  v_pk_mul_f32 v[12:13], v[12:13], v[246:247]
  v_pk_mul_f32 v[14:15], v[14:15], v[248:249]
  v_pk_mul_f32 v[246:247], v[36:37], v[238:239] op_sel:[0,1] op_sel_hi:[1,1]
  v_pk_mul_f32 v[248:249], v[38:39], v[238:239] op_sel:[0,1] op_sel_hi:[1,1]
  v_cvt_pk_bf16_f32 v28, v12, v13
  v_cvt_pk_bf16_f32 v29, v14, v15
  v_pk_fma_f32 v[242:243], v[242:243], v[232:233], v[232:233] op_sel:[0,0,0] op_sel_hi:[1,0,0]
  v_pk_fma_f32 v[244:245], v[244:245], v[232:233], v[232:233] op_sel:[0,0,0] op_sel_hi:[1,0,0]
  v_pk_mul_f32 v[36:37], v[36:37], v[52:53]
  v_pk_mul_f32 v[38:39], v[38:39], v[54:55]
  v_mfma_f32_16x16x32_bf16 v[88:91], a[92:95], a[56:59], v[88:91]
  ds_read_b64_tr_b16 a[74:75], v227 offset:53248
  buffer_load_dwordx4 v252, s[84:87], s93 offen offset:1024 lds
  v_rcp_f32 v242, v242
  v_rcp_f32 v243, v243
  v_mfma_f32_16x16x32_bf16 v[88:91], a[88:91], a[40:43], v[88:91]
  s_add_u32 s92, s92, 196608
  v_rcp_f32 v244, v244
  v_rcp_f32 v245, v245
  v_mfma_f32_16x16x32_bf16 v[84:87], a[88:91], a[36:39], v[84:87]
  ds_read_b64_tr_b16 a[76:77], v227 offset:57344
  v_exp_f32 v246, v246
  v_exp_f32 v247, v247
  v_mfma_f32_16x16x32_bf16 v[84:87], a[92:95], a[52:55], v[84:87]
  v_exp_f32 v248, v248
  v_exp_f32 v249, v249
  v_pk_mul_f32 v[32:33], v[32:33], v[242:243]
  v_pk_mul_f32 v[34:35], v[34:35], v[244:245]
  v_pk_mul_f32 v[242:243], v[40:41], v[240:241] op_sel:[0,0] op_sel_hi:[1,0]
  v_pk_mul_f32 v[244:245], v[42:43], v[240:241] op_sel:[0,0] op_sel_hi:[1,0]
  v_cvt_pk_bf16_f32 v18, v32, v33
  v_cvt_pk_bf16_f32 v19, v34, v35
  buffer_store_dwordx4 v[16:19], v231, s[4:7], s57 offen sc1
  s_add_u32 s57, s57, 16384
  v_pk_fma_f32 v[246:247], v[246:247], v[232:233], v[232:233] op_sel:[0,1,1] op_sel_hi:[1,1,1]
  v_pk_fma_f32 v[248:249], v[248:249], v[232:233], v[232:233] op_sel:[0,1,1] op_sel_hi:[1,1,1]
  v_pk_mul_f32 v[40:41], v[40:41], v[56:57]
  v_pk_mul_f32 v[42:43], v[42:43], v[58:59]
  v_mfma_f32_16x16x32_bf16 v[80:83], a[92:95], a[48:51], v[80:83]
  ds_read_b64_tr_b16 a[78:79], v227 offset:61440
  v_xor_b32 v227, 0x10000, v227
  v_rcp_f32 v246, v246
  v_rcp_f32 v247, v247
  v_mfma_f32_16x16x32_bf16 v[80:83], a[88:91], a[32:35], v[80:83]
  v_rcp_f32 v248, v248
  v_rcp_f32 v249, v249
  s_waitcnt lgkmcnt(4)
  v_mfma_f32_16x16x32_bf16 v[96:99], a[64:67], a[32:35], v[96:99]
  ds_read_b64_tr_b16 a[80:81], v228 offset:32768
  v_exp_f32 v242, v242
  v_exp_f32 v243, v243
  v_mfma_f32_16x16x32_bf16 v[96:99], a[68:71], a[48:51], v[96:99]
  v_exp_f32 v244, v244
  v_exp_f32 v245, v245
  v_pk_mul_f32 v[36:37], v[36:37], v[246:247]
  v_pk_mul_f32 v[38:39], v[38:39], v[248:249]
  v_pk_mul_f32 v[246:247], v[44:45], v[240:241] op_sel:[0,1] op_sel_hi:[1,1]
  v_pk_mul_f32 v[248:249], v[46:47], v[240:241] op_sel:[0,1] op_sel_hi:[1,1]
  v_cvt_pk_bf16_f32 v22, v36, v37
  v_cvt_pk_bf16_f32 v23, v38, v39
  buffer_store_dwordx4 v[20:23], v231, s[4:7], s58 offen sc1
  s_add_u32 s58, s58, 16384
  v_pk_fma_f32 v[242:243], v[242:243], v[234:235], v[234:235] op_sel:[0,0,0] op_sel_hi:[1,0,0]
  v_pk_fma_f32 v[244:245], v[244:245], v[234:235], v[234:235] op_sel:[0,0,0] op_sel_hi:[1,0,0]
  v_pk_mul_f32 v[44:45], v[44:45], v[60:61]
  v_pk_mul_f32 v[46:47], v[46:47], v[62:63]
  v_mfma_f32_16x16x32_bf16 v[100:103], a[68:71], a[52:55], v[100:103]
  ds_read_b64_tr_b16 a[82:83], v228 offset:36864
  v_rcp_f32 v242, v242
  v_rcp_f32 v243, v243
  v_mfma_f32_16x16x32_bf16 v[100:103], a[64:67], a[36:39], v[100:103]
  v_rcp_f32 v244, v244
  v_rcp_f32 v245, v245
  v_mfma_f32_16x16x32_bf16 v[104:107], a[64:67], a[40:43], v[104:107]
  ds_read_b64_tr_b16 a[84:85], v228 offset:40960
  v_exp_f32 v246, v246
  v_exp_f32 v247, v247
  v_mfma_f32_16x16x32_bf16 v[104:107], a[68:71], a[56:59], v[104:107]
  v_exp_f32 v248, v248
  v_exp_f32 v249, v249
  v_pk_mul_f32 v[40:41], v[40:41], v[242:243]
  v_pk_mul_f32 v[42:43], v[42:43], v[244:245]
  v_pk_mul_f32 v[242:243], v[64:65], v[238:239] op_sel:[0,0] op_sel_hi:[1,0]
  v_pk_mul_f32 v[244:245], v[66:67], v[238:239] op_sel:[0,0] op_sel_hi:[1,0]
  v_cvt_pk_bf16_f32 v26, v40, v41
  v_cvt_pk_bf16_f32 v27, v42, v43
  buffer_store_dwordx4 v[24:27], v231, s[4:7], s59 offen sc1
  s_add_u32 s59, s59, 16384
  v_pk_fma_f32 v[246:247], v[246:247], v[234:235], v[234:235] op_sel:[0,1,1] op_sel_hi:[1,1,1]
  v_pk_fma_f32 v[248:249], v[248:249], v[234:235], v[234:235] op_sel:[0,1,1] op_sel_hi:[1,1,1]
  v_pk_mul_f32 v[64:65], v[64:65], v[80:81]
  v_pk_mul_f32 v[66:67], v[66:67], v[82:83]
  v_mfma_f32_16x16x32_bf16 v[108:111], a[68:71], a[60:63], v[108:111]
  ds_read_b64_tr_b16 a[86:87], v228 offset:45056
  v_rcp_f32 v246, v246
  v_rcp_f32 v247, v247
  v_mfma_f32_16x16x32_bf16 v[108:111], a[64:67], a[44:47], v[108:111]
  v_rcp_f32 v248, v248
  v_rcp_f32 v249, v249
  s_waitcnt lgkmcnt(4)
  v_mfma_f32_16x16x32_bf16 v[124:127], a[72:75], a[44:47], v[124:127]
  ds_read_b64_tr_b16 a[88:89], v228 offset:49152
  v_exp_f32 v242, v242
  v_exp_f32 v243, v243
  v_mfma_f32_16x16x32_bf16 v[124:127], a[76:79], a[60:63], v[124:127]
  v_exp_f32 v244, v244
  v_exp_f32 v245, v245
  v_pk_mul_f32 v[44:45], v[44:45], v[246:247]
  v_pk_mul_f32 v[46:47], v[46:47], v[248:249]
  v_pk_mul_f32 v[246:247], v[68:69], v[238:239] op_sel:[0,1] op_sel_hi:[1,1]
  v_pk_mul_f32 v[248:249], v[70:71], v[238:239] op_sel:[0,1] op_sel_hi:[1,1]
  v_cvt_pk_bf16_f32 v30, v44, v45
  v_cvt_pk_bf16_f32 v31, v46, v47
  buffer_store_dwordx4 v[28:31], v231, s[4:7], s60 offen sc1
  s_add_u32 s60, s60, 16384
  v_pk_fma_f32 v[242:243], v[242:243], v[232:233], v[232:233] op_sel:[0,0,0] op_sel_hi:[1,0,0]
  v_pk_fma_f32 v[244:245], v[244:245], v[232:233], v[232:233] op_sel:[0,0,0] op_sel_hi:[1,0,0]
  v_pk_mul_f32 v[68:69], v[68:69], v[84:85]
  v_pk_mul_f32 v[70:71], v[70:71], v[86:87]
  v_mfma_f32_16x16x32_bf16 v[120:123], a[76:79], a[56:59], v[120:123]
  ds_read_b64_tr_b16 a[90:91], v228 offset:53248
  v_rcp_f32 v242, v242
  v_rcp_f32 v243, v243
  v_mfma_f32_16x16x32_bf16 v[120:123], a[72:75], a[40:43], v[120:123]
  v_rcp_f32 v244, v244
  v_rcp_f32 v245, v245
  v_mfma_f32_16x16x32_bf16 v[116:119], a[72:75], a[36:39], v[116:119]
  ds_read_b64_tr_b16 a[92:93], v228 offset:57344
  v_exp_f32 v246, v246
  v_exp_f32 v247, v247
  v_mfma_f32_16x16x32_bf16 v[116:119], a[76:79], a[52:55], v[116:119]
  v_exp_f32 v248, v248
  v_exp_f32 v249, v249
  v_pk_mul_f32 v[64:65], v[64:65], v[242:243]
  v_pk_mul_f32 v[66:67], v[66:67], v[244:245]
  v_pk_mul_f32 v[242:243], v[72:73], v[240:241] op_sel:[0,0] op_sel_hi:[1,0]
  v_pk_mul_f32 v[244:245], v[74:75], v[240:241] op_sel:[0,0] op_sel_hi:[1,0]
  v_cvt_pk_bf16_f32 v80, v64, v65
  v_cvt_pk_bf16_f32 v81, v66, v67
  v_pk_fma_f32 v[246:247], v[246:247], v[232:233], v[232:233] op_sel:[0,1,1] op_sel_hi:[1,1,1]
  v_pk_fma_f32 v[248:249], v[248:249], v[232:233], v[232:233] op_sel:[0,1,1] op_sel_hi:[1,1,1]
  v_pk_mul_f32 v[72:73], v[72:73], v[88:89]
  v_pk_mul_f32 v[74:75], v[74:75], v[90:91]
  v_mfma_f32_16x16x32_bf16 v[112:115], a[76:79], a[48:51], v[112:115]
  ds_read_b64_tr_b16 a[94:95], v228 offset:61440
  v_xor_b32 v228, 0x10000, v228
  v_rcp_f32 v246, v246
  v_rcp_f32 v247, v247
  v_mfma_f32_16x16x32_bf16 v[112:115], a[72:75], a[32:35], v[112:115]
  v_rcp_f32 v248, v248
  v_rcp_f32 v249, v249
  s_waitcnt lgkmcnt(4)
  v_mfma_f32_16x16x32_bf16 v[128:131], a[80:83], a[32:35], v[128:131]
  ds_read_b64_tr_b16 a[64:65], v229 offset:32768
  v_exp_f32 v242, v242
  v_exp_f32 v243, v243
  v_mfma_f32_16x16x32_bf16 v[128:131], a[84:87], a[48:51], v[128:131]
  v_exp_f32 v244, v244
  v_exp_f32 v245, v245
  v_pk_mul_f32 v[68:69], v[68:69], v[246:247]
  v_pk_mul_f32 v[70:71], v[70:71], v[248:249]
  v_pk_mul_f32 v[246:247], v[76:77], v[240:241] op_sel:[0,1] op_sel_hi:[1,1]
  v_pk_mul_f32 v[248:249], v[78:79], v[240:241] op_sel:[0,1] op_sel_hi:[1,1]
  v_cvt_pk_bf16_f32 v84, v68, v69
  v_cvt_pk_bf16_f32 v85, v70, v71
  v_pk_fma_f32 v[242:243], v[242:243], v[234:235], v[234:235] op_sel:[0,0,0] op_sel_hi:[1,0,0]
  v_pk_fma_f32 v[244:245], v[244:245], v[234:235], v[234:235] op_sel:[0,0,0] op_sel_hi:[1,0,0]
  v_pk_mul_f32 v[76:77], v[76:77], v[92:93]
  v_pk_mul_f32 v[78:79], v[78:79], v[94:95]
  v_mfma_f32_16x16x32_bf16 v[132:135], a[84:87], a[52:55], v[132:135]
  ds_read_b64_tr_b16 a[66:67], v229 offset:36864
  v_rcp_f32 v242, v242
  v_rcp_f32 v243, v243
  v_mfma_f32_16x16x32_bf16 v[132:135], a[80:83], a[36:39], v[132:135]
  v_rcp_f32 v244, v244
  v_rcp_f32 v245, v245
  v_mfma_f32_16x16x32_bf16 v[136:139], a[80:83], a[40:43], v[136:139]
  ds_read_b64_tr_b16 a[68:69], v229 offset:40960
  v_exp_f32 v246, v246
  v_exp_f32 v247, v247
  v_mfma_f32_16x16x32_bf16 v[136:139], a[84:87], a[56:59], v[136:139]
  v_exp_f32 v248, v248
  v_exp_f32 v249, v249
  v_pk_mul_f32 v[72:73], v[72:73], v[242:243]
  v_pk_mul_f32 v[74:75], v[74:75], v[244:245]
  v_pk_mul_f32 v[242:243], v[96:97], v[238:239] op_sel:[0,0] op_sel_hi:[1,0]
  v_pk_mul_f32 v[244:245], v[98:99], v[238:239] op_sel:[0,0] op_sel_hi:[1,0]
  v_cvt_pk_bf16_f32 v88, v72, v73
  v_cvt_pk_bf16_f32 v89, v74, v75
  v_pk_fma_f32 v[246:247], v[246:247], v[234:235], v[234:235] op_sel:[0,1,1] op_sel_hi:[1,1,1]
  v_pk_fma_f32 v[248:249], v[248:249], v[234:235], v[234:235] op_sel:[0,1,1] op_sel_hi:[1,1,1]
  v_pk_mul_f32 v[96:97], v[96:97], v[112:113]
  v_pk_mul_f32 v[98:99], v[98:99], v[114:115]
  v_mfma_f32_16x16x32_bf16 v[140:143], a[84:87], a[60:63], v[140:143]
  ds_read_b64_tr_b16 a[70:71], v229 offset:45056
  v_rcp_f32 v246, v246
  v_rcp_f32 v247, v247
  v_mfma_f32_16x16x32_bf16 v[140:143], a[80:83], a[44:47], v[140:143]
  v_rcp_f32 v248, v248
  v_rcp_f32 v249, v249
  s_waitcnt lgkmcnt(4)
  v_mfma_f32_16x16x32_bf16 v[156:159], a[88:91], a[44:47], v[156:159]
  ds_read_b64_tr_b16 a[72:73], v229 offset:49152
  v_exp_f32 v242, v242
  v_exp_f32 v243, v243
  v_mfma_f32_16x16x32_bf16 v[156:159], a[92:95], a[60:63], v[156:159]
  v_exp_f32 v244, v244
  v_exp_f32 v245, v245
  v_pk_mul_f32 v[76:77], v[76:77], v[246:247]
  v_pk_mul_f32 v[78:79], v[78:79], v[248:249]
  v_pk_mul_f32 v[246:247], v[100:101], v[238:239] op_sel:[0,1] op_sel_hi:[1,1]
  v_pk_mul_f32 v[248:249], v[102:103], v[238:239] op_sel:[0,1] op_sel_hi:[1,1]
  v_cvt_pk_bf16_f32 v92, v76, v77
  v_cvt_pk_bf16_f32 v93, v78, v79
  v_pk_fma_f32 v[242:243], v[242:243], v[232:233], v[232:233] op_sel:[0,0,0] op_sel_hi:[1,0,0]
  v_pk_fma_f32 v[244:245], v[244:245], v[232:233], v[232:233] op_sel:[0,0,0] op_sel_hi:[1,0,0]
  v_pk_mul_f32 v[100:101], v[100:101], v[116:117]
  v_pk_mul_f32 v[102:103], v[102:103], v[118:119]
  v_mfma_f32_16x16x32_bf16 v[152:155], a[92:95], a[56:59], v[152:155]
  ds_read_b64_tr_b16 a[74:75], v229 offset:53248
  v_rcp_f32 v242, v242
  v_rcp_f32 v243, v243
  v_mfma_f32_16x16x32_bf16 v[152:155], a[88:91], a[40:43], v[152:155]
  v_rcp_f32 v244, v244
  v_rcp_f32 v245, v245
  v_mfma_f32_16x16x32_bf16 v[148:151], a[88:91], a[36:39], v[148:151]
  ds_read_b64_tr_b16 a[76:77], v229 offset:57344
  v_exp_f32 v246, v246
  v_exp_f32 v247, v247
  v_mfma_f32_16x16x32_bf16 v[148:151], a[92:95], a[52:55], v[148:151]
  v_exp_f32 v248, v248
  v_exp_f32 v249, v249
  v_pk_mul_f32 v[96:97], v[96:97], v[242:243]
  v_pk_mul_f32 v[98:99], v[98:99], v[244:245]
  v_pk_mul_f32 v[242:243], v[104:105], v[240:241] op_sel:[0,0] op_sel_hi:[1,0]
  v_pk_mul_f32 v[244:245], v[106:107], v[240:241] op_sel:[0,0] op_sel_hi:[1,0]
  v_cvt_pk_bf16_f32 v82, v96, v97
  v_cvt_pk_bf16_f32 v83, v98, v99
  buffer_store_dwordx4 v[80:83], v231, s[4:7], s57 offen sc1
  s_add_u32 s57, s57, 16384
  v_pk_fma_f32 v[246:247], v[246:247], v[232:233], v[232:233] op_sel:[0,1,1] op_sel_hi:[1,1,1]
  v_pk_fma_f32 v[248:249], v[248:249], v[232:233], v[232:233] op_sel:[0,1,1] op_sel_hi:[1,1,1]
  v_pk_mul_f32 v[104:105], v[104:105], v[120:121]
  v_pk_mul_f32 v[106:107], v[106:107], v[122:123]
  v_mfma_f32_16x16x32_bf16 v[144:147], a[92:95], a[48:51], v[144:147]
  ds_read_b64_tr_b16 a[78:79], v229 offset:61440
  v_xor_b32 v229, 0x10000, v229
  v_rcp_f32 v246, v246
  v_rcp_f32 v247, v247
  v_mfma_f32_16x16x32_bf16 v[144:147], a[88:91], a[32:35], v[144:147]
  v_rcp_f32 v248, v248
  v_rcp_f32 v249, v249
  s_waitcnt lgkmcnt(4)
  v_mfma_f32_16x16x32_bf16 v[160:163], a[64:67], a[32:35], v[160:163]
  ds_read_b64_tr_b16 a[80:81], v230 offset:32768
  s_waitcnt vmcnt(1)
  s_barrier
  s_cmp_lg_u32 s40, 0
  s_cbranch_scc1 Lsgf18
  v_mov_b32 v250, 1
  s_mov_b64 exec, 1
  buffer_atomic_add v250, v251, s[4:7], s77 offen sc1
  s_mov_b64 exec, -1
Lsgf18:
  s_add_u32 s77, s77, 2048
  v_exp_f32 v242, v242
  v_exp_f32 v243, v243
  v_mfma_f32_16x16x32_bf16 v[160:163], a[68:71], a[48:51], v[160:163]
  v_exp_f32 v244, v244
  v_exp_f32 v245, v245
  v_pk_mul_f32 v[100:101], v[100:101], v[246:247]
  v_pk_mul_f32 v[102:103], v[102:103], v[248:249]
  v_pk_mul_f32 v[246:247], v[108:109], v[240:241] op_sel:[0,1] op_sel_hi:[1,1]
  v_pk_mul_f32 v[248:249], v[110:111], v[240:241] op_sel:[0,1] op_sel_hi:[1,1]
  v_cvt_pk_bf16_f32 v86, v100, v101
  v_cvt_pk_bf16_f32 v87, v102, v103
  buffer_store_dwordx4 v[84:87], v231, s[4:7], s58 offen sc1
  s_add_u32 s58, s58, 16384
  v_pk_fma_f32 v[242:243], v[242:243], v[234:235], v[234:235] op_sel:[0,0,0] op_sel_hi:[1,0,0]
  v_pk_fma_f32 v[244:245], v[244:245], v[234:235], v[234:235] op_sel:[0,0,0] op_sel_hi:[1,0,0]
  v_pk_mul_f32 v[108:109], v[108:109], v[124:125]
  v_pk_mul_f32 v[110:111], v[110:111], v[126:127]
  v_mfma_f32_16x16x32_bf16 v[164:167], a[68:71], a[52:55], v[164:167]
  ds_read_b64_tr_b16 a[82:83], v230 offset:36864
  v_rcp_f32 v242, v242
  v_rcp_f32 v243, v243
  s_add_u32 m0, s79, 65536
  s_add_u32 s93, s92, s88
  buffer_load_dwordx4 v252, s[80:83], s93 offen lds
  buffer_load_dwordx4 v252, s[84:87], s93 offen offset:1024 lds
  s_add_u32 s92, s92, 262144
  v_mfma_f32_16x16x32_bf16 v[164:167], a[64:67], a[36:39], v[164:167]
  v_rcp_f32 v244, v244
  v_rcp_f32 v245, v245
  v_mfma_f32_16x16x32_bf16 v[168:171], a[64:67], a[40:43], v[168:171]
  ds_read_b64_tr_b16 a[84:85], v230 offset:40960
  v_exp_f32 v246, v246
  v_exp_f32 v247, v247
  v_mfma_f32_16x16x32_bf16 v[168:171], a[68:71], a[56:59], v[168:171]
  v_exp_f32 v248, v248
  v_exp_f32 v249, v249
  v_pk_mul_f32 v[104:105], v[104:105], v[242:243]
  v_pk_mul_f32 v[106:107], v[106:107], v[244:245]
  v_pk_mul_f32 v[242:243], v[128:129], v[238:239] op_sel:[0,0] op_sel_hi:[1,0]
  v_pk_mul_f32 v[244:245], v[130:131], v[238:239] op_sel:[0,0] op_sel_hi:[1,0]
  v_cvt_pk_bf16_f32 v90, v104, v105
  v_cvt_pk_bf16_f32 v91, v106, v107
  buffer_store_dwordx4 v[88:91], v231, s[4:7], s59 offen sc1
  s_add_u32 s59, s59, 16384
  v_pk_fma_f32 v[246:247], v[246:247], v[234:235], v[234:235] op_sel:[0,1,1] op_sel_hi:[1,1,1]
  v_pk_fma_f32 v[248:249], v[248:249], v[234:235], v[234:235] op_sel:[0,1,1] op_sel_hi:[1,1,1]
  v_pk_mul_f32 v[128:129], v[128:129], v[144:145]
  v_pk_mul_f32 v[130:131], v[130:131], v[146:147]
  v_mfma_f32_16x16x32_bf16 v[172:175], a[68:71], a[60:63], v[172:175]
  ds_read_b64_tr_b16 a[86:87], v230 offset:45056
  v_rcp_f32 v246, v246
  v_rcp_f32 v247, v247
  s_add_u32 m0, s79, 73728
  s_add_u32 s93, s92, s89
  buffer_load_dwordx4 v252, s[80:83], s93 offen lds
  buffer_load_dwordx4 v252, s[84:87], s93 offen offset:1024 lds
  s_add_u32 s92, s92, 196608
  v_mfma_f32_16x16x32_bf16 v[172:175], a[64:67], a[44:47], v[172:175]
  v_rcp_f32 v248, v248
  v_rcp_f32 v249, v249
  s_waitcnt lgkmcnt(4)
  v_mfma_f32_16x16x32_bf16 v[188:191], a[72:75], a[44:47], v[188:191]
  ds_read_b64_tr_b16 a[88:89], v230 offset:49152
  v_exp_f32 v242, v242
  v_exp_f32 v243, v243
  v_mfma_f32_16x16x32_bf16 v[188:191], a[76:79], a[60:63], v[188:191]
  v_exp_f32 v244, v244
  v_exp_f32 v245, v245
  v_pk_mul_f32 v[108:109], v[108:109], v[246:247]
  v_pk_mul_f32 v[110:111], v[110:111], v[248:249]
  v_pk_mul_f32 v[246:247], v[132:133], v[238:239] op_sel:[0,1] op_sel_hi:[1,1]
  v_pk_mul_f32 v[248:249], v[134:135], v[238:239] op_sel:[0,1] op_sel_hi:[1,1]
  v_cvt_pk_bf16_f32 v94, v108, v109
  v_cvt_pk_bf16_f32 v95, v110, v111
  buffer_store_dwordx4 v[92:95], v231, s[4:7], s60 offen sc1
  s_add_u32 s60, s60, 16384
  v_pk_fma_f32 v[242:243], v[242:243], v[232:233], v[232:233] op_sel:[0,0,0] op_sel_hi:[1,0,0]
  v_pk_fma_f32 v[244:245], v[244:245], v[232:233], v[232:233] op_sel:[0,0,0] op_sel_hi:[1,0,0]
  v_pk_mul_f32 v[132:133], v[132:133], v[148:149]
  v_pk_mul_f32 v[134:135], v[134:135], v[150:151]
  v_mfma_f32_16x16x32_bf16 v[184:187], a[76:79], a[56:59], v[184:187]
  ds_read_b64_tr_b16 a[90:91], v230 offset:53248
  v_rcp_f32 v242, v242
  v_rcp_f32 v243, v243
  s_add_u32 m0, s79, 81920
  s_add_u32 s93, s92, s90
  buffer_load_dwordx4 v252, s[80:83], s93 offen lds
  buffer_load_dwordx4 v252, s[84:87], s93 offen offset:1024 lds
  s_add_u32 s92, s92, 262144
  v_mfma_f32_16x16x32_bf16 v[184:187], a[72:75], a[40:43], v[184:187]
  v_rcp_f32 v244, v244
  v_rcp_f32 v245, v245
  v_mfma_f32_16x16x32_bf16 v[180:183], a[72:75], a[36:39], v[180:183]
  ds_read_b64_tr_b16 a[92:93], v230 offset:57344
  v_exp_f32 v246, v246
  v_exp_f32 v247, v247
  v_mfma_f32_16x16x32_bf16 v[180:183], a[76:79], a[52:55], v[180:183]
  v_exp_f32 v248, v248
  v_exp_f32 v249, v249
  v_pk_mul_f32 v[128:129], v[128:129], v[242:243]
  v_pk_mul_f32 v[130:131], v[130:131], v[244:245]
  v_pk_mul_f32 v[242:243], v[136:137], v[240:241] op_sel:[0,0] op_sel_hi:[1,0]
  v_pk_mul_f32 v[244:245], v[138:139], v[240:241] op_sel:[0,0] op_sel_hi:[1,0]
  v_cvt_pk_bf16_f32 v144, v128, v129
  v_cvt_pk_bf16_f32 v145, v130, v131
  v_pk_fma_f32 v[246:247], v[246:247], v[232:233], v[232:233] op_sel:[0,1,1] op_sel_hi:[1,1,1]
  v_pk_fma_f32 v[248:249], v[248:249], v[232:233], v[232:233] op_sel:[0,1,1] op_sel_hi:[1,1,1]
  v_pk_mul_f32 v[136:137], v[136:137], v[152:153]
  v_pk_mul_f32 v[138:139], v[138:139], v[154:155]
  v_mfma_f32_16x16x32_bf16 v[176:179], a[76:79], a[48:51], v[176:179]
  ds_read_b64_tr_b16 a[94:95], v230 offset:61440
  v_xor_b32 v230, 0x10000, v230
  v_rcp_f32 v246, v246
  v_rcp_f32 v247, v247
  s_add_u32 m0, s79, 90112
  s_add_u32 s93, s92, s91
  buffer_load_dwordx4 v252, s[80:83], s93 offen lds
  buffer_load_dwordx4 v252, s[84:87], s93 offen offset:1024 lds
  s_add_u32 s92, s92, 196608
  v_mfma_f32_16x16x32_bf16 v[176:179], a[72:75], a[32:35], v[176:179]
  v_rcp_f32 v248, v248
  v_rcp_f32 v249, v249
  s_waitcnt lgkmcnt(4)
  v_mfma_f32_16x16x32_bf16 v[192:195], a[80:83], a[32:35], v[192:195]
  v_exp_f32 v242, v242
  v_exp_f32 v243, v243
  v_mfma_f32_16x16x32_bf16 v[192:195], a[84:87], a[48:51], v[192:195]
  v_exp_f32 v244, v244
  v_exp_f32 v245, v245
  v_pk_mul_f32 v[132:133], v[132:133], v[246:247]
  v_pk_mul_f32 v[134:135], v[134:135], v[248:249]
  v_pk_mul_f32 v[246:247], v[140:141], v[240:241] op_sel:[0,1] op_sel_hi:[1,1]
  v_pk_mul_f32 v[248:249], v[142:143], v[240:241] op_sel:[0,1] op_sel_hi:[1,1]
  v_cvt_pk_bf16_f32 v148, v132, v133
  v_cvt_pk_bf16_f32 v149, v134, v135
  v_pk_fma_f32 v[242:243], v[242:243], v[234:235], v[234:235] op_sel:[0,0,0] op_sel_hi:[1,0,0]
  v_pk_fma_f32 v[244:245], v[244:245], v[234:235], v[234:235] op_sel:[0,0,0] op_sel_hi:[1,0,0]
  v_pk_mul_f32 v[140:141], v[140:141], v[156:157]
  v_pk_mul_f32 v[142:143], v[142:143], v[158:159]
  v_mfma_f32_16x16x32_bf16 v[196:199], a[84:87], a[52:55], v[196:199]
  v_rcp_f32 v242, v242
  v_rcp_f32 v243, v243
  v_mfma_f32_16x16x32_bf16 v[196:199], a[80:83], a[36:39], v[196:199]
  v_rcp_f32 v244, v244
  v_rcp_f32 v245, v245
  s_and_b32 s43, s53, 1
  s_and_b32 s64, s52, 14
  s_add_u32 s64, s64, s43
  s_lshl_b32 s64, s64, 7
  s_add_u32 s64, s64, s42
  s_add_u32 s64, s64, 27795456
  s_lshl_b32 s49, s52, 3
  s_lshl_b32 s43, s40, 1
  s_add_u32 s49, s49, s43
  s_lshl_b32 s76, s49, 15
  s_lshl_b32 s43, s53, 11
  s_add_u32 s76, s76, s43
  s_add_u32 s76, s76, s42
  v_mfma_f32_16x16x32_bf16 v[200:203], a[80:83], a[40:43], v[200:203]
  v_exp_f32 v246, v246
  v_exp_f32 v247, v247
  v_mfma_f32_16x16x32_bf16 v[200:203], a[84:87], a[56:59], v[200:203]
  v_exp_f32 v248, v248
  v_exp_f32 v249, v249
  v_pk_mul_f32 v[136:137], v[136:137], v[242:243]
  v_pk_mul_f32 v[138:139], v[138:139], v[244:245]
  v_pk_mul_f32 v[242:243], v[160:161], v[238:239] op_sel:[0,0] op_sel_hi:[1,0]
  v_pk_mul_f32 v[244:245], v[162:163], v[238:239] op_sel:[0,0] op_sel_hi:[1,0]
  v_cvt_pk_bf16_f32 v152, v136, v137
  v_cvt_pk_bf16_f32 v153, v138, v139
  v_pk_fma_f32 v[246:247], v[246:247], v[234:235], v[234:235] op_sel:[0,1,1] op_sel_hi:[1,1,1]
  v_pk_fma_f32 v[248:249], v[248:249], v[234:235], v[234:235] op_sel:[0,1,1] op_sel_hi:[1,1,1]
  v_pk_mul_f32 v[160:161], v[160:161], v[176:177]
  v_pk_mul_f32 v[162:163], v[162:163], v[178:179]
  v_mfma_f32_16x16x32_bf16 v[204:207], a[84:87], a[60:63], v[204:207]
  v_rcp_f32 v246, v246
  v_rcp_f32 v247, v247
  v_mfma_f32_16x16x32_bf16 v[204:207], a[80:83], a[44:47], v[204:207]
  v_rcp_f32 v248, v248
  v_rcp_f32 v249, v249
  s_add_u32 s46, s76, 4194304
  s_add_u32 s47, s46, 32768
  v_lshlrev_b32 v72, 4, v253
  v_add_u32 v73, 114688, v72
  buffer_load_dwordx4 v[76:79], v72, s[4:7], s46 offen offset:0 sc1
  buffer_load_dwordx4 v[80:83], v72, s[4:7], s46 offen offset:1024 sc1
  buffer_load_dwordx4 v[84:87], v72, s[4:7], s47 offen offset:0 sc1
  buffer_load_dwordx4 v[88:91], v72, s[4:7], s47 offen offset:1024 sc1
  s_mul_i32 s48, s49, 114688
  s_and_b32 s43, s53, 1
  s_mul_i32 s44, s43, 57344
  s_add_u32 s48, s48, s44
  s_add_u32 s48, s48, 0
  s_waitcnt lgkmcnt(0)
  v_mfma_f32_16x16x32_bf16 v[220:223], a[88:91], a[44:47], v[220:223]
  v_exp_f32 v242, v242
  v_exp_f32 v243, v243
  v_mfma_f32_16x16x32_bf16 v[220:223], a[92:95], a[60:63], v[220:223]
  v_exp_f32 v244, v244
  v_exp_f32 v245, v245
  v_pk_mul_f32 v[140:141], v[140:141], v[246:247]
  v_pk_mul_f32 v[142:143], v[142:143], v[248:249]
  v_pk_mul_f32 v[246:247], v[164:165], v[238:239] op_sel:[0,1] op_sel_hi:[1,1]
  v_pk_mul_f32 v[248:249], v[166:167], v[238:239] op_sel:[0,1] op_sel_hi:[1,1]
  v_cvt_pk_bf16_f32 v156, v140, v141
  v_cvt_pk_bf16_f32 v157, v142, v143
  v_pk_fma_f32 v[242:243], v[242:243], v[232:233], v[232:233] op_sel:[0,0,0] op_sel_hi:[1,0,0]
  v_pk_fma_f32 v[244:245], v[244:245], v[232:233], v[232:233] op_sel:[0,0,0] op_sel_hi:[1,0,0]
  v_pk_mul_f32 v[164:165], v[164:165], v[180:181]
  v_pk_mul_f32 v[166:167], v[166:167], v[182:183]
  v_mfma_f32_16x16x32_bf16 v[216:219], a[92:95], a[56:59], v[216:219]
  v_rcp_f32 v242, v242
  v_rcp_f32 v243, v243
  v_mfma_f32_16x16x32_bf16 v[216:219], a[88:91], a[40:43], v[216:219]
  v_rcp_f32 v244, v244
  v_rcp_f32 v245, v245
  s_add_u32 s48, s48, 12582912
  v_bfe_u32 v92, v253, 2, 3
  v_bfe_u32 v93, v253, 3, 2
  v_and_b32 v94, 3, v253
  v_lshlrev_b32 v94, 3, v94
  v_lshl_add_u32 v94, v92, 7, v94
  v_lshrrev_b32 v92, 5, v253
  v_lshl_add_u32 v94, v92, 11, v94
  v_xor_b32 v92, 0, v93
  v_lshl_add_u32 v64, v92, 5, v94
  v_add_u32 v68, 0x10000, v64
  v_xor_b32 v92, 1, v93
  v_lshl_add_u32 v65, v92, 5, v94
  v_mfma_f32_16x16x32_bf16 v[212:215], a[88:91], a[36:39], v[212:215]
  buffer_load_dword v74, v251, s[4:7], s64 offen sc1
  v_exp_f32 v246, v246
  v_exp_f32 v247, v247
  v_mfma_f32_16x16x32_bf16 v[212:215], a[92:95], a[52:55], v[212:215]
  v_exp_f32 v248, v248
  v_exp_f32 v249, v249
  v_pk_mul_f32 v[160:161], v[160:161], v[242:243]
  v_pk_mul_f32 v[162:163], v[162:163], v[244:245]
  v_pk_mul_f32 v[242:243], v[168:169], v[240:241] op_sel:[0,0] op_sel_hi:[1,0]
  v_pk_mul_f32 v[244:245], v[170:171], v[240:241] op_sel:[0,0] op_sel_hi:[1,0]
  v_cvt_pk_bf16_f32 v146, v160, v161
  v_cvt_pk_bf16_f32 v147, v162, v163
  buffer_store_dwordx4 v[144:147], v231, s[4:7], s57 offen sc1
  s_add_u32 s57, s57, 16384
  v_pk_fma_f32 v[246:247], v[246:247], v[232:233], v[232:233] op_sel:[0,1,1] op_sel_hi:[1,1,1]
  v_pk_fma_f32 v[248:249], v[248:249], v[232:233], v[232:233] op_sel:[0,1,1] op_sel_hi:[1,1,1]
  v_pk_mul_f32 v[168:169], v[168:169], v[184:185]
  v_pk_mul_f32 v[170:171], v[170:171], v[186:187]
  v_mfma_f32_16x16x32_bf16 v[208:211], a[92:95], a[48:51], v[208:211]
  v_rcp_f32 v246, v246
  v_rcp_f32 v247, v247
  v_mfma_f32_16x16x32_bf16 v[208:211], a[88:91], a[32:35], v[208:211]
  v_rcp_f32 v248, v248
  v_rcp_f32 v249, v249
  v_add_u32 v69, 0x10000, v65
  v_xor_b32 v92, 2, v93
  v_lshl_add_u32 v66, v92, 5, v94
  v_add_u32 v70, 0x10000, v66
  v_xor_b32 v92, 3, v93
  v_lshl_add_u32 v67, v92, 5, v94
  v_add_u32 v71, 0x10000, v67
  v_mov_b32 v0, 0
  v_mov_b32 v1, 0
  v_mov_b32 v2, 0
  v_mov_b32 v3, 0
  v_mov_b32 v4, 0
  v_mov_b32 v5, 0
  s_waitcnt vmcnt(10)
  s_barrier
  s_cmp_lg_u32 s40, 0
  s_cbranch_scc1 Lsgf19
  v_mov_b32 v250, 1
  s_mov_b64 exec, 1
  buffer_atomic_add v250, v251, s[4:7], s77 offen sc1
  s_mov_b64 exec, -1
Lsgf19:
  s_add_u32 s77, s77, 2048
  v_exp_f32 v242, v242
  v_exp_f32 v243, v243
  v_exp_f32 v244, v244
  v_exp_f32 v245, v245
  v_pk_mul_f32 v[164:165], v[164:165], v[246:247]
  v_pk_mul_f32 v[166:167], v[166:167], v[248:249]
  v_pk_mul_f32 v[246:247], v[172:173], v[240:241] op_sel:[0,1] op_sel_hi:[1,1]
  v_pk_mul_f32 v[248:249], v[174:175], v[240:241] op_sel:[0,1] op_sel_hi:[1,1]
  v_cvt_pk_bf16_f32 v150, v164, v165
  v_cvt_pk_bf16_f32 v151, v166, v167
  buffer_store_dwordx4 v[148:151], v231, s[4:7], s58 offen sc1
  s_add_u32 s58, s58, 16384
  v_pk_fma_f32 v[242:243], v[242:243], v[234:235], v[234:235] op_sel:[0,0,0] op_sel_hi:[1,0,0]
  v_pk_fma_f32 v[244:245], v[244:245], v[234:235], v[234:235] op_sel:[0,0,0] op_sel_hi:[1,0,0]
  v_pk_mul_f32 v[172:173], v[172:173], v[188:189]
  v_pk_mul_f32 v[174:175], v[174:175], v[190:191]
  v_rcp_f32 v242, v242
  v_rcp_f32 v243, v243
  v_rcp_f32 v244, v244
  v_rcp_f32 v245, v245
  v_mov_b32 v6, 0
  v_mov_b32 v7, 0
  v_mov_b32 v8, 0
  v_mov_b32 v9, 0
  v_mov_b32 v10, 0
  v_mov_b32 v11, 0
  v_mov_b32 v12, 0
  v_mov_b32 v13, 0
  v_mov_b32 v14, 0
  v_mov_b32 v15, 0
  v_mov_b32 v16, 0
  v_mov_b32 v17, 0
  v_mov_b32 v18, 0
  v_exp_f32 v246, v246
  v_exp_f32 v247, v247
  v_exp_f32 v248, v248
  v_exp_f32 v249, v249
  v_pk_mul_f32 v[168:169], v[168:169], v[242:243]
  v_pk_mul_f32 v[170:171], v[170:171], v[244:245]
  v_pk_mul_f32 v[242:243], v[192:193], v[238:239] op_sel:[0,0] op_sel_hi:[1,0]
  v_pk_mul_f32 v[244:245], v[194:195], v[238:239] op_sel:[0,0] op_sel_hi:[1,0]
  v_cvt_pk_bf16_f32 v154, v168, v169
  v_cvt_pk_bf16_f32 v155, v170, v171
  buffer_store_dwordx4 v[152:155], v231, s[4:7], s59 offen sc1
  s_add_u32 s59, s59, 16384
  v_pk_fma_f32 v[246:247], v[246:247], v[234:235], v[234:235] op_sel:[0,1,1] op_sel_hi:[1,1,1]
  v_pk_fma_f32 v[248:249], v[248:249], v[234:235], v[234:235] op_sel:[0,1,1] op_sel_hi:[1,1,1]
  v_pk_mul_f32 v[192:193], v[192:193], v[208:209]
  v_pk_mul_f32 v[194:195], v[194:195], v[210:211]
  v_rcp_f32 v246, v246
  v_rcp_f32 v247, v247
  v_rcp_f32 v248, v248
  v_rcp_f32 v249, v249
  v_mov_b32 v19, 0
  v_mov_b32 v20, 0
  v_mov_b32 v21, 0
  v_mov_b32 v22, 0
  v_mov_b32 v23, 0
  v_mov_b32 v24, 0
  v_mov_b32 v25, 0
  v_mov_b32 v26, 0
  v_mov_b32 v27, 0
  v_mov_b32 v28, 0
  v_mov_b32 v29, 0
  v_mov_b32 v30, 0
  v_mov_b32 v31, 0
  v_exp_f32 v242, v242
  v_exp_f32 v243, v243
  v_exp_f32 v244, v244
  v_exp_f32 v245, v245
  v_pk_mul_f32 v[172:173], v[172:173], v[246:247]
  v_pk_mul_f32 v[174:175], v[174:175], v[248:249]
  v_pk_mul_f32 v[246:247], v[196:197], v[238:239] op_sel:[0,1] op_sel_hi:[1,1]
  v_pk_mul_f32 v[248:249], v[198:199], v[238:239] op_sel:[0,1] op_sel_hi:[1,1]
  v_cvt_pk_bf16_f32 v158, v172, v173
  v_cvt_pk_bf16_f32 v159, v174, v175
  buffer_store_dwordx4 v[156:159], v231, s[4:7], s60 offen sc1
  s_add_u32 s60, s60, 16384
  v_pk_fma_f32 v[242:243], v[242:243], v[232:233], v[232:233] op_sel:[0,0,0] op_sel_hi:[1,0,0]
  v_pk_fma_f32 v[244:245], v[244:245], v[232:233], v[232:233] op_sel:[0,0,0] op_sel_hi:[1,0,0]
  v_pk_mul_f32 v[196:197], v[196:197], v[212:213]
  v_pk_mul_f32 v[198:199], v[198:199], v[214:215]
  v_rcp_f32 v242, v242
  v_rcp_f32 v243, v243
  v_rcp_f32 v244, v244
  v_rcp_f32 v245, v245
  v_exp_f32 v246, v246
  v_exp_f32 v247, v247
  v_exp_f32 v248, v248
  v_exp_f32 v249, v249
  v_pk_mul_f32 v[192:193], v[192:193], v[242:243]
  v_pk_mul_f32 v[194:195], v[194:195], v[244:245]
  v_pk_mul_f32 v[242:243], v[200:201], v[240:241] op_sel:[0,0] op_sel_hi:[1,0]
  v_pk_mul_f32 v[244:245], v[202:203], v[240:241] op_sel:[0,0] op_sel_hi:[1,0]
  v_cvt_pk_bf16_f32 v208, v192, v193
  v_cvt_pk_bf16_f32 v209, v194, v195
  v_pk_fma_f32 v[246:247], v[246:247], v[232:233], v[232:233] op_sel:[0,1,1] op_sel_hi:[1,1,1]
  v_pk_fma_f32 v[248:249], v[248:249], v[232:233], v[232:233] op_sel:[0,1,1] op_sel_hi:[1,1,1]
  v_pk_mul_f32 v[200:201], v[200:201], v[216:217]
  v_pk_mul_f32 v[202:203], v[202:203], v[218:219]
  v_rcp_f32 v246, v246
  v_rcp_f32 v247, v247
  v_rcp_f32 v248, v248
  v_rcp_f32 v249, v249
  v_exp_f32 v242, v242
  v_exp_f32 v243, v243
  v_exp_f32 v244, v244
  v_exp_f32 v245, v245
  v_pk_mul_f32 v[196:197], v[196:197], v[246:247]
  v_pk_mul_f32 v[198:199], v[198:199], v[248:249]
  v_pk_mul_f32 v[246:247], v[204:205], v[240:241] op_sel:[0,1] op_sel_hi:[1,1]
  v_pk_mul_f32 v[248:249], v[206:207], v[240:241] op_sel:[0,1] op_sel_hi:[1,1]
  v_cvt_pk_bf16_f32 v210, v196, v197
  v_cvt_pk_bf16_f32 v211, v198, v199
  s_nop 1
  v_permlane32_swap_b32 v208, v210
  v_permlane32_swap_b32 v209, v211
  buffer_store_dwordx4 v[208:211], v236, s[4:7], s61 offen sc1
  v_pk_fma_f32 v[242:243], v[242:243], v[234:235], v[234:235] op_sel:[0,0,0] op_sel_hi:[1,0,0]
  v_pk_fma_f32 v[244:245], v[244:245], v[234:235], v[234:235] op_sel:[0,0,0] op_sel_hi:[1,0,0]
  v_pk_mul_f32 v[204:205], v[204:205], v[220:221]
  v_pk_mul_f32 v[206:207], v[206:207], v[222:223]
  v_rcp_f32 v242, v242
  v_rcp_f32 v243, v243
  v_rcp_f32 v244, v244
  v_rcp_f32 v245, v245
  v_exp_f32 v246, v246
  v_exp_f32 v247, v247
  v_exp_f32 v248, v248
  v_exp_f32 v249, v249
  v_pk_mul_f32 v[200:201], v[200:201], v[242:243]
  v_pk_mul_f32 v[202:203], v[202:203], v[244:245]
  v_cvt_pk_bf16_f32 v216, v200, v201
  v_cvt_pk_bf16_f32 v217, v202, v203
  v_pk_fma_f32 v[246:247], v[246:247], v[234:235], v[234:235] op_sel:[0,1,1] op_sel_hi:[1,1,1]
  v_pk_fma_f32 v[248:249], v[248:249], v[234:235], v[234:235] op_sel:[0,1,1] op_sel_hi:[1,1,1]
  v_rcp_f32 v246, v246
  v_rcp_f32 v247, v247
  v_rcp_f32 v248, v248
  v_rcp_f32 v249, v249
  s_nop 0
  v_pk_mul_f32 v[204:205], v[204:205], v[246:247]
  v_pk_mul_f32 v[206:207], v[206:207], v[248:249]
  v_cvt_pk_bf16_f32 v218, v204, v205
  v_cvt_pk_bf16_f32 v219, v206, v207
  s_nop 1
  v_permlane32_swap_b32 v216, v218
  v_permlane32_swap_b32 v217, v219
  buffer_store_dwordx4 v[216:219], v236, s[4:7], s62 offen sc1
  s_cmp_lg_u32 s88, 0
  s_cselect_b32 s57, 4096, 0
  s_cmp_lg_u32 s89, 0
  s_cselect_b32 s58, 4096, 0
  s_cmp_lg_u32 s90, 0
  s_cselect_b32 s59, 4096, 0
  s_cmp_lg_u32 s91, 0
  s_cselect_b32 s60, 4096, 0
  s_waitcnt vmcnt(6)
  v_cmp_gt_u32 vcc, 16, v74
  s_cbranch_vccz Lp4a_ok
  s_mov_b32 s43, 0x40000
Lp4a_sp:
  s_sleep 10
  buffer_load_dword v74, v251, s[4:7], s64 offen sc1
  s_waitcnt vmcnt(0)
  v_cmp_gt_u32 vcc, 16, v74
  s_cbranch_vccz Lp4a_ok
  s_sub_u32 s43, s43, 1
  s_cmp_lg_u32 s43, 0
  s_cbranch_scc1 Lp4a_sp
Lp4a_ok:
  s_add_u32 s64, s64, 2048
  s_add_u32 s47, s48, s57
  buffer_load_dwordx4 a[128:131], v72, s[4:7], s47 offen offset:0 sc1
  buffer_load_dwordx4 a[132:135], v73, s[4:7], s47 offen offset:0 sc1
  s_add_u32 s47, s48, s58
  buffer_load_dwordx4 a[136:139], v72, s[4:7], s47 offen offset:1024 sc1
  buffer_load_dwordx4 a[140:143], v73, s[4:7], s47 offen offset:1024 sc1
  s_add_u32 s47, s48, s59
  buffer_load_dwordx4 a[144:147], v72, s[4:7], s47 offen offset:2048 sc1
  buffer_load_dwordx4 a[148:151], v73, s[4:7], s47 offen offset:2048 sc1
  s_add_u32 s47, s48, s60
  buffer_load_dwordx4 a[152:155], v72, s[4:7], s47 offen offset:3072 sc1
  buffer_load_dwordx4 a[156:159], v73, s[4:7], s47 offen offset:3072 sc1
  s_add_u32 s48, s48, 4096
  s_add_u32 s47, s48, s57
  buffer_load_dwordx4 a[160:163], v72, s[4:7], s47 offen offset:0 sc1
  buffer_load_dwordx4 a[164:167], v73, s[4:7], s47 offen offset:0 sc1
  s_add_u32 s47, s48, s58
  buffer_load_dwordx4 a[168:171], v72, s[4:7], s47 offen offset:1024 sc1
  buffer_load_dwordx4 a[172:175], v73, s[4:7], s47 offen offset:1024 sc1
  s_barrier
  ds_read_b64_tr_b16 a[0:1], v64 offset:0
  ds_read_b64_tr_b16 a[2:3], v64 offset:4096
  ds_read_b64_tr_b16 a[16:17], v64 offset:8192
  ds_read_b64_tr_b16 a[18:19], v64 offset:12288
  ds_read_b64_tr_b16 a[4:5], v65 offset:0
  ds_read_b64_tr_b16 a[6:7], v65 offset:4096
  ds_read_b64_tr_b16 a[20:21], v65 offset:8192
  ds_read_b64_tr_b16 a[22:23], v65 offset:12288
  ds_read_b64_tr_b16 a[8:9], v66 offset:0
  ds_read_b64_tr_b16 a[10:11], v66 offset:4096
  ds_read_b64_tr_b16 a[24:25], v66 offset:8192
  ds_read_b64_tr_b16 a[26:27], v66 offset:12288
  ds_read_b64_tr_b16 a[12:13], v67 offset:0
  ds_read_b64_tr_b16 a[14:15], v67 offset:4096
  ds_read_b64_tr_b16 a[28:29], v67 offset:8192
  ds_read_b64_tr_b16 a[30:31], v67 offset:12288
  v_lshlrev_b32 v32, 16, v76
  v_and_b32 v33, 0xffff0000, v76
  v_lshlrev_b32 v34, 16, v77
  v_and_b32 v35, 0xffff0000, v77
  v_lshlrev_b32 v40, 16, v78
  v_and_b32 v41, 0xffff0000, v78
  v_lshlrev_b32 v42, 16, v79
  v_and_b32 v43, 0xffff0000, v79
  v_lshlrev_b32 v48, 16, v80
  v_and_b32 v49, 0xffff0000, v80
  v_lshlrev_b32 v50, 16, v81
  v_and_b32 v51, 0xffff0000, v81
  v_lshlrev_b32 v56, 16, v82
  v_and_b32 v57, 0xffff0000, v82
  v_lshlrev_b32 v58, 16, v83
  v_and_b32 v59, 0xffff0000, v83
  v_lshlrev_b32 v36, 16, v84
  v_and_b32 v37, 0xffff0000, v84
  v_lshlrev_b32 v38, 16, v85
  v_and_b32 v39, 0xffff0000, v85
  v_lshlrev_b32 v44, 16, v86
  v_and_b32 v45, 0xffff0000, v86
  v_lshlrev_b32 v46, 16, v87
  v_and_b32 v47, 0xffff0000, v87
  v_lshlrev_b32 v52, 16, v88
  v_and_b32 v53, 0xffff0000, v88
  v_lshlrev_b32 v54, 16, v89
  v_and_b32 v55, 0xffff0000, v89
  v_lshlrev_b32 v60, 16, v90
  v_and_b32 v61, 0xffff0000, v90
  v_lshlrev_b32 v62, 16, v91
  v_and_b32 v63, 0xffff0000, v91
  s_waitcnt vmcnt(12)
  s_barrier
  s_cmp_lg_u32 s40, 0
  s_cbranch_scc1 Lsgf20
  v_mov_b32 v250, 1
  s_mov_b64 exec, 1
  buffer_atomic_add v250, v251, s[4:7], s77 offen sc1
  s_mov_b64 exec, -1
Lsgf20:
  s_add_u32 s77, s77, 2048
  s_mov_b32 s56, 2
.p2align 3
Lp4_loop:
  s_waitcnt vmcnt(8) lgkmcnt(8)
  v_mfma_f32_16x16x32_bf16 v[0:3], a[0:3], a[128:131], v[0:3]
  s_barrier
  ds_read_b64_tr_b16 a[32:33], v64 offset:1024
  v_mfma_f32_16x16x32_bf16 v[0:3], a[16:19], a[136:139], v[0:3]
  ds_read_b64_tr_b16 a[34:35], v64 offset:5120
  s_add_u32 m0, s79, 98304
  v_mfma_f32_16x16x32_bf16 v[4:7], a[16:19], a[140:143], v[4:7]
  ds_read_b64_tr_b16 a[48:49], v64 offset:9216
  s_cmp_lg_u32 s88, 0
  s_cselect_b32 s93, -2686976, 0
  v_mfma_f32_16x16x32_bf16 v[4:7], a[0:3], a[132:135], v[4:7]
  ds_read_b64_tr_b16 a[50:51], v64 offset:13312
  v_mfma_f32_16x16x32_bf16 v[12:15], a[4:7], a[132:135], v[12:15]
  ds_read_b64_tr_b16 a[36:37], v65 offset:1024
  s_add_u32 s93, s93, s92
  v_mfma_f32_16x16x32_bf16 v[12:15], a[20:23], a[140:143], v[12:15]
  ds_read_b64_tr_b16 a[38:39], v65 offset:5120
  buffer_load_dwordx4 v252, s[80:83], s93 offen lds
  v_mfma_f32_16x16x32_bf16 v[8:11], a[20:23], a[136:139], v[8:11]
  ds_read_b64_tr_b16 a[52:53], v65 offset:9216
  v_mfma_f32_16x16x32_bf16 v[8:11], a[4:7], a[128:131], v[8:11]
  ds_read_b64_tr_b16 a[54:55], v65 offset:13312
  buffer_load_dwordx4 v252, s[84:87], s93 offen offset:1024 lds
  s_waitcnt lgkmcnt(8)
  v_mfma_f32_16x16x32_bf16 v[16:19], a[8:11], a[128:131], v[16:19]
  ds_read_b64_tr_b16 a[40:41], v66 offset:1024
  s_add_u32 s92, s92, 262144
  v_mfma_f32_16x16x32_bf16 v[16:19], a[24:27], a[136:139], v[16:19]
  ds_read_b64_tr_b16 a[42:43], v66 offset:5120
  v_mfma_f32_16x16x32_bf16 v[20:23], a[24:27], a[140:143], v[20:23]
  ds_read_b64_tr_b16 a[56:57], v66 offset:9216
  s_add_u32 s47, s48, s59
  v_mfma_f32_16x16x32_bf16 v[20:23], a[8:11], a[132:135], v[20:23]
  ds_read_b64_tr_b16 a[58:59], v66 offset:13312
  buffer_load_dwordx4 a[176:179], v72, s[4:7], s47 offen offset:2048 sc1
  v_mfma_f32_16x16x32_bf16 v[28:31], a[12:15], a[132:135], v[28:31]
  ds_read_b64_tr_b16 a[44:45], v67 offset:1024
  v_mfma_f32_16x16x32_bf16 v[28:31], a[28:31], a[140:143], v[28:31]
  ds_read_b64_tr_b16 a[46:47], v67 offset:5120
  buffer_load_dwordx4 a[180:183], v73, s[4:7], s47 offen offset:2048 sc1
  v_mfma_f32_16x16x32_bf16 v[24:27], a[28:31], a[136:139], v[24:27]
  ds_read_b64_tr_b16 a[60:61], v67 offset:9216
  v_mfma_f32_16x16x32_bf16 v[24:27], a[12:15], a[128:131], v[24:27]
  ds_read_b64_tr_b16 a[62:63], v67 offset:13312
  s_waitcnt lgkmcnt(8)
  v_mfma_f32_16x16x32_bf16 v[32:35], a[32:35], a[128:131], v[32:35]
  ds_read_b64_tr_b16 a[0:1], v64 offset:16384
  v_mfma_f32_16x16x32_bf16 v[32:35], a[48:51], a[136:139], v[32:35]
  ds_read_b64_tr_b16 a[2:3], v64 offset:20480
  s_add_u32 m0, s79, 106496
  v_mfma_f32_16x16x32_bf16 v[36:39], a[48:51], a[140:143], v[36:39]
  ds_read_b64_tr_b16 a[16:17], v64 offset:24576
  s_cmp_lg_u32 s89, 0
  s_cselect_b32 s93, -2686976, 0
  v_mfma_f32_16x16x32_bf16 v[36:39], a[32:35], a[132:135], v[36:39]
  ds_read_b64_tr_b16 a[18:19], v64 offset:28672
  s_add_u32 s93, s93, s92
  v_mfma_f32_16x16x32_bf16 v[44:47], a[36:39], a[132:135], v[44:47]
  ds_read_b64_tr_b16 a[4:5], v65 offset:16384
  v_mfma_f32_16x16x32_bf16 v[44:47], a[52:55], a[140:143], v[44:47]
  ds_read_b64_tr_b16 a[6:7], v65 offset:20480
  buffer_load_dwordx4 v252, s[80:83], s93 offen lds
  v_mfma_f32_16x16x32_bf16 v[40:43], a[52:55], a[136:139], v[40:43]
  ds_read_b64_tr_b16 a[20:21], v65 offset:24576
  buffer_load_dwordx4 v252, s[84:87], s93 offen offset:1024 lds
  v_mfma_f32_16x16x32_bf16 v[40:43], a[36:39], a[128:131], v[40:43]
  ds_read_b64_tr_b16 a[22:23], v65 offset:28672
  s_waitcnt lgkmcnt(8)
  v_mfma_f32_16x16x32_bf16 v[48:51], a[40:43], a[128:131], v[48:51]
  ds_read_b64_tr_b16 a[8:9], v66 offset:16384
  s_add_u32 s92, s92, 196608
  v_mfma_f32_16x16x32_bf16 v[48:51], a[56:59], a[136:139], v[48:51]
  ds_read_b64_tr_b16 a[10:11], v66 offset:20480
  s_add_u32 s47, s48, s60
  v_mfma_f32_16x16x32_bf16 v[52:55], a[56:59], a[140:143], v[52:55]
  ds_read_b64_tr_b16 a[24:25], v66 offset:24576
  buffer_load_dwordx4 a[184:187], v72, s[4:7], s47 offen offset:3072 sc1
  v_mfma_f32_16x16x32_bf16 v[52:55], a[40:43], a[132:135], v[52:55]
  ds_read_b64_tr_b16 a[26:27], v66 offset:28672
  v_mfma_f32_16x16x32_bf16 v[60:63], a[44:47], a[132:135], v[60:63]
  ds_read_b64_tr_b16 a[12:13], v67 offset:16384
  buffer_load_dwordx4 a[188:191], v73, s[4:7], s47 offen offset:3072 sc1
  v_mfma_f32_16x16x32_bf16 v[60:63], a[60:63], a[140:143], v[60:63]
  ds_read_b64_tr_b16 a[14:15], v67 offset:20480
  s_add_u32 s48, s48, 4096
  v_mfma_f32_16x16x32_bf16 v[56:59], a[60:63], a[136:139], v[56:59]
  ds_read_b64_tr_b16 a[28:29], v67 offset:24576
  v_mfma_f32_16x16x32_bf16 v[56:59], a[44:47], a[128:131], v[56:59]
  ds_read_b64_tr_b16 a[30:31], v67 offset:28672
  s_waitcnt vmcnt(12) lgkmcnt(8)
  v_mfma_f32_16x16x32_bf16 v[0:3], a[0:3], a[144:147], v[0:3]
  ds_read_b64_tr_b16 a[32:33], v64 offset:17408
  v_mfma_f32_16x16x32_bf16 v[0:3], a[16:19], a[152:155], v[0:3]
  ds_read_b64_tr_b16 a[34:35], v64 offset:21504
  s_add_u32 m0, s79, 114688
  v_mfma_f32_16x16x32_bf16 v[4:7], a[16:19], a[156:159], v[4:7]
  ds_read_b64_tr_b16 a[48:49], v64 offset:25600
  s_cmp_lg_u32 s90, 0
  s_cselect_b32 s93, -2686976, 0
  v_mfma_f32_16x16x32_bf16 v[4:7], a[0:3], a[148:151], v[4:7]
  ds_read_b64_tr_b16 a[50:51], v64 offset:29696
  v_mfma_f32_16x16x32_bf16 v[12:15], a[4:7], a[148:151], v[12:15]
  ds_read_b64_tr_b16 a[36:37], v65 offset:17408
  s_add_u32 s93, s93, s92
  v_mfma_f32_16x16x32_bf16 v[12:15], a[20:23], a[156:159], v[12:15]
  ds_read_b64_tr_b16 a[38:39], v65 offset:21504
  buffer_load_dwordx4 v252, s[80:83], s93 offen lds
  v_mfma_f32_16x16x32_bf16 v[8:11], a[20:23], a[152:155], v[8:11]
  ds_read_b64_tr_b16 a[52:53], v65 offset:25600
  v_mfma_f32_16x16x32_bf16 v[8:11], a[4:7], a[144:147], v[8:11]
  ds_read_b64_tr_b16 a[54:55], v65 offset:29696
  buffer_load_dwordx4 v252, s[84:87], s93 offen offset:1024 lds
  s_waitcnt lgkmcnt(8)
  v_mfma_f32_16x16x32_bf16 v[16:19], a[8:11], a[144:147], v[16:19]
  ds_read_b64_tr_b16 a[40:41], v66 offset:17408
  s_add_u32 s92, s92, 262144
  v_mfma_f32_16x16x32_bf16 v[16:19], a[24:27], a[152:155], v[16:19]
  ds_read_b64_tr_b16 a[42:43], v66 offset:21504
  v_mfma_f32_16x16x32_bf16 v[20:23], a[24:27], a[156:159], v[20:23]
  ds_read_b64_tr_b16 a[56:57], v66 offset:25600
  s_add_u32 s47, s48, s57
  v_mfma_f32_16x16x32_bf16 v[20:23], a[8:11], a[148:151], v[20:23]
  ds_read_b64_tr_b16 a[58:59], v66 offset:29696
  buffer_load_dwordx4 a[192:195], v72, s[4:7], s47 offen offset:0 sc1
  v_mfma_f32_16x16x32_bf16 v[28:31], a[12:15], a[148:151], v[28:31]
  ds_read_b64_tr_b16 a[44:45], v67 offset:17408
  v_mfma_f32_16x16x32_bf16 v[28:31], a[28:31], a[156:159], v[28:31]
  ds_read_b64_tr_b16 a[46:47], v67 offset:21504
  buffer_load_dwordx4 a[196:199], v73, s[4:7], s47 offen offset:0 sc1
  v_mfma_f32_16x16x32_bf16 v[24:27], a[28:31], a[152:155], v[24:27]
  ds_read_b64_tr_b16 a[60:61], v67 offset:25600
  v_mfma_f32_16x16x32_bf16 v[24:27], a[12:15], a[144:147], v[24:27]
  ds_read_b64_tr_b16 a[62:63], v67 offset:29696
  s_waitcnt lgkmcnt(8)
  v_mfma_f32_16x16x32_bf16 v[32:35], a[32:35], a[144:147], v[32:35]
  ds_read_b64_tr_b16 a[0:1], v64 offset:32768
  buffer_load_dword v74, v251, s[4:7], s64 offen sc1
  v_mfma_f32_16x16x32_bf16 v[32:35], a[48:51], a[152:155], v[32:35]
  ds_read_b64_tr_b16 a[2:3], v64 offset:36864
  s_add_u32 m0, s79, 122880
  v_mfma_f32_16x16x32_bf16 v[36:39], a[48:51], a[156:159], v[36:39]
  ds_read_b64_tr_b16 a[16:17], v64 offset:40960
  s_cmp_lg_u32 s91, 0
  s_cselect_b32 s93, -2686976, 0
  v_mfma_f32_16x16x32_bf16 v[36:39], a[32:35], a[148:151], v[36:39]
  ds_read_b64_tr_b16 a[18:19], v64 offset:45056
  v_mfma_f32_16x16x32_bf16 v[44:47], a[36:39], a[148:151], v[44:47]
  ds_read_b64_tr_b16 a[4:5], v65 offset:32768
  s_add_u32 s93, s93, s92
  v_mfma_f32_16x16x32_bf16 v[44:47], a[52:55], a[156:159], v[44:47]
  ds_read_b64_tr_b16 a[6:7], v65 offset:36864
  buffer_load_dwordx4 v252, s[80:83], s93 offen lds
  v_mfma_f32_16x16x32_bf16 v[40:43], a[52:55], a[152:155], v[40:43]
  ds_read_b64_tr_b16 a[20:21], v65 offset:40960
  v_mfma_f32_16x16x32_bf16 v[40:43], a[36:39], a[144:147], v[40:43]
  ds_read_b64_tr_b16 a[22:23], v65 offset:45056
  buffer_load_dwordx4 v252, s[84:87], s93 offen offset:1024 lds
  s_waitcnt lgkmcnt(8)
  v_mfma_f32_16x16x32_bf16 v[48:51], a[40:43], a[144:147], v[48:51]
  ds_read_b64_tr_b16 a[8:9], v66 offset:32768
  s_add_u32 s92, s92, -3407872
  v_mfma_f32_16x16x32_bf16 v[48:51], a[56:59], a[152:155], v[48:51]
  ds_read_b64_tr_b16 a[10:11], v66 offset:36864
  v_mfma_f32_16x16x32_bf16 v[52:55], a[56:59], a[156:159], v[52:55]
  ds_read_b64_tr_b16 a[24:25], v66 offset:40960
  s_add_u32 s47, s48, s58
  v_mfma_f32_16x16x32_bf16 v[52:55], a[40:43], a[148:151], v[52:55]
  ds_read_b64_tr_b16 a[26:27], v66 offset:45056
  buffer_load_dwordx4 a[200:203], v72, s[4:7], s47 offen offset:1024 sc1
  v_mfma_f32_16x16x32_bf16 v[60:63], a[44:47], a[148:151], v[60:63]
  ds_read_b64_tr_b16 a[12:13], v67 offset:32768
  v_mfma_f32_16x16x32_bf16 v[60:63], a[60:63], a[156:159], v[60:63]
  ds_read_b64_tr_b16 a[14:15], v67 offset:36864
  buffer_load_dwordx4 a[204:207], v73, s[4:7], s47 offen offset:1024 sc1
  v_mfma_f32_16x16x32_bf16 v[56:59], a[60:63], a[152:155], v[56:59]
  ds_read_b64_tr_b16 a[28:29], v67 offset:40960
  v_mfma_f32_16x16x32_bf16 v[56:59], a[44:47], a[144:147], v[56:59]
  ds_read_b64_tr_b16 a[30:31], v67 offset:45056
  s_waitcnt vmcnt(17) lgkmcnt(8)
  v_mfma_f32_16x16x32_bf16 v[0:3], a[0:3], a[160:163], v[0:3]
  s_barrier
  ds_read_b64_tr_b16 a[32:33], v64 offset:33792
  v_mfma_f32_16x16x32_bf16 v[0:3], a[16:19], a[168:171], v[0:3]
  ds_read_b64_tr_b16 a[34:35], v64 offset:37888
  s_add_u32 m0, s79, 0
  v_mfma_f32_16x16x32_bf16 v[4:7], a[16:19], a[172:175], v[4:7]
  ds_read_b64_tr_b16 a[48:49], v64 offset:41984
  s_add_u32 s93, s92, s88
  v_mfma_f32_16x16x32_bf16 v[4:7], a[0:3], a[164:167], v[4:7]
  ds_read_b64_tr_b16 a[50:51], v64 offset:46080
  v_mfma_f32_16x16x32_bf16 v[12:15], a[4:7], a[164:167], v[12:15]
  ds_read_b64_tr_b16 a[36:37], v65 offset:33792
  buffer_load_dwordx4 v252, s[80:83], s93 offen lds
  v_mfma_f32_16x16x32_bf16 v[12:15], a[20:23], a[172:175], v[12:15]
  ds_read_b64_tr_b16 a[38:39], v65 offset:37888
  v_mfma_f32_16x16x32_bf16 v[8:11], a[20:23], a[168:171], v[8:11]
  ds_read_b64_tr_b16 a[52:53], v65 offset:41984
  buffer_load_dwordx4 v252, s[84:87], s93 offen offset:1024 lds
  v_mfma_f32_16x16x32_bf16 v[8:11], a[4:7], a[160:163], v[8:11]
  ds_read_b64_tr_b16 a[54:55], v65 offset:46080
  s_waitcnt lgkmcnt(8)
  v_mfma_f32_16x16x32_bf16 v[16:19], a[8:11], a[160:163], v[16:19]
  ds_read_b64_tr_b16 a[40:41], v66 offset:33792
  s_add_u32 s92, s92, 262144
  v_mfma_f32_16x16x32_bf16 v[16:19], a[24:27], a[168:171], v[16:19]
  ds_read_b64_tr_b16 a[42:43], v66 offset:37888
  s_add_u32 s47, s48, s59
  v_mfma_f32_16x16x32_bf16 v[20:23], a[24:27], a[172:175], v[20:23]
  ds_read_b64_tr_b16 a[56:57], v66 offset:41984
  v_mfma_f32_16x16x32_bf16 v[20:23], a[8:11], a[164:167], v[20:23]
  ds_read_b64_tr_b16 a[58:59], v66 offset:46080
  buffer_load_dwordx4 a[208:211], v72, s[4:7], s47 offen offset:2048 sc1
  v_mfma_f32_16x16x32_bf16 v[28:31], a[12:15], a[164:167], v[28:31]
  ds_read_b64_tr_b16 a[44:45], v67 offset:33792
  v_mfma_f32_16x16x32_bf16 v[28:31], a[28:31], a[172:175], v[28:31]
  ds_read_b64_tr_b16 a[46:47], v67 offset:37888
  buffer_load_dwordx4 a[212:215], v73, s[4:7], s47 offen offset:2048 sc1
  v_mfma_f32_16x16x32_bf16 v[24:27], a[28:31], a[168:171], v[24:27]
  ds_read_b64_tr_b16 a[60:61], v67 offset:41984
  v_mfma_f32_16x16x32_bf16 v[24:27], a[12:15], a[160:163], v[24:27]
  ds_read_b64_tr_b16 a[62:63], v67 offset:46080
  s_waitcnt lgkmcnt(8)
  v_mfma_f32_16x16x32_bf16 v[32:35], a[32:35], a[160:163], v[32:35]
  ds_read_b64_tr_b16 a[0:1], v64 offset:49152
  v_mfma_f32_16x16x32_bf16 v[32:35], a[48:51], a[168:171], v[32:35]
  ds_read_b64_tr_b16 a[2:3], v64 offset:53248
  s_add_u32 m0, s79, 8192
  v_mfma_f32_16x16x32_bf16 v[36:39], a[48:51], a[172:175], v[36:39]
  ds_read_b64_tr_b16 a[16:17], v64 offset:57344
  s_add_u32 s93, s92, s89
  v_mfma_f32_16x16x32_bf16 v[36:39], a[32:35], a[164:167], v[36:39]
  ds_read_b64_tr_b16 a[18:19], v64 offset:61440
  v_mfma_f32_16x16x32_bf16 v[44:47], a[36:39], a[164:167], v[44:47]
  ds_read_b64_tr_b16 a[4:5], v65 offset:49152
  buffer_load_dwordx4 v252, s[80:83], s93 offen lds
  v_mfma_f32_16x16x32_bf16 v[44:47], a[52:55], a[172:175], v[44:47]
  ds_read_b64_tr_b16 a[6:7], v65 offset:53248
  buffer_load_dwordx4 v252, s[84:87], s93 offen offset:1024 lds
  v_mfma_f32_16x16x32_bf16 v[40:43], a[52:55], a[168:171], v[40:43]
  ds_read_b64_tr_b16 a[20:21], v65 offset:57344
  v_mfma_f32_16x16x32_bf16 v[40:43], a[36:39], a[160:163], v[40:43]
  ds_read_b64_tr_b16 a[22:23], v65 offset:61440
  s_add_u32 s92, s92, 196608
  s_waitcnt lgkmcnt(8)
  v_mfma_f32_16x16x32_bf16 v[48:51], a[40:43], a[160:163], v[48:51]
  ds_read_b64_tr_b16 a[8:9], v66 offset:49152
  s_add_u32 s47, s48, s60
  v_mfma_f32_16x16x32_bf16 v[48:51], a[56:59], a[168:171], v[48:51]
  ds_read_b64_tr_b16 a[10:11], v66 offset:53248
  v_mfma_f32_16x16x32_bf16 v[52:55], a[56:59], a[172:175], v[52:55]
  ds_read_b64_tr_b16 a[24:25], v66 offset:57344
  buffer_load_dwordx4 a[216:219], v72, s[4:7], s47 offen offset:3072 sc1
  v_mfma_f32_16x16x32_bf16 v[52:55], a[40:43], a[164:167], v[52:55]
  ds_read_b64_tr_b16 a[26:27], v66 offset:61440
  buffer_load_dwordx4 a[220:223], v73, s[4:7], s47 offen offset:3072 sc1
  v_mfma_f32_16x16x32_bf16 v[60:63], a[44:47], a[164:167], v[60:63]
  ds_read_b64_tr_b16 a[12:13], v67 offset:49152
  v_mfma_f32_16x16x32_bf16 v[60:63], a[60:63], a[172:175], v[60:63]
  ds_read_b64_tr_b16 a[14:15], v67 offset:53248
  s_add_u32 s48, s48, 4096
  v_mfma_f32_16x16x32_bf16 v[56:59], a[60:63], a[168:171], v[56:59]
  ds_read_b64_tr_b16 a[28:29], v67 offset:57344
  v_mfma_f32_16x16x32_bf16 v[56:59], a[44:47], a[160:163], v[56:59]
  ds_read_b64_tr_b16 a[30:31], v67 offset:61440
  s_waitcnt vmcnt(17) lgkmcnt(8)
  v_mfma_f32_16x16x32_bf16 v[0:3], a[0:3], a[176:179], v[0:3]
  ds_read_b64_tr_b16 a[32:33], v64 offset:50176
  s_waitcnt vmcnt(12)
  v_cmp_gt_u32 vcc, 16, v74
  s_cbranch_vccz Lp4b_ok
  s_mov_b32 s43, 0x40000
Lp4b_sp:
  s_sleep 10
  buffer_load_dword v74, v251, s[4:7], s64 offen sc1
  s_waitcnt vmcnt(0)
  v_cmp_gt_u32 vcc, 16, v74
  s_cbranch_vccz Lp4b_ok
  s_sub_u32 s43, s43, 1
  s_cmp_lg_u32 s43, 0
  s_cbranch_scc1 Lp4b_sp
Lp4b_ok:
  s_add_u32 s64, s64, 2048
  v_mfma_f32_16x16x32_bf16 v[0:3], a[16:19], a[184:187], v[0:3]
  ds_read_b64_tr_b16 a[34:35], v64 offset:54272
  s_add_u32 m0, s79, 16384
  v_mfma_f32_16x16x32_bf16 v[4:7], a[16:19], a[188:191], v[4:7]
  ds_read_b64_tr_b16 a[48:49], v64 offset:58368
  s_add_u32 s93, s92, s90
  v_mfma_f32_16x16x32_bf16 v[4:7], a[0:3], a[180:183], v[4:7]
  ds_read_b64_tr_b16 a[50:51], v64 offset:62464
  v_mfma_f32_16x16x32_bf16 v[12:15], a[4:7], a[180:183], v[12:15]
  ds_read_b64_tr_b16 a[36:37], v65 offset:50176
  buffer_load_dwordx4 v252, s[80:83], s93 offen lds
  v_mfma_f32_16x16x32_bf16 v[12:15], a[20:23], a[188:191], v[12:15]
  ds_read_b64_tr_b16 a[38:39], v65 offset:54272
  v_mfma_f32_16x16x32_bf16 v[8:11], a[20:23], a[184:187], v[8:11]
  ds_read_b64_tr_b16 a[52:53], v65 offset:58368
  buffer_load_dwordx4 v252, s[84:87], s93 offen offset:1024 lds
  v_mfma_f32_16x16x32_bf16 v[8:11], a[4:7], a[176:179], v[8:11]
  ds_read_b64_tr_b16 a[54:55], v65 offset:62464
  s_waitcnt lgkmcnt(8)
  v_mfma_f32_16x16x32_bf16 v[16:19], a[8:11], a[176:179], v[16:19]
  ds_read_b64_tr_b16 a[40:41], v66 offset:50176
  s_add_u32 s92, s92, 262144
  v_mfma_f32_16x16x32_bf16 v[16:19], a[24:27], a[184:187], v[16:19]
  ds_read_b64_tr_b16 a[42:43], v66 offset:54272
  s_add_u32 s47, s48, s57
  v_mfma_f32_16x16x32_bf16 v[20:23], a[24:27], a[188:191], v[20:23]
  ds_read_b64_tr_b16 a[56:57], v66 offset:58368
  v_mfma_f32_16x16x32_bf16 v[20:23], a[8:11], a[180:183], v[20:23]
  ds_read_b64_tr_b16 a[58:59], v66 offset:62464
  buffer_load_dwordx4 a[224:227], v72, s[4:7], s47 offen offset:0 sc1
  v_mfma_f32_16x16x32_bf16 v[28:31], a[12:15], a[180:183], v[28:31]
  ds_read_b64_tr_b16 a[44:45], v67 offset:50176
  v_mfma_f32_16x16x32_bf16 v[28:31], a[28:31], a[188:191], v[28:31]
  ds_read_b64_tr_b16 a[46:47], v67 offset:54272
  buffer_load_dwordx4 a[228:231], v73, s[4:7], s47 offen offset:0 sc1
  v_mfma_f32_16x16x32_bf16 v[24:27], a[28:31], a[184:187], v[24:27]
  ds_read_b64_tr_b16 a[60:61], v67 offset:58368
  v_mfma_f32_16x16x32_bf16 v[24:27], a[12:15], a[176:179], v[24:27]
  ds_read_b64_tr_b16 a[62:63], v67 offset:62464
  s_waitcnt lgkmcnt(8)
  v_mfma_f32_16x16x32_bf16 v[32:35], a[32:35], a[176:179], v[32:35]
  ds_read_b64_tr_b16 a[0:1], v68 offset:0
  v_mfma_f32_16x16x32_bf16 v[32:35], a[48:51], a[184:187], v[32:35]
  ds_read_b64_tr_b16 a[2:3], v68 offset:4096
  s_add_u32 m0, s79, 24576
  v_mfma_f32_16x16x32_bf16 v[36:39], a[48:51], a[188:191], v[36:39]
  ds_read_b64_tr_b16 a[16:17], v68 offset:8192
  s_add_u32 s93, s92, s91
  v_mfma_f32_16x16x32_bf16 v[36:39], a[32:35], a[180:183], v[36:39]
  ds_read_b64_tr_b16 a[18:19], v68 offset:12288
  v_mfma_f32_16x16x32_bf16 v[44:47], a[36:39], a[180:183], v[44:47]
  ds_read_b64_tr_b16 a[4:5], v69 offset:0
  buffer_load_dwordx4 v252, s[80:83], s93 offen lds
  v_mfma_f32_16x16x32_bf16 v[44:47], a[52:55], a[188:191], v[44:47]
  ds_read_b64_tr_b16 a[6:7], v69 offset:4096
  v_mfma_f32_16x16x32_bf16 v[40:43], a[52:55], a[184:187], v[40:43]
  ds_read_b64_tr_b16 a[20:21], v69 offset:8192
  buffer_load_dwordx4 v252, s[84:87], s93 offen offset:1024 lds
  v_mfma_f32_16x16x32_bf16 v[40:43], a[36:39], a[176:179], v[40:43]
  ds_read_b64_tr_b16 a[22:23], v69 offset:12288
  s_waitcnt lgkmcnt(8)
  v_mfma_f32_16x16x32_bf16 v[48:51], a[40:43], a[176:179], v[48:51]
  ds_read_b64_tr_b16 a[8:9], v70 offset:0
  s_add_u32 s92, s92, 196608
  v_mfma_f32_16x16x32_bf16 v[48:51], a[56:59], a[184:187], v[48:51]
  ds_read_b64_tr_b16 a[10:11], v70 offset:4096
  s_add_u32 s47, s48, s58
  v_mfma_f32_16x16x32_bf16 v[52:55], a[56:59], a[188:191], v[52:55]
  ds_read_b64_tr_b16 a[24:25], v70 offset:8192
  v_mfma_f32_16x16x32_bf16 v[52:55], a[40:43], a[180:183], v[52:55]
  ds_read_b64_tr_b16 a[26:27], v70 offset:12288
  buffer_load_dwordx4 a[232:235], v72, s[4:7], s47 offen offset:1024 sc1
  v_mfma_f32_16x16x32_bf16 v[60:63], a[44:47], a[180:183], v[60:63]
  ds_read_b64_tr_b16 a[12:13], v71 offset:0
  v_mfma_f32_16x16x32_bf16 v[60:63], a[60:63], a[188:191], v[60:63]
  ds_read_b64_tr_b16 a[14:15], v71 offset:4096
  buffer_load_dwordx4 a[236:239], v73, s[4:7], s47 offen offset:1024 sc1
  v_mfma_f32_16x16x32_bf16 v[56:59], a[60:63], a[184:187], v[56:59]
  ds_read_b64_tr_b16 a[28:29], v71 offset:8192
  v_mfma_f32_16x16x32_bf16 v[56:59], a[44:47], a[176:179], v[56:59]
  ds_read_b64_tr_b16 a[30:31], v71 offset:12288
  s_waitcnt vmcnt(16) lgkmcnt(8)
  v_mfma_f32_16x16x32_bf16 v[0:3], a[0:3], a[192:195], v[0:3]
  s_barrier
  ds_read_b64_tr_b16 a[32:33], v68 offset:1024
  v_mfma_f32_16x16x32_bf16 v[0:3], a[16:19], a[200:203], v[0:3]
  ds_read_b64_tr_b16 a[34:35], v68 offset:5120
  s_add_u32 m0, s79, 32768
  v_mfma_f32_16x16x32_bf16 v[4:7], a[16:19], a[204:207], v[4:7]
  ds_read_b64_tr_b16 a[48:49], v68 offset:9216
  s_add_u32 s93, s92, s88
  v_mfma_f32_16x16x32_bf16 v[4:7], a[0:3], a[196:199], v[4:7]
  ds_read_b64_tr_b16 a[50:51], v68 offset:13312
  v_mfma_f32_16x16x32_bf16 v[12:15], a[4:7], a[196:199], v[12:15]
  ds_read_b64_tr_b16 a[36:37], v69 offset:1024
  buffer_load_dwordx4 v252, s[80:83], s93 offen lds
  v_mfma_f32_16x16x32_bf16 v[12:15], a[20:23], a[204:207], v[12:15]
  ds_read_b64_tr_b16 a[38:39], v69 offset:5120
  v_mfma_f32_16x16x32_bf16 v[8:11], a[20:23], a[200:203], v[8:11]
  ds_read_b64_tr_b16 a[52:53], v69 offset:9216
  buffer_load_dwordx4 v252, s[84:87], s93 offen offset:1024 lds
  v_mfma_f32_16x16x32_bf16 v[8:11], a[4:7], a[192:195], v[8:11]
  ds_read_b64_tr_b16 a[54:55], v69 offset:13312
  s_waitcnt lgkmcnt(8)
  v_mfma_f32_16x16x32_bf16 v[16:19], a[8:11], a[192:195], v[16:19]
  ds_read_b64_tr_b16 a[40:41], v70 offset:1024
  s_add_u32 s92, s92, 262144
  v_mfma_f32_16x16x32_bf16 v[16:19], a[24:27], a[200:203], v[16:19]
  ds_read_b64_tr_b16 a[42:43], v70 offset:5120
  s_add_u32 s47, s48, s59
  v_mfma_f32_16x16x32_bf16 v[20:23], a[24:27], a[204:207], v[20:23]
  ds_read_b64_tr_b16 a[56:57], v70 offset:9216
  v_mfma_f32_16x16x32_bf16 v[20:23], a[8:11], a[196:199], v[20:23]
  ds_read_b64_tr_b16 a[58:59], v70 offset:13312
  buffer_load_dwordx4 a[240:243], v72, s[4:7], s47 offen offset:2048 sc1
  v_mfma_f32_16x16x32_bf16 v[28:31], a[12:15], a[196:199], v[28:31]
  ds_read_b64_tr_b16 a[44:45], v71 offset:1024
  v_mfma_f32_16x16x32_bf16 v[28:31], a[28:31], a[204:207], v[28:31]
  ds_read_b64_tr_b16 a[46:47], v71 offset:5120
  buffer_load_dwordx4 a[244:247], v73, s[4:7], s47 offen offset:2048 sc1
  v_mfma_f32_16x16x32_bf16 v[24:27], a[28:31], a[200:203], v[24:27]
  ds_read_b64_tr_b16 a[60:61], v71 offset:9216
  v_mfma_f32_16x16x32_bf16 v[24:27], a[12:15], a[192:195], v[24:27]
  ds_read_b64_tr_b16 a[62:63], v71 offset:13312
  s_waitcnt lgkmcnt(8)
  v_mfma_f32_16x16x32_bf16 v[32:35], a[32:35], a[192:195], v[32:35]
  ds_read_b64_tr_b16 a[0:1], v68 offset:16384
  v_mfma_f32_16x16x32_bf16 v[32:35], a[48:51], a[200:203], v[32:35]
  ds_read_b64_tr_b16 a[2:3], v68 offset:20480
  s_add_u32 m0, s79, 40960
  v_mfma_f32_16x16x32_bf16 v[36:39], a[48:51], a[204:207], v[36:39]
  ds_read_b64_tr_b16 a[16:17], v68 offset:24576
  s_add_u32 s93, s92, s89
  v_mfma_f32_16x16x32_bf16 v[36:39], a[32:35], a[196:199], v[36:39]
  ds_read_b64_tr_b16 a[18:19], v68 offset:28672
  v_mfma_f32_16x16x32_bf16 v[44:47], a[36:39], a[196:199], v[44:47]
  ds_read_b64_tr_b16 a[4:5], v69 offset:16384
  buffer_load_dwordx4 v252, s[80:83], s93 offen lds
  v_mfma_f32_16x16x32_bf16 v[44:47], a[52:55], a[204:207], v[44:47]
  ds_read_b64_tr_b16 a[6:7], v69 offset:20480
  buffer_load_dwordx4 v252, s[84:87], s93 offen offset:1024 lds
  v_mfma_f32_16x16x32_bf16 v[40:43], a[52:55], a[200:203], v[40:43]
  ds_read_b64_tr_b16 a[20:21], v69 offset:24576
  v_mfma_f32_16x16x32_bf16 v[40:43], a[36:39], a[192:195], v[40:43]
  ds_read_b64_tr_b16 a[22:23], v69 offset:28672
  s_add_u32 s92, s92, 196608
  s_waitcnt lgkmcnt(8)
  v_mfma_f32_16x16x32_bf16 v[48:51], a[40:43], a[192:195], v[48:51]
  ds_read_b64_tr_b16 a[8:9], v70 offset:16384
  s_add_u32 s47, s48, s60
  v_mfma_f32_16x16x32_bf16 v[48:51], a[56:59], a[200:203], v[48:51]
  ds_read_b64_tr_b16 a[10:11], v70 offset:20480
  v_mfma_f32_16x16x32_bf16 v[52:55], a[56:59], a[204:207], v[52:55]
  ds_read_b64_tr_b16 a[24:25], v70 offset:24576
  buffer_load_dwordx4 a[248:251], v72, s[4:7], s47 offen offset:3072 sc1
  v_mfma_f32_16x16x32_bf16 v[52:55], a[40:43], a[196:199], v[52:55]
  ds_read_b64_tr_b16 a[26:27], v70 offset:28672
  buffer_load_dwordx4 a[252:255], v73, s[4:7], s47 offen offset:3072 sc1
  v_mfma_f32_16x16x32_bf16 v[60:63], a[44:47], a[196:199], v[60:63]
  ds_read_b64_tr_b16 a[12:13], v71 offset:16384
  v_mfma_f32_16x16x32_bf16 v[60:63], a[60:63], a[204:207], v[60:63]
  ds_read_b64_tr_b16 a[14:15], v71 offset:20480
  s_add_u32 s48, s48, 4096
  v_mfma_f32_16x16x32_bf16 v[56:59], a[60:63], a[200:203], v[56:59]
  ds_read_b64_tr_b16 a[28:29], v71 offset:24576
  v_mfma_f32_16x16x32_bf16 v[56:59], a[44:47], a[192:195], v[56:59]
  ds_read_b64_tr_b16 a[30:31], v71 offset:28672
  s_waitcnt vmcnt(16) lgkmcnt(8)
  v_mfma_f32_16x16x32_bf16 v[0:3], a[0:3], a[208:211], v[0:3]
  ds_read_b64_tr_b16 a[32:33], v68 offset:17408
  v_mfma_f32_16x16x32_bf16 v[0:3], a[16:19], a[216:219], v[0:3]
  ds_read_b64_tr_b16 a[34:35], v68 offset:21504
  s_add_u32 m0, s79, 49152
  v_mfma_f32_16x16x32_bf16 v[4:7], a[16:19], a[220:223], v[4:7]
  ds_read_b64_tr_b16 a[48:49], v68 offset:25600
  s_add_u32 s93, s92, s90
  v_mfma_f32_16x16x32_bf16 v[4:7], a[0:3], a[212:215], v[4:7]
  ds_read_b64_tr_b16 a[50:51], v68 offset:29696
  v_mfma_f32_16x16x32_bf16 v[12:15], a[4:7], a[212:215], v[12:15]
  ds_read_b64_tr_b16 a[36:37], v69 offset:17408
  buffer_load_dwordx4 v252, s[80:83], s93 offen lds
  v_mfma_f32_16x16x32_bf16 v[12:15], a[20:23], a[220:223], v[12:15]
  ds_read_b64_tr_b16 a[38:39], v69 offset:21504
  v_mfma_f32_16x16x32_bf16 v[8:11], a[20:23], a[216:219], v[8:11]
  ds_read_b64_tr_b16 a[52:53], v69 offset:25600
  buffer_load_dwordx4 v252, s[84:87], s93 offen offset:1024 lds
  v_mfma_f32_16x16x32_bf16 v[8:11], a[4:7], a[208:211], v[8:11]
  ds_read_b64_tr_b16 a[54:55], v69 offset:29696
  s_waitcnt lgkmcnt(8)
  v_mfma_f32_16x16x32_bf16 v[16:19], a[8:11], a[208:211], v[16:19]
  ds_read_b64_tr_b16 a[40:41], v70 offset:17408
  s_add_u32 s92, s92, 262144
  v_mfma_f32_16x16x32_bf16 v[16:19], a[24:27], a[216:219], v[16:19]
  ds_read_b64_tr_b16 a[42:43], v70 offset:21504
  s_add_u32 s47, s48, s57
  v_mfma_f32_16x16x32_bf16 v[20:23], a[24:27], a[220:223], v[20:23]
  ds_read_b64_tr_b16 a[56:57], v70 offset:25600
  v_mfma_f32_16x16x32_bf16 v[20:23], a[8:11], a[212:215], v[20:23]
  ds_read_b64_tr_b16 a[58:59], v70 offset:29696
  buffer_load_dwordx4 a[128:131], v72, s[4:7], s47 offen offset:0 sc1
  v_mfma_f32_16x16x32_bf16 v[28:31], a[12:15], a[212:215], v[28:31]
  ds_read_b64_tr_b16 a[44:45], v71 offset:17408
  v_mfma_f32_16x16x32_bf16 v[28:31], a[28:31], a[220:223], v[28:31]
  ds_read_b64_tr_b16 a[46:47], v71 offset:21504
  buffer_load_dwordx4 a[132:135], v73, s[4:7], s47 offen offset:0 sc1
  v_mfma_f32_16x16x32_bf16 v[24:27], a[28:31], a[216:219], v[24:27]
  ds_read_b64_tr_b16 a[60:61], v71 offset:25600
  v_mfma_f32_16x16x32_bf16 v[24:27], a[12:15], a[208:211], v[24:27]
  ds_read_b64_tr_b16 a[62:63], v71 offset:29696
  s_waitcnt lgkmcnt(8)
  v_mfma_f32_16x16x32_bf16 v[32:35], a[32:35], a[208:211], v[32:35]
  ds_read_b64_tr_b16 a[0:1], v68 offset:32768
  v_mfma_f32_16x16x32_bf16 v[32:35], a[48:51], a[216:219], v[32:35]
  ds_read_b64_tr_b16 a[2:3], v68 offset:36864
  s_add_u32 m0, s79, 57344
  v_mfma_f32_16x16x32_bf16 v[36:39], a[48:51], a[220:223], v[36:39]
  ds_read_b64_tr_b16 a[16:17], v68 offset:40960
  s_add_u32 s93, s92, s91
  v_mfma_f32_16x16x32_bf16 v[36:39], a[32:35], a[212:215], v[36:39]
  ds_read_b64_tr_b16 a[18:19], v68 offset:45056
  v_mfma_f32_16x16x32_bf16 v[44:47], a[36:39], a[212:215], v[44:47]
  ds_read_b64_tr_b16 a[4:5], v69 offset:32768
  buffer_load_dwordx4 v252, s[80:83], s93 offen lds
  v_mfma_f32_16x16x32_bf16 v[44:47], a[52:55], a[220:223], v[44:47]
  ds_read_b64_tr_b16 a[6:7], v69 offset:36864
  v_mfma_f32_16x16x32_bf16 v[40:43], a[52:55], a[216:219], v[40:43]
  ds_read_b64_tr_b16 a[20:21], v69 offset:40960
  buffer_load_dwordx4 v252, s[84:87], s93 offen offset:1024 lds
  v_mfma_f32_16x16x32_bf16 v[40:43], a[36:39], a[208:211], v[40:43]
  ds_read_b64_tr_b16 a[22:23], v69 offset:45056
  s_waitcnt lgkmcnt(8)
  v_mfma_f32_16x16x32_bf16 v[48:51], a[40:43], a[208:211], v[48:51]
  ds_read_b64_tr_b16 a[8:9], v70 offset:32768
  s_add_u32 s92, s92, 196608
  v_mfma_f32_16x16x32_bf16 v[48:51], a[56:59], a[216:219], v[48:51]
  ds_read_b64_tr_b16 a[10:11], v70 offset:36864
  s_add_u32 s47, s48, s58
  v_mfma_f32_16x16x32_bf16 v[52:55], a[56:59], a[220:223], v[52:55]
  ds_read_b64_tr_b16 a[24:25], v70 offset:40960
  v_mfma_f32_16x16x32_bf16 v[52:55], a[40:43], a[212:215], v[52:55]
  ds_read_b64_tr_b16 a[26:27], v70 offset:45056
  buffer_load_dwordx4 a[136:139], v72, s[4:7], s47 offen offset:1024 sc1
  v_mfma_f32_16x16x32_bf16 v[60:63], a[44:47], a[212:215], v[60:63]
  ds_read_b64_tr_b16 a[12:13], v71 offset:32768
  v_mfma_f32_16x16x32_bf16 v[60:63], a[60:63], a[220:223], v[60:63]
  ds_read_b64_tr_b16 a[14:15], v71 offset:36864
  buffer_load_dwordx4 a[140:143], v73, s[4:7], s47 offen offset:1024 sc1
  v_mfma_f32_16x16x32_bf16 v[56:59], a[60:63], a[216:219], v[56:59]
  ds_read_b64_tr_b16 a[28:29], v71 offset:40960
  v_mfma_f32_16x16x32_bf16 v[56:59], a[44:47], a[208:211], v[56:59]
  ds_read_b64_tr_b16 a[30:31], v71 offset:45056
  s_waitcnt vmcnt(16) lgkmcnt(8)
  v_mfma_f32_16x16x32_bf16 v[0:3], a[0:3], a[224:227], v[0:3]
  s_barrier
  ds_read_b64_tr_b16 a[32:33], v68 offset:33792
  v_mfma_f32_16x16x32_bf16 v[0:3], a[16:19], a[232:235], v[0:3]
  ds_read_b64_tr_b16 a[34:35], v68 offset:37888
  s_add_u32 m0, s79, 65536
  v_mfma_f32_16x16x32_bf16 v[4:7], a[16:19], a[236:239], v[4:7]
  ds_read_b64_tr_b16 a[48:49], v68 offset:41984
  s_add_u32 s93, s92, s88
  v_mfma_f32_16x16x32_bf16 v[4:7], a[0:3], a[228:231], v[4:7]
  ds_read_b64_tr_b16 a[50:51], v68 offset:46080
  v_mfma_f32_16x16x32_bf16 v[12:15], a[4:7], a[228:231], v[12:15]
  ds_read_b64_tr_b16 a[36:37], v69 offset:33792
  buffer_load_dwordx4 v252, s[80:83], s93 offen lds
  v_mfma_f32_16x16x32_bf16 v[12:15], a[20:23], a[236:239], v[12:15]
  ds_read_b64_tr_b16 a[38:39], v69 offset:37888
  v_mfma_f32_16x16x32_bf16 v[8:11], a[20:23], a[232:235], v[8:11]
  ds_read_b64_tr_b16 a[52:53], v69 offset:41984
  buffer_load_dwordx4 v252, s[84:87], s93 offen offset:1024 lds
  v_mfma_f32_16x16x32_bf16 v[8:11], a[4:7], a[224:227], v[8:11]
  ds_read_b64_tr_b16 a[54:55], v69 offset:46080
  s_waitcnt lgkmcnt(8)
  v_mfma_f32_16x16x32_bf16 v[16:19], a[8:11], a[224:227], v[16:19]
  ds_read_b64_tr_b16 a[40:41], v70 offset:33792
  s_add_u32 s92, s92, 262144
  v_mfma_f32_16x16x32_bf16 v[16:19], a[24:27], a[232:235], v[16:19]
  ds_read_b64_tr_b16 a[42:43], v70 offset:37888
  s_add_u32 s47, s48, s59
  v_mfma_f32_16x16x32_bf16 v[20:23], a[24:27], a[236:239], v[20:23]
  ds_read_b64_tr_b16 a[56:57], v70 offset:41984
  v_mfma_f32_16x16x32_bf16 v[20:23], a[8:11], a[228:231], v[20:23]
  ds_read_b64_tr_b16 a[58:59], v70 offset:46080
  buffer_load_dwordx4 a[144:147], v72, s[4:7], s47 offen offset:2048 sc1
  v_mfma_f32_16x16x32_bf16 v[28:31], a[12:15], a[228:231], v[28:31]
  ds_read_b64_tr_b16 a[44:45], v71 offset:33792
  v_mfma_f32_16x16x32_bf16 v[28:31], a[28:31], a[236:239], v[28:31]
  ds_read_b64_tr_b16 a[46:47], v71 offset:37888
  buffer_load_dwordx4 a[148:151], v73, s[4:7], s47 offen offset:2048 sc1
  v_mfma_f32_16x16x32_bf16 v[24:27], a[28:31], a[232:235], v[24:27]
  ds_read_b64_tr_b16 a[60:61], v71 offset:41984
  v_mfma_f32_16x16x32_bf16 v[24:27], a[12:15], a[224:227], v[24:27]
  ds_read_b64_tr_b16 a[62:63], v71 offset:46080
  s_waitcnt lgkmcnt(8)
  v_mfma_f32_16x16x32_bf16 v[32:35], a[32:35], a[224:227], v[32:35]
  ds_read_b64_tr_b16 a[0:1], v68 offset:49152
  v_mfma_f32_16x16x32_bf16 v[32:35], a[48:51], a[232:235], v[32:35]
  ds_read_b64_tr_b16 a[2:3], v68 offset:53248
  s_add_u32 m0, s79, 73728
  v_mfma_f32_16x16x32_bf16 v[36:39], a[48:51], a[236:239], v[36:39]
  ds_read_b64_tr_b16 a[16:17], v68 offset:57344
  s_add_u32 s93, s92, s89
  v_mfma_f32_16x16x32_bf16 v[36:39], a[32:35], a[228:231], v[36:39]
  ds_read_b64_tr_b16 a[18:19], v68 offset:61440
  v_mfma_f32_16x16x32_bf16 v[44:47], a[36:39], a[228:231], v[44:47]
  ds_read_b64_tr_b16 a[4:5], v69 offset:49152
  buffer_load_dwordx4 v252, s[80:83], s93 offen lds
  v_mfma_f32_16x16x32_bf16 v[44:47], a[52:55], a[236:239], v[44:47]
  ds_read_b64_tr_b16 a[6:7], v69 offset:53248
  buffer_load_dwordx4 v252, s[84:87], s93 offen offset:1024 lds
  v_mfma_f32_16x16x32_bf16 v[40:43], a[52:55], a[232:235], v[40:43]
  ds_read_b64_tr_b16 a[20:21], v69 offset:57344
  v_mfma_f32_16x16x32_bf16 v[40:43], a[36:39], a[224:227], v[40:43]
  ds_read_b64_tr_b16 a[22:23], v69 offset:61440
  s_add_u32 s92, s92, 196608
  s_waitcnt lgkmcnt(8)
  v_mfma_f32_16x16x32_bf16 v[48:51], a[40:43], a[224:227], v[48:51]
  ds_read_b64_tr_b16 a[8:9], v70 offset:49152
  s_add_u32 s47, s48, s60
  v_mfma_f32_16x16x32_bf16 v[48:51], a[56:59], a[232:235], v[48:51]
  ds_read_b64_tr_b16 a[10:11], v70 offset:53248
  v_mfma_f32_16x16x32_bf16 v[52:55], a[56:59], a[236:239], v[52:55]
  ds_read_b64_tr_b16 a[24:25], v70 offset:57344
  buffer_load_dwordx4 a[152:155], v72, s[4:7], s47 offen offset:3072 sc1
  v_mfma_f32_16x16x32_bf16 v[52:55], a[40:43], a[228:231], v[52:55]
  ds_read_b64_tr_b16 a[26:27], v70 offset:61440
  buffer_load_dwordx4 a[156:159], v73, s[4:7], s47 offen offset:3072 sc1
  v_mfma_f32_16x16x32_bf16 v[60:63], a[44:47], a[228:231], v[60:63]
  ds_read_b64_tr_b16 a[12:13], v71 offset:49152
  v_mfma_f32_16x16x32_bf16 v[60:63], a[60:63], a[236:239], v[60:63]
  ds_read_b64_tr_b16 a[14:15], v71 offset:53248
  s_add_u32 s48, s48, 4096
  v_mfma_f32_16x16x32_bf16 v[56:59], a[60:63], a[232:235], v[56:59]
  ds_read_b64_tr_b16 a[28:29], v71 offset:57344
  v_mfma_f32_16x16x32_bf16 v[56:59], a[44:47], a[224:227], v[56:59]
  ds_read_b64_tr_b16 a[30:31], v71 offset:61440
  s_waitcnt vmcnt(16) lgkmcnt(8)
  v_mfma_f32_16x16x32_bf16 v[0:3], a[0:3], a[240:243], v[0:3]
  ds_read_b64_tr_b16 a[32:33], v68 offset:50176
  v_mfma_f32_16x16x32_bf16 v[0:3], a[16:19], a[248:251], v[0:3]
  ds_read_b64_tr_b16 a[34:35], v68 offset:54272
  s_add_u32 m0, s79, 81920
  v_mfma_f32_16x16x32_bf16 v[4:7], a[16:19], a[252:255], v[4:7]
  ds_read_b64_tr_b16 a[48:49], v68 offset:58368
  s_add_u32 s93, s92, s90
  v_mfma_f32_16x16x32_bf16 v[4:7], a[0:3], a[244:247], v[4:7]
  ds_read_b64_tr_b16 a[50:51], v68 offset:62464
  v_mfma_f32_16x16x32_bf16 v[12:15], a[4:7], a[244:247], v[12:15]
  ds_read_b64_tr_b16 a[36:37], v69 offset:50176
  buffer_load_dwordx4 v252, s[80:83], s93 offen lds
  v_mfma_f32_16x16x32_bf16 v[12:15], a[20:23], a[252:255], v[12:15]
  ds_read_b64_tr_b16 a[38:39], v69 offset:54272
  v_mfma_f32_16x16x32_bf16 v[8:11], a[20:23], a[248:251], v[8:11]
  ds_read_b64_tr_b16 a[52:53], v69 offset:58368
  buffer_load_dwordx4 v252, s[84:87], s93 offen offset:1024 lds
  v_mfma_f32_16x16x32_bf16 v[8:11], a[4:7], a[240:243], v[8:11]
  ds_read_b64_tr_b16 a[54:55], v69 offset:62464
  s_waitcnt lgkmcnt(8)
  v_mfma_f32_16x16x32_bf16 v[16:19], a[8:11], a[240:243], v[16:19]
  ds_read_b64_tr_b16 a[40:41], v70 offset:50176
  s_add_u32 s92, s92, 262144
  v_mfma_f32_16x16x32_bf16 v[16:19], a[24:27], a[248:251], v[16:19]
  ds_read_b64_tr_b16 a[42:43], v70 offset:54272
  s_add_u32 s47, s48, s57
  v_mfma_f32_16x16x32_bf16 v[20:23], a[24:27], a[252:255], v[20:23]
  ds_read_b64_tr_b16 a[56:57], v70 offset:58368
  v_mfma_f32_16x16x32_bf16 v[20:23], a[8:11], a[244:247], v[20:23]
  ds_read_b64_tr_b16 a[58:59], v70 offset:62464
  buffer_load_dwordx4 a[160:163], v72, s[4:7], s47 offen offset:0 sc1
  v_mfma_f32_16x16x32_bf16 v[28:31], a[12:15], a[244:247], v[28:31]
  ds_read_b64_tr_b16 a[44:45], v71 offset:50176
  v_mfma_f32_16x16x32_bf16 v[28:31], a[28:31], a[252:255], v[28:31]
  ds_read_b64_tr_b16 a[46:47], v71 offset:54272
  buffer_load_dwordx4 a[164:167], v73, s[4:7], s47 offen offset:0 sc1
  v_mfma_f32_16x16x32_bf16 v[24:27], a[28:31], a[248:251], v[24:27]
  ds_read_b64_tr_b16 a[60:61], v71 offset:58368
  v_mfma_f32_16x16x32_bf16 v[24:27], a[12:15], a[240:243], v[24:27]
  ds_read_b64_tr_b16 a[62:63], v71 offset:62464
  s_waitcnt lgkmcnt(8)
  v_mfma_f32_16x16x32_bf16 v[32:35], a[32:35], a[240:243], v[32:35]
  ds_read_b64_tr_b16 a[0:1], v64 offset:0
  v_mfma_f32_16x16x32_bf16 v[32:35], a[48:51], a[248:251], v[32:35]
  ds_read_b64_tr_b16 a[2:3], v64 offset:4096
  s_add_u32 m0, s79, 90112
  v_mfma_f32_16x16x32_bf16 v[36:39], a[48:51], a[252:255], v[36:39]
  ds_read_b64_tr_b16 a[16:17], v64 offset:8192
  s_add_u32 s93, s92, s91
  v_mfma_f32_16x16x32_bf16 v[36:39], a[32:35], a[244:247], v[36:39]
  ds_read_b64_tr_b16 a[18:19], v64 offset:12288
  v_mfma_f32_16x16x32_bf16 v[44:47], a[36:39], a[244:247], v[44:47]
  ds_read_b64_tr_b16 a[4:5], v65 offset:0
  buffer_load_dwordx4 v252, s[80:83], s93 offen lds
  v_mfma_f32_16x16x32_bf16 v[44:47], a[52:55], a[252:255], v[44:47]
  ds_read_b64_tr_b16 a[6:7], v65 offset:4096
  v_mfma_f32_16x16x32_bf16 v[40:43], a[52:55], a[248:251], v[40:43]
  ds_read_b64_tr_b16 a[20:21], v65 offset:8192
  buffer_load_dwordx4 v252, s[84:87], s93 offen offset:1024 lds
  v_mfma_f32_16x16x32_bf16 v[40:43], a[36:39], a[240:243], v[40:43]
  ds_read_b64_tr_b16 a[22:23], v65 offset:12288
  s_waitcnt lgkmcnt(8)
  v_mfma_f32_16x16x32_bf16 v[48:51], a[40:43], a[240:243], v[48:51]
  ds_read_b64_tr_b16 a[8:9], v66 offset:0
  s_add_u32 s92, s92, 196608
  v_mfma_f32_16x16x32_bf16 v[48:51], a[56:59], a[248:251], v[48:51]
  ds_read_b64_tr_b16 a[10:11], v66 offset:4096
  s_add_u32 s47, s48, s58
  v_mfma_f32_16x16x32_bf16 v[52:55], a[56:59], a[252:255], v[52:55]
  ds_read_b64_tr_b16 a[24:25], v66 offset:8192
  v_mfma_f32_16x16x32_bf16 v[52:55], a[40:43], a[244:247], v[52:55]
  ds_read_b64_tr_b16 a[26:27], v66 offset:12288
  buffer_load_dwordx4 a[168:171], v72, s[4:7], s47 offen offset:1024 sc1
  v_mfma_f32_16x16x32_bf16 v[60:63], a[44:47], a[244:247], v[60:63]
  ds_read_b64_tr_b16 a[12:13], v67 offset:0
  v_mfma_f32_16x16x32_bf16 v[60:63], a[60:63], a[252:255], v[60:63]
  ds_read_b64_tr_b16 a[14:15], v67 offset:4096
  buffer_load_dwordx4 a[172:175], v73, s[4:7], s47 offen offset:1024 sc1
  v_mfma_f32_16x16x32_bf16 v[56:59], a[60:63], a[248:251], v[56:59]
  ds_read_b64_tr_b16 a[28:29], v67 offset:8192
  v_mfma_f32_16x16x32_bf16 v[56:59], a[44:47], a[240:243], v[56:59]
  ds_read_b64_tr_b16 a[30:31], v67 offset:12288
  s_sub_u32 s56, s56, 1
  s_cmp_lg_u32 s56, 0
  s_cbranch_scc1 Lp4_loop
  s_waitcnt vmcnt(16) lgkmcnt(8)
  v_mfma_f32_16x16x32_bf16 v[0:3], a[0:3], a[128:131], v[0:3]
  s_barrier
  ds_read_b64_tr_b16 a[32:33], v64 offset:1024
  v_mfma_f32_16x16x32_bf16 v[0:3], a[16:19], a[136:139], v[0:3]
  ds_read_b64_tr_b16 a[34:35], v64 offset:5120
  s_add_u32 m0, s79, 98304
  v_mfma_f32_16x16x32_bf16 v[4:7], a[16:19], a[140:143], v[4:7]
  ds_read_b64_tr_b16 a[48:49], v64 offset:9216
  s_cmp_lg_u32 s88, 0
  s_cselect_b32 s93, -2686976, 0
  s_cselect_b32 s43, s78, 0
  v_mfma_f32_16x16x32_bf16 v[4:7], a[0:3], a[132:135], v[4:7]
  ds_read_b64_tr_b16 a[50:51], v64 offset:13312
  s_add_u32 s93, s93, s43
  v_mfma_f32_16x16x32_bf16 v[12:15], a[4:7], a[132:135], v[12:15]
  ds_read_b64_tr_b16 a[36:37], v65 offset:1024
  v_mfma_f32_16x16x32_bf16 v[12:15], a[20:23], a[140:143], v[12:15]
  ds_read_b64_tr_b16 a[38:39], v65 offset:5120
  s_add_u32 s93, s93, s92
  v_mfma_f32_16x16x32_bf16 v[8:11], a[20:23], a[136:139], v[8:11]
  ds_read_b64_tr_b16 a[52:53], v65 offset:9216
  buffer_load_dwordx4 v252, s[80:83], s93 offen lds
  v_mfma_f32_16x16x32_bf16 v[8:11], a[4:7], a[128:131], v[8:11]
  ds_read_b64_tr_b16 a[54:55], v65 offset:13312
  s_waitcnt lgkmcnt(8)
  v_mfma_f32_16x16x32_bf16 v[16:19], a[8:11], a[128:131], v[16:19]
  ds_read_b64_tr_b16 a[40:41], v66 offset:1024
  buffer_load_dwordx4 v252, s[84:87], s93 offen offset:1024 lds
  v_mfma_f32_16x16x32_bf16 v[16:19], a[24:27], a[136:139], v[16:19]
  ds_read_b64_tr_b16 a[42:43], v66 offset:5120
  s_add_u32 s92, s92, 262144
  v_mfma_f32_16x16x32_bf16 v[20:23], a[24:27], a[140:143], v[20:23]
  ds_read_b64_tr_b16 a[56:57], v66 offset:9216
  s_add_u32 s47, s48, s59
  v_mfma_f32_16x16x32_bf16 v[20:23], a[8:11], a[132:135], v[20:23]
  ds_read_b64_tr_b16 a[58:59], v66 offset:13312
  v_mfma_f32_16x16x32_bf16 v[28:31], a[12:15], a[132:135], v[28:31]
  ds_read_b64_tr_b16 a[44:45], v67 offset:1024
  buffer_load_dwordx4 a[176:179], v72, s[4:7], s47 offen offset:2048 sc1
  v_mfma_f32_16x16x32_bf16 v[28:31], a[28:31], a[140:143], v[28:31]
  ds_read_b64_tr_b16 a[46:47], v67 offset:5120
  buffer_load_dwordx4 a[180:183], v73, s[4:7], s47 offen offset:2048 sc1
  v_mfma_f32_16x16x32_bf16 v[24:27], a[28:31], a[136:139], v[24:27]
  ds_read_b64_tr_b16 a[60:61], v67 offset:9216
  v_mfma_f32_16x16x32_bf16 v[24:27], a[12:15], a[128:131], v[24:27]
  ds_read_b64_tr_b16 a[62:63], v67 offset:13312
  s_waitcnt lgkmcnt(8)
  v_mfma_f32_16x16x32_bf16 v[32:35], a[32:35], a[128:131], v[32:35]
  ds_read_b64_tr_b16 a[0:1], v64 offset:16384
  v_mfma_f32_16x16x32_bf16 v[32:35], a[48:51], a[136:139], v[32:35]
  ds_read_b64_tr_b16 a[2:3], v64 offset:20480
  s_add_u32 m0, s79, 106496
  v_mfma_f32_16x16x32_bf16 v[36:39], a[48:51], a[140:143], v[36:39]
  ds_read_b64_tr_b16 a[16:17], v64 offset:24576
  s_cmp_lg_u32 s89, 0
  s_cselect_b32 s93, -2490368, 0
  s_cselect_b32 s43, s78, 0
  v_mfma_f32_16x16x32_bf16 v[36:39], a[32:35], a[132:135], v[36:39]
  ds_read_b64_tr_b16 a[18:19], v64 offset:28672
  s_add_u32 s93, s93, s43
  v_mfma_f32_16x16x32_bf16 v[44:47], a[36:39], a[132:135], v[44:47]
  ds_read_b64_tr_b16 a[4:5], v65 offset:16384
  s_add_u32 s93, s93, s92
  v_mfma_f32_16x16x32_bf16 v[44:47], a[52:55], a[140:143], v[44:47]
  ds_read_b64_tr_b16 a[6:7], v65 offset:20480
  v_mfma_f32_16x16x32_bf16 v[40:43], a[52:55], a[136:139], v[40:43]
  ds_read_b64_tr_b16 a[20:21], v65 offset:24576
  buffer_load_dwordx4 v252, s[80:83], s93 offen lds
  v_mfma_f32_16x16x32_bf16 v[40:43], a[36:39], a[128:131], v[40:43]
  ds_read_b64_tr_b16 a[22:23], v65 offset:28672
  buffer_load_dwordx4 v252, s[84:87], s93 offen offset:1024 lds
  s_waitcnt lgkmcnt(8)
  v_mfma_f32_16x16x32_bf16 v[48:51], a[40:43], a[128:131], v[48:51]
  ds_read_b64_tr_b16 a[8:9], v66 offset:16384
  s_add_u32 s92, s92, 196608
  v_mfma_f32_16x16x32_bf16 v[48:51], a[56:59], a[136:139], v[48:51]
  ds_read_b64_tr_b16 a[10:11], v66 offset:20480
  s_add_u32 s47, s48, s60
  v_mfma_f32_16x16x32_bf16 v[52:55], a[56:59], a[140:143], v[52:55]
  ds_read_b64_tr_b16 a[24:25], v66 offset:24576
  v_mfma_f32_16x16x32_bf16 v[52:55], a[40:43], a[132:135], v[52:55]
  ds_read_b64_tr_b16 a[26:27], v66 offset:28672
  buffer_load_dwordx4 a[184:187], v72, s[4:7], s47 offen offset:3072 sc1
  v_mfma_f32_16x16x32_bf16 v[60:63], a[44:47], a[132:135], v[60:63]
  ds_read_b64_tr_b16 a[12:13], v67 offset:16384
  buffer_load_dwordx4 a[188:191], v73, s[4:7], s47 offen offset:3072 sc1
  v_mfma_f32_16x16x32_bf16 v[60:63], a[60:63], a[140:143], v[60:63]
  ds_read_b64_tr_b16 a[14:15], v67 offset:20480
  s_add_u32 s48, s48, 4096
  v_mfma_f32_16x16x32_bf16 v[56:59], a[60:63], a[136:139], v[56:59]
  ds_read_b64_tr_b16 a[28:29], v67 offset:24576
  v_mfma_f32_16x16x32_bf16 v[56:59], a[44:47], a[128:131], v[56:59]
  ds_read_b64_tr_b16 a[30:31], v67 offset:28672
  s_waitcnt vmcnt(16) lgkmcnt(8)
  v_mfma_f32_16x16x32_bf16 v[0:3], a[0:3], a[144:147], v[0:3]
  ds_read_b64_tr_b16 a[32:33], v64 offset:17408
  v_mfma_f32_16x16x32_bf16 v[0:3], a[16:19], a[152:155], v[0:3]
  ds_read_b64_tr_b16 a[34:35], v64 offset:21504
  s_add_u32 m0, s79, 114688
  v_mfma_f32_16x16x32_bf16 v[4:7], a[16:19], a[156:159], v[4:7]
  ds_read_b64_tr_b16 a[48:49], v64 offset:25600
  s_cmp_lg_u32 s90, 0
  s_cselect_b32 s93, -2228224, 0
  s_cselect_b32 s43, s78, 0
  v_mfma_f32_16x16x32_bf16 v[4:7], a[0:3], a[148:151], v[4:7]
  ds_read_b64_tr_b16 a[50:51], v64 offset:29696
  s_add_u32 s93, s93, s43
  v_mfma_f32_16x16x32_bf16 v[12:15], a[4:7], a[148:151], v[12:15]
  ds_read_b64_tr_b16 a[36:37], v65 offset:17408
  v_mfma_f32_16x16x32_bf16 v[12:15], a[20:23], a[156:159], v[12:15]
  ds_read_b64_tr_b16 a[38:39], v65 offset:21504
  s_add_u32 s93, s93, s92
  v_mfma_f32_16x16x32_bf16 v[8:11], a[20:23], a[152:155], v[8:11]
  ds_read_b64_tr_b16 a[52:53], v65 offset:25600
  buffer_load_dwordx4 v252, s[80:83], s93 offen lds
  v_mfma_f32_16x16x32_bf16 v[8:11], a[4:7], a[144:147], v[8:11]
  ds_read_b64_tr_b16 a[54:55], v65 offset:29696
  s_waitcnt lgkmcnt(8)
  v_mfma_f32_16x16x32_bf16 v[16:19], a[8:11], a[144:147], v[16:19]
  ds_read_b64_tr_b16 a[40:41], v66 offset:17408
  buffer_load_dwordx4 v252, s[84:87], s93 offen offset:1024 lds
  v_mfma_f32_16x16x32_bf16 v[16:19], a[24:27], a[152:155], v[16:19]
  ds_read_b64_tr_b16 a[42:43], v66 offset:21504
  s_add_u32 s92, s92, 262144
  v_mfma_f32_16x16x32_bf16 v[20:23], a[24:27], a[156:159], v[20:23]
  ds_read_b64_tr_b16 a[56:57], v66 offset:25600
  s_add_u32 s47, s48, s57
  v_mfma_f32_16x16x32_bf16 v[20:23], a[8:11], a[148:151], v[20:23]
  ds_read_b64_tr_b16 a[58:59], v66 offset:29696
  v_mfma_f32_16x16x32_bf16 v[28:31], a[12:15], a[148:151], v[28:31]
  ds_read_b64_tr_b16 a[44:45], v67 offset:17408
  buffer_load_dwordx4 a[192:195], v72, s[4:7], s47 offen offset:0 sc1
  v_mfma_f32_16x16x32_bf16 v[28:31], a[28:31], a[156:159], v[28:31]
  ds_read_b64_tr_b16 a[46:47], v67 offset:21504
  buffer_load_dwordx4 a[196:199], v73, s[4:7], s47 offen offset:0 sc1
  v_mfma_f32_16x16x32_bf16 v[24:27], a[28:31], a[152:155], v[24:27]
  ds_read_b64_tr_b16 a[60:61], v67 offset:25600
  v_mfma_f32_16x16x32_bf16 v[24:27], a[12:15], a[144:147], v[24:27]
  ds_read_b64_tr_b16 a[62:63], v67 offset:29696
  s_waitcnt lgkmcnt(8)
  v_mfma_f32_16x16x32_bf16 v[32:35], a[32:35], a[144:147], v[32:35]
  ds_read_b64_tr_b16 a[0:1], v64 offset:32768
  v_mfma_f32_16x16x32_bf16 v[32:35], a[48:51], a[152:155], v[32:35]
  ds_read_b64_tr_b16 a[2:3], v64 offset:36864
  s_add_u32 m0, s79, 122880
  v_mfma_f32_16x16x32_bf16 v[36:39], a[48:51], a[156:159], v[36:39]
  ds_read_b64_tr_b16 a[16:17], v64 offset:40960
  s_cmp_lg_u32 s91, 0
  s_cselect_b32 s93, -2031616, 0
  s_cselect_b32 s43, s78, 0
  v_mfma_f32_16x16x32_bf16 v[36:39], a[32:35], a[148:151], v[36:39]
  ds_read_b64_tr_b16 a[18:19], v64 offset:45056
  s_add_u32 s93, s93, s43
  v_mfma_f32_16x16x32_bf16 v[44:47], a[36:39], a[148:151], v[44:47]
  ds_read_b64_tr_b16 a[4:5], v65 offset:32768
  v_mfma_f32_16x16x32_bf16 v[44:47], a[52:55], a[156:159], v[44:47]
  ds_read_b64_tr_b16 a[6:7], v65 offset:36864
  s_add_u32 s93, s93, s92
  v_mfma_f32_16x16x32_bf16 v[40:43], a[52:55], a[152:155], v[40:43]
  ds_read_b64_tr_b16 a[20:21], v65 offset:40960
  buffer_load_dwordx4 v252, s[80:83], s93 offen lds
  v_mfma_f32_16x16x32_bf16 v[40:43], a[36:39], a[144:147], v[40:43]
  ds_read_b64_tr_b16 a[22:23], v65 offset:45056
  s_waitcnt lgkmcnt(8)
  v_mfma_f32_16x16x32_bf16 v[48:51], a[40:43], a[144:147], v[48:51]
  ds_read_b64_tr_b16 a[8:9], v66 offset:32768
  buffer_load_dwordx4 v252, s[84:87], s93 offen offset:1024 lds
  v_mfma_f32_16x16x32_bf16 v[48:51], a[56:59], a[152:155], v[48:51]
  ds_read_b64_tr_b16 a[10:11], v66 offset:36864
  s_add_u32 s92, s92, -3407872
  v_mfma_f32_16x16x32_bf16 v[52:55], a[56:59], a[156:159], v[52:55]
  ds_read_b64_tr_b16 a[24:25], v66 offset:40960
  s_add_u32 s47, s48, s58
  v_mfma_f32_16x16x32_bf16 v[52:55], a[40:43], a[148:151], v[52:55]
  ds_read_b64_tr_b16 a[26:27], v66 offset:45056
  v_mfma_f32_16x16x32_bf16 v[60:63], a[44:47], a[148:151], v[60:63]
  ds_read_b64_tr_b16 a[12:13], v67 offset:32768
  buffer_load_dwordx4 a[200:203], v72, s[4:7], s47 offen offset:1024 sc1
  v_mfma_f32_16x16x32_bf16 v[60:63], a[60:63], a[156:159], v[60:63]
  ds_read_b64_tr_b16 a[14:15], v67 offset:36864
  buffer_load_dwordx4 a[204:207], v73, s[4:7], s47 offen offset:1024 sc1
  v_mfma_f32_16x16x32_bf16 v[56:59], a[60:63], a[152:155], v[56:59]
  ds_read_b64_tr_b16 a[28:29], v67 offset:40960
  v_mfma_f32_16x16x32_bf16 v[56:59], a[44:47], a[144:147], v[56:59]
  ds_read_b64_tr_b16 a[30:31], v67 offset:45056
  s_waitcnt vmcnt(16) lgkmcnt(8)
  v_mfma_f32_16x16x32_bf16 v[0:3], a[0:3], a[160:163], v[0:3]
  s_barrier
  ds_read_b64_tr_b16 a[32:33], v64 offset:33792
  v_mfma_f32_16x16x32_bf16 v[0:3], a[16:19], a[168:171], v[0:3]
  ds_read_b64_tr_b16 a[34:35], v64 offset:37888
  s_add_u32 m0, s79, 0
  v_mfma_f32_16x16x32_bf16 v[4:7], a[16:19], a[172:175], v[4:7]
  ds_read_b64_tr_b16 a[48:49], v64 offset:41984
  s_cmp_lg_u32 s88, 0
  s_cselect_b32 s93, 1835008, 0
  v_mfma_f32_16x16x32_bf16 v[4:7], a[0:3], a[164:167], v[4:7]
  ds_read_b64_tr_b16 a[50:51], v64 offset:46080
  s_add_u32 s93, s93, s78
  v_mfma_f32_16x16x32_bf16 v[12:15], a[4:7], a[164:167], v[12:15]
  ds_read_b64_tr_b16 a[36:37], v65 offset:33792
  v_mfma_f32_16x16x32_bf16 v[12:15], a[20:23], a[172:175], v[12:15]
  ds_read_b64_tr_b16 a[38:39], v65 offset:37888
  s_add_u32 s93, s93, s92
  v_mfma_f32_16x16x32_bf16 v[8:11], a[20:23], a[168:171], v[8:11]
  ds_read_b64_tr_b16 a[52:53], v65 offset:41984
  buffer_load_dwordx4 v252, s[80:83], s93 offen lds
  v_mfma_f32_16x16x32_bf16 v[8:11], a[4:7], a[160:163], v[8:11]
  ds_read_b64_tr_b16 a[54:55], v65 offset:46080
  s_waitcnt lgkmcnt(8)
  v_mfma_f32_16x16x32_bf16 v[16:19], a[8:11], a[160:163], v[16:19]
  ds_read_b64_tr_b16 a[40:41], v66 offset:33792
  buffer_load_dwordx4 v252, s[84:87], s93 offen offset:1024 lds
  v_mfma_f32_16x16x32_bf16 v[16:19], a[24:27], a[168:171], v[16:19]
  ds_read_b64_tr_b16 a[42:43], v66 offset:37888
  s_add_u32 s92, s92, 458752
  v_mfma_f32_16x16x32_bf16 v[20:23], a[24:27], a[172:175], v[20:23]
  ds_read_b64_tr_b16 a[56:57], v66 offset:41984
  s_add_u32 s47, s48, s59
  v_mfma_f32_16x16x32_bf16 v[20:23], a[8:11], a[164:167], v[20:23]
  ds_read_b64_tr_b16 a[58:59], v66 offset:46080
  v_mfma_f32_16x16x32_bf16 v[28:31], a[12:15], a[164:167], v[28:31]
  ds_read_b64_tr_b16 a[44:45], v67 offset:33792
  buffer_load_dwordx4 a[208:211], v72, s[4:7], s47 offen offset:2048 sc1
  v_mfma_f32_16x16x32_bf16 v[28:31], a[28:31], a[172:175], v[28:31]
  ds_read_b64_tr_b16 a[46:47], v67 offset:37888
  buffer_load_dwordx4 a[212:215], v73, s[4:7], s47 offen offset:2048 sc1
  v_mfma_f32_16x16x32_bf16 v[24:27], a[28:31], a[168:171], v[24:27]
  ds_read_b64_tr_b16 a[60:61], v67 offset:41984
  v_mfma_f32_16x16x32_bf16 v[24:27], a[12:15], a[160:163], v[24:27]
  ds_read_b64_tr_b16 a[62:63], v67 offset:46080
  s_waitcnt lgkmcnt(8)
  v_mfma_f32_16x16x32_bf16 v[32:35], a[32:35], a[160:163], v[32:35]
  ds_read_b64_tr_b16 a[0:1], v64 offset:49152
  v_mfma_f32_16x16x32_bf16 v[32:35], a[48:51], a[168:171], v[32:35]
  ds_read_b64_tr_b16 a[2:3], v64 offset:53248
  s_add_u32 m0, s79, 8192
  v_mfma_f32_16x16x32_bf16 v[36:39], a[48:51], a[172:175], v[36:39]
  ds_read_b64_tr_b16 a[16:17], v64 offset:57344
  s_cmp_lg_u32 s89, 0
  s_cselect_b32 s93, 1835008, 0
  v_mfma_f32_16x16x32_bf16 v[36:39], a[32:35], a[164:167], v[36:39]
  ds_read_b64_tr_b16 a[18:19], v64 offset:61440
  s_add_u32 s93, s93, s78
  v_mfma_f32_16x16x32_bf16 v[44:47], a[36:39], a[164:167], v[44:47]
  ds_read_b64_tr_b16 a[4:5], v65 offset:49152
  s_add_u32 s93, s93, s92
  v_mfma_f32_16x16x32_bf16 v[44:47], a[52:55], a[172:175], v[44:47]
  ds_read_b64_tr_b16 a[6:7], v65 offset:53248
  v_mfma_f32_16x16x32_bf16 v[40:43], a[52:55], a[168:171], v[40:43]
  ds_read_b64_tr_b16 a[20:21], v65 offset:57344
  buffer_load_dwordx4 v252, s[80:83], s93 offen lds
  v_mfma_f32_16x16x32_bf16 v[40:43], a[36:39], a[160:163], v[40:43]
  ds_read_b64_tr_b16 a[22:23], v65 offset:61440
  buffer_load_dwordx4 v252, s[84:87], s93 offen offset:1024 lds
  s_waitcnt lgkmcnt(8)
  v_mfma_f32_16x16x32_bf16 v[48:51], a[40:43], a[160:163], v[48:51]
  ds_read_b64_tr_b16 a[8:9], v66 offset:49152
  s_add_u32 s92, s92, 458752
  v_mfma_f32_16x16x32_bf16 v[48:51], a[56:59], a[168:171], v[48:51]
  ds_read_b64_tr_b16 a[10:11], v66 offset:53248
  s_add_u32 s47, s48, s60
  v_mfma_f32_16x16x32_bf16 v[52:55], a[56:59], a[172:175], v[52:55]
  ds_read_b64_tr_b16 a[24:25], v66 offset:57344
  v_mfma_f32_16x16x32_bf16 v[52:55], a[40:43], a[164:167], v[52:55]
  ds_read_b64_tr_b16 a[26:27], v66 offset:61440
  buffer_load_dwordx4 a[216:219], v72, s[4:7], s47 offen offset:3072 sc1
  v_mfma_f32_16x16x32_bf16 v[60:63], a[44:47], a[164:167], v[60:63]
  ds_read_b64_tr_b16 a[12:13], v67 offset:49152
  buffer_load_dwordx4 a[220:223], v73, s[4:7], s47 offen offset:3072 sc1
  v_mfma_f32_16x16x32_bf16 v[60:63], a[60:63], a[172:175], v[60:63]
  ds_read_b64_tr_b16 a[14:15], v67 offset:53248
  s_add_u32 s48, s48, 4096
  v_mfma_f32_16x16x32_bf16 v[56:59], a[60:63], a[168:171], v[56:59]
  ds_read_b64_tr_b16 a[28:29], v67 offset:57344
  v_mfma_f32_16x16x32_bf16 v[56:59], a[44:47], a[160:163], v[56:59]
  ds_read_b64_tr_b16 a[30:31], v67 offset:61440
  s_waitcnt vmcnt(16) lgkmcnt(8)
  v_mfma_f32_16x16x32_bf16 v[0:3], a[0:3], a[176:179], v[0:3]
  ds_read_b64_tr_b16 a[32:33], v64 offset:50176
  v_mfma_f32_16x16x32_bf16 v[0:3], a[16:19], a[184:187], v[0:3]
  ds_read_b64_tr_b16 a[34:35], v64 offset:54272
  s_add_u32 m0, s79, 16384
  v_mfma_f32_16x16x32_bf16 v[4:7], a[16:19], a[188:191], v[4:7]
  ds_read_b64_tr_b16 a[48:49], v64 offset:58368
  s_cmp_lg_u32 s90, 0
  s_cselect_b32 s93, 1835008, 0
  v_mfma_f32_16x16x32_bf16 v[4:7], a[0:3], a[180:183], v[4:7]
  ds_read_b64_tr_b16 a[50:51], v64 offset:62464
  s_add_u32 s93, s93, s78
  v_mfma_f32_16x16x32_bf16 v[12:15], a[4:7], a[180:183], v[12:15]
  ds_read_b64_tr_b16 a[36:37], v65 offset:50176
  v_mfma_f32_16x16x32_bf16 v[12:15], a[20:23], a[188:191], v[12:15]
  ds_read_b64_tr_b16 a[38:39], v65 offset:54272
  s_add_u32 s93, s93, s92
  v_mfma_f32_16x16x32_bf16 v[8:11], a[20:23], a[184:187], v[8:11]
  ds_read_b64_tr_b16 a[52:53], v65 offset:58368
  buffer_load_dwordx4 v252, s[80:83], s93 offen lds
  v_mfma_f32_16x16x32_bf16 v[8:11], a[4:7], a[176:179], v[8:11]
  ds_read_b64_tr_b16 a[54:55], v65 offset:62464
  s_waitcnt lgkmcnt(8)
  v_mfma_f32_16x16x32_bf16 v[16:19], a[8:11], a[176:179], v[16:19]
  ds_read_b64_tr_b16 a[40:41], v66 offset:50176
  buffer_load_dwordx4 v252, s[84:87], s93 offen offset:1024 lds
  v_mfma_f32_16x16x32_bf16 v[16:19], a[24:27], a[184:187], v[16:19]
  ds_read_b64_tr_b16 a[42:43], v66 offset:54272
  s_add_u32 s92, s92, 458752
  v_mfma_f32_16x16x32_bf16 v[20:23], a[24:27], a[188:191], v[20:23]
  ds_read_b64_tr_b16 a[56:57], v66 offset:58368
  s_add_u32 s47, s48, s57
  v_mfma_f32_16x16x32_bf16 v[20:23], a[8:11], a[180:183], v[20:23]
  ds_read_b64_tr_b16 a[58:59], v66 offset:62464
  v_mfma_f32_16x16x32_bf16 v[28:31], a[12:15], a[180:183], v[28:31]
  ds_read_b64_tr_b16 a[44:45], v67 offset:50176
  buffer_load_dwordx4 a[224:227], v72, s[4:7], s47 offen offset:0 sc1
  v_mfma_f32_16x16x32_bf16 v[28:31], a[28:31], a[188:191], v[28:31]
  ds_read_b64_tr_b16 a[46:47], v67 offset:54272
  buffer_load_dwordx4 a[228:231], v73, s[4:7], s47 offen offset:0 sc1
  v_mfma_f32_16x16x32_bf16 v[24:27], a[28:31], a[184:187], v[24:27]
  ds_read_b64_tr_b16 a[60:61], v67 offset:58368
  v_mfma_f32_16x16x32_bf16 v[24:27], a[12:15], a[176:179], v[24:27]
  ds_read_b64_tr_b16 a[62:63], v67 offset:62464
  s_waitcnt lgkmcnt(8)
  v_mfma_f32_16x16x32_bf16 v[32:35], a[32:35], a[176:179], v[32:35]
  ds_read_b64_tr_b16 a[0:1], v68 offset:0
  v_mfma_f32_16x16x32_bf16 v[32:35], a[48:51], a[184:187], v[32:35]
  ds_read_b64_tr_b16 a[2:3], v68 offset:4096
  s_add_u32 m0, s79, 24576
  v_mfma_f32_16x16x32_bf16 v[36:39], a[48:51], a[188:191], v[36:39]
  ds_read_b64_tr_b16 a[16:17], v68 offset:8192
  s_cmp_lg_u32 s91, 0
  s_cselect_b32 s93, 1835008, 0
  v_mfma_f32_16x16x32_bf16 v[36:39], a[32:35], a[180:183], v[36:39]
  ds_read_b64_tr_b16 a[18:19], v68 offset:12288
  s_add_u32 s93, s93, s78
  v_mfma_f32_16x16x32_bf16 v[44:47], a[36:39], a[180:183], v[44:47]
  ds_read_b64_tr_b16 a[4:5], v69 offset:0
  v_mfma_f32_16x16x32_bf16 v[44:47], a[52:55], a[188:191], v[44:47]
  ds_read_b64_tr_b16 a[6:7], v69 offset:4096
  s_add_u32 s93, s93, s92
  v_mfma_f32_16x16x32_bf16 v[40:43], a[52:55], a[184:187], v[40:43]
  ds_read_b64_tr_b16 a[20:21], v69 offset:8192
  buffer_load_dwordx4 v252, s[80:83], s93 offen lds
  v_mfma_f32_16x16x32_bf16 v[40:43], a[36:39], a[176:179], v[40:43]
  ds_read_b64_tr_b16 a[22:23], v69 offset:12288
  s_waitcnt lgkmcnt(8)
  v_mfma_f32_16x16x32_bf16 v[48:51], a[40:43], a[176:179], v[48:51]
  ds_read_b64_tr_b16 a[8:9], v70 offset:0
  buffer_load_dwordx4 v252, s[84:87], s93 offen offset:1024 lds
  v_mfma_f32_16x16x32_bf16 v[48:51], a[56:59], a[184:187], v[48:51]
  ds_read_b64_tr_b16 a[10:11], v70 offset:4096
  s_add_u32 s92, s92, 458752
  v_mfma_f32_16x16x32_bf16 v[52:55], a[56:59], a[188:191], v[52:55]
  ds_read_b64_tr_b16 a[24:25], v70 offset:8192
  s_add_u32 s47, s48, s58
  v_mfma_f32_16x16x32_bf16 v[52:55], a[40:43], a[180:183], v[52:55]
  ds_read_b64_tr_b16 a[26:27], v70 offset:12288
  v_mfma_f32_16x16x32_bf16 v[60:63], a[44:47], a[180:183], v[60:63]
  ds_read_b64_tr_b16 a[12:13], v71 offset:0
  buffer_load_dwordx4 a[232:235], v72, s[4:7], s47 offen offset:1024 sc1
  v_mfma_f32_16x16x32_bf16 v[60:63], a[60:63], a[188:191], v[60:63]
  ds_read_b64_tr_b16 a[14:15], v71 offset:4096
  buffer_load_dwordx4 a[236:239], v73, s[4:7], s47 offen offset:1024 sc1
  v_mfma_f32_16x16x32_bf16 v[56:59], a[60:63], a[184:187], v[56:59]
  ds_read_b64_tr_b16 a[28:29], v71 offset:8192
  v_mfma_f32_16x16x32_bf16 v[56:59], a[44:47], a[176:179], v[56:59]
  ds_read_b64_tr_b16 a[30:31], v71 offset:12288
  s_waitcnt vmcnt(16) lgkmcnt(8)
  v_mfma_f32_16x16x32_bf16 v[0:3], a[0:3], a[192:195], v[0:3]
  s_barrier
  ds_read_b64_tr_b16 a[32:33], v68 offset:16384
  v_mfma_f32_16x16x32_bf16 v[0:3], a[16:19], a[200:203], v[0:3]
  ds_read_b64_tr_b16 a[34:35], v68 offset:20480
  s_add_u32 m0, s79, 32768
  s_cmp_lg_u32 s88, 0
  s_cselect_b32 s93, -2031616, 0
  s_cselect_b32 s43, 0, s78
  v_mfma_f32_16x16x32_bf16 v[4:7], a[16:19], a[204:207], v[4:7]
  ds_read_b64_tr_b16 a[48:49], v68 offset:24576
  s_add_u32 s93, s93, s43
  v_mfma_f32_16x16x32_bf16 v[4:7], a[0:3], a[196:199], v[4:7]
  ds_read_b64_tr_b16 a[50:51], v68 offset:28672
  s_add_u32 s93, s93, s92
  buffer_load_dwordx4 v252, s[80:83], s93 offen lds
  v_mfma_f32_16x16x32_bf16 v[12:15], a[4:7], a[196:199], v[12:15]
  ds_read_b64_tr_b16 a[36:37], v69 offset:16384
  buffer_load_dwordx4 v252, s[84:87], s93 offen offset:1024 lds
  v_mfma_f32_16x16x32_bf16 v[12:15], a[20:23], a[204:207], v[12:15]
  ds_read_b64_tr_b16 a[38:39], v69 offset:20480
  s_add_u32 s92, s92, 458752
  s_add_u32 s47, s48, s59
  v_mfma_f32_16x16x32_bf16 v[8:11], a[20:23], a[200:203], v[8:11]
  ds_read_b64_tr_b16 a[52:53], v69 offset:24576
  buffer_load_dwordx4 a[240:243], v72, s[4:7], s47 offen offset:2048 sc1
  v_mfma_f32_16x16x32_bf16 v[8:11], a[4:7], a[192:195], v[8:11]
  ds_read_b64_tr_b16 a[54:55], v69 offset:28672
  buffer_load_dwordx4 a[244:247], v73, s[4:7], s47 offen offset:2048 sc1
  s_add_u32 m0, s79, 40960
  s_waitcnt lgkmcnt(8)
  v_mfma_f32_16x16x32_bf16 v[16:19], a[8:11], a[192:195], v[16:19]
  ds_read_b64_tr_b16 a[40:41], v70 offset:16384
  s_cmp_lg_u32 s89, 0
  s_cselect_b32 s93, -2228224, 0
  s_cselect_b32 s43, 0, s78
  v_mfma_f32_16x16x32_bf16 v[16:19], a[24:27], a[200:203], v[16:19]
  ds_read_b64_tr_b16 a[42:43], v70 offset:20480
  s_add_u32 s93, s93, s43
  s_add_u32 s93, s93, s92
  v_mfma_f32_16x16x32_bf16 v[20:23], a[24:27], a[204:207], v[20:23]
  ds_read_b64_tr_b16 a[56:57], v70 offset:24576
  buffer_load_dwordx4 v252, s[80:83], s93 offen lds
  v_mfma_f32_16x16x32_bf16 v[20:23], a[8:11], a[196:199], v[20:23]
  ds_read_b64_tr_b16 a[58:59], v70 offset:28672
  buffer_load_dwordx4 v252, s[84:87], s93 offen offset:1024 lds
  s_add_u32 s92, s92, 458752
  v_mfma_f32_16x16x32_bf16 v[28:31], a[12:15], a[196:199], v[28:31]
  ds_read_b64_tr_b16 a[44:45], v71 offset:16384
  s_add_u32 s47, s48, s60
  v_mfma_f32_16x16x32_bf16 v[28:31], a[28:31], a[204:207], v[28:31]
  ds_read_b64_tr_b16 a[46:47], v71 offset:20480
  buffer_load_dwordx4 a[248:251], v72, s[4:7], s47 offen offset:3072 sc1
  buffer_load_dwordx4 a[252:255], v73, s[4:7], s47 offen offset:3072 sc1
  v_mfma_f32_16x16x32_bf16 v[24:27], a[28:31], a[200:203], v[24:27]
  ds_read_b64_tr_b16 a[60:61], v71 offset:24576
  s_add_u32 s48, s48, 4096
  v_mfma_f32_16x16x32_bf16 v[24:27], a[12:15], a[192:195], v[24:27]
  ds_read_b64_tr_b16 a[62:63], v71 offset:28672
  s_waitcnt vmcnt(16) lgkmcnt(8)
  v_mfma_f32_16x16x32_bf16 v[0:3], a[32:35], a[208:211], v[0:3]
  ds_read_b64_tr_b16 a[0:1], v68 offset:32768
  v_mfma_f32_16x16x32_bf16 v[0:3], a[48:51], a[216:219], v[0:3]
  ds_read_b64_tr_b16 a[2:3], v68 offset:36864
  s_add_u32 m0, s79, 49152
  s_cmp_lg_u32 s90, 0
  s_cselect_b32 s93, -2490368, 0
  s_cselect_b32 s43, 0, s78
  v_mfma_f32_16x16x32_bf16 v[4:7], a[48:51], a[220:223], v[4:7]
  ds_read_b64_tr_b16 a[16:17], v68 offset:40960
  s_add_u32 s93, s93, s43
  v_mfma_f32_16x16x32_bf16 v[4:7], a[32:35], a[212:215], v[4:7]
  ds_read_b64_tr_b16 a[18:19], v68 offset:45056
  s_add_u32 s93, s93, s92
  buffer_load_dwordx4 v252, s[80:83], s93 offen lds
  v_mfma_f32_16x16x32_bf16 v[12:15], a[36:39], a[212:215], v[12:15]
  ds_read_b64_tr_b16 a[4:5], v69 offset:32768
  buffer_load_dwordx4 v252, s[84:87], s93 offen offset:1024 lds
  v_mfma_f32_16x16x32_bf16 v[12:15], a[52:55], a[220:223], v[12:15]
  ds_read_b64_tr_b16 a[6:7], v69 offset:36864
  s_add_u32 s92, s92, 458752
  v_mfma_f32_16x16x32_bf16 v[8:11], a[52:55], a[216:219], v[8:11]
  ds_read_b64_tr_b16 a[20:21], v69 offset:40960
  s_add_u32 s47, s48, s57
  buffer_load_dwordx4 a[128:131], v72, s[4:7], s47 offen offset:0 sc1
  v_mfma_f32_16x16x32_bf16 v[8:11], a[36:39], a[208:211], v[8:11]
  ds_read_b64_tr_b16 a[22:23], v69 offset:45056
  buffer_load_dwordx4 a[132:135], v73, s[4:7], s47 offen offset:0 sc1
  s_waitcnt lgkmcnt(8)
  v_mfma_f32_16x16x32_bf16 v[16:19], a[40:43], a[208:211], v[16:19]
  ds_read_b64_tr_b16 a[8:9], v70 offset:32768
  s_add_u32 m0, s79, 57344
  v_mfma_f32_16x16x32_bf16 v[16:19], a[56:59], a[216:219], v[16:19]
  ds_read_b64_tr_b16 a[10:11], v70 offset:36864
  s_cmp_lg_u32 s91, 0
  s_cselect_b32 s93, -2686976, 0
  s_cselect_b32 s43, 0, s78
  s_add_u32 s93, s93, s43
  v_mfma_f32_16x16x32_bf16 v[20:23], a[56:59], a[220:223], v[20:23]
  ds_read_b64_tr_b16 a[24:25], v70 offset:40960
  s_add_u32 s93, s93, s92
  v_mfma_f32_16x16x32_bf16 v[20:23], a[40:43], a[212:215], v[20:23]
  ds_read_b64_tr_b16 a[26:27], v70 offset:45056
  buffer_load_dwordx4 v252, s[80:83], s93 offen lds
  v_mfma_f32_16x16x32_bf16 v[28:31], a[44:47], a[212:215], v[28:31]
  ds_read_b64_tr_b16 a[12:13], v71 offset:32768
  buffer_load_dwordx4 v252, s[84:87], s93 offen offset:1024 lds
  s_add_u32 s47, s48, s58
  v_mfma_f32_16x16x32_bf16 v[28:31], a[60:63], a[220:223], v[28:31]
  ds_read_b64_tr_b16 a[14:15], v71 offset:36864
  buffer_load_dwordx4 a[136:139], v72, s[4:7], s47 offen offset:1024 sc1
  v_mfma_f32_16x16x32_bf16 v[24:27], a[60:63], a[216:219], v[24:27]
  ds_read_b64_tr_b16 a[28:29], v71 offset:40960
  buffer_load_dwordx4 a[140:143], v73, s[4:7], s47 offen offset:1024 sc1
  v_mfma_f32_16x16x32_bf16 v[24:27], a[44:47], a[208:211], v[24:27]
  ds_read_b64_tr_b16 a[30:31], v71 offset:45056
  s_waitcnt vmcnt(16) lgkmcnt(8)
  v_mfma_f32_16x16x32_bf16 v[0:3], a[0:3], a[224:227], v[0:3]
  s_barrier
  ds_read_b64_tr_b16 a[32:33], v68 offset:49152
  v_mfma_f32_16x16x32_bf16 v[0:3], a[16:19], a[232:235], v[0:3]
  ds_read_b64_tr_b16 a[34:35], v68 offset:53248
  s_add_u32 s47, s48, s59
  v_mfma_f32_16x16x32_bf16 v[4:7], a[16:19], a[236:239], v[4:7]
  ds_read_b64_tr_b16 a[48:49], v68 offset:57344
  v_mfma_f32_16x16x32_bf16 v[4:7], a[0:3], a[228:231], v[4:7]
  ds_read_b64_tr_b16 a[50:51], v68 offset:61440
  buffer_load_dwordx4 a[144:147], v72, s[4:7], s47 offen offset:2048 sc1
  v_mfma_f32_16x16x32_bf16 v[12:15], a[4:7], a[228:231], v[12:15]
  ds_read_b64_tr_b16 a[36:37], v69 offset:49152
  v_mfma_f32_16x16x32_bf16 v[12:15], a[20:23], a[236:239], v[12:15]
  ds_read_b64_tr_b16 a[38:39], v69 offset:53248
  buffer_load_dwordx4 a[148:151], v73, s[4:7], s47 offen offset:2048 sc1
  v_mfma_f32_16x16x32_bf16 v[8:11], a[20:23], a[232:235], v[8:11]
  ds_read_b64_tr_b16 a[52:53], v69 offset:57344
  v_mfma_f32_16x16x32_bf16 v[8:11], a[4:7], a[224:227], v[8:11]
  ds_read_b64_tr_b16 a[54:55], v69 offset:61440
  s_add_u32 s47, s48, s60
  s_waitcnt lgkmcnt(8)
  v_mfma_f32_16x16x32_bf16 v[16:19], a[8:11], a[224:227], v[16:19]
  ds_read_b64_tr_b16 a[40:41], v70 offset:49152
  v_mfma_f32_16x16x32_bf16 v[16:19], a[24:27], a[232:235], v[16:19]
  ds_read_b64_tr_b16 a[42:43], v70 offset:53248
  buffer_load_dwordx4 a[152:155], v72, s[4:7], s47 offen offset:3072 sc1
  v_mfma_f32_16x16x32_bf16 v[20:23], a[24:27], a[236:239], v[20:23]
  ds_read_b64_tr_b16 a[56:57], v70 offset:57344
  v_mfma_f32_16x16x32_bf16 v[20:23], a[8:11], a[228:231], v[20:23]
  ds_read_b64_tr_b16 a[58:59], v70 offset:61440
  buffer_load_dwordx4 a[156:159], v73, s[4:7], s47 offen offset:3072 sc1
  v_mfma_f32_16x16x32_bf16 v[28:31], a[12:15], a[228:231], v[28:31]
  ds_read_b64_tr_b16 a[44:45], v71 offset:49152
  v_mfma_f32_16x16x32_bf16 v[28:31], a[28:31], a[236:239], v[28:31]
  ds_read_b64_tr_b16 a[46:47], v71 offset:53248
  s_add_u32 s48, s48, 4096
  v_mfma_f32_16x16x32_bf16 v[24:27], a[28:31], a[232:235], v[24:27]
  ds_read_b64_tr_b16 a[60:61], v71 offset:57344
  v_mfma_f32_16x16x32_bf16 v[24:27], a[12:15], a[224:227], v[24:27]
  ds_read_b64_tr_b16 a[62:63], v71 offset:61440
  s_waitcnt vmcnt(12) lgkmcnt(8)
  v_mfma_f32_16x16x32_bf16 v[0:3], a[32:35], a[240:243], v[0:3]
  ds_read_b64_tr_b16 a[0:1], v64 offset:0
  v_mfma_f32_16x16x32_bf16 v[0:3], a[48:51], a[248:251], v[0:3]
  ds_read_b64_tr_b16 a[2:3], v64 offset:4096
  s_mul_i32 s47, s57, -13
  v_mfma_f32_16x16x32_bf16 v[4:7], a[48:51], a[252:255], v[4:7]
  ds_read_b64_tr_b16 a[16:17], v64 offset:8192
  s_add_u32 s47, s47, s48
  v_mfma_f32_16x16x32_bf16 v[4:7], a[32:35], a[244:247], v[4:7]
  ds_read_b64_tr_b16 a[18:19], v64 offset:12288
  v_mfma_f32_16x16x32_bf16 v[12:15], a[36:39], a[244:247], v[12:15]
  ds_read_b64_tr_b16 a[4:5], v65 offset:0
  buffer_load_dwordx4 a[160:163], v72, s[4:7], s47 offen offset:0 sc1
  v_mfma_f32_16x16x32_bf16 v[12:15], a[52:55], a[252:255], v[12:15]
  ds_read_b64_tr_b16 a[6:7], v65 offset:4096
  v_mfma_f32_16x16x32_bf16 v[8:11], a[52:55], a[248:251], v[8:11]
  ds_read_b64_tr_b16 a[20:21], v65 offset:8192
  buffer_load_dwordx4 a[164:167], v73, s[4:7], s47 offen offset:0 sc1
  v_mfma_f32_16x16x32_bf16 v[8:11], a[36:39], a[240:243], v[8:11]
  ds_read_b64_tr_b16 a[22:23], v65 offset:12288
  s_waitcnt lgkmcnt(8)
  v_mfma_f32_16x16x32_bf16 v[16:19], a[40:43], a[240:243], v[16:19]
  ds_read_b64_tr_b16 a[8:9], v66 offset:0
  s_mul_i32 s47, s58, -13
  v_mfma_f32_16x16x32_bf16 v[16:19], a[56:59], a[248:251], v[16:19]
  ds_read_b64_tr_b16 a[10:11], v66 offset:4096
  s_add_u32 s47, s47, s48
  v_mfma_f32_16x16x32_bf16 v[20:23], a[56:59], a[252:255], v[20:23]
  ds_read_b64_tr_b16 a[24:25], v66 offset:8192
  v_mfma_f32_16x16x32_bf16 v[20:23], a[40:43], a[244:247], v[20:23]
  ds_read_b64_tr_b16 a[26:27], v66 offset:12288
  buffer_load_dwordx4 a[168:171], v72, s[4:7], s47 offen offset:1024 sc1
  v_mfma_f32_16x16x32_bf16 v[28:31], a[44:47], a[244:247], v[28:31]
  ds_read_b64_tr_b16 a[12:13], v67 offset:0
  v_mfma_f32_16x16x32_bf16 v[28:31], a[60:63], a[252:255], v[28:31]
  ds_read_b64_tr_b16 a[14:15], v67 offset:4096
  buffer_load_dwordx4 a[172:175], v73, s[4:7], s47 offen offset:1024 sc1
  v_mfma_f32_16x16x32_bf16 v[24:27], a[60:63], a[248:251], v[24:27]
  ds_read_b64_tr_b16 a[28:29], v67 offset:8192
  v_mfma_f32_16x16x32_bf16 v[24:27], a[44:47], a[240:243], v[24:27]
  ds_read_b64_tr_b16 a[30:31], v67 offset:12288
  s_waitcnt vmcnt(8) lgkmcnt(8)
  v_mfma_f32_16x16x32_bf16 v[0:3], a[0:3], a[128:131], v[0:3]
  s_barrier
  ds_read_b64_tr_b16 a[32:33], v64 offset:16384
  v_mfma_f32_16x16x32_bf16 v[0:3], a[16:19], a[136:139], v[0:3]
  ds_read_b64_tr_b16 a[34:35], v64 offset:20480
  s_mul_i32 s47, s59, -13
  v_mfma_f32_16x16x32_bf16 v[4:7], a[16:19], a[140:143], v[4:7]
  ds_read_b64_tr_b16 a[48:49], v64 offset:24576
  s_add_u32 s47, s47, s48
  v_mfma_f32_16x16x32_bf16 v[4:7], a[0:3], a[132:135], v[4:7]
  ds_read_b64_tr_b16 a[50:51], v64 offset:28672
  v_mfma_f32_16x16x32_bf16 v[12:15], a[4:7], a[132:135], v[12:15]
  ds_read_b64_tr_b16 a[36:37], v65 offset:16384
  buffer_load_dwordx4 a[176:179], v72, s[4:7], s47 offen offset:2048 sc1
  v_mfma_f32_16x16x32_bf16 v[12:15], a[20:23], a[140:143], v[12:15]
  ds_read_b64_tr_b16 a[38:39], v65 offset:20480
  buffer_load_dwordx4 a[180:183], v73, s[4:7], s47 offen offset:2048 sc1
  v_mfma_f32_16x16x32_bf16 v[8:11], a[20:23], a[136:139], v[8:11]
  ds_read_b64_tr_b16 a[52:53], v65 offset:24576
  v_mfma_f32_16x16x32_bf16 v[8:11], a[4:7], a[128:131], v[8:11]
  ds_read_b64_tr_b16 a[54:55], v65 offset:28672
  s_mul_i32 s47, s60, -13
  s_waitcnt lgkmcnt(8)
  v_mfma_f32_16x16x32_bf16 v[16:19], a[8:11], a[128:131], v[16:19]
  ds_read_b64_tr_b16 a[40:41], v66 offset:16384
  s_add_u32 s47, s47, s48
  v_mfma_f32_16x16x32_bf16 v[16:19], a[24:27], a[136:139], v[16:19]
  ds_read_b64_tr_b16 a[42:43], v66 offset:20480
  v_mfma_f32_16x16x32_bf16 v[20:23], a[24:27], a[140:143], v[20:23]
  ds_read_b64_tr_b16 a[56:57], v66 offset:24576
  buffer_load_dwordx4 a[184:187], v72, s[4:7], s47 offen offset:3072 sc1
  v_mfma_f32_16x16x32_bf16 v[20:23], a[8:11], a[132:135], v[20:23]
  ds_read_b64_tr_b16 a[58:59], v66 offset:28672
  buffer_load_dwordx4 a[188:191], v73, s[4:7], s47 offen offset:3072 sc1
  v_mfma_f32_16x16x32_bf16 v[28:31], a[12:15], a[132:135], v[28:31]
  ds_read_b64_tr_b16 a[44:45], v67 offset:16384
  v_mfma_f32_16x16x32_bf16 v[28:31], a[28:31], a[140:143], v[28:31]
  ds_read_b64_tr_b16 a[46:47], v67 offset:20480
  s_add_u32 s48, s48, 4096
  v_mfma_f32_16x16x32_bf16 v[24:27], a[28:31], a[136:139], v[24:27]
  ds_read_b64_tr_b16 a[60:61], v67 offset:24576
  v_mfma_f32_16x16x32_bf16 v[24:27], a[12:15], a[128:131], v[24:27]
  ds_read_b64_tr_b16 a[62:63], v67 offset:28672
  s_waitcnt vmcnt(8) lgkmcnt(8)
  v_mfma_f32_16x16x32_bf16 v[0:3], a[32:35], a[144:147], v[0:3]
  ds_read_b64_tr_b16 a[0:1], v64 offset:32768
  v_mfma_f32_16x16x32_bf16 v[0:3], a[48:51], a[152:155], v[0:3]
  ds_read_b64_tr_b16 a[2:3], v64 offset:36864
  v_mfma_f32_16x16x32_bf16 v[4:7], a[48:51], a[156:159], v[4:7]
  ds_read_b64_tr_b16 a[16:17], v64 offset:40960
  v_mfma_f32_16x16x32_bf16 v[4:7], a[32:35], a[148:151], v[4:7]
  ds_read_b64_tr_b16 a[18:19], v64 offset:45056
  v_mfma_f32_16x16x32_bf16 v[12:15], a[36:39], a[148:151], v[12:15]
  ds_read_b64_tr_b16 a[4:5], v65 offset:32768
  v_mfma_f32_16x16x32_bf16 v[12:15], a[52:55], a[156:159], v[12:15]
  ds_read_b64_tr_b16 a[6:7], v65 offset:36864
  v_mfma_f32_16x16x32_bf16 v[8:11], a[52:55], a[152:155], v[8:11]
  ds_read_b64_tr_b16 a[20:21], v65 offset:40960
  v_mfma_f32_16x16x32_bf16 v[8:11], a[36:39], a[144:147], v[8:11]
  ds_read_b64_tr_b16 a[22:23], v65 offset:45056
  s_waitcnt lgkmcnt(8)
  v_mfma_f32_16x16x32_bf16 v[16:19], a[40:43], a[144:147], v[16:19]
  ds_read_b64_tr_b16 a[8:9], v66 offset:32768
  v_mfma_f32_16x16x32_bf16 v[16:19], a[56:59], a[152:155], v[16:19]
  ds_read_b64_tr_b16 a[10:11], v66 offset:36864
  v_mfma_f32_16x16x32_bf16 v[20:23], a[56:59], a[156:159], v[20:23]
  ds_read_b64_tr_b16 a[24:25], v66 offset:40960
  v_mfma_f32_16x16x32_bf16 v[20:23], a[40:43], a[148:151], v[20:23]
  ds_read_b64_tr_b16 a[26:27], v66 offset:45056
  v_mfma_f32_16x16x32_bf16 v[28:31], a[44:47], a[148:151], v[28:31]
  ds_read_b64_tr_b16 a[12:13], v67 offset:32768
  v_mfma_f32_16x16x32_bf16 v[28:31], a[60:63], a[156:159], v[28:31]
  ds_read_b64_tr_b16 a[14:15], v67 offset:36864
  v_mfma_f32_16x16x32_bf16 v[24:27], a[60:63], a[152:155], v[24:27]
  ds_read_b64_tr_b16 a[28:29], v67 offset:40960
  v_mfma_f32_16x16x32_bf16 v[24:27], a[44:47], a[144:147], v[24:27]
  ds_read_b64_tr_b16 a[30:31], v67 offset:45056
  s_waitcnt vmcnt(4) lgkmcnt(8)
  v_mfma_f32_16x16x32_bf16 v[0:3], a[0:3], a[160:163], v[0:3]
  s_barrier
  ds_read_b64_tr_b16 a[32:33], v64 offset:49152
  v_mfma_f32_16x16x32_bf16 v[0:3], a[16:19], a[168:171], v[0:3]
  ds_read_b64_tr_b16 a[34:35], v64 offset:53248
  v_mfma_f32_16x16x32_bf16 v[4:7], a[16:19], a[172:175], v[4:7]
  ds_read_b64_tr_b16 a[48:49], v64 offset:57344
  v_mfma_f32_16x16x32_bf16 v[4:7], a[0:3], a[164:167], v[4:7]
  ds_read_b64_tr_b16 a[50:51], v64 offset:61440
  v_mfma_f32_16x16x32_bf16 v[12:15], a[4:7], a[164:167], v[12:15]
  ds_read_b64_tr_b16 a[36:37], v65 offset:49152
  v_mfma_f32_16x16x32_bf16 v[12:15], a[20:23], a[172:175], v[12:15]
  ds_read_b64_tr_b16 a[38:39], v65 offset:53248
  v_mfma_f32_16x16x32_bf16 v[8:11], a[20:23], a[168:171], v[8:11]
  ds_read_b64_tr_b16 a[52:53], v65 offset:57344
  v_mfma_f32_16x16x32_bf16 v[8:11], a[4:7], a[160:163], v[8:11]
  ds_read_b64_tr_b16 a[54:55], v65 offset:61440
  s_waitcnt lgkmcnt(8)
  v_mfma_f32_16x16x32_bf16 v[16:19], a[8:11], a[160:163], v[16:19]
  ds_read_b64_tr_b16 a[40:41], v66 offset:49152
  v_mfma_f32_16x16x32_bf16 v[16:19], a[24:27], a[168:171], v[16:19]
  ds_read_b64_tr_b16 a[42:43], v66 offset:53248
  v_mfma_f32_16x16x32_bf16 v[20:23], a[24:27], a[172:175], v[20:23]
  ds_read_b64_tr_b16 a[56:57], v66 offset:57344
  v_mfma_f32_16x16x32_bf16 v[20:23], a[8:11], a[164:167], v[20:23]
  ds_read_b64_tr_b16 a[58:59], v66 offset:61440
  v_mfma_f32_16x16x32_bf16 v[28:31], a[12:15], a[164:167], v[28:31]
  ds_read_b64_tr_b16 a[44:45], v67 offset:49152
  v_mfma_f32_16x16x32_bf16 v[28:31], a[28:31], a[172:175], v[28:31]
  ds_read_b64_tr_b16 a[46:47], v67 offset:53248
  v_mfma_f32_16x16x32_bf16 v[24:27], a[28:31], a[168:171], v[24:27]
  ds_read_b64_tr_b16 a[60:61], v67 offset:57344
  v_mfma_f32_16x16x32_bf16 v[24:27], a[12:15], a[160:163], v[24:27]
  ds_read_b64_tr_b16 a[62:63], v67 offset:61440
  s_waitcnt vmcnt(0) lgkmcnt(8)
  v_mfma_f32_16x16x32_bf16 v[0:3], a[32:35], a[176:179], v[0:3]
  ds_read_b64_tr_b16 a[0:1], v68 offset:1024
  v_mfma_f32_16x16x32_bf16 v[0:3], a[48:51], a[184:187], v[0:3]
  ds_read_b64_tr_b16 a[2:3], v68 offset:5120
  v_mfma_f32_16x16x32_bf16 v[4:7], a[48:51], a[188:191], v[4:7]
  ds_read_b64_tr_b16 a[16:17], v68 offset:9216
  v_mfma_f32_16x16x32_bf16 v[4:7], a[32:35], a[180:183], v[4:7]
  ds_read_b64_tr_b16 a[18:19], v68 offset:13312
  v_mfma_f32_16x16x32_bf16 v[12:15], a[36:39], a[180:183], v[12:15]
  ds_read_b64_tr_b16 a[4:5], v69 offset:1024
  v_mfma_f32_16x16x32_bf16 v[12:15], a[52:55], a[188:191], v[12:15]
  ds_read_b64_tr_b16 a[6:7], v69 offset:5120
  v_mfma_f32_16x16x32_bf16 v[8:11], a[52:55], a[184:187], v[8:11]
  ds_read_b64_tr_b16 a[20:21], v69 offset:9216
  v_mfma_f32_16x16x32_bf16 v[8:11], a[36:39], a[176:179], v[8:11]
  ds_read_b64_tr_b16 a[22:23], v69 offset:13312
  s_waitcnt lgkmcnt(8)
  v_mfma_f32_16x16x32_bf16 v[16:19], a[40:43], a[176:179], v[16:19]
  ds_read_b64_tr_b16 a[8:9], v70 offset:1024
  v_mfma_f32_16x16x32_bf16 v[16:19], a[56:59], a[184:187], v[16:19]
  ds_read_b64_tr_b16 a[10:11], v70 offset:5120
  v_mfma_f32_16x16x32_bf16 v[20:23], a[56:59], a[188:191], v[20:23]
  ds_read_b64_tr_b16 a[24:25], v70 offset:9216
  v_mfma_f32_16x16x32_bf16 v[20:23], a[40:43], a[180:183], v[20:23]
  ds_read_b64_tr_b16 a[26:27], v70 offset:13312
  v_mfma_f32_16x16x32_bf16 v[28:31], a[44:47], a[180:183], v[28:31]
  ds_read_b64_tr_b16 a[12:13], v71 offset:1024
  v_mfma_f32_16x16x32_bf16 v[28:31], a[60:63], a[188:191], v[28:31]
  ds_read_b64_tr_b16 a[14:15], v71 offset:5120
  v_mfma_f32_16x16x32_bf16 v[24:27], a[60:63], a[184:187], v[24:27]
  ds_read_b64_tr_b16 a[28:29], v71 offset:9216
  v_mfma_f32_16x16x32_bf16 v[24:27], a[44:47], a[176:179], v[24:27]
  ds_read_b64_tr_b16 a[30:31], v71 offset:13312
  s_waitcnt lgkmcnt(8)
  v_mfma_f32_16x16x32_bf16 v[32:35], a[0:3], a[192:195], v[32:35]
  ds_read_b64_tr_b16 a[32:33], v68 offset:17408
  s_lshl_b32 s45, s2, 2
  s_add_u32 s45, s45, s40
  v_mfma_f32_16x16x32_bf16 v[32:35], a[16:19], a[200:203], v[32:35]
  ds_read_b64_tr_b16 a[34:35], v68 offset:21504
  s_lshl_b32 s45, s45, 12
  s_xor_b32 s44, s45, 524288
  v_mfma_f32_16x16x32_bf16 v[36:39], a[16:19], a[204:207], v[36:39]
  ds_read_b64_tr_b16 a[48:49], v68 offset:25600
  s_add_u32 s43, s42, 28311552
  s_add_u32 s44, s44, s43
  v_mfma_f32_16x16x32_bf16 v[36:39], a[0:3], a[196:199], v[36:39]
  ds_read_b64_tr_b16 a[50:51], v68 offset:29696
  s_add_u32 s45, s45, s43
  v_cvt_pk_bf16_f32 v76, v0, v1
  v_mfma_f32_16x16x32_bf16 v[44:47], a[4:7], a[196:199], v[44:47]
  ds_read_b64_tr_b16 a[36:37], v69 offset:17408
  v_cvt_pk_bf16_f32 v77, v2, v3
  v_cvt_pk_bf16_f32 v78, v8, v9
  v_mfma_f32_16x16x32_bf16 v[44:47], a[20:23], a[204:207], v[44:47]
  ds_read_b64_tr_b16 a[38:39], v69 offset:21504
  v_cvt_pk_bf16_f32 v79, v10, v11
  buffer_store_dwordx4 v[76:79], v72, s[4:7], s44 offen offset:0 sc1
  v_mfma_f32_16x16x32_bf16 v[40:43], a[20:23], a[200:203], v[40:43]
  ds_read_b64_tr_b16 a[52:53], v69 offset:25600
  v_cvt_pk_bf16_f32 v84, v4, v5
  v_cvt_pk_bf16_f32 v85, v6, v7
  v_mfma_f32_16x16x32_bf16 v[40:43], a[4:7], a[192:195], v[40:43]
  ds_read_b64_tr_b16 a[54:55], v69 offset:29696
  v_cvt_pk_bf16_f32 v86, v12, v13
  v_cvt_pk_bf16_f32 v87, v14, v15
  s_waitcnt lgkmcnt(8)
  v_mfma_f32_16x16x32_bf16 v[48:51], a[8:11], a[192:195], v[48:51]
  ds_read_b64_tr_b16 a[40:41], v70 offset:17408
  buffer_store_dwordx4 v[84:87], v72, s[4:7], s44 offen offset:2048 sc1
  v_cvt_pk_bf16_f32 v80, v16, v17
  v_mfma_f32_16x16x32_bf16 v[48:51], a[24:27], a[200:203], v[48:51]
  ds_read_b64_tr_b16 a[42:43], v70 offset:21504
  v_cvt_pk_bf16_f32 v81, v18, v19
  v_cvt_pk_bf16_f32 v82, v24, v25
  v_mfma_f32_16x16x32_bf16 v[52:55], a[24:27], a[204:207], v[52:55]
  ds_read_b64_tr_b16 a[56:57], v70 offset:25600
  v_cvt_pk_bf16_f32 v83, v26, v27
  buffer_store_dwordx4 v[80:83], v72, s[4:7], s44 offen offset:1024 sc1
  v_mfma_f32_16x16x32_bf16 v[52:55], a[8:11], a[196:199], v[52:55]
  ds_read_b64_tr_b16 a[58:59], v70 offset:29696
  v_cvt_pk_bf16_f32 v88, v20, v21
  v_cvt_pk_bf16_f32 v89, v22, v23
  v_mfma_f32_16x16x32_bf16 v[60:63], a[12:15], a[196:199], v[60:63]
  ds_read_b64_tr_b16 a[44:45], v71 offset:17408
  v_cvt_pk_bf16_f32 v90, v28, v29
  v_cvt_pk_bf16_f32 v91, v30, v31
  v_mfma_f32_16x16x32_bf16 v[60:63], a[28:31], a[204:207], v[60:63]
  ds_read_b64_tr_b16 a[46:47], v71 offset:21504
  buffer_store_dwordx4 v[88:91], v72, s[4:7], s44 offen offset:3072 sc1
  v_mfma_f32_16x16x32_bf16 v[56:59], a[28:31], a[200:203], v[56:59]
  ds_read_b64_tr_b16 a[60:61], v71 offset:25600
  v_mfma_f32_16x16x32_bf16 v[56:59], a[12:15], a[192:195], v[56:59]
  ds_read_b64_tr_b16 a[62:63], v71 offset:29696
  s_waitcnt lgkmcnt(8)
  v_mfma_f32_16x16x32_bf16 v[32:35], a[32:35], a[208:211], v[32:35]
  ds_read_b64_tr_b16 a[0:1], v68 offset:33792
  v_mfma_f32_16x16x32_bf16 v[32:35], a[48:51], a[216:219], v[32:35]
  ds_read_b64_tr_b16 a[2:3], v68 offset:37888
  v_mfma_f32_16x16x32_bf16 v[36:39], a[48:51], a[220:223], v[36:39]
  ds_read_b64_tr_b16 a[16:17], v68 offset:41984
  v_mfma_f32_16x16x32_bf16 v[36:39], a[32:35], a[212:215], v[36:39]
  ds_read_b64_tr_b16 a[18:19], v68 offset:46080
  v_mfma_f32_16x16x32_bf16 v[44:47], a[36:39], a[212:215], v[44:47]
  ds_read_b64_tr_b16 a[4:5], v69 offset:33792
  v_mfma_f32_16x16x32_bf16 v[44:47], a[52:55], a[220:223], v[44:47]
  ds_read_b64_tr_b16 a[6:7], v69 offset:37888
  v_mfma_f32_16x16x32_bf16 v[40:43], a[52:55], a[216:219], v[40:43]
  ds_read_b64_tr_b16 a[20:21], v69 offset:41984
  v_mfma_f32_16x16x32_bf16 v[40:43], a[36:39], a[208:211], v[40:43]
  ds_read_b64_tr_b16 a[22:23], v69 offset:46080
  s_waitcnt lgkmcnt(8)
  v_mfma_f32_16x16x32_bf16 v[48:51], a[40:43], a[208:211], v[48:51]
  ds_read_b64_tr_b16 a[8:9], v70 offset:33792
  v_mfma_f32_16x16x32_bf16 v[48:51], a[56:59], a[216:219], v[48:51]
  ds_read_b64_tr_b16 a[10:11], v70 offset:37888
  v_mfma_f32_16x16x32_bf16 v[52:55], a[56:59], a[220:223], v[52:55]
  ds_read_b64_tr_b16 a[24:25], v70 offset:41984
  v_mfma_f32_16x16x32_bf16 v[52:55], a[40:43], a[212:215], v[52:55]
  ds_read_b64_tr_b16 a[26:27], v70 offset:46080
  v_mfma_f32_16x16x32_bf16 v[60:63], a[44:47], a[212:215], v[60:63]
  ds_read_b64_tr_b16 a[12:13], v71 offset:33792
  v_mfma_f32_16x16x32_bf16 v[60:63], a[60:63], a[220:223], v[60:63]
  ds_read_b64_tr_b16 a[14:15], v71 offset:37888
  v_mfma_f32_16x16x32_bf16 v[56:59], a[60:63], a[216:219], v[56:59]
  ds_read_b64_tr_b16 a[28:29], v71 offset:41984
  v_mfma_f32_16x16x32_bf16 v[56:59], a[44:47], a[208:211], v[56:59]
  ds_read_b64_tr_b16 a[30:31], v71 offset:46080
  s_waitcnt lgkmcnt(8)
  v_mfma_f32_16x16x32_bf16 v[32:35], a[0:3], a[224:227], v[32:35]
  ds_read_b64_tr_b16 a[32:33], v68 offset:50176
  v_mfma_f32_16x16x32_bf16 v[32:35], a[16:19], a[232:235], v[32:35]
  ds_read_b64_tr_b16 a[34:35], v68 offset:54272
  v_mfma_f32_16x16x32_bf16 v[36:39], a[16:19], a[236:239], v[36:39]
  ds_read_b64_tr_b16 a[48:49], v68 offset:58368
  v_mfma_f32_16x16x32_bf16 v[36:39], a[0:3], a[228:231], v[36:39]
  ds_read_b64_tr_b16 a[50:51], v68 offset:62464
  v_mfma_f32_16x16x32_bf16 v[44:47], a[4:7], a[228:231], v[44:47]
  ds_read_b64_tr_b16 a[36:37], v69 offset:50176
  v_mfma_f32_16x16x32_bf16 v[44:47], a[20:23], a[236:239], v[44:47]
  ds_read_b64_tr_b16 a[38:39], v69 offset:54272
  v_mfma_f32_16x16x32_bf16 v[40:43], a[20:23], a[232:235], v[40:43]
  ds_read_b64_tr_b16 a[52:53], v69 offset:58368
  v_mfma_f32_16x16x32_bf16 v[40:43], a[4:7], a[224:227], v[40:43]
  ds_read_b64_tr_b16 a[54:55], v69 offset:62464
  s_waitcnt lgkmcnt(8)
  v_mfma_f32_16x16x32_bf16 v[48:51], a[8:11], a[224:227], v[48:51]
  ds_read_b64_tr_b16 a[40:41], v70 offset:50176
  v_mfma_f32_16x16x32_bf16 v[48:51], a[24:27], a[232:235], v[48:51]
  ds_read_b64_tr_b16 a[42:43], v70 offset:54272
  v_mfma_f32_16x16x32_bf16 v[52:55], a[24:27], a[236:239], v[52:55]
  ds_read_b64_tr_b16 a[56:57], v70 offset:58368
  v_mfma_f32_16x16x32_bf16 v[52:55], a[8:11], a[228:231], v[52:55]
  ds_read_b64_tr_b16 a[58:59], v70 offset:62464
  v_mfma_f32_16x16x32_bf16 v[60:63], a[12:15], a[228:231], v[60:63]
  ds_read_b64_tr_b16 a[44:45], v71 offset:50176
  v_mfma_f32_16x16x32_bf16 v[60:63], a[28:31], a[236:239], v[60:63]
  ds_read_b64_tr_b16 a[46:47], v71 offset:54272
  v_mfma_f32_16x16x32_bf16 v[56:59], a[28:31], a[232:235], v[56:59]
  ds_read_b64_tr_b16 a[60:61], v71 offset:58368
  v_mfma_f32_16x16x32_bf16 v[56:59], a[12:15], a[224:227], v[56:59]
  ds_read_b64_tr_b16 a[62:63], v71 offset:62464
  s_waitcnt lgkmcnt(8)
  v_mfma_f32_16x16x32_bf16 v[32:35], a[32:35], a[240:243], v[32:35]
  ds_read_b64_tr_b16 a[0:1], v64 offset:1024
  v_mfma_f32_16x16x32_bf16 v[32:35], a[48:51], a[248:251], v[32:35]
  ds_read_b64_tr_b16 a[2:3], v64 offset:5120
  v_mfma_f32_16x16x32_bf16 v[36:39], a[48:51], a[252:255], v[36:39]
  ds_read_b64_tr_b16 a[16:17], v64 offset:9216
  v_mfma_f32_16x16x32_bf16 v[36:39], a[32:35], a[244:247], v[36:39]
  ds_read_b64_tr_b16 a[18:19], v64 offset:13312
  v_mfma_f32_16x16x32_bf16 v[44:47], a[36:39], a[244:247], v[44:47]
  ds_read_b64_tr_b16 a[4:5], v65 offset:1024
  v_mfma_f32_16x16x32_bf16 v[44:47], a[52:55], a[252:255], v[44:47]
  ds_read_b64_tr_b16 a[6:7], v65 offset:5120
  v_mfma_f32_16x16x32_bf16 v[40:43], a[52:55], a[248:251], v[40:43]
  ds_read_b64_tr_b16 a[20:21], v65 offset:9216
  v_mfma_f32_16x16x32_bf16 v[40:43], a[36:39], a[240:243], v[40:43]
  ds_read_b64_tr_b16 a[22:23], v65 offset:13312
  s_waitcnt lgkmcnt(8)
  v_mfma_f32_16x16x32_bf16 v[48:51], a[40:43], a[240:243], v[48:51]
  ds_read_b64_tr_b16 a[8:9], v66 offset:1024
  v_mfma_f32_16x16x32_bf16 v[48:51], a[56:59], a[248:251], v[48:51]
  ds_read_b64_tr_b16 a[10:11], v66 offset:5120
  v_mfma_f32_16x16x32_bf16 v[52:55], a[56:59], a[252:255], v[52:55]
  ds_read_b64_tr_b16 a[24:25], v66 offset:9216
  v_mfma_f32_16x16x32_bf16 v[52:55], a[40:43], a[244:247], v[52:55]
  ds_read_b64_tr_b16 a[26:27], v66 offset:13312
  v_mfma_f32_16x16x32_bf16 v[60:63], a[44:47], a[244:247], v[60:63]
  ds_read_b64_tr_b16 a[12:13], v67 offset:1024
  v_mfma_f32_16x16x32_bf16 v[60:63], a[60:63], a[252:255], v[60:63]
  ds_read_b64_tr_b16 a[14:15], v67 offset:5120
  v_mfma_f32_16x16x32_bf16 v[56:59], a[60:63], a[248:251], v[56:59]
  ds_read_b64_tr_b16 a[28:29], v67 offset:9216
  v_mfma_f32_16x16x32_bf16 v[56:59], a[44:47], a[240:243], v[56:59]
  ds_read_b64_tr_b16 a[30:31], v67 offset:13312
  s_waitcnt lgkmcnt(8)
  v_mfma_f32_16x16x32_bf16 v[32:35], a[0:3], a[128:131], v[32:35]
  ds_read_b64_tr_b16 a[32:33], v64 offset:17408
  v_mfma_f32_16x16x32_bf16 v[32:35], a[16:19], a[136:139], v[32:35]
  ds_read_b64_tr_b16 a[34:35], v64 offset:21504
  v_mfma_f32_16x16x32_bf16 v[36:39], a[16:19], a[140:143], v[36:39]
  ds_read_b64_tr_b16 a[48:49], v64 offset:25600
  v_mfma_f32_16x16x32_bf16 v[36:39], a[0:3], a[132:135], v[36:39]
  ds_read_b64_tr_b16 a[50:51], v64 offset:29696
  v_mfma_f32_16x16x32_bf16 v[44:47], a[4:7], a[132:135], v[44:47]
  ds_read_b64_tr_b16 a[36:37], v65 offset:17408
  v_mfma_f32_16x16x32_bf16 v[44:47], a[20:23], a[140:143], v[44:47]
  ds_read_b64_tr_b16 a[38:39], v65 offset:21504
  v_mfma_f32_16x16x32_bf16 v[40:43], a[20:23], a[136:139], v[40:43]
  ds_read_b64_tr_b16 a[52:53], v65 offset:25600
  v_mfma_f32_16x16x32_bf16 v[40:43], a[4:7], a[128:131], v[40:43]
  ds_read_b64_tr_b16 a[54:55], v65 offset:29696
  s_waitcnt lgkmcnt(8)
  v_mfma_f32_16x16x32_bf16 v[48:51], a[8:11], a[128:131], v[48:51]
  ds_read_b64_tr_b16 a[40:41], v66 offset:17408
  v_mfma_f32_16x16x32_bf16 v[48:51], a[24:27], a[136:139], v[48:51]
  ds_read_b64_tr_b16 a[42:43], v66 offset:21504
  v_mfma_f32_16x16x32_bf16 v[52:55], a[24:27], a[140:143], v[52:55]
  ds_read_b64_tr_b16 a[56:57], v66 offset:25600
  v_mfma_f32_16x16x32_bf16 v[52:55], a[8:11], a[132:135], v[52:55]
  ds_read_b64_tr_b16 a[58:59], v66 offset:29696
  v_mfma_f32_16x16x32_bf16 v[60:63], a[12:15], a[132:135], v[60:63]
  ds_read_b64_tr_b16 a[44:45], v67 offset:17408
  v_mfma_f32_16x16x32_bf16 v[60:63], a[28:31], a[140:143], v[60:63]
  ds_read_b64_tr_b16 a[46:47], v67 offset:21504
  v_mfma_f32_16x16x32_bf16 v[56:59], a[28:31], a[136:139], v[56:59]
  ds_read_b64_tr_b16 a[60:61], v67 offset:25600
  v_mfma_f32_16x16x32_bf16 v[56:59], a[12:15], a[128:131], v[56:59]
  ds_read_b64_tr_b16 a[62:63], v67 offset:29696
  s_waitcnt lgkmcnt(8)
  v_mfma_f32_16x16x32_bf16 v[32:35], a[32:35], a[144:147], v[32:35]
  ds_read_b64_tr_b16 a[0:1], v64 offset:33792
  buffer_load_dwordx4 v[96:99], v72, s[4:7], s45 offen offset:0 sc1
  v_mfma_f32_16x16x32_bf16 v[32:35], a[48:51], a[152:155], v[32:35]
  ds_read_b64_tr_b16 a[2:3], v64 offset:37888
  v_mfma_f32_16x16x32_bf16 v[36:39], a[48:51], a[156:159], v[36:39]
  ds_read_b64_tr_b16 a[16:17], v64 offset:41984
  buffer_load_dwordx4 v[100:103], v72, s[4:7], s45 offen offset:1024 sc1
  v_mfma_f32_16x16x32_bf16 v[36:39], a[32:35], a[148:151], v[36:39]
  ds_read_b64_tr_b16 a[18:19], v64 offset:46080
  v_mfma_f32_16x16x32_bf16 v[44:47], a[36:39], a[148:151], v[44:47]
  ds_read_b64_tr_b16 a[4:5], v65 offset:33792
  buffer_load_dwordx4 v[104:107], v72, s[4:7], s45 offen offset:2048 sc1
  v_mfma_f32_16x16x32_bf16 v[44:47], a[52:55], a[156:159], v[44:47]
  ds_read_b64_tr_b16 a[6:7], v65 offset:37888
  v_mfma_f32_16x16x32_bf16 v[40:43], a[52:55], a[152:155], v[40:43]
  ds_read_b64_tr_b16 a[20:21], v65 offset:41984
  buffer_load_dwordx4 v[108:111], v72, s[4:7], s45 offen offset:3072 sc1
  v_mfma_f32_16x16x32_bf16 v[40:43], a[36:39], a[144:147], v[40:43]
  ds_read_b64_tr_b16 a[22:23], v65 offset:46080
  s_waitcnt lgkmcnt(8)
  v_mfma_f32_16x16x32_bf16 v[48:51], a[40:43], a[144:147], v[48:51]
  ds_read_b64_tr_b16 a[8:9], v66 offset:33792
  v_mfma_f32_16x16x32_bf16 v[48:51], a[56:59], a[152:155], v[48:51]
  ds_read_b64_tr_b16 a[10:11], v66 offset:37888
  v_mfma_f32_16x16x32_bf16 v[52:55], a[56:59], a[156:159], v[52:55]
  ds_read_b64_tr_b16 a[24:25], v66 offset:41984
  v_mfma_f32_16x16x32_bf16 v[52:55], a[40:43], a[148:151], v[52:55]
  ds_read_b64_tr_b16 a[26:27], v66 offset:46080
  v_mfma_f32_16x16x32_bf16 v[60:63], a[44:47], a[148:151], v[60:63]
  ds_read_b64_tr_b16 a[12:13], v67 offset:33792
  v_mfma_f32_16x16x32_bf16 v[60:63], a[60:63], a[156:159], v[60:63]
  ds_read_b64_tr_b16 a[14:15], v67 offset:37888
  v_mfma_f32_16x16x32_bf16 v[56:59], a[60:63], a[152:155], v[56:59]
  ds_read_b64_tr_b16 a[28:29], v67 offset:41984
  v_mfma_f32_16x16x32_bf16 v[56:59], a[44:47], a[144:147], v[56:59]
  ds_read_b64_tr_b16 a[30:31], v67 offset:46080
  s_waitcnt lgkmcnt(8)
  v_mfma_f32_16x16x32_bf16 v[32:35], a[0:3], a[160:163], v[32:35]
  ds_read_b64_tr_b16 a[32:33], v64 offset:50176
  v_mfma_f32_16x16x32_bf16 v[32:35], a[16:19], a[168:171], v[32:35]
  ds_read_b64_tr_b16 a[34:35], v64 offset:54272
  v_mfma_f32_16x16x32_bf16 v[36:39], a[16:19], a[172:175], v[36:39]
  ds_read_b64_tr_b16 a[48:49], v64 offset:58368
  v_mfma_f32_16x16x32_bf16 v[36:39], a[0:3], a[164:167], v[36:39]
  ds_read_b64_tr_b16 a[50:51], v64 offset:62464
  v_mfma_f32_16x16x32_bf16 v[44:47], a[4:7], a[164:167], v[44:47]
  ds_read_b64_tr_b16 a[36:37], v65 offset:50176
  v_mfma_f32_16x16x32_bf16 v[44:47], a[20:23], a[172:175], v[44:47]
  ds_read_b64_tr_b16 a[38:39], v65 offset:54272
  v_mfma_f32_16x16x32_bf16 v[40:43], a[20:23], a[168:171], v[40:43]
  ds_read_b64_tr_b16 a[52:53], v65 offset:58368
  v_mfma_f32_16x16x32_bf16 v[40:43], a[4:7], a[160:163], v[40:43]
  ds_read_b64_tr_b16 a[54:55], v65 offset:62464
  s_waitcnt lgkmcnt(8)
  v_mfma_f32_16x16x32_bf16 v[48:51], a[8:11], a[160:163], v[48:51]
  ds_read_b64_tr_b16 a[40:41], v66 offset:50176
  v_mfma_f32_16x16x32_bf16 v[48:51], a[24:27], a[168:171], v[48:51]
  ds_read_b64_tr_b16 a[42:43], v66 offset:54272
  v_mfma_f32_16x16x32_bf16 v[52:55], a[24:27], a[172:175], v[52:55]
  ds_read_b64_tr_b16 a[56:57], v66 offset:58368
  v_mfma_f32_16x16x32_bf16 v[52:55], a[8:11], a[164:167], v[52:55]
  ds_read_b64_tr_b16 a[58:59], v66 offset:62464
  v_mfma_f32_16x16x32_bf16 v[60:63], a[12:15], a[164:167], v[60:63]
  ds_read_b64_tr_b16 a[44:45], v67 offset:50176
  v_mfma_f32_16x16x32_bf16 v[60:63], a[28:31], a[172:175], v[60:63]
  ds_read_b64_tr_b16 a[46:47], v67 offset:54272
  v_mfma_f32_16x16x32_bf16 v[56:59], a[28:31], a[168:171], v[56:59]
  ds_read_b64_tr_b16 a[60:61], v67 offset:58368
  v_mfma_f32_16x16x32_bf16 v[56:59], a[12:15], a[160:163], v[56:59]
  ds_read_b64_tr_b16 a[62:63], v67 offset:62464
  s_waitcnt lgkmcnt(8)
  v_mfma_f32_16x16x32_bf16 v[32:35], a[32:35], a[176:179], v[32:35]
  v_mfma_f32_16x16x32_bf16 v[32:35], a[48:51], a[184:187], v[32:35]
  v_mfma_f32_16x16x32_bf16 v[36:39], a[48:51], a[188:191], v[36:39]
  v_mfma_f32_16x16x32_bf16 v[36:39], a[32:35], a[180:183], v[36:39]
  v_mfma_f32_16x16x32_bf16 v[44:47], a[36:39], a[180:183], v[44:47]
  v_mfma_f32_16x16x32_bf16 v[44:47], a[52:55], a[188:191], v[44:47]
  v_mfma_f32_16x16x32_bf16 v[40:43], a[52:55], a[184:187], v[40:43]
  v_mfma_f32_16x16x32_bf16 v[40:43], a[36:39], a[176:179], v[40:43]
  s_waitcnt lgkmcnt(0)
  v_mfma_f32_16x16x32_bf16 v[48:51], a[40:43], a[176:179], v[48:51]
  v_mfma_f32_16x16x32_bf16 v[48:51], a[56:59], a[184:187], v[48:51]
  s_barrier
  v_mfma_f32_16x16x32_bf16 v[52:55], a[56:59], a[188:191], v[52:55]
  v_mfma_f32_16x16x32_bf16 v[52:55], a[40:43], a[180:183], v[52:55]
  v_mfma_f32_16x16x32_bf16 v[60:63], a[44:47], a[180:183], v[60:63]
  v_mfma_f32_16x16x32_bf16 v[60:63], a[60:63], a[188:191], v[60:63]
  v_mfma_f32_16x16x32_bf16 v[56:59], a[60:63], a[184:187], v[56:59]
  v_mfma_f32_16x16x32_bf16 v[56:59], a[44:47], a[176:179], v[56:59]
  s_mov_b32 s43, 0x40000
Lp4_mb:
  s_waitcnt vmcnt(0)
  v_max3_u32 v112, v96, v97, v98
  v_max3_u32 v113, v99, v100, v101
  v_max3_u32 v112, v112, v102, v103
  v_max3_u32 v113, v113, v104, v105
  v_max3_u32 v112, v112, v106, v107
  v_max3_u32 v113, v113, v108, v109
  v_max3_u32 v112, v112, v110, v111
  v_max_u32 v112, v112, v113
  v_cmp_eq_u32 vcc, -1, v112
  s_cbranch_vccz Lp4_mbok
  buffer_load_dwordx4 v[96:99], v72, s[4:7], s45 offen offset:0 sc1
  buffer_load_dwordx4 v[100:103], v72, s[4:7], s45 offen offset:1024 sc1
  buffer_load_dwordx4 v[104:107], v72, s[4:7], s45 offen offset:2048 sc1
  buffer_load_dwordx4 v[108:111], v72, s[4:7], s45 offen offset:3072 sc1
  s_sub_u32 s43, s43, 1
  s_cmp_lg_u32 s43, 0
  s_cbranch_scc1 Lp4_mb
  s_waitcnt vmcnt(0)
Lp4_mbok:
  s_add_u32 s46, s76, 33554432
  s_add_u32 s47, s46, 32768
  s_lshl_b32 s48, s49, 11
  s_lshl_b32 s43, s53, 7
  s_add_u32 s48, s48, s43
  s_add_u32 s48, s48, 60817408
  s_cmp_lg_u32 s41, 0
  s_cbranch_scc1 Lfinal
  v_lshlrev_b32 v112, 16, v96
  v_and_b32 v113, 0xffff0000, v96
  v_lshlrev_b32 v114, 16, v97
  v_and_b32 v115, 0xffff0000, v97
  v_lshlrev_b32 v116, 16, v98
  v_and_b32 v117, 0xffff0000, v98
  v_lshlrev_b32 v118, 16, v99
  v_and_b32 v119, 0xffff0000, v99
  v_pk_add_f32 v[32:33], v[32:33], v[112:113]
  v_pk_add_f32 v[34:35], v[34:35], v[114:115]
  v_pk_add_f32 v[40:41], v[40:41], v[116:117]
  v_pk_add_f32 v[42:43], v[42:43], v[118:119]
  v_cvt_pk_bf16_f32 v76, v32, v33
  v_cvt_pk_bf16_f32 v77, v34, v35
  v_cvt_pk_bf16_f32 v78, v40, v41
  v_cvt_pk_bf16_f32 v79, v42, v43
  buffer_store_dwordx4 v[76:79], v72, s[4:7], s46 offen offset:0 sc1
  v_lshlrev_b32 v112, 16, v104
  v_and_b32 v113, 0xffff0000, v104
  v_lshlrev_b32 v114, 16, v105
  v_and_b32 v115, 0xffff0000, v105
  v_lshlrev_b32 v116, 16, v106
  v_and_b32 v117, 0xffff0000, v106
  v_lshlrev_b32 v118, 16, v107
  v_and_b32 v119, 0xffff0000, v107
  v_pk_add_f32 v[36:37], v[36:37], v[112:113]
  v_pk_add_f32 v[38:39], v[38:39], v[114:115]
  v_pk_add_f32 v[44:45], v[44:45], v[116:117]
  v_pk_add_f32 v[46:47], v[46:47], v[118:119]
  v_cvt_pk_bf16_f32 v84, v36, v37
  v_cvt_pk_bf16_f32 v85, v38, v39
  v_cvt_pk_bf16_f32 v86, v44, v45
  v_cvt_pk_bf16_f32 v87, v46, v47
  buffer_store_dwordx4 v[84:87], v72, s[4:7], s47 offen offset:0 sc1
  v_lshlrev_b32 v112, 16, v100
  v_and_b32 v113, 0xffff0000, v100
  v_lshlrev_b32 v114, 16, v101
  v_and_b32 v115, 0xffff0000, v101
  v_lshlrev_b32 v116, 16, v102
  v_and_b32 v117, 0xffff0000, v102
  v_lshlrev_b32 v118, 16, v103
  v_and_b32 v119, 0xffff0000, v103
  v_pk_add_f32 v[48:49], v[48:49], v[112:113]
  v_pk_add_f32 v[50:51], v[50:51], v[114:115]
  v_pk_add_f32 v[56:57], v[56:57], v[116:117]
  v_pk_add_f32 v[58:59], v[58:59], v[118:119]
  v_cvt_pk_bf16_f32 v80, v48, v49
  v_cvt_pk_bf16_f32 v81, v50, v51
  v_cvt_pk_bf16_f32 v82, v56, v57
  v_cvt_pk_bf16_f32 v83, v58, v59
  buffer_store_dwordx4 v[80:83], v72, s[4:7], s46 offen offset:1024 sc1
  v_lshlrev_b32 v112, 16, v108
  v_and_b32 v113, 0xffff0000, v108
  v_lshlrev_b32 v114, 16, v109
  v_and_b32 v115, 0xffff0000, v109
  v_lshlrev_b32 v116, 16, v110
  v_and_b32 v117, 0xffff0000, v110
  v_lshlrev_b32 v118, 16, v111
  v_and_b32 v119, 0xffff0000, v111
  v_pk_add_f32 v[52:53], v[52:53], v[112:113]
  v_pk_add_f32 v[54:55], v[54:55], v[114:115]
  v_pk_add_f32 v[60:61], v[60:61], v[116:117]
  v_pk_add_f32 v[62:63], v[62:63], v[118:119]
  v_cvt_pk_bf16_f32 v88, v52, v53
  v_cvt_pk_bf16_f32 v89, v54, v55
  v_cvt_pk_bf16_f32 v90, v60, v61
  v_cvt_pk_bf16_f32 v91, v62, v63
  buffer_store_dwordx4 v[88:91], v72, s[4:7], s47 offen offset:1024 sc1
  v_mov_b32 v128, 0x3f803f80
  v_mov_b32 v129, 0x3f803f80
  v_mov_b32 v130, 0x3f803f80
  v_mov_b32 v131, 0x3f803f80
  v_and_b32 v148, 15, v253
  v_lshrrev_b32 v149, 4, v253
  v_mfma_f32_16x16x32_bf16 v[132:135], v[128:131], v[76:79], 0
  v_mfma_f32_16x16x32_bf16 v[136:139], v[76:79], v[76:79], 0
  v_mfma_f32_16x16x32_bf16 v[140:143], v[128:131], v[84:87], 0
  v_mfma_f32_16x16x32_bf16 v[144:147], v[84:87], v[84:87], 0
  v_mfma_f32_16x16x32_bf16 v[132:135], v[128:131], v[80:83], v[132:135]
  v_mfma_f32_16x16x32_bf16 v[136:139], v[80:83], v[80:83], v[136:139]
  v_mfma_f32_16x16x32_bf16 v[140:143], v[128:131], v[88:91], v[140:143]
  v_mfma_f32_16x16x32_bf16 v[144:147], v[88:91], v[88:91], v[144:147]
  v_lshrrev_b32 v128, 2, v148
  v_cmp_eq_u32 s[64:65], v128, v149
  v_and_b32 v128, 3, v148
  v_cmp_eq_u32 s[66:67], 1, v128
  v_cmp_eq_u32 s[68:69], 2, v128
  v_cmp_eq_u32 s[70:71], 3, v128
  v_lshlrev_b32 v148, 3, v148
  v_mov_b32 v149, 0x7ffffff0
  s_nop 0
  v_cndmask_b32 v148, v149, v148, s[64:65]
  v_cndmask_b32 v133, v136, v137, s[66:67]
  v_cndmask_b32 v133, v133, v138, s[68:69]
  v_cndmask_b32 v133, v133, v139, s[70:71]
  buffer_store_dwordx2 v[132:133], v148, s[4:7], s48 offen offset:0 sc1
  v_cndmask_b32 v141, v144, v145, s[66:67]
  v_cndmask_b32 v141, v141, v146, s[68:69]
  v_cndmask_b32 v141, v141, v147, s[70:71]
  buffer_store_dwordx2 v[140:141], v148, s[4:7], s48 offen offset:2048 sc1
  s_lshl_b32 s77, s52, 7
  s_add_u32 s77, s77, 27790336
  s_mov_b32 s41, 1
  s_mov_b32 s42, 0x2000000
  s_mov_b32 s28, s4
  s_mov_b32 s29, s5
  s_mov_b32 s30, 0x10000000
  s_lshr_b32 s57, s40, 1
  s_and_b32 s58, s40, 1
  s_lshl_b32 s71, s50, 3
  s_add_u32 s67, s50, s51
  s_and_b32 s67, s67, 3
  s_lshl_b32 s62, s40, 12
  s_mul_i32 s63, s40, 6144
  s_add_u32 s76, s63, 139264
  s_and_b32 s43, s50, 7
  s_cmp_lg_u32 s43, 0
  s_cselect_b32 s43, 1, 0
  s_sub_u32 s72, s71, s43
  v_lshrrev_b32 v2, 3, v253
  v_bfe_u32 v3, v253, 1, 2
  v_lshrrev_b32 v4, 4, v253
  v_xor_b32 v3, v3, v4
  v_and_b32 v5, 1, v253
  v_mov_b32 v6, v2
  s_lshl_b32 s43, s40, 4
  v_mul_u32_u24 v6, 6144, v6
  v_lshl_add_u32 v6, v3, 5, v6
  v_lshl_add_u32 v124, v5, 4, v6
  v_add_u32 v125, 48128, v124
  s_mul_i32 s43, s43, 6144
  s_lshl_b32 s60, s51, 7
  s_add_u32 s60, s60, s43
  v_and_b32 v3, 7, v253
  s_lshl_b32 s43, s40, 1
  s_add_u32 s43, s43, s71
  v_lshlrev_b32 v120, 4, v253
  v_mov_b32 v121, v120
  v_add_u32 v122, 30720, v120
  v_add_u32 v123, 30720, v120
  v_lshlrev_b32 v5, 8, v2
  v_lshl_add_u32 v5, v3, 4, v5
  v_add_u32 v126, 128, v5
  s_lshl_b32 s43, s43, 15
  s_mov_b32 s44, 33554432
  s_add_u32 s59, s43, s44
  s_lshl_b32 s43, s72, 15
  s_add_u32 s73, s43, s44
  s_movk_i32 s61, 2048
  v_and_b32 v2, 15, v253
  v_lshrrev_b32 v3, 4, v253
  v_and_b32 v4, 7, v253
  v_lshlrev_b32 v6, 4, v253
  v_add_u32 v7, 1024, v6
  v_lshlrev_b32 v5, 7, v3
  v_lshl_add_u32 v8, v4, 4, v5
  v_add_u32 v9, 512, v8
  s_lshl_b32 s43, s57, 13
  s_add_u32 s43, s43, 73728
  v_add_u32 v112, s43, v6
  v_add_u32 v113, s43, v7
  s_cmp_eq_u32 s57, 0
  s_cselect_b64 vcc, 0, -1
  s_movk_i32 s43, 1024
  s_cselect_b32 s64, s43, 16384
  s_cselect_b32 s65, s43, -32768
  s_mov_b32 s43, 122880
  s_cselect_b32 s43, s43, 79872
  v_cndmask_b32 v8, v8, v6, vcc
  v_cndmask_b32 v9, v9, v7, vcc
  v_add_u32 v114, s43, v8
  v_add_u32 v115, s43, v9
  v_lshrrev_b32 v2, 2, v253
  v_bfe_u32 v3, v253, 3, 2
  v_and_b32 v4, 3, v253
  v_lshlrev_b32 v4, 3, v4
  v_lshl_add_u32 v4, v2, 7, v4
  s_lshl_b32 s43, s58, 1
  v_xor_b32 v5, s43, v3
  v_lshl_add_u32 v116, v5, 5, v4
  v_xor_b32 v5, 1, v5
  v_lshl_add_u32 v117, v5, 5, v4
  v_add_u32 v118, 49152, v116
  v_add_u32 v119, 49152, v117
  s_mov_b32 s84, s16
  s_mov_b32 s85, s17
  s_mov_b32 s86, 7340032
  s_mov_b32 s87, 0x20000
  s_mov_b32 s3, 0
  s_mov_b32 s88, 63
  s_mov_b32 s100, 0
  v_mov_b32 v238, 0x40000000
  s_waitcnt vmcnt(0)
  s_barrier
  s_cmp_lg_u32 s40, 0
  s_cbranch_scc1 Lsig21
  v_mov_b32 v250, 1
  s_mov_b64 exec, 1
  buffer_atomic_add v250, v251, s[4:7], s77 offen sc1
  s_mov_b64 exec, -1
Lsig21:
  s_cmp_eq_u32 s67, 0
  s_cselect_b32 s44, 4, 0
  s_mul_i32 s45, s44, 393216
  s_add_u32 s69, s45, s60
  s_add_u32 s70, s69, 4096
  s_add_u32 m0, s63, 0
  s_nop 0
  buffer_load_dwordx4 v124, s[8:11], s69 offen offset:0 lds
  buffer_load_dwordx4 v125, s[8:11], s69 offen offset:1024 lds
  buffer_load_dwordx4 v124, s[8:11], s69 offen offset:2048 lds
  buffer_load_dwordx4 v125, s[8:11], s69 offen offset:3072 lds
  s_add_u32 m0, s63, 4096
  s_nop 0
  buffer_load_dwordx4 v124, s[8:11], s70 offen offset:0 lds
  buffer_load_dwordx4 v125, s[8:11], s70 offen offset:1024 lds
  s_cmp_eq_u32 s67, 1
  s_cselect_b32 s44, 5, 1
  s_mul_i32 s45, s44, 393216
  s_add_u32 s69, s45, s60
  s_add_u32 s70, s69, 4096
  s_add_u32 m0, s63, 24576
  s_nop 0
  buffer_load_dwordx4 v124, s[8:11], s69 offen offset:0 lds
  buffer_load_dwordx4 v125, s[8:11], s69 offen offset:1024 lds
  buffer_load_dwordx4 v124, s[8:11], s69 offen offset:2048 lds
  buffer_load_dwordx4 v125, s[8:11], s69 offen offset:3072 lds
  s_add_u32 m0, s63, 28672
  s_nop 0
  buffer_load_dwordx4 v124, s[8:11], s70 offen offset:0 lds
  buffer_load_dwordx4 v125, s[8:11], s70 offen offset:1024 lds
  s_cmp_eq_u32 s67, 2
  s_cselect_b32 s44, 6, 2
  s_mul_i32 s45, s44, 393216
  s_add_u32 s69, s45, s60
  s_add_u32 s70, s69, 4096
  s_add_u32 m0, s63, 49152
  s_nop 0
  buffer_load_dwordx4 v124, s[8:11], s69 offen offset:0 lds
  buffer_load_dwordx4 v125, s[8:11], s69 offen offset:1024 lds
  buffer_load_dwordx4 v124, s[8:11], s69 offen offset:2048 lds
  buffer_load_dwordx4 v125, s[8:11], s69 offen offset:3072 lds
  s_add_u32 m0, s63, 53248
  s_nop 0
  buffer_load_dwordx4 v124, s[8:11], s70 offen offset:0 lds
  buffer_load_dwordx4 v125, s[8:11], s70 offen offset:1024 lds
  v_mov_b32 v0, 0
  v_mov_b32 v1, 0
  v_mov_b32 v2, 0
  v_mov_b32 v3, 0
  v_mov_b32 v4, 0
  v_mov_b32 v5, 0
  v_mov_b32 v6, 0
  v_mov_b32 v7, 0
  v_mov_b32 v8, 0
  v_mov_b32 v9, 0
  v_mov_b32 v10, 0
  v_mov_b32 v11, 0
  v_mov_b32 v12, 0
  v_mov_b32 v13, 0
  v_mov_b32 v14, 0
  v_mov_b32 v15, 0
  v_mov_b32 v16, 0
  v_mov_b32 v17, 0
  v_mov_b32 v18, 0
  v_mov_b32 v19, 0
  v_mov_b32 v20, 0
  v_mov_b32 v21, 0
  v_mov_b32 v22, 0
  v_mov_b32 v23, 0
  v_mov_b32 v24, 0
  v_mov_b32 v25, 0
  v_mov_b32 v26, 0
  v_mov_b32 v27, 0
  v_mov_b32 v28, 0
  v_mov_b32 v29, 0
  v_mov_b32 v30, 0
  v_mov_b32 v31, 0
  v_mov_b32 v32, 0
  v_mov_b32 v33, 0
  v_mov_b32 v34, 0
  v_mov_b32 v35, 0
  v_mov_b32 v36, 0
  v_mov_b32 v37, 0
  v_mov_b32 v38, 0
  v_mov_b32 v39, 0
  v_mov_b32 v40, 0
  v_mov_b32 v41, 0
  v_mov_b32 v42, 0
  v_mov_b32 v43, 0
  v_mov_b32 v44, 0
  v_mov_b32 v45, 0
  v_mov_b32 v46, 0
  v_mov_b32 v47, 0
  v_mov_b32 v48, 0
  v_mov_b32 v49, 0
  v_mov_b32 v50, 0
  v_mov_b32 v51, 0
  v_mov_b32 v52, 0
  v_mov_b32 v53, 0
  v_mov_b32 v54, 0
  v_mov_b32 v55, 0
  v_mov_b32 v56, 0
  v_mov_b32 v57, 0
  v_mov_b32 v58, 0
  v_mov_b32 v59, 0
  v_mov_b32 v60, 0
  v_mov_b32 v61, 0
  v_mov_b32 v62, 0
  v_mov_b32 v63, 0
  v_mov_b32 v64, 0
  v_mov_b32 v65, 0
  v_mov_b32 v66, 0
  v_mov_b32 v67, 0
  v_mov_b32 v68, 0
  v_mov_b32 v69, 0
  v_mov_b32 v70, 0
  v_mov_b32 v71, 0
  v_mov_b32 v72, 0
  v_mov_b32 v73, 0
  v_mov_b32 v74, 0
  v_mov_b32 v75, 0
  v_mov_b32 v76, 0
  v_mov_b32 v77, 0
  v_mov_b32 v78, 0
  v_mov_b32 v79, 0
  v_mov_b32 v80, 0
  v_mov_b32 v81, 0
  v_mov_b32 v82, 0
  v_mov_b32 v83, 0
  v_mov_b32 v84, 0
  v_mov_b32 v85, 0
  v_mov_b32 v86, 0
  v_mov_b32 v87, 0
  v_mov_b32 v88, 0
  v_mov_b32 v89, 0
  v_mov_b32 v90, 0
  v_mov_b32 v91, 0
  v_mov_b32 v92, 0
  v_mov_b32 v93, 0
  v_mov_b32 v94, 0
  v_mov_b32 v95, 0
  v_mov_b32 v96, 0
  v_mov_b32 v97, 0
  v_mov_b32 v98, 0
  v_mov_b32 v99, 0
  v_mov_b32 v100, 0
  v_mov_b32 v101, 0
  v_mov_b32 v102, 0
  v_mov_b32 v103, 0
  v_mov_b32 v104, 0
  v_mov_b32 v105, 0
  v_mov_b32 v106, 0
  v_mov_b32 v107, 0
  v_mov_b32 v108, 0
  v_mov_b32 v109, 0
  v_mov_b32 v110, 0
  v_mov_b32 v111, 0
  s_lshl_b32 s77, s50, 7
  s_add_u32 s77, s77, 27790208
  s_and_b32 s43, s50, 7
  s_cmp_eq_u32 s43, 0
  s_cselect_b32 s43, 0x80, 0
  v_lshlrev_b32 v249, 7, v253
  v_or_b32 v249, s43, v249
  s_branch Llayer
Lfinal:
  v_and_b32 v128, 15, v253
  v_lshlrev_b32 v128, 12, v128
  v_bfe_u32 v129, v253, 4, 1
  v_lshl_add_u32 v128, v129, 5, v128
  v_lshrrev_b32 v129, 5, v253
  v_lshl_add_u32 v128, v129, 4, v128
  s_and_b32 s43, s49, 63
  s_lshl_b32 s43, s43, 16
  s_lshr_b32 s46, s49, 6
  s_lshl_b32 s46, s46, 11
  s_add_u32 s46, s46, s43
  s_lshl_b32 s43, s53, 7
  s_add_u32 s46, s46, s43
  s_add_u32 s47, s46, 65536
  v_lshlrev_b32 v112, 16, v96
  v_and_b32 v113, 0xffff0000, v96
  v_lshlrev_b32 v114, 16, v97
  v_and_b32 v115, 0xffff0000, v97
  v_lshlrev_b32 v116, 16, v98
  v_and_b32 v117, 0xffff0000, v98
  v_lshlrev_b32 v118, 16, v99
  v_and_b32 v119, 0xffff0000, v99
  v_pk_add_f32 v[32:33], v[32:33], v[112:113]
  v_pk_add_f32 v[34:35], v[34:35], v[114:115]
  v_pk_add_f32 v[40:41], v[40:41], v[116:117]
  v_pk_add_f32 v[42:43], v[42:43], v[118:119]
  v_cvt_pk_bf16_f32 v76, v32, v33
  v_cvt_pk_bf16_f32 v77, v34, v35
  v_cvt_pk_bf16_f32 v78, v40, v41
  v_cvt_pk_bf16_f32 v79, v42, v43
  s_nop 1
  v_permlane16_swap_b32 v76, v78
  v_permlane16_swap_b32 v77, v79
  buffer_store_dwordx4 v[76:79], v128, s[32:35], s46 offen offset:0
  v_lshlrev_b32 v112, 16, v104
  v_and_b32 v113, 0xffff0000, v104
  v_lshlrev_b32 v114, 16, v105
  v_and_b32 v115, 0xffff0000, v105
  v_lshlrev_b32 v116, 16, v106
  v_and_b32 v117, 0xffff0000, v106
  v_lshlrev_b32 v118, 16, v107
  v_and_b32 v119, 0xffff0000, v107
  v_pk_add_f32 v[36:37], v[36:37], v[112:113]
  v_pk_add_f32 v[38:39], v[38:39], v[114:115]
  v_pk_add_f32 v[44:45], v[44:45], v[116:117]
  v_pk_add_f32 v[46:47], v[46:47], v[118:119]
  v_cvt_pk_bf16_f32 v84, v36, v37
  v_cvt_pk_bf16_f32 v85, v38, v39
  v_cvt_pk_bf16_f32 v86, v44, v45
  v_cvt_pk_bf16_f32 v87, v46, v47
  s_nop 1
  v_permlane16_swap_b32 v84, v86
  v_permlane16_swap_b32 v85, v87
  buffer_store_dwordx4 v[84:87], v128, s[32:35], s47 offen offset:0
  v_lshlrev_b32 v112, 16, v100
  v_and_b32 v113, 0xffff0000, v100
  v_lshlrev_b32 v114, 16, v101
  v_and_b32 v115, 0xffff0000, v101
  v_lshlrev_b32 v116, 16, v102
  v_and_b32 v117, 0xffff0000, v102
  v_lshlrev_b32 v118, 16, v103
  v_and_b32 v119, 0xffff0000, v103
  v_pk_add_f32 v[48:49], v[48:49], v[112:113]
  v_pk_add_f32 v[50:51], v[50:51], v[114:115]
  v_pk_add_f32 v[56:57], v[56:57], v[116:117]
  v_pk_add_f32 v[58:59], v[58:59], v[118:119]
  v_cvt_pk_bf16_f32 v80, v48, v49
  v_cvt_pk_bf16_f32 v81, v50, v51
  v_cvt_pk_bf16_f32 v82, v56, v57
  v_cvt_pk_bf16_f32 v83, v58, v59
  s_nop 1
  v_permlane16_swap_b32 v80, v82
  v_permlane16_swap_b32 v81, v83
  buffer_store_dwordx4 v[80:83], v128, s[32:35], s46 offen offset:64
  v_lshlrev_b32 v112, 16, v108
  v_and_b32 v113, 0xffff0000, v108
  v_lshlrev_b32 v114, 16, v109
  v_and_b32 v115, 0xffff0000, v109
  v_lshlrev_b32 v116, 16, v110
  v_and_b32 v117, 0xffff0000, v110
  v_lshlrev_b32 v118, 16, v111
  v_and_b32 v119, 0xffff0000, v111
  v_pk_add_f32 v[52:53], v[52:53], v[112:113]
  v_pk_add_f32 v[54:55], v[54:55], v[114:115]
  v_pk_add_f32 v[60:61], v[60:61], v[116:117]
  v_pk_add_f32 v[62:63], v[62:63], v[118:119]
  v_cvt_pk_bf16_f32 v88, v52, v53
  v_cvt_pk_bf16_f32 v89, v54, v55
  v_cvt_pk_bf16_f32 v90, v60, v61
  v_cvt_pk_bf16_f32 v91, v62, v63
  s_nop 1
  v_permlane16_swap_b32 v88, v90
  v_permlane16_swap_b32 v89, v91
  buffer_store_dwordx4 v[88:91], v128, s[32:35], s47 offen offset:64
Lend:
  s_endpgm
Lside_sub:
  buffer_load_dwordx4 a[240:243], v239, s[12:15], s89 offen
  s_add_u32 s89, s89, 1024
  s_cmp_ge_u32 s88, 10
  s_cbranch_scc1 Lside_b
  s_cmp_lg_u32 s40, 0
  s_cbranch_scc1 Lside_a
  s_and_b32 s43, s2, 1
  s_lshl_b32 s43, s43, 7
  v_mov_b32 v250, 1
  s_mov_b64 exec, 1
  buffer_atomic_add v250, v251, s[36:39], s43 offen sc1
  s_mov_b64 exec, -1
Lside_a:
  buffer_load_dwordx4 a[176:179], v238, s[84:87], s100 offen
  s_add_u32 s100, s100, 57344
  buffer_load_dwordx4 a[180:183], v238, s[84:87], s100 offen
  s_add_u32 s100, s100, 57344
  buffer_load_dwordx4 a[184:187], v238, s[84:87], s100 offen
  s_add_u32 s100, s100, 57344
  buffer_load_dwordx4 a[188:191], v238, s[84:87], s100 offen
  s_add_u32 s100, s100, 57344
  buffer_load_dwordx4 a[192:195], v238, s[84:87], s100 offen
  s_add_u32 s100, s100, 57344
  buffer_load_dwordx4 a[196:199], v238, s[84:87], s100 offen
  s_add_u32 s100, s100, 57344
  buffer_load_dwordx4 a[200:203], v238, s[84:87], s100 offen
  s_add_u32 s100, s100, 57344
  buffer_load_dwordx4 a[204:207], v238, s[84:87], s100 offen
  s_add_u32 s100, s100, 57344
  s_add_u32 s100, s100, 3211264
  s_add_u32 s88, s88, 6
  s_setpc_b64 s[78:79]
Lside_b:
  buffer_load_dwordx4 a[208:211], v238, s[84:87], s100 offen
  s_add_u32 s100, s100, 57344
  buffer_load_dwordx4 a[212:215], v238, s[84:87], s100 offen
  s_add_u32 s100, s100, 57344
  buffer_load_dwordx4 a[216:219], v238, s[84:87], s100 offen
  s_add_u32 s100, s100, 57344
  buffer_load_dwordx4 a[220:223], v238, s[84:87], s100 offen
  s_add_u32 s100, s100, 57344
  buffer_load_dwordx4 a[224:227], v238, s[84:87], s100 offen
  s_add_u32 s100, s100, 57344
  buffer_load_dwordx4 a[228:231], v238, s[84:87], s100 offen
  s_add_u32 s100, s100, 57344
  buffer_load_dwordx4 a[232:235], v238, s[84:87], s100 offen
  s_add_u32 s100, s100, 57344
  buffer_load_dwordx4 a[236:239], v238, s[84:87], s100 offen
  s_add_u32 s100, s100, 57344
  s_add_u32 s100, s100, 0
  s_add_u32 s88, s88, 6
  s_setpc_b64 s[78:79]
Lcode_end:
.fill (Lpc0 + 65536 - Lcode_end)/4, 4, 0xbf810000
.section .rodata,"a"
.p2align 6
.amdhsa_kernel interleave_layers__sliding_local_dilated__swiglu_ffn__prompt_kernel
  .amdhsa_next_free_vgpr 512
  .amdhsa_next_free_sgpr 102
  .amdhsa_accum_offset 256
  .amdhsa_group_segment_fixed_size 0
  .amdhsa_kernarg_size 80
  .amdhsa_user_sgpr_count 2
  .amdhsa_user_sgpr_kernarg_segment_ptr 1
  .amdhsa_system_sgpr_workgroup_id_x 1
  .amdhsa_float_denorm_mode_32 3
.end_amdhsa_kernel
```

```asm
; @launch grid=(256,1,1) block=(256,1,1) lds=163840
.amdgcn_target "amdgcn-amd-amdhsa--gfx950"
.text
.globl interleave_layers__sliding_local_dilated__swiglu_ffn__prompt_kernel
.p2align 8
.type interleave_layers__sliding_local_dilated__swiglu_ffn__prompt_kernel,@function
interleave_layers__sliding_local_dilated__swiglu_ffn__prompt_kernel:
  s_cmp_lt_u32 s2, 256
  s_cbranch_scc1 Lgo
  s_endpgm
Lgo:
  s_load_dwordx2 s[28:29], s[0:1], 0
  s_load_dwordx2 s[8:9], s[0:1], 8
  s_getpc_b64 s[44:45]
Lpc0:
  s_bfe_u32 s43, s2, 0x40003
  s_lshl_b32 s43, s43, 12
  v_lshl_add_u32 v2, v0, 4, s43
  s_and_b32 s44, s44, 0xffffff80
  global_load_dwordx4 a[240:243], v2, s[44:45]
  v_lshrrev_b32 v1, 6, v0
  v_and_b32 v253, 63, v0
  v_readfirstlane_b32 s40, v1
  v_mov_b32 v251, 0
  s_mov_b32 s30, 0x400000
  s_mov_b32 s31, 0x20000
  s_mov_b32 s10, 0x600000
  s_mov_b32 s11, 0x20000
  s_and_b32 s44, s2, 1
  s_bfe_u32 s45, s2, 0x20001
  s_lshr_b32 s46, s2, 3
  s_lshl_b32 s47, s44, 3
  s_and_b32 s43, s46, 7
  s_add_u32 s50, s47, s43
  s_lshl_b32 s43, s45, 2
  s_lshr_b32 s51, s46, 3
  s_add_u32 s51, s51, s43
  s_lshr_b32 s57, s40, 1
  s_and_b32 s58, s40, 1
  s_lshl_b32 s71, s50, 3
  s_add_u32 s67, s50, s51
  s_and_b32 s67, s67, 15
  s_lshl_b32 s62, s40, 12
  s_mul_i32 s63, s40, 6144
  s_add_u32 s76, s63, 139264
  s_and_b32 s43, s50, 7
  s_cmp_lg_u32 s43, 0
  s_cselect_b32 s43, 1, 0
  s_sub_u32 s72, s71, s43
  v_lshrrev_b32 v2, 3, v253
  v_bfe_u32 v3, v253, 1, 2
  v_lshrrev_b32 v4, 4, v253
  v_xor_b32 v3, v3, v4
  v_and_b32 v5, 1, v253
  v_lshrrev_b32 v6, 5, v253
  v_lshl_add_u32 v6, v6, 2, v2
  s_lshl_b32 s43, s57, 5
  s_lshl_b32 s44, s58, 2
  s_add_u32 s43, s43, s44
  v_mul_u32_u24 v6, 6144, v6
  v_lshl_add_u32 v6, v3, 5, v6
  v_lshl_add_u32 v124, v5, 4, v6
  v_add_u32 v125, 97280, v124
  s_mul_i32 s43, s43, 6144
  s_lshl_b32 s60, s51, 7
  s_add_u32 s60, s60, s43
  v_and_b32 v3, 7, v253
  s_lshl_b32 s43, s40, 1
  s_add_u32 s43, s43, s71
  v_add_u32 v5, 0, v4
  v_xor_b32 v5, v5, v3
  v_lshlrev_b32 v5, 4, v5
  v_lshl_add_u32 v5, v2, 12, v5
  v_add_u32 v120, 0, v5
  v_add_u32 v5, 4, v4
  v_xor_b32 v5, v5, v3
  v_lshlrev_b32 v5, 4, v5
  v_lshl_add_u32 v5, v2, 12, v5
  v_add_u32 v121, 31744, v5
  v_add_u32 v5, 0, v4
  v_xor_b32 v5, v5, v3
  v_lshlrev_b32 v5, 4, v5
  v_lshl_add_u32 v5, v2, 12, v5
  v_add_u32 v122, 63488, v5
  v_add_u32 v5, 4, v4
  v_xor_b32 v5, v5, v3
  v_lshlrev_b32 v5, 4, v5
  v_lshl_add_u32 v5, v2, 12, v5
  v_add_u32 v123, 95232, v5
  v_and_b32 v5, 6, v2
  v_xor_b32 v5, v5, v3
  v_lshlrev_b32 v5, 4, v5
  v_lshl_add_u32 v5, v2, 12, v5
  v_add_u32 v126, 32768, v5
  s_lshr_b32 s44, s50, 3
  s_lshl_b32 s44, s44, 11
  s_and_b32 s43, s43, 63
  s_lshl_b32 s43, s43, 16
  s_add_u32 s59, s43, s44
  s_and_b32 s43, s72, 63
  s_lshl_b32 s43, s43, 16
  s_add_u32 s73, s43, s44
  s_movk_i32 s61, 128
  s_waitcnt lgkmcnt(0)
  s_add_u32 s44, s67, 0
  s_and_b32 s44, s44, 15
  s_mul_i32 s45, s44, s61
  s_add_u32 s68, s45, s59
  s_add_u32 m0, s62, 73728
  s_nop 0
  buffer_load_dwordx4 v120, s[28:31], s68 offen offset:0 sc1  lds
  buffer_load_dwordx4 v121, s[28:31], s68 offen offset:1024 sc1  lds
  buffer_load_dwordx4 v122, s[28:31], s68 offen offset:2048 sc1  lds
  buffer_load_dwordx4 v123, s[28:31], s68 offen offset:3072 sc1  lds
  s_add_u32 s44, s67, 0
  s_and_b32 s44, s44, 15
  s_mul_i32 s45, s44, 393216
  s_add_u32 s69, s45, s60
  s_add_u32 s70, s69, 4096
  s_add_u32 m0, s63, 0
  s_nop 0
  buffer_load_dwordx4 v124, s[8:11], s69 offen offset:0  lds
  buffer_load_dwordx4 v125, s[8:11], s69 offen offset:1024  lds
  buffer_load_dwordx4 v124, s[8:11], s69 offen offset:2048  lds
  buffer_load_dwordx4 v125, s[8:11], s69 offen offset:3072  lds
  s_add_u32 m0, s63, 4096
  s_nop 0
  buffer_load_dwordx4 v124, s[8:11], s70 offen offset:0  lds
  buffer_load_dwordx4 v125, s[8:11], s70 offen offset:1024  lds
  s_add_u32 s44, s67, s40
  s_add_u32 s44, s44, 0
  s_and_b32 s44, s44, 15
  s_mul_i32 s44, s44, s61
  s_lshl_b32 s45, s40, 10
  s_add_u32 m0, s45, 122880
  s_add_u32 s44, s44, s73
  buffer_load_dwordx4 v126, s[28:31], s44 offen sc1 lds
  s_load_dwordx2 s[4:5], s[0:1], 72
  s_load_dwordx2 s[12:13], s[0:1], 16
  s_load_dwordx2 s[16:17], s[0:1], 32
  s_load_dwordx2 s[20:21], s[0:1], 40
  s_load_dwordx2 s[24:25], s[0:1], 48
  s_load_dwordx2 s[32:33], s[0:1], 56
  s_load_dwordx2 s[36:37], s[0:1], 64
  s_mov_b32 s6, 0x10000000
  s_mov_b32 s7, 0x20000
  s_mov_b32 s14, 0x200000
  s_mov_b32 s15, 0x20000
  s_mov_b32 s18, 0x700000
  s_mov_b32 s19, 0x20000
  s_mov_b32 s22, 0x700000
  s_mov_b32 s23, 0x20000
  s_mov_b32 s26, 0x700000
  s_mov_b32 s27, 0x20000
  s_mov_b32 s34, 0x400000
  s_mov_b32 s35, 0x20000
  s_mov_b32 s38, 0x100
  s_mov_b32 s39, 0x20000
  s_mov_b32 s41, 0
  s_mov_b32 s42, 0
  s_and_b32 s44, s2, 1
  s_bfe_u32 s45, s2, 0x20001
  s_lshr_b32 s46, s2, 3
  s_lshl_b32 s47, s44, 3
  s_lshr_b32 s43, s45, 1
  s_lshl_b32 s43, s43, 2
  s_add_u32 s52, s47, s43
  s_and_b32 s48, s46, 3
  s_add_u32 s52, s52, s48
  s_and_b32 s43, s45, 1
  s_lshr_b32 s49, s46, 2
  s_lshl_b32 s53, s49, 1
  s_add_u32 s53, s53, s43
  s_lshl_b32 s43, s44, 2
  s_add_u32 s54, s43, s48
  s_lshl_b32 s43, s45, 3
  s_add_u32 s55, s43, s49
  v_lshrrev_b32 v2, 3, v253
  v_bfe_u32 v3, v253, 1, 2
  v_lshrrev_b32 v4, 4, v253
  v_xor_b32 v3, v3, v4
  v_and_b32 v4, 1, v253
  v_lshlrev_b32 v2, 11, v2
  v_lshl_add_u32 v2, v3, 5, v2
  v_lshl_add_u32 v252, v4, 4, v2
  s_waitcnt lgkmcnt(0)
  s_lshr_b32 s43, s2, 7
  s_mul_i32 s43, s43, 37748736
  s_and_b32 s44, s2, 127
  s_lshl_b32 s44, s44, 7
  s_add_u32 s43, s43, s44
  s_add_u32 s43, s43, 27787264
  buffer_store_dword v251, v251, s[4:7], s43 offen sc1
  v_and_b32 v2, 15, v253
  v_lshrrev_b32 v3, 4, v253
  v_and_b32 v4, 7, v253
  v_lshrrev_b32 v5, 1, v2
  v_xor_b32 v5, v5, v3
  v_lshlrev_b32 v5, 4, v5
  v_lshl_add_u32 v6, v2, 7, v5
  v_xor_b32 v7, 64, v6
  v_and_b32 v5, 6, v4
  v_xor_b32 v5, v5, v3
  v_lshlrev_b32 v5, 4, v5
  v_lshl_add_u32 v8, v4, 7, v5
  v_xor_b32 v9, 64, v8
  s_lshl_b32 s43, s57, 13
  s_add_u32 s43, s43, 73728
  v_add_u32 v112, s43, v6
  v_add_u32 v113, s43, v7
  s_cmp_eq_u32 s57, 0
  s_cselect_b64 vcc, 0, -1
  s_movk_i32 s43, 1024
  s_cselect_b32 s64, s43, 16384
  s_cselect_b32 s65, s43, -32768
  s_mov_b32 s43, 122880
  s_cselect_b32 s43, s43, 79872
  v_cndmask_b32 v8, v8, v6, vcc
  v_cndmask_b32 v9, v9, v7, vcc
  v_add_u32 v114, s43, v8
  v_add_u32 v115, s43, v9
  v_lshrrev_b32 v2, 2, v253
  v_bfe_u32 v3, v253, 3, 2
  v_and_b32 v4, 3, v253
  v_lshlrev_b32 v4, 3, v4
  v_lshl_add_u32 v4, v2, 7, v4
  s_lshl_b32 s43, s58, 1
  v_xor_b32 v5, s43, v3
  v_lshl_add_u32 v116, v5, 5, v4
  v_xor_b32 v5, 1, v5
  v_lshl_add_u32 v117, v5, 5, v4
  v_add_u32 v118, 49152, v116
  v_add_u32 v119, 49152, v117
  v_mov_b32 v0, 0
  v_mov_b32 v1, 0
  v_mov_b32 v2, 0
  v_mov_b32 v3, 0
  v_mov_b32 v4, 0
  v_mov_b32 v5, 0
  v_mov_b32 v6, 0
  v_mov_b32 v7, 0
  v_mov_b32 v8, 0
  v_mov_b32 v9, 0
  v_mov_b32 v10, 0
  v_mov_b32 v11, 0
  v_mov_b32 v12, 0
  v_mov_b32 v13, 0
  v_mov_b32 v14, 0
  v_mov_b32 v15, 0
  v_mov_b32 v16, 0
  v_mov_b32 v17, 0
  v_mov_b32 v18, 0
  v_mov_b32 v19, 0
  v_mov_b32 v20, 0
  v_mov_b32 v21, 0
  v_mov_b32 v22, 0
  v_mov_b32 v23, 0
  v_mov_b32 v24, 0
  v_mov_b32 v25, 0
  v_mov_b32 v26, 0
  v_mov_b32 v27, 0
  v_mov_b32 v28, 0
  v_mov_b32 v29, 0
  v_mov_b32 v30, 0
  v_mov_b32 v31, 0
  v_mov_b32 v32, 0
  v_mov_b32 v33, 0
  v_mov_b32 v34, 0
  v_mov_b32 v35, 0
  v_mov_b32 v36, 0
  v_mov_b32 v37, 0
  v_mov_b32 v38, 0
  v_mov_b32 v39, 0
  v_mov_b32 v40, 0
  v_mov_b32 v41, 0
  v_mov_b32 v42, 0
  v_mov_b32 v43, 0
  v_mov_b32 v44, 0
  v_mov_b32 v45, 0
  v_mov_b32 v46, 0
  v_mov_b32 v47, 0
  v_mov_b32 v48, 0
  v_mov_b32 v49, 0
  v_mov_b32 v50, 0
  v_mov_b32 v51, 0
  v_mov_b32 v52, 0
  v_mov_b32 v53, 0
  v_mov_b32 v54, 0
  v_mov_b32 v55, 0
  v_mov_b32 v56, 0
  v_mov_b32 v57, 0
  v_mov_b32 v58, 0
  v_mov_b32 v59, 0
  v_mov_b32 v60, 0
  v_mov_b32 v61, 0
  v_mov_b32 v62, 0
  v_mov_b32 v63, 0
  v_mov_b32 v64, 0
  v_mov_b32 v65, 0
  v_mov_b32 v66, 0
  v_mov_b32 v67, 0
  v_mov_b32 v68, 0
  v_mov_b32 v69, 0
  v_mov_b32 v70, 0
  v_mov_b32 v71, 0
  v_mov_b32 v72, 0
  v_mov_b32 v73, 0
  v_mov_b32 v74, 0
  v_mov_b32 v75, 0
  v_mov_b32 v76, 0
  v_mov_b32 v77, 0
  v_mov_b32 v78, 0
  v_mov_b32 v79, 0
  v_mov_b32 v80, 0
  v_mov_b32 v81, 0
  v_mov_b32 v82, 0
  v_mov_b32 v83, 0
  v_mov_b32 v84, 0
  v_mov_b32 v85, 0
  v_mov_b32 v86, 0
  v_mov_b32 v87, 0
  v_mov_b32 v88, 0
  v_mov_b32 v89, 0
  v_mov_b32 v90, 0
  v_mov_b32 v91, 0
  v_mov_b32 v92, 0
  v_mov_b32 v93, 0
  v_mov_b32 v94, 0
  v_mov_b32 v95, 0
  v_mov_b32 v96, 0
  v_mov_b32 v97, 0
  v_mov_b32 v98, 0
  v_mov_b32 v99, 0
  v_mov_b32 v100, 0
  v_mov_b32 v101, 0
  v_mov_b32 v102, 0
  v_mov_b32 v103, 0
  v_mov_b32 v104, 0
  v_mov_b32 v105, 0
  v_mov_b32 v106, 0
  v_mov_b32 v107, 0
  v_mov_b32 v108, 0
  v_mov_b32 v109, 0
  v_mov_b32 v110, 0
  v_mov_b32 v111, 0
  v_and_b32 v235, 15, v253
  v_lshrrev_b32 v236, 4, v253
  v_lshlrev_b32 v236, 2, v236
  v_sub_u32 v235, v235, v236
  v_mov_b32 v237, 0xf149f2ca
  v_subrev_u32 v238, 0, v235
  v_cmp_gt_u32 vcc, 8, v238
  v_add_u32 v238, 16, v238
  v_cmp_gt_u32 s[78:79], 8, v238
  v_cndmask_b32 v132, v237, 0, vcc
  s_nop 0
  v_cndmask_b32 v136, v237, 0, s[78:79]
  v_subrev_u32 v238, 1, v235
  v_cmp_gt_u32 vcc, 8, v238
  v_add_u32 v238, 16, v238
  v_cmp_gt_u32 s[78:79], 8, v238
  v_cndmask_b32 v133, v237, 0, vcc
  s_nop 0
  v_cndmask_b32 v137, v237, 0, s[78:79]
  v_subrev_u32 v238, 2, v235
  v_cmp_gt_u32 vcc, 8, v238
  v_add_u32 v238, 16, v238
  v_cmp_gt_u32 s[78:79], 8, v238
  v_cndmask_b32 v134, v237, 0, vcc
  s_nop 0
  v_cndmask_b32 v138, v237, 0, s[78:79]
  v_subrev_u32 v238, 3, v235
  v_cmp_gt_u32 vcc, 8, v238
  v_add_u32 v238, 16, v238
  v_cmp_gt_u32 s[78:79], 8, v238
  v_cndmask_b32 v135, v237, 0, vcc
  s_nop 0
  v_cndmask_b32 v139, v237, 0, s[78:79]
  v_lshlrev_b32 v232, 4, v253
  v_add_u32 v232, 149504, v232
  ds_write_b128 v232, v[132:135]
  ds_write_b128 v232, v[136:139] offset:1024
  v_and_b32 v128, 15, v253
  v_lshrrev_b32 v129, 5, v253
  v_lshrrev_b32 v130, 1, v128
  v_xor_b32 v129, v129, v130
  v_bfe_u32 v130, v253, 4, 1
  v_lshlrev_b32 v130, 3, v130
  v_lshl_add_u32 v130, v128, 7, v130
  v_lshl_add_u32 v130, v129, 4, v130
  s_add_u32 s43, s62, 73728
  v_xor_b32 v132, 0, v130
  v_add_u32 v132, s43, v132
  v_xor_b32 v133, 32, v130
  v_add_u32 v133, s43, v133
  v_xor_b32 v134, 64, v130
  v_add_u32 v134, s43, v134
  v_xor_b32 v135, 96, v130
  v_add_u32 v135, s43, v135
  v_lshrrev_b32 v129, 4, v253
  v_lshlrev_b32 v129, 4, v129
  v_mov_b32 v130, 0x40000000
  v_cmp_eq_u32 vcc, 0, v128
  s_lshl_b32 s43, s57, 30
  s_xor_b32 s44, s43, 0x40000000
  v_cndmask_b32 v129, v130, v129, vcc
  v_or_b32 v136, s43, v129
  v_or_b32 v137, s44, v129
  v_lshlrev_b32 v128, 4, v253
  v_mov_b32 v156, 0x3f803f80
  v_mov_b32 v157, 0x3f803f80
  v_mov_b32 v158, 0x3f803f80
  v_mov_b32 v159, 0x3f803f80
  s_lshl_b32 s43, s40, 1
  s_add_u32 s43, s43, s71
  s_lshl_b32 s46, s43, 15
  s_lshl_b32 s47, s67, 11
  s_add_u32 s46, s46, s47
  s_add_u32 s46, s46, 0
  s_add_u32 s47, s46, 32768
  s_lshl_b32 s48, s43, 11
  s_lshl_b32 s43, s67, 7
  s_add_u32 s48, s48, s43
  s_add_u32 s48, s48, 27262976
  s_lshl_b32 s43, s51, 1
  s_add_u32 s43, s43, s58
  s_lshl_b32 s43, s43, 7
  s_mul_i32 s49, s67, 12288
  s_add_u32 s49, s49, s43
  s_add_u32 s49, s49, 27983872
  s_add_u32 s44, s67, 1
  s_and_b32 s44, s44, 15
  s_mul_i32 s45, s44, s61
  s_add_u32 s68, s45, s59
  s_add_u32 m0, s62, 90112
  s_nop 0
  buffer_load_dwordx4 v120, s[28:31], s68 offen offset:0 sc1  lds
  buffer_load_dwordx4 v121, s[28:31], s68 offen offset:1024 sc1  lds
  buffer_load_dwordx4 v122, s[28:31], s68 offen offset:2048 sc1  lds
  buffer_load_dwordx4 v123, s[28:31], s68 offen offset:3072 sc1  lds
  s_waitcnt vmcnt(5)
  s_barrier
  ds_read_b64 v[140:141], v132 offset:0
  ds_read_b64 v[142:143], v133 offset:0
  ds_read_b64 v[144:145], v134 offset:0
  ds_read_b64 v[146:147], v135 offset:0
  ds_read_b64 v[148:149], v132 offset:2048
  ds_read_b64 v[150:151], v133 offset:2048
  ds_read_b64 v[152:153], v134 offset:2048
  ds_read_b64 v[154:155], v135 offset:2048
  ds_read_b64_tr_b16 a[40:41], v116 offset:0
  ds_read_b64_tr_b16 a[42:43], v116 offset:6144
  ds_read_b64_tr_b16 a[64:65], v116 offset:12288
  ds_read_b64_tr_b16 a[66:67], v116 offset:18432
  ds_read_b128 a[4:7], v112 offset:0
  ds_read_b128 a[24:27], v113 offset:0
  ds_read_b128 a[8:11], v112 offset:2048
  ds_read_b128 a[28:31], v113 offset:2048
  ds_read_b128 a[12:15], v112 offset:4096
  ds_read_b128 a[32:35], v113 offset:4096
  ds_read_b128 a[16:19], v112 offset:6144
  ds_read_b128 a[36:39], v113 offset:6144
  ds_read_b64_tr_b16 a[44:45], v117 offset:0
  ds_read_b64_tr_b16 a[46:47], v117 offset:6144
  ds_read_b64_tr_b16 a[68:69], v117 offset:12288
  ds_read_b64_tr_b16 a[70:71], v117 offset:18432
  ds_read_b128 a[0:3], v114
  v_add_u32 v114, s64, v114
  ds_read_b128 a[20:23], v115
  v_add_u32 v115, s64, v115
  ds_read_b64_tr_b16 a[48:49], v116 offset:2048
  ds_read_b64_tr_b16 a[50:51], v116 offset:8192
  ds_read_b64_tr_b16 a[72:73], v116 offset:14336
  ds_read_b64_tr_b16 a[74:75], v116 offset:20480
  ds_read_b64_tr_b16 a[52:53], v117 offset:2048
  ds_read_b64_tr_b16 a[54:55], v117 offset:8192
  ds_read_b64_tr_b16 a[76:77], v117 offset:14336
  ds_read_b64_tr_b16 a[78:79], v117 offset:20480
  ds_read_b64_tr_b16 a[56:57], v116 offset:4096
  ds_read_b64_tr_b16 a[58:59], v116 offset:10240
  ds_read_b64_tr_b16 a[80:81], v116 offset:16384
  ds_read_b64_tr_b16 a[82:83], v116 offset:22528
  ds_read_b64_tr_b16 a[60:61], v117 offset:4096
  ds_read_b64_tr_b16 a[62:63], v117 offset:10240
  ds_read_b64_tr_b16 a[84:85], v117 offset:16384
  ds_read_b64_tr_b16 a[86:87], v117 offset:22528
  s_add_u32 s44, s67, 1
  s_and_b32 s44, s44, 15
  s_mul_i32 s45, s44, 393216
  s_add_u32 s69, s45, s60
  s_add_u32 s70, s69, 4096
  s_add_u32 m0, s63, 24576
  s_nop 0
  buffer_load_dwordx4 v124, s[8:11], s69 offen offset:0  lds
  buffer_load_dwordx4 v125, s[8:11], s69 offen offset:1024  lds
  buffer_load_dwordx4 v124, s[8:11], s69 offen offset:2048  lds
  buffer_load_dwordx4 v125, s[8:11], s69 offen offset:3072  lds
  s_add_u32 m0, s63, 28672
  s_nop 0
  buffer_load_dwordx4 v124, s[8:11], s70 offen offset:0  lds
  buffer_load_dwordx4 v125, s[8:11], s70 offen offset:1024  lds
  s_waitcnt lgkmcnt(0)
  v_mfma_f32_16x16x32_bf16 v[160:163], a[40:43], v[156:159], 0
  v_mfma_f32_16x16x32_bf16 v[164:167], a[44:47], v[156:159], 0
  v_mfma_f32_16x16x32_bf16 v[168:171], a[48:51], v[156:159], 0
  v_mfma_f32_16x16x32_bf16 v[172:175], a[52:55], v[156:159], 0
  v_mfma_f32_16x16x32_bf16 v[176:179], a[56:59], v[156:159], 0
  v_mfma_f32_16x16x32_bf16 v[180:183], a[60:63], v[156:159], 0
  v_mfma_f32_16x16x32_bf16 v[160:163], a[64:67], v[156:159], v[160:163]
  v_mfma_f32_16x16x32_bf16 v[164:167], a[68:71], v[156:159], v[164:167]
  v_mfma_f32_16x16x32_bf16 v[168:171], a[72:75], v[156:159], v[168:171]
  v_mfma_f32_16x16x32_bf16 v[172:175], a[76:79], v[156:159], v[172:175]
  v_mfma_f32_16x16x32_bf16 v[176:179], a[80:83], v[156:159], v[176:179]
  v_mfma_f32_16x16x32_bf16 v[180:183], a[84:87], v[156:159], v[180:183]
  buffer_store_dwordx4 v[140:143], v128, s[4:7], s46 offen offset:0 sc1
  buffer_store_dwordx4 v[144:147], v128, s[4:7], s46 offen offset:1024 sc1
  buffer_store_dwordx4 v[148:151], v128, s[4:7], s47 offen offset:0 sc1
  buffer_store_dwordx4 v[152:155], v128, s[4:7], s47 offen offset:1024 sc1
  v_mov_b32 v192, 0x3f803f80
  v_mov_b32 v193, 0x3f803f80
  v_mov_b32 v194, 0x3f803f80
  v_mov_b32 v195, 0x3f803f80
  v_and_b32 v212, 15, v253
  v_lshrrev_b32 v213, 4, v253
  v_mfma_f32_16x16x32_bf16 v[196:199], v[192:195], v[140:143], 0
  v_mfma_f32_16x16x32_bf16 v[200:203], v[140:143], v[140:143], 0
  v_mfma_f32_16x16x32_bf16 v[204:207], v[192:195], v[148:151], 0
  v_mfma_f32_16x16x32_bf16 v[208:211], v[148:151], v[148:151], 0
  v_mfma_f32_16x16x32_bf16 v[196:199], v[192:195], v[144:147], v[196:199]
  v_mfma_f32_16x16x32_bf16 v[200:203], v[144:147], v[144:147], v[200:203]
  v_mfma_f32_16x16x32_bf16 v[204:207], v[192:195], v[152:155], v[204:207]
  v_mfma_f32_16x16x32_bf16 v[208:211], v[152:155], v[152:155], v[208:211]
  v_lshrrev_b32 v192, 2, v212
  v_cmp_eq_u32 s[80:81], v192, v213
  v_and_b32 v192, 3, v212
  v_cmp_eq_u32 s[82:83], 1, v192
  v_cmp_eq_u32 s[84:85], 2, v192
  v_cmp_eq_u32 s[86:87], 3, v192
  v_lshlrev_b32 v212, 3, v212
  v_mov_b32 v213, 0x7ffffff0
  s_nop 0
  v_cndmask_b32 v212, v213, v212, s[80:81]
  v_cndmask_b32 v197, v200, v201, s[82:83]
  v_cndmask_b32 v197, v197, v202, s[84:85]
  v_cndmask_b32 v197, v197, v203, s[86:87]
  buffer_store_dwordx2 v[196:197], v212, s[4:7], s48 offen offset:0 sc1
  v_cndmask_b32 v205, v208, v209, s[82:83]
  v_cndmask_b32 v205, v205, v210, s[84:85]
  v_cndmask_b32 v205, v205, v211, s[86:87]
  buffer_store_dwordx2 v[204:205], v212, s[4:7], s48 offen offset:2048 sc1
  buffer_store_dwordx4 v[160:163], v136, s[4:7], s49 offen offset:0 sc1
  buffer_store_dwordx4 v[164:167], v137, s[4:7], s49 offen offset:64 sc1
  s_add_u32 s49, s49, 4096
  buffer_store_dwordx4 v[168:171], v136, s[4:7], s49 offen offset:0 sc1
  buffer_store_dwordx4 v[172:175], v137, s[4:7], s49 offen offset:64 sc1
  s_add_u32 s49, s49, 4096
  buffer_store_dwordx4 v[176:179], v136, s[4:7], s49 offen offset:0 sc1
  buffer_store_dwordx4 v[180:183], v137, s[4:7], s49 offen offset:64 sc1
  s_add_u32 s49, s49, 4096
  s_lshr_b32 s46, s2, 3
  s_cmp_ge_u32 s46, 14
  s_cselect_b32 s44, 14, 0
  s_cselect_b32 s45, 1, 0
  s_cselect_b32 s84, s20, s16
  s_cselect_b32 s85, s21, s17
  s_mov_b32 s86, 7340032
  s_mov_b32 s87, 0x20000
  s_sub_u32 s44, s46, s44
  s_bfe_u32 s47, s2, 0x20001
  s_mul_i32 s47, s47, 14
  s_add_u32 s44, s44, s47
  s_and_b32 s47, s2, 1
  s_lshl_b32 s48, s47, 1
  s_add_u32 s48, s48, s45
  s_mul_i32 s48, s48, 14336
  s_lshl_b32 s49, s44, 8
  s_add_u32 s48, s48, s49
  s_add_u32 s101, s48, 27918336
  s_lshl_b32 s47, s47, 2
  s_add_u32 s47, s47, s40
  s_mul_i32 s47, s47, 458752
  s_lshl_b32 s44, s44, 7
  s_add_u32 s100, s47, s44
  s_cmp_lt_u32 s46, 28
  s_cselect_b32 s3, 1, 0
  s_cmp_eq_u32 s41, 0
  s_cselect_b32 s3, s3, 0
  v_lshrrev_b32 v238, 3, v253
  v_mul_u32_u24 v238, 7168, v238
  v_and_b32 v239, 7, v253
  v_lshl_add_u32 v238, v239, 4, v238
  s_cmp_eq_u32 s3, 0
  s_cselect_b32 s43, 0x40000000, 0
  v_or_b32 v238, s43, v238
  v_lshlrev_b32 v239, 4, v253
  s_lshl_b32 s43, s2, 2
  s_add_u32 s43, s43, s40
  s_lshl_b32 s89, s43, 11
  s_mul_i32 s43, s46, 43
  s_lshr_b32 s43, s43, 8
  s_mul_i32 s43, s43, 6
  s_sub_u32 s43, s46, s43
  s_add_u32 s43, s43, 5
  s_cmp_eq_u32 s41, 0
  s_cselect_b32 s88, s43, 63
  s_mov_b32 s90, 0
  s_add_u32 s44, s67, s40
  s_add_u32 s44, s44, 4
  s_and_b32 s44, s44, 15
  s_mul_i32 s44, s44, s61
  s_lshl_b32 s45, s40, 10
  s_add_u32 m0, s45, 126976
  s_add_u32 s44, s44, s73
  buffer_load_dwordx4 v126, s[28:31], s44 offen sc1 lds
  s_add_u32 s44, s67, s40
  s_add_u32 s44, s44, 8
  s_and_b32 s44, s44, 15
  s_mul_i32 s44, s44, s61
  s_lshl_b32 s45, s40, 10
  s_add_u32 m0, s45, 131072
  s_add_u32 s44, s44, s73
  buffer_load_dwordx4 v126, s[28:31], s44 offen sc1 lds
  s_add_u32 s44, s67, s40
  s_add_u32 s44, s44, 12
  s_and_b32 s44, s44, 15
  s_mul_i32 s44, s44, s61
  s_lshl_b32 s45, s40, 10
  s_add_u32 m0, s45, 135168
  s_add_u32 s44, s44, s73
  buffer_load_dwordx4 v126, s[28:31], s44 offen sc1 lds
  s_add_u32 s44, s67, 2
  s_and_b32 s44, s44, 15
  s_mul_i32 s45, s44, 393216
  s_add_u32 s69, s45, s60
  s_add_u32 s70, s69, 4096
  s_add_u32 m0, s63, 49152
  s_nop 0
  buffer_load_dwordx4 v124, s[8:11], s69 offen offset:0  lds
  buffer_load_dwordx4 v125, s[8:11], s69 offen offset:1024  lds
  buffer_load_dwordx4 v124, s[8:11], s69 offen offset:2048  lds
  buffer_load_dwordx4 v125, s[8:11], s69 offen offset:3072  lds
  s_add_u32 m0, s63, 53248
  s_nop 0
  buffer_load_dwordx4 v124, s[8:11], s70 offen offset:0  lds
  buffer_load_dwordx4 v125, s[8:11], s70 offen offset:1024  lds
  s_add_u32 s44, s67, 2
  s_and_b32 s44, s44, 15
  s_mul_i32 s45, s44, s61
  s_add_u32 s68, s45, s59
  s_add_u32 m0, s62, 106496
  s_nop 0
  buffer_load_dwordx4 v120, s[28:31], s68 offen offset:0 sc1  lds
  buffer_load_dwordx4 v121, s[28:31], s68 offen offset:1024 sc1  lds
  buffer_load_dwordx4 v122, s[28:31], s68 offen offset:2048 sc1  lds
  buffer_load_dwordx4 v123, s[28:31], s68 offen offset:3072 sc1  lds
  s_branch Lp1_common
Llayer:
  s_cmp_lg_u32 s40, 0
  s_cbranch_scc1 Lpdn2
  s_mov_b32 s43, 0x40000
  s_mov_b64 exec, 3
Lpol1:
  buffer_load_dword v250, v249, s[4:7], s77 offen sc1
  s_waitcnt vmcnt(0)
  v_cmp_gt_u32 vcc, 16, v250
  s_cbranch_vccz Lpdn2
  s_sub_u32 s43, s43, 1
  s_cmp_lg_u32 s43, 0
  s_cbranch_scc1 Lpol1
Lpdn2:
  s_mov_b64 exec, -1
  s_waitcnt vmcnt(0) lgkmcnt(0)
  s_barrier
  s_add_u32 s44, s67, s40
  s_add_u32 s44, s44, 0
  s_and_b32 s44, s44, 15
  s_mul_i32 s44, s44, s61
  s_lshl_b32 s45, s40, 10
  s_add_u32 m0, s45, 122880
  s_add_u32 s44, s44, s73
  buffer_load_dwordx4 v126, s[28:31], s44 offen sc1 lds
  s_add_u32 s44, s67, 0
  s_and_b32 s44, s44, 15
  s_mul_i32 s45, s44, s61
  s_add_u32 s68, s45, s59
  s_add_u32 m0, s62, 73728
  s_nop 0
  buffer_load_dwordx4 v120, s[28:31], s68 offen offset:0 sc1  lds
  buffer_load_dwordx4 v121, s[28:31], s68 offen offset:1024 sc1  lds
  buffer_load_dwordx4 v122, s[28:31], s68 offen offset:2048 sc1  lds
  buffer_load_dwordx4 v123, s[28:31], s68 offen offset:3072 sc1  lds
  s_add_u32 s44, s67, 1
  s_and_b32 s44, s44, 15
  s_mul_i32 s45, s44, s61
  s_add_u32 s68, s45, s59
  s_add_u32 m0, s62, 90112
  s_nop 0
  buffer_load_dwordx4 v120, s[28:31], s68 offen offset:0 sc1  lds
  buffer_load_dwordx4 v121, s[28:31], s68 offen offset:1024 sc1  lds
  buffer_load_dwordx4 v122, s[28:31], s68 offen offset:2048 sc1  lds
  buffer_load_dwordx4 v123, s[28:31], s68 offen offset:3072 sc1  lds
  s_waitcnt vmcnt(4)
  s_barrier
  ds_read_b64_tr_b16 a[40:41], v116 offset:0
  ds_read_b64_tr_b16 a[42:43], v116 offset:6144
  ds_read_b64_tr_b16 a[64:65], v116 offset:12288
  ds_read_b64_tr_b16 a[66:67], v116 offset:18432
  ds_read_b128 a[4:7], v112 offset:0
  ds_read_b128 a[24:27], v113 offset:0
  ds_read_b128 a[8:11], v112 offset:2048
  ds_read_b128 a[28:31], v113 offset:2048
  ds_read_b128 a[12:15], v112 offset:4096
  ds_read_b128 a[32:35], v113 offset:4096
  ds_read_b128 a[16:19], v112 offset:6144
  ds_read_b128 a[36:39], v113 offset:6144
  ds_read_b64_tr_b16 a[44:45], v117 offset:0
  ds_read_b64_tr_b16 a[46:47], v117 offset:6144
  ds_read_b64_tr_b16 a[68:69], v117 offset:12288
  ds_read_b64_tr_b16 a[70:71], v117 offset:18432
  ds_read_b128 a[0:3], v114
  v_add_u32 v114, s64, v114
  ds_read_b128 a[20:23], v115
  v_add_u32 v115, s64, v115
  ds_read_b64_tr_b16 a[48:49], v116 offset:2048
  ds_read_b64_tr_b16 a[50:51], v116 offset:8192
  ds_read_b64_tr_b16 a[72:73], v116 offset:14336
  ds_read_b64_tr_b16 a[74:75], v116 offset:20480
  ds_read_b64_tr_b16 a[52:53], v117 offset:2048
  ds_read_b64_tr_b16 a[54:55], v117 offset:8192
  ds_read_b64_tr_b16 a[76:77], v117 offset:14336
  ds_read_b64_tr_b16 a[78:79], v117 offset:20480
  ds_read_b64_tr_b16 a[56:57], v116 offset:4096
  ds_read_b64_tr_b16 a[58:59], v116 offset:10240
  ds_read_b64_tr_b16 a[80:81], v116 offset:16384
  ds_read_b64_tr_b16 a[82:83], v116 offset:22528
  ds_read_b64_tr_b16 a[60:61], v117 offset:4096
  ds_read_b64_tr_b16 a[62:63], v117 offset:10240
  ds_read_b64_tr_b16 a[84:85], v117 offset:16384
  ds_read_b64_tr_b16 a[86:87], v117 offset:22528
  s_add_u32 s44, s67, s40
  s_add_u32 s44, s44, 4
  s_and_b32 s44, s44, 15
  s_mul_i32 s44, s44, s61
  s_lshl_b32 s45, s40, 10
  s_add_u32 m0, s45, 126976
  s_add_u32 s44, s44, s73
  buffer_load_dwordx4 v126, s[28:31], s44 offen sc1 lds
  s_add_u32 s44, s67, s40
  s_add_u32 s44, s44, 8
  s_and_b32 s44, s44, 15
  s_mul_i32 s44, s44, s61
  s_lshl_b32 s45, s40, 10
  s_add_u32 m0, s45, 131072
  s_add_u32 s44, s44, s73
  buffer_load_dwordx4 v126, s[28:31], s44 offen sc1 lds
  s_add_u32 s44, s67, s40
  s_add_u32 s44, s44, 12
  s_and_b32 s44, s44, 15
  s_mul_i32 s44, s44, s61
  s_lshl_b32 s45, s40, 10
  s_add_u32 m0, s45, 135168
  s_add_u32 s44, s44, s73
  buffer_load_dwordx4 v126, s[28:31], s44 offen sc1 lds
  s_add_u32 s44, s67, 2
  s_and_b32 s44, s44, 15
  s_mul_i32 s45, s44, s61
  s_add_u32 s68, s45, s59
  s_add_u32 m0, s62, 106496
  s_nop 0
  buffer_load_dwordx4 v120, s[28:31], s68 offen offset:0 sc1  lds
  buffer_load_dwordx4 v121, s[28:31], s68 offen offset:1024 sc1  lds
  buffer_load_dwordx4 v122, s[28:31], s68 offen offset:2048 sc1  lds
  buffer_load_dwordx4 v123, s[28:31], s68 offen offset:3072 sc1  lds
Lp1_common:
  s_mov_b32 s66, 4
  s_add_u32 s44, s67, 3
  s_and_b32 s44, s44, 15
  s_mul_i32 s45, s44, s61
  s_add_u32 s68, s45, s59
  s_mov_b32 s56, 2
.p2align 3
Lp1_loop:
  s_waitcnt lgkmcnt(15)
  v_mfma_f32_16x16x32_bf16 v[0:3], a[40:43], a[4:7], v[0:3]
  s_mul_i32 s45, s44, 393216
  v_mfma_f32_16x16x32_bf16 v[0:3], a[64:67], a[24:27], v[0:3]
  s_add_u32 s69, s45, s60
  v_mfma_f32_16x16x32_bf16 v[4:7], a[64:67], a[28:31], v[4:7]
  s_add_u32 s70, s69, 4096
  v_mfma_f32_16x16x32_bf16 v[4:7], a[40:43], a[8:11], v[4:7]
  v_mfma_f32_16x16x32_bf16 v[8:11], a[40:43], a[12:15], v[8:11]
  v_mfma_f32_16x16x32_bf16 v[8:11], a[64:67], a[32:35], v[8:11]
  v_mfma_f32_16x16x32_bf16 v[12:15], a[64:67], a[36:39], v[12:15]
  v_mfma_f32_16x16x32_bf16 v[12:15], a[40:43], a[16:19], v[12:15]
  v_mfma_f32_16x16x32_bf16 v[28:31], a[44:47], a[16:19], v[28:31]
  v_mfma_f32_16x16x32_bf16 v[28:31], a[68:71], a[36:39], v[28:31]
  v_mfma_f32_16x16x32_bf16 v[24:27], a[68:71], a[32:35], v[24:27]
  v_mfma_f32_16x16x32_bf16 v[24:27], a[44:47], a[12:15], v[24:27]
  v_mfma_f32_16x16x32_bf16 v[20:23], a[44:47], a[8:11], v[20:23]
  s_waitcnt vmcnt(7) lgkmcnt(0)
  s_barrier
  ds_read_b64_tr_b16 a[128:129], v116 offset:24576
  v_mfma_f32_16x16x32_bf16 v[20:23], a[68:71], a[28:31], v[20:23]
  ds_read_b64_tr_b16 a[130:131], v116 offset:30720
  s_add_u32 m0, s62, 73728
  v_mfma_f32_16x16x32_bf16 v[16:19], a[68:71], a[24:27], v[16:19]
  ds_read_b64_tr_b16 a[152:153], v116 offset:36864
  buffer_load_dwordx4 v120, s[28:31], s68 offen offset:0 sc1  lds
  v_mfma_f32_16x16x32_bf16 v[16:19], a[44:47], a[4:7], v[16:19]
  ds_read_b64_tr_b16 a[154:155], v116 offset:43008
  v_mfma_f32_16x16x32_bf16 v[32:35], a[48:51], a[0:3], v[32:35]
  ds_read_b128 a[92:95], v112 offset:16384
  v_mfma_f32_16x16x32_bf16 v[32:35], a[72:75], a[20:23], v[32:35]
  ds_read_b128 a[112:115], v113 offset:16384
  v_mfma_f32_16x16x32_bf16 v[36:39], a[72:75], a[24:27], v[36:39]
  ds_read_b128 a[96:99], v112 offset:18432
  buffer_load_dwordx4 v121, s[28:31], s68 offen offset:1024 sc1  lds
  v_mfma_f32_16x16x32_bf16 v[36:39], a[48:51], a[4:7], v[36:39]
  ds_read_b128 a[116:119], v113 offset:18432
  v_mfma_f32_16x16x32_bf16 v[40:43], a[48:51], a[8:11], v[40:43]
  ds_read_b128 a[100:103], v112 offset:20480
  v_mfma_f32_16x16x32_bf16 v[40:43], a[72:75], a[28:31], v[40:43]
  ds_read_b128 a[120:123], v113 offset:20480
  v_mfma_f32_16x16x32_bf16 v[44:47], a[72:75], a[32:35], v[44:47]
  ds_read_b128 a[104:107], v112 offset:22528
  buffer_load_dwordx4 v122, s[28:31], s68 offen offset:2048 sc1  lds
  v_mfma_f32_16x16x32_bf16 v[44:47], a[48:51], a[12:15], v[44:47]
  ds_read_b128 a[124:127], v113 offset:22528
  v_mfma_f32_16x16x32_bf16 v[48:51], a[48:51], a[16:19], v[48:51]
  ds_read_b64_tr_b16 a[132:133], v117 offset:24576
  v_mfma_f32_16x16x32_bf16 v[48:51], a[72:75], a[36:39], v[48:51]
  ds_read_b64_tr_b16 a[134:135], v117 offset:30720
  v_mfma_f32_16x16x32_bf16 v[68:71], a[76:79], a[36:39], v[68:71]
  ds_read_b64_tr_b16 a[156:157], v117 offset:36864
  buffer_load_dwordx4 v123, s[28:31], s68 offen offset:3072 sc1  lds
  v_mfma_f32_16x16x32_bf16 v[68:71], a[52:55], a[16:19], v[68:71]
  ds_read_b64_tr_b16 a[158:159], v117 offset:43008
  v_mfma_f32_16x16x32_bf16 v[64:67], a[52:55], a[12:15], v[64:67]
  ds_read_b128 a[88:91], v114
  v_add_u32 v114, s64, v114
  v_mfma_f32_16x16x32_bf16 v[64:67], a[76:79], a[32:35], v[64:67]
  s_add_u32 m0, s63, 0
  ds_read_b128 a[108:111], v115
  v_add_u32 v115, s64, v115
  v_mfma_f32_16x16x32_bf16 v[60:63], a[76:79], a[28:31], v[60:63]
  ds_read_b64_tr_b16 a[136:137], v116 offset:26624
  buffer_load_dwordx4 v124, s[8:11], s69 offen offset:0  lds
  v_mfma_f32_16x16x32_bf16 v[60:63], a[52:55], a[8:11], v[60:63]
  ds_read_b64_tr_b16 a[138:139], v116 offset:32768
  v_mfma_f32_16x16x32_bf16 v[56:59], a[52:55], a[4:7], v[56:59]
  ds_read_b64_tr_b16 a[160:161], v116 offset:38912
  v_mfma_f32_16x16x32_bf16 v[56:59], a[76:79], a[24:27], v[56:59]
  ds_read_b64_tr_b16 a[162:163], v116 offset:45056
  v_mfma_f32_16x16x32_bf16 v[52:55], a[76:79], a[20:23], v[52:55]
  ds_read_b64_tr_b16 a[140:141], v117 offset:26624
  buffer_load_dwordx4 v125, s[8:11], s69 offen offset:1024  lds
  v_mfma_f32_16x16x32_bf16 v[52:55], a[52:55], a[0:3], v[52:55]
  ds_read_b64_tr_b16 a[142:143], v117 offset:32768
  v_mfma_f32_16x16x32_bf16 v[72:75], a[0:3], a[56:59], v[72:75]
  ds_read_b64_tr_b16 a[164:165], v117 offset:38912
  v_mfma_f32_16x16x32_bf16 v[72:75], a[20:23], a[80:83], v[72:75]
  ds_read_b64_tr_b16 a[166:167], v117 offset:45056
  v_mfma_f32_16x16x32_bf16 v[76:79], a[24:27], a[80:83], v[76:79]
  ds_read_b64_tr_b16 a[144:145], v116 offset:28672
  buffer_load_dwordx4 v124, s[8:11], s69 offen offset:2048  lds
  v_mfma_f32_16x16x32_bf16 v[76:79], a[4:7], a[56:59], v[76:79]
  ds_read_b64_tr_b16 a[146:147], v116 offset:34816
  v_mfma_f32_16x16x32_bf16 v[80:83], a[8:11], a[56:59], v[80:83]
  ds_read_b64_tr_b16 a[168:169], v116 offset:40960
  v_mfma_f32_16x16x32_bf16 v[80:83], a[28:31], a[80:83], v[80:83]
  ds_read_b64_tr_b16 a[170:171], v116 offset:47104
  v_mfma_f32_16x16x32_bf16 v[84:87], a[32:35], a[80:83], v[84:87]
  ds_read_b64_tr_b16 a[148:149], v117 offset:28672
  buffer_load_dwordx4 v125, s[8:11], s69 offen offset:3072  lds
  v_mfma_f32_16x16x32_bf16 v[84:87], a[12:15], a[56:59], v[84:87]
  ds_read_b64_tr_b16 a[150:151], v117 offset:34816
  v_mfma_f32_16x16x32_bf16 v[88:91], a[16:19], a[56:59], v[88:91]
  ds_read_b64_tr_b16 a[172:173], v117 offset:40960
  v_mfma_f32_16x16x32_bf16 v[88:91], a[36:39], a[80:83], v[88:91]
  ds_read_b64_tr_b16 a[174:175], v117 offset:47104
  s_add_u32 m0, s63, 4096
  v_mfma_f32_16x16x32_bf16 v[108:111], a[36:39], a[84:87], v[108:111]
  buffer_load_dwordx4 v124, s[8:11], s70 offen offset:0  lds
  v_mfma_f32_16x16x32_bf16 v[108:111], a[16:19], a[60:63], v[108:111]
  s_add_u32 s44, s44, 1
  v_mfma_f32_16x16x32_bf16 v[104:107], a[12:15], a[60:63], v[104:107]
  s_and_b32 s44, s44, 15
  v_mfma_f32_16x16x32_bf16 v[104:107], a[32:35], a[84:87], v[104:107]
  s_add_u32 s66, s66, 1
  v_mfma_f32_16x16x32_bf16 v[100:103], a[28:31], a[84:87], v[100:103]
  s_mul_i32 s45, s44, s61
  buffer_load_dwordx4 v125, s[8:11], s70 offen offset:1024  lds
  v_mfma_f32_16x16x32_bf16 v[100:103], a[8:11], a[60:63], v[100:103]
  s_add_u32 s68, s45, s59
  v_mfma_f32_16x16x32_bf16 v[96:99], a[4:7], a[60:63], v[96:99]
  v_mfma_f32_16x16x32_bf16 v[96:99], a[24:27], a[84:87], v[96:99]
  v_mfma_f32_16x16x32_bf16 v[92:95], a[20:23], a[84:87], v[92:95]
  v_mfma_f32_16x16x32_bf16 v[92:95], a[0:3], a[60:63], v[92:95]
  s_cmp_eq_u32 s66, s88
  s_cbranch_scc0 Lside_skip0
  s_call_b64 s[78:79], Lside_sub
Lside_skip0:
  s_waitcnt lgkmcnt(15)
  v_mfma_f32_16x16x32_bf16 v[0:3], a[128:131], a[92:95], v[0:3]
  s_mul_i32 s45, s44, 393216
  v_mfma_f32_16x16x32_bf16 v[0:3], a[152:155], a[112:115], v[0:3]
  s_add_u32 s69, s45, s60
  v_mfma_f32_16x16x32_bf16 v[4:7], a[152:155], a[116:119], v[4:7]
  s_add_u32 s70, s69, 4096
  v_mfma_f32_16x16x32_bf16 v[4:7], a[128:131], a[96:99], v[4:7]
  v_mfma_f32_16x16x32_bf16 v[8:11], a[128:131], a[100:103], v[8:11]
  v_mfma_f32_16x16x32_bf16 v[8:11], a[152:155], a[120:123], v[8:11]
  v_mfma_f32_16x16x32_bf16 v[12:15], a[152:155], a[124:127], v[12:15]
  v_mfma_f32_16x16x32_bf16 v[12:15], a[128:131], a[104:107], v[12:15]
  v_mfma_f32_16x16x32_bf16 v[28:31], a[132:135], a[104:107], v[28:31]
  v_mfma_f32_16x16x32_bf16 v[28:31], a[156:159], a[124:127], v[28:31]
  v_mfma_f32_16x16x32_bf16 v[24:27], a[156:159], a[120:123], v[24:27]
  v_mfma_f32_16x16x32_bf16 v[24:27], a[132:135], a[100:103], v[24:27]
  v_mfma_f32_16x16x32_bf16 v[20:23], a[132:135], a[96:99], v[20:23]
  s_waitcnt vmcnt(10) lgkmcnt(0)
  s_barrier
  ds_read_b64_tr_b16 a[40:41], v118 offset:0
  v_mfma_f32_16x16x32_bf16 v[20:23], a[156:159], a[116:119], v[20:23]
  ds_read_b64_tr_b16 a[42:43], v118 offset:6144
  s_add_u32 m0, s62, 90112
  v_mfma_f32_16x16x32_bf16 v[16:19], a[156:159], a[112:115], v[16:19]
  ds_read_b64_tr_b16 a[64:65], v118 offset:12288
  buffer_load_dwordx4 v120, s[28:31], s68 offen offset:0 sc1  lds
  v_mfma_f32_16x16x32_bf16 v[16:19], a[132:135], a[92:95], v[16:19]
  ds_read_b64_tr_b16 a[66:67], v118 offset:18432
  v_mfma_f32_16x16x32_bf16 v[32:35], a[136:139], a[88:91], v[32:35]
  ds_read_b128 a[4:7], v112 offset:32768
  v_mfma_f32_16x16x32_bf16 v[32:35], a[160:163], a[108:111], v[32:35]
  ds_read_b128 a[24:27], v113 offset:32768
  v_mfma_f32_16x16x32_bf16 v[36:39], a[160:163], a[112:115], v[36:39]
  ds_read_b128 a[8:11], v112 offset:34816
  buffer_load_dwordx4 v121, s[28:31], s68 offen offset:1024 sc1  lds
  v_mfma_f32_16x16x32_bf16 v[36:39], a[136:139], a[92:95], v[36:39]
  ds_read_b128 a[28:31], v113 offset:34816
  v_mfma_f32_16x16x32_bf16 v[40:43], a[136:139], a[96:99], v[40:43]
  ds_read_b128 a[12:15], v112 offset:36864
  v_mfma_f32_16x16x32_bf16 v[40:43], a[160:163], a[116:119], v[40:43]
  ds_read_b128 a[32:35], v113 offset:36864
  v_mfma_f32_16x16x32_bf16 v[44:47], a[160:163], a[120:123], v[44:47]
  ds_read_b128 a[16:19], v112 offset:38912
  buffer_load_dwordx4 v122, s[28:31], s68 offen offset:2048 sc1  lds
  v_mfma_f32_16x16x32_bf16 v[44:47], a[136:139], a[100:103], v[44:47]
  ds_read_b128 a[36:39], v113 offset:38912
  v_mfma_f32_16x16x32_bf16 v[48:51], a[136:139], a[104:107], v[48:51]
  ds_read_b64_tr_b16 a[44:45], v119 offset:0
  v_mfma_f32_16x16x32_bf16 v[48:51], a[160:163], a[124:127], v[48:51]
  ds_read_b64_tr_b16 a[46:47], v119 offset:6144
  v_mfma_f32_16x16x32_bf16 v[68:71], a[164:167], a[124:127], v[68:71]
  ds_read_b64_tr_b16 a[68:69], v119 offset:12288
  buffer_load_dwordx4 v123, s[28:31], s68 offen offset:3072 sc1  lds
  v_mfma_f32_16x16x32_bf16 v[68:71], a[140:143], a[104:107], v[68:71]
  ds_read_b64_tr_b16 a[70:71], v119 offset:18432
  v_mfma_f32_16x16x32_bf16 v[64:67], a[140:143], a[100:103], v[64:67]
  ds_read_b128 a[0:3], v114
  v_add_u32 v114, s65, v114
  v_mfma_f32_16x16x32_bf16 v[64:67], a[164:167], a[120:123], v[64:67]
  s_add_u32 m0, s63, 24576
  ds_read_b128 a[20:23], v115
  v_add_u32 v115, s65, v115
  v_mfma_f32_16x16x32_bf16 v[60:63], a[164:167], a[116:119], v[60:63]
  ds_read_b64_tr_b16 a[48:49], v118 offset:2048
  buffer_load_dwordx4 v124, s[8:11], s69 offen offset:0  lds
  v_mfma_f32_16x16x32_bf16 v[60:63], a[140:143], a[96:99], v[60:63]
  ds_read_b64_tr_b16 a[50:51], v118 offset:8192
  v_mfma_f32_16x16x32_bf16 v[56:59], a[140:143], a[92:95], v[56:59]
  ds_read_b64_tr_b16 a[72:73], v118 offset:14336
  v_mfma_f32_16x16x32_bf16 v[56:59], a[164:167], a[112:115], v[56:59]
  ds_read_b64_tr_b16 a[74:75], v118 offset:20480
  v_mfma_f32_16x16x32_bf16 v[52:55], a[164:167], a[108:111], v[52:55]
  ds_read_b64_tr_b16 a[52:53], v119 offset:2048
  buffer_load_dwordx4 v125, s[8:11], s69 offen offset:1024  lds
  v_mfma_f32_16x16x32_bf16 v[52:55], a[140:143], a[88:91], v[52:55]
  ds_read_b64_tr_b16 a[54:55], v119 offset:8192
  v_mfma_f32_16x16x32_bf16 v[72:75], a[88:91], a[144:147], v[72:75]
  ds_read_b64_tr_b16 a[76:77], v119 offset:14336
  v_mfma_f32_16x16x32_bf16 v[72:75], a[108:111], a[168:171], v[72:75]
  ds_read_b64_tr_b16 a[78:79], v119 offset:20480
  v_mfma_f32_16x16x32_bf16 v[76:79], a[112:115], a[168:171], v[76:79]
  ds_read_b64_tr_b16 a[56:57], v118 offset:4096
  buffer_load_dwordx4 v124, s[8:11], s69 offen offset:2048  lds
  v_mfma_f32_16x16x32_bf16 v[76:79], a[92:95], a[144:147], v[76:79]
  ds_read_b64_tr_b16 a[58:59], v118 offset:10240
  v_mfma_f32_16x16x32_bf16 v[80:83], a[96:99], a[144:147], v[80:83]
  ds_read_b64_tr_b16 a[80:81], v118 offset:16384
  v_mfma_f32_16x16x32_bf16 v[80:83], a[116:119], a[168:171], v[80:83]
  ds_read_b64_tr_b16 a[82:83], v118 offset:22528
  v_mfma_f32_16x16x32_bf16 v[84:87], a[120:123], a[168:171], v[84:87]
  ds_read_b64_tr_b16 a[60:61], v119 offset:4096
  buffer_load_dwordx4 v125, s[8:11], s69 offen offset:3072  lds
  v_mfma_f32_16x16x32_bf16 v[84:87], a[100:103], a[144:147], v[84:87]
  ds_read_b64_tr_b16 a[62:63], v119 offset:10240
  v_mfma_f32_16x16x32_bf16 v[88:91], a[104:107], a[144:147], v[88:91]
  ds_read_b64_tr_b16 a[84:85], v119 offset:16384
  v_mfma_f32_16x16x32_bf16 v[88:91], a[124:127], a[168:171], v[88:91]
  ds_read_b64_tr_b16 a[86:87], v119 offset:22528
  s_add_u32 m0, s63, 28672
  v_mfma_f32_16x16x32_bf16 v[108:111], a[124:127], a[172:175], v[108:111]
  buffer_load_dwordx4 v124, s[8:11], s70 offen offset:0  lds
  v_mfma_f32_16x16x32_bf16 v[108:111], a[104:107], a[148:151], v[108:111]
  s_add_u32 s44, s44, 1
  v_mfma_f32_16x16x32_bf16 v[104:107], a[100:103], a[148:151], v[104:107]
  s_and_b32 s44, s44, 15
  v_mfma_f32_16x16x32_bf16 v[104:107], a[120:123], a[172:175], v[104:107]
  s_add_u32 s66, s66, 1
  v_mfma_f32_16x16x32_bf16 v[100:103], a[116:119], a[172:175], v[100:103]
  s_mul_i32 s45, s44, s61
  buffer_load_dwordx4 v125, s[8:11], s70 offen offset:1024  lds
  v_mfma_f32_16x16x32_bf16 v[100:103], a[96:99], a[148:151], v[100:103]
  s_add_u32 s68, s45, s59
  v_mfma_f32_16x16x32_bf16 v[96:99], a[92:95], a[148:151], v[96:99]
  v_mfma_f32_16x16x32_bf16 v[96:99], a[112:115], a[172:175], v[96:99]
  v_mfma_f32_16x16x32_bf16 v[92:95], a[108:111], a[172:175], v[92:95]
  v_mfma_f32_16x16x32_bf16 v[92:95], a[88:91], a[148:151], v[92:95]
  s_cmp_eq_u32 s66, s88
  s_cbranch_scc0 Lside_skip1
  s_call_b64 s[78:79], Lside_sub
Lside_skip1:
  s_waitcnt lgkmcnt(15)
  v_mfma_f32_16x16x32_bf16 v[0:3], a[40:43], a[4:7], v[0:3]
  s_mul_i32 s45, s44, 393216
  v_mfma_f32_16x16x32_bf16 v[0:3], a[64:67], a[24:27], v[0:3]
  s_add_u32 s69, s45, s60
  v_mfma_f32_16x16x32_bf16 v[4:7], a[64:67], a[28:31], v[4:7]
  s_add_u32 s70, s69, 4096
  v_mfma_f32_16x16x32_bf16 v[4:7], a[40:43], a[8:11], v[4:7]
  v_mfma_f32_16x16x32_bf16 v[8:11], a[40:43], a[12:15], v[8:11]
  v_mfma_f32_16x16x32_bf16 v[8:11], a[64:67], a[32:35], v[8:11]
  v_mfma_f32_16x16x32_bf16 v[12:15], a[64:67], a[36:39], v[12:15]
  v_mfma_f32_16x16x32_bf16 v[12:15], a[40:43], a[16:19], v[12:15]
  v_mfma_f32_16x16x32_bf16 v[28:31], a[44:47], a[16:19], v[28:31]
  v_mfma_f32_16x16x32_bf16 v[28:31], a[68:71], a[36:39], v[28:31]
  v_mfma_f32_16x16x32_bf16 v[24:27], a[68:71], a[32:35], v[24:27]
  v_mfma_f32_16x16x32_bf16 v[24:27], a[44:47], a[12:15], v[24:27]
  v_mfma_f32_16x16x32_bf16 v[20:23], a[44:47], a[8:11], v[20:23]
  s_waitcnt vmcnt(10) lgkmcnt(0)
  s_barrier
  ds_read_b64_tr_b16 a[128:129], v116 offset:0
  v_mfma_f32_16x16x32_bf16 v[20:23], a[68:71], a[28:31], v[20:23]
  ds_read_b64_tr_b16 a[130:131], v116 offset:6144
  s_add_u32 m0, s62, 106496
  v_mfma_f32_16x16x32_bf16 v[16:19], a[68:71], a[24:27], v[16:19]
  ds_read_b64_tr_b16 a[152:153], v116 offset:12288
  buffer_load_dwordx4 v120, s[28:31], s68 offen offset:0 sc1  lds
  v_mfma_f32_16x16x32_bf16 v[16:19], a[44:47], a[4:7], v[16:19]
  ds_read_b64_tr_b16 a[154:155], v116 offset:18432
  v_mfma_f32_16x16x32_bf16 v[32:35], a[48:51], a[0:3], v[32:35]
  ds_read_b128 a[92:95], v112 offset:0
  v_mfma_f32_16x16x32_bf16 v[32:35], a[72:75], a[20:23], v[32:35]
  ds_read_b128 a[112:115], v113 offset:0
  v_mfma_f32_16x16x32_bf16 v[36:39], a[72:75], a[24:27], v[36:39]
  ds_read_b128 a[96:99], v112 offset:2048
  buffer_load_dwordx4 v121, s[28:31], s68 offen offset:1024 sc1  lds
  v_mfma_f32_16x16x32_bf16 v[36:39], a[48:51], a[4:7], v[36:39]
  ds_read_b128 a[116:119], v113 offset:2048
  v_mfma_f32_16x16x32_bf16 v[40:43], a[48:51], a[8:11], v[40:43]
  ds_read_b128 a[100:103], v112 offset:4096
  v_mfma_f32_16x16x32_bf16 v[40:43], a[72:75], a[28:31], v[40:43]
  ds_read_b128 a[120:123], v113 offset:4096
  v_mfma_f32_16x16x32_bf16 v[44:47], a[72:75], a[32:35], v[44:47]
  ds_read_b128 a[104:107], v112 offset:6144
  buffer_load_dwordx4 v122, s[28:31], s68 offen offset:2048 sc1  lds
  v_mfma_f32_16x16x32_bf16 v[44:47], a[48:51], a[12:15], v[44:47]
  ds_read_b128 a[124:127], v113 offset:6144
  v_mfma_f32_16x16x32_bf16 v[48:51], a[48:51], a[16:19], v[48:51]
  ds_read_b64_tr_b16 a[132:133], v117 offset:0
  v_mfma_f32_16x16x32_bf16 v[48:51], a[72:75], a[36:39], v[48:51]
  ds_read_b64_tr_b16 a[134:135], v117 offset:6144
  v_mfma_f32_16x16x32_bf16 v[68:71], a[76:79], a[36:39], v[68:71]
  ds_read_b64_tr_b16 a[156:157], v117 offset:12288
  buffer_load_dwordx4 v123, s[28:31], s68 offen offset:3072 sc1  lds
  v_mfma_f32_16x16x32_bf16 v[68:71], a[52:55], a[16:19], v[68:71]
  ds_read_b64_tr_b16 a[158:159], v117 offset:18432
  v_mfma_f32_16x16x32_bf16 v[64:67], a[52:55], a[12:15], v[64:67]
  ds_read_b128 a[88:91], v114
  v_add_u32 v114, s64, v114
  v_mfma_f32_16x16x32_bf16 v[64:67], a[76:79], a[32:35], v[64:67]
  s_add_u32 m0, s63, 49152
  ds_read_b128 a[108:111], v115
  v_add_u32 v115, s64, v115
  v_mfma_f32_16x16x32_bf16 v[60:63], a[76:79], a[28:31], v[60:63]
  ds_read_b64_tr_b16 a[136:137], v116 offset:2048
  buffer_load_dwordx4 v124, s[8:11], s69 offen offset:0  lds
  v_mfma_f32_16x16x32_bf16 v[60:63], a[52:55], a[8:11], v[60:63]
  ds_read_b64_tr_b16 a[138:139], v116 offset:8192
  v_mfma_f32_16x16x32_bf16 v[56:59], a[52:55], a[4:7], v[56:59]
  ds_read_b64_tr_b16 a[160:161], v116 offset:14336
  v_mfma_f32_16x16x32_bf16 v[56:59], a[76:79], a[24:27], v[56:59]
  ds_read_b64_tr_b16 a[162:163], v116 offset:20480
  v_mfma_f32_16x16x32_bf16 v[52:55], a[76:79], a[20:23], v[52:55]
  ds_read_b64_tr_b16 a[140:141], v117 offset:2048
  buffer_load_dwordx4 v125, s[8:11], s69 offen offset:1024  lds
  v_mfma_f32_16x16x32_bf16 v[52:55], a[52:55], a[0:3], v[52:55]
  ds_read_b64_tr_b16 a[142:143], v117 offset:8192
  v_mfma_f32_16x16x32_bf16 v[72:75], a[0:3], a[56:59], v[72:75]
  ds_read_b64_tr_b16 a[164:165], v117 offset:14336
  v_mfma_f32_16x16x32_bf16 v[72:75], a[20:23], a[80:83], v[72:75]
  ds_read_b64_tr_b16 a[166:167], v117 offset:20480
  v_mfma_f32_16x16x32_bf16 v[76:79], a[24:27], a[80:83], v[76:79]
  ds_read_b64_tr_b16 a[144:145], v116 offset:4096
  buffer_load_dwordx4 v124, s[8:11], s69 offen offset:2048  lds
  v_mfma_f32_16x16x32_bf16 v[76:79], a[4:7], a[56:59], v[76:79]
  ds_read_b64_tr_b16 a[146:147], v116 offset:10240
  v_mfma_f32_16x16x32_bf16 v[80:83], a[8:11], a[56:59], v[80:83]
  ds_read_b64_tr_b16 a[168:169], v116 offset:16384
  v_mfma_f32_16x16x32_bf16 v[80:83], a[28:31], a[80:83], v[80:83]
  ds_read_b64_tr_b16 a[170:171], v116 offset:22528
  v_mfma_f32_16x16x32_bf16 v[84:87], a[32:35], a[80:83], v[84:87]
  ds_read_b64_tr_b16 a[148:149], v117 offset:4096
  buffer_load_dwordx4 v125, s[8:11], s69 offen offset:3072  lds
  v_mfma_f32_16x16x32_bf16 v[84:87], a[12:15], a[56:59], v[84:87]
  ds_read_b64_tr_b16 a[150:151], v117 offset:10240
  v_mfma_f32_16x16x32_bf16 v[88:91], a[16:19], a[56:59], v[88:91]
  ds_read_b64_tr_b16 a[172:173], v117 offset:16384
  v_mfma_f32_16x16x32_bf16 v[88:91], a[36:39], a[80:83], v[88:91]
  ds_read_b64_tr_b16 a[174:175], v117 offset:22528
  s_add_u32 m0, s63, 53248
  v_mfma_f32_16x16x32_bf16 v[108:111], a[36:39], a[84:87], v[108:111]
  buffer_load_dwordx4 v124, s[8:11], s70 offen offset:0  lds
  v_mfma_f32_16x16x32_bf16 v[108:111], a[16:19], a[60:63], v[108:111]
  s_add_u32 s44, s44, 1
  v_mfma_f32_16x16x32_bf16 v[104:107], a[12:15], a[60:63], v[104:107]
  s_and_b32 s44, s44, 15
  v_mfma_f32_16x16x32_bf16 v[104:107], a[32:35], a[84:87], v[104:107]
  s_add_u32 s66, s66, 1
  v_mfma_f32_16x16x32_bf16 v[100:103], a[28:31], a[84:87], v[100:103]
  s_mul_i32 s45, s44, s61
  buffer_load_dwordx4 v125, s[8:11], s70 offen offset:1024  lds
  v_mfma_f32_16x16x32_bf16 v[100:103], a[8:11], a[60:63], v[100:103]
  s_add_u32 s68, s45, s59
  v_mfma_f32_16x16x32_bf16 v[96:99], a[4:7], a[60:63], v[96:99]
  v_mfma_f32_16x16x32_bf16 v[96:99], a[24:27], a[84:87], v[96:99]
  v_mfma_f32_16x16x32_bf16 v[92:95], a[20:23], a[84:87], v[92:95]
  v_mfma_f32_16x16x32_bf16 v[92:95], a[0:3], a[60:63], v[92:95]
  s_cmp_eq_u32 s66, s88
  s_cbranch_scc0 Lside_skip2
  s_call_b64 s[78:79], Lside_sub
Lside_skip2:
  s_waitcnt lgkmcnt(15)
  v_mfma_f32_16x16x32_bf16 v[0:3], a[128:131], a[92:95], v[0:3]
  s_mul_i32 s45, s44, 393216
  v_mfma_f32_16x16x32_bf16 v[0:3], a[152:155], a[112:115], v[0:3]
  s_add_u32 s69, s45, s60
  v_mfma_f32_16x16x32_bf16 v[4:7], a[152:155], a[116:119], v[4:7]
  s_add_u32 s70, s69, 4096
  v_mfma_f32_16x16x32_bf16 v[4:7], a[128:131], a[96:99], v[4:7]
  v_mfma_f32_16x16x32_bf16 v[8:11], a[128:131], a[100:103], v[8:11]
  v_mfma_f32_16x16x32_bf16 v[8:11], a[152:155], a[120:123], v[8:11]
  v_mfma_f32_16x16x32_bf16 v[12:15], a[152:155], a[124:127], v[12:15]
  v_mfma_f32_16x16x32_bf16 v[12:15], a[128:131], a[104:107], v[12:15]
  v_mfma_f32_16x16x32_bf16 v[28:31], a[132:135], a[104:107], v[28:31]
  v_mfma_f32_16x16x32_bf16 v[28:31], a[156:159], a[124:127], v[28:31]
  v_mfma_f32_16x16x32_bf16 v[24:27], a[156:159], a[120:123], v[24:27]
  v_mfma_f32_16x16x32_bf16 v[24:27], a[132:135], a[100:103], v[24:27]
  v_mfma_f32_16x16x32_bf16 v[20:23], a[132:135], a[96:99], v[20:23]
  s_waitcnt vmcnt(10) lgkmcnt(0)
  s_barrier
  ds_read_b64_tr_b16 a[40:41], v116 offset:24576
  v_mfma_f32_16x16x32_bf16 v[20:23], a[156:159], a[116:119], v[20:23]
  ds_read_b64_tr_b16 a[42:43], v116 offset:30720
  s_add_u32 m0, s62, 73728
  v_mfma_f32_16x16x32_bf16 v[16:19], a[156:159], a[112:115], v[16:19]
  ds_read_b64_tr_b16 a[64:65], v116 offset:36864
  buffer_load_dwordx4 v120, s[28:31], s68 offen offset:0 sc1  lds
  v_mfma_f32_16x16x32_bf16 v[16:19], a[132:135], a[92:95], v[16:19]
  ds_read_b64_tr_b16 a[66:67], v116 offset:43008
  v_mfma_f32_16x16x32_bf16 v[32:35], a[136:139], a[88:91], v[32:35]
  ds_read_b128 a[4:7], v112 offset:16384
  v_mfma_f32_16x16x32_bf16 v[32:35], a[160:163], a[108:111], v[32:35]
  ds_read_b128 a[24:27], v113 offset:16384
  v_mfma_f32_16x16x32_bf16 v[36:39], a[160:163], a[112:115], v[36:39]
  ds_read_b128 a[8:11], v112 offset:18432
  buffer_load_dwordx4 v121, s[28:31], s68 offen offset:1024 sc1  lds
  v_mfma_f32_16x16x32_bf16 v[36:39], a[136:139], a[92:95], v[36:39]
  ds_read_b128 a[28:31], v113 offset:18432
  v_mfma_f32_16x16x32_bf16 v[40:43], a[136:139], a[96:99], v[40:43]
  ds_read_b128 a[12:15], v112 offset:20480
  v_mfma_f32_16x16x32_bf16 v[40:43], a[160:163], a[116:119], v[40:43]
  ds_read_b128 a[32:35], v113 offset:20480
  v_mfma_f32_16x16x32_bf16 v[44:47], a[160:163], a[120:123], v[44:47]
  ds_read_b128 a[16:19], v112 offset:22528
  buffer_load_dwordx4 v122, s[28:31], s68 offen offset:2048 sc1  lds
  v_mfma_f32_16x16x32_bf16 v[44:47], a[136:139], a[100:103], v[44:47]
  ds_read_b128 a[36:39], v113 offset:22528
  v_mfma_f32_16x16x32_bf16 v[48:51], a[136:139], a[104:107], v[48:51]
  ds_read_b64_tr_b16 a[44:45], v117 offset:24576
  v_mfma_f32_16x16x32_bf16 v[48:51], a[160:163], a[124:127], v[48:51]
  ds_read_b64_tr_b16 a[46:47], v117 offset:30720
  v_mfma_f32_16x16x32_bf16 v[68:71], a[164:167], a[124:127], v[68:71]
  ds_read_b64_tr_b16 a[68:69], v117 offset:36864
  buffer_load_dwordx4 v123, s[28:31], s68 offen offset:3072 sc1  lds
  v_mfma_f32_16x16x32_bf16 v[68:71], a[140:143], a[104:107], v[68:71]
  ds_read_b64_tr_b16 a[70:71], v117 offset:43008
  v_mfma_f32_16x16x32_bf16 v[64:67], a[140:143], a[100:103], v[64:67]
  ds_read_b128 a[0:3], v114
  v_add_u32 v114, s64, v114
  v_mfma_f32_16x16x32_bf16 v[64:67], a[164:167], a[120:123], v[64:67]
  s_add_u32 m0, s63, 0
  ds_read_b128 a[20:23], v115
  v_add_u32 v115, s64, v115
  v_mfma_f32_16x16x32_bf16 v[60:63], a[164:167], a[116:119], v[60:63]
  ds_read_b64_tr_b16 a[48:49], v116 offset:26624
  buffer_load_dwordx4 v124, s[8:11], s69 offen offset:0  lds
  v_mfma_f32_16x16x32_bf16 v[60:63], a[140:143], a[96:99], v[60:63]
  ds_read_b64_tr_b16 a[50:51], v116 offset:32768
  v_mfma_f32_16x16x32_bf16 v[56:59], a[140:143], a[92:95], v[56:59]
  ds_read_b64_tr_b16 a[72:73], v116 offset:38912
  v_mfma_f32_16x16x32_bf16 v[56:59], a[164:167], a[112:115], v[56:59]
  ds_read_b64_tr_b16 a[74:75], v116 offset:45056
  v_mfma_f32_16x16x32_bf16 v[52:55], a[164:167], a[108:111], v[52:55]
  ds_read_b64_tr_b16 a[52:53], v117 offset:26624
  buffer_load_dwordx4 v125, s[8:11], s69 offen offset:1024  lds
  v_mfma_f32_16x16x32_bf16 v[52:55], a[140:143], a[88:91], v[52:55]
  ds_read_b64_tr_b16 a[54:55], v117 offset:32768
  v_mfma_f32_16x16x32_bf16 v[72:75], a[88:91], a[144:147], v[72:75]
  ds_read_b64_tr_b16 a[76:77], v117 offset:38912
  v_mfma_f32_16x16x32_bf16 v[72:75], a[108:111], a[168:171], v[72:75]
  ds_read_b64_tr_b16 a[78:79], v117 offset:45056
  v_mfma_f32_16x16x32_bf16 v[76:79], a[112:115], a[168:171], v[76:79]
  ds_read_b64_tr_b16 a[56:57], v116 offset:28672
  buffer_load_dwordx4 v124, s[8:11], s69 offen offset:2048  lds
  v_mfma_f32_16x16x32_bf16 v[76:79], a[92:95], a[144:147], v[76:79]
  ds_read_b64_tr_b16 a[58:59], v116 offset:34816
  v_mfma_f32_16x16x32_bf16 v[80:83], a[96:99], a[144:147], v[80:83]
  ds_read_b64_tr_b16 a[80:81], v116 offset:40960
  v_mfma_f32_16x16x32_bf16 v[80:83], a[116:119], a[168:171], v[80:83]
  ds_read_b64_tr_b16 a[82:83], v116 offset:47104
  v_mfma_f32_16x16x32_bf16 v[84:87], a[120:123], a[168:171], v[84:87]
  ds_read_b64_tr_b16 a[60:61], v117 offset:28672
  buffer_load_dwordx4 v125, s[8:11], s69 offen offset:3072  lds
  v_mfma_f32_16x16x32_bf16 v[84:87], a[100:103], a[144:147], v[84:87]
  ds_read_b64_tr_b16 a[62:63], v117 offset:34816
  v_mfma_f32_16x16x32_bf16 v[88:91], a[104:107], a[144:147], v[88:91]
  ds_read_b64_tr_b16 a[84:85], v117 offset:40960
  v_mfma_f32_16x16x32_bf16 v[88:91], a[124:127], a[168:171], v[88:91]
  ds_read_b64_tr_b16 a[86:87], v117 offset:47104
  s_add_u32 m0, s63, 4096
  v_mfma_f32_16x16x32_bf16 v[108:111], a[124:127], a[172:175], v[108:111]
  buffer_load_dwordx4 v124, s[8:11], s70 offen offset:0  lds
  v_mfma_f32_16x16x32_bf16 v[108:111], a[104:107], a[148:151], v[108:111]
  s_add_u32 s44, s44, 1
  v_mfma_f32_16x16x32_bf16 v[104:107], a[100:103], a[148:151], v[104:107]
  s_and_b32 s44, s44, 15
  v_mfma_f32_16x16x32_bf16 v[104:107], a[120:123], a[172:175], v[104:107]
  s_add_u32 s66, s66, 1
  v_mfma_f32_16x16x32_bf16 v[100:103], a[116:119], a[172:175], v[100:103]
  s_mul_i32 s45, s44, s61
  buffer_load_dwordx4 v125, s[8:11], s70 offen offset:1024  lds
  v_mfma_f32_16x16x32_bf16 v[100:103], a[96:99], a[148:151], v[100:103]
  s_add_u32 s68, s45, s59
  v_mfma_f32_16x16x32_bf16 v[96:99], a[92:95], a[148:151], v[96:99]
  v_mfma_f32_16x16x32_bf16 v[96:99], a[112:115], a[172:175], v[96:99]
  v_mfma_f32_16x16x32_bf16 v[92:95], a[108:111], a[172:175], v[92:95]
  v_mfma_f32_16x16x32_bf16 v[92:95], a[88:91], a[148:151], v[92:95]
  s_cmp_eq_u32 s66, s88
  s_cbranch_scc0 Lside_skip3
  s_call_b64 s[78:79], Lside_sub
Lside_skip3:
  s_waitcnt lgkmcnt(15)
  v_mfma_f32_16x16x32_bf16 v[0:3], a[40:43], a[4:7], v[0:3]
  s_mul_i32 s45, s44, 393216
  v_mfma_f32_16x16x32_bf16 v[0:3], a[64:67], a[24:27], v[0:3]
  s_add_u32 s69, s45, s60
  v_mfma_f32_16x16x32_bf16 v[4:7], a[64:67], a[28:31], v[4:7]
  s_add_u32 s70, s69, 4096
  v_mfma_f32_16x16x32_bf16 v[4:7], a[40:43], a[8:11], v[4:7]
  v_mfma_f32_16x16x32_bf16 v[8:11], a[40:43], a[12:15], v[8:11]
  v_mfma_f32_16x16x32_bf16 v[8:11], a[64:67], a[32:35], v[8:11]
  v_mfma_f32_16x16x32_bf16 v[12:15], a[64:67], a[36:39], v[12:15]
  v_mfma_f32_16x16x32_bf16 v[12:15], a[40:43], a[16:19], v[12:15]
  v_mfma_f32_16x16x32_bf16 v[28:31], a[44:47], a[16:19], v[28:31]
  v_mfma_f32_16x16x32_bf16 v[28:31], a[68:71], a[36:39], v[28:31]
  v_mfma_f32_16x16x32_bf16 v[24:27], a[68:71], a[32:35], v[24:27]
  v_mfma_f32_16x16x32_bf16 v[24:27], a[44:47], a[12:15], v[24:27]
  v_mfma_f32_16x16x32_bf16 v[20:23], a[44:47], a[8:11], v[20:23]
  s_waitcnt vmcnt(10) lgkmcnt(0)
  s_barrier
  ds_read_b64_tr_b16 a[128:129], v118 offset:0
  v_mfma_f32_16x16x32_bf16 v[20:23], a[68:71], a[28:31], v[20:23]
  ds_read_b64_tr_b16 a[130:131], v118 offset:6144
  s_add_u32 m0, s62, 90112
  v_mfma_f32_16x16x32_bf16 v[16:19], a[68:71], a[24:27], v[16:19]
  ds_read_b64_tr_b16 a[152:153], v118 offset:12288
  buffer_load_dwordx4 v120, s[28:31], s68 offen offset:0 sc1  lds
  v_mfma_f32_16x16x32_bf16 v[16:19], a[44:47], a[4:7], v[16:19]
  ds_read_b64_tr_b16 a[154:155], v118 offset:18432
  v_mfma_f32_16x16x32_bf16 v[32:35], a[48:51], a[0:3], v[32:35]
  ds_read_b128 a[92:95], v112 offset:32768
  v_mfma_f32_16x16x32_bf16 v[32:35], a[72:75], a[20:23], v[32:35]
  ds_read_b128 a[112:115], v113 offset:32768
  v_mfma_f32_16x16x32_bf16 v[36:39], a[72:75], a[24:27], v[36:39]
  ds_read_b128 a[96:99], v112 offset:34816
  buffer_load_dwordx4 v121, s[28:31], s68 offen offset:1024 sc1  lds
  v_mfma_f32_16x16x32_bf16 v[36:39], a[48:51], a[4:7], v[36:39]
  ds_read_b128 a[116:119], v113 offset:34816
  v_mfma_f32_16x16x32_bf16 v[40:43], a[48:51], a[8:11], v[40:43]
  ds_read_b128 a[100:103], v112 offset:36864
  v_mfma_f32_16x16x32_bf16 v[40:43], a[72:75], a[28:31], v[40:43]
  ds_read_b128 a[120:123], v113 offset:36864
  v_mfma_f32_16x16x32_bf16 v[44:47], a[72:75], a[32:35], v[44:47]
  ds_read_b128 a[104:107], v112 offset:38912
  buffer_load_dwordx4 v122, s[28:31], s68 offen offset:2048 sc1  lds
  v_mfma_f32_16x16x32_bf16 v[44:47], a[48:51], a[12:15], v[44:47]
  ds_read_b128 a[124:127], v113 offset:38912
  v_mfma_f32_16x16x32_bf16 v[48:51], a[48:51], a[16:19], v[48:51]
  ds_read_b64_tr_b16 a[132:133], v119 offset:0
  v_mfma_f32_16x16x32_bf16 v[48:51], a[72:75], a[36:39], v[48:51]
  ds_read_b64_tr_b16 a[134:135], v119 offset:6144
  v_mfma_f32_16x16x32_bf16 v[68:71], a[76:79], a[36:39], v[68:71]
  ds_read_b64_tr_b16 a[156:157], v119 offset:12288
  buffer_load_dwordx4 v123, s[28:31], s68 offen offset:3072 sc1  lds
  v_mfma_f32_16x16x32_bf16 v[68:71], a[52:55], a[16:19], v[68:71]
  ds_read_b64_tr_b16 a[158:159], v119 offset:18432
  v_mfma_f32_16x16x32_bf16 v[64:67], a[52:55], a[12:15], v[64:67]
  ds_read_b128 a[88:91], v114
  v_add_u32 v114, s65, v114
  v_mfma_f32_16x16x32_bf16 v[64:67], a[76:79], a[32:35], v[64:67]
  s_add_u32 m0, s63, 24576
  ds_read_b128 a[108:111], v115
  v_add_u32 v115, s65, v115
  v_mfma_f32_16x16x32_bf16 v[60:63], a[76:79], a[28:31], v[60:63]
  ds_read_b64_tr_b16 a[136:137], v118 offset:2048
  buffer_load_dwordx4 v124, s[8:11], s69 offen offset:0  lds
  v_mfma_f32_16x16x32_bf16 v[60:63], a[52:55], a[8:11], v[60:63]
  ds_read_b64_tr_b16 a[138:139], v118 offset:8192
  v_mfma_f32_16x16x32_bf16 v[56:59], a[52:55], a[4:7], v[56:59]
  ds_read_b64_tr_b16 a[160:161], v118 offset:14336
  v_mfma_f32_16x16x32_bf16 v[56:59], a[76:79], a[24:27], v[56:59]
  ds_read_b64_tr_b16 a[162:163], v118 offset:20480
  v_mfma_f32_16x16x32_bf16 v[52:55], a[76:79], a[20:23], v[52:55]
  ds_read_b64_tr_b16 a[140:141], v119 offset:2048
  buffer_load_dwordx4 v125, s[8:11], s69 offen offset:1024  lds
  v_mfma_f32_16x16x32_bf16 v[52:55], a[52:55], a[0:3], v[52:55]
  ds_read_b64_tr_b16 a[142:143], v119 offset:8192
  v_mfma_f32_16x16x32_bf16 v[72:75], a[0:3], a[56:59], v[72:75]
  ds_read_b64_tr_b16 a[164:165], v119 offset:14336
  v_mfma_f32_16x16x32_bf16 v[72:75], a[20:23], a[80:83], v[72:75]
  ds_read_b64_tr_b16 a[166:167], v119 offset:20480
  v_mfma_f32_16x16x32_bf16 v[76:79], a[24:27], a[80:83], v[76:79]
  ds_read_b64_tr_b16 a[144:145], v118 offset:4096
  buffer_load_dwordx4 v124, s[8:11], s69 offen offset:2048  lds
  v_mfma_f32_16x16x32_bf16 v[76:79], a[4:7], a[56:59], v[76:79]
  ds_read_b64_tr_b16 a[146:147], v118 offset:10240
  v_mfma_f32_16x16x32_bf16 v[80:83], a[8:11], a[56:59], v[80:83]
  ds_read_b64_tr_b16 a[168:169], v118 offset:16384
  v_mfma_f32_16x16x32_bf16 v[80:83], a[28:31], a[80:83], v[80:83]
  ds_read_b64_tr_b16 a[170:171], v118 offset:22528
  v_mfma_f32_16x16x32_bf16 v[84:87], a[32:35], a[80:83], v[84:87]
  ds_read_b64_tr_b16 a[148:149], v119 offset:4096
  buffer_load_dwordx4 v125, s[8:11], s69 offen offset:3072  lds
  v_mfma_f32_16x16x32_bf16 v[84:87], a[12:15], a[56:59], v[84:87]
  ds_read_b64_tr_b16 a[150:151], v119 offset:10240
  v_mfma_f32_16x16x32_bf16 v[88:91], a[16:19], a[56:59], v[88:91]
  ds_read_b64_tr_b16 a[172:173], v119 offset:16384
  v_mfma_f32_16x16x32_bf16 v[88:91], a[36:39], a[80:83], v[88:91]
  ds_read_b64_tr_b16 a[174:175], v119 offset:22528
  s_add_u32 m0, s63, 28672
  v_mfma_f32_16x16x32_bf16 v[108:111], a[36:39], a[84:87], v[108:111]
  buffer_load_dwordx4 v124, s[8:11], s70 offen offset:0  lds
  v_mfma_f32_16x16x32_bf16 v[108:111], a[16:19], a[60:63], v[108:111]
  s_add_u32 s44, s44, 1
  v_mfma_f32_16x16x32_bf16 v[104:107], a[12:15], a[60:63], v[104:107]
  s_and_b32 s44, s44, 15
  v_mfma_f32_16x16x32_bf16 v[104:107], a[32:35], a[84:87], v[104:107]
  s_add_u32 s66, s66, 1
  v_mfma_f32_16x16x32_bf16 v[100:103], a[28:31], a[84:87], v[100:103]
  s_mul_i32 s45, s44, s61
  buffer_load_dwordx4 v125, s[8:11], s70 offen offset:1024  lds
  v_mfma_f32_16x16x32_bf16 v[100:103], a[8:11], a[60:63], v[100:103]
  s_add_u32 s68, s45, s59
  v_mfma_f32_16x16x32_bf16 v[96:99], a[4:7], a[60:63], v[96:99]
  v_mfma_f32_16x16x32_bf16 v[96:99], a[24:27], a[84:87], v[96:99]
  v_mfma_f32_16x16x32_bf16 v[92:95], a[20:23], a[84:87], v[92:95]
  v_mfma_f32_16x16x32_bf16 v[92:95], a[0:3], a[60:63], v[92:95]
  s_cmp_eq_u32 s66, s88
  s_cbranch_scc0 Lside_skip4
  s_call_b64 s[78:79], Lside_sub
Lside_skip4:
  s_waitcnt lgkmcnt(15)
  v_mfma_f32_16x16x32_bf16 v[0:3], a[128:131], a[92:95], v[0:3]
  s_mul_i32 s45, s44, 393216
  v_mfma_f32_16x16x32_bf16 v[0:3], a[152:155], a[112:115], v[0:3]
  s_add_u32 s69, s45, s60
  v_mfma_f32_16x16x32_bf16 v[4:7], a[152:155], a[116:119], v[4:7]
  s_add_u32 s70, s69, 4096
  v_mfma_f32_16x16x32_bf16 v[4:7], a[128:131], a[96:99], v[4:7]
  v_mfma_f32_16x16x32_bf16 v[8:11], a[128:131], a[100:103], v[8:11]
  v_mfma_f32_16x16x32_bf16 v[8:11], a[152:155], a[120:123], v[8:11]
  v_mfma_f32_16x16x32_bf16 v[12:15], a[152:155], a[124:127], v[12:15]
  v_mfma_f32_16x16x32_bf16 v[12:15], a[128:131], a[104:107], v[12:15]
  v_mfma_f32_16x16x32_bf16 v[28:31], a[132:135], a[104:107], v[28:31]
  v_mfma_f32_16x16x32_bf16 v[28:31], a[156:159], a[124:127], v[28:31]
  v_mfma_f32_16x16x32_bf16 v[24:27], a[156:159], a[120:123], v[24:27]
  v_mfma_f32_16x16x32_bf16 v[24:27], a[132:135], a[100:103], v[24:27]
  v_mfma_f32_16x16x32_bf16 v[20:23], a[132:135], a[96:99], v[20:23]
  s_waitcnt vmcnt(10) lgkmcnt(0)
  s_barrier
  ds_read_b64_tr_b16 a[40:41], v116 offset:0
  v_mfma_f32_16x16x32_bf16 v[20:23], a[156:159], a[116:119], v[20:23]
  ds_read_b64_tr_b16 a[42:43], v116 offset:6144
  s_add_u32 m0, s62, 106496
  v_mfma_f32_16x16x32_bf16 v[16:19], a[156:159], a[112:115], v[16:19]
  ds_read_b64_tr_b16 a[64:65], v116 offset:12288
  buffer_load_dwordx4 v120, s[28:31], s68 offen offset:0 sc1  lds
  v_mfma_f32_16x16x32_bf16 v[16:19], a[132:135], a[92:95], v[16:19]
  ds_read_b64_tr_b16 a[66:67], v116 offset:18432
  v_mfma_f32_16x16x32_bf16 v[32:35], a[136:139], a[88:91], v[32:35]
  ds_read_b128 a[4:7], v112 offset:0
  v_mfma_f32_16x16x32_bf16 v[32:35], a[160:163], a[108:111], v[32:35]
  ds_read_b128 a[24:27], v113 offset:0
  v_mfma_f32_16x16x32_bf16 v[36:39], a[160:163], a[112:115], v[36:39]
  ds_read_b128 a[8:11], v112 offset:2048
  buffer_load_dwordx4 v121, s[28:31], s68 offen offset:1024 sc1  lds
  v_mfma_f32_16x16x32_bf16 v[36:39], a[136:139], a[92:95], v[36:39]
  ds_read_b128 a[28:31], v113 offset:2048
  v_mfma_f32_16x16x32_bf16 v[40:43], a[136:139], a[96:99], v[40:43]
  ds_read_b128 a[12:15], v112 offset:4096
  v_mfma_f32_16x16x32_bf16 v[40:43], a[160:163], a[116:119], v[40:43]
  ds_read_b128 a[32:35], v113 offset:4096
  v_mfma_f32_16x16x32_bf16 v[44:47], a[160:163], a[120:123], v[44:47]
  ds_read_b128 a[16:19], v112 offset:6144
  buffer_load_dwordx4 v122, s[28:31], s68 offen offset:2048 sc1  lds
  v_mfma_f32_16x16x32_bf16 v[44:47], a[136:139], a[100:103], v[44:47]
  ds_read_b128 a[36:39], v113 offset:6144
  v_mfma_f32_16x16x32_bf16 v[48:51], a[136:139], a[104:107], v[48:51]
  ds_read_b64_tr_b16 a[44:45], v117 offset:0
  v_mfma_f32_16x16x32_bf16 v[48:51], a[160:163], a[124:127], v[48:51]
  ds_read_b64_tr_b16 a[46:47], v117 offset:6144
  v_mfma_f32_16x16x32_bf16 v[68:71], a[164:167], a[124:127], v[68:71]
  ds_read_b64_tr_b16 a[68:69], v117 offset:12288
  buffer_load_dwordx4 v123, s[28:31], s68 offen offset:3072 sc1  lds
  v_mfma_f32_16x16x32_bf16 v[68:71], a[140:143], a[104:107], v[68:71]
  ds_read_b64_tr_b16 a[70:71], v117 offset:18432
  v_mfma_f32_16x16x32_bf16 v[64:67], a[140:143], a[100:103], v[64:67]
  ds_read_b128 a[0:3], v114
  v_add_u32 v114, s64, v114
  v_mfma_f32_16x16x32_bf16 v[64:67], a[164:167], a[120:123], v[64:67]
  s_add_u32 m0, s63, 49152
  ds_read_b128 a[20:23], v115
  v_add_u32 v115, s64, v115
  v_mfma_f32_16x16x32_bf16 v[60:63], a[164:167], a[116:119], v[60:63]
  ds_read_b64_tr_b16 a[48:49], v116 offset:2048
  buffer_load_dwordx4 v124, s[8:11], s69 offen offset:0  lds
  v_mfma_f32_16x16x32_bf16 v[60:63], a[140:143], a[96:99], v[60:63]
  ds_read_b64_tr_b16 a[50:51], v116 offset:8192
  v_mfma_f32_16x16x32_bf16 v[56:59], a[140:143], a[92:95], v[56:59]
  ds_read_b64_tr_b16 a[72:73], v116 offset:14336
  v_mfma_f32_16x16x32_bf16 v[56:59], a[164:167], a[112:115], v[56:59]
  ds_read_b64_tr_b16 a[74:75], v116 offset:20480
  v_mfma_f32_16x16x32_bf16 v[52:55], a[164:167], a[108:111], v[52:55]
  ds_read_b64_tr_b16 a[52:53], v117 offset:2048
  buffer_load_dwordx4 v125, s[8:11], s69 offen offset:1024  lds
  v_mfma_f32_16x16x32_bf16 v[52:55], a[140:143], a[88:91], v[52:55]
  ds_read_b64_tr_b16 a[54:55], v117 offset:8192
  v_mfma_f32_16x16x32_bf16 v[72:75], a[88:91], a[144:147], v[72:75]
  ds_read_b64_tr_b16 a[76:77], v117 offset:14336
  v_mfma_f32_16x16x32_bf16 v[72:75], a[108:111], a[168:171], v[72:75]
  ds_read_b64_tr_b16 a[78:79], v117 offset:20480
  v_mfma_f32_16x16x32_bf16 v[76:79], a[112:115], a[168:171], v[76:79]
  ds_read_b64_tr_b16 a[56:57], v116 offset:4096
  buffer_load_dwordx4 v124, s[8:11], s69 offen offset:2048  lds
  v_mfma_f32_16x16x32_bf16 v[76:79], a[92:95], a[144:147], v[76:79]
  ds_read_b64_tr_b16 a[58:59], v116 offset:10240
  v_mfma_f32_16x16x32_bf16 v[80:83], a[96:99], a[144:147], v[80:83]
  ds_read_b64_tr_b16 a[80:81], v116 offset:16384
  v_mfma_f32_16x16x32_bf16 v[80:83], a[116:119], a[168:171], v[80:83]
  ds_read_b64_tr_b16 a[82:83], v116 offset:22528
  v_mfma_f32_16x16x32_bf16 v[84:87], a[120:123], a[168:171], v[84:87]
  ds_read_b64_tr_b16 a[60:61], v117 offset:4096
  buffer_load_dwordx4 v125, s[8:11], s69 offen offset:3072  lds
  v_mfma_f32_16x16x32_bf16 v[84:87], a[100:103], a[144:147], v[84:87]
  ds_read_b64_tr_b16 a[62:63], v117 offset:10240
  v_mfma_f32_16x16x32_bf16 v[88:91], a[104:107], a[144:147], v[88:91]
  ds_read_b64_tr_b16 a[84:85], v117 offset:16384
  v_mfma_f32_16x16x32_bf16 v[88:91], a[124:127], a[168:171], v[88:91]
  ds_read_b64_tr_b16 a[86:87], v117 offset:22528
  s_add_u32 m0, s63, 53248
  v_mfma_f32_16x16x32_bf16 v[108:111], a[124:127], a[172:175], v[108:111]
  buffer_load_dwordx4 v124, s[8:11], s70 offen offset:0  lds
  v_mfma_f32_16x16x32_bf16 v[108:111], a[104:107], a[148:151], v[108:111]
  s_add_u32 s44, s44, 1
  v_mfma_f32_16x16x32_bf16 v[104:107], a[100:103], a[148:151], v[104:107]
  s_and_b32 s44, s44, 15
  v_mfma_f32_16x16x32_bf16 v[104:107], a[120:123], a[172:175], v[104:107]
  s_add_u32 s66, s66, 1
  v_mfma_f32_16x16x32_bf16 v[100:103], a[116:119], a[172:175], v[100:103]
  s_mul_i32 s45, s44, s61
  buffer_load_dwordx4 v125, s[8:11], s70 offen offset:1024  lds
  v_mfma_f32_16x16x32_bf16 v[100:103], a[96:99], a[148:151], v[100:103]
  s_add_u32 s68, s45, s59
  v_mfma_f32_16x16x32_bf16 v[96:99], a[92:95], a[148:151], v[96:99]
  v_mfma_f32_16x16x32_bf16 v[96:99], a[112:115], a[172:175], v[96:99]
  v_mfma_f32_16x16x32_bf16 v[92:95], a[108:111], a[172:175], v[92:95]
  v_mfma_f32_16x16x32_bf16 v[92:95], a[88:91], a[148:151], v[92:95]
  s_cmp_eq_u32 s66, s88
  s_cbranch_scc0 Lside_skip5
  s_call_b64 s[78:79], Lside_sub
Lside_skip5:
  s_sub_u32 s56, s56, 1
  s_cmp_lg_u32 s56, 0
  s_cbranch_scc1 Lp1_loop
Lmk_Lp1_loop_tail:
  s_waitcnt lgkmcnt(15)
  v_mfma_f32_16x16x32_bf16 v[0:3], a[40:43], a[4:7], v[0:3]
  s_mul_i32 s45, s44, 393216
  v_and_b32 v187, 1, v253
  v_lshlrev_b32 v187, 7, v187
  v_mfma_f32_16x16x32_bf16 v[0:3], a[64:67], a[24:27], v[0:3]
  s_add_u32 s69, s45, s60
  buffer_load_dword v127, v187, s[36:39], 0 offen sc1
  v_mfma_f32_16x16x32_bf16 v[4:7], a[64:67], a[28:31], v[4:7]
  s_add_u32 s70, s69, 4096
  v_mfma_f32_16x16x32_bf16 v[4:7], a[40:43], a[8:11], v[4:7]
  v_mfma_f32_16x16x32_bf16 v[8:11], a[40:43], a[12:15], v[8:11]
  v_mfma_f32_16x16x32_bf16 v[8:11], a[64:67], a[32:35], v[8:11]
  v_mfma_f32_16x16x32_bf16 v[12:15], a[64:67], a[36:39], v[12:15]
  v_mfma_f32_16x16x32_bf16 v[12:15], a[40:43], a[16:19], v[12:15]
  v_mfma_f32_16x16x32_bf16 v[28:31], a[44:47], a[16:19], v[28:31]
  v_mfma_f32_16x16x32_bf16 v[28:31], a[68:71], a[36:39], v[28:31]
  v_mfma_f32_16x16x32_bf16 v[24:27], a[68:71], a[32:35], v[24:27]
  s_lshl_b32 s43, s57, 2
  s_add_u32 s74, s71, s43
  v_mfma_f32_16x16x32_bf16 v[24:27], a[44:47], a[12:15], v[24:27]
  s_sub_u32 s44, s74, 1
  s_cmp_eq_u32 s57, 0
  s_cselect_b32 s44, s72, s44
  v_mfma_f32_16x16x32_bf16 v[20:23], a[44:47], a[8:11], v[20:23]
  s_waitcnt vmcnt(11) lgkmcnt(0)
  s_barrier
  ds_read_b64_tr_b16 a[128:129], v116 offset:24576
  v_mfma_f32_16x16x32_bf16 v[20:23], a[68:71], a[28:31], v[20:23]
  ds_read_b64_tr_b16 a[130:131], v116 offset:30720
  s_add_u32 m0, s62, 73728
  v_mfma_f32_16x16x32_bf16 v[16:19], a[68:71], a[24:27], v[16:19]
  ds_read_b64_tr_b16 a[152:153], v116 offset:36864
  buffer_load_dwordx4 v120, s[28:31], s68 offen offset:0 sc1  lds
  v_mfma_f32_16x16x32_bf16 v[16:19], a[44:47], a[4:7], v[16:19]
  ds_read_b64_tr_b16 a[154:155], v116 offset:43008
  s_add_u32 s45, s42, 27262976
  v_mfma_f32_16x16x32_bf16 v[32:35], a[48:51], a[0:3], v[32:35]
  ds_read_b128 a[92:95], v112 offset:16384
  s_lshl_b32 s44, s44, 11
  v_mfma_f32_16x16x32_bf16 v[32:35], a[72:75], a[20:23], v[32:35]
  ds_read_b128 a[112:115], v113 offset:16384
  s_add_u32 s77, s44, s45
  v_mfma_f32_16x16x32_bf16 v[36:39], a[72:75], a[24:27], v[36:39]
  ds_read_b128 a[96:99], v112 offset:18432
  buffer_load_dwordx4 v121, s[28:31], s68 offen offset:1024 sc1  lds
  v_mfma_f32_16x16x32_bf16 v[36:39], a[48:51], a[4:7], v[36:39]
  ds_read_b128 a[116:119], v113 offset:18432
  s_lshl_b32 s44, s74, 11
  v_mfma_f32_16x16x32_bf16 v[40:43], a[48:51], a[8:11], v[40:43]
  ds_read_b128 a[100:103], v112 offset:20480
  s_add_u32 s78, s44, s45
  v_mfma_f32_16x16x32_bf16 v[40:43], a[72:75], a[28:31], v[40:43]
  ds_read_b128 a[120:123], v113 offset:20480
  s_add_u32 s79, s78, 4096
  v_mfma_f32_16x16x32_bf16 v[44:47], a[72:75], a[32:35], v[44:47]
  ds_read_b128 a[104:107], v112 offset:22528
  buffer_load_dwordx4 v122, s[28:31], s68 offen offset:2048 sc1  lds
  v_mfma_f32_16x16x32_bf16 v[44:47], a[48:51], a[12:15], v[44:47]
  ds_read_b128 a[124:127], v113 offset:22528
  s_lshl_b32 s43, s51, 1
  v_mfma_f32_16x16x32_bf16 v[48:51], a[48:51], a[16:19], v[48:51]
  ds_read_b64_tr_b16 a[132:133], v117 offset:24576
  s_add_u32 s75, s43, s58
  v_mfma_f32_16x16x32_bf16 v[48:51], a[72:75], a[36:39], v[48:51]
  ds_read_b64_tr_b16 a[134:135], v117 offset:30720
  s_lshl_b32 s43, s75, 7
  v_mfma_f32_16x16x32_bf16 v[68:71], a[76:79], a[36:39], v[68:71]
  ds_read_b64_tr_b16 a[156:157], v117 offset:36864
  buffer_load_dwordx4 v123, s[28:31], s68 offen offset:3072 sc1  lds
  v_mfma_f32_16x16x32_bf16 v[68:71], a[52:55], a[16:19], v[68:71]
  ds_read_b64_tr_b16 a[158:159], v117 offset:43008
  s_add_u32 s46, s43, 27983872
  v_mfma_f32_16x16x32_bf16 v[64:67], a[52:55], a[12:15], v[64:67]
  ds_read_b128 a[88:91], v114
  v_add_u32 v114, s64, v114
  v_mfma_f32_16x16x32_bf16 v[64:67], a[76:79], a[32:35], v[64:67]
  s_add_u32 m0, s63, 0
  ds_read_b128 a[108:111], v115
  v_add_u32 v115, s64, v115
  v_mfma_f32_16x16x32_bf16 v[60:63], a[76:79], a[28:31], v[60:63]
  ds_read_b64_tr_b16 a[136:137], v116 offset:26624
  buffer_load_dwordx4 v124, s[8:11], s69 offen offset:0  lds
  v_mfma_f32_16x16x32_bf16 v[60:63], a[52:55], a[8:11], v[60:63]
  ds_read_b64_tr_b16 a[138:139], v116 offset:32768
  v_mfma_f32_16x16x32_bf16 v[56:59], a[52:55], a[4:7], v[56:59]
  ds_read_b64_tr_b16 a[160:161], v116 offset:38912
  v_mfma_f32_16x16x32_bf16 v[56:59], a[76:79], a[24:27], v[56:59]
  ds_read_b64_tr_b16 a[162:163], v116 offset:45056
  v_mfma_f32_16x16x32_bf16 v[52:55], a[76:79], a[20:23], v[52:55]
  ds_read_b64_tr_b16 a[140:141], v117 offset:26624
  buffer_load_dwordx4 v125, s[8:11], s69 offen offset:1024  lds
  v_mfma_f32_16x16x32_bf16 v[52:55], a[52:55], a[0:3], v[52:55]
  ds_read_b64_tr_b16 a[142:143], v117 offset:32768
  v_mfma_f32_16x16x32_bf16 v[72:75], a[0:3], a[56:59], v[72:75]
  ds_read_b64_tr_b16 a[164:165], v117 offset:38912
  v_lshlrev_b32 v121, 3, v253
  v_mfma_f32_16x16x32_bf16 v[72:75], a[20:23], a[80:83], v[72:75]
  ds_read_b64_tr_b16 a[166:167], v117 offset:45056
  v_lshlrev_b32 v120, 4, v253
  v_mfma_f32_16x16x32_bf16 v[76:79], a[24:27], a[80:83], v[76:79]
  ds_read_b64_tr_b16 a[144:145], v116 offset:28672
  buffer_load_dwordx4 v124, s[8:11], s69 offen offset:2048  lds
  v_mfma_f32_16x16x32_bf16 v[76:79], a[4:7], a[56:59], v[76:79]
  ds_read_b64_tr_b16 a[146:147], v116 offset:34816
  v_add_u32 v126, s76, v120
  v_mfma_f32_16x16x32_bf16 v[80:83], a[8:11], a[56:59], v[80:83]
  ds_read_b64_tr_b16 a[168:169], v116 offset:40960
  v_mfma_f32_16x16x32_bf16 v[80:83], a[28:31], a[80:83], v[80:83]
  ds_read_b64_tr_b16 a[170:171], v116 offset:47104
  v_mfma_f32_16x16x32_bf16 v[84:87], a[32:35], a[80:83], v[84:87]
  ds_read_b64_tr_b16 a[148:149], v117 offset:28672
  buffer_load_dwordx4 v125, s[8:11], s69 offen offset:3072  lds
  v_mfma_f32_16x16x32_bf16 v[84:87], a[12:15], a[56:59], v[84:87]
  ds_read_b64_tr_b16 a[150:151], v117 offset:34816
  v_mfma_f32_16x16x32_bf16 v[88:91], a[16:19], a[56:59], v[88:91]
  ds_read_b64_tr_b16 a[172:173], v117 offset:40960
  v_mfma_f32_16x16x32_bf16 v[88:91], a[36:39], a[80:83], v[88:91]
  ds_read_b64_tr_b16 a[174:175], v117 offset:47104
  s_add_u32 m0, s63, 4096
  v_mfma_f32_16x16x32_bf16 v[108:111], a[36:39], a[84:87], v[108:111]
  buffer_load_dwordx4 v124, s[8:11], s70 offen offset:0  lds
  v_mfma_f32_16x16x32_bf16 v[108:111], a[16:19], a[60:63], v[108:111]
  s_waitcnt vmcnt(9)
  v_cmp_gt_u32 vcc, 128, v127
  s_cbranch_vccz Lcdn4
  s_mov_b32 s43, 0x40000
Lchk3:
  s_sleep 8
  buffer_load_dword v127, v187, s[36:39], 0 offen sc1
  s_waitcnt vmcnt(0)
  v_cmp_gt_u32 vcc, 128, v127
  s_cbranch_vccz Lcdn4
  s_sub_u32 s43, s43, 1
  s_cmp_lg_u32 s43, 0
  s_cbranch_scc1 Lchk3
Lcdn4:
  v_mfma_f32_16x16x32_bf16 v[104:107], a[12:15], a[60:63], v[104:107]
  v_mfma_f32_16x16x32_bf16 v[104:107], a[32:35], a[84:87], v[104:107]
  v_mfma_f32_16x16x32_bf16 v[100:103], a[28:31], a[84:87], v[100:103]
  buffer_load_dwordx4 v125, s[8:11], s70 offen offset:1024  lds
  v_mfma_f32_16x16x32_bf16 v[100:103], a[8:11], a[60:63], v[100:103]
  v_mfma_f32_16x16x32_bf16 v[96:99], a[4:7], a[60:63], v[96:99]
  s_cmp_lg_u32 s41, 0
  s_cbranch_scc1 Lp1_csl
  v_bfe_u32 v122, v253, 3, 2
  v_lshrrev_b32 v123, 5, v253
  v_mad_u32_u24 v122, v123, 3, v122
  v_and_b32 v123, 7, v253
  v_lshlrev_b32 v123, 4, v123
  v_lshl_add_u32 v122, v122, 12, v123
  buffer_load_dwordx4 v[200:203], v122, s[4:7], s46 offen sc1
  s_add_u32 s46, s46, 24576
  buffer_load_dwordx4 v[204:207], v122, s[4:7], s46 offen sc1
  s_add_u32 s46, s46, 24576
  buffer_load_dwordx4 v[208:211], v122, s[4:7], s46 offen sc1
  s_add_u32 s46, s46, 24576
  buffer_load_dwordx4 v[212:215], v122, s[4:7], s46 offen sc1
  s_add_u32 s46, s46, 24576
  buffer_load_dwordx4 v[216:219], v122, s[4:7], s46 offen sc1
  s_add_u32 s46, s46, 24576
  buffer_load_dwordx4 v[220:223], v122, s[4:7], s46 offen sc1
  s_add_u32 s46, s46, 24576
  buffer_load_dwordx4 v[224:227], v122, s[4:7], s46 offen sc1
  s_add_u32 s46, s46, 24576
  buffer_load_dwordx4 v[228:231], v122, s[4:7], s46 offen sc1
  s_add_u32 s46, s46, 24576
Lp1_csl:
  v_mfma_f32_16x16x32_bf16 v[96:99], a[24:27], a[84:87], v[96:99]
  v_mfma_f32_16x16x32_bf16 v[92:95], a[20:23], a[84:87], v[92:95]
  v_mfma_f32_16x16x32_bf16 v[92:95], a[0:3], a[60:63], v[92:95]
  s_waitcnt lgkmcnt(15)
  v_mfma_f32_16x16x32_bf16 v[0:3], a[128:131], a[92:95], v[0:3]
  s_lshl_b32 s88, s53, 7
  s_lshl_b32 s92, s40, 14
  v_mfma_f32_16x16x32_bf16 v[0:3], a[152:155], a[112:115], v[0:3]
  buffer_load_dwordx2 v[128:129], v121, s[4:7], s77 offen offset:0 sc1
  s_add_u32 s88, s88, s92
  v_mfma_f32_16x16x32_bf16 v[4:7], a[152:155], a[116:119], v[4:7]
  s_lshl_b32 s89, s40, 10
  s_and_b32 s92, s52, 3
  v_mfma_f32_16x16x32_bf16 v[4:7], a[128:131], a[96:99], v[4:7]
  buffer_load_dwordx2 v[130:131], v121, s[4:7], s77 offen offset:512 sc1
  s_lshl_b32 s91, s92, 19
  v_mfma_f32_16x16x32_bf16 v[8:11], a[128:131], a[100:103], v[8:11]
  v_add_u32 v186, s88, v252
  s_mul_i32 s92, s92, 0
  v_mfma_f32_16x16x32_bf16 v[8:11], a[152:155], a[120:123], v[8:11]
  buffer_load_dwordx2 v[132:133], v121, s[4:7], s77 offen offset:1024 sc1
  s_lshr_b32 s93, s2, 5
  v_mfma_f32_16x16x32_bf16 v[12:15], a[152:155], a[124:127], v[12:15]
  s_add_u32 s92, s92, s93
  s_cmp_ge_u32 s92, 8
  s_cselect_b32 s93, 8, 0
  v_mfma_f32_16x16x32_bf16 v[12:15], a[128:131], a[104:107], v[12:15]
  s_sub_u32 s92, s92, s93
  buffer_load_dwordx2 v[134:135], v121, s[4:7], s77 offen offset:1536 sc1
  s_cmp_ge_u32 s92, 8
  s_cselect_b32 s93, 8, 0
  v_mfma_f32_16x16x32_bf16 v[28:31], a[132:135], a[104:107], v[28:31]
  s_sub_u32 s92, s92, s93
  s_lshl_b32 s93, 1, s92
  s_lshr_b32 s92, s93, 8
  v_mfma_f32_16x16x32_bf16 v[28:31], a[156:159], a[124:127], v[28:31]
  buffer_load_dwordx2 v[136:137], v121, s[4:7], s78 offen offset:0 sc1
  s_or_b32 s93, s93, s92
  v_mfma_f32_16x16x32_bf16 v[24:27], a[156:159], a[120:123], v[24:27]
  s_bitcmp1_b32 s93, 0
  s_cselect_b32 s80, 524288, 0
  s_bitcmp1_b32 s93, 1
  v_mfma_f32_16x16x32_bf16 v[24:27], a[132:135], a[100:103], v[24:27]
  s_cselect_b32 s81, 524288, 0
  buffer_load_dwordx2 v[138:139], v121, s[4:7], s78 offen offset:512 sc1
  s_bitcmp1_b32 s93, 2
  s_cselect_b32 s82, 524288, 0
  v_mfma_f32_16x16x32_bf16 v[20:23], a[132:135], a[96:99], v[20:23]
  s_waitcnt lgkmcnt(0)
  s_barrier
  ds_read_b64_tr_b16 a[40:41], v118 offset:0
  v_mfma_f32_16x16x32_bf16 v[20:23], a[156:159], a[116:119], v[20:23]
  ds_read_b64_tr_b16 a[42:43], v118 offset:6144
  buffer_load_dwordx2 v[140:141], v121, s[4:7], s78 offen offset:1024 sc1
  v_mfma_f32_16x16x32_bf16 v[16:19], a[156:159], a[112:115], v[16:19]
  s_bitcmp1_b32 s93, 3
  ds_read_b64_tr_b16 a[64:65], v118 offset:12288
  s_cselect_b32 s83, 524288, 0
  v_mfma_f32_16x16x32_bf16 v[16:19], a[132:135], a[92:95], v[16:19]
  ds_read_b64_tr_b16 a[66:67], v118 offset:18432
  buffer_load_dwordx2 v[142:143], v121, s[4:7], s78 offen offset:1536 sc1
  v_mfma_f32_16x16x32_bf16 v[32:35], a[136:139], a[88:91], v[32:35]
  s_bitcmp1_b32 s93, 4
  ds_read_b128 a[4:7], v112 offset:32768
  s_cselect_b32 s84, 524288, 0
  v_mfma_f32_16x16x32_bf16 v[32:35], a[160:163], a[108:111], v[32:35]
  ds_read_b128 a[24:27], v113 offset:32768
  buffer_load_dwordx2 v[144:145], v121, s[4:7], s78 offen offset:2048 sc1
  v_mfma_f32_16x16x32_bf16 v[36:39], a[160:163], a[112:115], v[36:39]
  s_bitcmp1_b32 s93, 5
  ds_read_b128 a[8:11], v112 offset:34816
  s_cselect_b32 s85, 524288, 0
  v_mfma_f32_16x16x32_bf16 v[36:39], a[136:139], a[92:95], v[36:39]
  ds_read_b128 a[28:31], v113 offset:34816
  buffer_load_dwordx2 v[146:147], v121, s[4:7], s78 offen offset:2560 sc1
  v_mfma_f32_16x16x32_bf16 v[40:43], a[136:139], a[96:99], v[40:43]
  s_bitcmp1_b32 s93, 6
  ds_read_b128 a[12:15], v112 offset:36864
  s_cselect_b32 s86, 524288, 0
  v_mfma_f32_16x16x32_bf16 v[40:43], a[160:163], a[116:119], v[40:43]
  ds_read_b128 a[32:35], v113 offset:36864
  buffer_load_dwordx2 v[148:149], v121, s[4:7], s78 offen offset:3072 sc1
  v_mfma_f32_16x16x32_bf16 v[44:47], a[160:163], a[120:123], v[44:47]
  s_bitcmp1_b32 s93, 7
  ds_read_b128 a[16:19], v112 offset:38912
  s_cselect_b32 s87, 524288, 0
  v_mfma_f32_16x16x32_bf16 v[44:47], a[136:139], a[100:103], v[44:47]
  ds_read_b128 a[36:39], v113 offset:38912
  buffer_load_dwordx2 v[150:151], v121, s[4:7], s78 offen offset:3584 sc1
  v_mfma_f32_16x16x32_bf16 v[48:51], a[136:139], a[104:107], v[48:51]
  ds_read_b64_tr_b16 a[44:45], v119 offset:0
  v_mfma_f32_16x16x32_bf16 v[48:51], a[160:163], a[124:127], v[48:51]
  ds_read_b64_tr_b16 a[46:47], v119 offset:6144
  buffer_load_dwordx2 v[152:153], v121, s[4:7], s79 offen offset:0 sc1
  v_mfma_f32_16x16x32_bf16 v[68:71], a[164:167], a[124:127], v[68:71]
  ds_read_b64_tr_b16 a[68:69], v119 offset:12288
  v_mfma_f32_16x16x32_bf16 v[68:71], a[140:143], a[104:107], v[68:71]
  ds_read_b64_tr_b16 a[70:71], v119 offset:18432
  buffer_load_dwordx2 v[154:155], v121, s[4:7], s79 offen offset:512 sc1
  v_mfma_f32_16x16x32_bf16 v[64:67], a[140:143], a[100:103], v[64:67]
  ds_read_b128 a[0:3], v114
  v_add_u32 v114, s65, v114
  v_mfma_f32_16x16x32_bf16 v[64:67], a[164:167], a[120:123], v[64:67]
  ds_read_b128 a[20:23], v115
  buffer_load_dwordx2 v[156:157], v121, s[4:7], s79 offen offset:1024 sc1
  v_add_u32 v115, s65, v115
  v_mfma_f32_16x16x32_bf16 v[60:63], a[164:167], a[116:119], v[60:63]
  ds_read_b64_tr_b16 a[48:49], v118 offset:2048
  s_lshl_b32 s44, s2, 2
  v_mfma_f32_16x16x32_bf16 v[60:63], a[140:143], a[96:99], v[60:63]
  ds_read_b64_tr_b16 a[50:51], v118 offset:8192
  buffer_load_dwordx2 v[158:159], v121, s[4:7], s79 offen offset:1536 sc1
  v_mfma_f32_16x16x32_bf16 v[56:59], a[140:143], a[92:95], v[56:59]
  ds_read_b64_tr_b16 a[72:73], v118 offset:14336
  s_add_u32 s44, s44, s40
  v_mfma_f32_16x16x32_bf16 v[56:59], a[164:167], a[112:115], v[56:59]
  ds_read_b64_tr_b16 a[74:75], v118 offset:20480
  buffer_load_dwordx2 v[160:161], v121, s[4:7], s79 offen offset:2048 sc1
  v_mfma_f32_16x16x32_bf16 v[52:55], a[164:167], a[108:111], v[52:55]
  ds_read_b64_tr_b16 a[52:53], v119 offset:2048
  s_lshl_b32 s44, s44, 12
  v_mfma_f32_16x16x32_bf16 v[52:55], a[140:143], a[88:91], v[52:55]
  ds_read_b64_tr_b16 a[54:55], v119 offset:8192
  buffer_load_dwordx2 v[162:163], v121, s[4:7], s79 offen offset:2560 sc1
  v_mfma_f32_16x16x32_bf16 v[72:75], a[88:91], a[144:147], v[72:75]
  ds_read_b64_tr_b16 a[76:77], v119 offset:14336
  s_add_u32 s44, s44, s42
  v_mfma_f32_16x16x32_bf16 v[72:75], a[108:111], a[168:171], v[72:75]
  ds_read_b64_tr_b16 a[78:79], v119 offset:20480
  buffer_load_dwordx2 v[164:165], v121, s[4:7], s79 offen offset:3072 sc1
  v_mfma_f32_16x16x32_bf16 v[76:79], a[112:115], a[168:171], v[76:79]
  ds_read_b64_tr_b16 a[56:57], v118 offset:4096
  s_add_u32 s44, s44, 28311552
  v_mfma_f32_16x16x32_bf16 v[76:79], a[92:95], a[144:147], v[76:79]
  ds_read_b64_tr_b16 a[58:59], v118 offset:10240
  buffer_load_dwordx2 v[166:167], v121, s[4:7], s79 offen offset:3584 sc1
  v_mfma_f32_16x16x32_bf16 v[80:83], a[96:99], a[144:147], v[80:83]
  ds_read_b64_tr_b16 a[80:81], v118 offset:16384
  v_mov_b32 v240, -1
  v_mfma_f32_16x16x32_bf16 v[80:83], a[116:119], a[168:171], v[80:83]
  ds_read_b64_tr_b16 a[82:83], v118 offset:22528
  v_mov_b32 v241, -1
  v_mfma_f32_16x16x32_bf16 v[84:87], a[120:123], a[168:171], v[84:87]
  ds_read_b64_tr_b16 a[60:61], v119 offset:4096
  v_mov_b32 v242, -1
  v_mfma_f32_16x16x32_bf16 v[84:87], a[100:103], a[144:147], v[84:87]
  ds_read_b64_tr_b16 a[62:63], v119 offset:10240
  v_mov_b32 v243, -1
  v_mfma_f32_16x16x32_bf16 v[88:91], a[104:107], a[144:147], v[88:91]
  ds_read_b64_tr_b16 a[84:85], v119 offset:16384
  buffer_store_dwordx4 v[240:243], v120, s[4:7], s44 offen offset:0 sc1
  v_mfma_f32_16x16x32_bf16 v[88:91], a[124:127], a[168:171], v[88:91]
  ds_read_b64_tr_b16 a[86:87], v119 offset:22528
  buffer_store_dwordx4 v[240:243], v120, s[4:7], s44 offen offset:1024 sc1
  v_mfma_f32_16x16x32_bf16 v[108:111], a[124:127], a[172:175], v[108:111]
  buffer_store_dwordx4 v[240:243], v120, s[4:7], s44 offen offset:2048 sc1
  buffer_store_dwordx4 v[240:243], v120, s[4:7], s44 offen offset:3072 sc1
  v_mfma_f32_16x16x32_bf16 v[108:111], a[104:107], a[148:151], v[108:111]
  v_mfma_f32_16x16x32_bf16 v[104:107], a[100:103], a[148:151], v[104:107]
  v_lshrrev_b32 v124, 4, v253
  v_lshlrev_b32 v124, 4, v124
  v_mfma_f32_16x16x32_bf16 v[104:107], a[120:123], a[172:175], v[104:107]
  v_and_b32 v125, 15, v253
  v_lshlrev_b32 v125, 2, v125
  v_mfma_f32_16x16x32_bf16 v[100:103], a[116:119], a[172:175], v[100:103]
  v_add_u32 v124, s76, v124
  v_add_u32 v125, s76, v125
  v_mfma_f32_16x16x32_bf16 v[100:103], a[96:99], a[148:151], v[100:103]
  v_add_u32 v123, 149504, v120
  s_waitcnt vmcnt(20)
  s_cmp_lg_u32 s41, 0
  s_cbranch_scc1 Lp1_css
  v_pk_add_f32 v[200:201], v[200:201], v[216:217]
  v_pk_add_f32 v[202:203], v[202:203], v[218:219]
  v_pk_add_f32 v[204:205], v[204:205], v[220:221]
  v_pk_add_f32 v[206:207], v[206:207], v[222:223]
  v_pk_add_f32 v[208:209], v[208:209], v[224:225]
  v_pk_add_f32 v[210:211], v[210:211], v[226:227]
  v_pk_add_f32 v[212:213], v[212:213], v[228:229]
  v_pk_add_f32 v[214:215], v[214:215], v[230:231]
  v_pk_add_f32 v[200:201], v[200:201], v[208:209]
  v_pk_add_f32 v[202:203], v[202:203], v[210:211]
  v_pk_add_f32 v[204:205], v[204:205], v[212:213]
  v_pk_add_f32 v[206:207], v[206:207], v[214:215]
  v_pk_add_f32 v[200:201], v[200:201], v[204:205]
  v_pk_add_f32 v[202:203], v[202:203], v[206:207]
  v_mov_b32 v204, v200
  v_mov_b32 v205, v201
  v_mov_b32 v206, v202
  v_mov_b32 v207, v203
  v_permlane32_swap_b32 v200, v204
  v_permlane32_swap_b32 v201, v205
  v_permlane32_swap_b32 v202, v206
  v_permlane32_swap_b32 v203, v207
  v_add_f32 v200, v200, v204
  v_add_f32 v201, v201, v205
  v_add_f32 v202, v202, v206
  v_add_f32 v203, v203, v207
  ds_write_b128 v126, v[200:203] offset:1024
Lp1_css:
  v_mfma_f32_16x16x32_bf16 v[96:99], a[92:95], a[148:151], v[96:99]
  ds_read_b128 v[168:171], v124 offset:1024
  ds_read_b128 v[172:175], v124 offset:1088
  v_mfma_f32_16x16x32_bf16 v[96:99], a[112:115], a[172:175], v[96:99]
  ds_read_b128 v[176:179], v124 offset:1152
  ds_read_b128 v[180:183], v124 offset:1216
  v_mfma_f32_16x16x32_bf16 v[92:95], a[108:111], a[172:175], v[92:95]
  ds_read_b32 v184, v125 offset:1280
  ds_read_b32 v185, v125 offset:1344
  v_mfma_f32_16x16x32_bf16 v[92:95], a[88:91], a[148:151], v[92:95]
  v_add_f32 v128, v128, v130
  s_waitcnt lgkmcnt(15)
  v_mfma_f32_16x16x32_bf16 v[0:3], a[40:43], a[4:7], v[0:3]
  v_add_f32 v129, v129, v131
  v_add_f32 v132, v132, v134
  v_mfma_f32_16x16x32_bf16 v[0:3], a[64:67], a[24:27], v[0:3]
  v_add_f32 v133, v133, v135
  v_add_f32 v188, v128, v132
  v_mfma_f32_16x16x32_bf16 v[4:7], a[64:67], a[28:31], v[4:7]
  v_add_f32 v194, v129, v133
  s_waitcnt vmcnt(16)
  v_mfma_f32_16x16x32_bf16 v[4:7], a[40:43], a[8:11], v[4:7]
  v_add_f32 v136, v136, v138
  v_add_f32 v137, v137, v139
  v_mfma_f32_16x16x32_bf16 v[8:11], a[40:43], a[12:15], v[8:11]
  v_add_f32 v140, v140, v142
  v_add_f32 v141, v141, v143
  v_mfma_f32_16x16x32_bf16 v[8:11], a[64:67], a[32:35], v[8:11]
  v_add_f32 v189, v136, v140
  v_add_f32 v195, v137, v141
  v_mfma_f32_16x16x32_bf16 v[12:15], a[64:67], a[36:39], v[12:15]
  s_waitcnt vmcnt(12)
  v_add_f32 v144, v144, v146
  v_mfma_f32_16x16x32_bf16 v[12:15], a[40:43], a[16:19], v[12:15]
  v_add_f32 v145, v145, v147
  v_add_f32 v148, v148, v150
  v_mfma_f32_16x16x32_bf16 v[28:31], a[44:47], a[16:19], v[28:31]
  v_add_f32 v149, v149, v151
  v_add_f32 v190, v144, v148
  v_mfma_f32_16x16x32_bf16 v[28:31], a[68:71], a[36:39], v[28:31]
  v_add_f32 v196, v145, v149
  s_waitcnt vmcnt(8)
  v_mfma_f32_16x16x32_bf16 v[24:27], a[68:71], a[32:35], v[24:27]
  v_add_f32 v152, v152, v154
  v_add_f32 v153, v153, v155
  v_mfma_f32_16x16x32_bf16 v[24:27], a[44:47], a[12:15], v[24:27]
  v_add_f32 v156, v156, v158
  v_add_f32 v157, v157, v159
  v_mfma_f32_16x16x32_bf16 v[20:23], a[44:47], a[8:11], v[20:23]
  s_waitcnt lgkmcnt(0)
  s_barrier
  ds_read_b64_tr_b16 a[128:129], v116 offset:0
  v_mfma_f32_16x16x32_bf16 v[20:23], a[68:71], a[28:31], v[20:23]
  ds_read_b64_tr_b16 a[130:131], v116 offset:6144
  v_add_f32 v191, v152, v156
  v_mfma_f32_16x16x32_bf16 v[16:19], a[68:71], a[24:27], v[16:19]
  ds_read_b64_tr_b16 a[152:153], v116 offset:12288
  v_add_f32 v197, v153, v157
  v_mfma_f32_16x16x32_bf16 v[16:19], a[44:47], a[4:7], v[16:19]
  ds_read_b64_tr_b16 a[154:155], v116 offset:18432
  s_waitcnt vmcnt(4)
  v_mfma_f32_16x16x32_bf16 v[32:35], a[48:51], a[0:3], v[32:35]
  ds_read_b128 a[92:95], v112 offset:0
  v_add_f32 v160, v160, v162
  v_mfma_f32_16x16x32_bf16 v[32:35], a[72:75], a[20:23], v[32:35]
  ds_read_b128 a[112:115], v113 offset:0
  v_add_f32 v161, v161, v163
  v_mfma_f32_16x16x32_bf16 v[36:39], a[72:75], a[24:27], v[36:39]
  ds_read_b128 a[96:99], v112 offset:2048
  v_add_f32 v164, v164, v166
  v_mfma_f32_16x16x32_bf16 v[36:39], a[48:51], a[4:7], v[36:39]
  ds_read_b128 a[116:119], v113 offset:2048
  v_add_f32 v165, v165, v167
  v_mfma_f32_16x16x32_bf16 v[40:43], a[48:51], a[8:11], v[40:43]
  ds_read_b128 a[100:103], v112 offset:4096
  v_add_f32 v192, v160, v164
  v_mfma_f32_16x16x32_bf16 v[40:43], a[72:75], a[28:31], v[40:43]
  ds_read_b128 a[120:123], v113 offset:4096
  v_add_f32 v198, v161, v165
  v_mfma_f32_16x16x32_bf16 v[44:47], a[72:75], a[32:35], v[44:47]
  ds_read_b128 a[104:107], v112 offset:6144
  ds_read_b128 v[128:131], v123
  v_mfma_f32_16x16x32_bf16 v[44:47], a[48:51], a[12:15], v[44:47]
  ds_read_b128 a[124:127], v113 offset:6144
  ds_read_b128 v[132:135], v123 offset:1024
  v_mfma_f32_16x16x32_bf16 v[48:51], a[48:51], a[16:19], v[48:51]
  ds_read_b64_tr_b16 a[132:133], v117 offset:0
  v_mov_b32 v240, v188
  v_mfma_f32_16x16x32_bf16 v[48:51], a[72:75], a[36:39], v[48:51]
  ds_read_b64_tr_b16 a[134:135], v117 offset:6144
  v_mov_b32 v241, v189
  v_mfma_f32_16x16x32_bf16 v[68:71], a[76:79], a[36:39], v[68:71]
  ds_read_b64_tr_b16 a[156:157], v117 offset:12288
  v_mov_b32 v242, v190
  v_mfma_f32_16x16x32_bf16 v[68:71], a[52:55], a[16:19], v[68:71]
  ds_read_b64_tr_b16 a[158:159], v117 offset:18432
  v_mov_b32 v243, v191
  v_mfma_f32_16x16x32_bf16 v[64:67], a[52:55], a[12:15], v[64:67]
  ds_read_b128 a[88:91], v114
  v_add_u32 v114, s64, v114
  v_mov_b32 v244, v192
  v_mfma_f32_16x16x32_bf16 v[64:67], a[76:79], a[32:35], v[64:67]
  ds_read_b128 a[108:111], v115
  v_add_u32 v115, s64, v115
  v_mov_b32 v245, v194
  v_mfma_f32_16x16x32_bf16 v[60:63], a[76:79], a[28:31], v[60:63]
  ds_read_b64_tr_b16 a[136:137], v116 offset:2048
  v_mov_b32 v246, v195
  v_mfma_f32_16x16x32_bf16 v[60:63], a[52:55], a[8:11], v[60:63]
  ds_read_b64_tr_b16 a[138:139], v116 offset:8192
  v_mov_b32 v247, v196
  v_mfma_f32_16x16x32_bf16 v[56:59], a[52:55], a[4:7], v[56:59]
  ds_read_b64_tr_b16 a[160:161], v116 offset:14336
  v_mov_b32 v248, v197
  v_mfma_f32_16x16x32_bf16 v[56:59], a[76:79], a[24:27], v[56:59]
  ds_read_b64_tr_b16 a[162:163], v116 offset:20480
  v_mov_b32 v249, v198
  v_mfma_f32_16x16x32_bf16 v[52:55], a[76:79], a[20:23], v[52:55]
  ds_read_b64_tr_b16 a[140:141], v117 offset:2048
  v_permlane32_swap_b32 v188, v240
  v_mfma_f32_16x16x32_bf16 v[52:55], a[52:55], a[0:3], v[52:55]
  ds_read_b64_tr_b16 a[142:143], v117 offset:8192
  v_permlane32_swap_b32 v189, v241
  v_mfma_f32_16x16x32_bf16 v[72:75], a[0:3], a[56:59], v[72:75]
  ds_read_b64_tr_b16 a[164:165], v117 offset:14336
  v_permlane32_swap_b32 v190, v242
  v_mfma_f32_16x16x32_bf16 v[72:75], a[20:23], a[80:83], v[72:75]
  ds_read_b64_tr_b16 a[166:167], v117 offset:20480
  v_permlane32_swap_b32 v191, v243
  v_mfma_f32_16x16x32_bf16 v[76:79], a[24:27], a[80:83], v[76:79]
  ds_read_b64_tr_b16 a[144:145], v116 offset:4096
  v_permlane32_swap_b32 v192, v244
  v_mfma_f32_16x16x32_bf16 v[76:79], a[4:7], a[56:59], v[76:79]
  ds_read_b64_tr_b16 a[146:147], v116 offset:10240
  v_permlane32_swap_b32 v194, v245
  v_mfma_f32_16x16x32_bf16 v[80:83], a[8:11], a[56:59], v[80:83]
  ds_read_b64_tr_b16 a[168:169], v116 offset:16384
  v_permlane32_swap_b32 v195, v246
  v_mfma_f32_16x16x32_bf16 v[80:83], a[28:31], a[80:83], v[80:83]
  ds_read_b64_tr_b16 a[170:171], v116 offset:22528
  v_permlane32_swap_b32 v196, v247
  v_mfma_f32_16x16x32_bf16 v[84:87], a[32:35], a[80:83], v[84:87]
  ds_read_b64_tr_b16 a[148:149], v117 offset:4096
  v_permlane32_swap_b32 v197, v248
  v_mfma_f32_16x16x32_bf16 v[84:87], a[12:15], a[56:59], v[84:87]
  ds_read_b64_tr_b16 a[150:151], v117 offset:10240
  v_permlane32_swap_b32 v198, v249
  v_mfma_f32_16x16x32_bf16 v[88:91], a[16:19], a[56:59], v[88:91]
  ds_read_b64_tr_b16 a[172:173], v117 offset:16384
  v_add_f32 v188, v188, v240
  v_mfma_f32_16x16x32_bf16 v[88:91], a[36:39], a[80:83], v[88:91]
  ds_read_b64_tr_b16 a[174:175], v117 offset:22528
  v_add_f32 v189, v189, v241
  v_mfma_f32_16x16x32_bf16 v[108:111], a[36:39], a[84:87], v[108:111]
  v_add_f32 v190, v190, v242
  v_add_f32 v191, v191, v243
  v_mfma_f32_16x16x32_bf16 v[108:111], a[16:19], a[60:63], v[108:111]
  v_add_f32 v192, v192, v244
  v_add_f32 v194, v194, v245
  v_mfma_f32_16x16x32_bf16 v[104:107], a[12:15], a[60:63], v[104:107]
  v_add_f32 v195, v195, v246
  v_add_f32 v196, v196, v247
  v_mfma_f32_16x16x32_bf16 v[104:107], a[32:35], a[84:87], v[104:107]
  v_add_f32 v197, v197, v248
  v_add_f32 v198, v198, v249
  v_mfma_f32_16x16x32_bf16 v[100:103], a[28:31], a[84:87], v[100:103]
  v_mov_b32 v240, v188
  v_mov_b32 v241, v189
  v_mfma_f32_16x16x32_bf16 v[100:103], a[8:11], a[60:63], v[100:103]
  v_mov_b32 v242, v190
  v_mov_b32 v243, v191
  v_mfma_f32_16x16x32_bf16 v[96:99], a[4:7], a[60:63], v[96:99]
  v_mov_b32 v244, v192
  v_mov_b32 v245, v194
  v_mfma_f32_16x16x32_bf16 v[96:99], a[24:27], a[84:87], v[96:99]
  v_mov_b32 v246, v195
  v_mov_b32 v247, v196
  v_mfma_f32_16x16x32_bf16 v[92:95], a[20:23], a[84:87], v[92:95]
  v_mov_b32 v248, v197
  v_mov_b32 v249, v198
  v_mfma_f32_16x16x32_bf16 v[92:95], a[0:3], a[60:63], v[92:95]
  s_waitcnt lgkmcnt(15)
  v_permlane16_swap_b32 v188, v240
  v_permlane16_swap_b32 v189, v241
  v_mfma_f32_16x16x32_bf16 v[0:3], a[128:131], a[92:95], v[0:3]
  v_permlane16_swap_b32 v190, v242
  v_permlane16_swap_b32 v191, v243
  v_mfma_f32_16x16x32_bf16 v[0:3], a[152:155], a[112:115], v[0:3]
  v_permlane16_swap_b32 v192, v244
  v_permlane16_swap_b32 v194, v245
  v_mfma_f32_16x16x32_bf16 v[4:7], a[152:155], a[116:119], v[4:7]
  v_permlane16_swap_b32 v195, v246
  v_permlane16_swap_b32 v196, v247
  v_mfma_f32_16x16x32_bf16 v[4:7], a[128:131], a[96:99], v[4:7]
  v_permlane16_swap_b32 v197, v248
  v_permlane16_swap_b32 v198, v249
  v_mfma_f32_16x16x32_bf16 v[8:11], a[128:131], a[100:103], v[8:11]
  v_add_f32 v188, v188, v240
  v_add_f32 v189, v189, v241
  v_mfma_f32_16x16x32_bf16 v[8:11], a[152:155], a[120:123], v[8:11]
  v_add_f32 v190, v190, v242
  v_add_f32 v191, v191, v243
  v_mfma_f32_16x16x32_bf16 v[12:15], a[152:155], a[124:127], v[12:15]
  v_add_f32 v192, v192, v244
  v_add_f32 v194, v194, v245
  v_mfma_f32_16x16x32_bf16 v[12:15], a[128:131], a[104:107], v[12:15]
  v_add_f32 v195, v195, v246
  v_add_f32 v196, v196, v247
  v_mfma_f32_16x16x32_bf16 v[28:31], a[132:135], a[104:107], v[28:31]
  v_add_f32 v197, v197, v248
  v_add_f32 v198, v198, v249
  v_mfma_f32_16x16x32_bf16 v[28:31], a[156:159], a[124:127], v[28:31]
  s_mov_b32 s48, 0x3a800000
  v_mov_b32 v240, 0x3727c5ac
  v_mfma_f32_16x16x32_bf16 v[24:27], a[156:159], a[120:123], v[24:27]
  v_mul_f32 v188, 0xba800000, v188
  v_fma_f32 v194, v194, s48, v240
  v_mfma_f32_16x16x32_bf16 v[24:27], a[132:135], a[100:103], v[24:27]
  v_fma_f32 v194, -v188, v188, v194
  v_max_f32 v194, v194, v240
  v_mfma_f32_16x16x32_bf16 v[20:23], a[132:135], a[96:99], v[20:23]
  s_waitcnt lgkmcnt(0)
  s_barrier
  v_rsq_f32 v194, v194
  v_mfma_f32_16x16x32_bf16 v[20:23], a[156:159], a[116:119], v[20:23]
  s_add_u32 m0, s89, 0
  ds_write_b32 v125, v188 offset:0
  v_mfma_f32_16x16x32_bf16 v[16:19], a[156:159], a[112:115], v[16:19]
  s_add_u32 s92, s91, s80
  ds_write_b32 v125, v194 offset:64
  v_mfma_f32_16x16x32_bf16 v[16:19], a[132:135], a[92:95], v[16:19]
  s_and_b32 s92, s92, 0x1fffff
  v_mul_f32 v189, 0xba800000, v189
  v_mfma_f32_16x16x32_bf16 v[32:35], a[136:139], a[88:91], v[32:35]
  buffer_load_dwordx4 v186, s[12:15], s92 offen lds
  v_fma_f32 v195, v195, s48, v240
  v_mfma_f32_16x16x32_bf16 v[32:35], a[160:163], a[108:111], v[32:35]
  s_add_u32 s91, s91, 65536
  v_fma_f32 v195, -v189, v189, v195
  v_mfma_f32_16x16x32_bf16 v[36:39], a[160:163], a[112:115], v[36:39]
  s_add_u32 m0, s89, 4096
  v_max_f32 v195, v195, v240
  v_mfma_f32_16x16x32_bf16 v[36:39], a[136:139], a[92:95], v[36:39]
  s_add_u32 s92, s91, s81
  v_rsq_f32 v195, v195
  v_mfma_f32_16x16x32_bf16 v[40:43], a[136:139], a[96:99], v[40:43]
  s_and_b32 s92, s92, 0x1fffff
  ds_write_b32 v125, v189 offset:128
  v_mfma_f32_16x16x32_bf16 v[40:43], a[160:163], a[116:119], v[40:43]
  buffer_load_dwordx4 v186, s[12:15], s92 offen lds
  ds_write_b32 v125, v195 offset:192
  v_mfma_f32_16x16x32_bf16 v[44:47], a[160:163], a[120:123], v[44:47]
  s_add_u32 s91, s91, 65536
  v_mul_f32 v190, 0xba800000, v190
  v_mfma_f32_16x16x32_bf16 v[44:47], a[136:139], a[100:103], v[44:47]
  s_add_u32 m0, s89, 8192
  v_fma_f32 v196, v196, s48, v240
  v_mfma_f32_16x16x32_bf16 v[48:51], a[136:139], a[104:107], v[48:51]
  s_add_u32 s92, s91, s82
  v_fma_f32 v196, -v190, v190, v196
  v_mfma_f32_16x16x32_bf16 v[48:51], a[160:163], a[124:127], v[48:51]
  s_and_b32 s92, s92, 0x1fffff
  v_max_f32 v196, v196, v240
  v_mfma_f32_16x16x32_bf16 v[68:71], a[164:167], a[124:127], v[68:71]
  buffer_load_dwordx4 v186, s[12:15], s92 offen lds
  v_rsq_f32 v196, v196
  v_mfma_f32_16x16x32_bf16 v[68:71], a[140:143], a[104:107], v[68:71]
  s_add_u32 s91, s91, 65536
  ds_write_b32 v125, v190 offset:256
  v_mfma_f32_16x16x32_bf16 v[64:67], a[140:143], a[100:103], v[64:67]
  s_add_u32 m0, s89, 12288
  ds_write_b32 v125, v196 offset:320
  v_mfma_f32_16x16x32_bf16 v[64:67], a[164:167], a[120:123], v[64:67]
  s_add_u32 s92, s91, s83
  v_mul_f32 v191, 0xba800000, v191
  v_mfma_f32_16x16x32_bf16 v[60:63], a[164:167], a[116:119], v[60:63]
  s_and_b32 s92, s92, 0x1fffff
  v_fma_f32 v197, v197, s48, v240
  v_mfma_f32_16x16x32_bf16 v[60:63], a[140:143], a[96:99], v[60:63]
  buffer_load_dwordx4 v186, s[12:15], s92 offen lds
  v_fma_f32 v197, -v191, v191, v197
  v_mfma_f32_16x16x32_bf16 v[56:59], a[140:143], a[92:95], v[56:59]
  s_add_u32 s91, s91, 65536
  v_max_f32 v197, v197, v240
  v_mfma_f32_16x16x32_bf16 v[56:59], a[164:167], a[112:115], v[56:59]
  s_add_u32 m0, s89, 16384
  v_rsq_f32 v197, v197
  v_mfma_f32_16x16x32_bf16 v[52:55], a[164:167], a[108:111], v[52:55]
  s_add_u32 s92, s91, s84
  ds_write_b32 v125, v191 offset:384
  v_mfma_f32_16x16x32_bf16 v[52:55], a[140:143], a[88:91], v[52:55]
  s_and_b32 s92, s92, 0x1fffff
  ds_write_b32 v125, v197 offset:448
  v_mfma_f32_16x16x32_bf16 v[72:75], a[88:91], a[144:147], v[72:75]
  buffer_load_dwordx4 v186, s[12:15], s92 offen lds
  v_mul_f32 v192, 0xba800000, v192
  v_mfma_f32_16x16x32_bf16 v[72:75], a[108:111], a[168:171], v[72:75]
  s_add_u32 s91, s91, 65536
  v_fma_f32 v198, v198, s48, v240
  v_mfma_f32_16x16x32_bf16 v[76:79], a[112:115], a[168:171], v[76:79]
  s_add_u32 m0, s89, 20480
  v_fma_f32 v198, -v192, v192, v198
  v_mfma_f32_16x16x32_bf16 v[76:79], a[92:95], a[144:147], v[76:79]
  s_add_u32 s92, s91, s85
  v_max_f32 v198, v198, v240
  v_mfma_f32_16x16x32_bf16 v[80:83], a[96:99], a[144:147], v[80:83]
  s_and_b32 s92, s92, 0x1fffff
  v_rsq_f32 v198, v198
  v_mfma_f32_16x16x32_bf16 v[80:83], a[116:119], a[168:171], v[80:83]
  buffer_load_dwordx4 v186, s[12:15], s92 offen lds
  ds_write_b32 v125, v192 offset:512
  v_mfma_f32_16x16x32_bf16 v[84:87], a[120:123], a[168:171], v[84:87]
  s_add_u32 s91, s91, 65536
  ds_write_b32 v125, v198 offset:576
  v_mfma_f32_16x16x32_bf16 v[84:87], a[100:103], a[144:147], v[84:87]
  s_add_u32 m0, s89, 24576
  ds_read_b128 v[200:203], v124 offset:0
  v_mfma_f32_16x16x32_bf16 v[88:91], a[104:107], a[144:147], v[88:91]
  s_add_u32 s92, s91, s86
  ds_read_b128 v[220:223], v124 offset:64
  v_mfma_f32_16x16x32_bf16 v[88:91], a[124:127], a[168:171], v[88:91]
  s_and_b32 s92, s92, 0x1fffff
  ds_read_b128 v[204:207], v124 offset:128
  v_mfma_f32_16x16x32_bf16 v[108:111], a[124:127], a[172:175], v[108:111]
  buffer_load_dwordx4 v186, s[12:15], s92 offen lds
  ds_read_b128 v[224:227], v124 offset:192
  v_mfma_f32_16x16x32_bf16 v[108:111], a[104:107], a[148:151], v[108:111]
  s_add_u32 s91, s91, 65536
  ds_read_b128 v[208:211], v124 offset:256
  v_mfma_f32_16x16x32_bf16 v[104:107], a[100:103], a[148:151], v[104:107]
  s_add_u32 m0, s89, 28672
  ds_read_b128 v[228:231], v124 offset:320
  v_mfma_f32_16x16x32_bf16 v[104:107], a[120:123], a[172:175], v[104:107]
  s_add_u32 s92, s91, s87
  ds_read_b128 v[212:215], v124 offset:384
  v_mfma_f32_16x16x32_bf16 v[100:103], a[116:119], a[172:175], v[100:103]
  s_and_b32 s92, s92, 0x1fffff
  ds_read_b128 v[232:235], v124 offset:448
  v_mfma_f32_16x16x32_bf16 v[100:103], a[96:99], a[148:151], v[100:103]
  buffer_load_dwordx4 v186, s[12:15], s92 offen lds
  ds_read_b128 v[216:219], v124 offset:512
  v_mfma_f32_16x16x32_bf16 v[96:99], a[92:95], a[148:151], v[96:99]
  s_add_u32 s91, s91, 65536
  ds_read_b128 v[236:239], v124 offset:576
  v_mfma_f32_16x16x32_bf16 v[96:99], a[112:115], a[172:175], v[96:99]
  s_and_b32 s43, s50, 7
  s_or_b32 s43, s43, s57
  s_cselect_b64 s[46:47], -1, 0
  v_mfma_f32_16x16x32_bf16 v[92:95], a[108:111], a[172:175], v[92:95]
  v_mov_b32 v245, 0xf149f2ca
  v_mfma_f32_16x16x32_bf16 v[92:95], a[88:91], a[148:151], v[92:95]
  v_cndmask_b32 v136, v245, v132, s[46:47]
  v_mov_b32 v160, 0x3f803f80
  v_cndmask_b32 v137, v245, v133, s[46:47]
  v_mov_b32 v161, 0x3f803f80
  v_cndmask_b32 v138, v245, v134, s[46:47]
  v_mov_b32 v162, 0x3f803f80
  v_cndmask_b32 v139, v245, v135, s[46:47]
  v_mov_b32 v163, 0x3f803f80
  v_pk_fma_f32 v[32:33], v[176:177], v[188:189], v[32:33] op_sel:[0,0,0] op_sel_hi:[1,0,1]
  v_pk_fma_f32 v[34:35], v[178:179], v[188:189], v[34:35] op_sel:[0,0,0] op_sel_hi:[1,0,1]
  v_pk_fma_f32 v[52:53], v[180:181], v[188:189], v[52:53] op_sel:[0,0,0] op_sel_hi:[1,0,1]
  v_pk_fma_f32 v[54:55], v[182:183], v[188:189], v[54:55] op_sel:[0,0,0] op_sel_hi:[1,0,1]
  v_pk_mul_f32 v[32:33], v[32:33], v[194:195] op_sel:[0,0] op_sel_hi:[1,0]
  v_pk_mul_f32 v[34:35], v[34:35], v[194:195] op_sel:[0,0] op_sel_hi:[1,0]
  v_pk_mul_f32 v[52:53], v[52:53], v[194:195] op_sel:[0,0] op_sel_hi:[1,0]
  v_pk_mul_f32 v[54:55], v[54:55], v[194:195] op_sel:[0,0] op_sel_hi:[1,0]
  v_cvt_pk_bf16_f32 v32, v32, v33
  v_cvt_pk_bf16_f32 v33, v34, v35
  v_cvt_pk_bf16_f32 v34, v52, v53
  v_cvt_pk_bf16_f32 v35, v54, v55
  s_add_u32 m0, s89, 32768
  s_add_u32 s92, s91, s80
  s_and_b32 s92, s92, 0x1fffff
  buffer_load_dwordx4 v186, s[12:15], s92 offen lds
  s_add_u32 s91, s91, 65536
  v_pk_fma_f32 v[36:37], v[176:177], v[188:189], v[36:37] op_sel:[0,1,0] op_sel_hi:[1,1,1]
  v_pk_fma_f32 v[38:39], v[178:179], v[188:189], v[38:39] op_sel:[0,1,0] op_sel_hi:[1,1,1]
  v_pk_fma_f32 v[56:57], v[180:181], v[188:189], v[56:57] op_sel:[0,1,0] op_sel_hi:[1,1,1]
  v_pk_fma_f32 v[58:59], v[182:183], v[188:189], v[58:59] op_sel:[0,1,0] op_sel_hi:[1,1,1]
  v_pk_mul_f32 v[36:37], v[36:37], v[194:195] op_sel:[0,1] op_sel_hi:[1,1]
  v_pk_mul_f32 v[38:39], v[38:39], v[194:195] op_sel:[0,1] op_sel_hi:[1,1]
  v_pk_mul_f32 v[56:57], v[56:57], v[194:195] op_sel:[0,1] op_sel_hi:[1,1]
  v_pk_mul_f32 v[58:59], v[58:59], v[194:195] op_sel:[0,1] op_sel_hi:[1,1]
  v_cvt_pk_bf16_f32 v36, v36, v37
  v_cvt_pk_bf16_f32 v37, v38, v39
  v_cvt_pk_bf16_f32 v38, v56, v57
  v_cvt_pk_bf16_f32 v39, v58, v59
  s_add_u32 m0, s89, 36864
  s_add_u32 s92, s91, s81
  s_and_b32 s92, s92, 0x1fffff
  buffer_load_dwordx4 v186, s[12:15], s92 offen lds
  s_add_u32 s91, s91, 65536
  v_pk_fma_f32 v[40:41], v[176:177], v[190:191], v[40:41] op_sel:[0,0,0] op_sel_hi:[1,0,1]
  v_pk_fma_f32 v[42:43], v[178:179], v[190:191], v[42:43] op_sel:[0,0,0] op_sel_hi:[1,0,1]
  v_pk_fma_f32 v[60:61], v[180:181], v[190:191], v[60:61] op_sel:[0,0,0] op_sel_hi:[1,0,1]
  v_pk_fma_f32 v[62:63], v[182:183], v[190:191], v[62:63] op_sel:[0,0,0] op_sel_hi:[1,0,1]
  v_pk_mul_f32 v[40:41], v[40:41], v[196:197] op_sel:[0,0] op_sel_hi:[1,0]
  v_pk_mul_f32 v[42:43], v[42:43], v[196:197] op_sel:[0,0] op_sel_hi:[1,0]
  v_pk_mul_f32 v[60:61], v[60:61], v[196:197] op_sel:[0,0] op_sel_hi:[1,0]
  v_pk_mul_f32 v[62:63], v[62:63], v[196:197] op_sel:[0,0] op_sel_hi:[1,0]
  v_cvt_pk_bf16_f32 v40, v40, v41
  v_cvt_pk_bf16_f32 v41, v42, v43
  v_cvt_pk_bf16_f32 v42, v60, v61
  v_cvt_pk_bf16_f32 v43, v62, v63
  v_pk_fma_f32 v[44:45], v[176:177], v[190:191], v[44:45] op_sel:[0,1,0] op_sel_hi:[1,1,1]
  v_pk_fma_f32 v[46:47], v[178:179], v[190:191], v[46:47] op_sel:[0,1,0] op_sel_hi:[1,1,1]
  v_pk_fma_f32 v[64:65], v[180:181], v[190:191], v[64:65] op_sel:[0,1,0] op_sel_hi:[1,1,1]
  v_pk_fma_f32 v[66:67], v[182:183], v[190:191], v[66:67] op_sel:[0,1,0] op_sel_hi:[1,1,1]
  v_pk_mul_f32 v[44:45], v[44:45], v[196:197] op_sel:[0,1] op_sel_hi:[1,1]
  v_pk_mul_f32 v[46:47], v[46:47], v[196:197] op_sel:[0,1] op_sel_hi:[1,1]
  v_pk_mul_f32 v[64:65], v[64:65], v[196:197] op_sel:[0,1] op_sel_hi:[1,1]
  v_pk_mul_f32 v[66:67], v[66:67], v[196:197] op_sel:[0,1] op_sel_hi:[1,1]
  v_cvt_pk_bf16_f32 v44, v44, v45
  v_cvt_pk_bf16_f32 v45, v46, v47
  v_cvt_pk_bf16_f32 v46, v64, v65
  v_cvt_pk_bf16_f32 v47, v66, v67
  s_add_u32 m0, s89, 40960
  s_add_u32 s92, s91, s82
  s_and_b32 s92, s92, 0x1fffff
  buffer_load_dwordx4 v186, s[12:15], s92 offen lds
  s_add_u32 s91, s91, 65536
  v_pk_fma_f32 v[48:49], v[176:177], v[192:193], v[48:49] op_sel:[0,0,0] op_sel_hi:[1,0,1]
  v_pk_fma_f32 v[50:51], v[178:179], v[192:193], v[50:51] op_sel:[0,0,0] op_sel_hi:[1,0,1]
  v_pk_fma_f32 v[68:69], v[180:181], v[192:193], v[68:69] op_sel:[0,0,0] op_sel_hi:[1,0,1]
  v_pk_fma_f32 v[70:71], v[182:183], v[192:193], v[70:71] op_sel:[0,0,0] op_sel_hi:[1,0,1]
  v_pk_mul_f32 v[48:49], v[48:49], v[198:199] op_sel:[0,0] op_sel_hi:[1,0]
  v_pk_mul_f32 v[50:51], v[50:51], v[198:199] op_sel:[0,0] op_sel_hi:[1,0]
  v_pk_mul_f32 v[68:69], v[68:69], v[198:199] op_sel:[0,0] op_sel_hi:[1,0]
  v_pk_mul_f32 v[70:71], v[70:71], v[198:199] op_sel:[0,0] op_sel_hi:[1,0]
  v_cvt_pk_bf16_f32 v48, v48, v49
  v_cvt_pk_bf16_f32 v49, v50, v51
  v_cvt_pk_bf16_f32 v50, v68, v69
  v_cvt_pk_bf16_f32 v51, v70, v71
  s_add_u32 m0, s89, 45056
  s_add_u32 s92, s91, s83
  s_and_b32 s92, s92, 0x1fffff
  buffer_load_dwordx4 v186, s[12:15], s92 offen lds
  s_add_u32 s91, s91, 65536
  v_pk_fma_f32 v[0:1], v[168:169], v[188:189], v[0:1] op_sel:[0,1,0] op_sel_hi:[1,1,1]
  v_pk_fma_f32 v[2:3], v[170:171], v[188:189], v[2:3] op_sel:[0,1,0] op_sel_hi:[1,1,1]
  v_pk_fma_f32 v[16:17], v[172:173], v[188:189], v[16:17] op_sel:[0,1,0] op_sel_hi:[1,1,1]
  v_pk_fma_f32 v[18:19], v[174:175], v[188:189], v[18:19] op_sel:[0,1,0] op_sel_hi:[1,1,1]
  v_pk_mul_f32 v[0:1], v[0:1], v[194:195] op_sel:[0,1] op_sel_hi:[1,1]
  v_pk_mul_f32 v[2:3], v[2:3], v[194:195] op_sel:[0,1] op_sel_hi:[1,1]
  v_pk_mul_f32 v[16:17], v[16:17], v[194:195] op_sel:[0,1] op_sel_hi:[1,1]
  v_pk_mul_f32 v[18:19], v[18:19], v[194:195] op_sel:[0,1] op_sel_hi:[1,1]
  v_cvt_pk_bf16_f32 v0, v0, v1
  v_cvt_pk_bf16_f32 v1, v2, v3
  v_cvt_pk_bf16_f32 v2, v16, v17
  v_cvt_pk_bf16_f32 v3, v18, v19
  s_add_u32 m0, s89, 49152
  s_add_u32 s92, s91, s84
  s_and_b32 s92, s92, 0x1fffff
  buffer_load_dwordx4 v186, s[12:15], s92 offen lds
  s_add_u32 s91, s91, 65536
  v_pk_fma_f32 v[4:5], v[168:169], v[190:191], v[4:5] op_sel:[0,0,0] op_sel_hi:[1,0,1]
  v_pk_fma_f32 v[6:7], v[170:171], v[190:191], v[6:7] op_sel:[0,0,0] op_sel_hi:[1,0,1]
  v_pk_fma_f32 v[20:21], v[172:173], v[190:191], v[20:21] op_sel:[0,0,0] op_sel_hi:[1,0,1]
  v_pk_fma_f32 v[22:23], v[174:175], v[190:191], v[22:23] op_sel:[0,0,0] op_sel_hi:[1,0,1]
  v_pk_mul_f32 v[4:5], v[4:5], v[196:197] op_sel:[0,0] op_sel_hi:[1,0]
  v_pk_mul_f32 v[6:7], v[6:7], v[196:197] op_sel:[0,0] op_sel_hi:[1,0]
  v_pk_mul_f32 v[20:21], v[20:21], v[196:197] op_sel:[0,0] op_sel_hi:[1,0]
  v_pk_mul_f32 v[22:23], v[22:23], v[196:197] op_sel:[0,0] op_sel_hi:[1,0]
  v_cvt_pk_bf16_f32 v4, v4, v5
  v_cvt_pk_bf16_f32 v5, v6, v7
  v_cvt_pk_bf16_f32 v6, v20, v21
  v_cvt_pk_bf16_f32 v7, v22, v23
  v_pk_fma_f32 v[8:9], v[168:169], v[190:191], v[8:9] op_sel:[0,1,0] op_sel_hi:[1,1,1]
  v_pk_fma_f32 v[10:11], v[170:171], v[190:191], v[10:11] op_sel:[0,1,0] op_sel_hi:[1,1,1]
  v_pk_fma_f32 v[24:25], v[172:173], v[190:191], v[24:25] op_sel:[0,1,0] op_sel_hi:[1,1,1]
  v_pk_fma_f32 v[26:27], v[174:175], v[190:191], v[26:27] op_sel:[0,1,0] op_sel_hi:[1,1,1]
  v_pk_mul_f32 v[8:9], v[8:9], v[196:197] op_sel:[0,1] op_sel_hi:[1,1]
  v_pk_mul_f32 v[10:11], v[10:11], v[196:197] op_sel:[0,1] op_sel_hi:[1,1]
  v_pk_mul_f32 v[24:25], v[24:25], v[196:197] op_sel:[0,1] op_sel_hi:[1,1]
  v_pk_mul_f32 v[26:27], v[26:27], v[196:197] op_sel:[0,1] op_sel_hi:[1,1]
  v_cvt_pk_bf16_f32 v8, v8, v9
  v_cvt_pk_bf16_f32 v9, v10, v11
  v_cvt_pk_bf16_f32 v10, v24, v25
  v_cvt_pk_bf16_f32 v11, v26, v27
  s_add_u32 m0, s89, 53248
  s_add_u32 s92, s91, s85
  s_and_b32 s92, s92, 0x1fffff
  buffer_load_dwordx4 v186, s[12:15], s92 offen lds
  s_add_u32 s91, s91, 65536
  v_pk_fma_f32 v[12:13], v[168:169], v[192:193], v[12:13] op_sel:[0,0,0] op_sel_hi:[1,0,1]
  v_pk_fma_f32 v[14:15], v[170:171], v[192:193], v[14:15] op_sel:[0,0,0] op_sel_hi:[1,0,1]
  v_pk_fma_f32 v[28:29], v[172:173], v[192:193], v[28:29] op_sel:[0,0,0] op_sel_hi:[1,0,1]
  v_pk_fma_f32 v[30:31], v[174:175], v[192:193], v[30:31] op_sel:[0,0,0] op_sel_hi:[1,0,1]
  v_pk_mul_f32 v[12:13], v[12:13], v[198:199] op_sel:[0,0] op_sel_hi:[1,0]
  v_pk_mul_f32 v[14:15], v[14:15], v[198:199] op_sel:[0,0] op_sel_hi:[1,0]
  v_pk_mul_f32 v[28:29], v[28:29], v[198:199] op_sel:[0,0] op_sel_hi:[1,0]
  v_pk_mul_f32 v[30:31], v[30:31], v[198:199] op_sel:[0,0] op_sel_hi:[1,0]
  v_cvt_pk_bf16_f32 v12, v12, v13
  v_cvt_pk_bf16_f32 v13, v14, v15
  v_cvt_pk_bf16_f32 v14, v28, v29
  v_cvt_pk_bf16_f32 v15, v30, v31
  s_nop 1
  v_mfma_f32_16x16x32_bf16 v[16:19], v[32:35], v[0:3], v[136:139]
  v_mfma_f32_16x16x32_bf16 v[56:59], v[36:39], v[0:3], v[128:131]
  v_mfma_f32_16x16x32_bf16 v[20:23], v[36:39], v[4:7], v[132:135]
  v_mfma_f32_16x16x32_bf16 v[60:63], v[40:43], v[4:7], v[128:131]
  v_mfma_f32_16x16x32_bf16 v[24:27], v[40:43], v[8:11], v[132:135]
  v_mfma_f32_16x16x32_bf16 v[64:67], v[44:47], v[8:11], v[128:131]
  v_mfma_f32_16x16x32_bf16 v[28:31], v[44:47], v[12:15], v[132:135]
  v_mfma_f32_16x16x32_bf16 v[68:71], v[48:51], v[12:15], v[128:131]
  s_waitcnt lgkmcnt(0)
  v_pk_fma_f32 v[72:73], v[200:201], v[184:185], v[72:73] op_sel:[0,0,0] op_sel_hi:[1,0,1]
  v_pk_fma_f32 v[74:75], v[202:203], v[184:185], v[74:75] op_sel:[0,0,0] op_sel_hi:[1,0,1]
  v_pk_fma_f32 v[92:93], v[200:201], v[184:185], v[92:93] op_sel:[0,1,0] op_sel_hi:[1,1,1]
  v_pk_fma_f32 v[94:95], v[202:203], v[184:185], v[94:95] op_sel:[0,1,0] op_sel_hi:[1,1,1]
  v_pk_mul_f32 v[72:73], v[72:73], v[220:221]
  v_pk_mul_f32 v[74:75], v[74:75], v[222:223]
  v_pk_mul_f32 v[92:93], v[92:93], v[220:221]
  v_pk_mul_f32 v[94:95], v[94:95], v[222:223]
  v_cvt_pk_bf16_f32 v140, v72, v73
  v_cvt_pk_bf16_f32 v141, v74, v75
  v_cvt_pk_bf16_f32 v150, v92, v93
  v_cvt_pk_bf16_f32 v151, v94, v95
  s_add_u32 m0, s89, 57344
  s_add_u32 s92, s91, s86
  s_and_b32 s92, s92, 0x1fffff
  buffer_load_dwordx4 v186, s[12:15], s92 offen lds
  s_add_u32 s91, s91, 65536
  v_pk_fma_f32 v[76:77], v[204:205], v[184:185], v[76:77] op_sel:[0,0,0] op_sel_hi:[1,0,1]
  v_pk_fma_f32 v[78:79], v[206:207], v[184:185], v[78:79] op_sel:[0,0,0] op_sel_hi:[1,0,1]
  v_pk_fma_f32 v[96:97], v[204:205], v[184:185], v[96:97] op_sel:[0,1,0] op_sel_hi:[1,1,1]
  v_pk_fma_f32 v[98:99], v[206:207], v[184:185], v[98:99] op_sel:[0,1,0] op_sel_hi:[1,1,1]
  v_pk_mul_f32 v[76:77], v[76:77], v[224:225]
  v_pk_mul_f32 v[78:79], v[78:79], v[226:227]
  v_pk_mul_f32 v[96:97], v[96:97], v[224:225]
  v_pk_mul_f32 v[98:99], v[98:99], v[226:227]
  v_cvt_pk_bf16_f32 v142, v76, v77
  v_cvt_pk_bf16_f32 v143, v78, v79
  v_cvt_pk_bf16_f32 v152, v96, v97
  v_cvt_pk_bf16_f32 v153, v98, v99
  v_pk_fma_f32 v[80:81], v[208:209], v[184:185], v[80:81] op_sel:[0,0,0] op_sel_hi:[1,0,1]
  v_pk_fma_f32 v[82:83], v[210:211], v[184:185], v[82:83] op_sel:[0,0,0] op_sel_hi:[1,0,1]
  v_pk_fma_f32 v[100:101], v[208:209], v[184:185], v[100:101] op_sel:[0,1,0] op_sel_hi:[1,1,1]
  v_pk_fma_f32 v[102:103], v[210:211], v[184:185], v[102:103] op_sel:[0,1,0] op_sel_hi:[1,1,1]
  v_pk_mul_f32 v[80:81], v[80:81], v[228:229]
  v_pk_mul_f32 v[82:83], v[82:83], v[230:231]
  v_pk_mul_f32 v[100:101], v[100:101], v[228:229]
  v_pk_mul_f32 v[102:103], v[102:103], v[230:231]
  v_cvt_pk_bf16_f32 v144, v80, v81
  v_cvt_pk_bf16_f32 v145, v82, v83
  v_cvt_pk_bf16_f32 v154, v100, v101
  v_cvt_pk_bf16_f32 v155, v102, v103
  s_add_u32 m0, s89, 61440
  s_add_u32 s92, s91, s87
  s_and_b32 s92, s92, 0x1fffff
  buffer_load_dwordx4 v186, s[12:15], s92 offen lds
  s_add_u32 s91, s91, 65536
  v_pk_fma_f32 v[84:85], v[212:213], v[184:185], v[84:85] op_sel:[0,0,0] op_sel_hi:[1,0,1]
  v_pk_fma_f32 v[86:87], v[214:215], v[184:185], v[86:87] op_sel:[0,0,0] op_sel_hi:[1,0,1]
  v_pk_fma_f32 v[104:105], v[212:213], v[184:185], v[104:105] op_sel:[0,1,0] op_sel_hi:[1,1,1]
  v_pk_fma_f32 v[106:107], v[214:215], v[184:185], v[106:107] op_sel:[0,1,0] op_sel_hi:[1,1,1]
  v_pk_mul_f32 v[84:85], v[84:85], v[232:233]
  v_pk_mul_f32 v[86:87], v[86:87], v[234:235]
  v_pk_mul_f32 v[104:105], v[104:105], v[232:233]
  v_pk_mul_f32 v[106:107], v[106:107], v[234:235]
  v_cvt_pk_bf16_f32 v146, v84, v85
  v_cvt_pk_bf16_f32 v147, v86, v87
  v_cvt_pk_bf16_f32 v156, v104, v105
  v_cvt_pk_bf16_f32 v157, v106, v107
  v_pk_fma_f32 v[88:89], v[216:217], v[184:185], v[88:89] op_sel:[0,0,0] op_sel_hi:[1,0,1]
  v_pk_fma_f32 v[90:91], v[218:219], v[184:185], v[90:91] op_sel:[0,0,0] op_sel_hi:[1,0,1]
  v_pk_fma_f32 v[108:109], v[216:217], v[184:185], v[108:109] op_sel:[0,1,0] op_sel_hi:[1,1,1]
  v_pk_fma_f32 v[110:111], v[218:219], v[184:185], v[110:111] op_sel:[0,1,0] op_sel_hi:[1,1,1]
  v_pk_mul_f32 v[88:89], v[88:89], v[236:237]
  v_pk_mul_f32 v[90:91], v[90:91], v[238:239]
  v_pk_mul_f32 v[108:109], v[108:109], v[236:237]
  v_pk_mul_f32 v[110:111], v[110:111], v[238:239]
  v_cvt_pk_bf16_f32 v148, v88, v89
  v_cvt_pk_bf16_f32 v149, v90, v91
  v_cvt_pk_bf16_f32 v158, v108, v109
  v_cvt_pk_bf16_f32 v159, v110, v111
  s_add_u32 m0, s89, 65536
  s_add_u32 s92, s91, s80
  s_and_b32 s92, s92, 0x1fffff
  buffer_load_dwordx4 v186, s[12:15], s92 offen lds
  s_add_u32 s91, s91, 65536
  v_max3_f32 v240, v16, v17, v18
  v_max3_f32 v241, v20, v21, v22
  v_max3_f32 v242, v24, v25, v26
  v_max3_f32 v243, v28, v29, v30
  v_max3_f32 v240, v240, v19, v56
  v_max3_f32 v241, v241, v23, v60
  v_max3_f32 v242, v242, v27, v64
  v_max3_f32 v243, v243, v31, v68
  v_max3_f32 v240, v240, v57, v58
  v_max3_f32 v241, v241, v61, v62
  v_max3_f32 v242, v242, v65, v66
  v_max3_f32 v243, v243, v69, v70
  v_max_f32 v240, v240, v59
  v_max_f32 v241, v241, v63
  v_max_f32 v242, v242, v67
  v_max_f32 v243, v243, v71
  v_mov_b32 v244, v240
  v_mov_b32 v245, v241
  v_mov_b32 v246, v242
  v_mov_b32 v247, v243
  v_permlane32_swap_b32 v240, v244
  v_permlane32_swap_b32 v241, v245
  v_permlane32_swap_b32 v242, v246
  v_permlane32_swap_b32 v243, v247
  v_max_f32 v240, v240, v244
  v_max_f32 v241, v241, v245
  v_max_f32 v242, v242, v246
  v_max_f32 v243, v243, v247
  v_mov_b32 v244, v240
  v_mov_b32 v245, v241
  v_mov_b32 v246, v242
  v_mov_b32 v247, v243
  v_permlane16_swap_b32 v240, v244
  v_permlane16_swap_b32 v241, v245
  v_permlane16_swap_b32 v242, v246
  v_permlane16_swap_b32 v243, v247
  v_max_f32 v240, v240, v244
  v_max_f32 v241, v241, v245
  v_max_f32 v242, v242, v246
  v_max_f32 v243, v243, v247
  s_add_u32 m0, s89, 69632
  s_add_u32 s92, s91, s81
  s_and_b32 s92, s92, 0x1fffff
  buffer_load_dwordx4 v186, s[12:15], s92 offen lds
  s_add_u32 s91, s91, 65536
  s_mov_b32 s46, 0x3e8293ee
  v_mul_f32 v240, 0xbe8293ee, v240
  v_mul_f32 v241, 0xbe8293ee, v241
  v_mul_f32 v242, 0xbe8293ee, v242
  v_mul_f32 v243, 0xbe8293ee, v243
  v_fma_f32 v16, v16, s46, v240
  v_fma_f32 v17, v17, s46, v240
  v_fma_f32 v18, v18, s46, v240
  v_fma_f32 v19, v19, s46, v240
  v_fma_f32 v56, v56, s46, v240
  v_fma_f32 v57, v57, s46, v240
  v_fma_f32 v58, v58, s46, v240
  v_fma_f32 v59, v59, s46, v240
  v_exp_f32 v16, v16
  v_exp_f32 v17, v17
  v_exp_f32 v18, v18
  v_exp_f32 v19, v19
  v_exp_f32 v56, v56
  v_exp_f32 v57, v57
  v_exp_f32 v58, v58
  v_exp_f32 v59, v59
  v_cvt_pk_bf16_f32 v0, v16, v17
  v_cvt_pk_bf16_f32 v1, v18, v19
  v_cvt_pk_bf16_f32 v2, v56, v57
  v_cvt_pk_bf16_f32 v3, v58, v59
  v_fma_f32 v20, v20, s46, v241
  v_fma_f32 v21, v21, s46, v241
  v_fma_f32 v22, v22, s46, v241
  v_fma_f32 v23, v23, s46, v241
  v_fma_f32 v60, v60, s46, v241
  v_fma_f32 v61, v61, s46, v241
  v_fma_f32 v62, v62, s46, v241
  v_fma_f32 v63, v63, s46, v241
  v_exp_f32 v20, v20
  v_exp_f32 v21, v21
  v_exp_f32 v22, v22
  v_exp_f32 v23, v23
  v_exp_f32 v60, v60
  v_exp_f32 v61, v61
  v_exp_f32 v62, v62
  v_exp_f32 v63, v63
  v_cvt_pk_bf16_f32 v4, v20, v21
  v_cvt_pk_bf16_f32 v5, v22, v23
  v_cvt_pk_bf16_f32 v6, v60, v61
  v_cvt_pk_bf16_f32 v7, v62, v63
  v_fma_f32 v24, v24, s46, v242
  v_fma_f32 v25, v25, s46, v242
  v_fma_f32 v26, v26, s46, v242
  v_fma_f32 v27, v27, s46, v242
  v_fma_f32 v64, v64, s46, v242
  v_fma_f32 v65, v65, s46, v242
  v_fma_f32 v66, v66, s46, v242
  v_fma_f32 v67, v67, s46, v242
  v_exp_f32 v24, v24
  v_exp_f32 v25, v25
  v_exp_f32 v26, v26
  v_exp_f32 v27, v27
  v_exp_f32 v64, v64
  v_exp_f32 v65, v65
  v_exp_f32 v66, v66
  v_exp_f32 v67, v67
  v_cvt_pk_bf16_f32 v8, v24, v25
  v_cvt_pk_bf16_f32 v9, v26, v27
  v_cvt_pk_bf16_f32 v10, v64, v65
  v_cvt_pk_bf16_f32 v11, v66, v67
  v_fma_f32 v28, v28, s46, v243
  v_fma_f32 v29, v29, s46, v243
  v_fma_f32 v30, v30, s46, v243
  v_fma_f32 v31, v31, s46, v243
  v_fma_f32 v68, v68, s46, v243
  v_fma_f32 v69, v69, s46, v243
  v_fma_f32 v70, v70, s46, v243
  v_fma_f32 v71, v71, s46, v243
  v_exp_f32 v28, v28
  v_exp_f32 v29, v29
  v_exp_f32 v30, v30
  v_exp_f32 v31, v31
  v_exp_f32 v68, v68
  v_exp_f32 v69, v69
  v_exp_f32 v70, v70
  v_exp_f32 v71, v71
  v_cvt_pk_bf16_f32 v12, v28, v29
  v_cvt_pk_bf16_f32 v13, v30, v31
  v_cvt_pk_bf16_f32 v14, v68, v69
  v_cvt_pk_bf16_f32 v15, v70, v71
  s_nop 1
  v_mfma_f32_16x16x32_bf16 v[36:39], v[160:163], v[0:3], 0
  v_mfma_f32_16x16x32_bf16 v[76:79], v[140:143], v[0:3], 0
  v_mfma_f32_16x16x32_bf16 v[96:99], v[150:153], v[0:3], 0
  v_mfma_f32_16x16x32_bf16 v[40:43], v[160:163], v[4:7], 0
  v_mfma_f32_16x16x32_bf16 v[80:83], v[142:145], v[4:7], 0
  v_mfma_f32_16x16x32_bf16 v[100:103], v[152:155], v[4:7], 0
  v_mfma_f32_16x16x32_bf16 v[44:47], v[160:163], v[8:11], 0
  v_mfma_f32_16x16x32_bf16 v[84:87], v[144:147], v[8:11], 0
  v_mfma_f32_16x16x32_bf16 v[104:107], v[154:157], v[8:11], 0
  v_mfma_f32_16x16x32_bf16 v[48:51], v[160:163], v[12:15], 0
  v_mfma_f32_16x16x32_bf16 v[88:91], v[146:149], v[12:15], 0
  v_mfma_f32_16x16x32_bf16 v[108:111], v[156:159], v[12:15], 0
  s_lshl_b32 s43, s74, 15
  s_lshl_b32 s44, s75, 10
  s_add_u32 s43, s43, s44
  s_add_u32 s43, s43, s42
  s_add_u32 s46, s43, 8388608
  s_add_u32 s47, s46, 32768
  s_add_u32 s48, s47, 32768
  s_add_u32 s49, s48, 32768
  v_rcp_f32 v36, v36
  v_rcp_f32 v40, v40
  v_rcp_f32 v44, v44
  v_rcp_f32 v48, v48
  v_pk_mul_f32 v[76:77], v[76:77], v[36:37] op_sel:[0,0] op_sel_hi:[1,0]
  v_pk_mul_f32 v[78:79], v[78:79], v[36:37] op_sel:[0,0] op_sel_hi:[1,0]
  v_pk_mul_f32 v[96:97], v[96:97], v[36:37] op_sel:[0,0] op_sel_hi:[1,0]
  v_pk_mul_f32 v[98:99], v[98:99], v[36:37] op_sel:[0,0] op_sel_hi:[1,0]
  v_cvt_pk_bf16_f32 v16, v76, v77
  v_cvt_pk_bf16_f32 v17, v78, v79
  v_cvt_pk_bf16_f32 v18, v96, v97
  v_cvt_pk_bf16_f32 v19, v98, v99
  buffer_store_dwordx4 v[16:19], v120, s[4:7], s46 offen sc1
  v_pk_mul_f32 v[80:81], v[80:81], v[40:41] op_sel:[0,0] op_sel_hi:[1,0]
  v_pk_mul_f32 v[82:83], v[82:83], v[40:41] op_sel:[0,0] op_sel_hi:[1,0]
  v_pk_mul_f32 v[100:101], v[100:101], v[40:41] op_sel:[0,0] op_sel_hi:[1,0]
  v_pk_mul_f32 v[102:103], v[102:103], v[40:41] op_sel:[0,0] op_sel_hi:[1,0]
  v_cvt_pk_bf16_f32 v20, v80, v81
  v_cvt_pk_bf16_f32 v21, v82, v83
  v_cvt_pk_bf16_f32 v22, v100, v101
  v_cvt_pk_bf16_f32 v23, v102, v103
  buffer_store_dwordx4 v[20:23], v120, s[4:7], s47 offen sc1
  v_pk_mul_f32 v[84:85], v[84:85], v[44:45] op_sel:[0,0] op_sel_hi:[1,0]
  v_pk_mul_f32 v[86:87], v[86:87], v[44:45] op_sel:[0,0] op_sel_hi:[1,0]
  v_pk_mul_f32 v[104:105], v[104:105], v[44:45] op_sel:[0,0] op_sel_hi:[1,0]
  v_pk_mul_f32 v[106:107], v[106:107], v[44:45] op_sel:[0,0] op_sel_hi:[1,0]
  v_cvt_pk_bf16_f32 v24, v84, v85
  v_cvt_pk_bf16_f32 v25, v86, v87
  v_cvt_pk_bf16_f32 v26, v104, v105
  v_cvt_pk_bf16_f32 v27, v106, v107
  buffer_store_dwordx4 v[24:27], v120, s[4:7], s48 offen sc1
  v_pk_mul_f32 v[88:89], v[88:89], v[48:49] op_sel:[0,0] op_sel_hi:[1,0]
  v_pk_mul_f32 v[90:91], v[90:91], v[48:49] op_sel:[0,0] op_sel_hi:[1,0]
  v_pk_mul_f32 v[108:109], v[108:109], v[48:49] op_sel:[0,0] op_sel_hi:[1,0]
  v_pk_mul_f32 v[110:111], v[110:111], v[48:49] op_sel:[0,0] op_sel_hi:[1,0]
  v_cvt_pk_bf16_f32 v28, v88, v89
  v_cvt_pk_bf16_f32 v29, v90, v91
  v_cvt_pk_bf16_f32 v30, v108, v109
  v_cvt_pk_bf16_f32 v31, v110, v111
  buffer_store_dwordx4 v[28:31], v120, s[4:7], s49 offen sc1
  s_lshl_b32 s77, s50, 1
  s_lshr_b32 s43, s51, 3
  s_add_u32 s77, s77, s43
  s_lshl_b32 s77, s77, 7
  s_add_u32 s77, s77, s42
  s_add_u32 s77, s77, 27787264
  s_lshl_b32 s58, s52, 3
  s_lshl_b32 s43, s40, 1
  s_add_u32 s58, s58, s43
  s_lshl_b32 s59, s58, 15
  s_lshl_b32 s43, s53, 11
  s_add_u32 s59, s59, s43
  s_add_u32 s59, s59, s42
  s_add_u32 s46, s59, 0
  s_add_u32 s47, s46, 32768
  v_lshlrev_b32 v48, 4, v253
  v_add_u32 v49, 32768, v48
  buffer_load_dwordx4 v[52:55], v48, s[4:7], s46 offen offset:0 sc1
  buffer_load_dwordx4 v[56:59], v48, s[4:7], s46 offen offset:1024 sc1
  buffer_load_dwordx4 v[60:63], v48, s[4:7], s47 offen offset:0 sc1
  buffer_load_dwordx4 v[64:67], v48, s[4:7], s47 offen offset:1024 sc1
  s_mul_i32 s57, s58, 32768
  s_add_u32 s57, s57, s42
  s_add_u32 s57, s57, 8388608
  s_and_b32 s60, s52, 3
  s_lshl_b32 s60, s60, 13
  v_lshrrev_b32 v2, 2, v253
  v_bfe_u32 v3, v253, 3, 2
  v_and_b32 v4, 3, v253
  v_lshlrev_b32 v4, 3, v4
  v_lshl_add_u32 v4, v2, 7, v4
  v_xor_b32 v5, 0, v3
  v_lshl_add_u32 v40, v5, 5, v4
  v_xor_b32 v5, 1, v3
  v_lshl_add_u32 v41, v5, 5, v4
  v_xor_b32 v5, 2, v3
  v_lshl_add_u32 v42, v5, 5, v4
  v_xor_b32 v5, 3, v3
  v_lshl_add_u32 v43, v5, 5, v4
  s_cmp_eq_u32 s3, 0
  s_cbranch_scc1 Lsd6
  v_accvgpr_read_b32 v236, a176
  v_accvgpr_read_b32 v237, a177
  v_accvgpr_read_b32 v238, a178
  v_accvgpr_read_b32 v239, a179
  v_lshlrev_b32 v224, 16, v236
  v_and_b32 v225, 0xffff0000, v236
  v_lshlrev_b32 v226, 16, v237
  v_and_b32 v227, 0xffff0000, v237
  v_lshlrev_b32 v228, 16, v238
  v_and_b32 v229, 0xffff0000, v238
  v_lshlrev_b32 v230, 16, v239
  v_and_b32 v231, 0xffff0000, v239
  v_accvgpr_read_b32 v236, a180
  v_accvgpr_read_b32 v237, a181
  v_accvgpr_read_b32 v238, a182
  v_accvgpr_read_b32 v239, a183
  v_lshlrev_b32 v232, 16, v236
  v_and_b32 v233, 0xffff0000, v236
  v_pk_add_f32 v[224:225], v[224:225], v[232:233]
  v_lshlrev_b32 v232, 16, v237
  v_and_b32 v233, 0xffff0000, v237
  v_pk_add_f32 v[226:227], v[226:227], v[232:233]
  v_lshlrev_b32 v232, 16, v238
  v_and_b32 v233, 0xffff0000, v238
  v_pk_add_f32 v[228:229], v[228:229], v[232:233]
  v_lshlrev_b32 v232, 16, v239
  v_and_b32 v233, 0xffff0000, v239
  v_pk_add_f32 v[230:231], v[230:231], v[232:233]
  v_accvgpr_read_b32 v236, a184
  v_accvgpr_read_b32 v237, a185
  v_accvgpr_read_b32 v238, a186
  v_accvgpr_read_b32 v239, a187
  v_lshlrev_b32 v232, 16, v236
  v_and_b32 v233, 0xffff0000, v236
  v_pk_add_f32 v[224:225], v[224:225], v[232:233]
  v_lshlrev_b32 v232, 16, v237
  v_and_b32 v233, 0xffff0000, v237
  v_pk_add_f32 v[226:227], v[226:227], v[232:233]
  v_lshlrev_b32 v232, 16, v238
  v_and_b32 v233, 0xffff0000, v238
  v_pk_add_f32 v[228:229], v[228:229], v[232:233]
  v_lshlrev_b32 v232, 16, v239
  v_and_b32 v233, 0xffff0000, v239
  v_pk_add_f32 v[230:231], v[230:231], v[232:233]
  v_accvgpr_read_b32 v236, a188
  v_accvgpr_read_b32 v237, a189
  v_accvgpr_read_b32 v238, a190
  v_accvgpr_read_b32 v239, a191
  v_lshlrev_b32 v232, 16, v236
  v_and_b32 v233, 0xffff0000, v236
  v_pk_add_f32 v[224:225], v[224:225], v[232:233]
  v_lshlrev_b32 v232, 16, v237
  v_and_b32 v233, 0xffff0000, v237
  v_pk_add_f32 v[226:227], v[226:227], v[232:233]
  v_lshlrev_b32 v232, 16, v238
  v_and_b32 v233, 0xffff0000, v238
  v_pk_add_f32 v[228:229], v[228:229], v[232:233]
  v_lshlrev_b32 v232, 16, v239
  v_and_b32 v233, 0xffff0000, v239
  v_pk_add_f32 v[230:231], v[230:231], v[232:233]
  v_accvgpr_read_b32 v236, a192
  v_accvgpr_read_b32 v237, a193
  v_accvgpr_read_b32 v238, a194
  v_accvgpr_read_b32 v239, a195
  v_lshlrev_b32 v232, 16, v236
  v_and_b32 v233, 0xffff0000, v236
  v_pk_add_f32 v[224:225], v[224:225], v[232:233]
  v_lshlrev_b32 v232, 16, v237
  v_and_b32 v233, 0xffff0000, v237
  v_pk_add_f32 v[226:227], v[226:227], v[232:233]
  v_lshlrev_b32 v232, 16, v238
  v_and_b32 v233, 0xffff0000, v238
  v_pk_add_f32 v[228:229], v[228:229], v[232:233]
  v_lshlrev_b32 v232, 16, v239
  v_and_b32 v233, 0xffff0000, v239
  v_pk_add_f32 v[230:231], v[230:231], v[232:233]
  v_accvgpr_read_b32 v236, a196
  v_accvgpr_read_b32 v237, a197
  v_accvgpr_read_b32 v238, a198
  v_accvgpr_read_b32 v239, a199
  v_lshlrev_b32 v232, 16, v236
  v_and_b32 v233, 0xffff0000, v236
  v_pk_add_f32 v[224:225], v[224:225], v[232:233]
  v_lshlrev_b32 v232, 16, v237
  v_and_b32 v233, 0xffff0000, v237
  v_pk_add_f32 v[226:227], v[226:227], v[232:233]
  v_lshlrev_b32 v232, 16, v238
  v_and_b32 v233, 0xffff0000, v238
  v_pk_add_f32 v[228:229], v[228:229], v[232:233]
  v_lshlrev_b32 v232, 16, v239
  v_and_b32 v233, 0xffff0000, v239
  v_pk_add_f32 v[230:231], v[230:231], v[232:233]
  v_accvgpr_read_b32 v236, a200
  v_accvgpr_read_b32 v237, a201
  v_accvgpr_read_b32 v238, a202
  v_accvgpr_read_b32 v239, a203
  v_lshlrev_b32 v232, 16, v236
  v_and_b32 v233, 0xffff0000, v236
  v_pk_add_f32 v[224:225], v[224:225], v[232:233]
  v_lshlrev_b32 v232, 16, v237
  v_and_b32 v233, 0xffff0000, v237
  v_pk_add_f32 v[226:227], v[226:227], v[232:233]
  v_lshlrev_b32 v232, 16, v238
  v_and_b32 v233, 0xffff0000, v238
  v_pk_add_f32 v[228:229], v[228:229], v[232:233]
  v_lshlrev_b32 v232, 16, v239
  v_and_b32 v233, 0xffff0000, v239
  v_pk_add_f32 v[230:231], v[230:231], v[232:233]
  v_accvgpr_read_b32 v236, a204
  v_accvgpr_read_b32 v237, a205
  v_accvgpr_read_b32 v238, a206
  v_accvgpr_read_b32 v239, a207
  v_lshlrev_b32 v232, 16, v236
  v_and_b32 v233, 0xffff0000, v236
  v_pk_add_f32 v[224:225], v[224:225], v[232:233]
  v_lshlrev_b32 v232, 16, v237
  v_and_b32 v233, 0xffff0000, v237
  v_pk_add_f32 v[226:227], v[226:227], v[232:233]
  v_lshlrev_b32 v232, 16, v238
  v_and_b32 v233, 0xffff0000, v238
  v_pk_add_f32 v[228:229], v[228:229], v[232:233]
  v_lshlrev_b32 v232, 16, v239
  v_and_b32 v233, 0xffff0000, v239
  v_pk_add_f32 v[230:231], v[230:231], v[232:233]
Lsd6:
  s_waitcnt vmcnt(4)
  s_barrier
  s_cmp_lg_u32 s40, 0
  s_cbranch_scc1 Lsig5
  v_mov_b32 v250, 1
  s_mov_b64 exec, 1
  buffer_atomic_add v250, v251, s[4:7], s77 offen sc1
  s_mov_b64 exec, -1
Lsig5:
  s_add_u32 m0, s89, 73728
  s_add_u32 s92, s91, s82
  s_and_b32 s92, s92, 0x1fffff
  buffer_load_dwordx4 v186, s[12:15], s92 offen lds
  s_add_u32 s91, s91, 65536
  s_add_u32 m0, s89, 77824
  s_add_u32 s92, s91, s83
  s_and_b32 s92, s92, 0x1fffff
  buffer_load_dwordx4 v186, s[12:15], s92 offen lds
  s_add_u32 s91, s91, 65536
  s_add_u32 m0, s89, 81920
  s_add_u32 s92, s91, s84
  s_and_b32 s92, s92, 0x1fffff
  buffer_load_dwordx4 v186, s[12:15], s92 offen lds
  s_add_u32 s91, s91, 65536
  s_add_u32 m0, s89, 86016
  s_add_u32 s92, s91, s85
  s_and_b32 s92, s92, 0x1fffff
  buffer_load_dwordx4 v186, s[12:15], s92 offen lds
  s_add_u32 s91, s91, 65536
  s_add_u32 m0, s89, 90112
  s_add_u32 s92, s91, s86
  s_and_b32 s92, s92, 0x1fffff
  buffer_load_dwordx4 v186, s[12:15], s92 offen lds
  s_add_u32 s91, s91, 65536
  s_add_u32 m0, s89, 94208
  s_add_u32 s92, s91, s87
  s_and_b32 s92, s92, 0x1fffff
  buffer_load_dwordx4 v186, s[12:15], s92 offen lds
  s_add_u32 s91, s91, 65536
  s_add_u32 m0, s89, 98304
  s_add_u32 s92, s91, s80
  s_and_b32 s92, s92, 0x1fffff
  buffer_load_dwordx4 v186, s[12:15], s92 offen lds
  s_add_u32 s91, s91, 65536
  s_add_u32 m0, s89, 102400
  s_add_u32 s92, s91, s81
  s_and_b32 s92, s92, 0x1fffff
  buffer_load_dwordx4 v186, s[12:15], s92 offen lds
  s_add_u32 s91, s91, 65536
  s_add_u32 m0, s89, 106496
  s_add_u32 s92, s91, s82
  s_and_b32 s92, s92, 0x1fffff
  buffer_load_dwordx4 v186, s[12:15], s92 offen lds
  s_add_u32 s91, s91, 65536
  s_add_u32 m0, s89, 110592
  s_add_u32 s92, s91, s83
  s_and_b32 s92, s92, 0x1fffff
  buffer_load_dwordx4 v186, s[12:15], s92 offen lds
  s_add_u32 s91, s91, 65536
  s_add_u32 m0, s89, 114688
  s_add_u32 s92, s91, s84
  s_and_b32 s92, s92, 0x1fffff
  buffer_load_dwordx4 v186, s[12:15], s92 offen lds
  s_add_u32 s91, s91, 65536
  s_add_u32 m0, s89, 118784
  s_add_u32 s92, s91, s85
  s_and_b32 s92, s92, 0x1fffff
  buffer_load_dwordx4 v186, s[12:15], s92 offen lds
  s_add_u32 s91, s91, 65536
  s_add_u32 m0, s89, 122880
  s_add_u32 s92, s91, s86
  s_and_b32 s92, s92, 0x1fffff
  buffer_load_dwordx4 v186, s[12:15], s92 offen lds
  s_add_u32 s91, s91, 65536
  s_add_u32 m0, s89, 126976
  s_add_u32 s92, s91, s87
  s_and_b32 s92, s92, 0x1fffff
  buffer_load_dwordx4 v186, s[12:15], s92 offen lds
  s_add_u32 s91, s91, 65536
  s_waitcnt vmcnt(14)
  v_lshlrev_b32 v0, 16, v52
  v_and_b32 v1, 0xffff0000, v52
  v_lshlrev_b32 v2, 16, v53
  v_and_b32 v3, 0xffff0000, v53
  v_lshlrev_b32 v8, 16, v54
  v_and_b32 v9, 0xffff0000, v54
  v_lshlrev_b32 v10, 16, v55
  v_and_b32 v11, 0xffff0000, v55
  v_lshlrev_b32 v16, 16, v56
  v_and_b32 v17, 0xffff0000, v56
  v_lshlrev_b32 v18, 16, v57
  v_and_b32 v19, 0xffff0000, v57
  v_lshlrev_b32 v24, 16, v58
  v_and_b32 v25, 0xffff0000, v58
  v_lshlrev_b32 v26, 16, v59
  v_and_b32 v27, 0xffff0000, v59
  v_lshlrev_b32 v4, 16, v60
  v_and_b32 v5, 0xffff0000, v60
  v_lshlrev_b32 v6, 16, v61
  v_and_b32 v7, 0xffff0000, v61
  v_lshlrev_b32 v12, 16, v62
  v_and_b32 v13, 0xffff0000, v62
  v_lshlrev_b32 v14, 16, v63
  v_and_b32 v15, 0xffff0000, v63
  v_lshlrev_b32 v20, 16, v64
  v_and_b32 v21, 0xffff0000, v64
  v_lshlrev_b32 v22, 16, v65
  v_and_b32 v23, 0xffff0000, v65
  v_lshlrev_b32 v28, 16, v66
  v_and_b32 v29, 0xffff0000, v66
  v_lshlrev_b32 v30, 16, v67
  v_and_b32 v31, 0xffff0000, v67
  s_cmp_eq_u32 s3, 0
  s_cbranch_scc1 Lsd7
  v_accvgpr_read_b32 v236, a208
  v_accvgpr_read_b32 v237, a209
  v_accvgpr_read_b32 v238, a210
  v_accvgpr_read_b32 v239, a211
  v_lshlrev_b32 v232, 16, v236
  v_and_b32 v233, 0xffff0000, v236
  v_pk_add_f32 v[224:225], v[224:225], v[232:233]
  v_lshlrev_b32 v232, 16, v237
  v_and_b32 v233, 0xffff0000, v237
  v_pk_add_f32 v[226:227], v[226:227], v[232:233]
  v_lshlrev_b32 v232, 16, v238
  v_and_b32 v233, 0xffff0000, v238
  v_pk_add_f32 v[228:229], v[228:229], v[232:233]
  v_lshlrev_b32 v232, 16, v239
  v_and_b32 v233, 0xffff0000, v239
  v_pk_add_f32 v[230:231], v[230:231], v[232:233]
  v_accvgpr_read_b32 v236, a212
  v_accvgpr_read_b32 v237, a213
  v_accvgpr_read_b32 v238, a214
  v_accvgpr_read_b32 v239, a215
  v_lshlrev_b32 v232, 16, v236
  v_and_b32 v233, 0xffff0000, v236
  v_pk_add_f32 v[224:225], v[224:225], v[232:233]
  v_lshlrev_b32 v232, 16, v237
  v_and_b32 v233, 0xffff0000, v237
  v_pk_add_f32 v[226:227], v[226:227], v[232:233]
  v_lshlrev_b32 v232, 16, v238
  v_and_b32 v233, 0xffff0000, v238
  v_pk_add_f32 v[228:229], v[228:229], v[232:233]
  v_lshlrev_b32 v232, 16, v239
  v_and_b32 v233, 0xffff0000, v239
  v_pk_add_f32 v[230:231], v[230:231], v[232:233]
  v_accvgpr_read_b32 v236, a216
  v_accvgpr_read_b32 v237, a217
  v_accvgpr_read_b32 v238, a218
  v_accvgpr_read_b32 v239, a219
  v_lshlrev_b32 v232, 16, v236
  v_and_b32 v233, 0xffff0000, v236
  v_pk_add_f32 v[224:225], v[224:225], v[232:233]
  v_lshlrev_b32 v232, 16, v237
  v_and_b32 v233, 0xffff0000, v237
  v_pk_add_f32 v[226:227], v[226:227], v[232:233]
  v_lshlrev_b32 v232, 16, v238
  v_and_b32 v233, 0xffff0000, v238
  v_pk_add_f32 v[228:229], v[228:229], v[232:233]
  v_lshlrev_b32 v232, 16, v239
  v_and_b32 v233, 0xffff0000, v239
  v_pk_add_f32 v[230:231], v[230:231], v[232:233]
  v_accvgpr_read_b32 v236, a220
  v_accvgpr_read_b32 v237, a221
  v_accvgpr_read_b32 v238, a222
  v_accvgpr_read_b32 v239, a223
  v_lshlrev_b32 v232, 16, v236
  v_and_b32 v233, 0xffff0000, v236
  v_pk_add_f32 v[224:225], v[224:225], v[232:233]
  v_lshlrev_b32 v232, 16, v237
  v_and_b32 v233, 0xffff0000, v237
  v_pk_add_f32 v[226:227], v[226:227], v[232:233]
  v_lshlrev_b32 v232, 16, v238
  v_and_b32 v233, 0xffff0000, v238
  v_pk_add_f32 v[228:229], v[228:229], v[232:233]
  v_lshlrev_b32 v232, 16, v239
  v_and_b32 v233, 0xffff0000, v239
  v_pk_add_f32 v[230:231], v[230:231], v[232:233]
  v_accvgpr_read_b32 v236, a224
  v_accvgpr_read_b32 v237, a225
  v_accvgpr_read_b32 v238, a226
  v_accvgpr_read_b32 v239, a227
  v_lshlrev_b32 v232, 16, v236
  v_and_b32 v233, 0xffff0000, v236
  v_pk_add_f32 v[224:225], v[224:225], v[232:233]
  v_lshlrev_b32 v232, 16, v237
  v_and_b32 v233, 0xffff0000, v237
  v_pk_add_f32 v[226:227], v[226:227], v[232:233]
  v_lshlrev_b32 v232, 16, v238
  v_and_b32 v233, 0xffff0000, v238
  v_pk_add_f32 v[228:229], v[228:229], v[232:233]
  v_lshlrev_b32 v232, 16, v239
  v_and_b32 v233, 0xffff0000, v239
  v_pk_add_f32 v[230:231], v[230:231], v[232:233]
  v_accvgpr_read_b32 v236, a228
  v_accvgpr_read_b32 v237, a229
  v_accvgpr_read_b32 v238, a230
  v_accvgpr_read_b32 v239, a231
  v_lshlrev_b32 v232, 16, v236
  v_and_b32 v233, 0xffff0000, v236
  v_pk_add_f32 v[224:225], v[224:225], v[232:233]
  v_lshlrev_b32 v232, 16, v237
  v_and_b32 v233, 0xffff0000, v237
  v_pk_add_f32 v[226:227], v[226:227], v[232:233]
  v_lshlrev_b32 v232, 16, v238
  v_and_b32 v233, 0xffff0000, v238
  v_pk_add_f32 v[228:229], v[228:229], v[232:233]
  v_lshlrev_b32 v232, 16, v239
  v_and_b32 v233, 0xffff0000, v239
  v_pk_add_f32 v[230:231], v[230:231], v[232:233]
  v_accvgpr_read_b32 v236, a232
  v_accvgpr_read_b32 v237, a233
  v_accvgpr_read_b32 v238, a234
  v_accvgpr_read_b32 v239, a235
  v_lshlrev_b32 v232, 16, v236
  v_and_b32 v233, 0xffff0000, v236
  v_pk_add_f32 v[224:225], v[224:225], v[232:233]
  v_lshlrev_b32 v232, 16, v237
  v_and_b32 v233, 0xffff0000, v237
  v_pk_add_f32 v[226:227], v[226:227], v[232:233]
  v_lshlrev_b32 v232, 16, v238
  v_and_b32 v233, 0xffff0000, v238
  v_pk_add_f32 v[228:229], v[228:229], v[232:233]
  v_lshlrev_b32 v232, 16, v239
  v_and_b32 v233, 0xffff0000, v239
  v_pk_add_f32 v[230:231], v[230:231], v[232:233]
  v_accvgpr_read_b32 v236, a236
  v_accvgpr_read_b32 v237, a237
  v_accvgpr_read_b32 v238, a238
  v_accvgpr_read_b32 v239, a239
  v_lshlrev_b32 v232, 16, v236
  v_and_b32 v233, 0xffff0000, v236
  v_pk_add_f32 v[224:225], v[224:225], v[232:233]
  v_lshlrev_b32 v232, 16, v237
  v_and_b32 v233, 0xffff0000, v237
  v_pk_add_f32 v[226:227], v[226:227], v[232:233]
  v_lshlrev_b32 v232, 16, v238
  v_and_b32 v233, 0xffff0000, v238
  v_pk_add_f32 v[228:229], v[228:229], v[232:233]
  v_lshlrev_b32 v232, 16, v239
  v_and_b32 v233, 0xffff0000, v239
  v_pk_add_f32 v[230:231], v[230:231], v[232:233]
  v_mov_b32 v232, v224
  v_mov_b32 v233, v225
  v_mov_b32 v234, v226
  v_mov_b32 v235, v227
  v_mov_b32 v236, v228
  v_mov_b32 v237, v229
  v_mov_b32 v238, v230
  v_mov_b32 v239, v231
  v_permlane32_swap_b32 v224, v232
  v_permlane32_swap_b32 v225, v233
  v_permlane32_swap_b32 v226, v234
  v_permlane32_swap_b32 v227, v235
  v_permlane32_swap_b32 v228, v236
  v_permlane32_swap_b32 v229, v237
  v_permlane32_swap_b32 v230, v238
  v_permlane32_swap_b32 v231, v239
  v_add_f32 v224, v224, v232
  v_add_f32 v225, v225, v233
  v_add_f32 v226, v226, v234
  v_add_f32 v227, v227, v235
  v_add_f32 v228, v228, v236
  v_add_f32 v229, v229, v237
  v_add_f32 v230, v230, v238
  v_add_f32 v231, v231, v239
  v_mov_b32 v232, v224
  v_mov_b32 v233, v225
  v_mov_b32 v234, v226
  v_mov_b32 v235, v227
  v_mov_b32 v236, v228
  v_mov_b32 v237, v229
  v_mov_b32 v238, v230
  v_mov_b32 v239, v231
  v_permlane16_swap_b32 v224, v232
  v_permlane16_swap_b32 v225, v233
  v_permlane16_swap_b32 v226, v234
  v_permlane16_swap_b32 v227, v235
  v_permlane16_swap_b32 v228, v236
  v_permlane16_swap_b32 v229, v237
  v_permlane16_swap_b32 v230, v238
  v_permlane16_swap_b32 v231, v239
  v_add_f32 v224, v224, v232
  v_add_f32 v225, v225, v233
  v_add_f32 v226, v226, v234
  v_add_f32 v227, v227, v235
  v_add_f32 v228, v228, v236
  v_add_f32 v229, v229, v237
  v_add_f32 v230, v230, v238
  v_add_f32 v231, v231, v239
  v_and_b32 v232, 7, v253
  s_lshl_b32 s43, s40, 8
  s_add_u32 s43, s43, 143360
  v_add_f32_dpp v224, v224, v224 row_ror:8 row_mask:0xf bank_mask:0xf
  v_add_f32_dpp v225, v225, v225 row_ror:8 row_mask:0xf bank_mask:0xf
  v_add_f32_dpp v226, v226, v226 row_ror:8 row_mask:0xf bank_mask:0xf
  v_add_f32_dpp v227, v227, v227 row_ror:8 row_mask:0xf bank_mask:0xf
  v_add_f32_dpp v228, v228, v228 row_ror:8 row_mask:0xf bank_mask:0xf
  v_add_f32_dpp v229, v229, v229 row_ror:8 row_mask:0xf bank_mask:0xf
  v_add_f32_dpp v230, v230, v230 row_ror:8 row_mask:0xf bank_mask:0xf
  v_add_f32_dpp v231, v231, v231 row_ror:8 row_mask:0xf bank_mask:0xf
  v_lshl_add_u32 v232, v232, 5, s43
  ds_write_b128 v232, v[224:227]
  ds_write_b128 v232, v[228:231] offset:16
Lsd7:
  s_lshl_b32 s77, s52, 8
  s_add_u32 s77, s77, 27787264
  v_lshlrev_b32 v249, 7, v253
  s_add_u32 s77, s77, s42
  s_cmp_lg_u32 s40, 0
  s_cbranch_scc1 Lpdn9
  s_mov_b32 s43, 0x40000
  s_mov_b64 exec, 3
Lpol8:
  buffer_load_dword v250, v249, s[4:7], s77 offen sc1
  s_waitcnt vmcnt(0)
  v_cmp_gt_u32 vcc, 8, v250
  s_cbranch_vccz Lpdn9
  s_sub_u32 s43, s43, 1
  s_cmp_lg_u32 s43, 0
  s_cbranch_scc1 Lpol8
Lpdn9:
  s_mov_b64 exec, -1
  s_waitcnt vmcnt(0) lgkmcnt(0)
  s_barrier
  s_cmp_eq_u32 s40, 1
  s_cselect_b32 s3, s3, 0
  s_cmp_eq_u32 s3, 0
  s_cbranch_scc1 Lsd10
  v_lshlrev_b32 v232, 2, v253
  v_add_u32 v233, 143360, v232
  ds_read_b32 v234, v233 offset:0
  ds_read_b32 v235, v233 offset:256
  ds_read_b32 v236, v233 offset:512
  ds_read_b32 v237, v233 offset:768
  s_waitcnt lgkmcnt(0)
  v_add_f32 v234, v234, v235
  v_add_f32 v236, v236, v237
  v_add_f32 v234, v234, v236
  buffer_store_dword v234, v232, s[4:7], s101 offen sc1
Lsd10:
  s_lshr_b32 s93, s80, 6
  s_add_u32 s93, s93, s60
  s_and_b32 s93, s93, 0x7fff
  s_add_u32 s93, s93, s57
  buffer_load_dwordx4 a[0:3], v48, s[4:7], s93 offen sc1
  buffer_load_dwordx4 a[4:7], v49, s[4:7], s93 offen sc1
  s_add_u32 s60, s60, 1024
  s_lshr_b32 s93, s81, 6
  s_add_u32 s93, s93, s60
  s_and_b32 s93, s93, 0x7fff
  s_add_u32 s93, s93, s57
  buffer_load_dwordx4 a[8:11], v48, s[4:7], s93 offen sc1
  buffer_load_dwordx4 a[12:15], v49, s[4:7], s93 offen sc1
  s_add_u32 s60, s60, 1024
  s_lshr_b32 s93, s82, 6
  s_add_u32 s93, s93, s60
  s_and_b32 s93, s93, 0x7fff
  s_add_u32 s93, s93, s57
  buffer_load_dwordx4 a[16:19], v48, s[4:7], s93 offen sc1
  buffer_load_dwordx4 a[20:23], v49, s[4:7], s93 offen sc1
  s_add_u32 s60, s60, 1024
  s_lshr_b32 s93, s83, 6
  s_add_u32 s93, s93, s60
  s_and_b32 s93, s93, 0x7fff
  s_add_u32 s93, s93, s57
  buffer_load_dwordx4 a[24:27], v48, s[4:7], s93 offen sc1
  buffer_load_dwordx4 a[28:31], v49, s[4:7], s93 offen sc1
  s_add_u32 s60, s60, 1024
  s_lshr_b32 s93, s84, 6
  s_add_u32 s93, s93, s60
  s_and_b32 s93, s93, 0x7fff
  s_add_u32 s93, s93, s57
  buffer_load_dwordx4 a[32:35], v48, s[4:7], s93 offen sc1
  buffer_load_dwordx4 a[36:39], v49, s[4:7], s93 offen sc1
  s_add_u32 s60, s60, 1024
  s_lshr_b32 s93, s85, 6
  s_add_u32 s93, s93, s60
  s_and_b32 s93, s93, 0x7fff
  s_add_u32 s93, s93, s57
  buffer_load_dwordx4 a[40:43], v48, s[4:7], s93 offen sc1
  buffer_load_dwordx4 a[44:47], v49, s[4:7], s93 offen sc1
  s_add_u32 s60, s60, 1024
  ds_read_b64_tr_b16 a[112:113], v40 offset:0
  ds_read_b64_tr_b16 a[114:115], v40 offset:2048
  ds_read_b64_tr_b16 a[128:129], v40 offset:4096
  ds_read_b64_tr_b16 a[130:131], v40 offset:6144
  ds_read_b64_tr_b16 a[116:117], v41 offset:0
  ds_read_b64_tr_b16 a[118:119], v41 offset:2048
  ds_read_b64_tr_b16 a[132:133], v41 offset:4096
  ds_read_b64_tr_b16 a[134:135], v41 offset:6144
  ds_read_b64_tr_b16 a[120:121], v42 offset:0
  ds_read_b64_tr_b16 a[122:123], v42 offset:2048
  ds_read_b64_tr_b16 a[136:137], v42 offset:4096
  ds_read_b64_tr_b16 a[138:139], v42 offset:6144
  ds_read_b64_tr_b16 a[124:125], v43 offset:0
  ds_read_b64_tr_b16 a[126:127], v43 offset:2048
  ds_read_b64_tr_b16 a[140:141], v43 offset:4096
  ds_read_b64_tr_b16 a[142:143], v43 offset:6144
  s_mov_b32 s56, 3
.p2align 3
Lp2_loop:
  s_waitcnt vmcnt(8) lgkmcnt(12)
  v_mfma_f32_16x16x32_bf16 v[0:3], a[112:115], a[0:3], v[0:3]
  ds_read_b64_tr_b16 a[144:145], v40 offset:8192
  v_mfma_f32_16x16x32_bf16 v[0:3], a[128:131], a[8:11], v[0:3]
  s_lshr_b32 s93, s86, 6
  ds_read_b64_tr_b16 a[146:147], v40 offset:10240
  s_add_u32 s93, s93, s60
  s_and_b32 s93, s93, 0x7fff
  s_add_u32 s93, s93, s57
  buffer_load_dwordx4 a[48:51], v48, s[4:7], s93 offen sc1
  v_mfma_f32_16x16x32_bf16 v[4:7], a[128:131], a[12:15], v[4:7]
  ds_read_b64_tr_b16 a[160:161], v40 offset:12288
  v_mfma_f32_16x16x32_bf16 v[4:7], a[112:115], a[4:7], v[4:7]
  ds_read_b64_tr_b16 a[162:163], v40 offset:14336
  s_waitcnt lgkmcnt(12)
  v_mfma_f32_16x16x32_bf16 v[12:15], a[116:119], a[4:7], v[12:15]
  s_add_u32 s60, s60, 1024
  ds_read_b64_tr_b16 a[148:149], v41 offset:8192
  buffer_load_dwordx4 a[52:55], v49, s[4:7], s93 offen sc1
  v_mfma_f32_16x16x32_bf16 v[12:15], a[132:135], a[12:15], v[12:15]
  ds_read_b64_tr_b16 a[150:151], v41 offset:10240
  v_mfma_f32_16x16x32_bf16 v[8:11], a[132:135], a[8:11], v[8:11]
  ds_read_b64_tr_b16 a[164:165], v41 offset:12288
  v_mfma_f32_16x16x32_bf16 v[8:11], a[116:119], a[0:3], v[8:11]
  ds_read_b64_tr_b16 a[166:167], v41 offset:14336
  s_waitcnt lgkmcnt(12)
  v_mfma_f32_16x16x32_bf16 v[16:19], a[120:123], a[0:3], v[16:19]
  s_lshr_b32 s93, s87, 6
  ds_read_b64_tr_b16 a[152:153], v42 offset:8192
  s_add_u32 s93, s93, s60
  s_and_b32 s93, s93, 0x7fff
  s_add_u32 s93, s93, s57
  buffer_load_dwordx4 a[56:59], v48, s[4:7], s93 offen sc1
  v_mfma_f32_16x16x32_bf16 v[16:19], a[136:139], a[8:11], v[16:19]
  ds_read_b64_tr_b16 a[154:155], v42 offset:10240
  v_mfma_f32_16x16x32_bf16 v[20:23], a[136:139], a[12:15], v[20:23]
  ds_read_b64_tr_b16 a[168:169], v42 offset:12288
  v_mfma_f32_16x16x32_bf16 v[20:23], a[120:123], a[4:7], v[20:23]
  s_add_u32 s60, s60, 1024
  ds_read_b64_tr_b16 a[170:171], v42 offset:14336
  buffer_load_dwordx4 a[60:63], v49, s[4:7], s93 offen sc1
  s_waitcnt lgkmcnt(12)
  v_mfma_f32_16x16x32_bf16 v[28:31], a[124:127], a[4:7], v[28:31]
  ds_read_b64_tr_b16 a[156:157], v43 offset:8192
  v_mfma_f32_16x16x32_bf16 v[28:31], a[140:143], a[12:15], v[28:31]
  ds_read_b64_tr_b16 a[158:159], v43 offset:10240
  v_mfma_f32_16x16x32_bf16 v[24:27], a[140:143], a[8:11], v[24:27]
  ds_read_b64_tr_b16 a[172:173], v43 offset:12288
  v_mfma_f32_16x16x32_bf16 v[24:27], a[124:127], a[0:3], v[24:27]
  ds_read_b64_tr_b16 a[174:175], v43 offset:14336
  s_waitcnt vmcnt(8) lgkmcnt(12)
  v_mfma_f32_16x16x32_bf16 v[0:3], a[144:147], a[16:19], v[0:3]
  ds_read_b64_tr_b16 a[112:113], v40 offset:16384
  v_mfma_f32_16x16x32_bf16 v[0:3], a[160:163], a[24:27], v[0:3]
  s_lshr_b32 s93, s80, 6
  ds_read_b64_tr_b16 a[114:115], v40 offset:18432
  s_add_u32 s93, s93, s60
  s_and_b32 s93, s93, 0x7fff
  s_add_u32 s93, s93, s57
  buffer_load_dwordx4 a[0:3], v48, s[4:7], s93 offen sc1
  v_mfma_f32_16x16x32_bf16 v[4:7], a[160:163], a[28:31], v[4:7]
  ds_read_b64_tr_b16 a[128:129], v40 offset:20480
  v_mfma_f32_16x16x32_bf16 v[4:7], a[144:147], a[20:23], v[4:7]
  ds_read_b64_tr_b16 a[130:131], v40 offset:22528
  s_waitcnt lgkmcnt(12)
  v_mfma_f32_16x16x32_bf16 v[12:15], a[148:151], a[20:23], v[12:15]
  s_add_u32 s60, s60, 1024
  ds_read_b64_tr_b16 a[116:117], v41 offset:16384
  buffer_load_dwordx4 a[4:7], v49, s[4:7], s93 offen sc1
  v_mfma_f32_16x16x32_bf16 v[12:15], a[164:167], a[28:31], v[12:15]
  ds_read_b64_tr_b16 a[118:119], v41 offset:18432
  v_mfma_f32_16x16x32_bf16 v[8:11], a[164:167], a[24:27], v[8:11]
  ds_read_b64_tr_b16 a[132:133], v41 offset:20480
  v_mfma_f32_16x16x32_bf16 v[8:11], a[148:151], a[16:19], v[8:11]
  ds_read_b64_tr_b16 a[134:135], v41 offset:22528
  s_waitcnt lgkmcnt(12)
  v_mfma_f32_16x16x32_bf16 v[16:19], a[152:155], a[16:19], v[16:19]
  s_lshr_b32 s93, s81, 6
  ds_read_b64_tr_b16 a[120:121], v42 offset:16384
  s_add_u32 s93, s93, s60
  s_and_b32 s93, s93, 0x7fff
  s_add_u32 s93, s93, s57
  buffer_load_dwordx4 a[8:11], v48, s[4:7], s93 offen sc1
  v_mfma_f32_16x16x32_bf16 v[16:19], a[168:171], a[24:27], v[16:19]
  ds_read_b64_tr_b16 a[122:123], v42 offset:18432
  v_mfma_f32_16x16x32_bf16 v[20:23], a[168:171], a[28:31], v[20:23]
  ds_read_b64_tr_b16 a[136:137], v42 offset:20480
  v_mfma_f32_16x16x32_bf16 v[20:23], a[152:155], a[20:23], v[20:23]
  s_add_u32 s60, s60, 1024
  ds_read_b64_tr_b16 a[138:139], v42 offset:22528
  buffer_load_dwordx4 a[12:15], v49, s[4:7], s93 offen sc1
  s_waitcnt lgkmcnt(12)
  v_mfma_f32_16x16x32_bf16 v[28:31], a[156:159], a[20:23], v[28:31]
  ds_read_b64_tr_b16 a[124:125], v43 offset:16384
  v_mfma_f32_16x16x32_bf16 v[28:31], a[172:175], a[28:31], v[28:31]
  ds_read_b64_tr_b16 a[126:127], v43 offset:18432
  v_mfma_f32_16x16x32_bf16 v[24:27], a[172:175], a[24:27], v[24:27]
  ds_read_b64_tr_b16 a[140:141], v43 offset:20480
  v_mfma_f32_16x16x32_bf16 v[24:27], a[156:159], a[16:19], v[24:27]
  ds_read_b64_tr_b16 a[142:143], v43 offset:22528
  s_waitcnt vmcnt(8) lgkmcnt(12)
  v_mfma_f32_16x16x32_bf16 v[0:3], a[112:115], a[32:35], v[0:3]
  ds_read_b64_tr_b16 a[144:145], v40 offset:24576
  v_mfma_f32_16x16x32_bf16 v[0:3], a[128:131], a[40:43], v[0:3]
  s_lshr_b32 s93, s82, 6
  ds_read_b64_tr_b16 a[146:147], v40 offset:26624
  s_add_u32 s93, s93, s60
  s_and_b32 s93, s93, 0x7fff
  s_add_u32 s93, s93, s57
  buffer_load_dwordx4 a[16:19], v48, s[4:7], s93 offen sc1
  v_mfma_f32_16x16x32_bf16 v[4:7], a[128:131], a[44:47], v[4:7]
  ds_read_b64_tr_b16 a[160:161], v40 offset:28672
  v_mfma_f32_16x16x32_bf16 v[4:7], a[112:115], a[36:39], v[4:7]
  s_waitcnt lgkmcnt(11)
  ds_read_b64_tr_b16 a[162:163], v40 offset:30720
  v_add_u32 v40, 32768, v40
  v_mfma_f32_16x16x32_bf16 v[12:15], a[116:119], a[36:39], v[12:15]
  s_add_u32 s60, s60, 1024
  ds_read_b64_tr_b16 a[148:149], v41 offset:24576
  buffer_load_dwordx4 a[20:23], v49, s[4:7], s93 offen sc1
  v_mfma_f32_16x16x32_bf16 v[12:15], a[132:135], a[44:47], v[12:15]
  ds_read_b64_tr_b16 a[150:151], v41 offset:26624
  v_mfma_f32_16x16x32_bf16 v[8:11], a[132:135], a[40:43], v[8:11]
  ds_read_b64_tr_b16 a[164:165], v41 offset:28672
  v_mfma_f32_16x16x32_bf16 v[8:11], a[116:119], a[32:35], v[8:11]
  s_waitcnt lgkmcnt(11)
  ds_read_b64_tr_b16 a[166:167], v41 offset:30720
  v_add_u32 v41, 32768, v41
  v_mfma_f32_16x16x32_bf16 v[16:19], a[120:123], a[32:35], v[16:19]
  s_lshr_b32 s93, s83, 6
  ds_read_b64_tr_b16 a[152:153], v42 offset:24576
  s_add_u32 s93, s93, s60
  s_and_b32 s93, s93, 0x7fff
  s_add_u32 s93, s93, s57
  buffer_load_dwordx4 a[24:27], v48, s[4:7], s93 offen sc1
  v_mfma_f32_16x16x32_bf16 v[16:19], a[136:139], a[40:43], v[16:19]
  ds_read_b64_tr_b16 a[154:155], v42 offset:26624
  v_mfma_f32_16x16x32_bf16 v[20:23], a[136:139], a[44:47], v[20:23]
  ds_read_b64_tr_b16 a[168:169], v42 offset:28672
  v_mfma_f32_16x16x32_bf16 v[20:23], a[120:123], a[36:39], v[20:23]
  s_add_u32 s60, s60, 1024
  ds_read_b64_tr_b16 a[170:171], v42 offset:30720
  buffer_load_dwordx4 a[28:31], v49, s[4:7], s93 offen sc1
  v_add_u32 v42, 32768, v42
  s_waitcnt lgkmcnt(12)
  v_mfma_f32_16x16x32_bf16 v[28:31], a[124:127], a[36:39], v[28:31]
  ds_read_b64_tr_b16 a[156:157], v43 offset:24576
  v_mfma_f32_16x16x32_bf16 v[28:31], a[140:143], a[44:47], v[28:31]
  ds_read_b64_tr_b16 a[158:159], v43 offset:26624
  v_mfma_f32_16x16x32_bf16 v[24:27], a[140:143], a[40:43], v[24:27]
  ds_read_b64_tr_b16 a[172:173], v43 offset:28672
  v_mfma_f32_16x16x32_bf16 v[24:27], a[124:127], a[32:35], v[24:27]
  s_waitcnt vmcnt(8) lgkmcnt(11)
  ds_read_b64_tr_b16 a[174:175], v43 offset:30720
  v_add_u32 v43, 32768, v43
  v_mfma_f32_16x16x32_bf16 v[0:3], a[144:147], a[48:51], v[0:3]
  ds_read_b64_tr_b16 a[112:113], v40 offset:0
  v_mfma_f32_16x16x32_bf16 v[0:3], a[160:163], a[56:59], v[0:3]
  s_lshr_b32 s93, s84, 6
  ds_read_b64_tr_b16 a[114:115], v40 offset:2048
  s_add_u32 s93, s93, s60
  s_and_b32 s93, s93, 0x7fff
  s_add_u32 s93, s93, s57
  buffer_load_dwordx4 a[32:35], v48, s[4:7], s93 offen sc1
  v_mfma_f32_16x16x32_bf16 v[4:7], a[160:163], a[60:63], v[4:7]
  ds_read_b64_tr_b16 a[128:129], v40 offset:4096
  v_mfma_f32_16x16x32_bf16 v[4:7], a[144:147], a[52:55], v[4:7]
  ds_read_b64_tr_b16 a[130:131], v40 offset:6144
  s_waitcnt lgkmcnt(12)
  v_mfma_f32_16x16x32_bf16 v[12:15], a[148:151], a[52:55], v[12:15]
  s_add_u32 s60, s60, 1024
  ds_read_b64_tr_b16 a[116:117], v41 offset:0
  buffer_load_dwordx4 a[36:39], v49, s[4:7], s93 offen sc1
  v_mfma_f32_16x16x32_bf16 v[12:15], a[164:167], a[60:63], v[12:15]
  ds_read_b64_tr_b16 a[118:119], v41 offset:2048
  v_mfma_f32_16x16x32_bf16 v[8:11], a[164:167], a[56:59], v[8:11]
  ds_read_b64_tr_b16 a[132:133], v41 offset:4096
  v_mfma_f32_16x16x32_bf16 v[8:11], a[148:151], a[48:51], v[8:11]
  ds_read_b64_tr_b16 a[134:135], v41 offset:6144
  s_waitcnt lgkmcnt(12)
  v_mfma_f32_16x16x32_bf16 v[16:19], a[152:155], a[48:51], v[16:19]
  s_lshr_b32 s93, s85, 6
  ds_read_b64_tr_b16 a[120:121], v42 offset:0
  s_add_u32 s93, s93, s60
  s_and_b32 s93, s93, 0x7fff
  s_add_u32 s93, s93, s57
  buffer_load_dwordx4 a[40:43], v48, s[4:7], s93 offen sc1
  v_mfma_f32_16x16x32_bf16 v[16:19], a[168:171], a[56:59], v[16:19]
  ds_read_b64_tr_b16 a[122:123], v42 offset:2048
  v_mfma_f32_16x16x32_bf16 v[20:23], a[168:171], a[60:63], v[20:23]
  ds_read_b64_tr_b16 a[136:137], v42 offset:4096
  v_mfma_f32_16x16x32_bf16 v[20:23], a[152:155], a[52:55], v[20:23]
  s_add_u32 s60, s60, 1024
  ds_read_b64_tr_b16 a[138:139], v42 offset:6144
  buffer_load_dwordx4 a[44:47], v49, s[4:7], s93 offen sc1
  s_waitcnt lgkmcnt(12)
  v_mfma_f32_16x16x32_bf16 v[28:31], a[156:159], a[52:55], v[28:31]
  ds_read_b64_tr_b16 a[124:125], v43 offset:0
  v_mfma_f32_16x16x32_bf16 v[28:31], a[172:175], a[60:63], v[28:31]
  ds_read_b64_tr_b16 a[126:127], v43 offset:2048
  v_mfma_f32_16x16x32_bf16 v[24:27], a[172:175], a[56:59], v[24:27]
  ds_read_b64_tr_b16 a[140:141], v43 offset:4096
  v_mfma_f32_16x16x32_bf16 v[24:27], a[156:159], a[48:51], v[24:27]
  s_sub_u32 s56, s56, 1
  ds_read_b64_tr_b16 a[142:143], v43 offset:6144
  s_cmp_lg_u32 s56, 0
  s_cbranch_scc1 Lp2_loop
Lmk_Lp2_loop_tail:
  s_waitcnt vmcnt(8) lgkmcnt(12)
  v_mfma_f32_16x16x32_bf16 v[0:3], a[112:115], a[0:3], v[0:3]
  ds_read_b64_tr_b16 a[144:145], v40 offset:8192
  v_mfma_f32_16x16x32_bf16 v[0:3], a[128:131], a[8:11], v[0:3]
  s_lshr_b32 s93, s86, 6
  ds_read_b64_tr_b16 a[146:147], v40 offset:10240
  s_add_u32 s93, s93, s60
  s_and_b32 s93, s93, 0x7fff
  s_add_u32 s93, s93, s57
  buffer_load_dwordx4 a[48:51], v48, s[4:7], s93 offen sc1
  v_mfma_f32_16x16x32_bf16 v[4:7], a[128:131], a[12:15], v[4:7]
  ds_read_b64_tr_b16 a[160:161], v40 offset:12288
  v_mfma_f32_16x16x32_bf16 v[4:7], a[112:115], a[4:7], v[4:7]
  ds_read_b64_tr_b16 a[162:163], v40 offset:14336
  s_waitcnt lgkmcnt(12)
  v_mfma_f32_16x16x32_bf16 v[12:15], a[116:119], a[4:7], v[12:15]
  s_add_u32 s60, s60, 1024
  ds_read_b64_tr_b16 a[148:149], v41 offset:8192
  buffer_load_dwordx4 a[52:55], v49, s[4:7], s93 offen sc1
  v_mfma_f32_16x16x32_bf16 v[12:15], a[132:135], a[12:15], v[12:15]
  ds_read_b64_tr_b16 a[150:151], v41 offset:10240
  v_mfma_f32_16x16x32_bf16 v[8:11], a[132:135], a[8:11], v[8:11]
  ds_read_b64_tr_b16 a[164:165], v41 offset:12288
  v_mfma_f32_16x16x32_bf16 v[8:11], a[116:119], a[0:3], v[8:11]
  ds_read_b64_tr_b16 a[166:167], v41 offset:14336
  s_waitcnt lgkmcnt(12)
  v_mfma_f32_16x16x32_bf16 v[16:19], a[120:123], a[0:3], v[16:19]
  s_lshr_b32 s93, s87, 6
  ds_read_b64_tr_b16 a[152:153], v42 offset:8192
  s_add_u32 s93, s93, s60
  s_and_b32 s93, s93, 0x7fff
  s_add_u32 s93, s93, s57
  buffer_load_dwordx4 a[56:59], v48, s[4:7], s93 offen sc1
  v_mfma_f32_16x16x32_bf16 v[16:19], a[136:139], a[8:11], v[16:19]
  ds_read_b64_tr_b16 a[154:155], v42 offset:10240
  v_mfma_f32_16x16x32_bf16 v[20:23], a[136:139], a[12:15], v[20:23]
  ds_read_b64_tr_b16 a[168:169], v42 offset:12288
  v_mfma_f32_16x16x32_bf16 v[20:23], a[120:123], a[4:7], v[20:23]
  s_add_u32 s60, s60, 1024
  ds_read_b64_tr_b16 a[170:171], v42 offset:14336
  buffer_load_dwordx4 a[60:63], v49, s[4:7], s93 offen sc1
  s_waitcnt lgkmcnt(12)
  v_mfma_f32_16x16x32_bf16 v[28:31], a[124:127], a[4:7], v[28:31]
  ds_read_b64_tr_b16 a[156:157], v43 offset:8192
  v_mfma_f32_16x16x32_bf16 v[28:31], a[140:143], a[12:15], v[28:31]
  ds_read_b64_tr_b16 a[158:159], v43 offset:10240
  v_mfma_f32_16x16x32_bf16 v[24:27], a[140:143], a[8:11], v[24:27]
  ds_read_b64_tr_b16 a[172:173], v43 offset:12288
  v_mfma_f32_16x16x32_bf16 v[24:27], a[124:127], a[0:3], v[24:27]
  ds_read_b64_tr_b16 a[174:175], v43 offset:14336
  s_waitcnt vmcnt(8) lgkmcnt(12)
  v_mfma_f32_16x16x32_bf16 v[0:3], a[144:147], a[16:19], v[0:3]
  s_barrier
  ds_read_b64_tr_b16 a[112:113], v40 offset:16384
  v_mfma_f32_16x16x32_bf16 v[0:3], a[160:163], a[24:27], v[0:3]
  ds_read_b64_tr_b16 a[114:115], v40 offset:18432
  v_mfma_f32_16x16x32_bf16 v[4:7], a[160:163], a[28:31], v[4:7]
  ds_read_b64_tr_b16 a[128:129], v40 offset:20480
  v_mfma_f32_16x16x32_bf16 v[4:7], a[144:147], a[20:23], v[4:7]
  ds_read_b64_tr_b16 a[130:131], v40 offset:22528
  s_waitcnt lgkmcnt(12)
  v_mfma_f32_16x16x32_bf16 v[12:15], a[148:151], a[20:23], v[12:15]
  ds_read_b64_tr_b16 a[116:117], v41 offset:16384
  v_mfma_f32_16x16x32_bf16 v[12:15], a[164:167], a[28:31], v[12:15]
  ds_read_b64_tr_b16 a[118:119], v41 offset:18432
  v_mfma_f32_16x16x32_bf16 v[8:11], a[164:167], a[24:27], v[8:11]
  ds_read_b64_tr_b16 a[132:133], v41 offset:20480
  v_mfma_f32_16x16x32_bf16 v[8:11], a[148:151], a[16:19], v[8:11]
  ds_read_b64_tr_b16 a[134:135], v41 offset:22528
  s_waitcnt lgkmcnt(12)
  v_mfma_f32_16x16x32_bf16 v[16:19], a[152:155], a[16:19], v[16:19]
  ds_read_b64_tr_b16 a[120:121], v42 offset:16384
  v_mfma_f32_16x16x32_bf16 v[16:19], a[168:171], a[24:27], v[16:19]
  ds_read_b64_tr_b16 a[122:123], v42 offset:18432
  v_mfma_f32_16x16x32_bf16 v[20:23], a[168:171], a[28:31], v[20:23]
  ds_read_b64_tr_b16 a[136:137], v42 offset:20480
  v_mfma_f32_16x16x32_bf16 v[20:23], a[152:155], a[20:23], v[20:23]
  ds_read_b64_tr_b16 a[138:139], v42 offset:22528
  s_waitcnt lgkmcnt(12)
  v_mfma_f32_16x16x32_bf16 v[28:31], a[156:159], a[20:23], v[28:31]
  ds_read_b64_tr_b16 a[124:125], v43 offset:16384
  v_mfma_f32_16x16x32_bf16 v[28:31], a[172:175], a[28:31], v[28:31]
  ds_read_b64_tr_b16 a[126:127], v43 offset:18432
  v_mfma_f32_16x16x32_bf16 v[24:27], a[172:175], a[24:27], v[24:27]
  ds_read_b64_tr_b16 a[140:141], v43 offset:20480
  v_mfma_f32_16x16x32_bf16 v[24:27], a[156:159], a[16:19], v[24:27]
  ds_read_b64_tr_b16 a[142:143], v43 offset:22528
  s_waitcnt vmcnt(4) lgkmcnt(12)
  v_mfma_f32_16x16x32_bf16 v[0:3], a[112:115], a[32:35], v[0:3]
  ds_read_b64_tr_b16 a[144:145], v40 offset:24576
  v_mfma_f32_16x16x32_bf16 v[0:3], a[128:131], a[40:43], v[0:3]
  ds_read_b64_tr_b16 a[146:147], v40 offset:26624
  v_mfma_f32_16x16x32_bf16 v[4:7], a[128:131], a[44:47], v[4:7]
  ds_read_b64_tr_b16 a[160:161], v40 offset:28672
  v_mfma_f32_16x16x32_bf16 v[4:7], a[112:115], a[36:39], v[4:7]
  s_waitcnt lgkmcnt(11)
  ds_read_b64_tr_b16 a[162:163], v40 offset:30720
  v_add_u32 v40, 32768, v40
  v_mfma_f32_16x16x32_bf16 v[12:15], a[116:119], a[36:39], v[12:15]
  ds_read_b64_tr_b16 a[148:149], v41 offset:24576
  v_mfma_f32_16x16x32_bf16 v[12:15], a[132:135], a[44:47], v[12:15]
  ds_read_b64_tr_b16 a[150:151], v41 offset:26624
  v_mfma_f32_16x16x32_bf16 v[8:11], a[132:135], a[40:43], v[8:11]
  ds_read_b64_tr_b16 a[164:165], v41 offset:28672
  v_mfma_f32_16x16x32_bf16 v[8:11], a[116:119], a[32:35], v[8:11]
  s_waitcnt lgkmcnt(11)
  ds_read_b64_tr_b16 a[166:167], v41 offset:30720
  v_add_u32 v41, 32768, v41
  v_mfma_f32_16x16x32_bf16 v[16:19], a[120:123], a[32:35], v[16:19]
  ds_read_b64_tr_b16 a[152:153], v42 offset:24576
  v_mfma_f32_16x16x32_bf16 v[16:19], a[136:139], a[40:43], v[16:19]
  ds_read_b64_tr_b16 a[154:155], v42 offset:26624
  v_mfma_f32_16x16x32_bf16 v[20:23], a[136:139], a[44:47], v[20:23]
  ds_read_b64_tr_b16 a[168:169], v42 offset:28672
  v_mfma_f32_16x16x32_bf16 v[20:23], a[120:123], a[36:39], v[20:23]
  s_waitcnt lgkmcnt(11)
  ds_read_b64_tr_b16 a[170:171], v42 offset:30720
  v_add_u32 v42, 32768, v42
  v_mfma_f32_16x16x32_bf16 v[28:31], a[124:127], a[36:39], v[28:31]
  ds_read_b64_tr_b16 a[156:157], v43 offset:24576
  v_mfma_f32_16x16x32_bf16 v[28:31], a[140:143], a[44:47], v[28:31]
  ds_read_b64_tr_b16 a[158:159], v43 offset:26624
  v_mfma_f32_16x16x32_bf16 v[24:27], a[140:143], a[40:43], v[24:27]
  ds_read_b64_tr_b16 a[172:173], v43 offset:28672
  v_mfma_f32_16x16x32_bf16 v[24:27], a[124:127], a[32:35], v[24:27]
  s_waitcnt vmcnt(0) lgkmcnt(11)
  ds_read_b64_tr_b16 a[174:175], v43 offset:30720
  v_add_u32 v43, 32768, v43
  v_mfma_f32_16x16x32_bf16 v[0:3], a[144:147], a[48:51], v[0:3]
  v_mfma_f32_16x16x32_bf16 v[0:3], a[160:163], a[56:59], v[0:3]
  v_mfma_f32_16x16x32_bf16 v[4:7], a[160:163], a[60:63], v[4:7]
  v_mfma_f32_16x16x32_bf16 v[4:7], a[144:147], a[52:55], v[4:7]
  s_waitcnt lgkmcnt(8)
  v_mfma_f32_16x16x32_bf16 v[12:15], a[148:151], a[52:55], v[12:15]
  v_mfma_f32_16x16x32_bf16 v[12:15], a[164:167], a[60:63], v[12:15]
  v_mfma_f32_16x16x32_bf16 v[8:11], a[164:167], a[56:59], v[8:11]
  v_mfma_f32_16x16x32_bf16 v[8:11], a[148:151], a[48:51], v[8:11]
  s_waitcnt lgkmcnt(4)
  v_mfma_f32_16x16x32_bf16 v[16:19], a[152:155], a[48:51], v[16:19]
  v_mfma_f32_16x16x32_bf16 v[16:19], a[168:171], a[56:59], v[16:19]
  v_mfma_f32_16x16x32_bf16 v[20:23], a[168:171], a[60:63], v[20:23]
  v_mfma_f32_16x16x32_bf16 v[20:23], a[152:155], a[52:55], v[20:23]
  s_waitcnt lgkmcnt(0)
  v_mfma_f32_16x16x32_bf16 v[28:31], a[156:159], a[52:55], v[28:31]
  v_mfma_f32_16x16x32_bf16 v[28:31], a[172:175], a[60:63], v[28:31]
  v_mfma_f32_16x16x32_bf16 v[24:27], a[172:175], a[56:59], v[24:27]
  v_mfma_f32_16x16x32_bf16 v[24:27], a[156:159], a[48:51], v[24:27]
  s_add_u32 s46, s59, 4194304
  s_add_u32 s47, s46, 32768
  s_lshl_b32 s48, s58, 11
  s_lshl_b32 s43, s53, 7
  s_add_u32 s48, s48, s43
  s_add_u32 s48, s48, s42
  s_add_u32 s48, s48, 27525120
  s_nop 0
  v_cvt_pk_bf16_f32 v52, v0, v1
  v_cvt_pk_bf16_f32 v53, v2, v3
  v_cvt_pk_bf16_f32 v54, v8, v9
  v_cvt_pk_bf16_f32 v55, v10, v11
  buffer_store_dwordx4 v[52:55], v48, s[4:7], s46 offen offset:0 sc1
  v_cvt_pk_bf16_f32 v60, v4, v5
  v_cvt_pk_bf16_f32 v61, v6, v7
  v_cvt_pk_bf16_f32 v62, v12, v13
  v_cvt_pk_bf16_f32 v63, v14, v15
  buffer_store_dwordx4 v[60:63], v48, s[4:7], s47 offen offset:0 sc1
  v_cvt_pk_bf16_f32 v56, v16, v17
  v_cvt_pk_bf16_f32 v57, v18, v19
  v_cvt_pk_bf16_f32 v58, v24, v25
  v_cvt_pk_bf16_f32 v59, v26, v27
  buffer_store_dwordx4 v[56:59], v48, s[4:7], s46 offen offset:1024 sc1
  v_cvt_pk_bf16_f32 v64, v20, v21
  v_cvt_pk_bf16_f32 v65, v22, v23
  v_cvt_pk_bf16_f32 v66, v28, v29
  v_cvt_pk_bf16_f32 v67, v30, v31
  buffer_store_dwordx4 v[64:67], v48, s[4:7], s47 offen offset:1024 sc1
  v_mov_b32 v72, 0x3f803f80
  v_mov_b32 v73, 0x3f803f80
  v_mov_b32 v74, 0x3f803f80
  v_mov_b32 v75, 0x3f803f80
  v_and_b32 v92, 15, v253
  v_lshrrev_b32 v93, 4, v253
  v_mfma_f32_16x16x32_bf16 v[76:79], v[72:75], v[52:55], 0
  v_mfma_f32_16x16x32_bf16 v[80:83], v[52:55], v[52:55], 0
  v_mfma_f32_16x16x32_bf16 v[84:87], v[72:75], v[60:63], 0
  v_mfma_f32_16x16x32_bf16 v[88:91], v[60:63], v[60:63], 0
  v_mfma_f32_16x16x32_bf16 v[76:79], v[72:75], v[56:59], v[76:79]
  v_mfma_f32_16x16x32_bf16 v[80:83], v[56:59], v[56:59], v[80:83]
  v_mfma_f32_16x16x32_bf16 v[84:87], v[72:75], v[64:67], v[84:87]
  v_mfma_f32_16x16x32_bf16 v[88:91], v[64:67], v[64:67], v[88:91]
  v_lshrrev_b32 v72, 2, v92
  v_cmp_eq_u32 s[64:65], v72, v93
  v_and_b32 v72, 3, v92
  v_cmp_eq_u32 s[66:67], 1, v72
  v_cmp_eq_u32 s[68:69], 2, v72
  v_cmp_eq_u32 s[70:71], 3, v72
  v_lshlrev_b32 v92, 3, v92
  v_mov_b32 v93, 0x7ffffff0
  s_nop 0
  v_cndmask_b32 v92, v93, v92, s[64:65]
  v_cndmask_b32 v77, v80, v81, s[66:67]
  v_cndmask_b32 v77, v77, v82, s[68:69]
  v_cndmask_b32 v77, v77, v83, s[70:71]
  buffer_store_dwordx2 v[76:77], v92, s[4:7], s48 offen offset:0 sc1
  v_cndmask_b32 v85, v88, v89, s[66:67]
  v_cndmask_b32 v85, v85, v90, s[68:69]
  v_cndmask_b32 v85, v85, v91, s[70:71]
  buffer_store_dwordx2 v[84:85], v92, s[4:7], s48 offen offset:2048 sc1
  s_lshr_b32 s77, s52, 1
  s_lshl_b32 s77, s77, 7
  s_add_u32 s77, s77, s42
  s_add_u32 s77, s77, 27791360
  s_and_b32 s66, s55, 1
  v_lshrrev_b32 v2, 4, v253
  v_bfe_u32 v3, v253, 1, 3
  v_and_b32 v4, 1, v253
  v_lshlrev_b32 v4, 4, v4
  v_mul_u32_u24 v5, 7168, v2
  v_add_u32 v5, v5, v4
  s_cmp_eq_u32 s66, 0
  s_cselect_b32 s44, 7, 0
  v_mov_b32 v7, 0x40000000
  v_add_u32 v6, 0, v2
  v_xor_b32 v6, v6, v3
  v_cmp_eq_u32 vcc, s44, v6
  v_lshl_add_u32 v6, v6, 5, v5
  v_add_u32 v6, 0, v6
  v_cndmask_b32 v232, v6, v7, vcc
  v_add_u32 v6, 4, v2
  v_xor_b32 v6, v6, v3
  v_cmp_eq_u32 vcc, s44, v6
  v_lshl_add_u32 v6, v6, 5, v5
  v_add_u32 v6, 27648, v6
  v_cndmask_b32 v233, v6, v7, vcc
  v_add_u32 v6, 0, v2
  v_xor_b32 v6, v6, v3
  v_cmp_eq_u32 vcc, s44, v6
  v_lshl_add_u32 v6, v6, 5, v5
  v_add_u32 v6, 55296, v6
  v_cndmask_b32 v234, v6, v7, vcc
  v_add_u32 v6, 4, v2
  v_xor_b32 v6, v6, v3
  v_cmp_eq_u32 vcc, s44, v6
  v_lshl_add_u32 v6, v6, 5, v5
  v_add_u32 v6, 82944, v6
  v_cndmask_b32 v235, v6, v7, vcc
  s_mul_i32 s67, s55, 224
  s_and_b32 s67, s67, 0xffffffc0
  s_mul_i32 s43, s40, 114688
  s_add_u32 s67, s67, s43
  s_lshl_b32 s68, s40, 12
  v_lshlrev_b32 v231, 4, v253
  s_lshl_b32 s43, s41, 30
  v_or_b32 v236, s43, v231
  s_lshl_b32 s43, s2, 2
  s_add_u32 s43, s43, s40
  s_mul_i32 s70, s43, 7168
  s_lshl_b32 s69, s54, 2
  s_add_u32 s69, s69, s40
  s_lshl_b32 s72, s69, 17
  s_add_u32 s72, s72, s42
  s_add_u32 s72, s72, 4194304
  s_add_u32 s73, s72, 32768
  s_add_u32 s74, s73, 32768
  s_add_u32 s75, s74, 32768
  s_lshl_b32 s71, s40, 11
  s_add_u32 s71, s71, 131072
  v_lshrrev_b32 v2, 2, v253
  v_and_b32 v3, 7, v2
  v_and_b32 v4, 3, v253
  v_lshlrev_b32 v5, 3, v4
  v_lshl_add_u32 v5, v2, 8, v5
  s_lshl_b32 s43, s66, 1
  s_cmp_eq_u32 s66, 0
  s_cselect_b32 s45, 6, 1
  s_add_u32 s46, s43, 0
  v_xor_b32 v6, s46, v3
  v_lshl_add_u32 v224, v6, 5, v5
  s_add_u32 s46, s43, 1
  v_xor_b32 v6, s46, v3
  v_lshl_add_u32 v225, v6, 5, v5
  s_add_u32 s46, s43, 2
  v_xor_b32 v6, s46, v3
  v_lshl_add_u32 v226, v6, 5, v5
  s_add_u32 s46, s43, 3
  v_xor_b32 v6, s46, v3
  v_lshl_add_u32 v227, v6, 5, v5
  s_add_u32 s46, s43, 4
  v_xor_b32 v6, s46, v3
  v_lshl_add_u32 v228, v6, 5, v5
  s_add_u32 s46, s43, 5
  v_xor_b32 v6, s46, v3
  v_lshl_add_u32 v229, v6, 5, v5
  v_xor_b32 v6, s45, v3
  v_lshl_add_u32 v230, v6, 5, v5
  s_mul_i32 s46, s55, 448
  s_add_u32 s46, s46, 27918336
  s_add_u32 s47, s46, 28672
  s_lshr_b32 s48, s55, 3
  s_lshl_b32 s48, s48, 7
  s_add_u32 s48, s48, 27794432
  s_lshl_b32 s44, s69, 13
  s_add_u32 s44, s44, s42
  s_add_u32 s44, s44, 27525120
  s_add_u32 s45, s44, 4096
  s_waitcnt vmcnt(0)
  s_barrier
  s_cmp_lg_u32 s40, 0
  s_cbranch_scc1 Lsig11
  v_mov_b32 v250, 1
  s_mov_b64 exec, 1
  buffer_atomic_add v250, v251, s[4:7], s77 offen sc1
  s_mov_b64 exec, -1
Lsig11:
  s_cmp_eq_u32 s3, 0
  s_cbranch_scc1 Lsd12
  s_bfe_u32 s43, s2, 0x20001
  s_lshl_b32 s43, s43, 7
  s_add_u32 s43, s43, 27794432
  v_mov_b32 v250, 1
  s_mov_b64 exec, 1
  buffer_atomic_add v250, v251, s[4:7], s43 offen sc1
  s_mov_b64 exec, -1
Lsd12:
  s_add_u32 m0, s68, 0
  s_nop 0
  buffer_load_dwordx4 v232, s[16:19], s67 offen offset:0  lds
  buffer_load_dwordx4 v233, s[16:19], s67 offen offset:1024  lds
  buffer_load_dwordx4 v234, s[16:19], s67 offen offset:2048  lds
  buffer_load_dwordx4 v235, s[16:19], s67 offen offset:3072  lds
  s_add_u32 m0, s68, 16384
  s_nop 0
  buffer_load_dwordx4 v232, s[20:23], s67 offen offset:0  lds
  buffer_load_dwordx4 v233, s[20:23], s67 offen offset:1024  lds
  buffer_load_dwordx4 v234, s[20:23], s67 offen offset:2048  lds
  buffer_load_dwordx4 v235, s[20:23], s67 offen offset:3072  lds
  s_add_u32 s67, s67, 458752
  s_add_u32 m0, s68, 32768
  s_nop 0
  buffer_load_dwordx4 v232, s[16:19], s67 offen offset:0  lds
  buffer_load_dwordx4 v233, s[16:19], s67 offen offset:1024  lds
  buffer_load_dwordx4 v234, s[16:19], s67 offen offset:2048  lds
  buffer_load_dwordx4 v235, s[16:19], s67 offen offset:3072  lds
  s_add_u32 m0, s68, 49152
  s_nop 0
  buffer_load_dwordx4 v232, s[20:23], s67 offen offset:0  lds
  buffer_load_dwordx4 v233, s[20:23], s67 offen offset:1024  lds
  buffer_load_dwordx4 v234, s[20:23], s67 offen offset:2048  lds
  buffer_load_dwordx4 v235, s[20:23], s67 offen offset:3072  lds
  s_add_u32 s67, s67, 458752
  s_xor_b32 s68, s68, 0x10000
  s_lshl_b32 s77, s54, 7
  s_add_u32 s77, s77, s42
  s_add_u32 s77, s77, 27791360
  s_cmp_lg_u32 s40, 0
  s_cbranch_scc1 Lpdn14
  s_mov_b32 s43, 0x40000
  s_mov_b64 exec, 1
Lpol13:
  buffer_load_dword v250, v251, s[4:7], s77 offen sc1
  s_waitcnt vmcnt(0)
  v_cmp_gt_u32 vcc, 32, v250
  s_cbranch_vccz Lpdn14
  s_sub_u32 s43, s43, 1
  s_cmp_lg_u32 s43, 0
  s_cbranch_scc1 Lpol13
Lpdn14:
  s_mov_b64 exec, -1
  s_waitcnt vmcnt(0) lgkmcnt(0)
  s_barrier
  buffer_load_dwordx4 a[0:3], v231, s[4:7], s72 offen offset:0 sc1
  buffer_load_dwordx4 a[16:19], v231, s[4:7], s72 offen offset:1024 sc1
  buffer_load_dwordx4 a[4:7], v231, s[4:7], s73 offen offset:0 sc1
  buffer_load_dwordx4 a[20:23], v231, s[4:7], s73 offen offset:1024 sc1
  buffer_load_dwordx4 a[8:11], v231, s[4:7], s74 offen offset:0 sc1
  buffer_load_dwordx4 a[24:27], v231, s[4:7], s74 offen offset:1024 sc1
  buffer_load_dwordx4 a[12:15], v231, s[4:7], s75 offen offset:0 sc1
  buffer_load_dwordx4 a[28:31], v231, s[4:7], s75 offen offset:1024 sc1
  ds_read_b64_tr_b16 a[64:65], v224 offset:0
  ds_read_b64_tr_b16 a[66:67], v224 offset:4096
  ds_read_b64_tr_b16 a[68:69], v224 offset:8192
  ds_read_b64_tr_b16 a[70:71], v224 offset:12288
  ds_read_b64_tr_b16 a[72:73], v224 offset:16384
  ds_read_b64_tr_b16 a[74:75], v224 offset:20480
  ds_read_b64_tr_b16 a[76:77], v224 offset:24576
  ds_read_b64_tr_b16 a[78:79], v224 offset:28672
Lmk_p3s0:
  s_waitcnt vmcnt(6) lgkmcnt(4)
  v_mfma_f32_16x16x32_bf16 v[0:3], a[64:67], a[0:3], 0
  ds_read_b64_tr_b16 a[80:81], v225 offset:0
  v_mfma_f32_16x16x32_bf16 v[0:3], a[68:71], a[16:19], v[0:3]
  s_waitcnt vmcnt(4)
  v_mfma_f32_16x16x32_bf16 v[4:7], a[68:71], a[20:23], 0
  ds_read_b64_tr_b16 a[82:83], v225 offset:4096
  v_mfma_f32_16x16x32_bf16 v[4:7], a[64:67], a[4:7], v[4:7]
  s_waitcnt vmcnt(2)
  v_mfma_f32_16x16x32_bf16 v[8:11], a[64:67], a[8:11], 0
  ds_read_b64_tr_b16 a[84:85], v225 offset:8192
  v_mfma_f32_16x16x32_bf16 v[8:11], a[68:71], a[24:27], v[8:11]
  s_waitcnt vmcnt(0)
  v_mfma_f32_16x16x32_bf16 v[12:15], a[68:71], a[28:31], 0
  ds_read_b64_tr_b16 a[86:87], v225 offset:12288
  v_mfma_f32_16x16x32_bf16 v[12:15], a[64:67], a[12:15], v[12:15]
  s_waitcnt lgkmcnt(4)
  v_mfma_f32_16x16x32_bf16 v[28:31], a[72:75], a[12:15], 0
  ds_read_b64_tr_b16 a[88:89], v225 offset:16384
  v_mfma_f32_16x16x32_bf16 v[28:31], a[76:79], a[28:31], v[28:31]
  buffer_load_dwordx4 a[32:35], v231, s[4:7], s72 offen offset:2048 sc1
  v_mfma_f32_16x16x32_bf16 v[24:27], a[76:79], a[24:27], 0
  ds_read_b64_tr_b16 a[90:91], v225 offset:20480
  v_mfma_f32_16x16x32_bf16 v[24:27], a[72:75], a[8:11], v[24:27]
  v_mfma_f32_16x16x32_bf16 v[20:23], a[72:75], a[4:7], 0
  ds_read_b64_tr_b16 a[92:93], v225 offset:24576
  v_mfma_f32_16x16x32_bf16 v[20:23], a[76:79], a[20:23], v[20:23]
  buffer_load_dwordx4 a[48:51], v231, s[4:7], s72 offen offset:3072 sc1
  v_mfma_f32_16x16x32_bf16 v[16:19], a[76:79], a[16:19], 0
  ds_read_b64_tr_b16 a[94:95], v225 offset:28672
  s_add_u32 s72, s72, 4096
  v_mfma_f32_16x16x32_bf16 v[16:19], a[72:75], a[0:3], v[16:19]
  s_waitcnt lgkmcnt(4)
  v_mfma_f32_16x16x32_bf16 v[32:35], a[80:83], a[0:3], 0
  ds_read_b64_tr_b16 a[64:65], v226 offset:0
  v_mfma_f32_16x16x32_bf16 v[32:35], a[84:87], a[16:19], v[32:35]
  buffer_load_dwordx4 a[36:39], v231, s[4:7], s73 offen offset:2048 sc1
  v_mfma_f32_16x16x32_bf16 v[36:39], a[84:87], a[20:23], 0
  ds_read_b64_tr_b16 a[66:67], v226 offset:4096
  v_mfma_f32_16x16x32_bf16 v[36:39], a[80:83], a[4:7], v[36:39]
  v_mfma_f32_16x16x32_bf16 v[40:43], a[80:83], a[8:11], 0
  ds_read_b64_tr_b16 a[68:69], v226 offset:8192
  v_mfma_f32_16x16x32_bf16 v[40:43], a[84:87], a[24:27], v[40:43]
  buffer_load_dwordx4 a[52:55], v231, s[4:7], s73 offen offset:3072 sc1
  v_mfma_f32_16x16x32_bf16 v[44:47], a[84:87], a[28:31], 0
  ds_read_b64_tr_b16 a[70:71], v226 offset:12288
  s_add_u32 s73, s73, 4096
  v_mfma_f32_16x16x32_bf16 v[44:47], a[80:83], a[12:15], v[44:47]
  s_waitcnt lgkmcnt(4)
  v_mfma_f32_16x16x32_bf16 v[60:63], a[88:91], a[12:15], 0
  ds_read_b64_tr_b16 a[72:73], v226 offset:16384
  v_mfma_f32_16x16x32_bf16 v[60:63], a[92:95], a[28:31], v[60:63]
  buffer_load_dwordx4 a[40:43], v231, s[4:7], s74 offen offset:2048 sc1
  v_mfma_f32_16x16x32_bf16 v[56:59], a[92:95], a[24:27], 0
  ds_read_b64_tr_b16 a[74:75], v226 offset:20480
  v_mfma_f32_16x16x32_bf16 v[56:59], a[88:91], a[8:11], v[56:59]
  v_mfma_f32_16x16x32_bf16 v[52:55], a[88:91], a[4:7], 0
  ds_read_b64_tr_b16 a[76:77], v226 offset:24576
  v_mfma_f32_16x16x32_bf16 v[52:55], a[92:95], a[20:23], v[52:55]
  buffer_load_dwordx4 a[56:59], v231, s[4:7], s74 offen offset:3072 sc1
  v_mfma_f32_16x16x32_bf16 v[48:51], a[92:95], a[16:19], 0
  ds_read_b64_tr_b16 a[78:79], v226 offset:28672
  s_add_u32 s74, s74, 4096
  v_mfma_f32_16x16x32_bf16 v[48:51], a[88:91], a[0:3], v[48:51]
  s_waitcnt lgkmcnt(4)
  v_mfma_f32_16x16x32_bf16 v[64:67], a[64:67], a[0:3], 0
  ds_read_b64_tr_b16 a[80:81], v227 offset:0
  v_mfma_f32_16x16x32_bf16 v[64:67], a[68:71], a[16:19], v[64:67]
  buffer_load_dwordx4 a[44:47], v231, s[4:7], s75 offen offset:2048 sc1
  v_mfma_f32_16x16x32_bf16 v[68:71], a[68:71], a[20:23], 0
  ds_read_b64_tr_b16 a[82:83], v227 offset:4096
  v_mfma_f32_16x16x32_bf16 v[68:71], a[64:67], a[4:7], v[68:71]
  v_mfma_f32_16x16x32_bf16 v[72:75], a[64:67], a[8:11], 0
  ds_read_b64_tr_b16 a[84:85], v227 offset:8192
  v_mfma_f32_16x16x32_bf16 v[72:75], a[68:71], a[24:27], v[72:75]
  buffer_load_dwordx4 a[60:63], v231, s[4:7], s75 offen offset:3072 sc1
  v_mfma_f32_16x16x32_bf16 v[76:79], a[68:71], a[28:31], 0
  ds_read_b64_tr_b16 a[86:87], v227 offset:12288
  s_add_u32 s75, s75, 4096
  v_mfma_f32_16x16x32_bf16 v[76:79], a[64:67], a[12:15], v[76:79]
  s_waitcnt lgkmcnt(4)
  v_mfma_f32_16x16x32_bf16 v[92:95], a[72:75], a[12:15], 0
  ds_read_b64_tr_b16 a[88:89], v227 offset:16384
  s_add_u32 m0, s68, 32768
  v_mfma_f32_16x16x32_bf16 v[92:95], a[76:79], a[28:31], v[92:95]
  buffer_load_dwordx4 v231, s[4:7], s44 offen offset:0 sc1 lds
  v_mfma_f32_16x16x32_bf16 v[88:91], a[76:79], a[24:27], 0
  ds_read_b64_tr_b16 a[90:91], v227 offset:20480
  v_mfma_f32_16x16x32_bf16 v[88:91], a[72:75], a[8:11], v[88:91]
  v_mfma_f32_16x16x32_bf16 v[84:87], a[72:75], a[4:7], 0
  ds_read_b64_tr_b16 a[92:93], v227 offset:24576
  v_mfma_f32_16x16x32_bf16 v[84:87], a[76:79], a[20:23], v[84:87]
  buffer_load_dwordx4 v231, s[4:7], s44 offen offset:1024 sc1 lds
  v_mfma_f32_16x16x32_bf16 v[80:83], a[76:79], a[16:19], 0
  ds_read_b64_tr_b16 a[94:95], v227 offset:28672
  v_mfma_f32_16x16x32_bf16 v[80:83], a[72:75], a[0:3], v[80:83]
  s_waitcnt lgkmcnt(4)
  v_mfma_f32_16x16x32_bf16 v[96:99], a[80:83], a[0:3], 0
  ds_read_b64_tr_b16 a[64:65], v228 offset:0
  v_mfma_f32_16x16x32_bf16 v[96:99], a[84:87], a[16:19], v[96:99]
  buffer_load_dwordx4 v231, s[4:7], s44 offen offset:2048 sc1 lds
  v_mfma_f32_16x16x32_bf16 v[100:103], a[84:87], a[20:23], 0
  ds_read_b64_tr_b16 a[66:67], v228 offset:4096
  v_mfma_f32_16x16x32_bf16 v[100:103], a[80:83], a[4:7], v[100:103]
  v_mfma_f32_16x16x32_bf16 v[104:107], a[80:83], a[8:11], 0
  ds_read_b64_tr_b16 a[68:69], v228 offset:8192
  v_mfma_f32_16x16x32_bf16 v[104:107], a[84:87], a[24:27], v[104:107]
  buffer_load_dwordx4 v231, s[4:7], s44 offen offset:3072 sc1 lds
  v_mfma_f32_16x16x32_bf16 v[108:111], a[84:87], a[28:31], 0
  ds_read_b64_tr_b16 a[70:71], v228 offset:12288
  v_mfma_f32_16x16x32_bf16 v[108:111], a[80:83], a[12:15], v[108:111]
  s_waitcnt lgkmcnt(4)
  v_mfma_f32_16x16x32_bf16 v[124:127], a[88:91], a[12:15], 0
  ds_read_b64_tr_b16 a[72:73], v228 offset:16384
  s_add_u32 m0, s68, 49152
  v_mfma_f32_16x16x32_bf16 v[124:127], a[92:95], a[28:31], v[124:127]
  buffer_load_dwordx4 v231, s[4:7], s45 offen offset:0 sc1 lds
  v_mfma_f32_16x16x32_bf16 v[120:123], a[92:95], a[24:27], 0
  ds_read_b64_tr_b16 a[74:75], v228 offset:20480
  v_mfma_f32_16x16x32_bf16 v[120:123], a[88:91], a[8:11], v[120:123]
  v_mfma_f32_16x16x32_bf16 v[116:119], a[88:91], a[4:7], 0
  ds_read_b64_tr_b16 a[76:77], v228 offset:24576
  v_mfma_f32_16x16x32_bf16 v[116:119], a[92:95], a[20:23], v[116:119]
  buffer_load_dwordx4 v231, s[4:7], s45 offen offset:1024 sc1 lds
  v_mfma_f32_16x16x32_bf16 v[112:115], a[92:95], a[16:19], 0
  ds_read_b64_tr_b16 a[78:79], v228 offset:28672
  v_mfma_f32_16x16x32_bf16 v[112:115], a[88:91], a[0:3], v[112:115]
  s_waitcnt lgkmcnt(4)
  v_mfma_f32_16x16x32_bf16 v[128:131], a[64:67], a[0:3], 0
  ds_read_b64_tr_b16 a[80:81], v229 offset:0
  v_mfma_f32_16x16x32_bf16 v[128:131], a[68:71], a[16:19], v[128:131]
  buffer_load_dwordx4 v231, s[4:7], s45 offen offset:2048 sc1 lds
  v_mfma_f32_16x16x32_bf16 v[132:135], a[68:71], a[20:23], 0
  ds_read_b64_tr_b16 a[82:83], v229 offset:4096
  v_mfma_f32_16x16x32_bf16 v[132:135], a[64:67], a[4:7], v[132:135]
  v_mfma_f32_16x16x32_bf16 v[136:139], a[64:67], a[8:11], 0
  ds_read_b64_tr_b16 a[84:85], v229 offset:8192
  v_mfma_f32_16x16x32_bf16 v[136:139], a[68:71], a[24:27], v[136:139]
  buffer_load_dwordx4 v231, s[4:7], s45 offen offset:3072 sc1 lds
  v_mfma_f32_16x16x32_bf16 v[140:143], a[68:71], a[28:31], 0
  ds_read_b64_tr_b16 a[86:87], v229 offset:12288
  v_mfma_f32_16x16x32_bf16 v[140:143], a[64:67], a[12:15], v[140:143]
  s_waitcnt lgkmcnt(4)
  v_mfma_f32_16x16x32_bf16 v[156:159], a[72:75], a[12:15], 0
  ds_read_b64_tr_b16 a[88:89], v229 offset:16384
  v_mfma_f32_16x16x32_bf16 v[156:159], a[76:79], a[28:31], v[156:159]
  v_mfma_f32_16x16x32_bf16 v[152:155], a[76:79], a[24:27], 0
  ds_read_b64_tr_b16 a[90:91], v229 offset:20480
  s_add_u32 m0, s68, 0
  v_mfma_f32_16x16x32_bf16 v[152:155], a[72:75], a[8:11], v[152:155]
  buffer_load_dwordx4 v232, s[16:19], s67 offen offset:0  lds
  v_mfma_f32_16x16x32_bf16 v[148:151], a[72:75], a[4:7], 0
  ds_read_b64_tr_b16 a[92:93], v229 offset:24576
  v_mfma_f32_16x16x32_bf16 v[148:151], a[76:79], a[20:23], v[148:151]
  v_mfma_f32_16x16x32_bf16 v[144:147], a[76:79], a[16:19], 0
  ds_read_b64_tr_b16 a[94:95], v229 offset:28672
  v_mfma_f32_16x16x32_bf16 v[144:147], a[72:75], a[0:3], v[144:147]
  buffer_load_dwordx4 v233, s[16:19], s67 offen offset:1024  lds
  s_waitcnt lgkmcnt(4)
  v_mfma_f32_16x16x32_bf16 v[160:163], a[80:83], a[0:3], 0
  ds_read_b64_tr_b16 a[64:65], v230 offset:0
  v_mfma_f32_16x16x32_bf16 v[160:163], a[84:87], a[16:19], v[160:163]
  v_mfma_f32_16x16x32_bf16 v[164:167], a[84:87], a[20:23], 0
  ds_read_b64_tr_b16 a[66:67], v230 offset:4096
  v_mfma_f32_16x16x32_bf16 v[164:167], a[80:83], a[4:7], v[164:167]
  buffer_load_dwordx4 v234, s[16:19], s67 offen offset:2048  lds
  v_mfma_f32_16x16x32_bf16 v[168:171], a[80:83], a[8:11], 0
  ds_read_b64_tr_b16 a[68:69], v230 offset:8192
  v_mfma_f32_16x16x32_bf16 v[168:171], a[84:87], a[24:27], v[168:171]
  v_mfma_f32_16x16x32_bf16 v[172:175], a[84:87], a[28:31], 0
  ds_read_b64_tr_b16 a[70:71], v230 offset:12288
  v_mfma_f32_16x16x32_bf16 v[172:175], a[80:83], a[12:15], v[172:175]
  buffer_load_dwordx4 v235, s[16:19], s67 offen offset:3072  lds
  s_waitcnt lgkmcnt(4)
  v_mfma_f32_16x16x32_bf16 v[188:191], a[88:91], a[12:15], 0
  ds_read_b64_tr_b16 a[72:73], v230 offset:16384
  v_mfma_f32_16x16x32_bf16 v[188:191], a[92:95], a[28:31], v[188:191]
  v_mfma_f32_16x16x32_bf16 v[184:187], a[92:95], a[24:27], 0
  ds_read_b64_tr_b16 a[74:75], v230 offset:20480
  s_add_u32 m0, s68, 16384
  v_mfma_f32_16x16x32_bf16 v[184:187], a[88:91], a[8:11], v[184:187]
  buffer_load_dwordx4 v232, s[20:23], s67 offen offset:0  lds
  v_mfma_f32_16x16x32_bf16 v[180:183], a[88:91], a[4:7], 0
  ds_read_b64_tr_b16 a[76:77], v230 offset:24576
  v_mfma_f32_16x16x32_bf16 v[180:183], a[92:95], a[20:23], v[180:183]
  v_mfma_f32_16x16x32_bf16 v[176:179], a[92:95], a[16:19], 0
  ds_read_b64_tr_b16 a[78:79], v230 offset:28672
  v_mfma_f32_16x16x32_bf16 v[176:179], a[88:91], a[0:3], v[176:179]
  buffer_load_dwordx4 v233, s[20:23], s67 offen offset:1024  lds
  s_waitcnt lgkmcnt(4)
  v_mfma_f32_16x16x32_bf16 v[192:195], a[64:67], a[0:3], 0
  s_barrier
  ds_read_b64_tr_b16 a[80:81], v224 offset:32768
  v_mfma_f32_16x16x32_bf16 v[192:195], a[68:71], a[16:19], v[192:195]
  v_mfma_f32_16x16x32_bf16 v[196:199], a[68:71], a[20:23], 0
  ds_read_b64_tr_b16 a[82:83], v224 offset:36864
  v_mfma_f32_16x16x32_bf16 v[196:199], a[64:67], a[4:7], v[196:199]
  buffer_load_dwordx4 v234, s[20:23], s67 offen offset:2048  lds
  v_mfma_f32_16x16x32_bf16 v[200:203], a[64:67], a[8:11], 0
  ds_read_b64_tr_b16 a[84:85], v224 offset:40960
  v_mfma_f32_16x16x32_bf16 v[200:203], a[68:71], a[24:27], v[200:203]
  v_mfma_f32_16x16x32_bf16 v[204:207], a[68:71], a[28:31], 0
  ds_read_b64_tr_b16 a[86:87], v224 offset:45056
  v_mfma_f32_16x16x32_bf16 v[204:207], a[64:67], a[12:15], v[204:207]
  buffer_load_dwordx4 v235, s[20:23], s67 offen offset:3072  lds
  s_waitcnt lgkmcnt(4)
  v_mfma_f32_16x16x32_bf16 v[220:223], a[72:75], a[12:15], 0
  ds_read_b64_tr_b16 a[88:89], v224 offset:49152
  s_add_u32 s67, s67, 458752
  v_mfma_f32_16x16x32_bf16 v[220:223], a[76:79], a[28:31], v[220:223]
  v_mfma_f32_16x16x32_bf16 v[216:219], a[76:79], a[24:27], 0
  ds_read_b64_tr_b16 a[90:91], v224 offset:53248
  v_mfma_f32_16x16x32_bf16 v[216:219], a[72:75], a[8:11], v[216:219]
  v_mfma_f32_16x16x32_bf16 v[212:215], a[72:75], a[4:7], 0
  ds_read_b64_tr_b16 a[92:93], v224 offset:57344
  buffer_load_dwordx4 a[96:99], v236, s[24:27], s70 offen
  v_mfma_f32_16x16x32_bf16 v[212:215], a[76:79], a[20:23], v[212:215]
  s_add_u32 s70, s70, 1024
  v_mfma_f32_16x16x32_bf16 v[208:211], a[76:79], a[16:19], 0
  ds_read_b64_tr_b16 a[94:95], v224 offset:61440
  v_xor_b32 v224, 0x10000, v224
  v_mfma_f32_16x16x32_bf16 v[208:211], a[72:75], a[0:3], v[208:211]
Lmk_p3s1:
  s_waitcnt vmcnt(17) lgkmcnt(4)
  v_mfma_f32_16x16x32_bf16 v[0:3], a[80:83], a[32:35], v[0:3]
  ds_read_b64_tr_b16 a[64:65], v225 offset:32768
  v_mfma_f32_16x16x32_bf16 v[0:3], a[84:87], a[48:51], v[0:3]
  v_mfma_f32_16x16x32_bf16 v[4:7], a[84:87], a[52:55], v[4:7]
  ds_read_b64_tr_b16 a[66:67], v225 offset:36864
  v_mfma_f32_16x16x32_bf16 v[4:7], a[80:83], a[36:39], v[4:7]
  buffer_load_dwordx4 a[0:3], v231, s[4:7], s72 offen offset:0 sc1
  v_mfma_f32_16x16x32_bf16 v[8:11], a[80:83], a[40:43], v[8:11]
  ds_read_b64_tr_b16 a[68:69], v225 offset:40960
  v_mfma_f32_16x16x32_bf16 v[8:11], a[84:87], a[56:59], v[8:11]
  s_add_u32 s43, s68, 32768
  v_lshlrev_b32 v250, 3, v253
  v_mfma_f32_16x16x32_bf16 v[12:15], a[84:87], a[60:63], v[12:15]
  ds_read_b64_tr_b16 a[70:71], v225 offset:45056
  v_add_u32 v250, s43, v250
  v_mfma_f32_16x16x32_bf16 v[12:15], a[80:83], a[44:47], v[12:15]
  s_waitcnt lgkmcnt(4)
  v_mfma_f32_16x16x32_bf16 v[28:31], a[88:91], a[44:47], v[28:31]
  ds_read_b64_tr_b16 a[72:73], v225 offset:49152
  v_mfma_f32_16x16x32_bf16 v[28:31], a[92:95], a[60:63], v[28:31]
  v_mfma_f32_16x16x32_bf16 v[24:27], a[92:95], a[56:59], v[24:27]
  ds_read_b64_tr_b16 a[74:75], v225 offset:53248
  buffer_load_dwordx4 a[16:19], v231, s[4:7], s72 offen offset:1024 sc1
  v_mfma_f32_16x16x32_bf16 v[24:27], a[88:91], a[40:43], v[24:27]
  v_mfma_f32_16x16x32_bf16 v[20:23], a[88:91], a[36:39], v[20:23]
  ds_read_b64_tr_b16 a[76:77], v225 offset:57344
  v_mfma_f32_16x16x32_bf16 v[20:23], a[92:95], a[52:55], v[20:23]
  s_waitcnt vmcnt(11)
  ds_read_b64 v[238:239], v250 offset:0
  v_mfma_f32_16x16x32_bf16 v[16:19], a[92:95], a[48:51], v[16:19]
  ds_read_b64_tr_b16 a[78:79], v225 offset:61440
  ds_read_b64 v[240:241], v250 offset:2048
  v_xor_b32 v225, 0x10000, v225
  v_mfma_f32_16x16x32_bf16 v[16:19], a[88:91], a[32:35], v[16:19]
  ds_read_b64 v[242:243], v250 offset:16384
  s_waitcnt lgkmcnt(7)
  v_mfma_f32_16x16x32_bf16 v[32:35], a[64:67], a[32:35], v[32:35]
  ds_read_b64_tr_b16 a[80:81], v226 offset:32768
  ds_read_b64 v[244:245], v250 offset:18432
  v_mfma_f32_16x16x32_bf16 v[32:35], a[68:71], a[48:51], v[32:35]
  buffer_load_dwordx4 a[4:7], v231, s[4:7], s73 offen offset:0 sc1
  ds_read_b64 v[246:247], v250 offset:512
  v_mfma_f32_16x16x32_bf16 v[36:39], a[68:71], a[52:55], v[36:39]
  ds_read_b64_tr_b16 a[82:83], v226 offset:36864
  v_mfma_f32_16x16x32_bf16 v[36:39], a[64:67], a[36:39], v[36:39]
  v_mfma_f32_16x16x32_bf16 v[40:43], a[64:67], a[40:43], v[40:43]
  ds_read_b64_tr_b16 a[84:85], v226 offset:40960
  ds_read_b64 v[248:249], v250 offset:2560
  v_mfma_f32_16x16x32_bf16 v[40:43], a[68:71], a[56:59], v[40:43]
  v_mfma_f32_16x16x32_bf16 v[44:47], a[68:71], a[60:63], v[44:47]
  s_waitcnt lgkmcnt(3)
  ds_read_b64_tr_b16 a[86:87], v226 offset:45056
  v_add_f32 v238, v238, v246
  v_add_f32 v239, v239, v247
  v_mfma_f32_16x16x32_bf16 v[44:47], a[64:67], a[44:47], v[44:47]
  ds_read_b64 v[246:247], v250 offset:16896
  v_mfma_f32_16x16x32_bf16 v[60:63], a[72:75], a[44:47], v[60:63]
  ds_read_b64_tr_b16 a[88:89], v226 offset:49152
  buffer_load_dwordx4 a[20:23], v231, s[4:7], s73 offen offset:1024 sc1
  v_mfma_f32_16x16x32_bf16 v[60:63], a[76:79], a[60:63], v[60:63]
  s_waitcnt lgkmcnt(3)
  v_add_f32 v240, v240, v248
  v_add_f32 v241, v241, v249
  v_mfma_f32_16x16x32_bf16 v[56:59], a[76:79], a[56:59], v[56:59]
  ds_read_b64_tr_b16 a[90:91], v226 offset:53248
  ds_read_b64 v[248:249], v250 offset:18944
  v_mfma_f32_16x16x32_bf16 v[56:59], a[72:75], a[40:43], v[56:59]
  v_mfma_f32_16x16x32_bf16 v[52:55], a[72:75], a[36:39], v[52:55]
  s_waitcnt lgkmcnt(3)
  ds_read_b64_tr_b16 a[92:93], v226 offset:57344
  v_add_f32 v242, v242, v246
  v_add_f32 v243, v243, v247
  v_mfma_f32_16x16x32_bf16 v[52:55], a[76:79], a[52:55], v[52:55]
  ds_read_b64 v[246:247], v250 offset:1024
  v_mfma_f32_16x16x32_bf16 v[48:51], a[76:79], a[48:51], v[48:51]
  ds_read_b64_tr_b16 a[94:95], v226 offset:61440
  v_xor_b32 v226, 0x10000, v226
  v_mfma_f32_16x16x32_bf16 v[48:51], a[72:75], a[32:35], v[48:51]
  s_waitcnt lgkmcnt(3)
  buffer_load_dwordx4 a[8:11], v231, s[4:7], s74 offen offset:0 sc1
  v_add_f32 v244, v244, v248
  v_add_f32 v245, v245, v249
  v_mfma_f32_16x16x32_bf16 v[64:67], a[80:83], a[32:35], v[64:67]
  ds_read_b64_tr_b16 a[64:65], v227 offset:32768
  ds_read_b64 v[248:249], v250 offset:3072
  v_mfma_f32_16x16x32_bf16 v[64:67], a[84:87], a[48:51], v[64:67]
  v_mfma_f32_16x16x32_bf16 v[68:71], a[84:87], a[52:55], v[68:71]
  s_waitcnt lgkmcnt(3)
  ds_read_b64_tr_b16 a[66:67], v227 offset:36864
  v_add_f32 v238, v238, v246
  v_add_f32 v239, v239, v247
  v_mfma_f32_16x16x32_bf16 v[68:71], a[80:83], a[36:39], v[68:71]
  ds_read_b64 v[246:247], v250 offset:17408
  v_mfma_f32_16x16x32_bf16 v[72:75], a[80:83], a[40:43], v[72:75]
  ds_read_b64_tr_b16 a[68:69], v227 offset:40960
  v_mfma_f32_16x16x32_bf16 v[72:75], a[84:87], a[56:59], v[72:75]
  s_waitcnt lgkmcnt(3)
  v_add_f32 v240, v240, v248
  v_add_f32 v241, v241, v249
  v_mfma_f32_16x16x32_bf16 v[76:79], a[84:87], a[60:63], v[76:79]
  ds_read_b64_tr_b16 a[70:71], v227 offset:45056
  buffer_load_dwordx4 a[24:27], v231, s[4:7], s74 offen offset:1024 sc1
  ds_read_b64 v[248:249], v250 offset:19456
  v_mfma_f32_16x16x32_bf16 v[76:79], a[80:83], a[44:47], v[76:79]
  v_mfma_f32_16x16x32_bf16 v[92:95], a[88:91], a[44:47], v[92:95]
  s_waitcnt lgkmcnt(3)
  ds_read_b64_tr_b16 a[72:73], v227 offset:49152
  v_add_f32 v242, v242, v246
  v_add_f32 v243, v243, v247
  v_mfma_f32_16x16x32_bf16 v[92:95], a[92:95], a[60:63], v[92:95]
  ds_read_b64 v[246:247], v250 offset:1536
  v_mfma_f32_16x16x32_bf16 v[88:91], a[92:95], a[56:59], v[88:91]
  ds_read_b64_tr_b16 a[74:75], v227 offset:53248
  v_mfma_f32_16x16x32_bf16 v[88:91], a[88:91], a[40:43], v[88:91]
  s_waitcnt lgkmcnt(3)
  v_add_f32 v244, v244, v248
  v_add_f32 v245, v245, v249
  v_mfma_f32_16x16x32_bf16 v[84:87], a[88:91], a[36:39], v[84:87]
  ds_read_b64_tr_b16 a[76:77], v227 offset:57344
  ds_read_b64 v[248:249], v250 offset:3584
  v_mfma_f32_16x16x32_bf16 v[84:87], a[92:95], a[52:55], v[84:87]
  buffer_load_dwordx4 a[12:15], v231, s[4:7], s75 offen offset:0 sc1
  v_mfma_f32_16x16x32_bf16 v[80:83], a[92:95], a[48:51], v[80:83]
  s_waitcnt lgkmcnt(3)
  ds_read_b64_tr_b16 a[78:79], v227 offset:61440
  v_xor_b32 v227, 0x10000, v227
  v_add_f32 v238, v238, v246
  v_add_f32 v239, v239, v247
  v_mfma_f32_16x16x32_bf16 v[80:83], a[88:91], a[32:35], v[80:83]
  ds_read_b64 v[246:247], v250 offset:17920
  v_mfma_f32_16x16x32_bf16 v[96:99], a[64:67], a[32:35], v[96:99]
  ds_read_b64_tr_b16 a[80:81], v228 offset:32768
  v_mfma_f32_16x16x32_bf16 v[96:99], a[68:71], a[48:51], v[96:99]
  s_waitcnt lgkmcnt(3)
  v_add_f32 v240, v240, v248
  v_add_f32 v241, v241, v249
  v_mfma_f32_16x16x32_bf16 v[100:103], a[68:71], a[52:55], v[100:103]
  ds_read_b64_tr_b16 a[82:83], v228 offset:36864
  ds_read_b64 v[248:249], v250 offset:19968
  v_mfma_f32_16x16x32_bf16 v[100:103], a[64:67], a[36:39], v[100:103]
  v_mfma_f32_16x16x32_bf16 v[104:107], a[64:67], a[40:43], v[104:107]
  s_waitcnt lgkmcnt(3)
  ds_read_b64_tr_b16 a[84:85], v228 offset:40960
  buffer_load_dwordx4 a[28:31], v231, s[4:7], s75 offen offset:1024 sc1
  v_add_f32 v242, v242, v246
  v_add_f32 v243, v243, v247
  v_mfma_f32_16x16x32_bf16 v[104:107], a[68:71], a[56:59], v[104:107]
  buffer_load_dwordx4 a[96:99], v236, s[24:27], s70 offen
  v_mfma_f32_16x16x32_bf16 v[108:111], a[68:71], a[60:63], v[108:111]
  ds_read_b64_tr_b16 a[86:87], v228 offset:45056
  s_add_u32 s70, s70, 1024
  v_mfma_f32_16x16x32_bf16 v[108:111], a[64:67], a[44:47], v[108:111]
  s_waitcnt lgkmcnt(2)
  buffer_load_dword v237, v251, s[4:7], s48 offen sc1
  v_add_f32 v244, v244, v248
  v_add_f32 v245, v245, v249
  v_mfma_f32_16x16x32_bf16 v[124:127], a[72:75], a[44:47], v[124:127]
  ds_read_b64_tr_b16 a[88:89], v228 offset:49152
  v_mov_b32 v246, v238
  v_mfma_f32_16x16x32_bf16 v[124:127], a[76:79], a[60:63], v[124:127]
  v_mov_b32 v247, v239
  v_mov_b32 v248, v240
  v_mfma_f32_16x16x32_bf16 v[120:123], a[76:79], a[56:59], v[120:123]
  ds_read_b64_tr_b16 a[90:91], v228 offset:53248
  s_add_u32 m0, s68, 32768
  v_mfma_f32_16x16x32_bf16 v[120:123], a[72:75], a[40:43], v[120:123]
  buffer_load_dwordx4 v232, s[16:19], s67 offen offset:0  lds
  v_mov_b32 v249, v241
  v_mfma_f32_16x16x32_bf16 v[116:119], a[72:75], a[36:39], v[116:119]
  ds_read_b64_tr_b16 a[92:93], v228 offset:57344
  v_permlane32_swap_b32 v238, v246
  v_mfma_f32_16x16x32_bf16 v[116:119], a[76:79], a[52:55], v[116:119]
  v_permlane32_swap_b32 v239, v247
  v_permlane32_swap_b32 v240, v248
  v_mfma_f32_16x16x32_bf16 v[112:115], a[76:79], a[48:51], v[112:115]
  ds_read_b64_tr_b16 a[94:95], v228 offset:61440
  v_xor_b32 v228, 0x10000, v228
  v_permlane32_swap_b32 v241, v249
  v_mfma_f32_16x16x32_bf16 v[112:115], a[72:75], a[32:35], v[112:115]
  s_waitcnt lgkmcnt(4)
  v_add_f32 v238, v238, v246
  v_add_f32 v239, v239, v247
  v_mfma_f32_16x16x32_bf16 v[128:131], a[80:83], a[32:35], v[128:131]
  ds_read_b64_tr_b16 a[64:65], v229 offset:32768
  v_add_f32 v240, v240, v248
  v_mfma_f32_16x16x32_bf16 v[128:131], a[84:87], a[48:51], v[128:131]
  v_add_f32 v241, v241, v249
  v_mov_b32 v246, v238
  v_mfma_f32_16x16x32_bf16 v[132:135], a[84:87], a[52:55], v[132:135]
  ds_read_b64_tr_b16 a[66:67], v229 offset:36864
  buffer_load_dwordx4 v233, s[16:19], s67 offen offset:1024  lds
  v_mfma_f32_16x16x32_bf16 v[132:135], a[80:83], a[36:39], v[132:135]
  v_mov_b32 v247, v239
  v_mov_b32 v248, v240
  v_mfma_f32_16x16x32_bf16 v[136:139], a[80:83], a[40:43], v[136:139]
  ds_read_b64_tr_b16 a[68:69], v229 offset:40960
  v_mov_b32 v249, v241
  v_mfma_f32_16x16x32_bf16 v[136:139], a[84:87], a[56:59], v[136:139]
  v_permlane16_swap_b32 v238, v246
  v_permlane16_swap_b32 v239, v247
  v_mfma_f32_16x16x32_bf16 v[140:143], a[84:87], a[60:63], v[140:143]
  ds_read_b64_tr_b16 a[70:71], v229 offset:45056
  v_permlane16_swap_b32 v240, v248
  v_mfma_f32_16x16x32_bf16 v[140:143], a[80:83], a[44:47], v[140:143]
  s_waitcnt lgkmcnt(4)
  v_permlane16_swap_b32 v241, v249
  v_add_f32 v238, v238, v246
  v_mfma_f32_16x16x32_bf16 v[156:159], a[88:91], a[44:47], v[156:159]
  ds_read_b64_tr_b16 a[72:73], v229 offset:49152
  v_add_f32 v239, v239, v247
  v_add_f32 v240, v240, v248
  v_mfma_f32_16x16x32_bf16 v[156:159], a[92:95], a[60:63], v[156:159]
  buffer_load_dwordx4 v234, s[16:19], s67 offen offset:2048  lds
  v_add_f32 v241, v241, v249
  v_mov_b32 v246, v242
  v_mfma_f32_16x16x32_bf16 v[152:155], a[92:95], a[56:59], v[152:155]
  ds_read_b64_tr_b16 a[74:75], v229 offset:53248
  v_mov_b32 v247, v243
  v_mov_b32 v248, v244
  v_mfma_f32_16x16x32_bf16 v[152:155], a[88:91], a[40:43], v[152:155]
  v_mov_b32 v249, v245
  v_permlane32_swap_b32 v242, v246
  v_permlane32_swap_b32 v243, v247
  v_mfma_f32_16x16x32_bf16 v[148:151], a[88:91], a[36:39], v[148:151]
  ds_read_b64_tr_b16 a[76:77], v229 offset:57344
  v_permlane32_swap_b32 v244, v248
  v_permlane32_swap_b32 v245, v249
  v_mfma_f32_16x16x32_bf16 v[148:151], a[92:95], a[52:55], v[148:151]
  v_add_f32 v242, v242, v246
  v_add_f32 v243, v243, v247
  v_add_f32 v244, v244, v248
  v_mfma_f32_16x16x32_bf16 v[144:147], a[92:95], a[48:51], v[144:147]
  ds_read_b64_tr_b16 a[78:79], v229 offset:61440
  v_xor_b32 v229, 0x10000, v229
  v_add_f32 v245, v245, v249
  v_mov_b32 v246, v242
  v_mfma_f32_16x16x32_bf16 v[144:147], a[88:91], a[32:35], v[144:147]
  s_waitcnt lgkmcnt(4)
  v_mov_b32 v247, v243
  v_mov_b32 v248, v244
  v_mov_b32 v249, v245
  v_mfma_f32_16x16x32_bf16 v[160:163], a[64:67], a[32:35], v[160:163]
  ds_read_b64_tr_b16 a[80:81], v230 offset:32768
  buffer_load_dwordx4 v235, s[16:19], s67 offen offset:3072  lds
  v_permlane16_swap_b32 v242, v246
  v_mfma_f32_16x16x32_bf16 v[160:163], a[68:71], a[48:51], v[160:163]
  v_permlane16_swap_b32 v243, v247
  v_permlane16_swap_b32 v244, v248
  v_permlane16_swap_b32 v245, v249
  v_mfma_f32_16x16x32_bf16 v[164:167], a[68:71], a[52:55], v[164:167]
  ds_read_b64_tr_b16 a[82:83], v230 offset:36864
  v_add_f32 v242, v242, v246
  v_add_f32 v243, v243, v247
  v_mfma_f32_16x16x32_bf16 v[164:167], a[64:67], a[36:39], v[164:167]
  s_mov_b32 s43, 0x3a800000
  v_add_f32 v244, v244, v248
  v_add_f32 v245, v245, v249
  v_mfma_f32_16x16x32_bf16 v[168:171], a[64:67], a[40:43], v[168:171]
  ds_read_b64_tr_b16 a[84:85], v230 offset:40960
  v_mov_b32 v250, 0x3727c5ac
  v_mul_f32 v238, 0xba800000, v238
  v_mfma_f32_16x16x32_bf16 v[168:171], a[68:71], a[56:59], v[168:171]
  v_fma_f32 v239, v239, s43, v250
  v_mul_f32 v240, 0xba800000, v240
  v_fma_f32 v241, v241, s43, v250
  v_mfma_f32_16x16x32_bf16 v[172:175], a[68:71], a[60:63], v[172:175]
  s_add_u32 m0, s68, 49152
  ds_read_b64_tr_b16 a[86:87], v230 offset:45056
  v_mul_f32 v242, 0xba800000, v242
  v_mfma_f32_16x16x32_bf16 v[172:175], a[64:67], a[44:47], v[172:175]
  s_waitcnt lgkmcnt(4)
  buffer_load_dwordx4 v232, s[20:23], s67 offen offset:0  lds
  v_fma_f32 v243, v243, s43, v250
  v_mul_f32 v244, 0xba800000, v244
  v_mfma_f32_16x16x32_bf16 v[188:191], a[72:75], a[44:47], v[188:191]
  ds_read_b64_tr_b16 a[88:89], v230 offset:49152
  v_fma_f32 v245, v245, s43, v250
  v_fma_f32 v239, -v238, v238, v239
  v_mfma_f32_16x16x32_bf16 v[188:191], a[76:79], a[60:63], v[188:191]
  v_max_f32 v239, v239, v250
  v_fma_f32 v241, -v240, v240, v241
  v_max_f32 v241, v241, v250
  v_mfma_f32_16x16x32_bf16 v[184:187], a[76:79], a[56:59], v[184:187]
  ds_read_b64_tr_b16 a[90:91], v230 offset:53248
  v_fma_f32 v243, -v242, v242, v243
  v_max_f32 v243, v243, v250
  v_mfma_f32_16x16x32_bf16 v[184:187], a[72:75], a[40:43], v[184:187]
  v_fma_f32 v245, -v244, v244, v245
  v_max_f32 v245, v245, v250
  v_rsq_f32 v246, v239
  v_mfma_f32_16x16x32_bf16 v[180:183], a[72:75], a[36:39], v[180:183]
  ds_read_b64_tr_b16 a[92:93], v230 offset:57344
  v_accvgpr_write_b32 a108, v239
  v_rsq_f32 v247, v241
  v_mfma_f32_16x16x32_bf16 v[180:183], a[76:79], a[52:55], v[180:183]
  v_accvgpr_write_b32 a109, v241
  v_rsq_f32 v248, v243
  v_accvgpr_write_b32 a110, v243
  v_mfma_f32_16x16x32_bf16 v[176:179], a[76:79], a[48:51], v[176:179]
  ds_read_b64_tr_b16 a[94:95], v230 offset:61440
  buffer_load_dwordx4 v233, s[20:23], s67 offen offset:1024  lds
  v_xor_b32 v230, 0x10000, v230
  v_rsq_f32 v249, v245
  v_mfma_f32_16x16x32_bf16 v[176:179], a[72:75], a[32:35], v[176:179]
  s_waitcnt lgkmcnt(4)
  v_accvgpr_write_b32 a111, v245
  v_mul_f32 v246, 0xbfb8aa3b, v246
  v_accvgpr_write_b32 a104, v246
  v_mfma_f32_16x16x32_bf16 v[192:195], a[80:83], a[32:35], v[192:195]
  s_waitcnt vmcnt(17)
  s_barrier
  ds_read_b64_tr_b16 a[64:65], v224 offset:0
  v_mul_f32 v247, 0xbfb8aa3b, v247
  v_accvgpr_write_b32 a105, v247
  v_mfma_f32_16x16x32_bf16 v[192:195], a[84:87], a[48:51], v[192:195]
  v_mul_f32 v248, 0xbfb8aa3b, v248
  v_accvgpr_write_b32 a106, v248
  v_mul_f32 v249, 0xbfb8aa3b, v249
  v_mfma_f32_16x16x32_bf16 v[196:199], a[84:87], a[52:55], v[196:199]
  ds_read_b64_tr_b16 a[66:67], v224 offset:4096
  v_accvgpr_write_b32 a107, v249
  v_mov_b32 v239, v240
  v_mfma_f32_16x16x32_bf16 v[196:199], a[80:83], a[36:39], v[196:199]
  v_mov_b32 v240, v242
  v_mov_b32 v241, v244
  v_lshrrev_b32 v250, 3, v253
  v_mfma_f32_16x16x32_bf16 v[200:203], a[80:83], a[40:43], v[200:203]
  ds_read_b64_tr_b16 a[68:69], v224 offset:8192
  v_add_u32 v250, s66, v250
  v_cmp_ne_u32 vcc, 7, v250
  v_mfma_f32_16x16x32_bf16 v[200:203], a[84:87], a[56:59], v[200:203]
  buffer_load_dwordx4 v234, s[20:23], s67 offen offset:2048  lds
  v_bfe_u32 v242, v253, 2, 1
  v_mul_u32_u24 v242, 14336, v242
  v_mfma_f32_16x16x32_bf16 v[204:207], a[84:87], a[60:63], v[204:207]
  ds_read_b64_tr_b16 a[70:71], v224 offset:12288
  v_cndmask_b32 v250, 0, v250, vcc
  v_lshl_add_u32 v250, v250, 6, v242
  v_mfma_f32_16x16x32_bf16 v[204:207], a[80:83], a[44:47], v[204:207]
  s_waitcnt vmcnt(7)
  v_and_b32 v242, 3, v253
  v_lshl_add_u32 v250, v242, 4, v250
  v_cmp_gt_u32 vcc, 56, v237
  s_cbranch_vccz Lcdn16
  s_mov_b32 s43, 0x40000
Lchk15:
  s_sleep 8
  buffer_load_dword v237, v251, s[4:7], s48 offen sc1
  s_waitcnt vmcnt(0)
  v_cmp_gt_u32 vcc, 56, v237
  s_cbranch_vccz Lcdn16
  s_sub_u32 s43, s43, 1
  s_cmp_lg_u32 s43, 0
  s_cbranch_scc1 Lchk15
Lcdn16:
  s_waitcnt lgkmcnt(4)
  v_mfma_f32_16x16x32_bf16 v[220:223], a[88:91], a[44:47], v[220:223]
  ds_read_b64_tr_b16 a[72:73], v224 offset:16384
  buffer_load_dwordx4 v[242:245], v250, s[4:7], s46 offen sc1
  buffer_load_dwordx4 v[246:249], v250, s[4:7], s47 offen sc1
  v_mfma_f32_16x16x32_bf16 v[220:223], a[92:95], a[60:63], v[220:223]
  v_lshrrev_b32 v237, 4, v253
  v_lshlrev_b32 v237, 4, v237
  v_add_u32 v237, s71, v237
  v_mfma_f32_16x16x32_bf16 v[216:219], a[92:95], a[56:59], v[216:219]
  ds_read_b64_tr_b16 a[74:75], v224 offset:20480
  v_add_u32 v250, s71, v231
  v_mfma_f32_16x16x32_bf16 v[216:219], a[88:91], a[40:43], v[216:219]
  v_mfma_f32_16x16x32_bf16 v[212:215], a[88:91], a[36:39], v[212:215]
  ds_read_b64_tr_b16 a[76:77], v224 offset:24576
  buffer_load_dwordx4 v235, s[20:23], s67 offen offset:3072  lds
  v_mfma_f32_16x16x32_bf16 v[212:215], a[92:95], a[52:55], v[212:215]
  s_add_u32 s67, s67, 458752
  s_xor_b32 s68, s68, 0x10000
  v_mfma_f32_16x16x32_bf16 v[208:211], a[92:95], a[48:51], v[208:211]
  ds_read_b64_tr_b16 a[78:79], v224 offset:28672
  v_mfma_f32_16x16x32_bf16 v[208:211], a[88:91], a[32:35], v[208:211]
  s_mov_b32 s56, 5
.p2align 3
Lp3_loop:
  s_waitcnt lgkmcnt(4) vmcnt(8)
  v_mfma_f32_16x16x32_bf16 v[0:3], a[64:67], a[0:3], v[0:3]
  ds_read_b64_tr_b16 a[80:81], v225 offset:0
  v_mfma_f32_16x16x32_bf16 v[0:3], a[68:71], a[16:19], v[0:3]
  v_mfma_f32_16x16x32_bf16 v[4:7], a[68:71], a[20:23], v[4:7]
  ds_read_b64_tr_b16 a[82:83], v225 offset:4096
  v_mfma_f32_16x16x32_bf16 v[4:7], a[64:67], a[4:7], v[4:7]
  buffer_load_dwordx4 a[32:35], v231, s[4:7], s72 offen offset:2048 sc1
  v_mfma_f32_16x16x32_bf16 v[8:11], a[64:67], a[8:11], v[8:11]
  ds_read_b64_tr_b16 a[84:85], v225 offset:8192
  v_mfma_f32_16x16x32_bf16 v[8:11], a[68:71], a[24:27], v[8:11]
  v_mfma_f32_16x16x32_bf16 v[12:15], a[68:71], a[28:31], v[12:15]
  ds_read_b64_tr_b16 a[86:87], v225 offset:12288
  v_mfma_f32_16x16x32_bf16 v[12:15], a[64:67], a[12:15], v[12:15]
  s_waitcnt lgkmcnt(4)
  v_mfma_f32_16x16x32_bf16 v[28:31], a[72:75], a[12:15], v[28:31]
  ds_read_b64_tr_b16 a[88:89], v225 offset:16384
  v_mfma_f32_16x16x32_bf16 v[28:31], a[76:79], a[28:31], v[28:31]
  v_mfma_f32_16x16x32_bf16 v[24:27], a[76:79], a[24:27], v[24:27]
  ds_read_b64_tr_b16 a[90:91], v225 offset:20480
  buffer_load_dwordx4 a[48:51], v231, s[4:7], s72 offen offset:3072 sc1
  v_mfma_f32_16x16x32_bf16 v[24:27], a[72:75], a[8:11], v[24:27]
  s_add_u32 s72, s72, 4096
  v_mfma_f32_16x16x32_bf16 v[20:23], a[72:75], a[4:7], v[20:23]
  ds_read_b64_tr_b16 a[92:93], v225 offset:24576
  v_mfma_f32_16x16x32_bf16 v[20:23], a[76:79], a[20:23], v[20:23]
  v_mfma_f32_16x16x32_bf16 v[16:19], a[76:79], a[16:19], v[16:19]
  ds_read_b64_tr_b16 a[94:95], v225 offset:28672
  v_mfma_f32_16x16x32_bf16 v[16:19], a[72:75], a[0:3], v[16:19]
  s_waitcnt lgkmcnt(4)
  v_mfma_f32_16x16x32_bf16 v[32:35], a[80:83], a[0:3], v[32:35]
  ds_read_b64_tr_b16 a[64:65], v226 offset:0
  v_mfma_f32_16x16x32_bf16 v[32:35], a[84:87], a[16:19], v[32:35]
  buffer_load_dwordx4 a[36:39], v231, s[4:7], s73 offen offset:2048 sc1
  v_mfma_f32_16x16x32_bf16 v[36:39], a[84:87], a[20:23], v[36:39]
  ds_read_b64_tr_b16 a[66:67], v226 offset:4096
  v_mfma_f32_16x16x32_bf16 v[36:39], a[80:83], a[4:7], v[36:39]
  v_mfma_f32_16x16x32_bf16 v[40:43], a[80:83], a[8:11], v[40:43]
  ds_read_b64_tr_b16 a[68:69], v226 offset:8192
  v_mfma_f32_16x16x32_bf16 v[40:43], a[84:87], a[24:27], v[40:43]
  v_mfma_f32_16x16x32_bf16 v[44:47], a[84:87], a[28:31], v[44:47]
  ds_read_b64_tr_b16 a[70:71], v226 offset:12288
  v_mfma_f32_16x16x32_bf16 v[44:47], a[80:83], a[12:15], v[44:47]
  s_waitcnt lgkmcnt(4)
  v_mfma_f32_16x16x32_bf16 v[60:63], a[88:91], a[12:15], v[60:63]
  ds_read_b64_tr_b16 a[72:73], v226 offset:16384
  buffer_load_dwordx4 a[52:55], v231, s[4:7], s73 offen offset:3072 sc1
  v_mfma_f32_16x16x32_bf16 v[60:63], a[92:95], a[28:31], v[60:63]
  s_add_u32 s73, s73, 4096
  v_mfma_f32_16x16x32_bf16 v[56:59], a[92:95], a[24:27], v[56:59]
  ds_read_b64_tr_b16 a[74:75], v226 offset:20480
  v_mfma_f32_16x16x32_bf16 v[56:59], a[88:91], a[8:11], v[56:59]
  v_mfma_f32_16x16x32_bf16 v[52:55], a[88:91], a[4:7], v[52:55]
  ds_read_b64_tr_b16 a[76:77], v226 offset:24576
  v_mfma_f32_16x16x32_bf16 v[52:55], a[92:95], a[20:23], v[52:55]
  v_mfma_f32_16x16x32_bf16 v[48:51], a[92:95], a[16:19], v[48:51]
  ds_read_b64_tr_b16 a[78:79], v226 offset:28672
  v_mfma_f32_16x16x32_bf16 v[48:51], a[88:91], a[0:3], v[48:51]
  buffer_load_dwordx4 a[40:43], v231, s[4:7], s74 offen offset:2048 sc1
  s_waitcnt lgkmcnt(4)
  v_mfma_f32_16x16x32_bf16 v[64:67], a[64:67], a[0:3], v[64:67]
  ds_read_b64_tr_b16 a[80:81], v227 offset:0
  v_mfma_f32_16x16x32_bf16 v[64:67], a[68:71], a[16:19], v[64:67]
  v_mfma_f32_16x16x32_bf16 v[68:71], a[68:71], a[20:23], v[68:71]
  ds_read_b64_tr_b16 a[82:83], v227 offset:4096
  v_mfma_f32_16x16x32_bf16 v[68:71], a[64:67], a[4:7], v[68:71]
  v_mfma_f32_16x16x32_bf16 v[72:75], a[64:67], a[8:11], v[72:75]
  ds_read_b64_tr_b16 a[84:85], v227 offset:8192
  v_mfma_f32_16x16x32_bf16 v[72:75], a[68:71], a[24:27], v[72:75]
  v_mfma_f32_16x16x32_bf16 v[76:79], a[68:71], a[28:31], v[76:79]
  ds_read_b64_tr_b16 a[86:87], v227 offset:12288
  buffer_load_dwordx4 a[56:59], v231, s[4:7], s74 offen offset:3072 sc1
  v_mfma_f32_16x16x32_bf16 v[76:79], a[64:67], a[12:15], v[76:79]
  s_add_u32 s74, s74, 4096
  s_waitcnt lgkmcnt(4)
  v_mfma_f32_16x16x32_bf16 v[92:95], a[72:75], a[12:15], v[92:95]
  ds_read_b64_tr_b16 a[88:89], v227 offset:16384
  v_mfma_f32_16x16x32_bf16 v[92:95], a[76:79], a[28:31], v[92:95]
  v_mfma_f32_16x16x32_bf16 v[88:91], a[76:79], a[24:27], v[88:91]
  ds_read_b64_tr_b16 a[90:91], v227 offset:20480
  v_mfma_f32_16x16x32_bf16 v[88:91], a[72:75], a[8:11], v[88:91]
  v_mfma_f32_16x16x32_bf16 v[84:87], a[72:75], a[4:7], v[84:87]
  ds_read_b64_tr_b16 a[92:93], v227 offset:24576
  v_mfma_f32_16x16x32_bf16 v[84:87], a[76:79], a[20:23], v[84:87]
  buffer_load_dwordx4 a[44:47], v231, s[4:7], s75 offen offset:2048 sc1
  v_mfma_f32_16x16x32_bf16 v[80:83], a[76:79], a[16:19], v[80:83]
  ds_read_b64_tr_b16 a[94:95], v227 offset:28672
  v_mfma_f32_16x16x32_bf16 v[80:83], a[72:75], a[0:3], v[80:83]
  s_waitcnt lgkmcnt(4)
  v_mfma_f32_16x16x32_bf16 v[96:99], a[80:83], a[0:3], v[96:99]
  ds_read_b64_tr_b16 a[64:65], v228 offset:0
  v_mfma_f32_16x16x32_bf16 v[96:99], a[84:87], a[16:19], v[96:99]
  v_mfma_f32_16x16x32_bf16 v[100:103], a[84:87], a[20:23], v[100:103]
  ds_read_b64_tr_b16 a[66:67], v228 offset:4096
  v_mfma_f32_16x16x32_bf16 v[100:103], a[80:83], a[4:7], v[100:103]
  v_mfma_f32_16x16x32_bf16 v[104:107], a[80:83], a[8:11], v[104:107]
  ds_read_b64_tr_b16 a[68:69], v228 offset:8192
  buffer_load_dwordx4 a[60:63], v231, s[4:7], s75 offen offset:3072 sc1
  v_mfma_f32_16x16x32_bf16 v[104:107], a[84:87], a[24:27], v[104:107]
  s_add_u32 s75, s75, 4096
  buffer_load_dwordx4 a[96:99], v236, s[24:27], s70 offen
  v_mfma_f32_16x16x32_bf16 v[108:111], a[84:87], a[28:31], v[108:111]
  ds_read_b64_tr_b16 a[70:71], v228 offset:12288
  s_add_u32 s70, s70, 1024
  v_mfma_f32_16x16x32_bf16 v[108:111], a[80:83], a[12:15], v[108:111]
  s_waitcnt lgkmcnt(4)
  v_mfma_f32_16x16x32_bf16 v[124:127], a[88:91], a[12:15], v[124:127]
  ds_read_b64_tr_b16 a[72:73], v228 offset:16384
  v_mfma_f32_16x16x32_bf16 v[124:127], a[92:95], a[28:31], v[124:127]
  v_mfma_f32_16x16x32_bf16 v[120:123], a[92:95], a[24:27], v[120:123]
  ds_read_b64_tr_b16 a[74:75], v228 offset:20480
  s_add_u32 m0, s68, 0
  v_mfma_f32_16x16x32_bf16 v[120:123], a[88:91], a[8:11], v[120:123]
  buffer_load_dwordx4 v232, s[16:19], s67 offen offset:0  lds
  v_mfma_f32_16x16x32_bf16 v[116:119], a[88:91], a[4:7], v[116:119]
  ds_read_b64_tr_b16 a[76:77], v228 offset:24576
  v_mfma_f32_16x16x32_bf16 v[116:119], a[92:95], a[20:23], v[116:119]
  v_mfma_f32_16x16x32_bf16 v[112:115], a[92:95], a[16:19], v[112:115]
  ds_read_b64_tr_b16 a[78:79], v228 offset:28672
  v_mfma_f32_16x16x32_bf16 v[112:115], a[88:91], a[0:3], v[112:115]
  s_waitcnt lgkmcnt(4)
  v_mfma_f32_16x16x32_bf16 v[128:131], a[64:67], a[0:3], v[128:131]
  ds_read_b64_tr_b16 a[80:81], v229 offset:0
  v_mfma_f32_16x16x32_bf16 v[128:131], a[68:71], a[16:19], v[128:131]
  v_mfma_f32_16x16x32_bf16 v[132:135], a[68:71], a[20:23], v[132:135]
  ds_read_b64_tr_b16 a[82:83], v229 offset:4096
  buffer_load_dwordx4 v233, s[16:19], s67 offen offset:1024  lds
  v_mfma_f32_16x16x32_bf16 v[132:135], a[64:67], a[4:7], v[132:135]
  v_mfma_f32_16x16x32_bf16 v[136:139], a[64:67], a[8:11], v[136:139]
  ds_read_b64_tr_b16 a[84:85], v229 offset:8192
  v_mfma_f32_16x16x32_bf16 v[136:139], a[68:71], a[24:27], v[136:139]
  v_mfma_f32_16x16x32_bf16 v[140:143], a[68:71], a[28:31], v[140:143]
  ds_read_b64_tr_b16 a[86:87], v229 offset:12288
  v_mfma_f32_16x16x32_bf16 v[140:143], a[64:67], a[12:15], v[140:143]
  s_waitcnt lgkmcnt(4)
  v_mfma_f32_16x16x32_bf16 v[156:159], a[72:75], a[12:15], v[156:159]
  ds_read_b64_tr_b16 a[88:89], v229 offset:16384
  v_mfma_f32_16x16x32_bf16 v[156:159], a[76:79], a[28:31], v[156:159]
  buffer_load_dwordx4 v234, s[16:19], s67 offen offset:2048  lds
  v_mfma_f32_16x16x32_bf16 v[152:155], a[76:79], a[24:27], v[152:155]
  ds_read_b64_tr_b16 a[90:91], v229 offset:20480
  v_mfma_f32_16x16x32_bf16 v[152:155], a[72:75], a[8:11], v[152:155]
  v_mfma_f32_16x16x32_bf16 v[148:151], a[72:75], a[4:7], v[148:151]
  ds_read_b64_tr_b16 a[92:93], v229 offset:24576
  v_mfma_f32_16x16x32_bf16 v[148:151], a[76:79], a[20:23], v[148:151]
  v_mfma_f32_16x16x32_bf16 v[144:147], a[76:79], a[16:19], v[144:147]
  ds_read_b64_tr_b16 a[94:95], v229 offset:28672
  v_mfma_f32_16x16x32_bf16 v[144:147], a[72:75], a[0:3], v[144:147]
  s_waitcnt lgkmcnt(4)
  v_mfma_f32_16x16x32_bf16 v[160:163], a[80:83], a[0:3], v[160:163]
  ds_read_b64_tr_b16 a[64:65], v230 offset:0
  buffer_load_dwordx4 v235, s[16:19], s67 offen offset:3072  lds
  v_mfma_f32_16x16x32_bf16 v[160:163], a[84:87], a[16:19], v[160:163]
  v_mfma_f32_16x16x32_bf16 v[164:167], a[84:87], a[20:23], v[164:167]
  ds_read_b64_tr_b16 a[66:67], v230 offset:4096
  v_mfma_f32_16x16x32_bf16 v[164:167], a[80:83], a[4:7], v[164:167]
  v_mfma_f32_16x16x32_bf16 v[168:171], a[80:83], a[8:11], v[168:171]
  ds_read_b64_tr_b16 a[68:69], v230 offset:8192
  v_mfma_f32_16x16x32_bf16 v[168:171], a[84:87], a[24:27], v[168:171]
  v_mfma_f32_16x16x32_bf16 v[172:175], a[84:87], a[28:31], v[172:175]
  ds_read_b64_tr_b16 a[70:71], v230 offset:12288
  s_add_u32 m0, s68, 16384
  v_mfma_f32_16x16x32_bf16 v[172:175], a[80:83], a[12:15], v[172:175]
  buffer_load_dwordx4 v232, s[20:23], s67 offen offset:0  lds
  s_waitcnt lgkmcnt(4)
  v_mfma_f32_16x16x32_bf16 v[188:191], a[88:91], a[12:15], v[188:191]
  ds_read_b64_tr_b16 a[72:73], v230 offset:16384
  v_mfma_f32_16x16x32_bf16 v[188:191], a[92:95], a[28:31], v[188:191]
  v_mfma_f32_16x16x32_bf16 v[184:187], a[92:95], a[24:27], v[184:187]
  ds_read_b64_tr_b16 a[74:75], v230 offset:20480
  v_mfma_f32_16x16x32_bf16 v[184:187], a[88:91], a[8:11], v[184:187]
  v_mfma_f32_16x16x32_bf16 v[180:183], a[88:91], a[4:7], v[180:183]
  ds_read_b64_tr_b16 a[76:77], v230 offset:24576
  v_mfma_f32_16x16x32_bf16 v[180:183], a[92:95], a[20:23], v[180:183]
  v_mfma_f32_16x16x32_bf16 v[176:179], a[92:95], a[16:19], v[176:179]
  ds_read_b64_tr_b16 a[78:79], v230 offset:28672
  buffer_load_dwordx4 v233, s[20:23], s67 offen offset:1024  lds
  v_mfma_f32_16x16x32_bf16 v[176:179], a[88:91], a[0:3], v[176:179]
  s_waitcnt lgkmcnt(4)
  v_mfma_f32_16x16x32_bf16 v[192:195], a[64:67], a[0:3], v[192:195]
  s_waitcnt vmcnt(15)
  s_barrier
  ds_read_b64_tr_b16 a[80:81], v224 offset:32768
  v_mfma_f32_16x16x32_bf16 v[192:195], a[68:71], a[16:19], v[192:195]
  v_mfma_f32_16x16x32_bf16 v[196:199], a[68:71], a[20:23], v[196:199]
  ds_read_b64_tr_b16 a[82:83], v224 offset:36864
  v_mfma_f32_16x16x32_bf16 v[196:199], a[64:67], a[4:7], v[196:199]
  v_mfma_f32_16x16x32_bf16 v[200:203], a[64:67], a[8:11], v[200:203]
  ds_read_b64_tr_b16 a[84:85], v224 offset:40960
  v_mfma_f32_16x16x32_bf16 v[200:203], a[68:71], a[24:27], v[200:203]
  buffer_load_dwordx4 v234, s[20:23], s67 offen offset:2048  lds
  v_mfma_f32_16x16x32_bf16 v[204:207], a[68:71], a[28:31], v[204:207]
  ds_read_b64_tr_b16 a[86:87], v224 offset:45056
  v_mfma_f32_16x16x32_bf16 v[204:207], a[64:67], a[12:15], v[204:207]
  s_waitcnt lgkmcnt(4)
  v_mfma_f32_16x16x32_bf16 v[220:223], a[72:75], a[12:15], v[220:223]
  ds_read_b64_tr_b16 a[88:89], v224 offset:49152
  v_mfma_f32_16x16x32_bf16 v[220:223], a[76:79], a[28:31], v[220:223]
  v_mfma_f32_16x16x32_bf16 v[216:219], a[76:79], a[24:27], v[216:219]
  ds_read_b64_tr_b16 a[90:91], v224 offset:53248
  v_mfma_f32_16x16x32_bf16 v[216:219], a[72:75], a[8:11], v[216:219]
  v_mfma_f32_16x16x32_bf16 v[212:215], a[72:75], a[4:7], v[212:215]
  ds_read_b64_tr_b16 a[92:93], v224 offset:57344
  buffer_load_dwordx4 v235, s[20:23], s67 offen offset:3072  lds
  v_mfma_f32_16x16x32_bf16 v[212:215], a[76:79], a[20:23], v[212:215]
  s_add_u32 s67, s67, 458752
  v_mfma_f32_16x16x32_bf16 v[208:211], a[76:79], a[16:19], v[208:211]
  ds_read_b64_tr_b16 a[94:95], v224 offset:61440
  v_xor_b32 v224, 0x10000, v224
  v_mfma_f32_16x16x32_bf16 v[208:211], a[72:75], a[0:3], v[208:211]
  s_waitcnt vmcnt(9) lgkmcnt(4)
  v_mfma_f32_16x16x32_bf16 v[0:3], a[80:83], a[32:35], v[0:3]
  ds_read_b64_tr_b16 a[64:65], v225 offset:32768
  v_mfma_f32_16x16x32_bf16 v[0:3], a[84:87], a[48:51], v[0:3]
  v_mfma_f32_16x16x32_bf16 v[4:7], a[84:87], a[52:55], v[4:7]
  ds_read_b64_tr_b16 a[66:67], v225 offset:36864
  v_mfma_f32_16x16x32_bf16 v[4:7], a[80:83], a[36:39], v[4:7]
  buffer_load_dwordx4 a[0:3], v231, s[4:7], s72 offen offset:0 sc1
  v_mfma_f32_16x16x32_bf16 v[8:11], a[80:83], a[40:43], v[8:11]
  ds_read_b64_tr_b16 a[68:69], v225 offset:40960
  v_mfma_f32_16x16x32_bf16 v[8:11], a[84:87], a[56:59], v[8:11]
  v_mfma_f32_16x16x32_bf16 v[12:15], a[84:87], a[60:63], v[12:15]
  ds_read_b64_tr_b16 a[70:71], v225 offset:45056
  v_mfma_f32_16x16x32_bf16 v[12:15], a[80:83], a[44:47], v[12:15]
  s_waitcnt lgkmcnt(4)
  v_mfma_f32_16x16x32_bf16 v[28:31], a[88:91], a[44:47], v[28:31]
  ds_read_b64_tr_b16 a[72:73], v225 offset:49152
  v_mfma_f32_16x16x32_bf16 v[28:31], a[92:95], a[60:63], v[28:31]
  v_mfma_f32_16x16x32_bf16 v[24:27], a[92:95], a[56:59], v[24:27]
  ds_read_b64_tr_b16 a[74:75], v225 offset:53248
  buffer_load_dwordx4 a[16:19], v231, s[4:7], s72 offen offset:1024 sc1
  v_mfma_f32_16x16x32_bf16 v[24:27], a[88:91], a[40:43], v[24:27]
  v_mfma_f32_16x16x32_bf16 v[20:23], a[88:91], a[36:39], v[20:23]
  ds_read_b64_tr_b16 a[76:77], v225 offset:57344
  v_mfma_f32_16x16x32_bf16 v[20:23], a[92:95], a[52:55], v[20:23]
  v_mfma_f32_16x16x32_bf16 v[16:19], a[92:95], a[48:51], v[16:19]
  ds_read_b64_tr_b16 a[78:79], v225 offset:61440
  v_xor_b32 v225, 0x10000, v225
  v_mfma_f32_16x16x32_bf16 v[16:19], a[88:91], a[32:35], v[16:19]
  s_waitcnt lgkmcnt(4)
  v_mfma_f32_16x16x32_bf16 v[32:35], a[64:67], a[32:35], v[32:35]
  ds_read_b64_tr_b16 a[80:81], v226 offset:32768
  v_mfma_f32_16x16x32_bf16 v[32:35], a[68:71], a[48:51], v[32:35]
  buffer_load_dwordx4 a[4:7], v231, s[4:7], s73 offen offset:0 sc1
  v_mfma_f32_16x16x32_bf16 v[36:39], a[68:71], a[52:55], v[36:39]
  ds_read_b64_tr_b16 a[82:83], v226 offset:36864
  v_mfma_f32_16x16x32_bf16 v[36:39], a[64:67], a[36:39], v[36:39]
  v_mfma_f32_16x16x32_bf16 v[40:43], a[64:67], a[40:43], v[40:43]
  ds_read_b64_tr_b16 a[84:85], v226 offset:40960
  v_mfma_f32_16x16x32_bf16 v[40:43], a[68:71], a[56:59], v[40:43]
  v_mfma_f32_16x16x32_bf16 v[44:47], a[68:71], a[60:63], v[44:47]
  ds_read_b64_tr_b16 a[86:87], v226 offset:45056
  v_mfma_f32_16x16x32_bf16 v[44:47], a[64:67], a[44:47], v[44:47]
  s_waitcnt lgkmcnt(4)
  v_mfma_f32_16x16x32_bf16 v[60:63], a[72:75], a[44:47], v[60:63]
  ds_read_b64_tr_b16 a[88:89], v226 offset:49152
  buffer_load_dwordx4 a[20:23], v231, s[4:7], s73 offen offset:1024 sc1
  v_mfma_f32_16x16x32_bf16 v[60:63], a[76:79], a[60:63], v[60:63]
  v_mfma_f32_16x16x32_bf16 v[56:59], a[76:79], a[56:59], v[56:59]
  ds_read_b64_tr_b16 a[90:91], v226 offset:53248
  v_mfma_f32_16x16x32_bf16 v[56:59], a[72:75], a[40:43], v[56:59]
  v_mfma_f32_16x16x32_bf16 v[52:55], a[72:75], a[36:39], v[52:55]
  ds_read_b64_tr_b16 a[92:93], v226 offset:57344
  v_mfma_f32_16x16x32_bf16 v[52:55], a[76:79], a[52:55], v[52:55]
  v_mfma_f32_16x16x32_bf16 v[48:51], a[76:79], a[48:51], v[48:51]
  ds_read_b64_tr_b16 a[94:95], v226 offset:61440
  v_xor_b32 v226, 0x10000, v226
  v_mfma_f32_16x16x32_bf16 v[48:51], a[72:75], a[32:35], v[48:51]
  buffer_load_dwordx4 a[8:11], v231, s[4:7], s74 offen offset:0 sc1
  s_waitcnt lgkmcnt(4)
  v_mfma_f32_16x16x32_bf16 v[64:67], a[80:83], a[32:35], v[64:67]
  ds_read_b64_tr_b16 a[64:65], v227 offset:32768
  v_mfma_f32_16x16x32_bf16 v[64:67], a[84:87], a[48:51], v[64:67]
  v_mfma_f32_16x16x32_bf16 v[68:71], a[84:87], a[52:55], v[68:71]
  ds_read_b64_tr_b16 a[66:67], v227 offset:36864
  v_mfma_f32_16x16x32_bf16 v[68:71], a[80:83], a[36:39], v[68:71]
  v_mfma_f32_16x16x32_bf16 v[72:75], a[80:83], a[40:43], v[72:75]
  ds_read_b64_tr_b16 a[68:69], v227 offset:40960
  v_mfma_f32_16x16x32_bf16 v[72:75], a[84:87], a[56:59], v[72:75]
  v_mfma_f32_16x16x32_bf16 v[76:79], a[84:87], a[60:63], v[76:79]
  ds_read_b64_tr_b16 a[70:71], v227 offset:45056
  buffer_load_dwordx4 a[24:27], v231, s[4:7], s74 offen offset:1024 sc1
  v_mfma_f32_16x16x32_bf16 v[76:79], a[80:83], a[44:47], v[76:79]
  s_waitcnt lgkmcnt(4)
  v_mfma_f32_16x16x32_bf16 v[92:95], a[88:91], a[44:47], v[92:95]
  ds_read_b64_tr_b16 a[72:73], v227 offset:49152
  v_mfma_f32_16x16x32_bf16 v[92:95], a[92:95], a[60:63], v[92:95]
  v_mfma_f32_16x16x32_bf16 v[88:91], a[92:95], a[56:59], v[88:91]
  ds_read_b64_tr_b16 a[74:75], v227 offset:53248
  v_mfma_f32_16x16x32_bf16 v[88:91], a[88:91], a[40:43], v[88:91]
  v_mfma_f32_16x16x32_bf16 v[84:87], a[88:91], a[36:39], v[84:87]
  ds_read_b64_tr_b16 a[76:77], v227 offset:57344
  v_mfma_f32_16x16x32_bf16 v[84:87], a[92:95], a[52:55], v[84:87]
  buffer_load_dwordx4 a[12:15], v231, s[4:7], s75 offen offset:0 sc1
  v_mfma_f32_16x16x32_bf16 v[80:83], a[92:95], a[48:51], v[80:83]
  ds_read_b64_tr_b16 a[78:79], v227 offset:61440
  v_xor_b32 v227, 0x10000, v227
  v_mfma_f32_16x16x32_bf16 v[80:83], a[88:91], a[32:35], v[80:83]
  s_waitcnt lgkmcnt(4)
  v_mfma_f32_16x16x32_bf16 v[96:99], a[64:67], a[32:35], v[96:99]
  ds_read_b64_tr_b16 a[80:81], v228 offset:32768
  v_mfma_f32_16x16x32_bf16 v[96:99], a[68:71], a[48:51], v[96:99]
  v_mfma_f32_16x16x32_bf16 v[100:103], a[68:71], a[52:55], v[100:103]
  ds_read_b64_tr_b16 a[82:83], v228 offset:36864
  v_mfma_f32_16x16x32_bf16 v[100:103], a[64:67], a[36:39], v[100:103]
  v_mfma_f32_16x16x32_bf16 v[104:107], a[64:67], a[40:43], v[104:107]
  ds_read_b64_tr_b16 a[84:85], v228 offset:40960
  buffer_load_dwordx4 a[28:31], v231, s[4:7], s75 offen offset:1024 sc1
  v_mfma_f32_16x16x32_bf16 v[104:107], a[68:71], a[56:59], v[104:107]
  v_mfma_f32_16x16x32_bf16 v[108:111], a[68:71], a[60:63], v[108:111]
  ds_read_b64_tr_b16 a[86:87], v228 offset:45056
  v_mfma_f32_16x16x32_bf16 v[108:111], a[64:67], a[44:47], v[108:111]
  s_waitcnt lgkmcnt(4)
  v_mfma_f32_16x16x32_bf16 v[124:127], a[72:75], a[44:47], v[124:127]
  ds_read_b64_tr_b16 a[88:89], v228 offset:49152
  v_mfma_f32_16x16x32_bf16 v[124:127], a[76:79], a[60:63], v[124:127]
  v_mfma_f32_16x16x32_bf16 v[120:123], a[76:79], a[56:59], v[120:123]
  ds_read_b64_tr_b16 a[90:91], v228 offset:53248
  s_add_u32 m0, s68, 32768
  v_mfma_f32_16x16x32_bf16 v[120:123], a[72:75], a[40:43], v[120:123]
  buffer_load_dwordx4 v232, s[16:19], s67 offen offset:0  lds
  v_mfma_f32_16x16x32_bf16 v[116:119], a[72:75], a[36:39], v[116:119]
  ds_read_b64_tr_b16 a[92:93], v228 offset:57344
  v_mfma_f32_16x16x32_bf16 v[116:119], a[76:79], a[52:55], v[116:119]
  v_mfma_f32_16x16x32_bf16 v[112:115], a[76:79], a[48:51], v[112:115]
  ds_read_b64_tr_b16 a[94:95], v228 offset:61440
  v_xor_b32 v228, 0x10000, v228
  v_mfma_f32_16x16x32_bf16 v[112:115], a[72:75], a[32:35], v[112:115]
  s_waitcnt lgkmcnt(4)
  v_mfma_f32_16x16x32_bf16 v[128:131], a[80:83], a[32:35], v[128:131]
  ds_read_b64_tr_b16 a[64:65], v229 offset:32768
  v_mfma_f32_16x16x32_bf16 v[128:131], a[84:87], a[48:51], v[128:131]
  v_mfma_f32_16x16x32_bf16 v[132:135], a[84:87], a[52:55], v[132:135]
  ds_read_b64_tr_b16 a[66:67], v229 offset:36864
  buffer_load_dwordx4 v233, s[16:19], s67 offen offset:1024  lds
  v_mfma_f32_16x16x32_bf16 v[132:135], a[80:83], a[36:39], v[132:135]
  v_mfma_f32_16x16x32_bf16 v[136:139], a[80:83], a[40:43], v[136:139]
  ds_read_b64_tr_b16 a[68:69], v229 offset:40960
  v_mfma_f32_16x16x32_bf16 v[136:139], a[84:87], a[56:59], v[136:139]
  v_mfma_f32_16x16x32_bf16 v[140:143], a[84:87], a[60:63], v[140:143]
  ds_read_b64_tr_b16 a[70:71], v229 offset:45056
  v_mfma_f32_16x16x32_bf16 v[140:143], a[80:83], a[44:47], v[140:143]
  s_waitcnt lgkmcnt(4)
  v_mfma_f32_16x16x32_bf16 v[156:159], a[88:91], a[44:47], v[156:159]
  ds_read_b64_tr_b16 a[72:73], v229 offset:49152
  v_mfma_f32_16x16x32_bf16 v[156:159], a[92:95], a[60:63], v[156:159]
  buffer_load_dwordx4 v234, s[16:19], s67 offen offset:2048  lds
  v_mfma_f32_16x16x32_bf16 v[152:155], a[92:95], a[56:59], v[152:155]
  ds_read_b64_tr_b16 a[74:75], v229 offset:53248
  v_mfma_f32_16x16x32_bf16 v[152:155], a[88:91], a[40:43], v[152:155]
  v_mfma_f32_16x16x32_bf16 v[148:151], a[88:91], a[36:39], v[148:151]
  ds_read_b64_tr_b16 a[76:77], v229 offset:57344
  v_mfma_f32_16x16x32_bf16 v[148:151], a[92:95], a[52:55], v[148:151]
  v_mfma_f32_16x16x32_bf16 v[144:147], a[92:95], a[48:51], v[144:147]
  ds_read_b64_tr_b16 a[78:79], v229 offset:61440
  v_xor_b32 v229, 0x10000, v229
  v_mfma_f32_16x16x32_bf16 v[144:147], a[88:91], a[32:35], v[144:147]
  s_waitcnt lgkmcnt(4)
  v_mfma_f32_16x16x32_bf16 v[160:163], a[64:67], a[32:35], v[160:163]
  ds_read_b64_tr_b16 a[80:81], v230 offset:32768
  buffer_load_dwordx4 v235, s[16:19], s67 offen offset:3072  lds
  v_mfma_f32_16x16x32_bf16 v[160:163], a[68:71], a[48:51], v[160:163]
  v_mfma_f32_16x16x32_bf16 v[164:167], a[68:71], a[52:55], v[164:167]
  ds_read_b64_tr_b16 a[82:83], v230 offset:36864
  v_mfma_f32_16x16x32_bf16 v[164:167], a[64:67], a[36:39], v[164:167]
  v_mfma_f32_16x16x32_bf16 v[168:171], a[64:67], a[40:43], v[168:171]
  ds_read_b64_tr_b16 a[84:85], v230 offset:40960
  v_mfma_f32_16x16x32_bf16 v[168:171], a[68:71], a[56:59], v[168:171]
  v_mfma_f32_16x16x32_bf16 v[172:175], a[68:71], a[60:63], v[172:175]
  ds_read_b64_tr_b16 a[86:87], v230 offset:45056
  s_add_u32 m0, s68, 49152
  v_mfma_f32_16x16x32_bf16 v[172:175], a[64:67], a[44:47], v[172:175]
  buffer_load_dwordx4 v232, s[20:23], s67 offen offset:0  lds
  s_waitcnt lgkmcnt(4)
  v_mfma_f32_16x16x32_bf16 v[188:191], a[72:75], a[44:47], v[188:191]
  ds_read_b64_tr_b16 a[88:89], v230 offset:49152
  v_mfma_f32_16x16x32_bf16 v[188:191], a[76:79], a[60:63], v[188:191]
  v_mfma_f32_16x16x32_bf16 v[184:187], a[76:79], a[56:59], v[184:187]
  ds_read_b64_tr_b16 a[90:91], v230 offset:53248
  v_mfma_f32_16x16x32_bf16 v[184:187], a[72:75], a[40:43], v[184:187]
  v_mfma_f32_16x16x32_bf16 v[180:183], a[72:75], a[36:39], v[180:183]
  ds_read_b64_tr_b16 a[92:93], v230 offset:57344
  v_mfma_f32_16x16x32_bf16 v[180:183], a[76:79], a[52:55], v[180:183]
  v_mfma_f32_16x16x32_bf16 v[176:179], a[76:79], a[48:51], v[176:179]
  ds_read_b64_tr_b16 a[94:95], v230 offset:61440
  buffer_load_dwordx4 v233, s[20:23], s67 offen offset:1024  lds
  v_xor_b32 v230, 0x10000, v230
  v_mfma_f32_16x16x32_bf16 v[176:179], a[72:75], a[32:35], v[176:179]
  s_waitcnt lgkmcnt(4)
  v_mfma_f32_16x16x32_bf16 v[192:195], a[80:83], a[32:35], v[192:195]
  s_waitcnt vmcnt(14)
  s_barrier
  ds_read_b64_tr_b16 a[64:65], v224 offset:0
  v_mfma_f32_16x16x32_bf16 v[192:195], a[84:87], a[48:51], v[192:195]
  v_mfma_f32_16x16x32_bf16 v[196:199], a[84:87], a[52:55], v[196:199]
  ds_read_b64_tr_b16 a[66:67], v224 offset:4096
  v_mfma_f32_16x16x32_bf16 v[196:199], a[80:83], a[36:39], v[196:199]
  v_mfma_f32_16x16x32_bf16 v[200:203], a[80:83], a[40:43], v[200:203]
  ds_read_b64_tr_b16 a[68:69], v224 offset:8192
  v_mfma_f32_16x16x32_bf16 v[200:203], a[84:87], a[56:59], v[200:203]
  buffer_load_dwordx4 v234, s[20:23], s67 offen offset:2048  lds
  v_mfma_f32_16x16x32_bf16 v[204:207], a[84:87], a[60:63], v[204:207]
  ds_read_b64_tr_b16 a[70:71], v224 offset:12288
  v_mfma_f32_16x16x32_bf16 v[204:207], a[80:83], a[44:47], v[204:207]
  s_waitcnt lgkmcnt(4)
  v_mfma_f32_16x16x32_bf16 v[220:223], a[88:91], a[44:47], v[220:223]
  ds_read_b64_tr_b16 a[72:73], v224 offset:16384
  v_mfma_f32_16x16x32_bf16 v[220:223], a[92:95], a[60:63], v[220:223]
  v_mfma_f32_16x16x32_bf16 v[216:219], a[92:95], a[56:59], v[216:219]
  ds_read_b64_tr_b16 a[74:75], v224 offset:20480
  v_mfma_f32_16x16x32_bf16 v[216:219], a[88:91], a[40:43], v[216:219]
  v_mfma_f32_16x16x32_bf16 v[212:215], a[88:91], a[36:39], v[212:215]
  ds_read_b64_tr_b16 a[76:77], v224 offset:24576
  buffer_load_dwordx4 v235, s[20:23], s67 offen offset:3072  lds
  v_mfma_f32_16x16x32_bf16 v[212:215], a[92:95], a[52:55], v[212:215]
  s_add_u32 s67, s67, 458752
  s_xor_b32 s68, s68, 0x10000
  v_mfma_f32_16x16x32_bf16 v[208:211], a[92:95], a[48:51], v[208:211]
  ds_read_b64_tr_b16 a[78:79], v224 offset:28672
  v_mfma_f32_16x16x32_bf16 v[208:211], a[88:91], a[32:35], v[208:211]
  s_sub_u32 s56, s56, 1
  s_cmp_lg_u32 s56, 0
  s_cbranch_scc1 Lp3_loop
Lmk_Lp3_loop_tail:
  s_waitcnt vmcnt(8) lgkmcnt(4)
  v_mfma_f32_16x16x32_bf16 v[0:3], a[64:67], a[0:3], v[0:3]
  ds_read_b64_tr_b16 a[80:81], v225 offset:0
  v_add_f32 v242, v242, v246
  v_mfma_f32_16x16x32_bf16 v[0:3], a[68:71], a[16:19], v[0:3]
  v_add_f32 v243, v243, v247
  v_add_f32 v244, v244, v248
  v_mfma_f32_16x16x32_bf16 v[4:7], a[68:71], a[20:23], v[4:7]
  ds_read_b64_tr_b16 a[82:83], v225 offset:4096
  v_add_f32 v245, v245, v249
  v_mfma_f32_16x16x32_bf16 v[4:7], a[64:67], a[4:7], v[4:7]
  buffer_load_dwordx4 a[32:35], v231, s[4:7], s72 offen offset:2048 sc1
  ds_write_b128 v250, v[242:245]
  v_mfma_f32_16x16x32_bf16 v[8:11], a[64:67], a[8:11], v[8:11]
  ds_read_b64_tr_b16 a[84:85], v225 offset:8192
  v_mfma_f32_16x16x32_bf16 v[8:11], a[68:71], a[24:27], v[8:11]
  v_mfma_f32_16x16x32_bf16 v[12:15], a[68:71], a[28:31], v[12:15]
  ds_read_b64_tr_b16 a[86:87], v225 offset:12288
  v_mfma_f32_16x16x32_bf16 v[12:15], a[64:67], a[12:15], v[12:15]
  buffer_load_dwordx4 a[48:51], v231, s[4:7], s72 offen offset:3072 sc1
  s_waitcnt lgkmcnt(5)
  v_mfma_f32_16x16x32_bf16 v[28:31], a[72:75], a[12:15], v[28:31]
  s_add_u32 s72, s72, 4096
  ds_read_b64_tr_b16 a[88:89], v225 offset:16384
  v_mfma_f32_16x16x32_bf16 v[28:31], a[76:79], a[28:31], v[28:31]
  ds_read_b128 v[246:249], v237 offset:384
  v_mfma_f32_16x16x32_bf16 v[24:27], a[76:79], a[24:27], v[24:27]
  ds_read_b64_tr_b16 a[90:91], v225 offset:20480
  v_mfma_f32_16x16x32_bf16 v[24:27], a[72:75], a[8:11], v[24:27]
  v_mfma_f32_16x16x32_bf16 v[20:23], a[72:75], a[4:7], v[20:23]
  ds_read_b64_tr_b16 a[92:93], v225 offset:24576
  v_mfma_f32_16x16x32_bf16 v[20:23], a[76:79], a[20:23], v[20:23]
  buffer_load_dwordx4 a[36:39], v231, s[4:7], s73 offen offset:2048 sc1
  v_mfma_f32_16x16x32_bf16 v[16:19], a[76:79], a[16:19], v[16:19]
  ds_read_b64_tr_b16 a[94:95], v225 offset:28672
  v_mfma_f32_16x16x32_bf16 v[16:19], a[72:75], a[0:3], v[16:19]
  s_waitcnt lgkmcnt(5)
  v_mfma_f32_16x16x32_bf16 v[32:35], a[80:83], a[0:3], v[32:35]
  s_waitcnt lgkmcnt(3)
  ds_read_b64_tr_b16 a[64:65], v226 offset:0
  v_fmac_f32 v96, v246, v238
  v_mfma_f32_16x16x32_bf16 v[32:35], a[84:87], a[16:19], v[32:35]
  buffer_load_dwordx4 a[52:55], v231, s[4:7], s73 offen offset:3072 sc1
  ds_read_b128 v[242:245], v237 offset:0
  v_mfma_f32_16x16x32_bf16 v[36:39], a[84:87], a[20:23], v[36:39]
  s_add_u32 s73, s73, 4096
  ds_read_b64_tr_b16 a[66:67], v226 offset:4096
  v_fmac_f32 v97, v247, v238
  v_mfma_f32_16x16x32_bf16 v[36:39], a[80:83], a[4:7], v[36:39]
  v_fmac_f32 v98, v248, v238
  v_fmac_f32 v99, v249, v238
  v_mfma_f32_16x16x32_bf16 v[40:43], a[80:83], a[8:11], v[40:43]
  s_xor_b32 s93, s53, 1
  ds_read_b64_tr_b16 a[68:69], v226 offset:8192
  v_fmac_f32 v100, v246, v239
  v_mfma_f32_16x16x32_bf16 v[40:43], a[84:87], a[24:27], v[40:43]
  s_lshl_b32 s93, s93, 7
  v_fmac_f32 v101, v247, v239
  v_fmac_f32 v102, v248, v239
  v_mfma_f32_16x16x32_bf16 v[44:47], a[84:87], a[28:31], v[44:47]
  s_add_u32 s80, s24, s93
  s_addc_u32 s81, s25, 0
  ds_read_b64_tr_b16 a[70:71], v226 offset:12288
  v_fmac_f32 v103, v249, v239
  v_mfma_f32_16x16x32_bf16 v[44:47], a[80:83], a[12:15], v[44:47]
  s_sub_u32 s82, 7340032, s93
  buffer_load_dwordx4 a[40:43], v231, s[4:7], s74 offen offset:2048 sc1
  v_fmac_f32 v104, v246, v240
  s_waitcnt lgkmcnt(5)
  v_mfma_f32_16x16x32_bf16 v[60:63], a[88:91], a[12:15], v[60:63]
  s_mov_b32 s83, 0x20000
  ds_read_b64_tr_b16 a[72:73], v226 offset:16384
  v_fmac_f32 v105, v247, v240
  v_mfma_f32_16x16x32_bf16 v[60:63], a[92:95], a[28:31], v[60:63]
  s_lshl_b32 s93, s53, 7
  v_fmac_f32 v106, v248, v240
  v_fmac_f32 v107, v249, v240
  v_mfma_f32_16x16x32_bf16 v[56:59], a[92:95], a[24:27], v[56:59]
  s_add_u32 s84, s24, s93
  s_addc_u32 s85, s25, 0
  ds_read_b64_tr_b16 a[74:75], v226 offset:20480
  v_fmac_f32 v108, v246, v241
  v_mfma_f32_16x16x32_bf16 v[56:59], a[88:91], a[8:11], v[56:59]
  s_sub_u32 s84, s84, 1024
  s_subb_u32 s85, s85, 0
  buffer_load_dwordx4 a[56:59], v231, s[4:7], s74 offen offset:3072 sc1
  v_fmac_f32 v109, v247, v241
  v_mfma_f32_16x16x32_bf16 v[52:55], a[88:91], a[4:7], v[52:55]
  s_add_u32 s74, s74, 4096
  ds_read_b64_tr_b16 a[76:77], v226 offset:24576
  v_fmac_f32 v110, v248, v241
  v_mfma_f32_16x16x32_bf16 v[52:55], a[92:95], a[20:23], v[52:55]
  s_sub_u32 s86, 7341056, s93
  v_fmac_f32 v111, v249, v241
  v_mfma_f32_16x16x32_bf16 v[48:51], a[92:95], a[16:19], v[48:51]
  s_mov_b32 s87, 0x20000
  ds_read_b64_tr_b16 a[78:79], v226 offset:28672
  v_mfma_f32_16x16x32_bf16 v[48:51], a[88:91], a[0:3], v[48:51]
  s_and_b32 s93, s53, 1
  s_waitcnt lgkmcnt(4)
  v_mfma_f32_16x16x32_bf16 v[64:67], a[64:67], a[0:3], v[64:67]
  ds_read_b64_tr_b16 a[80:81], v227 offset:0
  v_fmac_f32 v0, v242, v238
  v_mfma_f32_16x16x32_bf16 v[64:67], a[68:71], a[16:19], v[64:67]
  s_mul_i32 s92, s93, 3670016
  buffer_load_dwordx4 a[44:47], v231, s[4:7], s75 offen offset:2048 sc1
  ds_read_b128 v[246:249], v237 offset:64
  v_mfma_f32_16x16x32_bf16 v[68:71], a[68:71], a[20:23], v[68:71]
  s_lshl_b32 s93, s40, 14
  ds_read_b64_tr_b16 a[82:83], v227 offset:4096
  v_fmac_f32 v1, v243, v238
  v_mfma_f32_16x16x32_bf16 v[68:71], a[64:67], a[4:7], v[68:71]
  s_add_u32 s92, s92, s93
  v_fmac_f32 v2, v244, v238
  v_fmac_f32 v3, v245, v238
  v_mfma_f32_16x16x32_bf16 v[72:75], a[64:67], a[8:11], v[72:75]
  s_lshl_b32 s79, s40, 11
  ds_read_b64_tr_b16 a[84:85], v227 offset:8192
  v_fmac_f32 v4, v242, v239
  v_mfma_f32_16x16x32_bf16 v[72:75], a[68:71], a[24:27], v[72:75]
  s_cmp_eq_u32 s40, 1
  s_cselect_b32 s78, 16384, 0
  buffer_load_dwordx4 a[60:63], v231, s[4:7], s75 offen offset:3072 sc1
  v_fmac_f32 v5, v243, v239
  v_mfma_f32_16x16x32_bf16 v[76:79], a[68:71], a[28:31], v[76:79]
  s_add_u32 s75, s75, 4096
  ds_read_b64_tr_b16 a[86:87], v227 offset:12288
  v_fmac_f32 v6, v244, v239
  v_mfma_f32_16x16x32_bf16 v[76:79], a[64:67], a[12:15], v[76:79]
  s_cmp_eq_u32 s40, 2
  s_cselect_b32 s78, -16384, s78
  v_fmac_f32 v7, v245, v239
  v_fmac_f32 v8, v242, v240
  s_waitcnt lgkmcnt(5)
  v_mfma_f32_16x16x32_bf16 v[92:95], a[72:75], a[12:15], v[92:95]
  s_mul_i32 s43, s69, 458752
  ds_read_b64_tr_b16 a[88:89], v227 offset:16384
  v_fmac_f32 v9, v243, v240
  v_mfma_f32_16x16x32_bf16 v[92:95], a[76:79], a[28:31], v[92:95]
  s_lshr_b32 s45, s55, 4
  v_fmac_f32 v10, v244, v240
  v_fmac_f32 v11, v245, v240
  v_mfma_f32_16x16x32_bf16 v[88:91], a[76:79], a[24:27], v[88:91]
  s_add_u32 m0, s68, 0
  ds_read_b64_tr_b16 a[90:91], v227 offset:20480
  v_fmac_f32 v12, v242, v241
  v_mfma_f32_16x16x32_bf16 v[88:91], a[72:75], a[8:11], v[88:91]
  s_mul_i32 s45, s45, 57344
  buffer_load_dwordx4 v232, s[16:19], s67 offen offset:0  lds
  v_fmac_f32 v13, v243, v241
  v_mfma_f32_16x16x32_bf16 v[84:87], a[72:75], a[4:7], v[84:87]
  s_add_u32 s43, s43, s45
  ds_read_b64_tr_b16 a[92:93], v227 offset:24576
  v_fmac_f32 v14, v244, v241
  v_mfma_f32_16x16x32_bf16 v[84:87], a[76:79], a[20:23], v[84:87]
  s_add_u32 s43, s43, 0
  v_fmac_f32 v15, v245, v241
  v_mfma_f32_16x16x32_bf16 v[80:83], a[76:79], a[16:19], v[80:83]
  s_add_u32 s43, s43, 12582912
  ds_read_b64_tr_b16 a[94:95], v227 offset:28672
  v_mfma_f32_16x16x32_bf16 v[80:83], a[72:75], a[0:3], v[80:83]
  s_and_b32 s44, s55, 15
  buffer_load_dwordx4 v233, s[16:19], s67 offen offset:1024  lds
  s_waitcnt lgkmcnt(4)
  v_mfma_f32_16x16x32_bf16 v[96:99], a[80:83], a[0:3], v[96:99]
  ds_read_b64_tr_b16 a[64:65], v228 offset:0
  v_fmac_f32 v16, v246, v238
  v_mfma_f32_16x16x32_bf16 v[96:99], a[84:87], a[16:19], v[96:99]
  s_lshl_b32 s45, s44, 10
  ds_read_b128 v[242:245], v237 offset:128
  v_fmac_f32 v17, v247, v238
  v_mfma_f32_16x16x32_bf16 v[100:103], a[84:87], a[20:23], v[100:103]
  s_add_u32 s57, s43, s45
  ds_read_b64_tr_b16 a[66:67], v228 offset:4096
  v_fmac_f32 v18, v248, v238
  v_mfma_f32_16x16x32_bf16 v[100:103], a[80:83], a[4:7], v[100:103]
  s_lshl_b32 s45, s44, 9
  v_fmac_f32 v19, v249, v238
  v_fmac_f32 v20, v246, v239
  v_mfma_f32_16x16x32_bf16 v[104:107], a[80:83], a[8:11], v[104:107]
  s_add_u32 s61, s43, s45
  ds_read_b64_tr_b16 a[68:69], v228 offset:8192
  v_fmac_f32 v21, v247, v239
  v_mfma_f32_16x16x32_bf16 v[104:107], a[84:87], a[24:27], v[104:107]
  s_add_u32 s61, s61, 49152
  buffer_load_dwordx4 v234, s[16:19], s67 offen offset:2048  lds
  v_fmac_f32 v22, v248, v239
  v_mfma_f32_16x16x32_bf16 v[108:111], a[84:87], a[28:31], v[108:111]
  s_add_u32 s62, s61, 229376
  ds_read_b64_tr_b16 a[70:71], v228 offset:12288
  v_fmac_f32 v23, v249, v239
  v_mfma_f32_16x16x32_bf16 v[108:111], a[80:83], a[12:15], v[108:111]
  s_add_u32 s58, s57, 114688
  v_fmac_f32 v24, v246, v240
  v_fmac_f32 v25, v247, v240
  s_waitcnt lgkmcnt(5)
  v_mfma_f32_16x16x32_bf16 v[124:127], a[88:91], a[12:15], v[124:127]
  s_add_u32 s59, s58, 114688
  ds_read_b64_tr_b16 a[72:73], v228 offset:16384
  v_fmac_f32 v26, v248, v240
  v_mfma_f32_16x16x32_bf16 v[124:127], a[92:95], a[28:31], v[124:127]
  s_add_u32 s60, s59, 114688
  buffer_load_dwordx4 v235, s[16:19], s67 offen offset:3072  lds
  v_fmac_f32 v27, v249, v240
  v_mfma_f32_16x16x32_bf16 v[120:123], a[92:95], a[24:27], v[120:123]
  s_lshl_b32 s77, s54, 1
  ds_read_b64_tr_b16 a[74:75], v228 offset:20480
  v_fmac_f32 v28, v246, v241
  v_mfma_f32_16x16x32_bf16 v[120:123], a[88:91], a[8:11], v[120:123]
  s_lshr_b32 s43, s55, 4
  v_fmac_f32 v29, v247, v241
  v_fmac_f32 v30, v248, v241
  v_mfma_f32_16x16x32_bf16 v[116:119], a[88:91], a[4:7], v[116:119]
  s_add_u32 s77, s77, s43
  ds_read_b64_tr_b16 a[76:77], v228 offset:24576
  v_fmac_f32 v31, v249, v241
  v_mfma_f32_16x16x32_bf16 v[116:119], a[92:95], a[20:23], v[116:119]
  s_lshl_b32 s77, s77, 7
  v_mfma_f32_16x16x32_bf16 v[112:115], a[92:95], a[16:19], v[112:115]
  s_add_u32 m0, s68, 16384
  ds_read_b64_tr_b16 a[78:79], v228 offset:28672
  v_mfma_f32_16x16x32_bf16 v[112:115], a[88:91], a[0:3], v[112:115]
  s_add_u32 s77, s77, s42
  buffer_load_dwordx4 v232, s[20:23], s67 offen offset:0  lds
  s_waitcnt lgkmcnt(4)
  v_mfma_f32_16x16x32_bf16 v[128:131], a[64:67], a[0:3], v[128:131]
  ds_read_b64_tr_b16 a[80:81], v229 offset:0
  v_fmac_f32 v32, v242, v238
  v_mfma_f32_16x16x32_bf16 v[128:131], a[68:71], a[16:19], v[128:131]
  s_add_u32 s77, s77, 27795456
  ds_read_b128 v[246:249], v237 offset:192
  v_fmac_f32 v33, v243, v238
  v_mfma_f32_16x16x32_bf16 v[132:135], a[68:71], a[20:23], v[132:135]
  s_and_b32 s43, s53, 1
  ds_read_b64_tr_b16 a[82:83], v229 offset:4096
  v_fmac_f32 v34, v244, v238
  v_mfma_f32_16x16x32_bf16 v[132:135], a[64:67], a[4:7], v[132:135]
  s_and_b32 s64, s52, 14
  buffer_load_dwordx4 v233, s[20:23], s67 offen offset:1024  lds
  v_fmac_f32 v35, v245, v238
  v_mfma_f32_16x16x32_bf16 v[136:139], a[64:67], a[8:11], v[136:139]
  s_add_u32 s64, s64, s43
  ds_read_b64_tr_b16 a[84:85], v229 offset:8192
  v_fmac_f32 v36, v242, v239
  v_mfma_f32_16x16x32_bf16 v[136:139], a[68:71], a[24:27], v[136:139]
  s_lshl_b32 s64, s64, 7
  v_fmac_f32 v37, v243, v239
  v_fmac_f32 v38, v244, v239
  v_mfma_f32_16x16x32_bf16 v[140:143], a[68:71], a[28:31], v[140:143]
  s_add_u32 s64, s64, s42
  ds_read_b64_tr_b16 a[86:87], v229 offset:12288
  v_fmac_f32 v39, v245, v239
  v_mfma_f32_16x16x32_bf16 v[140:143], a[64:67], a[12:15], v[140:143]
  s_add_u32 s64, s64, 27795456
  v_fmac_f32 v40, v242, v240
  v_fmac_f32 v41, v243, v240
  s_waitcnt lgkmcnt(5)
  v_mfma_f32_16x16x32_bf16 v[156:159], a[72:75], a[12:15], v[156:159]
  s_lshl_b32 s49, s52, 3
  ds_read_b64_tr_b16 a[88:89], v229 offset:16384
  v_fmac_f32 v42, v244, v240
  v_mfma_f32_16x16x32_bf16 v[156:159], a[76:79], a[28:31], v[156:159]
  s_lshl_b32 s43, s40, 1
  buffer_load_dwordx4 v234, s[20:23], s67 offen offset:2048  lds
  v_fmac_f32 v43, v245, v240
  v_mfma_f32_16x16x32_bf16 v[152:155], a[76:79], a[24:27], v[152:155]
  s_add_u32 s49, s49, s43
  ds_read_b64_tr_b16 a[90:91], v229 offset:20480
  v_fmac_f32 v44, v242, v241
  v_mfma_f32_16x16x32_bf16 v[152:155], a[72:75], a[8:11], v[152:155]
  s_lshl_b32 s76, s49, 15
  v_fmac_f32 v45, v243, v241
  v_fmac_f32 v46, v244, v241
  v_mfma_f32_16x16x32_bf16 v[148:151], a[72:75], a[4:7], v[148:151]
  s_lshl_b32 s43, s53, 11
  ds_read_b64_tr_b16 a[92:93], v229 offset:24576
  v_fmac_f32 v47, v245, v241
  v_mfma_f32_16x16x32_bf16 v[148:151], a[76:79], a[20:23], v[148:151]
  s_add_u32 s76, s76, s43
  buffer_load_dwordx4 v235, s[20:23], s67 offen offset:3072  lds
  v_mfma_f32_16x16x32_bf16 v[144:147], a[76:79], a[16:19], v[144:147]
  s_add_u32 s67, s67, 458752
  ds_read_b64_tr_b16 a[94:95], v229 offset:28672
  v_mfma_f32_16x16x32_bf16 v[144:147], a[72:75], a[0:3], v[144:147]
  s_add_u32 s76, s76, s42
  s_waitcnt lgkmcnt(4)
  v_mfma_f32_16x16x32_bf16 v[160:163], a[80:83], a[0:3], v[160:163]
  ds_read_b64_tr_b16 a[64:65], v230 offset:0
  v_fmac_f32 v48, v246, v238
  v_mfma_f32_16x16x32_bf16 v[160:163], a[84:87], a[16:19], v[160:163]
  s_add_u32 s46, s76, 4194304
  ds_read_b128 v[242:245], v237 offset:256
  v_fmac_f32 v49, v247, v238
  v_mfma_f32_16x16x32_bf16 v[164:167], a[84:87], a[20:23], v[164:167]
  s_add_u32 s47, s46, 32768
  ds_read_b64_tr_b16 a[66:67], v230 offset:4096
  v_fmac_f32 v50, v248, v238
  v_mfma_f32_16x16x32_bf16 v[164:167], a[80:83], a[4:7], v[164:167]
  s_mul_i32 s48, s49, 114688
  buffer_load_dwordx4 a[192:195], v231, s[4:7], s72 offen offset:0 sc1
  v_fmac_f32 v51, v249, v238
  v_mfma_f32_16x16x32_bf16 v[168:171], a[80:83], a[8:11], v[168:171]
  s_and_b32 s43, s53, 1
  ds_read_b64_tr_b16 a[68:69], v230 offset:8192
  v_fmac_f32 v52, v246, v239
  v_mfma_f32_16x16x32_bf16 v[168:171], a[84:87], a[24:27], v[168:171]
  s_mul_i32 s44, s43, 57344
  v_fmac_f32 v53, v247, v239
  v_fmac_f32 v54, v248, v239
  v_mfma_f32_16x16x32_bf16 v[172:175], a[84:87], a[28:31], v[172:175]
  s_add_u32 s48, s48, s44
  ds_read_b64_tr_b16 a[70:71], v230 offset:12288
  v_fmac_f32 v55, v249, v239
  v_mfma_f32_16x16x32_bf16 v[172:175], a[80:83], a[12:15], v[172:175]
  s_add_u32 s48, s48, 0
  buffer_load_dwordx4 a[208:211], v231, s[4:7], s72 offen offset:1024 sc1
  v_fmac_f32 v56, v246, v240
  s_waitcnt lgkmcnt(5)
  v_mfma_f32_16x16x32_bf16 v[188:191], a[88:91], a[12:15], v[188:191]
  s_add_u32 s48, s48, 12582912
  ds_read_b64_tr_b16 a[72:73], v230 offset:16384
  v_fmac_f32 v57, v247, v240
  v_mfma_f32_16x16x32_bf16 v[188:191], a[92:95], a[28:31], v[188:191]
  v_fmac_f32 v58, v248, v240
  v_fmac_f32 v59, v249, v240
  v_mfma_f32_16x16x32_bf16 v[184:187], a[92:95], a[24:27], v[184:187]
  ds_read_b64_tr_b16 a[74:75], v230 offset:20480
  v_fmac_f32 v60, v246, v241
  v_mfma_f32_16x16x32_bf16 v[184:187], a[88:91], a[8:11], v[184:187]
  v_fmac_f32 v61, v247, v241
  v_fmac_f32 v62, v248, v241
  v_mfma_f32_16x16x32_bf16 v[180:183], a[88:91], a[4:7], v[180:183]
  ds_read_b64_tr_b16 a[76:77], v230 offset:24576
  v_fmac_f32 v63, v249, v241
  v_mfma_f32_16x16x32_bf16 v[180:183], a[92:95], a[20:23], v[180:183]
  buffer_load_dwordx4 a[196:199], v231, s[4:7], s73 offen offset:0 sc1
  v_mfma_f32_16x16x32_bf16 v[176:179], a[92:95], a[16:19], v[176:179]
  ds_read_b64_tr_b16 a[78:79], v230 offset:28672
  v_mfma_f32_16x16x32_bf16 v[176:179], a[88:91], a[0:3], v[176:179]
  s_waitcnt lgkmcnt(4)
  v_mfma_f32_16x16x32_bf16 v[192:195], a[64:67], a[0:3], v[192:195]
  s_waitcnt vmcnt(19)
  s_barrier
  ds_read_b64_tr_b16 a[80:81], v224 offset:32768
  v_mfma_f32_16x16x32_bf16 v[192:195], a[68:71], a[16:19], v[192:195]
  buffer_load_dwordx4 a[212:215], v231, s[4:7], s73 offen offset:1024 sc1
  ds_read_b128 v[246:249], v237 offset:320
  v_mfma_f32_16x16x32_bf16 v[196:199], a[68:71], a[20:23], v[196:199]
  ds_read_b64_tr_b16 a[82:83], v224 offset:36864
  v_fmac_f32 v64, v242, v238
  v_mfma_f32_16x16x32_bf16 v[196:199], a[64:67], a[4:7], v[196:199]
  v_fmac_f32 v65, v243, v238
  v_fmac_f32 v66, v244, v238
  v_mfma_f32_16x16x32_bf16 v[200:203], a[64:67], a[8:11], v[200:203]
  ds_read_b64_tr_b16 a[84:85], v224 offset:40960
  v_fmac_f32 v67, v245, v238
  v_mfma_f32_16x16x32_bf16 v[200:203], a[68:71], a[24:27], v[200:203]
  v_fmac_f32 v68, v242, v239
  v_fmac_f32 v69, v243, v239
  v_mfma_f32_16x16x32_bf16 v[204:207], a[68:71], a[28:31], v[204:207]
  ds_read_b64_tr_b16 a[86:87], v224 offset:45056
  v_fmac_f32 v70, v244, v239
  v_mfma_f32_16x16x32_bf16 v[204:207], a[64:67], a[12:15], v[204:207]
  s_waitcnt lgkmcnt(5)
  buffer_load_dwordx4 a[200:203], v231, s[4:7], s74 offen offset:0 sc1
  v_fmac_f32 v71, v245, v239
  v_mfma_f32_16x16x32_bf16 v[220:223], a[72:75], a[12:15], v[220:223]
  ds_read_b64_tr_b16 a[88:89], v224 offset:49152
  v_fmac_f32 v72, v242, v240
  v_mfma_f32_16x16x32_bf16 v[220:223], a[76:79], a[28:31], v[220:223]
  v_fmac_f32 v73, v243, v240
  v_fmac_f32 v74, v244, v240
  v_mfma_f32_16x16x32_bf16 v[216:219], a[76:79], a[24:27], v[216:219]
  ds_read_b64_tr_b16 a[90:91], v224 offset:53248
  v_fmac_f32 v75, v245, v240
  v_mfma_f32_16x16x32_bf16 v[216:219], a[72:75], a[8:11], v[216:219]
  buffer_load_dwordx4 a[216:219], v231, s[4:7], s74 offen offset:1024 sc1
  v_fmac_f32 v76, v242, v241
  v_mfma_f32_16x16x32_bf16 v[212:215], a[72:75], a[4:7], v[212:215]
  ds_read_b64_tr_b16 a[92:93], v224 offset:57344
  v_fmac_f32 v77, v243, v241
  v_mfma_f32_16x16x32_bf16 v[212:215], a[76:79], a[20:23], v[212:215]
  v_fmac_f32 v78, v244, v241
  v_fmac_f32 v79, v245, v241
  v_mfma_f32_16x16x32_bf16 v[208:211], a[76:79], a[16:19], v[208:211]
  ds_read_b64_tr_b16 a[94:95], v224 offset:61440
  v_xor_b32 v224, 0x10000, v224
  v_mfma_f32_16x16x32_bf16 v[208:211], a[72:75], a[0:3], v[208:211]
  s_waitcnt vmcnt(20) lgkmcnt(4)
  v_mfma_f32_16x16x32_bf16 v[0:3], a[80:83], a[32:35], v[0:3]
  ds_read_b64_tr_b16 a[64:65], v225 offset:32768
  v_fmac_f32 v80, v246, v238
  v_mfma_f32_16x16x32_bf16 v[0:3], a[84:87], a[48:51], v[0:3]
  s_waitcnt vmcnt(18)
  buffer_load_dwordx4 a[204:207], v231, s[4:7], s75 offen offset:0 sc1
  ds_read_b128 v[242:245], v237 offset:448
  v_mfma_f32_16x16x32_bf16 v[4:7], a[84:87], a[52:55], v[4:7]
  ds_read_b64_tr_b16 a[66:67], v225 offset:36864
  v_fmac_f32 v81, v247, v238
  v_mfma_f32_16x16x32_bf16 v[4:7], a[80:83], a[36:39], v[4:7]
  s_waitcnt vmcnt(17)
  v_fmac_f32 v82, v248, v238
  v_fmac_f32 v83, v249, v238
  v_mfma_f32_16x16x32_bf16 v[8:11], a[80:83], a[40:43], v[8:11]
  ds_read_b64_tr_b16 a[68:69], v225 offset:40960
  v_fmac_f32 v84, v246, v239
  v_mfma_f32_16x16x32_bf16 v[8:11], a[84:87], a[56:59], v[8:11]
  s_waitcnt vmcnt(15)
  buffer_load_dwordx4 a[220:223], v231, s[4:7], s75 offen offset:1024 sc1
  v_fmac_f32 v85, v247, v239
  v_mfma_f32_16x16x32_bf16 v[12:15], a[84:87], a[60:63], v[12:15]
  ds_read_b64_tr_b16 a[70:71], v225 offset:45056
  v_fmac_f32 v86, v248, v239
  v_mfma_f32_16x16x32_bf16 v[12:15], a[80:83], a[44:47], v[12:15]
  s_waitcnt lgkmcnt(5)
  v_fmac_f32 v87, v249, v239
  v_fmac_f32 v88, v246, v240
  v_mfma_f32_16x16x32_bf16 v[28:31], a[88:91], a[44:47], v[28:31]
  ds_read_b64_tr_b16 a[72:73], v225 offset:49152
  v_fmac_f32 v89, v247, v240
  v_mfma_f32_16x16x32_bf16 v[28:31], a[92:95], a[60:63], v[28:31]
  v_fmac_f32 v90, v248, v240
  v_fmac_f32 v91, v249, v240
  v_mfma_f32_16x16x32_bf16 v[24:27], a[92:95], a[56:59], v[24:27]
  s_add_u32 m0, s68, 32768
  ds_read_b64_tr_b16 a[74:75], v225 offset:53248
  v_fmac_f32 v92, v246, v241
  v_mfma_f32_16x16x32_bf16 v[24:27], a[88:91], a[40:43], v[24:27]
  buffer_load_dwordx4 v232, s[16:19], s67 offen offset:0  lds
  v_fmac_f32 v93, v247, v241
  v_mfma_f32_16x16x32_bf16 v[20:23], a[88:91], a[36:39], v[20:23]
  ds_read_b64_tr_b16 a[76:77], v225 offset:57344
  v_fmac_f32 v94, v248, v241
  v_mfma_f32_16x16x32_bf16 v[20:23], a[92:95], a[52:55], v[20:23]
  v_fmac_f32 v95, v249, v241
  v_mfma_f32_16x16x32_bf16 v[16:19], a[92:95], a[48:51], v[16:19]
  ds_read_b64_tr_b16 a[78:79], v225 offset:61440
  v_xor_b32 v225, 0x10000, v225
  v_mfma_f32_16x16x32_bf16 v[16:19], a[88:91], a[32:35], v[16:19]
  buffer_load_dwordx4 v233, s[16:19], s67 offen offset:1024  lds
  s_waitcnt lgkmcnt(4)
  v_mfma_f32_16x16x32_bf16 v[32:35], a[64:67], a[32:35], v[32:35]
  ds_read_b64_tr_b16 a[80:81], v226 offset:32768
  v_fmac_f32 v112, v242, v238
  v_mfma_f32_16x16x32_bf16 v[32:35], a[68:71], a[48:51], v[32:35]
  ds_read_b128 v[246:249], v237 offset:512
  v_fmac_f32 v113, v243, v238
  v_mfma_f32_16x16x32_bf16 v[36:39], a[68:71], a[52:55], v[36:39]
  ds_read_b64_tr_b16 a[82:83], v226 offset:36864
  v_fmac_f32 v114, v244, v238
  v_mfma_f32_16x16x32_bf16 v[36:39], a[64:67], a[36:39], v[36:39]
  v_fmac_f32 v115, v245, v238
  v_fmac_f32 v116, v242, v239
  v_mfma_f32_16x16x32_bf16 v[40:43], a[64:67], a[40:43], v[40:43]
  ds_read_b64_tr_b16 a[84:85], v226 offset:40960
  v_fmac_f32 v117, v243, v239
  v_mfma_f32_16x16x32_bf16 v[40:43], a[68:71], a[56:59], v[40:43]
  buffer_load_dwordx4 v234, s[16:19], s67 offen offset:2048  lds
  v_fmac_f32 v118, v244, v239
  v_mfma_f32_16x16x32_bf16 v[44:47], a[68:71], a[60:63], v[44:47]
  ds_read_b64_tr_b16 a[86:87], v226 offset:45056
  v_fmac_f32 v119, v245, v239
  v_mfma_f32_16x16x32_bf16 v[44:47], a[64:67], a[44:47], v[44:47]
  s_waitcnt lgkmcnt(5)
  v_fmac_f32 v120, v242, v240
  v_fmac_f32 v121, v243, v240
  v_mfma_f32_16x16x32_bf16 v[60:63], a[72:75], a[44:47], v[60:63]
  ds_read_b64_tr_b16 a[88:89], v226 offset:49152
  v_fmac_f32 v122, v244, v240
  v_mfma_f32_16x16x32_bf16 v[60:63], a[76:79], a[60:63], v[60:63]
  buffer_load_dwordx4 v235, s[16:19], s67 offen offset:3072  lds
  v_fmac_f32 v123, v245, v240
  v_mfma_f32_16x16x32_bf16 v[56:59], a[76:79], a[56:59], v[56:59]
  ds_read_b64_tr_b16 a[90:91], v226 offset:53248
  v_fmac_f32 v124, v242, v241
  v_mfma_f32_16x16x32_bf16 v[56:59], a[72:75], a[40:43], v[56:59]
  v_fmac_f32 v125, v243, v241
  v_fmac_f32 v126, v244, v241
  v_mfma_f32_16x16x32_bf16 v[52:55], a[72:75], a[36:39], v[52:55]
  ds_read_b64_tr_b16 a[92:93], v226 offset:57344
  v_fmac_f32 v127, v245, v241
  v_mfma_f32_16x16x32_bf16 v[52:55], a[76:79], a[52:55], v[52:55]
  v_mfma_f32_16x16x32_bf16 v[48:51], a[76:79], a[48:51], v[48:51]
  s_add_u32 m0, s68, 49152
  ds_read_b64_tr_b16 a[94:95], v226 offset:61440
  v_xor_b32 v226, 0x10000, v226
  v_mfma_f32_16x16x32_bf16 v[48:51], a[72:75], a[32:35], v[48:51]
  buffer_load_dwordx4 v232, s[20:23], s67 offen offset:0  lds
  s_waitcnt lgkmcnt(4)
  v_mfma_f32_16x16x32_bf16 v[64:67], a[80:83], a[32:35], v[64:67]
  ds_read_b64_tr_b16 a[64:65], v227 offset:32768
  v_fmac_f32 v128, v246, v238
  v_mfma_f32_16x16x32_bf16 v[64:67], a[84:87], a[48:51], v[64:67]
  ds_read_b128 v[242:245], v237 offset:576
  v_fmac_f32 v129, v247, v238
  v_mfma_f32_16x16x32_bf16 v[68:71], a[84:87], a[52:55], v[68:71]
  ds_read_b64_tr_b16 a[66:67], v227 offset:36864
  v_fmac_f32 v130, v248, v238
  v_mfma_f32_16x16x32_bf16 v[68:71], a[80:83], a[36:39], v[68:71]
  buffer_load_dwordx4 v233, s[20:23], s67 offen offset:1024  lds
  v_fmac_f32 v131, v249, v238
  v_mfma_f32_16x16x32_bf16 v[72:75], a[80:83], a[40:43], v[72:75]
  ds_read_b64_tr_b16 a[68:69], v227 offset:40960
  v_fmac_f32 v132, v246, v239
  v_mfma_f32_16x16x32_bf16 v[72:75], a[84:87], a[56:59], v[72:75]
  v_fmac_f32 v133, v247, v239
  v_fmac_f32 v134, v248, v239
  v_mfma_f32_16x16x32_bf16 v[76:79], a[84:87], a[60:63], v[76:79]
  ds_read_b64_tr_b16 a[70:71], v227 offset:45056
  v_fmac_f32 v135, v249, v239
  v_mfma_f32_16x16x32_bf16 v[76:79], a[80:83], a[44:47], v[76:79]
  s_waitcnt lgkmcnt(5)
  v_fmac_f32 v136, v246, v240
  v_fmac_f32 v137, v247, v240
  v_mfma_f32_16x16x32_bf16 v[92:95], a[88:91], a[44:47], v[92:95]
  ds_read_b64_tr_b16 a[72:73], v227 offset:49152
  v_fmac_f32 v138, v248, v240
  v_mfma_f32_16x16x32_bf16 v[92:95], a[92:95], a[60:63], v[92:95]
  buffer_load_dwordx4 v234, s[20:23], s67 offen offset:2048  lds
  v_fmac_f32 v139, v249, v240
  v_mfma_f32_16x16x32_bf16 v[88:91], a[92:95], a[56:59], v[88:91]
  ds_read_b64_tr_b16 a[74:75], v227 offset:53248
  v_fmac_f32 v140, v246, v241
  v_mfma_f32_16x16x32_bf16 v[88:91], a[88:91], a[40:43], v[88:91]
  v_fmac_f32 v141, v247, v241
  v_fmac_f32 v142, v248, v241
  v_mfma_f32_16x16x32_bf16 v[84:87], a[88:91], a[36:39], v[84:87]
  ds_read_b64_tr_b16 a[76:77], v227 offset:57344
  v_fmac_f32 v143, v249, v241
  v_mfma_f32_16x16x32_bf16 v[84:87], a[92:95], a[52:55], v[84:87]
  buffer_load_dwordx4 v235, s[20:23], s67 offen offset:3072  lds
  v_mfma_f32_16x16x32_bf16 v[80:83], a[92:95], a[48:51], v[80:83]
  s_add_u32 s67, s67, 458752
  s_xor_b32 s68, s68, 0x10000
  ds_read_b64_tr_b16 a[78:79], v227 offset:61440
  v_xor_b32 v227, 0x10000, v227
  v_mfma_f32_16x16x32_bf16 v[80:83], a[88:91], a[32:35], v[80:83]
  s_waitcnt lgkmcnt(4)
  v_mfma_f32_16x16x32_bf16 v[96:99], a[64:67], a[32:35], v[96:99]
  s_waitcnt vmcnt(16)
  s_barrier
  ds_read_b64_tr_b16 a[80:81], v224 offset:0
  v_mfma_f32_16x16x32_bf16 v[96:99], a[68:71], a[48:51], v[96:99]
  ds_read_b128 v[246:249], v237 offset:640
  v_fmac_f32 v144, v242, v238
  v_mfma_f32_16x16x32_bf16 v[100:103], a[68:71], a[52:55], v[100:103]
  ds_read_b64_tr_b16 a[82:83], v224 offset:4096
  v_fmac_f32 v145, v243, v238
  v_mfma_f32_16x16x32_bf16 v[100:103], a[64:67], a[36:39], v[100:103]
  buffer_load_dwordx4 a[224:227], v231, s[4:7], s72 offen offset:2048 sc1
  v_fmac_f32 v146, v244, v238
  v_mfma_f32_16x16x32_bf16 v[104:107], a[64:67], a[40:43], v[104:107]
  ds_read_b64_tr_b16 a[84:85], v224 offset:8192
  v_fmac_f32 v147, v245, v238
  v_mfma_f32_16x16x32_bf16 v[104:107], a[68:71], a[56:59], v[104:107]
  v_fmac_f32 v148, v242, v239
  v_fmac_f32 v149, v243, v239
  v_mfma_f32_16x16x32_bf16 v[108:111], a[68:71], a[60:63], v[108:111]
  ds_read_b64_tr_b16 a[86:87], v224 offset:12288
  v_fmac_f32 v150, v244, v239
  v_mfma_f32_16x16x32_bf16 v[108:111], a[64:67], a[44:47], v[108:111]
  s_waitcnt lgkmcnt(5)
  buffer_load_dwordx4 a[240:243], v231, s[4:7], s72 offen offset:3072 sc1
  v_fmac_f32 v151, v245, v239
  v_mfma_f32_16x16x32_bf16 v[124:127], a[72:75], a[44:47], v[124:127]
  s_add_u32 s72, s72, 4096
  ds_read_b64_tr_b16 a[88:89], v224 offset:16384
  v_fmac_f32 v152, v242, v240
  v_mfma_f32_16x16x32_bf16 v[124:127], a[76:79], a[60:63], v[124:127]
  v_fmac_f32 v153, v243, v240
  v_fmac_f32 v154, v244, v240
  v_mfma_f32_16x16x32_bf16 v[120:123], a[76:79], a[56:59], v[120:123]
  ds_read_b64_tr_b16 a[90:91], v224 offset:20480
  v_fmac_f32 v155, v245, v240
  v_mfma_f32_16x16x32_bf16 v[120:123], a[72:75], a[40:43], v[120:123]
  v_fmac_f32 v156, v242, v241
  v_fmac_f32 v157, v243, v241
  v_mfma_f32_16x16x32_bf16 v[116:119], a[72:75], a[36:39], v[116:119]
  ds_read_b64_tr_b16 a[92:93], v224 offset:24576
  v_fmac_f32 v158, v244, v241
  v_mfma_f32_16x16x32_bf16 v[116:119], a[76:79], a[52:55], v[116:119]
  buffer_load_dwordx4 a[228:231], v231, s[4:7], s73 offen offset:2048 sc1
  v_fmac_f32 v159, v245, v241
  v_mfma_f32_16x16x32_bf16 v[112:115], a[76:79], a[48:51], v[112:115]
  ds_read_b64_tr_b16 a[94:95], v224 offset:28672
  v_mfma_f32_16x16x32_bf16 v[112:115], a[72:75], a[32:35], v[112:115]
  s_waitcnt vmcnt(17) lgkmcnt(4)
  v_mfma_f32_16x16x32_bf16 v[0:3], a[80:83], a[192:195], v[0:3]
  ds_read_b64_tr_b16 a[64:65], v225 offset:0
  v_fmac_f32 v160, v246, v238
  v_mfma_f32_16x16x32_bf16 v[0:3], a[84:87], a[208:211], v[0:3]
  s_waitcnt vmcnt(15)
  buffer_load_dwordx4 a[244:247], v231, s[4:7], s73 offen offset:3072 sc1
  ds_read_b128 v[242:245], v237 offset:704
  v_mfma_f32_16x16x32_bf16 v[4:7], a[84:87], a[212:215], v[4:7]
  s_add_u32 s73, s73, 4096
  ds_read_b64_tr_b16 a[66:67], v225 offset:4096
  v_fmac_f32 v161, v247, v238
  v_mfma_f32_16x16x32_bf16 v[4:7], a[80:83], a[196:199], v[4:7]
  s_waitcnt vmcnt(14)
  v_fmac_f32 v162, v248, v238
  v_fmac_f32 v163, v249, v238
  v_mfma_f32_16x16x32_bf16 v[8:11], a[80:83], a[200:203], v[8:11]
  ds_read_b64_tr_b16 a[68:69], v225 offset:8192
  v_fmac_f32 v164, v246, v239
  v_mfma_f32_16x16x32_bf16 v[8:11], a[84:87], a[216:219], v[8:11]
  s_waitcnt vmcnt(12)
  v_fmac_f32 v165, v247, v239
  v_fmac_f32 v166, v248, v239
  v_mfma_f32_16x16x32_bf16 v[12:15], a[84:87], a[220:223], v[12:15]
  ds_read_b64_tr_b16 a[70:71], v225 offset:12288
  v_fmac_f32 v167, v249, v239
  v_mfma_f32_16x16x32_bf16 v[12:15], a[80:83], a[204:207], v[12:15]
  s_waitcnt lgkmcnt(5)
  buffer_load_dwordx4 a[232:235], v231, s[4:7], s74 offen offset:2048 sc1
  v_fmac_f32 v168, v246, v240
  v_mfma_f32_16x16x32_bf16 v[28:31], a[88:91], a[204:207], v[28:31]
  ds_read_b64_tr_b16 a[72:73], v225 offset:16384
  v_fmac_f32 v169, v247, v240
  v_mfma_f32_16x16x32_bf16 v[28:31], a[92:95], a[220:223], v[28:31]
  v_fmac_f32 v170, v248, v240
  v_fmac_f32 v171, v249, v240
  v_mfma_f32_16x16x32_bf16 v[24:27], a[92:95], a[216:219], v[24:27]
  ds_read_b64_tr_b16 a[74:75], v225 offset:20480
  v_fmac_f32 v172, v246, v241
  v_mfma_f32_16x16x32_bf16 v[24:27], a[88:91], a[200:203], v[24:27]
  buffer_load_dwordx4 a[248:251], v231, s[4:7], s74 offen offset:3072 sc1
  v_fmac_f32 v173, v247, v241
  v_mfma_f32_16x16x32_bf16 v[20:23], a[88:91], a[196:199], v[20:23]
  s_add_u32 s74, s74, 4096
  ds_read_b64_tr_b16 a[76:77], v225 offset:24576
  v_fmac_f32 v174, v248, v241
  v_mfma_f32_16x16x32_bf16 v[20:23], a[92:95], a[212:215], v[20:23]
  v_fmac_f32 v175, v249, v241
  v_mfma_f32_16x16x32_bf16 v[16:19], a[92:95], a[208:211], v[16:19]
  ds_read_b64_tr_b16 a[78:79], v225 offset:28672
  v_mfma_f32_16x16x32_bf16 v[16:19], a[88:91], a[192:195], v[16:19]
  s_waitcnt lgkmcnt(4)
  v_mfma_f32_16x16x32_bf16 v[32:35], a[64:67], a[192:195], v[32:35]
  ds_read_b64_tr_b16 a[80:81], v226 offset:0
  v_fmac_f32 v176, v242, v238
  v_mfma_f32_16x16x32_bf16 v[32:35], a[68:71], a[208:211], v[32:35]
  buffer_load_dwordx4 a[236:239], v231, s[4:7], s75 offen offset:2048 sc1
  ds_read_b128 v[246:249], v237 offset:768
  v_mfma_f32_16x16x32_bf16 v[36:39], a[68:71], a[212:215], v[36:39]
  ds_read_b64_tr_b16 a[82:83], v226 offset:4096
  v_fmac_f32 v177, v243, v238
  v_mfma_f32_16x16x32_bf16 v[36:39], a[64:67], a[196:199], v[36:39]
  v_fmac_f32 v178, v244, v238
  v_fmac_f32 v179, v245, v238
  v_mfma_f32_16x16x32_bf16 v[40:43], a[64:67], a[200:203], v[40:43]
  ds_read_b64_tr_b16 a[84:85], v226 offset:8192
  v_fmac_f32 v180, v242, v239
  v_mfma_f32_16x16x32_bf16 v[40:43], a[68:71], a[216:219], v[40:43]
  buffer_load_dwordx4 a[252:255], v231, s[4:7], s75 offen offset:3072 sc1
  v_fmac_f32 v181, v243, v239
  v_mfma_f32_16x16x32_bf16 v[44:47], a[68:71], a[220:223], v[44:47]
  s_add_u32 s75, s75, 4096
  ds_read_b64_tr_b16 a[86:87], v226 offset:12288
  v_fmac_f32 v182, v244, v239
  v_mfma_f32_16x16x32_bf16 v[44:47], a[64:67], a[204:207], v[44:47]
  s_waitcnt lgkmcnt(5)
  v_fmac_f32 v183, v245, v239
  v_fmac_f32 v184, v242, v240
  v_mfma_f32_16x16x32_bf16 v[60:63], a[72:75], a[204:207], v[60:63]
  ds_read_b64_tr_b16 a[88:89], v226 offset:16384
  v_fmac_f32 v185, v243, v240
  v_mfma_f32_16x16x32_bf16 v[60:63], a[76:79], a[220:223], v[60:63]
  v_fmac_f32 v186, v244, v240
  v_fmac_f32 v187, v245, v240
  v_mfma_f32_16x16x32_bf16 v[56:59], a[76:79], a[216:219], v[56:59]
  ds_read_b64_tr_b16 a[90:91], v226 offset:20480
  v_fmac_f32 v188, v242, v241
  v_mfma_f32_16x16x32_bf16 v[56:59], a[72:75], a[200:203], v[56:59]
  s_add_u32 m0, s79, 0
  v_fmac_f32 v189, v243, v241
  v_fmac_f32 v190, v244, v241
  v_mfma_f32_16x16x32_bf16 v[52:55], a[72:75], a[196:199], v[52:55]
  s_add_u32 s92, s92, 0
  ds_read_b64_tr_b16 a[92:93], v226 offset:24576
  v_fmac_f32 v191, v245, v241
  v_mfma_f32_16x16x32_bf16 v[52:55], a[76:79], a[212:215], v[52:55]
  buffer_load_dwordx4 v252, s[80:83], s92 offen lds
  v_mfma_f32_16x16x32_bf16 v[48:51], a[76:79], a[208:211], v[48:51]
  ds_read_b64_tr_b16 a[94:95], v226 offset:28672
  v_mfma_f32_16x16x32_bf16 v[48:51], a[72:75], a[192:195], v[48:51]
  s_waitcnt lgkmcnt(4)
  v_mfma_f32_16x16x32_bf16 v[64:67], a[80:83], a[192:195], v[64:67]
  ds_read_b64_tr_b16 a[64:65], v228 offset:32768
  v_fmac_f32 v192, v246, v238
  v_mfma_f32_16x16x32_bf16 v[64:67], a[84:87], a[208:211], v[64:67]
  ds_read_b128 v[242:245], v237 offset:832
  v_fmac_f32 v193, v247, v238
  v_mfma_f32_16x16x32_bf16 v[68:71], a[84:87], a[212:215], v[68:71]
  ds_read_b64_tr_b16 a[66:67], v228 offset:36864
  v_fmac_f32 v194, v248, v238
  v_mfma_f32_16x16x32_bf16 v[68:71], a[80:83], a[196:199], v[68:71]
  buffer_load_dwordx4 v252, s[84:87], s92 offen offset:1024 lds
  v_fmac_f32 v195, v249, v238
  v_fmac_f32 v196, v246, v239
  v_mfma_f32_16x16x32_bf16 v[72:75], a[80:83], a[200:203], v[72:75]
  ds_read_b64_tr_b16 a[68:69], v228 offset:40960
  v_fmac_f32 v197, v247, v239
  v_mfma_f32_16x16x32_bf16 v[72:75], a[84:87], a[216:219], v[72:75]
  v_fmac_f32 v198, v248, v239
  v_fmac_f32 v199, v249, v239
  v_mfma_f32_16x16x32_bf16 v[76:79], a[84:87], a[220:223], v[76:79]
  ds_read_b64_tr_b16 a[70:71], v228 offset:45056
  v_fmac_f32 v200, v246, v240
  v_mfma_f32_16x16x32_bf16 v[76:79], a[80:83], a[204:207], v[76:79]
  s_add_u32 m0, s79, 8192
  v_fmac_f32 v201, v247, v240
  v_fmac_f32 v202, v248, v240
  s_waitcnt lgkmcnt(5)
  v_mfma_f32_16x16x32_bf16 v[92:95], a[88:91], a[204:207], v[92:95]
  s_add_u32 s92, s92, 262144
  ds_read_b64_tr_b16 a[72:73], v228 offset:49152
  v_fmac_f32 v203, v249, v240
  v_mfma_f32_16x16x32_bf16 v[92:95], a[92:95], a[220:223], v[92:95]
  buffer_load_dwordx4 v252, s[80:83], s92 offen lds
  v_fmac_f32 v204, v246, v241
  v_fmac_f32 v205, v247, v241
  v_mfma_f32_16x16x32_bf16 v[88:91], a[92:95], a[216:219], v[88:91]
  ds_read_b64_tr_b16 a[74:75], v228 offset:53248
  v_fmac_f32 v206, v248, v241
  v_mfma_f32_16x16x32_bf16 v[88:91], a[88:91], a[200:203], v[88:91]
  v_fmac_f32 v207, v249, v241
  v_mfma_f32_16x16x32_bf16 v[84:87], a[88:91], a[196:199], v[84:87]
  ds_read_b64_tr_b16 a[76:77], v228 offset:57344
  v_mfma_f32_16x16x32_bf16 v[84:87], a[92:95], a[212:215], v[84:87]
  v_mfma_f32_16x16x32_bf16 v[80:83], a[92:95], a[208:211], v[80:83]
  ds_read_b64_tr_b16 a[78:79], v228 offset:61440
  v_xor_b32 v228, 0x10000, v228
  v_mfma_f32_16x16x32_bf16 v[80:83], a[88:91], a[192:195], v[80:83]
  buffer_load_dwordx4 v252, s[84:87], s92 offen offset:1024 lds
  s_waitcnt lgkmcnt(4)
  v_mfma_f32_16x16x32_bf16 v[128:131], a[64:67], a[32:35], v[128:131]
  s_waitcnt vmcnt(12)
  s_barrier
  ds_read_b64_tr_b16 a[80:81], v224 offset:32768
  v_mfma_f32_16x16x32_bf16 v[128:131], a[68:71], a[48:51], v[128:131]
  v_fmac_f32 v208, v242, v238
  v_fmac_f32 v209, v243, v238
  v_mfma_f32_16x16x32_bf16 v[132:135], a[68:71], a[52:55], v[132:135]
  ds_read_b64_tr_b16 a[82:83], v224 offset:36864
  v_fmac_f32 v210, v244, v238
  v_mfma_f32_16x16x32_bf16 v[132:135], a[64:67], a[36:39], v[132:135]
  s_add_u32 m0, s79, 16384
  v_fmac_f32 v211, v245, v238
  v_fmac_f32 v212, v242, v239
  v_mfma_f32_16x16x32_bf16 v[136:139], a[64:67], a[40:43], v[136:139]
  s_add_u32 s92, s92, 196608
  ds_read_b64_tr_b16 a[84:85], v224 offset:40960
  v_fmac_f32 v213, v243, v239
  v_mfma_f32_16x16x32_bf16 v[136:139], a[68:71], a[56:59], v[136:139]
  buffer_load_dwordx4 v252, s[80:83], s92 offen lds
  v_fmac_f32 v214, v244, v239
  v_fmac_f32 v215, v245, v239
  v_mfma_f32_16x16x32_bf16 v[140:143], a[68:71], a[60:63], v[140:143]
  ds_read_b64_tr_b16 a[86:87], v224 offset:45056
  v_fmac_f32 v216, v242, v240
  v_mfma_f32_16x16x32_bf16 v[140:143], a[64:67], a[44:47], v[140:143]
  s_waitcnt lgkmcnt(4)
  v_fmac_f32 v217, v243, v240
  v_fmac_f32 v218, v244, v240
  v_mfma_f32_16x16x32_bf16 v[156:159], a[72:75], a[44:47], v[156:159]
  ds_read_b64_tr_b16 a[88:89], v224 offset:49152
  v_fmac_f32 v219, v245, v240
  v_mfma_f32_16x16x32_bf16 v[156:159], a[76:79], a[60:63], v[156:159]
  v_fmac_f32 v220, v242, v241
  v_fmac_f32 v221, v243, v241
  v_mfma_f32_16x16x32_bf16 v[152:155], a[76:79], a[56:59], v[152:155]
  ds_read_b64_tr_b16 a[90:91], v224 offset:53248
  v_fmac_f32 v222, v244, v241
  v_mfma_f32_16x16x32_bf16 v[152:155], a[72:75], a[40:43], v[152:155]
  buffer_load_dwordx4 v252, s[84:87], s92 offen offset:1024 lds
  v_fmac_f32 v223, v245, v241
  v_mfma_f32_16x16x32_bf16 v[148:151], a[72:75], a[36:39], v[148:151]
  ds_read_b64_tr_b16 a[92:93], v224 offset:57344
  v_mfma_f32_16x16x32_bf16 v[148:151], a[76:79], a[52:55], v[148:151]
  v_mfma_f32_16x16x32_bf16 v[144:147], a[76:79], a[48:51], v[144:147]
  ds_read_b64_tr_b16 a[94:95], v224 offset:61440
  v_mfma_f32_16x16x32_bf16 v[144:147], a[72:75], a[32:35], v[144:147]
  s_add_u32 m0, s79, 24576
  s_waitcnt vmcnt(12) lgkmcnt(4)
  v_mfma_f32_16x16x32_bf16 v[0:3], a[80:83], a[224:227], v[0:3]
  s_add_u32 s92, s92, 262144
  ds_read_b64_tr_b16 a[64:65], v229 offset:32768
  v_mfma_f32_16x16x32_bf16 v[0:3], a[84:87], a[240:243], v[0:3]
  buffer_load_dwordx4 v252, s[80:83], s92 offen lds
  s_waitcnt vmcnt(11)
  v_mfma_f32_16x16x32_bf16 v[4:7], a[84:87], a[244:247], v[4:7]
  ds_read_b64_tr_b16 a[66:67], v229 offset:36864
  v_mfma_f32_16x16x32_bf16 v[4:7], a[80:83], a[228:231], v[4:7]
  s_waitcnt vmcnt(9)
  v_mfma_f32_16x16x32_bf16 v[8:11], a[80:83], a[232:235], v[8:11]
  ds_read_b64_tr_b16 a[68:69], v229 offset:40960
  v_mfma_f32_16x16x32_bf16 v[8:11], a[84:87], a[248:251], v[8:11]
  s_waitcnt vmcnt(7)
  v_mfma_f32_16x16x32_bf16 v[12:15], a[84:87], a[252:255], v[12:15]
  ds_read_b64_tr_b16 a[70:71], v229 offset:45056
  v_and_b32 v236, 31, v253
  v_mfma_f32_16x16x32_bf16 v[12:15], a[80:83], a[236:239], v[12:15]
  s_waitcnt lgkmcnt(4)
  buffer_load_dwordx4 v252, s[84:87], s92 offen offset:1024 lds
  v_lshlrev_b32 v236, 4, v236
  v_mfma_f32_16x16x32_bf16 v[28:31], a[88:91], a[236:239], v[28:31]
  ds_read_b64_tr_b16 a[72:73], v229 offset:49152
  v_lshrrev_b32 v250, 5, v253
  v_mfma_f32_16x16x32_bf16 v[28:31], a[92:95], a[252:255], v[28:31]
  s_mov_b32 s43, 114688
  v_mad_u32_u24 v236, v250, s43, v236
  v_accvgpr_read_b32 v238, a104
  v_mfma_f32_16x16x32_bf16 v[24:27], a[92:95], a[248:251], v[24:27]
  ds_read_b64_tr_b16 a[74:75], v229 offset:53248
  v_accvgpr_read_b32 v232, a108
  v_mfma_f32_16x16x32_bf16 v[24:27], a[88:91], a[232:235], v[24:27]
  v_accvgpr_read_b32 v239, a105
  v_accvgpr_read_b32 v233, a109
  v_mfma_f32_16x16x32_bf16 v[20:23], a[88:91], a[228:231], v[20:23]
  ds_read_b64_tr_b16 a[76:77], v229 offset:57344
  v_accvgpr_read_b32 v240, a106
  v_mfma_f32_16x16x32_bf16 v[20:23], a[92:95], a[244:247], v[20:23]
  v_accvgpr_read_b32 v234, a110
  v_accvgpr_read_b32 v241, a107
  v_mfma_f32_16x16x32_bf16 v[16:19], a[92:95], a[240:243], v[16:19]
  ds_read_b64_tr_b16 a[78:79], v229 offset:61440
  v_xor_b32 v229, 0x10000, v229
  v_accvgpr_read_b32 v235, a111
  v_mfma_f32_16x16x32_bf16 v[16:19], a[88:91], a[224:227], v[16:19]
  s_waitcnt lgkmcnt(4)
  v_mfma_f32_16x16x32_bf16 v[160:163], a[64:67], a[32:35], v[160:163]
  ds_read_b64_tr_b16 a[80:81], v225 offset:32768
  v_mfma_f32_16x16x32_bf16 v[160:163], a[68:71], a[48:51], v[160:163]
  v_mfma_f32_16x16x32_bf16 v[164:167], a[68:71], a[52:55], v[164:167]
  ds_read_b64_tr_b16 a[82:83], v225 offset:36864
  v_mfma_f32_16x16x32_bf16 v[164:167], a[64:67], a[36:39], v[164:167]
  v_pk_mul_f32 v[242:243], v[0:1], v[238:239] op_sel:[0,0] op_sel_hi:[1,0]
  v_pk_mul_f32 v[244:245], v[2:3], v[238:239] op_sel:[0,0] op_sel_hi:[1,0]
  v_pk_mul_f32 v[0:1], v[0:1], v[16:17]
  v_pk_mul_f32 v[2:3], v[2:3], v[18:19]
  v_mfma_f32_16x16x32_bf16 v[168:171], a[64:67], a[40:43], v[168:171]
  ds_read_b64_tr_b16 a[84:85], v225 offset:40960
  v_mfma_f32_16x16x32_bf16 v[168:171], a[68:71], a[56:59], v[168:171]
  v_mfma_f32_16x16x32_bf16 v[172:175], a[68:71], a[60:63], v[172:175]
  ds_read_b64_tr_b16 a[86:87], v225 offset:45056
  v_mfma_f32_16x16x32_bf16 v[172:175], a[64:67], a[44:47], v[172:175]
  s_waitcnt lgkmcnt(4)
  v_mfma_f32_16x16x32_bf16 v[188:191], a[72:75], a[44:47], v[188:191]
  v_exp_f32 v242, v242
  v_mfma_f32_16x16x32_bf16 v[188:191], a[76:79], a[60:63], v[188:191]
  v_exp_f32 v243, v243
  v_mfma_f32_16x16x32_bf16 v[184:187], a[76:79], a[56:59], v[184:187]
  ds_read_b64_tr_b16 a[88:89], v225 offset:49152
  ds_read_b64_tr_b16 a[90:91], v225 offset:53248
  v_mfma_f32_16x16x32_bf16 v[184:187], a[72:75], a[40:43], v[184:187]
  v_exp_f32 v244, v244
  v_exp_f32 v245, v245
  s_nop 0
  v_pk_fma_f32 v[242:243], v[242:243], v[232:233], v[232:233] op_sel:[0,0,0] op_sel_hi:[1,0,0]
  v_pk_fma_f32 v[244:245], v[244:245], v[232:233], v[232:233] op_sel:[0,0,0] op_sel_hi:[1,0,0]
  v_pk_mul_f32 v[246:247], v[4:5], v[238:239] op_sel:[0,1] op_sel_hi:[1,1]
  v_pk_mul_f32 v[248:249], v[6:7], v[238:239] op_sel:[0,1] op_sel_hi:[1,1]
  v_pk_mul_f32 v[4:5], v[4:5], v[20:21]
  v_pk_mul_f32 v[6:7], v[6:7], v[22:23]
  v_rcp_f32 v242, v242
  v_mfma_f32_16x16x32_bf16 v[180:183], a[72:75], a[36:39], v[180:183]
  v_rcp_f32 v243, v243
  v_mfma_f32_16x16x32_bf16 v[180:183], a[76:79], a[52:55], v[180:183]
  v_rcp_f32 v244, v244
  v_mfma_f32_16x16x32_bf16 v[176:179], a[76:79], a[48:51], v[176:179]
  ds_read_b64_tr_b16 a[92:93], v225 offset:57344
  v_mfma_f32_16x16x32_bf16 v[176:179], a[72:75], a[32:35], v[176:179]
  ds_read_b64_tr_b16 a[94:95], v225 offset:61440
  s_waitcnt lgkmcnt(4)
  v_mfma_f32_16x16x32_bf16 v[32:35], a[80:83], a[224:227], v[32:35]
  v_exp_f32 v246, v246
  v_mfma_f32_16x16x32_bf16 v[32:35], a[84:87], a[240:243], v[32:35]
  v_exp_f32 v247, v247
  v_mfma_f32_16x16x32_bf16 v[36:39], a[84:87], a[244:247], v[36:39]
  ds_read_b64_tr_b16 a[64:65], v230 offset:32768
  ds_read_b64_tr_b16 a[66:67], v230 offset:36864
  v_mfma_f32_16x16x32_bf16 v[36:39], a[80:83], a[228:231], v[36:39]
  v_exp_f32 v248, v248
  v_exp_f32 v249, v249
  v_rcp_f32 v245, v245
  v_pk_fma_f32 v[246:247], v[246:247], v[232:233], v[232:233] op_sel:[0,1,1] op_sel_hi:[1,1,1]
  v_pk_fma_f32 v[248:249], v[248:249], v[232:233], v[232:233] op_sel:[0,1,1] op_sel_hi:[1,1,1]
  v_pk_mul_f32 v[0:1], v[0:1], v[242:243]
  v_pk_mul_f32 v[2:3], v[2:3], v[244:245]
  v_pk_mul_f32 v[242:243], v[8:9], v[240:241] op_sel:[0,0] op_sel_hi:[1,0]
  v_pk_mul_f32 v[244:245], v[10:11], v[240:241] op_sel:[0,0] op_sel_hi:[1,0]
  v_pk_mul_f32 v[8:9], v[8:9], v[24:25]
  v_pk_mul_f32 v[10:11], v[10:11], v[26:27]
  v_rcp_f32 v246, v246
  v_mfma_f32_16x16x32_bf16 v[40:43], a[80:83], a[232:235], v[40:43]
  v_rcp_f32 v247, v247
  v_mfma_f32_16x16x32_bf16 v[40:43], a[84:87], a[248:251], v[40:43]
  v_rcp_f32 v248, v248
  v_mfma_f32_16x16x32_bf16 v[44:47], a[84:87], a[252:255], v[44:47]
  ds_read_b64_tr_b16 a[68:69], v230 offset:40960
  v_cvt_pk_bf16_f32 v16, v0, v1
  v_mfma_f32_16x16x32_bf16 v[44:47], a[80:83], a[236:239], v[44:47]
  s_waitcnt lgkmcnt(3)
  ds_read_b64_tr_b16 a[70:71], v230 offset:45056
  v_cvt_pk_bf16_f32 v17, v2, v3
  v_mfma_f32_16x16x32_bf16 v[60:63], a[88:91], a[236:239], v[60:63]
  v_exp_f32 v242, v242
  v_mfma_f32_16x16x32_bf16 v[60:63], a[92:95], a[252:255], v[60:63]
  v_exp_f32 v243, v243
  v_mfma_f32_16x16x32_bf16 v[56:59], a[92:95], a[248:251], v[56:59]
  ds_read_b64_tr_b16 a[72:73], v230 offset:49152
  ds_read_b64_tr_b16 a[74:75], v230 offset:53248
  v_mfma_f32_16x16x32_bf16 v[56:59], a[88:91], a[232:235], v[56:59]
  v_exp_f32 v244, v244
  v_exp_f32 v245, v245
  v_rcp_f32 v249, v249
  v_pk_fma_f32 v[242:243], v[242:243], v[234:235], v[234:235] op_sel:[0,0,0] op_sel_hi:[1,0,0]
  v_pk_fma_f32 v[244:245], v[244:245], v[234:235], v[234:235] op_sel:[0,0,0] op_sel_hi:[1,0,0]
  v_pk_mul_f32 v[4:5], v[4:5], v[246:247]
  v_pk_mul_f32 v[6:7], v[6:7], v[248:249]
  v_pk_mul_f32 v[246:247], v[12:13], v[240:241] op_sel:[0,1] op_sel_hi:[1,1]
  v_pk_mul_f32 v[248:249], v[14:15], v[240:241] op_sel:[0,1] op_sel_hi:[1,1]
  v_pk_mul_f32 v[12:13], v[12:13], v[28:29]
  v_pk_mul_f32 v[14:15], v[14:15], v[30:31]
  v_rcp_f32 v242, v242
  v_mfma_f32_16x16x32_bf16 v[52:55], a[88:91], a[228:231], v[52:55]
  v_rcp_f32 v243, v243
  v_mfma_f32_16x16x32_bf16 v[52:55], a[92:95], a[244:247], v[52:55]
  v_rcp_f32 v244, v244
  v_mfma_f32_16x16x32_bf16 v[48:51], a[92:95], a[240:243], v[48:51]
  ds_read_b64_tr_b16 a[76:77], v230 offset:57344
  v_cvt_pk_bf16_f32 v20, v4, v5
  v_mfma_f32_16x16x32_bf16 v[48:51], a[88:91], a[224:227], v[48:51]
  s_waitcnt lgkmcnt(3)
  ds_read_b64_tr_b16 a[78:79], v230 offset:61440
  v_xor_b32 v230, 0x10000, v230
  v_cvt_pk_bf16_f32 v21, v6, v7
  v_mfma_f32_16x16x32_bf16 v[192:195], a[64:67], a[32:35], v[192:195]
  v_exp_f32 v246, v246
  v_mfma_f32_16x16x32_bf16 v[192:195], a[68:71], a[48:51], v[192:195]
  v_exp_f32 v247, v247
  v_mfma_f32_16x16x32_bf16 v[196:199], a[68:71], a[52:55], v[196:199]
  ds_read_b64_tr_b16 a[80:81], v226 offset:32768
  ds_read_b64_tr_b16 a[82:83], v226 offset:36864
  v_mfma_f32_16x16x32_bf16 v[196:199], a[64:67], a[36:39], v[196:199]
  v_exp_f32 v248, v248
  v_exp_f32 v249, v249
  v_rcp_f32 v245, v245
  v_pk_fma_f32 v[246:247], v[246:247], v[234:235], v[234:235] op_sel:[0,1,1] op_sel_hi:[1,1,1]
  v_pk_fma_f32 v[248:249], v[248:249], v[234:235], v[234:235] op_sel:[0,1,1] op_sel_hi:[1,1,1]
  v_pk_mul_f32 v[8:9], v[8:9], v[242:243]
  v_pk_mul_f32 v[10:11], v[10:11], v[244:245]
  v_pk_mul_f32 v[242:243], v[32:33], v[238:239] op_sel:[0,0] op_sel_hi:[1,0]
  v_pk_mul_f32 v[244:245], v[34:35], v[238:239] op_sel:[0,0] op_sel_hi:[1,0]
  v_pk_mul_f32 v[32:33], v[32:33], v[48:49]
  v_pk_mul_f32 v[34:35], v[34:35], v[50:51]
  v_rcp_f32 v246, v246
  v_mfma_f32_16x16x32_bf16 v[200:203], a[64:67], a[40:43], v[200:203]
  v_rcp_f32 v247, v247
  v_mfma_f32_16x16x32_bf16 v[200:203], a[68:71], a[56:59], v[200:203]
  v_rcp_f32 v248, v248
  v_mfma_f32_16x16x32_bf16 v[204:207], a[68:71], a[60:63], v[204:207]
  ds_read_b64_tr_b16 a[84:85], v226 offset:40960
  v_cvt_pk_bf16_f32 v24, v8, v9
  v_mfma_f32_16x16x32_bf16 v[204:207], a[64:67], a[44:47], v[204:207]
  s_waitcnt lgkmcnt(3)
  ds_read_b64_tr_b16 a[86:87], v226 offset:45056
  v_cvt_pk_bf16_f32 v25, v10, v11
  v_mfma_f32_16x16x32_bf16 v[220:223], a[72:75], a[44:47], v[220:223]
  v_exp_f32 v242, v242
  v_mfma_f32_16x16x32_bf16 v[220:223], a[76:79], a[60:63], v[220:223]
  v_exp_f32 v243, v243
  v_mfma_f32_16x16x32_bf16 v[216:219], a[76:79], a[56:59], v[216:219]
  ds_read_b64_tr_b16 a[88:89], v226 offset:49152
  ds_read_b64_tr_b16 a[90:91], v226 offset:53248
  v_mfma_f32_16x16x32_bf16 v[216:219], a[72:75], a[40:43], v[216:219]
  v_exp_f32 v244, v244
  v_exp_f32 v245, v245
  v_rcp_f32 v249, v249
  v_pk_fma_f32 v[242:243], v[242:243], v[232:233], v[232:233] op_sel:[0,0,0] op_sel_hi:[1,0,0]
  v_pk_fma_f32 v[244:245], v[244:245], v[232:233], v[232:233] op_sel:[0,0,0] op_sel_hi:[1,0,0]
  v_pk_mul_f32 v[12:13], v[12:13], v[246:247]
  v_pk_mul_f32 v[14:15], v[14:15], v[248:249]
  v_pk_mul_f32 v[246:247], v[36:37], v[238:239] op_sel:[0,1] op_sel_hi:[1,1]
  v_pk_mul_f32 v[248:249], v[38:39], v[238:239] op_sel:[0,1] op_sel_hi:[1,1]
  v_pk_mul_f32 v[36:37], v[36:37], v[52:53]
  v_pk_mul_f32 v[38:39], v[38:39], v[54:55]
  v_rcp_f32 v242, v242
  v_mfma_f32_16x16x32_bf16 v[212:215], a[72:75], a[36:39], v[212:215]
  v_rcp_f32 v243, v243
  v_mfma_f32_16x16x32_bf16 v[212:215], a[76:79], a[52:55], v[212:215]
  v_rcp_f32 v244, v244
  v_mfma_f32_16x16x32_bf16 v[208:211], a[76:79], a[48:51], v[208:211]
  ds_read_b64_tr_b16 a[92:93], v226 offset:57344
  v_cvt_pk_bf16_f32 v28, v12, v13
  v_mfma_f32_16x16x32_bf16 v[208:211], a[72:75], a[32:35], v[208:211]
  s_waitcnt lgkmcnt(3)
  ds_read_b64_tr_b16 a[94:95], v226 offset:61440
  v_cvt_pk_bf16_f32 v29, v14, v15
  v_mfma_f32_16x16x32_bf16 v[64:67], a[80:83], a[224:227], v[64:67]
  v_exp_f32 v246, v246
  v_mfma_f32_16x16x32_bf16 v[64:67], a[84:87], a[240:243], v[64:67]
  v_exp_f32 v247, v247
  v_mfma_f32_16x16x32_bf16 v[68:71], a[84:87], a[244:247], v[68:71]
  ds_read_b64_tr_b16 a[64:65], v227 offset:0
  ds_read_b64_tr_b16 a[66:67], v227 offset:4096
  v_mfma_f32_16x16x32_bf16 v[68:71], a[80:83], a[228:231], v[68:71]
  v_exp_f32 v248, v248
  v_exp_f32 v249, v249
  v_rcp_f32 v245, v245
  v_pk_fma_f32 v[246:247], v[246:247], v[232:233], v[232:233] op_sel:[0,1,1] op_sel_hi:[1,1,1]
  v_pk_fma_f32 v[248:249], v[248:249], v[232:233], v[232:233] op_sel:[0,1,1] op_sel_hi:[1,1,1]
  v_pk_mul_f32 v[32:33], v[32:33], v[242:243]
  v_pk_mul_f32 v[34:35], v[34:35], v[244:245]
  v_pk_mul_f32 v[242:243], v[40:41], v[240:241] op_sel:[0,0] op_sel_hi:[1,0]
  v_pk_mul_f32 v[244:245], v[42:43], v[240:241] op_sel:[0,0] op_sel_hi:[1,0]
  v_pk_mul_f32 v[40:41], v[40:41], v[56:57]
  v_pk_mul_f32 v[42:43], v[42:43], v[58:59]
  v_rcp_f32 v246, v246
  v_mfma_f32_16x16x32_bf16 v[72:75], a[80:83], a[232:235], v[72:75]
  v_rcp_f32 v247, v247
  v_mfma_f32_16x16x32_bf16 v[72:75], a[84:87], a[248:251], v[72:75]
  v_rcp_f32 v248, v248
  v_mfma_f32_16x16x32_bf16 v[76:79], a[84:87], a[252:255], v[76:79]
  ds_read_b64_tr_b16 a[68:69], v227 offset:8192
  v_cvt_pk_bf16_f32 v18, v32, v33
  v_mfma_f32_16x16x32_bf16 v[76:79], a[80:83], a[236:239], v[76:79]
  s_waitcnt lgkmcnt(3)
  ds_read_b64_tr_b16 a[70:71], v227 offset:12288
  v_cvt_pk_bf16_f32 v19, v34, v35
  v_mfma_f32_16x16x32_bf16 v[92:95], a[88:91], a[236:239], v[92:95]
  buffer_store_dwordx4 v[16:19], v231, s[4:7], s57 offen sc1
  s_add_u32 s57, s57, 16384
  v_exp_f32 v242, v242
  v_mfma_f32_16x16x32_bf16 v[92:95], a[92:95], a[252:255], v[92:95]
  v_exp_f32 v243, v243
  v_mfma_f32_16x16x32_bf16 v[88:91], a[92:95], a[248:251], v[88:91]
  ds_read_b64_tr_b16 a[72:73], v227 offset:16384
  ds_read_b64_tr_b16 a[74:75], v227 offset:20480
  v_mfma_f32_16x16x32_bf16 v[88:91], a[88:91], a[232:235], v[88:91]
  v_exp_f32 v244, v244
  v_exp_f32 v245, v245
  v_rcp_f32 v249, v249
  v_pk_fma_f32 v[242:243], v[242:243], v[234:235], v[234:235] op_sel:[0,0,0] op_sel_hi:[1,0,0]
  v_pk_fma_f32 v[244:245], v[244:245], v[234:235], v[234:235] op_sel:[0,0,0] op_sel_hi:[1,0,0]
  v_pk_mul_f32 v[36:37], v[36:37], v[246:247]
  v_pk_mul_f32 v[38:39], v[38:39], v[248:249]
  v_pk_mul_f32 v[246:247], v[44:45], v[240:241] op_sel:[0,1] op_sel_hi:[1,1]
  v_pk_mul_f32 v[248:249], v[46:47], v[240:241] op_sel:[0,1] op_sel_hi:[1,1]
  v_pk_mul_f32 v[44:45], v[44:45], v[60:61]
  v_pk_mul_f32 v[46:47], v[46:47], v[62:63]
  v_rcp_f32 v242, v242
  v_mfma_f32_16x16x32_bf16 v[84:87], a[88:91], a[228:231], v[84:87]
  v_rcp_f32 v243, v243
  v_mfma_f32_16x16x32_bf16 v[84:87], a[92:95], a[244:247], v[84:87]
  v_rcp_f32 v244, v244
  v_mfma_f32_16x16x32_bf16 v[80:83], a[92:95], a[240:243], v[80:83]
  ds_read_b64_tr_b16 a[76:77], v227 offset:24576
  v_cvt_pk_bf16_f32 v22, v36, v37
  v_mfma_f32_16x16x32_bf16 v[80:83], a[88:91], a[224:227], v[80:83]
  s_waitcnt lgkmcnt(3)
  ds_read_b64_tr_b16 a[78:79], v227 offset:28672
  v_cvt_pk_bf16_f32 v23, v38, v39
  v_mfma_f32_16x16x32_bf16 v[96:99], a[64:67], a[192:195], v[96:99]
  buffer_store_dwordx4 v[20:23], v231, s[4:7], s58 offen sc1
  s_add_u32 s58, s58, 16384
  v_exp_f32 v246, v246
  v_mfma_f32_16x16x32_bf16 v[96:99], a[68:71], a[208:211], v[96:99]
  v_exp_f32 v247, v247
  v_mfma_f32_16x16x32_bf16 v[100:103], a[68:71], a[212:215], v[100:103]
  ds_read_b64_tr_b16 a[80:81], v227 offset:32768
  ds_read_b64_tr_b16 a[82:83], v227 offset:36864
  v_mfma_f32_16x16x32_bf16 v[100:103], a[64:67], a[196:199], v[100:103]
  v_exp_f32 v248, v248
  v_exp_f32 v249, v249
  v_rcp_f32 v245, v245
  v_pk_fma_f32 v[246:247], v[246:247], v[234:235], v[234:235] op_sel:[0,1,1] op_sel_hi:[1,1,1]
  v_pk_fma_f32 v[248:249], v[248:249], v[234:235], v[234:235] op_sel:[0,1,1] op_sel_hi:[1,1,1]
  v_pk_mul_f32 v[40:41], v[40:41], v[242:243]
  v_pk_mul_f32 v[42:43], v[42:43], v[244:245]
  v_pk_mul_f32 v[242:243], v[64:65], v[238:239] op_sel:[0,0] op_sel_hi:[1,0]
  v_pk_mul_f32 v[244:245], v[66:67], v[238:239] op_sel:[0,0] op_sel_hi:[1,0]
  v_pk_mul_f32 v[64:65], v[64:65], v[80:81]
  v_pk_mul_f32 v[66:67], v[66:67], v[82:83]
  v_rcp_f32 v246, v246
  v_mfma_f32_16x16x32_bf16 v[104:107], a[64:67], a[200:203], v[104:107]
  v_rcp_f32 v247, v247
  v_mfma_f32_16x16x32_bf16 v[104:107], a[68:71], a[216:219], v[104:107]
  v_rcp_f32 v248, v248
  v_mfma_f32_16x16x32_bf16 v[108:111], a[68:71], a[220:223], v[108:111]
  ds_read_b64_tr_b16 a[84:85], v227 offset:40960
  v_cvt_pk_bf16_f32 v26, v40, v41
  v_mfma_f32_16x16x32_bf16 v[108:111], a[64:67], a[204:207], v[108:111]
  s_waitcnt lgkmcnt(3)
  ds_read_b64_tr_b16 a[86:87], v227 offset:45056
  v_cvt_pk_bf16_f32 v27, v42, v43
  v_mfma_f32_16x16x32_bf16 v[124:127], a[72:75], a[204:207], v[124:127]
  buffer_store_dwordx4 v[24:27], v231, s[4:7], s59 offen sc1
  s_add_u32 s59, s59, 16384
  v_exp_f32 v242, v242
  v_mfma_f32_16x16x32_bf16 v[124:127], a[76:79], a[220:223], v[124:127]
  v_exp_f32 v243, v243
  v_mfma_f32_16x16x32_bf16 v[120:123], a[76:79], a[216:219], v[120:123]
  ds_read_b64_tr_b16 a[88:89], v227 offset:49152
  ds_read_b64_tr_b16 a[90:91], v227 offset:53248
  v_mfma_f32_16x16x32_bf16 v[120:123], a[72:75], a[200:203], v[120:123]
  v_exp_f32 v244, v244
  v_exp_f32 v245, v245
  v_rcp_f32 v249, v249
  v_pk_fma_f32 v[242:243], v[242:243], v[232:233], v[232:233] op_sel:[0,0,0] op_sel_hi:[1,0,0]
  v_pk_fma_f32 v[244:245], v[244:245], v[232:233], v[232:233] op_sel:[0,0,0] op_sel_hi:[1,0,0]
  v_pk_mul_f32 v[44:45], v[44:45], v[246:247]
  v_pk_mul_f32 v[46:47], v[46:47], v[248:249]
  v_pk_mul_f32 v[246:247], v[68:69], v[238:239] op_sel:[0,1] op_sel_hi:[1,1]
  v_pk_mul_f32 v[248:249], v[70:71], v[238:239] op_sel:[0,1] op_sel_hi:[1,1]
  v_pk_mul_f32 v[68:69], v[68:69], v[84:85]
  v_pk_mul_f32 v[70:71], v[70:71], v[86:87]
  v_rcp_f32 v242, v242
  v_mfma_f32_16x16x32_bf16 v[116:119], a[72:75], a[196:199], v[116:119]
  v_rcp_f32 v243, v243
  v_mfma_f32_16x16x32_bf16 v[116:119], a[76:79], a[212:215], v[116:119]
  v_rcp_f32 v244, v244
  v_mfma_f32_16x16x32_bf16 v[112:115], a[76:79], a[208:211], v[112:115]
  ds_read_b64_tr_b16 a[92:93], v227 offset:57344
  v_cvt_pk_bf16_f32 v30, v44, v45
  v_mfma_f32_16x16x32_bf16 v[112:115], a[72:75], a[192:195], v[112:115]
  s_waitcnt lgkmcnt(3)
  ds_read_b64_tr_b16 a[94:95], v227 offset:61440
  v_cvt_pk_bf16_f32 v31, v46, v47
  v_mfma_f32_16x16x32_bf16 v[96:99], a[80:83], a[224:227], v[96:99]
  buffer_store_dwordx4 v[28:31], v231, s[4:7], s60 offen sc1
  s_add_u32 s60, s60, 16384
  v_exp_f32 v246, v246
  v_mfma_f32_16x16x32_bf16 v[96:99], a[84:87], a[240:243], v[96:99]
  v_exp_f32 v247, v247
  v_mfma_f32_16x16x32_bf16 v[100:103], a[84:87], a[244:247], v[100:103]
  ds_read_b64_tr_b16 a[64:65], v228 offset:0
  ds_read_b64_tr_b16 a[66:67], v228 offset:4096
  v_mfma_f32_16x16x32_bf16 v[100:103], a[80:83], a[228:231], v[100:103]
  v_exp_f32 v248, v248
  v_exp_f32 v249, v249
  v_rcp_f32 v245, v245
  v_pk_fma_f32 v[246:247], v[246:247], v[232:233], v[232:233] op_sel:[0,1,1] op_sel_hi:[1,1,1]
  v_pk_fma_f32 v[248:249], v[248:249], v[232:233], v[232:233] op_sel:[0,1,1] op_sel_hi:[1,1,1]
  v_pk_mul_f32 v[64:65], v[64:65], v[242:243]
  v_pk_mul_f32 v[66:67], v[66:67], v[244:245]
  v_pk_mul_f32 v[242:243], v[72:73], v[240:241] op_sel:[0,0] op_sel_hi:[1,0]
  v_pk_mul_f32 v[244:245], v[74:75], v[240:241] op_sel:[0,0] op_sel_hi:[1,0]
  v_pk_mul_f32 v[72:73], v[72:73], v[88:89]
  v_pk_mul_f32 v[74:75], v[74:75], v[90:91]
  v_rcp_f32 v246, v246
  v_mfma_f32_16x16x32_bf16 v[104:107], a[80:83], a[232:235], v[104:107]
  v_rcp_f32 v247, v247
  v_lshlrev_b32 v8, 4, v253
  v_mfma_f32_16x16x32_bf16 v[104:107], a[84:87], a[248:251], v[104:107]
  v_rcp_f32 v248, v248
  v_add_u32 v9, 114688, v8
  v_mfma_f32_16x16x32_bf16 v[108:111], a[84:87], a[252:255], v[108:111]
  ds_read_b64_tr_b16 a[68:69], v228 offset:8192
  v_cvt_pk_bf16_f32 v80, v64, v65
  v_mfma_f32_16x16x32_bf16 v[108:111], a[80:83], a[236:239], v[108:111]
  s_waitcnt lgkmcnt(3)
  ds_read_b64_tr_b16 a[70:71], v228 offset:12288
  v_cvt_pk_bf16_f32 v81, v66, v67
  v_mfma_f32_16x16x32_bf16 v[124:127], a[88:91], a[236:239], v[124:127]
  buffer_load_dwordx4 v[16:19], v8, s[4:7], s46 offen offset:0 sc1
  v_exp_f32 v242, v242
  v_mfma_f32_16x16x32_bf16 v[124:127], a[92:95], a[252:255], v[124:127]
  buffer_load_dwordx4 v[20:23], v8, s[4:7], s46 offen offset:1024 sc1
  v_exp_f32 v243, v243
  v_mfma_f32_16x16x32_bf16 v[120:123], a[92:95], a[248:251], v[120:123]
  ds_read_b64_tr_b16 a[72:73], v228 offset:16384
  ds_read_b64_tr_b16 a[74:75], v228 offset:20480
  v_mfma_f32_16x16x32_bf16 v[120:123], a[88:91], a[232:235], v[120:123]
  v_exp_f32 v244, v244
  v_exp_f32 v245, v245
  v_rcp_f32 v249, v249
  v_pk_fma_f32 v[242:243], v[242:243], v[234:235], v[234:235] op_sel:[0,0,0] op_sel_hi:[1,0,0]
  v_pk_fma_f32 v[244:245], v[244:245], v[234:235], v[234:235] op_sel:[0,0,0] op_sel_hi:[1,0,0]
  v_pk_mul_f32 v[68:69], v[68:69], v[246:247]
  v_pk_mul_f32 v[70:71], v[70:71], v[248:249]
  v_pk_mul_f32 v[246:247], v[76:77], v[240:241] op_sel:[0,1] op_sel_hi:[1,1]
  v_pk_mul_f32 v[248:249], v[78:79], v[240:241] op_sel:[0,1] op_sel_hi:[1,1]
  v_pk_mul_f32 v[76:77], v[76:77], v[92:93]
  v_pk_mul_f32 v[78:79], v[78:79], v[94:95]
  v_rcp_f32 v242, v242
  v_mfma_f32_16x16x32_bf16 v[116:119], a[88:91], a[228:231], v[116:119]
  buffer_load_dwordx4 v[24:27], v8, s[4:7], s47 offen offset:0 sc1
  v_rcp_f32 v243, v243
  v_mfma_f32_16x16x32_bf16 v[116:119], a[92:95], a[244:247], v[116:119]
  buffer_load_dwordx4 v[28:31], v8, s[4:7], s47 offen offset:1024 sc1
  v_rcp_f32 v244, v244
  v_mfma_f32_16x16x32_bf16 v[112:115], a[92:95], a[240:243], v[112:115]
  ds_read_b64_tr_b16 a[76:77], v228 offset:24576
  v_cvt_pk_bf16_f32 v84, v68, v69
  v_mfma_f32_16x16x32_bf16 v[112:115], a[88:91], a[224:227], v[112:115]
  s_waitcnt lgkmcnt(3)
  ds_read_b64_tr_b16 a[78:79], v228 offset:28672
  v_cvt_pk_bf16_f32 v85, v70, v71
  v_mfma_f32_16x16x32_bf16 v[128:131], a[64:67], a[192:195], v[128:131]
  v_exp_f32 v246, v246
  v_bfe_u32 v11, v253, 2, 3
  v_mfma_f32_16x16x32_bf16 v[128:131], a[68:71], a[208:211], v[128:131]
  v_exp_f32 v247, v247
  v_bfe_u32 v12, v253, 3, 2
  v_mfma_f32_16x16x32_bf16 v[132:135], a[68:71], a[212:215], v[132:135]
  ds_read_b64_tr_b16 a[80:81], v228 offset:32768
  ds_read_b64_tr_b16 a[82:83], v228 offset:36864
  v_mfma_f32_16x16x32_bf16 v[132:135], a[64:67], a[196:199], v[132:135]
  v_exp_f32 v248, v248
  v_exp_f32 v249, v249
  v_rcp_f32 v245, v245
  v_pk_fma_f32 v[246:247], v[246:247], v[234:235], v[234:235] op_sel:[0,1,1] op_sel_hi:[1,1,1]
  v_pk_fma_f32 v[248:249], v[248:249], v[234:235], v[234:235] op_sel:[0,1,1] op_sel_hi:[1,1,1]
  v_pk_mul_f32 v[72:73], v[72:73], v[242:243]
  v_pk_mul_f32 v[74:75], v[74:75], v[244:245]
  v_pk_mul_f32 v[242:243], v[96:97], v[238:239] op_sel:[0,0] op_sel_hi:[1,0]
  v_pk_mul_f32 v[244:245], v[98:99], v[238:239] op_sel:[0,0] op_sel_hi:[1,0]
  v_pk_mul_f32 v[96:97], v[96:97], v[112:113]
  v_pk_mul_f32 v[98:99], v[98:99], v[114:115]
  v_rcp_f32 v246, v246
  v_mfma_f32_16x16x32_bf16 v[136:139], a[64:67], a[200:203], v[136:139]
  v_rcp_f32 v247, v247
  v_and_b32 v13, 3, v253
  v_mfma_f32_16x16x32_bf16 v[136:139], a[68:71], a[216:219], v[136:139]
  v_rcp_f32 v248, v248
  v_lshlrev_b32 v13, 3, v13
  v_mfma_f32_16x16x32_bf16 v[140:143], a[68:71], a[220:223], v[140:143]
  ds_read_b64_tr_b16 a[84:85], v228 offset:40960
  v_cvt_pk_bf16_f32 v88, v72, v73
  v_mfma_f32_16x16x32_bf16 v[140:143], a[64:67], a[204:207], v[140:143]
  s_waitcnt lgkmcnt(3)
  ds_read_b64_tr_b16 a[86:87], v228 offset:45056
  v_cvt_pk_bf16_f32 v89, v74, v75
  v_mfma_f32_16x16x32_bf16 v[156:159], a[72:75], a[204:207], v[156:159]
  v_exp_f32 v242, v242
  v_lshl_add_u32 v13, v11, 7, v13
  v_mfma_f32_16x16x32_bf16 v[156:159], a[76:79], a[220:223], v[156:159]
  v_exp_f32 v243, v243
  v_lshrrev_b32 v11, 5, v253
  v_mfma_f32_16x16x32_bf16 v[152:155], a[76:79], a[216:219], v[152:155]
  ds_read_b64_tr_b16 a[88:89], v228 offset:49152
  ds_read_b64_tr_b16 a[90:91], v228 offset:53248
  v_mfma_f32_16x16x32_bf16 v[152:155], a[72:75], a[200:203], v[152:155]
  v_exp_f32 v244, v244
  v_exp_f32 v245, v245
  v_rcp_f32 v249, v249
  v_pk_fma_f32 v[242:243], v[242:243], v[232:233], v[232:233] op_sel:[0,0,0] op_sel_hi:[1,0,0]
  v_pk_fma_f32 v[244:245], v[244:245], v[232:233], v[232:233] op_sel:[0,0,0] op_sel_hi:[1,0,0]
  v_pk_mul_f32 v[76:77], v[76:77], v[246:247]
  v_pk_mul_f32 v[78:79], v[78:79], v[248:249]
  v_pk_mul_f32 v[246:247], v[100:101], v[238:239] op_sel:[0,1] op_sel_hi:[1,1]
  v_pk_mul_f32 v[248:249], v[102:103], v[238:239] op_sel:[0,1] op_sel_hi:[1,1]
  v_pk_mul_f32 v[100:101], v[100:101], v[116:117]
  v_pk_mul_f32 v[102:103], v[102:103], v[118:119]
  v_rcp_f32 v242, v242
  v_mfma_f32_16x16x32_bf16 v[148:151], a[72:75], a[196:199], v[148:151]
  s_waitcnt vmcnt(4)
  s_barrier
  s_cmp_lg_u32 s40, 0
  s_cbranch_scc1 Lsgf17
  v_mov_b32 v250, 1
  s_mov_b64 exec, 1
  buffer_atomic_add v250, v251, s[4:7], s77 offen sc1
  s_mov_b64 exec, -1
Lsgf17:
  s_add_u32 s77, s77, 2048
  v_rcp_f32 v243, v243
  v_lshl_add_u32 v13, v11, 11, v13
  v_mfma_f32_16x16x32_bf16 v[148:151], a[76:79], a[212:215], v[148:151]
  s_add_u32 m0, s79, 32768
  v_rcp_f32 v244, v244
  v_xor_b32 v11, 0, v12
  v_mfma_f32_16x16x32_bf16 v[144:147], a[76:79], a[208:211], v[144:147]
  s_add_u32 s92, s92, 196608
  ds_read_b64_tr_b16 a[92:93], v228 offset:57344
  v_cvt_pk_bf16_f32 v92, v76, v77
  v_mfma_f32_16x16x32_bf16 v[144:147], a[72:75], a[192:195], v[144:147]
  s_waitcnt lgkmcnt(3)
  ds_read_b64_tr_b16 a[94:95], v228 offset:61440
  v_cvt_pk_bf16_f32 v93, v78, v79
  v_mfma_f32_16x16x32_bf16 v[128:131], a[80:83], a[224:227], v[128:131]
  buffer_load_dwordx4 v252, s[80:83], s92 offen lds
  v_exp_f32 v246, v246
  v_mfma_f32_16x16x32_bf16 v[128:131], a[84:87], a[240:243], v[128:131]
  buffer_load_dwordx4 v252, s[84:87], s92 offen offset:1024 lds
  v_exp_f32 v247, v247
  v_mfma_f32_16x16x32_bf16 v[132:135], a[84:87], a[244:247], v[132:135]
  ds_read_b64_tr_b16 a[64:65], v229 offset:0
  ds_read_b64_tr_b16 a[66:67], v229 offset:4096
  v_mfma_f32_16x16x32_bf16 v[132:135], a[80:83], a[228:231], v[132:135]
  v_exp_f32 v248, v248
  v_exp_f32 v249, v249
  v_rcp_f32 v245, v245
  v_pk_fma_f32 v[246:247], v[246:247], v[232:233], v[232:233] op_sel:[0,1,1] op_sel_hi:[1,1,1]
  v_pk_fma_f32 v[248:249], v[248:249], v[232:233], v[232:233] op_sel:[0,1,1] op_sel_hi:[1,1,1]
  v_pk_mul_f32 v[96:97], v[96:97], v[242:243]
  v_pk_mul_f32 v[98:99], v[98:99], v[244:245]
  v_pk_mul_f32 v[242:243], v[104:105], v[240:241] op_sel:[0,0] op_sel_hi:[1,0]
  v_pk_mul_f32 v[244:245], v[106:107], v[240:241] op_sel:[0,0] op_sel_hi:[1,0]
  v_pk_mul_f32 v[104:105], v[104:105], v[120:121]
  v_pk_mul_f32 v[106:107], v[106:107], v[122:123]
  v_rcp_f32 v246, v246
  v_mfma_f32_16x16x32_bf16 v[136:139], a[80:83], a[232:235], v[136:139]
  s_add_u32 m0, s79, 40960
  v_rcp_f32 v247, v247
  v_lshl_add_u32 v0, v11, 5, v13
  v_mfma_f32_16x16x32_bf16 v[136:139], a[84:87], a[248:251], v[136:139]
  s_add_u32 s92, s92, 262144
  buffer_load_dwordx4 v252, s[80:83], s92 offen lds
  v_rcp_f32 v248, v248
  v_mfma_f32_16x16x32_bf16 v[140:143], a[84:87], a[252:255], v[140:143]
  ds_read_b64_tr_b16 a[68:69], v229 offset:8192
  v_cvt_pk_bf16_f32 v82, v96, v97
  v_mfma_f32_16x16x32_bf16 v[140:143], a[80:83], a[236:239], v[140:143]
  s_waitcnt lgkmcnt(3)
  ds_read_b64_tr_b16 a[70:71], v229 offset:12288
  v_cvt_pk_bf16_f32 v83, v98, v99
  v_mfma_f32_16x16x32_bf16 v[156:159], a[88:91], a[236:239], v[156:159]
  buffer_load_dwordx4 v252, s[84:87], s92 offen offset:1024 lds
  buffer_store_dwordx4 v[80:83], v231, s[4:7], s57 offen sc1
  s_add_u32 s57, s57, 16384
  v_exp_f32 v242, v242
  v_mfma_f32_16x16x32_bf16 v[156:159], a[92:95], a[252:255], v[156:159]
  v_exp_f32 v243, v243
  v_add_u32 v4, 0x10000, v0
  v_mfma_f32_16x16x32_bf16 v[152:155], a[92:95], a[248:251], v[152:155]
  ds_read_b64_tr_b16 a[72:73], v229 offset:16384
  ds_read_b64_tr_b16 a[74:75], v229 offset:20480
  v_mfma_f32_16x16x32_bf16 v[152:155], a[88:91], a[232:235], v[152:155]
  v_exp_f32 v244, v244
  v_exp_f32 v245, v245
  v_rcp_f32 v249, v249
  v_pk_fma_f32 v[242:243], v[242:243], v[234:235], v[234:235] op_sel:[0,0,0] op_sel_hi:[1,0,0]
  v_pk_fma_f32 v[244:245], v[244:245], v[234:235], v[234:235] op_sel:[0,0,0] op_sel_hi:[1,0,0]
  v_pk_mul_f32 v[100:101], v[100:101], v[246:247]
  v_pk_mul_f32 v[102:103], v[102:103], v[248:249]
  v_pk_mul_f32 v[246:247], v[108:109], v[240:241] op_sel:[0,1] op_sel_hi:[1,1]
  v_pk_mul_f32 v[248:249], v[110:111], v[240:241] op_sel:[0,1] op_sel_hi:[1,1]
  v_pk_mul_f32 v[108:109], v[108:109], v[124:125]
  v_pk_mul_f32 v[110:111], v[110:111], v[126:127]
  v_rcp_f32 v242, v242
  v_mfma_f32_16x16x32_bf16 v[148:151], a[88:91], a[228:231], v[148:151]
  s_add_u32 m0, s79, 49152
  v_rcp_f32 v243, v243
  v_xor_b32 v11, 1, v12
  v_mfma_f32_16x16x32_bf16 v[148:151], a[92:95], a[244:247], v[148:151]
  s_add_u32 s92, s92, 196608
  buffer_load_dwordx4 v252, s[80:83], s92 offen lds
  v_rcp_f32 v244, v244
  v_mfma_f32_16x16x32_bf16 v[144:147], a[92:95], a[240:243], v[144:147]
  ds_read_b64_tr_b16 a[76:77], v229 offset:24576
  v_cvt_pk_bf16_f32 v86, v100, v101
  v_mfma_f32_16x16x32_bf16 v[144:147], a[88:91], a[224:227], v[144:147]
  s_waitcnt lgkmcnt(3)
  ds_read_b64_tr_b16 a[78:79], v229 offset:28672
  v_cvt_pk_bf16_f32 v87, v102, v103
  v_mfma_f32_16x16x32_bf16 v[160:163], a[64:67], a[192:195], v[160:163]
  buffer_load_dwordx4 v252, s[84:87], s92 offen offset:1024 lds
  buffer_store_dwordx4 v[84:87], v231, s[4:7], s58 offen sc1
  s_add_u32 s58, s58, 16384
  v_exp_f32 v246, v246
  v_mfma_f32_16x16x32_bf16 v[160:163], a[68:71], a[208:211], v[160:163]
  v_exp_f32 v247, v247
  v_lshl_add_u32 v1, v11, 5, v13
  v_mfma_f32_16x16x32_bf16 v[164:167], a[68:71], a[212:215], v[164:167]
  ds_read_b64_tr_b16 a[80:81], v229 offset:32768
  ds_read_b64_tr_b16 a[82:83], v229 offset:36864
  v_mfma_f32_16x16x32_bf16 v[164:167], a[64:67], a[196:199], v[164:167]
  v_exp_f32 v248, v248
  v_exp_f32 v249, v249
  v_rcp_f32 v245, v245
  v_pk_fma_f32 v[246:247], v[246:247], v[234:235], v[234:235] op_sel:[0,1,1] op_sel_hi:[1,1,1]
  v_pk_fma_f32 v[248:249], v[248:249], v[234:235], v[234:235] op_sel:[0,1,1] op_sel_hi:[1,1,1]
  v_pk_mul_f32 v[104:105], v[104:105], v[242:243]
  v_pk_mul_f32 v[106:107], v[106:107], v[244:245]
  v_pk_mul_f32 v[242:243], v[128:129], v[238:239] op_sel:[0,0] op_sel_hi:[1,0]
  v_pk_mul_f32 v[244:245], v[130:131], v[238:239] op_sel:[0,0] op_sel_hi:[1,0]
  v_pk_mul_f32 v[128:129], v[128:129], v[144:145]
  v_pk_mul_f32 v[130:131], v[130:131], v[146:147]
  v_rcp_f32 v246, v246
  v_mfma_f32_16x16x32_bf16 v[168:171], a[64:67], a[200:203], v[168:171]
  s_add_u32 m0, s79, 57344
  v_rcp_f32 v247, v247
  v_add_u32 v5, 0x10000, v1
  v_mfma_f32_16x16x32_bf16 v[168:171], a[68:71], a[216:219], v[168:171]
  s_add_u32 s92, s92, 262144
  buffer_load_dwordx4 v252, s[80:83], s92 offen lds
  v_rcp_f32 v248, v248
  v_mfma_f32_16x16x32_bf16 v[172:175], a[68:71], a[220:223], v[172:175]
  ds_read_b64_tr_b16 a[84:85], v229 offset:40960
  v_cvt_pk_bf16_f32 v90, v104, v105
  v_mfma_f32_16x16x32_bf16 v[172:175], a[64:67], a[204:207], v[172:175]
  s_waitcnt lgkmcnt(3)
  ds_read_b64_tr_b16 a[86:87], v229 offset:45056
  v_cvt_pk_bf16_f32 v91, v106, v107
  v_mfma_f32_16x16x32_bf16 v[188:191], a[72:75], a[204:207], v[188:191]
  buffer_load_dwordx4 v252, s[84:87], s92 offen offset:1024 lds
  buffer_store_dwordx4 v[88:91], v231, s[4:7], s59 offen sc1
  s_add_u32 s59, s59, 16384
  v_exp_f32 v242, v242
  v_mfma_f32_16x16x32_bf16 v[188:191], a[76:79], a[220:223], v[188:191]
  v_exp_f32 v243, v243
  v_xor_b32 v11, 2, v12
  v_mfma_f32_16x16x32_bf16 v[184:187], a[76:79], a[216:219], v[184:187]
  ds_read_b64_tr_b16 a[88:89], v229 offset:49152
  ds_read_b64_tr_b16 a[90:91], v229 offset:53248
  v_mfma_f32_16x16x32_bf16 v[184:187], a[72:75], a[200:203], v[184:187]
  v_exp_f32 v244, v244
  v_exp_f32 v245, v245
  v_rcp_f32 v249, v249
  v_pk_fma_f32 v[242:243], v[242:243], v[232:233], v[232:233] op_sel:[0,0,0] op_sel_hi:[1,0,0]
  v_pk_fma_f32 v[244:245], v[244:245], v[232:233], v[232:233] op_sel:[0,0,0] op_sel_hi:[1,0,0]
  v_pk_mul_f32 v[108:109], v[108:109], v[246:247]
  v_pk_mul_f32 v[110:111], v[110:111], v[248:249]
  v_pk_mul_f32 v[246:247], v[132:133], v[238:239] op_sel:[0,1] op_sel_hi:[1,1]
  v_pk_mul_f32 v[248:249], v[134:135], v[238:239] op_sel:[0,1] op_sel_hi:[1,1]
  v_pk_mul_f32 v[132:133], v[132:133], v[148:149]
  v_pk_mul_f32 v[134:135], v[134:135], v[150:151]
  v_rcp_f32 v242, v242
  v_mfma_f32_16x16x32_bf16 v[180:183], a[72:75], a[196:199], v[180:183]
  buffer_load_dword v10, v251, s[4:7], s64 offen sc1
  v_rcp_f32 v243, v243
  v_mfma_f32_16x16x32_bf16 v[180:183], a[76:79], a[212:215], v[180:183]
  v_rcp_f32 v244, v244
  v_lshl_add_u32 v2, v11, 5, v13
  v_mfma_f32_16x16x32_bf16 v[176:179], a[76:79], a[208:211], v[176:179]
  ds_read_b64_tr_b16 a[92:93], v229 offset:57344
  v_cvt_pk_bf16_f32 v94, v108, v109
  v_mfma_f32_16x16x32_bf16 v[176:179], a[72:75], a[192:195], v[176:179]
  s_waitcnt lgkmcnt(3)
  ds_read_b64_tr_b16 a[94:95], v229 offset:61440
  v_cvt_pk_bf16_f32 v95, v110, v111
  v_mfma_f32_16x16x32_bf16 v[160:163], a[80:83], a[224:227], v[160:163]
  buffer_store_dwordx4 v[92:95], v231, s[4:7], s60 offen sc1
  s_add_u32 s60, s60, 16384
  v_exp_f32 v246, v246
  v_mfma_f32_16x16x32_bf16 v[160:163], a[84:87], a[240:243], v[160:163]
  v_exp_f32 v247, v247
  v_add_u32 v6, 0x10000, v2
  v_mfma_f32_16x16x32_bf16 v[164:167], a[84:87], a[244:247], v[164:167]
  ds_read_b64_tr_b16 a[64:65], v230 offset:0
  ds_read_b64_tr_b16 a[66:67], v230 offset:4096
  v_mfma_f32_16x16x32_bf16 v[164:167], a[80:83], a[228:231], v[164:167]
  v_exp_f32 v248, v248
  v_exp_f32 v249, v249
  v_rcp_f32 v245, v245
  v_pk_fma_f32 v[246:247], v[246:247], v[232:233], v[232:233] op_sel:[0,1,1] op_sel_hi:[1,1,1]
  v_pk_fma_f32 v[248:249], v[248:249], v[232:233], v[232:233] op_sel:[0,1,1] op_sel_hi:[1,1,1]
  v_pk_mul_f32 v[128:129], v[128:129], v[242:243]
  v_pk_mul_f32 v[130:131], v[130:131], v[244:245]
  v_pk_mul_f32 v[242:243], v[136:137], v[240:241] op_sel:[0,0] op_sel_hi:[1,0]
  v_pk_mul_f32 v[244:245], v[138:139], v[240:241] op_sel:[0,0] op_sel_hi:[1,0]
  v_pk_mul_f32 v[136:137], v[136:137], v[152:153]
  v_pk_mul_f32 v[138:139], v[138:139], v[154:155]
  v_rcp_f32 v246, v246
  v_mfma_f32_16x16x32_bf16 v[168:171], a[80:83], a[232:235], v[168:171]
  v_rcp_f32 v247, v247
  v_xor_b32 v11, 3, v12
  v_mfma_f32_16x16x32_bf16 v[168:171], a[84:87], a[248:251], v[168:171]
  v_rcp_f32 v248, v248
  v_lshl_add_u32 v3, v11, 5, v13
  v_mfma_f32_16x16x32_bf16 v[172:175], a[84:87], a[252:255], v[172:175]
  ds_read_b64_tr_b16 a[68:69], v230 offset:8192
  v_cvt_pk_bf16_f32 v144, v128, v129
  v_mfma_f32_16x16x32_bf16 v[172:175], a[80:83], a[236:239], v[172:175]
  s_waitcnt lgkmcnt(3)
  ds_read_b64_tr_b16 a[70:71], v230 offset:12288
  v_cvt_pk_bf16_f32 v145, v130, v131
  v_mfma_f32_16x16x32_bf16 v[188:191], a[88:91], a[236:239], v[188:191]
  v_exp_f32 v242, v242
  v_add_u32 v7, 0x10000, v3
  v_mfma_f32_16x16x32_bf16 v[188:191], a[92:95], a[252:255], v[188:191]
  v_exp_f32 v243, v243
  v_mfma_f32_16x16x32_bf16 v[184:187], a[92:95], a[248:251], v[184:187]
  ds_read_b64_tr_b16 a[72:73], v230 offset:16384
  ds_read_b64_tr_b16 a[74:75], v230 offset:20480
  v_mfma_f32_16x16x32_bf16 v[184:187], a[88:91], a[232:235], v[184:187]
  v_exp_f32 v244, v244
  v_exp_f32 v245, v245
  v_rcp_f32 v249, v249
  v_pk_fma_f32 v[242:243], v[242:243], v[234:235], v[234:235] op_sel:[0,0,0] op_sel_hi:[1,0,0]
  v_pk_fma_f32 v[244:245], v[244:245], v[234:235], v[234:235] op_sel:[0,0,0] op_sel_hi:[1,0,0]
  v_pk_mul_f32 v[132:133], v[132:133], v[246:247]
  v_pk_mul_f32 v[134:135], v[134:135], v[248:249]
  v_pk_mul_f32 v[246:247], v[140:141], v[240:241] op_sel:[0,1] op_sel_hi:[1,1]
  v_pk_mul_f32 v[248:249], v[142:143], v[240:241] op_sel:[0,1] op_sel_hi:[1,1]
  v_pk_mul_f32 v[140:141], v[140:141], v[156:157]
  v_pk_mul_f32 v[142:143], v[142:143], v[158:159]
  v_rcp_f32 v242, v242
  v_mfma_f32_16x16x32_bf16 v[180:183], a[88:91], a[228:231], v[180:183]
  v_rcp_f32 v243, v243
  v_mfma_f32_16x16x32_bf16 v[180:183], a[92:95], a[244:247], v[180:183]
  v_rcp_f32 v244, v244
  v_mfma_f32_16x16x32_bf16 v[176:179], a[92:95], a[240:243], v[176:179]
  ds_read_b64_tr_b16 a[76:77], v230 offset:24576
  v_cvt_pk_bf16_f32 v148, v132, v133
  v_mfma_f32_16x16x32_bf16 v[176:179], a[88:91], a[224:227], v[176:179]
  s_waitcnt lgkmcnt(3)
  ds_read_b64_tr_b16 a[78:79], v230 offset:28672
  v_cvt_pk_bf16_f32 v149, v134, v135
  v_mfma_f32_16x16x32_bf16 v[192:195], a[64:67], a[192:195], v[192:195]
  v_exp_f32 v246, v246
  v_mfma_f32_16x16x32_bf16 v[192:195], a[68:71], a[208:211], v[192:195]
  v_exp_f32 v247, v247
  v_mfma_f32_16x16x32_bf16 v[196:199], a[68:71], a[212:215], v[196:199]
  ds_read_b64_tr_b16 a[80:81], v230 offset:32768
  ds_read_b64_tr_b16 a[82:83], v230 offset:36864
  v_mfma_f32_16x16x32_bf16 v[196:199], a[64:67], a[196:199], v[196:199]
  v_exp_f32 v248, v248
  v_exp_f32 v249, v249
  v_rcp_f32 v245, v245
  v_pk_fma_f32 v[246:247], v[246:247], v[234:235], v[234:235] op_sel:[0,1,1] op_sel_hi:[1,1,1]
  v_pk_fma_f32 v[248:249], v[248:249], v[234:235], v[234:235] op_sel:[0,1,1] op_sel_hi:[1,1,1]
  v_pk_mul_f32 v[136:137], v[136:137], v[242:243]
  v_pk_mul_f32 v[138:139], v[138:139], v[244:245]
  v_pk_mul_f32 v[242:243], v[160:161], v[238:239] op_sel:[0,0] op_sel_hi:[1,0]
  v_pk_mul_f32 v[244:245], v[162:163], v[238:239] op_sel:[0,0] op_sel_hi:[1,0]
  v_pk_mul_f32 v[160:161], v[160:161], v[176:177]
  v_pk_mul_f32 v[162:163], v[162:163], v[178:179]
  v_rcp_f32 v246, v246
  v_mfma_f32_16x16x32_bf16 v[200:203], a[64:67], a[200:203], v[200:203]
  s_waitcnt vmcnt(1)
  v_cmp_gt_u32 vcc, 16, v10
  s_cbranch_vccz Lp4a_ok
  s_mov_b32 s43, 0x40000
Lp4a_sp:
  s_sleep 10
  buffer_load_dword v10, v251, s[4:7], s64 offen sc1
  s_waitcnt vmcnt(0)
  v_cmp_gt_u32 vcc, 16, v10
  s_cbranch_vccz Lp4a_ok
  s_sub_u32 s43, s43, 1
  s_cmp_lg_u32 s43, 0
  s_cbranch_scc1 Lp4a_sp
Lp4a_ok:
  s_add_u32 s64, s64, 2048
  buffer_load_dwordx4 a[128:131], v8, s[4:7], s48 offen offset:0 sc1
  v_rcp_f32 v247, v247
  v_mfma_f32_16x16x32_bf16 v[200:203], a[68:71], a[216:219], v[200:203]
  buffer_load_dwordx4 a[132:135], v9, s[4:7], s48 offen offset:0 sc1
  v_rcp_f32 v248, v248
  v_mfma_f32_16x16x32_bf16 v[204:207], a[68:71], a[220:223], v[204:207]
  ds_read_b64_tr_b16 a[84:85], v230 offset:40960
  v_cvt_pk_bf16_f32 v152, v136, v137
  v_mfma_f32_16x16x32_bf16 v[204:207], a[64:67], a[204:207], v[204:207]
  s_waitcnt lgkmcnt(3)
  ds_read_b64_tr_b16 a[86:87], v230 offset:45056
  v_cvt_pk_bf16_f32 v153, v138, v139
  v_mfma_f32_16x16x32_bf16 v[220:223], a[72:75], a[204:207], v[220:223]
  buffer_load_dwordx4 a[136:139], v8, s[4:7], s48 offen offset:1024 sc1
  v_exp_f32 v242, v242
  v_mfma_f32_16x16x32_bf16 v[220:223], a[76:79], a[220:223], v[220:223]
  v_exp_f32 v243, v243
  v_mfma_f32_16x16x32_bf16 v[216:219], a[76:79], a[216:219], v[216:219]
  ds_read_b64_tr_b16 a[88:89], v230 offset:49152
  ds_read_b64_tr_b16 a[90:91], v230 offset:53248
  v_mfma_f32_16x16x32_bf16 v[216:219], a[72:75], a[200:203], v[216:219]
  v_exp_f32 v244, v244
  v_exp_f32 v245, v245
  v_rcp_f32 v249, v249
  v_pk_fma_f32 v[242:243], v[242:243], v[232:233], v[232:233] op_sel:[0,0,0] op_sel_hi:[1,0,0]
  v_pk_fma_f32 v[244:245], v[244:245], v[232:233], v[232:233] op_sel:[0,0,0] op_sel_hi:[1,0,0]
  v_pk_mul_f32 v[140:141], v[140:141], v[246:247]
  v_pk_mul_f32 v[142:143], v[142:143], v[248:249]
  v_pk_mul_f32 v[246:247], v[164:165], v[238:239] op_sel:[0,1] op_sel_hi:[1,1]
  v_pk_mul_f32 v[248:249], v[166:167], v[238:239] op_sel:[0,1] op_sel_hi:[1,1]
  v_pk_mul_f32 v[164:165], v[164:165], v[180:181]
  v_pk_mul_f32 v[166:167], v[166:167], v[182:183]
  v_rcp_f32 v242, v242
  v_mfma_f32_16x16x32_bf16 v[212:215], a[72:75], a[196:199], v[212:215]
  buffer_load_dwordx4 a[140:143], v9, s[4:7], s48 offen offset:1024 sc1
  v_rcp_f32 v243, v243
  v_mfma_f32_16x16x32_bf16 v[212:215], a[76:79], a[212:215], v[212:215]
  buffer_load_dwordx4 a[144:147], v8, s[4:7], s48 offen offset:2048 sc1
  v_rcp_f32 v244, v244
  v_mfma_f32_16x16x32_bf16 v[208:211], a[76:79], a[208:211], v[208:211]
  ds_read_b64_tr_b16 a[92:93], v230 offset:57344
  v_cvt_pk_bf16_f32 v156, v140, v141
  v_mfma_f32_16x16x32_bf16 v[208:211], a[72:75], a[192:195], v[208:211]
  s_waitcnt lgkmcnt(3)
  ds_read_b64_tr_b16 a[94:95], v230 offset:61440
  v_cvt_pk_bf16_f32 v157, v142, v143
  v_mfma_f32_16x16x32_bf16 v[192:195], a[80:83], a[224:227], v[192:195]
  buffer_load_dwordx4 a[148:151], v9, s[4:7], s48 offen offset:2048 sc1
  v_exp_f32 v246, v246
  v_mfma_f32_16x16x32_bf16 v[192:195], a[84:87], a[240:243], v[192:195]
  v_exp_f32 v247, v247
  v_mfma_f32_16x16x32_bf16 v[196:199], a[84:87], a[244:247], v[196:199]
  v_mfma_f32_16x16x32_bf16 v[196:199], a[80:83], a[228:231], v[196:199]
  v_exp_f32 v248, v248
  v_exp_f32 v249, v249
  v_rcp_f32 v245, v245
  v_pk_fma_f32 v[246:247], v[246:247], v[232:233], v[232:233] op_sel:[0,1,1] op_sel_hi:[1,1,1]
  v_pk_fma_f32 v[248:249], v[248:249], v[232:233], v[232:233] op_sel:[0,1,1] op_sel_hi:[1,1,1]
  v_pk_mul_f32 v[160:161], v[160:161], v[242:243]
  v_pk_mul_f32 v[162:163], v[162:163], v[244:245]
  v_pk_mul_f32 v[242:243], v[168:169], v[240:241] op_sel:[0,0] op_sel_hi:[1,0]
  v_pk_mul_f32 v[244:245], v[170:171], v[240:241] op_sel:[0,0] op_sel_hi:[1,0]
  v_pk_mul_f32 v[168:169], v[168:169], v[184:185]
  v_pk_mul_f32 v[170:171], v[170:171], v[186:187]
  v_rcp_f32 v246, v246
  v_mfma_f32_16x16x32_bf16 v[200:203], a[80:83], a[232:235], v[200:203]
  s_waitcnt vmcnt(6)
  s_barrier
  s_cmp_lg_u32 s40, 0
  s_cbranch_scc1 Lsgf18
  v_mov_b32 v250, 1
  s_mov_b64 exec, 1
  buffer_atomic_add v250, v251, s[4:7], s77 offen sc1
  s_mov_b64 exec, -1
Lsgf18:
  s_add_u32 s77, s77, 2048
  buffer_load_dwordx4 a[152:155], v8, s[4:7], s48 offen offset:3072 sc1
  v_rcp_f32 v247, v247
  v_mfma_f32_16x16x32_bf16 v[200:203], a[84:87], a[248:251], v[200:203]
  buffer_load_dwordx4 a[156:159], v9, s[4:7], s48 offen offset:3072 sc1
  v_rcp_f32 v248, v248
  v_mfma_f32_16x16x32_bf16 v[204:207], a[84:87], a[252:255], v[204:207]
  s_add_u32 s48, s48, 4096
  v_cvt_pk_bf16_f32 v146, v160, v161
  v_mfma_f32_16x16x32_bf16 v[204:207], a[80:83], a[236:239], v[204:207]
  v_cvt_pk_bf16_f32 v147, v162, v163
  s_waitcnt lgkmcnt(0)
  v_mfma_f32_16x16x32_bf16 v[220:223], a[88:91], a[236:239], v[220:223]
  buffer_load_dwordx4 a[160:163], v8, s[4:7], s48 offen offset:0 sc1
  buffer_store_dwordx4 v[144:147], v231, s[4:7], s57 offen sc1
  s_add_u32 s57, s57, 16384
  v_exp_f32 v242, v242
  v_mfma_f32_16x16x32_bf16 v[220:223], a[92:95], a[252:255], v[220:223]
  v_exp_f32 v243, v243
  v_mfma_f32_16x16x32_bf16 v[216:219], a[92:95], a[248:251], v[216:219]
  v_mfma_f32_16x16x32_bf16 v[216:219], a[88:91], a[232:235], v[216:219]
  v_exp_f32 v244, v244
  v_exp_f32 v245, v245
  v_rcp_f32 v249, v249
  v_pk_fma_f32 v[242:243], v[242:243], v[234:235], v[234:235] op_sel:[0,0,0] op_sel_hi:[1,0,0]
  v_pk_fma_f32 v[244:245], v[244:245], v[234:235], v[234:235] op_sel:[0,0,0] op_sel_hi:[1,0,0]
  v_pk_mul_f32 v[164:165], v[164:165], v[246:247]
  v_pk_mul_f32 v[166:167], v[166:167], v[248:249]
  v_pk_mul_f32 v[246:247], v[172:173], v[240:241] op_sel:[0,1] op_sel_hi:[1,1]
  v_pk_mul_f32 v[248:249], v[174:175], v[240:241] op_sel:[0,1] op_sel_hi:[1,1]
  v_pk_mul_f32 v[172:173], v[172:173], v[188:189]
  v_pk_mul_f32 v[174:175], v[174:175], v[190:191]
  v_rcp_f32 v242, v242
  v_mfma_f32_16x16x32_bf16 v[212:215], a[88:91], a[228:231], v[212:215]
  v_mfma_f32_16x16x32_bf16 v[212:215], a[92:95], a[244:247], v[212:215]
  v_mfma_f32_16x16x32_bf16 v[208:211], a[92:95], a[240:243], v[208:211]
  v_mfma_f32_16x16x32_bf16 v[208:211], a[88:91], a[224:227], v[208:211]
  ds_read_b64_tr_b16 a[0:1], v0 offset:0
  ds_read_b64_tr_b16 a[2:3], v0 offset:4096
  ds_read_b64_tr_b16 a[16:17], v0 offset:8192
  ds_read_b64_tr_b16 a[18:19], v0 offset:12288
  ds_read_b64_tr_b16 a[4:5], v1 offset:0
  ds_read_b64_tr_b16 a[6:7], v1 offset:4096
  ds_read_b64_tr_b16 a[20:21], v1 offset:8192
  ds_read_b64_tr_b16 a[22:23], v1 offset:12288
  ds_read_b64_tr_b16 a[8:9], v2 offset:0
  ds_read_b64_tr_b16 a[10:11], v2 offset:4096
  ds_read_b64_tr_b16 a[24:25], v2 offset:8192
  ds_read_b64_tr_b16 a[26:27], v2 offset:12288
  ds_read_b64_tr_b16 a[12:13], v3 offset:0
  ds_read_b64_tr_b16 a[14:15], v3 offset:4096
  ds_read_b64_tr_b16 a[28:29], v3 offset:8192
  ds_read_b64_tr_b16 a[30:31], v3 offset:12288
  buffer_load_dwordx4 a[164:167], v9, s[4:7], s48 offen offset:0 sc1
  buffer_load_dwordx4 a[168:171], v8, s[4:7], s48 offen offset:1024 sc1
  v_rcp_f32 v243, v243
  v_rcp_f32 v244, v244
  v_cvt_pk_bf16_f32 v150, v164, v165
  v_cvt_pk_bf16_f32 v151, v166, v167
  buffer_load_dwordx4 a[172:175], v9, s[4:7], s48 offen offset:1024 sc1
  buffer_store_dwordx4 v[148:151], v231, s[4:7], s58 offen sc1
  s_add_u32 s58, s58, 16384
  v_exp_f32 v246, v246
  v_exp_f32 v247, v247
  v_exp_f32 v248, v248
  v_exp_f32 v249, v249
  v_rcp_f32 v245, v245
  v_pk_fma_f32 v[246:247], v[246:247], v[234:235], v[234:235] op_sel:[0,1,1] op_sel_hi:[1,1,1]
  v_pk_fma_f32 v[248:249], v[248:249], v[234:235], v[234:235] op_sel:[0,1,1] op_sel_hi:[1,1,1]
  v_pk_mul_f32 v[168:169], v[168:169], v[242:243]
  v_pk_mul_f32 v[170:171], v[170:171], v[244:245]
  v_pk_mul_f32 v[242:243], v[192:193], v[238:239] op_sel:[0,0] op_sel_hi:[1,0]
  v_pk_mul_f32 v[244:245], v[194:195], v[238:239] op_sel:[0,0] op_sel_hi:[1,0]
  v_pk_mul_f32 v[192:193], v[192:193], v[208:209]
  v_pk_mul_f32 v[194:195], v[194:195], v[210:211]
  v_rcp_f32 v246, v246
  buffer_load_dwordx4 a[176:179], v8, s[4:7], s48 offen offset:2048 sc1
  buffer_load_dwordx4 a[180:183], v9, s[4:7], s48 offen offset:2048 sc1
  v_rcp_f32 v247, v247
  v_rcp_f32 v248, v248
  v_cvt_pk_bf16_f32 v154, v168, v169
  v_cvt_pk_bf16_f32 v155, v170, v171
  buffer_load_dwordx4 a[184:187], v8, s[4:7], s48 offen offset:3072 sc1
  buffer_load_dwordx4 a[188:191], v9, s[4:7], s48 offen offset:3072 sc1
  buffer_store_dwordx4 v[152:155], v231, s[4:7], s59 offen sc1
  s_add_u32 s59, s59, 16384
  v_exp_f32 v242, v242
  v_exp_f32 v243, v243
  v_exp_f32 v244, v244
  v_exp_f32 v245, v245
  v_rcp_f32 v249, v249
  v_pk_fma_f32 v[242:243], v[242:243], v[232:233], v[232:233] op_sel:[0,0,0] op_sel_hi:[1,0,0]
  v_pk_fma_f32 v[244:245], v[244:245], v[232:233], v[232:233] op_sel:[0,0,0] op_sel_hi:[1,0,0]
  v_pk_mul_f32 v[172:173], v[172:173], v[246:247]
  v_pk_mul_f32 v[174:175], v[174:175], v[248:249]
  v_pk_mul_f32 v[246:247], v[196:197], v[238:239] op_sel:[0,1] op_sel_hi:[1,1]
  v_pk_mul_f32 v[248:249], v[198:199], v[238:239] op_sel:[0,1] op_sel_hi:[1,1]
  v_pk_mul_f32 v[196:197], v[196:197], v[212:213]
  v_pk_mul_f32 v[198:199], v[198:199], v[214:215]
  v_rcp_f32 v242, v242
  s_add_u32 m0, s79, 65536
  s_add_u32 s92, s92, 196608
  v_rcp_f32 v243, v243
  v_rcp_f32 v244, v244
  v_cvt_pk_bf16_f32 v158, v172, v173
  v_cvt_pk_bf16_f32 v159, v174, v175
  buffer_load_dwordx4 v252, s[80:83], s92 offen lds
  buffer_load_dwordx4 v252, s[84:87], s92 offen offset:1024 lds
  buffer_store_dwordx4 v[156:159], v231, s[4:7], s60 offen sc1
  s_add_u32 s60, s60, 16384
  v_exp_f32 v246, v246
  v_exp_f32 v247, v247
  v_exp_f32 v248, v248
  v_exp_f32 v249, v249
  v_rcp_f32 v245, v245
  v_pk_fma_f32 v[246:247], v[246:247], v[232:233], v[232:233] op_sel:[0,1,1] op_sel_hi:[1,1,1]
  v_pk_fma_f32 v[248:249], v[248:249], v[232:233], v[232:233] op_sel:[0,1,1] op_sel_hi:[1,1,1]
  v_pk_mul_f32 v[192:193], v[192:193], v[242:243]
  v_pk_mul_f32 v[194:195], v[194:195], v[244:245]
  v_pk_mul_f32 v[242:243], v[200:201], v[240:241] op_sel:[0,0] op_sel_hi:[1,0]
  v_pk_mul_f32 v[244:245], v[202:203], v[240:241] op_sel:[0,0] op_sel_hi:[1,0]
  v_pk_mul_f32 v[200:201], v[200:201], v[216:217]
  v_pk_mul_f32 v[202:203], v[202:203], v[218:219]
  v_rcp_f32 v246, v246
  s_add_u32 m0, s79, 73728
  s_add_u32 s92, s92, 262144
  v_rcp_f32 v247, v247
  v_rcp_f32 v248, v248
  v_cvt_pk_bf16_f32 v208, v192, v193
  v_cvt_pk_bf16_f32 v209, v194, v195
  buffer_load_dwordx4 v252, s[80:83], s92 offen lds
  buffer_load_dwordx4 v252, s[84:87], s92 offen offset:1024 lds
  v_exp_f32 v242, v242
  v_exp_f32 v243, v243
  v_exp_f32 v244, v244
  v_exp_f32 v245, v245
  v_rcp_f32 v249, v249
  v_pk_fma_f32 v[242:243], v[242:243], v[234:235], v[234:235] op_sel:[0,0,0] op_sel_hi:[1,0,0]
  v_pk_fma_f32 v[244:245], v[244:245], v[234:235], v[234:235] op_sel:[0,0,0] op_sel_hi:[1,0,0]
  v_pk_mul_f32 v[196:197], v[196:197], v[246:247]
  v_pk_mul_f32 v[198:199], v[198:199], v[248:249]
  v_pk_mul_f32 v[246:247], v[204:205], v[240:241] op_sel:[0,1] op_sel_hi:[1,1]
  v_pk_mul_f32 v[248:249], v[206:207], v[240:241] op_sel:[0,1] op_sel_hi:[1,1]
  v_pk_mul_f32 v[204:205], v[204:205], v[220:221]
  v_pk_mul_f32 v[206:207], v[206:207], v[222:223]
  v_rcp_f32 v242, v242
  s_add_u32 m0, s79, 81920
  s_add_u32 s92, s92, 196608
  v_rcp_f32 v243, v243
  v_rcp_f32 v244, v244
  v_cvt_pk_bf16_f32 v210, v196, v197
  v_cvt_pk_bf16_f32 v211, v198, v199
  buffer_load_dwordx4 v252, s[80:83], s92 offen lds
  buffer_load_dwordx4 v252, s[84:87], s92 offen offset:1024 lds
  s_nop 1
  v_permlane32_swap_b32 v208, v210
  v_permlane32_swap_b32 v209, v211
  buffer_store_dwordx4 v[208:211], v236, s[4:7], s61 offen sc1
  v_exp_f32 v246, v246
  v_exp_f32 v247, v247
  v_exp_f32 v248, v248
  v_exp_f32 v249, v249
  v_rcp_f32 v245, v245
  v_pk_fma_f32 v[246:247], v[246:247], v[234:235], v[234:235] op_sel:[0,1,1] op_sel_hi:[1,1,1]
  v_pk_fma_f32 v[248:249], v[248:249], v[234:235], v[234:235] op_sel:[0,1,1] op_sel_hi:[1,1,1]
  v_pk_mul_f32 v[200:201], v[200:201], v[242:243]
  v_pk_mul_f32 v[202:203], v[202:203], v[244:245]
  v_rcp_f32 v246, v246
  s_add_u32 m0, s79, 90112
  s_add_u32 s92, s92, 262144
  v_rcp_f32 v247, v247
  v_rcp_f32 v248, v248
  v_cvt_pk_bf16_f32 v216, v200, v201
  v_cvt_pk_bf16_f32 v217, v202, v203
  buffer_load_dwordx4 v252, s[80:83], s92 offen lds
  buffer_load_dwordx4 v252, s[84:87], s92 offen offset:1024 lds
  v_rcp_f32 v249, v249
  s_nop 0
  v_pk_mul_f32 v[204:205], v[204:205], v[246:247]
  v_pk_mul_f32 v[206:207], v[206:207], v[248:249]
  v_cvt_pk_bf16_f32 v218, v204, v205
  v_cvt_pk_bf16_f32 v219, v206, v207
  s_nop 1
  v_permlane32_swap_b32 v216, v218
  v_permlane32_swap_b32 v217, v219
  buffer_store_dwordx4 v[216:219], v236, s[4:7], s62 offen sc1
  v_pk_mul_f32 v[32:33], v[250:251], 0 op_sel:[1,0] op_sel_hi:[1,0]
  v_pk_mul_f32 v[34:35], v[250:251], 0 op_sel:[1,0] op_sel_hi:[1,0]
  v_pk_mul_f32 v[36:37], v[250:251], 0 op_sel:[1,0] op_sel_hi:[1,0]
  v_pk_mul_f32 v[38:39], v[250:251], 0 op_sel:[1,0] op_sel_hi:[1,0]
  v_pk_mul_f32 v[40:41], v[250:251], 0 op_sel:[1,0] op_sel_hi:[1,0]
  v_pk_mul_f32 v[42:43], v[250:251], 0 op_sel:[1,0] op_sel_hi:[1,0]
  v_pk_mul_f32 v[44:45], v[250:251], 0 op_sel:[1,0] op_sel_hi:[1,0]
  v_pk_mul_f32 v[46:47], v[250:251], 0 op_sel:[1,0] op_sel_hi:[1,0]
  v_pk_mul_f32 v[48:49], v[250:251], 0 op_sel:[1,0] op_sel_hi:[1,0]
  v_pk_mul_f32 v[50:51], v[250:251], 0 op_sel:[1,0] op_sel_hi:[1,0]
  v_pk_mul_f32 v[52:53], v[250:251], 0 op_sel:[1,0] op_sel_hi:[1,0]
  v_pk_mul_f32 v[54:55], v[250:251], 0 op_sel:[1,0] op_sel_hi:[1,0]
  v_pk_mul_f32 v[56:57], v[250:251], 0 op_sel:[1,0] op_sel_hi:[1,0]
  v_pk_mul_f32 v[58:59], v[250:251], 0 op_sel:[1,0] op_sel_hi:[1,0]
  v_pk_mul_f32 v[60:61], v[250:251], 0 op_sel:[1,0] op_sel_hi:[1,0]
  v_pk_mul_f32 v[62:63], v[250:251], 0 op_sel:[1,0] op_sel_hi:[1,0]
  v_lshlrev_b32 v64, 16, v16
  v_and_b32 v65, 0xffff0000, v16
  v_lshlrev_b32 v66, 16, v17
  v_and_b32 v67, 0xffff0000, v17
  v_lshlrev_b32 v72, 16, v18
  v_and_b32 v73, 0xffff0000, v18
  v_lshlrev_b32 v74, 16, v19
  v_and_b32 v75, 0xffff0000, v19
  v_lshlrev_b32 v80, 16, v20
  v_and_b32 v81, 0xffff0000, v20
  v_lshlrev_b32 v82, 16, v21
  v_and_b32 v83, 0xffff0000, v21
  v_lshlrev_b32 v88, 16, v22
  v_and_b32 v89, 0xffff0000, v22
  v_lshlrev_b32 v90, 16, v23
  v_and_b32 v91, 0xffff0000, v23
  v_lshlrev_b32 v68, 16, v24
  v_and_b32 v69, 0xffff0000, v24
  v_lshlrev_b32 v70, 16, v25
  v_and_b32 v71, 0xffff0000, v25
  v_lshlrev_b32 v76, 16, v26
  v_and_b32 v77, 0xffff0000, v26
  v_lshlrev_b32 v78, 16, v27
  v_and_b32 v79, 0xffff0000, v27
  v_lshlrev_b32 v84, 16, v28
  v_and_b32 v85, 0xffff0000, v28
  v_lshlrev_b32 v86, 16, v29
  v_and_b32 v87, 0xffff0000, v29
  v_lshlrev_b32 v92, 16, v30
  v_and_b32 v93, 0xffff0000, v30
  v_lshlrev_b32 v94, 16, v31
  v_and_b32 v95, 0xffff0000, v31
  s_mov_b32 s56, 2
.p2align 3
Lp4_loop:
  s_waitcnt vmcnt(24) lgkmcnt(8)
  v_mfma_f32_16x16x32_bf16 v[32:35], a[0:3], a[128:131], v[32:35]
  s_waitcnt vmcnt(26)
  s_barrier
  ds_read_b64_tr_b16 a[32:33], v0 offset:1024
  v_mfma_f32_16x16x32_bf16 v[32:35], a[16:19], a[136:139], v[32:35]
  s_add_u32 m0, s79, 98304
  ds_read_b64_tr_b16 a[34:35], v0 offset:5120
  s_add_u32 s92, s92, 196608
  v_mfma_f32_16x16x32_bf16 v[36:39], a[16:19], a[140:143], v[36:39]
  ds_read_b64_tr_b16 a[48:49], v0 offset:9216
  buffer_load_dwordx4 v252, s[80:83], s92 offen lds
  v_mfma_f32_16x16x32_bf16 v[36:39], a[0:3], a[132:135], v[36:39]
  ds_read_b64_tr_b16 a[50:51], v0 offset:13312
  v_mfma_f32_16x16x32_bf16 v[44:47], a[4:7], a[132:135], v[44:47]
  ds_read_b64_tr_b16 a[36:37], v1 offset:1024
  v_mfma_f32_16x16x32_bf16 v[44:47], a[20:23], a[140:143], v[44:47]
  ds_read_b64_tr_b16 a[38:39], v1 offset:5120
  v_mfma_f32_16x16x32_bf16 v[40:43], a[20:23], a[136:139], v[40:43]
  ds_read_b64_tr_b16 a[52:53], v1 offset:9216
  buffer_load_dwordx4 v252, s[84:87], s92 offen offset:1024 lds
  v_mfma_f32_16x16x32_bf16 v[40:43], a[4:7], a[128:131], v[40:43]
  ds_read_b64_tr_b16 a[54:55], v1 offset:13312
  s_waitcnt lgkmcnt(8)
  v_mfma_f32_16x16x32_bf16 v[48:51], a[8:11], a[128:131], v[48:51]
  ds_read_b64_tr_b16 a[40:41], v2 offset:1024
  v_mfma_f32_16x16x32_bf16 v[48:51], a[24:27], a[136:139], v[48:51]
  ds_read_b64_tr_b16 a[42:43], v2 offset:5120
  s_add_u32 s48, s48, 4096
  v_mfma_f32_16x16x32_bf16 v[52:55], a[24:27], a[140:143], v[52:55]
  ds_read_b64_tr_b16 a[56:57], v2 offset:9216
  buffer_load_dwordx4 a[192:195], v8, s[4:7], s48 offen offset:0 sc1
  v_mfma_f32_16x16x32_bf16 v[52:55], a[8:11], a[132:135], v[52:55]
  ds_read_b64_tr_b16 a[58:59], v2 offset:13312
  v_mfma_f32_16x16x32_bf16 v[60:63], a[12:15], a[132:135], v[60:63]
  ds_read_b64_tr_b16 a[44:45], v3 offset:1024
  v_mfma_f32_16x16x32_bf16 v[60:63], a[28:31], a[140:143], v[60:63]
  ds_read_b64_tr_b16 a[46:47], v3 offset:5120
  v_mfma_f32_16x16x32_bf16 v[56:59], a[28:31], a[136:139], v[56:59]
  ds_read_b64_tr_b16 a[60:61], v3 offset:9216
  buffer_load_dwordx4 a[196:199], v9, s[4:7], s48 offen offset:0 sc1
  v_mfma_f32_16x16x32_bf16 v[56:59], a[12:15], a[128:131], v[56:59]
  ds_read_b64_tr_b16 a[62:63], v3 offset:13312
  s_waitcnt lgkmcnt(8)
  v_mfma_f32_16x16x32_bf16 v[64:67], a[32:35], a[128:131], v[64:67]
  ds_read_b64_tr_b16 a[0:1], v0 offset:16384
  s_add_u32 m0, s79, 106496
  v_mfma_f32_16x16x32_bf16 v[64:67], a[48:51], a[136:139], v[64:67]
  ds_read_b64_tr_b16 a[2:3], v0 offset:20480
  s_add_u32 s92, s92, 262144
  v_mfma_f32_16x16x32_bf16 v[68:71], a[48:51], a[140:143], v[68:71]
  ds_read_b64_tr_b16 a[16:17], v0 offset:24576
  buffer_load_dwordx4 v252, s[80:83], s92 offen lds
  v_mfma_f32_16x16x32_bf16 v[68:71], a[32:35], a[132:135], v[68:71]
  ds_read_b64_tr_b16 a[18:19], v0 offset:28672
  v_mfma_f32_16x16x32_bf16 v[76:79], a[36:39], a[132:135], v[76:79]
  ds_read_b64_tr_b16 a[4:5], v1 offset:16384
  v_mfma_f32_16x16x32_bf16 v[76:79], a[52:55], a[140:143], v[76:79]
  ds_read_b64_tr_b16 a[6:7], v1 offset:20480
  v_mfma_f32_16x16x32_bf16 v[72:75], a[52:55], a[136:139], v[72:75]
  ds_read_b64_tr_b16 a[20:21], v1 offset:24576
  buffer_load_dwordx4 v252, s[84:87], s92 offen offset:1024 lds
  v_mfma_f32_16x16x32_bf16 v[72:75], a[36:39], a[128:131], v[72:75]
  ds_read_b64_tr_b16 a[22:23], v1 offset:28672
  s_waitcnt lgkmcnt(8)
  v_mfma_f32_16x16x32_bf16 v[80:83], a[40:43], a[128:131], v[80:83]
  ds_read_b64_tr_b16 a[8:9], v2 offset:16384
  v_mfma_f32_16x16x32_bf16 v[80:83], a[56:59], a[136:139], v[80:83]
  ds_read_b64_tr_b16 a[10:11], v2 offset:20480
  v_mfma_f32_16x16x32_bf16 v[84:87], a[56:59], a[140:143], v[84:87]
  ds_read_b64_tr_b16 a[24:25], v2 offset:24576
  buffer_load_dwordx4 a[200:203], v8, s[4:7], s48 offen offset:1024 sc1
  v_mfma_f32_16x16x32_bf16 v[84:87], a[40:43], a[132:135], v[84:87]
  ds_read_b64_tr_b16 a[26:27], v2 offset:28672
  v_mfma_f32_16x16x32_bf16 v[92:95], a[44:47], a[132:135], v[92:95]
  ds_read_b64_tr_b16 a[12:13], v3 offset:16384
  v_mfma_f32_16x16x32_bf16 v[92:95], a[60:63], a[140:143], v[92:95]
  ds_read_b64_tr_b16 a[14:15], v3 offset:20480
  v_mfma_f32_16x16x32_bf16 v[88:91], a[60:63], a[136:139], v[88:91]
  ds_read_b64_tr_b16 a[28:29], v3 offset:24576
  buffer_load_dwordx4 a[204:207], v9, s[4:7], s48 offen offset:1024 sc1
  v_mfma_f32_16x16x32_bf16 v[88:91], a[44:47], a[128:131], v[88:91]
  ds_read_b64_tr_b16 a[30:31], v3 offset:28672
  s_waitcnt vmcnt(24) lgkmcnt(8)
  v_mfma_f32_16x16x32_bf16 v[32:35], a[0:3], a[144:147], v[32:35]
  ds_read_b64_tr_b16 a[32:33], v0 offset:17408
  s_add_u32 m0, s79, 114688
  v_mfma_f32_16x16x32_bf16 v[32:35], a[16:19], a[152:155], v[32:35]
  ds_read_b64_tr_b16 a[34:35], v0 offset:21504
  s_add_u32 s92, s92, 196608
  v_mfma_f32_16x16x32_bf16 v[36:39], a[16:19], a[156:159], v[36:39]
  ds_read_b64_tr_b16 a[48:49], v0 offset:25600
  buffer_load_dwordx4 v252, s[80:83], s92 offen lds
  v_mfma_f32_16x16x32_bf16 v[36:39], a[0:3], a[148:151], v[36:39]
  ds_read_b64_tr_b16 a[50:51], v0 offset:29696
  v_mfma_f32_16x16x32_bf16 v[44:47], a[4:7], a[148:151], v[44:47]
  ds_read_b64_tr_b16 a[36:37], v1 offset:17408
  v_mfma_f32_16x16x32_bf16 v[44:47], a[20:23], a[156:159], v[44:47]
  ds_read_b64_tr_b16 a[38:39], v1 offset:21504
  v_mfma_f32_16x16x32_bf16 v[40:43], a[20:23], a[152:155], v[40:43]
  ds_read_b64_tr_b16 a[52:53], v1 offset:25600
  buffer_load_dwordx4 v252, s[84:87], s92 offen offset:1024 lds
  v_mfma_f32_16x16x32_bf16 v[40:43], a[4:7], a[144:147], v[40:43]
  ds_read_b64_tr_b16 a[54:55], v1 offset:29696
  s_waitcnt lgkmcnt(8)
  v_mfma_f32_16x16x32_bf16 v[48:51], a[8:11], a[144:147], v[48:51]
  ds_read_b64_tr_b16 a[40:41], v2 offset:17408
  v_mfma_f32_16x16x32_bf16 v[48:51], a[24:27], a[152:155], v[48:51]
  ds_read_b64_tr_b16 a[42:43], v2 offset:21504
  v_mfma_f32_16x16x32_bf16 v[52:55], a[24:27], a[156:159], v[52:55]
  ds_read_b64_tr_b16 a[56:57], v2 offset:25600
  buffer_load_dwordx4 a[208:211], v8, s[4:7], s48 offen offset:2048 sc1
  v_mfma_f32_16x16x32_bf16 v[52:55], a[8:11], a[148:151], v[52:55]
  ds_read_b64_tr_b16 a[58:59], v2 offset:29696
  v_mfma_f32_16x16x32_bf16 v[60:63], a[12:15], a[148:151], v[60:63]
  ds_read_b64_tr_b16 a[44:45], v3 offset:17408
  v_mfma_f32_16x16x32_bf16 v[60:63], a[28:31], a[156:159], v[60:63]
  ds_read_b64_tr_b16 a[46:47], v3 offset:21504
  v_mfma_f32_16x16x32_bf16 v[56:59], a[28:31], a[152:155], v[56:59]
  ds_read_b64_tr_b16 a[60:61], v3 offset:25600
  buffer_load_dwordx4 a[212:215], v9, s[4:7], s48 offen offset:2048 sc1
  v_mfma_f32_16x16x32_bf16 v[56:59], a[12:15], a[144:147], v[56:59]
  ds_read_b64_tr_b16 a[62:63], v3 offset:29696
  s_waitcnt lgkmcnt(8)
  v_mfma_f32_16x16x32_bf16 v[64:67], a[32:35], a[144:147], v[64:67]
  ds_read_b64_tr_b16 a[0:1], v0 offset:32768
  s_add_u32 m0, s79, 122880
  v_mfma_f32_16x16x32_bf16 v[64:67], a[48:51], a[152:155], v[64:67]
  ds_read_b64_tr_b16 a[2:3], v0 offset:36864
  s_add_u32 s92, s92, 262144
  v_mfma_f32_16x16x32_bf16 v[68:71], a[48:51], a[156:159], v[68:71]
  ds_read_b64_tr_b16 a[16:17], v0 offset:40960
  buffer_load_dwordx4 v252, s[80:83], s92 offen lds
  v_mfma_f32_16x16x32_bf16 v[68:71], a[32:35], a[148:151], v[68:71]
  ds_read_b64_tr_b16 a[18:19], v0 offset:45056
  v_mfma_f32_16x16x32_bf16 v[76:79], a[36:39], a[148:151], v[76:79]
  ds_read_b64_tr_b16 a[4:5], v1 offset:32768
  v_mfma_f32_16x16x32_bf16 v[76:79], a[52:55], a[156:159], v[76:79]
  ds_read_b64_tr_b16 a[6:7], v1 offset:36864
  v_mfma_f32_16x16x32_bf16 v[72:75], a[52:55], a[152:155], v[72:75]
  ds_read_b64_tr_b16 a[20:21], v1 offset:40960
  buffer_load_dwordx4 v252, s[84:87], s92 offen offset:1024 lds
  v_mfma_f32_16x16x32_bf16 v[72:75], a[36:39], a[144:147], v[72:75]
  ds_read_b64_tr_b16 a[22:23], v1 offset:45056
  s_waitcnt lgkmcnt(8)
  v_mfma_f32_16x16x32_bf16 v[80:83], a[40:43], a[144:147], v[80:83]
  ds_read_b64_tr_b16 a[8:9], v2 offset:32768
  v_mfma_f32_16x16x32_bf16 v[80:83], a[56:59], a[152:155], v[80:83]
  ds_read_b64_tr_b16 a[10:11], v2 offset:36864
  v_mfma_f32_16x16x32_bf16 v[84:87], a[56:59], a[156:159], v[84:87]
  ds_read_b64_tr_b16 a[24:25], v2 offset:40960
  buffer_load_dwordx4 a[216:219], v8, s[4:7], s48 offen offset:3072 sc1
  v_mfma_f32_16x16x32_bf16 v[84:87], a[40:43], a[148:151], v[84:87]
  ds_read_b64_tr_b16 a[26:27], v2 offset:45056
  v_mfma_f32_16x16x32_bf16 v[92:95], a[44:47], a[148:151], v[92:95]
  ds_read_b64_tr_b16 a[12:13], v3 offset:32768
  v_mfma_f32_16x16x32_bf16 v[92:95], a[60:63], a[156:159], v[92:95]
  ds_read_b64_tr_b16 a[14:15], v3 offset:36864
  v_mfma_f32_16x16x32_bf16 v[88:91], a[60:63], a[152:155], v[88:91]
  ds_read_b64_tr_b16 a[28:29], v3 offset:40960
  buffer_load_dwordx4 a[220:223], v9, s[4:7], s48 offen offset:3072 sc1
  v_mfma_f32_16x16x32_bf16 v[88:91], a[44:47], a[144:147], v[88:91]
  ds_read_b64_tr_b16 a[30:31], v3 offset:45056
  s_waitcnt vmcnt(24) lgkmcnt(8)
  v_mfma_f32_16x16x32_bf16 v[32:35], a[0:3], a[160:163], v[32:35]
  s_waitcnt vmcnt(22)
  s_barrier
  ds_read_b64_tr_b16 a[32:33], v0 offset:33792
  v_mfma_f32_16x16x32_bf16 v[32:35], a[16:19], a[168:171], v[32:35]
  s_add_u32 m0, s79, 0
  ds_read_b64_tr_b16 a[34:35], v0 offset:37888
  s_add_u32 s92, s92, -3407872
  v_mfma_f32_16x16x32_bf16 v[36:39], a[16:19], a[172:175], v[36:39]
  ds_read_b64_tr_b16 a[48:49], v0 offset:41984
  buffer_load_dwordx4 v252, s[80:83], s92 offen lds
  v_mfma_f32_16x16x32_bf16 v[36:39], a[0:3], a[164:167], v[36:39]
  ds_read_b64_tr_b16 a[50:51], v0 offset:46080
  v_mfma_f32_16x16x32_bf16 v[44:47], a[4:7], a[164:167], v[44:47]
  ds_read_b64_tr_b16 a[36:37], v1 offset:33792
  v_mfma_f32_16x16x32_bf16 v[44:47], a[20:23], a[172:175], v[44:47]
  ds_read_b64_tr_b16 a[38:39], v1 offset:37888
  v_mfma_f32_16x16x32_bf16 v[40:43], a[20:23], a[168:171], v[40:43]
  ds_read_b64_tr_b16 a[52:53], v1 offset:41984
  buffer_load_dwordx4 v252, s[84:87], s92 offen offset:1024 lds
  v_mfma_f32_16x16x32_bf16 v[40:43], a[4:7], a[160:163], v[40:43]
  ds_read_b64_tr_b16 a[54:55], v1 offset:46080
  s_waitcnt lgkmcnt(8)
  v_mfma_f32_16x16x32_bf16 v[48:51], a[8:11], a[160:163], v[48:51]
  ds_read_b64_tr_b16 a[40:41], v2 offset:33792
  v_mfma_f32_16x16x32_bf16 v[48:51], a[24:27], a[168:171], v[48:51]
  ds_read_b64_tr_b16 a[42:43], v2 offset:37888
  s_add_u32 s48, s48, 4096
  v_mfma_f32_16x16x32_bf16 v[52:55], a[24:27], a[172:175], v[52:55]
  ds_read_b64_tr_b16 a[56:57], v2 offset:41984
  buffer_load_dwordx4 a[224:227], v8, s[4:7], s48 offen offset:0 sc1
  v_mfma_f32_16x16x32_bf16 v[52:55], a[8:11], a[164:167], v[52:55]
  ds_read_b64_tr_b16 a[58:59], v2 offset:46080
  v_mfma_f32_16x16x32_bf16 v[60:63], a[12:15], a[164:167], v[60:63]
  ds_read_b64_tr_b16 a[44:45], v3 offset:33792
  v_mfma_f32_16x16x32_bf16 v[60:63], a[28:31], a[172:175], v[60:63]
  ds_read_b64_tr_b16 a[46:47], v3 offset:37888
  v_mfma_f32_16x16x32_bf16 v[56:59], a[28:31], a[168:171], v[56:59]
  ds_read_b64_tr_b16 a[60:61], v3 offset:41984
  buffer_load_dwordx4 a[228:231], v9, s[4:7], s48 offen offset:0 sc1
  v_mfma_f32_16x16x32_bf16 v[56:59], a[12:15], a[160:163], v[56:59]
  ds_read_b64_tr_b16 a[62:63], v3 offset:46080
  s_waitcnt lgkmcnt(8)
  v_mfma_f32_16x16x32_bf16 v[64:67], a[32:35], a[160:163], v[64:67]
  s_add_u32 m0, s79, 8192
  ds_read_b64_tr_b16 a[0:1], v0 offset:49152
  buffer_load_dword v10, v251, s[4:7], s64 offen sc1
  v_mfma_f32_16x16x32_bf16 v[64:67], a[48:51], a[168:171], v[64:67]
  ds_read_b64_tr_b16 a[2:3], v0 offset:53248
  s_add_u32 s92, s92, 262144
  v_mfma_f32_16x16x32_bf16 v[68:71], a[48:51], a[172:175], v[68:71]
  ds_read_b64_tr_b16 a[16:17], v0 offset:57344
  buffer_load_dwordx4 v252, s[80:83], s92 offen lds
  v_mfma_f32_16x16x32_bf16 v[68:71], a[32:35], a[164:167], v[68:71]
  ds_read_b64_tr_b16 a[18:19], v0 offset:61440
  v_mfma_f32_16x16x32_bf16 v[76:79], a[36:39], a[164:167], v[76:79]
  ds_read_b64_tr_b16 a[4:5], v1 offset:49152
  v_mfma_f32_16x16x32_bf16 v[76:79], a[52:55], a[172:175], v[76:79]
  ds_read_b64_tr_b16 a[6:7], v1 offset:53248
  v_mfma_f32_16x16x32_bf16 v[72:75], a[52:55], a[168:171], v[72:75]
  ds_read_b64_tr_b16 a[20:21], v1 offset:57344
  buffer_load_dwordx4 v252, s[84:87], s92 offen offset:1024 lds
  v_mfma_f32_16x16x32_bf16 v[72:75], a[36:39], a[160:163], v[72:75]
  ds_read_b64_tr_b16 a[22:23], v1 offset:61440
  s_waitcnt lgkmcnt(8)
  v_mfma_f32_16x16x32_bf16 v[80:83], a[40:43], a[160:163], v[80:83]
  ds_read_b64_tr_b16 a[8:9], v2 offset:49152
  v_mfma_f32_16x16x32_bf16 v[80:83], a[56:59], a[168:171], v[80:83]
  ds_read_b64_tr_b16 a[10:11], v2 offset:53248
  v_mfma_f32_16x16x32_bf16 v[84:87], a[56:59], a[172:175], v[84:87]
  ds_read_b64_tr_b16 a[24:25], v2 offset:57344
  buffer_load_dwordx4 a[232:235], v8, s[4:7], s48 offen offset:1024 sc1
  v_mfma_f32_16x16x32_bf16 v[84:87], a[40:43], a[164:167], v[84:87]
  ds_read_b64_tr_b16 a[26:27], v2 offset:61440
  v_mfma_f32_16x16x32_bf16 v[92:95], a[44:47], a[164:167], v[92:95]
  ds_read_b64_tr_b16 a[12:13], v3 offset:49152
  v_mfma_f32_16x16x32_bf16 v[92:95], a[60:63], a[172:175], v[92:95]
  ds_read_b64_tr_b16 a[14:15], v3 offset:53248
  v_mfma_f32_16x16x32_bf16 v[88:91], a[60:63], a[168:171], v[88:91]
  ds_read_b64_tr_b16 a[28:29], v3 offset:57344
  buffer_load_dwordx4 a[236:239], v9, s[4:7], s48 offen offset:1024 sc1
  v_mfma_f32_16x16x32_bf16 v[88:91], a[44:47], a[160:163], v[88:91]
  ds_read_b64_tr_b16 a[30:31], v3 offset:61440
  s_waitcnt vmcnt(25) lgkmcnt(8)
  v_mfma_f32_16x16x32_bf16 v[32:35], a[0:3], a[176:179], v[32:35]
  ds_read_b64_tr_b16 a[32:33], v0 offset:50176
  s_add_u32 m0, s79, 16384
  v_mfma_f32_16x16x32_bf16 v[32:35], a[16:19], a[184:187], v[32:35]
  ds_read_b64_tr_b16 a[34:35], v0 offset:54272
  s_add_u32 s92, s92, 196608
  v_mfma_f32_16x16x32_bf16 v[36:39], a[16:19], a[188:191], v[36:39]
  ds_read_b64_tr_b16 a[48:49], v0 offset:58368
  buffer_load_dwordx4 v252, s[80:83], s92 offen lds
  v_mfma_f32_16x16x32_bf16 v[36:39], a[0:3], a[180:183], v[36:39]
  ds_read_b64_tr_b16 a[50:51], v0 offset:62464
  v_mfma_f32_16x16x32_bf16 v[44:47], a[4:7], a[180:183], v[44:47]
  ds_read_b64_tr_b16 a[36:37], v1 offset:50176
  v_mfma_f32_16x16x32_bf16 v[44:47], a[20:23], a[188:191], v[44:47]
  ds_read_b64_tr_b16 a[38:39], v1 offset:54272
  v_mfma_f32_16x16x32_bf16 v[40:43], a[20:23], a[184:187], v[40:43]
  ds_read_b64_tr_b16 a[52:53], v1 offset:58368
  buffer_load_dwordx4 v252, s[84:87], s92 offen offset:1024 lds
  v_mfma_f32_16x16x32_bf16 v[40:43], a[4:7], a[176:179], v[40:43]
  ds_read_b64_tr_b16 a[54:55], v1 offset:62464
  s_waitcnt lgkmcnt(8)
  v_mfma_f32_16x16x32_bf16 v[48:51], a[8:11], a[176:179], v[48:51]
  ds_read_b64_tr_b16 a[40:41], v2 offset:50176
  v_mfma_f32_16x16x32_bf16 v[48:51], a[24:27], a[184:187], v[48:51]
  ds_read_b64_tr_b16 a[42:43], v2 offset:54272
  v_mfma_f32_16x16x32_bf16 v[52:55], a[24:27], a[188:191], v[52:55]
  ds_read_b64_tr_b16 a[56:57], v2 offset:58368
  buffer_load_dwordx4 a[240:243], v8, s[4:7], s48 offen offset:2048 sc1
  v_mfma_f32_16x16x32_bf16 v[52:55], a[8:11], a[180:183], v[52:55]
  ds_read_b64_tr_b16 a[58:59], v2 offset:62464
  v_mfma_f32_16x16x32_bf16 v[60:63], a[12:15], a[180:183], v[60:63]
  ds_read_b64_tr_b16 a[44:45], v3 offset:50176
  v_mfma_f32_16x16x32_bf16 v[60:63], a[28:31], a[188:191], v[60:63]
  ds_read_b64_tr_b16 a[46:47], v3 offset:54272
  v_mfma_f32_16x16x32_bf16 v[56:59], a[28:31], a[184:187], v[56:59]
  ds_read_b64_tr_b16 a[60:61], v3 offset:58368
  buffer_load_dwordx4 a[244:247], v9, s[4:7], s48 offen offset:2048 sc1
  v_mfma_f32_16x16x32_bf16 v[56:59], a[12:15], a[176:179], v[56:59]
  ds_read_b64_tr_b16 a[62:63], v3 offset:62464
  s_waitcnt lgkmcnt(8)
  v_mfma_f32_16x16x32_bf16 v[64:67], a[32:35], a[176:179], v[64:67]
  ds_read_b64_tr_b16 a[0:1], v4 offset:0
  s_add_u32 m0, s79, 24576
  v_mfma_f32_16x16x32_bf16 v[64:67], a[48:51], a[184:187], v[64:67]
  ds_read_b64_tr_b16 a[2:3], v4 offset:4096
  s_add_u32 s92, s92, 262144
  v_mfma_f32_16x16x32_bf16 v[68:71], a[48:51], a[188:191], v[68:71]
  ds_read_b64_tr_b16 a[16:17], v4 offset:8192
  buffer_load_dwordx4 v252, s[80:83], s92 offen lds
  v_mfma_f32_16x16x32_bf16 v[68:71], a[32:35], a[180:183], v[68:71]
  ds_read_b64_tr_b16 a[18:19], v4 offset:12288
  v_mfma_f32_16x16x32_bf16 v[76:79], a[36:39], a[180:183], v[76:79]
  ds_read_b64_tr_b16 a[4:5], v5 offset:0
  v_mfma_f32_16x16x32_bf16 v[76:79], a[52:55], a[188:191], v[76:79]
  ds_read_b64_tr_b16 a[6:7], v5 offset:4096
  v_mfma_f32_16x16x32_bf16 v[72:75], a[52:55], a[184:187], v[72:75]
  ds_read_b64_tr_b16 a[20:21], v5 offset:8192
  buffer_load_dwordx4 v252, s[84:87], s92 offen offset:1024 lds
  v_mfma_f32_16x16x32_bf16 v[72:75], a[36:39], a[176:179], v[72:75]
  ds_read_b64_tr_b16 a[22:23], v5 offset:12288
  s_waitcnt lgkmcnt(8)
  v_mfma_f32_16x16x32_bf16 v[80:83], a[40:43], a[176:179], v[80:83]
  ds_read_b64_tr_b16 a[8:9], v6 offset:0
  v_mfma_f32_16x16x32_bf16 v[80:83], a[56:59], a[184:187], v[80:83]
  ds_read_b64_tr_b16 a[10:11], v6 offset:4096
  v_mfma_f32_16x16x32_bf16 v[84:87], a[56:59], a[188:191], v[84:87]
  ds_read_b64_tr_b16 a[24:25], v6 offset:8192
  buffer_load_dwordx4 a[248:251], v8, s[4:7], s48 offen offset:3072 sc1
  v_mfma_f32_16x16x32_bf16 v[84:87], a[40:43], a[180:183], v[84:87]
  ds_read_b64_tr_b16 a[26:27], v6 offset:12288
  v_mfma_f32_16x16x32_bf16 v[92:95], a[44:47], a[180:183], v[92:95]
  ds_read_b64_tr_b16 a[12:13], v7 offset:0
  v_mfma_f32_16x16x32_bf16 v[92:95], a[60:63], a[188:191], v[92:95]
  ds_read_b64_tr_b16 a[14:15], v7 offset:4096
  v_mfma_f32_16x16x32_bf16 v[88:91], a[60:63], a[184:187], v[88:91]
  ds_read_b64_tr_b16 a[28:29], v7 offset:8192
  buffer_load_dwordx4 a[252:255], v9, s[4:7], s48 offen offset:3072 sc1
  v_mfma_f32_16x16x32_bf16 v[88:91], a[44:47], a[176:179], v[88:91]
  ds_read_b64_tr_b16 a[30:31], v7 offset:12288
  s_waitcnt vmcnt(25) lgkmcnt(8)
  v_mfma_f32_16x16x32_bf16 v[32:35], a[0:3], a[192:195], v[32:35]
  s_waitcnt vmcnt(27)
  s_barrier
  s_xor_b32 s43, s56, 2
  s_or_b32 s43, s43, s40
  s_cbranch_scc1 Lp3_sgl
  v_mov_b32 v250, 1
  s_mov_b64 exec, 1
  buffer_atomic_add v250, v251, s[4:7], s77 offen sc1
  s_mov_b64 exec, -1
Lp3_sgl:
  ds_read_b64_tr_b16 a[32:33], v4 offset:1024
  s_waitcnt vmcnt(12)
  v_cmp_gt_u32 vcc, 16, v10
  s_cbranch_vccz Lp4b_ok
  s_mov_b32 s43, 0x40000
Lp4b_sp:
  s_sleep 10
  buffer_load_dword v10, v251, s[4:7], s64 offen sc1
  s_waitcnt vmcnt(0)
  v_cmp_gt_u32 vcc, 16, v10
  s_cbranch_vccz Lp4b_ok
  s_sub_u32 s43, s43, 1
  s_cmp_lg_u32 s43, 0
  s_cbranch_scc1 Lp4b_sp
Lp4b_ok:
  s_add_u32 s64, s64, 2048
  s_add_u32 m0, s79, 32768
  v_mfma_f32_16x16x32_bf16 v[32:35], a[16:19], a[200:203], v[32:35]
  ds_read_b64_tr_b16 a[34:35], v4 offset:5120
  s_add_u32 s92, s92, 196608
  v_mfma_f32_16x16x32_bf16 v[36:39], a[16:19], a[204:207], v[36:39]
  ds_read_b64_tr_b16 a[48:49], v4 offset:9216
  buffer_load_dwordx4 v252, s[80:83], s92 offen lds
  v_mfma_f32_16x16x32_bf16 v[36:39], a[0:3], a[196:199], v[36:39]
  ds_read_b64_tr_b16 a[50:51], v4 offset:13312
  v_mfma_f32_16x16x32_bf16 v[44:47], a[4:7], a[196:199], v[44:47]
  ds_read_b64_tr_b16 a[36:37], v5 offset:1024
  v_mfma_f32_16x16x32_bf16 v[44:47], a[20:23], a[204:207], v[44:47]
  ds_read_b64_tr_b16 a[38:39], v5 offset:5120
  v_mfma_f32_16x16x32_bf16 v[40:43], a[20:23], a[200:203], v[40:43]
  ds_read_b64_tr_b16 a[52:53], v5 offset:9216
  buffer_load_dwordx4 v252, s[84:87], s92 offen offset:1024 lds
  v_mfma_f32_16x16x32_bf16 v[40:43], a[4:7], a[192:195], v[40:43]
  ds_read_b64_tr_b16 a[54:55], v5 offset:13312
  s_waitcnt lgkmcnt(8)
  v_mfma_f32_16x16x32_bf16 v[48:51], a[8:11], a[192:195], v[48:51]
  ds_read_b64_tr_b16 a[40:41], v6 offset:1024
  v_mfma_f32_16x16x32_bf16 v[48:51], a[24:27], a[200:203], v[48:51]
  ds_read_b64_tr_b16 a[42:43], v6 offset:5120
  s_add_u32 s48, s48, 4096
  v_mfma_f32_16x16x32_bf16 v[52:55], a[24:27], a[204:207], v[52:55]
  ds_read_b64_tr_b16 a[56:57], v6 offset:9216
  buffer_load_dwordx4 a[128:131], v8, s[4:7], s48 offen offset:0 sc1
  v_mfma_f32_16x16x32_bf16 v[52:55], a[8:11], a[196:199], v[52:55]
  ds_read_b64_tr_b16 a[58:59], v6 offset:13312
  v_mfma_f32_16x16x32_bf16 v[60:63], a[12:15], a[196:199], v[60:63]
  ds_read_b64_tr_b16 a[44:45], v7 offset:1024
  v_mfma_f32_16x16x32_bf16 v[60:63], a[28:31], a[204:207], v[60:63]
  ds_read_b64_tr_b16 a[46:47], v7 offset:5120
  v_mfma_f32_16x16x32_bf16 v[56:59], a[28:31], a[200:203], v[56:59]
  ds_read_b64_tr_b16 a[60:61], v7 offset:9216
  buffer_load_dwordx4 a[132:135], v9, s[4:7], s48 offen offset:0 sc1
  v_mfma_f32_16x16x32_bf16 v[56:59], a[12:15], a[192:195], v[56:59]
  ds_read_b64_tr_b16 a[62:63], v7 offset:13312
  s_waitcnt lgkmcnt(8)
  v_mfma_f32_16x16x32_bf16 v[64:67], a[32:35], a[192:195], v[64:67]
  ds_read_b64_tr_b16 a[0:1], v4 offset:16384
  s_add_u32 m0, s79, 40960
  v_mfma_f32_16x16x32_bf16 v[64:67], a[48:51], a[200:203], v[64:67]
  ds_read_b64_tr_b16 a[2:3], v4 offset:20480
  s_add_u32 s92, s92, 262144
  v_mfma_f32_16x16x32_bf16 v[68:71], a[48:51], a[204:207], v[68:71]
  ds_read_b64_tr_b16 a[16:17], v4 offset:24576
  buffer_load_dwordx4 v252, s[80:83], s92 offen lds
  v_mfma_f32_16x16x32_bf16 v[68:71], a[32:35], a[196:199], v[68:71]
  ds_read_b64_tr_b16 a[18:19], v4 offset:28672
  v_mfma_f32_16x16x32_bf16 v[76:79], a[36:39], a[196:199], v[76:79]
  ds_read_b64_tr_b16 a[4:5], v5 offset:16384
  v_mfma_f32_16x16x32_bf16 v[76:79], a[52:55], a[204:207], v[76:79]
  ds_read_b64_tr_b16 a[6:7], v5 offset:20480
  v_mfma_f32_16x16x32_bf16 v[72:75], a[52:55], a[200:203], v[72:75]
  ds_read_b64_tr_b16 a[20:21], v5 offset:24576
  buffer_load_dwordx4 v252, s[84:87], s92 offen offset:1024 lds
  v_mfma_f32_16x16x32_bf16 v[72:75], a[36:39], a[192:195], v[72:75]
  ds_read_b64_tr_b16 a[22:23], v5 offset:28672
  s_waitcnt lgkmcnt(8)
  v_mfma_f32_16x16x32_bf16 v[80:83], a[40:43], a[192:195], v[80:83]
  ds_read_b64_tr_b16 a[8:9], v6 offset:16384
  v_mfma_f32_16x16x32_bf16 v[80:83], a[56:59], a[200:203], v[80:83]
  ds_read_b64_tr_b16 a[10:11], v6 offset:20480
  v_mfma_f32_16x16x32_bf16 v[84:87], a[56:59], a[204:207], v[84:87]
  ds_read_b64_tr_b16 a[24:25], v6 offset:24576
  buffer_load_dwordx4 a[136:139], v8, s[4:7], s48 offen offset:1024 sc1
  v_mfma_f32_16x16x32_bf16 v[84:87], a[40:43], a[196:199], v[84:87]
  ds_read_b64_tr_b16 a[26:27], v6 offset:28672
  v_mfma_f32_16x16x32_bf16 v[92:95], a[44:47], a[196:199], v[92:95]
  ds_read_b64_tr_b16 a[12:13], v7 offset:16384
  v_mfma_f32_16x16x32_bf16 v[92:95], a[60:63], a[204:207], v[92:95]
  ds_read_b64_tr_b16 a[14:15], v7 offset:20480
  v_mfma_f32_16x16x32_bf16 v[88:91], a[60:63], a[200:203], v[88:91]
  ds_read_b64_tr_b16 a[28:29], v7 offset:24576
  buffer_load_dwordx4 a[140:143], v9, s[4:7], s48 offen offset:1024 sc1
  v_mfma_f32_16x16x32_bf16 v[88:91], a[44:47], a[192:195], v[88:91]
  ds_read_b64_tr_b16 a[30:31], v7 offset:28672
  s_waitcnt vmcnt(25) lgkmcnt(8)
  v_mfma_f32_16x16x32_bf16 v[32:35], a[0:3], a[208:211], v[32:35]
  ds_read_b64_tr_b16 a[32:33], v4 offset:17408
  s_add_u32 m0, s79, 49152
  v_mfma_f32_16x16x32_bf16 v[32:35], a[16:19], a[216:219], v[32:35]
  ds_read_b64_tr_b16 a[34:35], v4 offset:21504
  s_add_u32 s92, s92, 196608
  v_mfma_f32_16x16x32_bf16 v[36:39], a[16:19], a[220:223], v[36:39]
  ds_read_b64_tr_b16 a[48:49], v4 offset:25600
  buffer_load_dwordx4 v252, s[80:83], s92 offen lds
  v_mfma_f32_16x16x32_bf16 v[36:39], a[0:3], a[212:215], v[36:39]
  ds_read_b64_tr_b16 a[50:51], v4 offset:29696
  v_mfma_f32_16x16x32_bf16 v[44:47], a[4:7], a[212:215], v[44:47]
  ds_read_b64_tr_b16 a[36:37], v5 offset:17408
  v_mfma_f32_16x16x32_bf16 v[44:47], a[20:23], a[220:223], v[44:47]
  ds_read_b64_tr_b16 a[38:39], v5 offset:21504
  v_mfma_f32_16x16x32_bf16 v[40:43], a[20:23], a[216:219], v[40:43]
  ds_read_b64_tr_b16 a[52:53], v5 offset:25600
  buffer_load_dwordx4 v252, s[84:87], s92 offen offset:1024 lds
  v_mfma_f32_16x16x32_bf16 v[40:43], a[4:7], a[208:211], v[40:43]
  ds_read_b64_tr_b16 a[54:55], v5 offset:29696
  s_waitcnt lgkmcnt(8)
  v_mfma_f32_16x16x32_bf16 v[48:51], a[8:11], a[208:211], v[48:51]
  ds_read_b64_tr_b16 a[40:41], v6 offset:17408
  v_mfma_f32_16x16x32_bf16 v[48:51], a[24:27], a[216:219], v[48:51]
  ds_read_b64_tr_b16 a[42:43], v6 offset:21504
  v_mfma_f32_16x16x32_bf16 v[52:55], a[24:27], a[220:223], v[52:55]
  ds_read_b64_tr_b16 a[56:57], v6 offset:25600
  buffer_load_dwordx4 a[144:147], v8, s[4:7], s48 offen offset:2048 sc1
  v_mfma_f32_16x16x32_bf16 v[52:55], a[8:11], a[212:215], v[52:55]
  ds_read_b64_tr_b16 a[58:59], v6 offset:29696
  v_mfma_f32_16x16x32_bf16 v[60:63], a[12:15], a[212:215], v[60:63]
  ds_read_b64_tr_b16 a[44:45], v7 offset:17408
  v_mfma_f32_16x16x32_bf16 v[60:63], a[28:31], a[220:223], v[60:63]
  ds_read_b64_tr_b16 a[46:47], v7 offset:21504
  v_mfma_f32_16x16x32_bf16 v[56:59], a[28:31], a[216:219], v[56:59]
  ds_read_b64_tr_b16 a[60:61], v7 offset:25600
  buffer_load_dwordx4 a[148:151], v9, s[4:7], s48 offen offset:2048 sc1
  v_mfma_f32_16x16x32_bf16 v[56:59], a[12:15], a[208:211], v[56:59]
  ds_read_b64_tr_b16 a[62:63], v7 offset:29696
  s_waitcnt lgkmcnt(8)
  v_mfma_f32_16x16x32_bf16 v[64:67], a[32:35], a[208:211], v[64:67]
  ds_read_b64_tr_b16 a[0:1], v4 offset:32768
  s_add_u32 m0, s79, 57344
  v_mfma_f32_16x16x32_bf16 v[64:67], a[48:51], a[216:219], v[64:67]
  ds_read_b64_tr_b16 a[2:3], v4 offset:36864
  s_add_u32 s92, s92, 262144
  v_mfma_f32_16x16x32_bf16 v[68:71], a[48:51], a[220:223], v[68:71]
  ds_read_b64_tr_b16 a[16:17], v4 offset:40960
  buffer_load_dwordx4 v252, s[80:83], s92 offen lds
  v_mfma_f32_16x16x32_bf16 v[68:71], a[32:35], a[212:215], v[68:71]
  ds_read_b64_tr_b16 a[18:19], v4 offset:45056
  v_mfma_f32_16x16x32_bf16 v[76:79], a[36:39], a[212:215], v[76:79]
  ds_read_b64_tr_b16 a[4:5], v5 offset:32768
  v_mfma_f32_16x16x32_bf16 v[76:79], a[52:55], a[220:223], v[76:79]
  ds_read_b64_tr_b16 a[6:7], v5 offset:36864
  v_mfma_f32_16x16x32_bf16 v[72:75], a[52:55], a[216:219], v[72:75]
  ds_read_b64_tr_b16 a[20:21], v5 offset:40960
  buffer_load_dwordx4 v252, s[84:87], s92 offen offset:1024 lds
  v_mfma_f32_16x16x32_bf16 v[72:75], a[36:39], a[208:211], v[72:75]
  ds_read_b64_tr_b16 a[22:23], v5 offset:45056
  s_waitcnt lgkmcnt(8)
  v_mfma_f32_16x16x32_bf16 v[80:83], a[40:43], a[208:211], v[80:83]
  ds_read_b64_tr_b16 a[8:9], v6 offset:32768
  v_mfma_f32_16x16x32_bf16 v[80:83], a[56:59], a[216:219], v[80:83]
  ds_read_b64_tr_b16 a[10:11], v6 offset:36864
  v_mfma_f32_16x16x32_bf16 v[84:87], a[56:59], a[220:223], v[84:87]
  ds_read_b64_tr_b16 a[24:25], v6 offset:40960
  buffer_load_dwordx4 a[152:155], v8, s[4:7], s48 offen offset:3072 sc1
  v_mfma_f32_16x16x32_bf16 v[84:87], a[40:43], a[212:215], v[84:87]
  ds_read_b64_tr_b16 a[26:27], v6 offset:45056
  v_mfma_f32_16x16x32_bf16 v[92:95], a[44:47], a[212:215], v[92:95]
  ds_read_b64_tr_b16 a[12:13], v7 offset:32768
  v_mfma_f32_16x16x32_bf16 v[92:95], a[60:63], a[220:223], v[92:95]
  ds_read_b64_tr_b16 a[14:15], v7 offset:36864
  v_mfma_f32_16x16x32_bf16 v[88:91], a[60:63], a[216:219], v[88:91]
  ds_read_b64_tr_b16 a[28:29], v7 offset:40960
  buffer_load_dwordx4 a[156:159], v9, s[4:7], s48 offen offset:3072 sc1
  v_mfma_f32_16x16x32_bf16 v[88:91], a[44:47], a[208:211], v[88:91]
  ds_read_b64_tr_b16 a[30:31], v7 offset:45056
  s_waitcnt vmcnt(24) lgkmcnt(8)
  v_mfma_f32_16x16x32_bf16 v[32:35], a[0:3], a[224:227], v[32:35]
  s_waitcnt vmcnt(26)
  s_barrier
  ds_read_b64_tr_b16 a[32:33], v4 offset:33792
  v_mfma_f32_16x16x32_bf16 v[32:35], a[16:19], a[232:235], v[32:35]
  s_add_u32 m0, s79, 65536
  ds_read_b64_tr_b16 a[34:35], v4 offset:37888
  s_add_u32 s92, s92, 196608
  v_mfma_f32_16x16x32_bf16 v[36:39], a[16:19], a[236:239], v[36:39]
  ds_read_b64_tr_b16 a[48:49], v4 offset:41984
  buffer_load_dwordx4 v252, s[80:83], s92 offen lds
  v_mfma_f32_16x16x32_bf16 v[36:39], a[0:3], a[228:231], v[36:39]
  ds_read_b64_tr_b16 a[50:51], v4 offset:46080
  v_mfma_f32_16x16x32_bf16 v[44:47], a[4:7], a[228:231], v[44:47]
  ds_read_b64_tr_b16 a[36:37], v5 offset:33792
  v_mfma_f32_16x16x32_bf16 v[44:47], a[20:23], a[236:239], v[44:47]
  ds_read_b64_tr_b16 a[38:39], v5 offset:37888
  v_mfma_f32_16x16x32_bf16 v[40:43], a[20:23], a[232:235], v[40:43]
  ds_read_b64_tr_b16 a[52:53], v5 offset:41984
  buffer_load_dwordx4 v252, s[84:87], s92 offen offset:1024 lds
  v_mfma_f32_16x16x32_bf16 v[40:43], a[4:7], a[224:227], v[40:43]
  ds_read_b64_tr_b16 a[54:55], v5 offset:46080
  s_waitcnt lgkmcnt(8)
  v_mfma_f32_16x16x32_bf16 v[48:51], a[8:11], a[224:227], v[48:51]
  ds_read_b64_tr_b16 a[40:41], v6 offset:33792
  v_mfma_f32_16x16x32_bf16 v[48:51], a[24:27], a[232:235], v[48:51]
  ds_read_b64_tr_b16 a[42:43], v6 offset:37888
  s_add_u32 s48, s48, 4096
  v_mfma_f32_16x16x32_bf16 v[52:55], a[24:27], a[236:239], v[52:55]
  ds_read_b64_tr_b16 a[56:57], v6 offset:41984
  buffer_load_dwordx4 a[160:163], v8, s[4:7], s48 offen offset:0 sc1
  v_mfma_f32_16x16x32_bf16 v[52:55], a[8:11], a[228:231], v[52:55]
  ds_read_b64_tr_b16 a[58:59], v6 offset:46080
  v_mfma_f32_16x16x32_bf16 v[60:63], a[12:15], a[228:231], v[60:63]
  ds_read_b64_tr_b16 a[44:45], v7 offset:33792
  v_mfma_f32_16x16x32_bf16 v[60:63], a[28:31], a[236:239], v[60:63]
  ds_read_b64_tr_b16 a[46:47], v7 offset:37888
  v_mfma_f32_16x16x32_bf16 v[56:59], a[28:31], a[232:235], v[56:59]
  ds_read_b64_tr_b16 a[60:61], v7 offset:41984
  buffer_load_dwordx4 a[164:167], v9, s[4:7], s48 offen offset:0 sc1
  v_mfma_f32_16x16x32_bf16 v[56:59], a[12:15], a[224:227], v[56:59]
  ds_read_b64_tr_b16 a[62:63], v7 offset:46080
  s_waitcnt lgkmcnt(8)
  v_mfma_f32_16x16x32_bf16 v[64:67], a[32:35], a[224:227], v[64:67]
  ds_read_b64_tr_b16 a[0:1], v4 offset:49152
  s_add_u32 m0, s79, 73728
  v_mfma_f32_16x16x32_bf16 v[64:67], a[48:51], a[232:235], v[64:67]
  ds_read_b64_tr_b16 a[2:3], v4 offset:53248
  s_add_u32 s92, s92, 262144
  v_mfma_f32_16x16x32_bf16 v[68:71], a[48:51], a[236:239], v[68:71]
  ds_read_b64_tr_b16 a[16:17], v4 offset:57344
  buffer_load_dwordx4 v252, s[80:83], s92 offen lds
  v_mfma_f32_16x16x32_bf16 v[68:71], a[32:35], a[228:231], v[68:71]
  ds_read_b64_tr_b16 a[18:19], v4 offset:61440
  v_mfma_f32_16x16x32_bf16 v[76:79], a[36:39], a[228:231], v[76:79]
  ds_read_b64_tr_b16 a[4:5], v5 offset:49152
  v_mfma_f32_16x16x32_bf16 v[76:79], a[52:55], a[236:239], v[76:79]
  ds_read_b64_tr_b16 a[6:7], v5 offset:53248
  v_mfma_f32_16x16x32_bf16 v[72:75], a[52:55], a[232:235], v[72:75]
  ds_read_b64_tr_b16 a[20:21], v5 offset:57344
  buffer_load_dwordx4 v252, s[84:87], s92 offen offset:1024 lds
  v_mfma_f32_16x16x32_bf16 v[72:75], a[36:39], a[224:227], v[72:75]
  ds_read_b64_tr_b16 a[22:23], v5 offset:61440
  s_waitcnt lgkmcnt(8)
  v_mfma_f32_16x16x32_bf16 v[80:83], a[40:43], a[224:227], v[80:83]
  ds_read_b64_tr_b16 a[8:9], v6 offset:49152
  v_mfma_f32_16x16x32_bf16 v[80:83], a[56:59], a[232:235], v[80:83]
  ds_read_b64_tr_b16 a[10:11], v6 offset:53248
  v_mfma_f32_16x16x32_bf16 v[84:87], a[56:59], a[236:239], v[84:87]
  ds_read_b64_tr_b16 a[24:25], v6 offset:57344
  buffer_load_dwordx4 a[168:171], v8, s[4:7], s48 offen offset:1024 sc1
  v_mfma_f32_16x16x32_bf16 v[84:87], a[40:43], a[228:231], v[84:87]
  ds_read_b64_tr_b16 a[26:27], v6 offset:61440
  v_mfma_f32_16x16x32_bf16 v[92:95], a[44:47], a[228:231], v[92:95]
  ds_read_b64_tr_b16 a[12:13], v7 offset:49152
  v_mfma_f32_16x16x32_bf16 v[92:95], a[60:63], a[236:239], v[92:95]
  ds_read_b64_tr_b16 a[14:15], v7 offset:53248
  v_mfma_f32_16x16x32_bf16 v[88:91], a[60:63], a[232:235], v[88:91]
  ds_read_b64_tr_b16 a[28:29], v7 offset:57344
  buffer_load_dwordx4 a[172:175], v9, s[4:7], s48 offen offset:1024 sc1
  v_mfma_f32_16x16x32_bf16 v[88:91], a[44:47], a[224:227], v[88:91]
  ds_read_b64_tr_b16 a[30:31], v7 offset:61440
  s_waitcnt vmcnt(24) lgkmcnt(8)
  v_mfma_f32_16x16x32_bf16 v[32:35], a[0:3], a[240:243], v[32:35]
  ds_read_b64_tr_b16 a[32:33], v4 offset:50176
  s_add_u32 m0, s79, 81920
  v_mfma_f32_16x16x32_bf16 v[32:35], a[16:19], a[248:251], v[32:35]
  ds_read_b64_tr_b16 a[34:35], v4 offset:54272
  s_add_u32 s92, s92, 196608
  v_mfma_f32_16x16x32_bf16 v[36:39], a[16:19], a[252:255], v[36:39]
  ds_read_b64_tr_b16 a[48:49], v4 offset:58368
  buffer_load_dwordx4 v252, s[80:83], s92 offen lds
  v_mfma_f32_16x16x32_bf16 v[36:39], a[0:3], a[244:247], v[36:39]
  ds_read_b64_tr_b16 a[50:51], v4 offset:62464
  v_mfma_f32_16x16x32_bf16 v[44:47], a[4:7], a[244:247], v[44:47]
  ds_read_b64_tr_b16 a[36:37], v5 offset:50176
  v_mfma_f32_16x16x32_bf16 v[44:47], a[20:23], a[252:255], v[44:47]
  ds_read_b64_tr_b16 a[38:39], v5 offset:54272
  v_mfma_f32_16x16x32_bf16 v[40:43], a[20:23], a[248:251], v[40:43]
  ds_read_b64_tr_b16 a[52:53], v5 offset:58368
  buffer_load_dwordx4 v252, s[84:87], s92 offen offset:1024 lds
  v_mfma_f32_16x16x32_bf16 v[40:43], a[4:7], a[240:243], v[40:43]
  ds_read_b64_tr_b16 a[54:55], v5 offset:62464
  s_waitcnt lgkmcnt(8)
  v_mfma_f32_16x16x32_bf16 v[48:51], a[8:11], a[240:243], v[48:51]
  ds_read_b64_tr_b16 a[40:41], v6 offset:50176
  v_mfma_f32_16x16x32_bf16 v[48:51], a[24:27], a[248:251], v[48:51]
  ds_read_b64_tr_b16 a[42:43], v6 offset:54272
  v_mfma_f32_16x16x32_bf16 v[52:55], a[24:27], a[252:255], v[52:55]
  ds_read_b64_tr_b16 a[56:57], v6 offset:58368
  buffer_load_dwordx4 a[176:179], v8, s[4:7], s48 offen offset:2048 sc1
  v_mfma_f32_16x16x32_bf16 v[52:55], a[8:11], a[244:247], v[52:55]
  ds_read_b64_tr_b16 a[58:59], v6 offset:62464
  v_mfma_f32_16x16x32_bf16 v[60:63], a[12:15], a[244:247], v[60:63]
  ds_read_b64_tr_b16 a[44:45], v7 offset:50176
  v_mfma_f32_16x16x32_bf16 v[60:63], a[28:31], a[252:255], v[60:63]
  ds_read_b64_tr_b16 a[46:47], v7 offset:54272
  v_mfma_f32_16x16x32_bf16 v[56:59], a[28:31], a[248:251], v[56:59]
  ds_read_b64_tr_b16 a[60:61], v7 offset:58368
  buffer_load_dwordx4 a[180:183], v9, s[4:7], s48 offen offset:2048 sc1
  v_mfma_f32_16x16x32_bf16 v[56:59], a[12:15], a[240:243], v[56:59]
  ds_read_b64_tr_b16 a[62:63], v7 offset:62464
  s_waitcnt lgkmcnt(8)
  v_mfma_f32_16x16x32_bf16 v[64:67], a[32:35], a[240:243], v[64:67]
  ds_read_b64_tr_b16 a[0:1], v0 offset:0
  s_add_u32 m0, s79, 90112
  v_mfma_f32_16x16x32_bf16 v[64:67], a[48:51], a[248:251], v[64:67]
  ds_read_b64_tr_b16 a[2:3], v0 offset:4096
  s_add_u32 s92, s92, 262144
  v_mfma_f32_16x16x32_bf16 v[68:71], a[48:51], a[252:255], v[68:71]
  ds_read_b64_tr_b16 a[16:17], v0 offset:8192
  buffer_load_dwordx4 v252, s[80:83], s92 offen lds
  v_mfma_f32_16x16x32_bf16 v[68:71], a[32:35], a[244:247], v[68:71]
  ds_read_b64_tr_b16 a[18:19], v0 offset:12288
  v_mfma_f32_16x16x32_bf16 v[76:79], a[36:39], a[244:247], v[76:79]
  ds_read_b64_tr_b16 a[4:5], v1 offset:0
  v_mfma_f32_16x16x32_bf16 v[76:79], a[52:55], a[252:255], v[76:79]
  ds_read_b64_tr_b16 a[6:7], v1 offset:4096
  v_mfma_f32_16x16x32_bf16 v[72:75], a[52:55], a[248:251], v[72:75]
  ds_read_b64_tr_b16 a[20:21], v1 offset:8192
  buffer_load_dwordx4 v252, s[84:87], s92 offen offset:1024 lds
  v_mfma_f32_16x16x32_bf16 v[72:75], a[36:39], a[240:243], v[72:75]
  ds_read_b64_tr_b16 a[22:23], v1 offset:12288
  s_waitcnt lgkmcnt(8)
  v_mfma_f32_16x16x32_bf16 v[80:83], a[40:43], a[240:243], v[80:83]
  ds_read_b64_tr_b16 a[8:9], v2 offset:0
  v_mfma_f32_16x16x32_bf16 v[80:83], a[56:59], a[248:251], v[80:83]
  ds_read_b64_tr_b16 a[10:11], v2 offset:4096
  v_mfma_f32_16x16x32_bf16 v[84:87], a[56:59], a[252:255], v[84:87]
  ds_read_b64_tr_b16 a[24:25], v2 offset:8192
  buffer_load_dwordx4 a[184:187], v8, s[4:7], s48 offen offset:3072 sc1
  v_mfma_f32_16x16x32_bf16 v[84:87], a[40:43], a[244:247], v[84:87]
  ds_read_b64_tr_b16 a[26:27], v2 offset:12288
  v_mfma_f32_16x16x32_bf16 v[92:95], a[44:47], a[244:247], v[92:95]
  ds_read_b64_tr_b16 a[12:13], v3 offset:0
  v_mfma_f32_16x16x32_bf16 v[92:95], a[60:63], a[252:255], v[92:95]
  ds_read_b64_tr_b16 a[14:15], v3 offset:4096
  v_mfma_f32_16x16x32_bf16 v[88:91], a[60:63], a[248:251], v[88:91]
  ds_read_b64_tr_b16 a[28:29], v3 offset:8192
  buffer_load_dwordx4 a[188:191], v9, s[4:7], s48 offen offset:3072 sc1
  v_mfma_f32_16x16x32_bf16 v[88:91], a[44:47], a[240:243], v[88:91]
  s_sub_u32 s56, s56, 1
  ds_read_b64_tr_b16 a[30:31], v3 offset:12288
  s_cmp_lg_u32 s56, 0
  s_cbranch_scc1 Lp4_loop
Lmk_Lp4_loop_tail:
  s_waitcnt vmcnt(24) lgkmcnt(8)
  v_mfma_f32_16x16x32_bf16 v[32:35], a[0:3], a[128:131], v[32:35]
  s_waitcnt vmcnt(26)
  s_barrier
  ds_read_b64_tr_b16 a[32:33], v0 offset:1024
  v_mfma_f32_16x16x32_bf16 v[32:35], a[16:19], a[136:139], v[32:35]
  s_add_u32 m0, s79, 98304
  ds_read_b64_tr_b16 a[34:35], v0 offset:5120
  s_add_u32 s92, s92, 196608
  v_mfma_f32_16x16x32_bf16 v[36:39], a[16:19], a[140:143], v[36:39]
  ds_read_b64_tr_b16 a[48:49], v0 offset:9216
  buffer_load_dwordx4 v252, s[80:83], s92 offen lds
  v_mfma_f32_16x16x32_bf16 v[36:39], a[0:3], a[132:135], v[36:39]
  ds_read_b64_tr_b16 a[50:51], v0 offset:13312
  v_mfma_f32_16x16x32_bf16 v[44:47], a[4:7], a[132:135], v[44:47]
  ds_read_b64_tr_b16 a[36:37], v1 offset:1024
  v_mfma_f32_16x16x32_bf16 v[44:47], a[20:23], a[140:143], v[44:47]
  ds_read_b64_tr_b16 a[38:39], v1 offset:5120
  v_mfma_f32_16x16x32_bf16 v[40:43], a[20:23], a[136:139], v[40:43]
  ds_read_b64_tr_b16 a[52:53], v1 offset:9216
  buffer_load_dwordx4 v252, s[84:87], s92 offen offset:1024 lds
  v_mfma_f32_16x16x32_bf16 v[40:43], a[4:7], a[128:131], v[40:43]
  ds_read_b64_tr_b16 a[54:55], v1 offset:13312
  s_waitcnt lgkmcnt(8)
  v_mfma_f32_16x16x32_bf16 v[48:51], a[8:11], a[128:131], v[48:51]
  ds_read_b64_tr_b16 a[40:41], v2 offset:1024
  v_mfma_f32_16x16x32_bf16 v[48:51], a[24:27], a[136:139], v[48:51]
  ds_read_b64_tr_b16 a[42:43], v2 offset:5120
  s_add_u32 s48, s48, 4096
  v_mfma_f32_16x16x32_bf16 v[52:55], a[24:27], a[140:143], v[52:55]
  ds_read_b64_tr_b16 a[56:57], v2 offset:9216
  buffer_load_dwordx4 a[192:195], v8, s[4:7], s48 offen offset:0 sc1
  v_mfma_f32_16x16x32_bf16 v[52:55], a[8:11], a[132:135], v[52:55]
  ds_read_b64_tr_b16 a[58:59], v2 offset:13312
  v_mfma_f32_16x16x32_bf16 v[60:63], a[12:15], a[132:135], v[60:63]
  ds_read_b64_tr_b16 a[44:45], v3 offset:1024
  v_mfma_f32_16x16x32_bf16 v[60:63], a[28:31], a[140:143], v[60:63]
  ds_read_b64_tr_b16 a[46:47], v3 offset:5120
  v_mfma_f32_16x16x32_bf16 v[56:59], a[28:31], a[136:139], v[56:59]
  ds_read_b64_tr_b16 a[60:61], v3 offset:9216
  buffer_load_dwordx4 a[196:199], v9, s[4:7], s48 offen offset:0 sc1
  v_mfma_f32_16x16x32_bf16 v[56:59], a[12:15], a[128:131], v[56:59]
  ds_read_b64_tr_b16 a[62:63], v3 offset:13312
  s_waitcnt lgkmcnt(8)
  v_mfma_f32_16x16x32_bf16 v[64:67], a[32:35], a[128:131], v[64:67]
  ds_read_b64_tr_b16 a[0:1], v0 offset:16384
  s_add_u32 m0, s79, 106496
  v_mfma_f32_16x16x32_bf16 v[64:67], a[48:51], a[136:139], v[64:67]
  ds_read_b64_tr_b16 a[2:3], v0 offset:20480
  s_add_u32 s92, s92, 262144
  v_mfma_f32_16x16x32_bf16 v[68:71], a[48:51], a[140:143], v[68:71]
  ds_read_b64_tr_b16 a[16:17], v0 offset:24576
  buffer_load_dwordx4 v252, s[80:83], s92 offen lds
  v_mfma_f32_16x16x32_bf16 v[68:71], a[32:35], a[132:135], v[68:71]
  ds_read_b64_tr_b16 a[18:19], v0 offset:28672
  v_mfma_f32_16x16x32_bf16 v[76:79], a[36:39], a[132:135], v[76:79]
  ds_read_b64_tr_b16 a[4:5], v1 offset:16384
  v_mfma_f32_16x16x32_bf16 v[76:79], a[52:55], a[140:143], v[76:79]
  ds_read_b64_tr_b16 a[6:7], v1 offset:20480
  v_mfma_f32_16x16x32_bf16 v[72:75], a[52:55], a[136:139], v[72:75]
  ds_read_b64_tr_b16 a[20:21], v1 offset:24576
  buffer_load_dwordx4 v252, s[84:87], s92 offen offset:1024 lds
  v_mfma_f32_16x16x32_bf16 v[72:75], a[36:39], a[128:131], v[72:75]
  ds_read_b64_tr_b16 a[22:23], v1 offset:28672
  s_waitcnt lgkmcnt(8)
  v_mfma_f32_16x16x32_bf16 v[80:83], a[40:43], a[128:131], v[80:83]
  ds_read_b64_tr_b16 a[8:9], v2 offset:16384
  v_mfma_f32_16x16x32_bf16 v[80:83], a[56:59], a[136:139], v[80:83]
  ds_read_b64_tr_b16 a[10:11], v2 offset:20480
  v_mfma_f32_16x16x32_bf16 v[84:87], a[56:59], a[140:143], v[84:87]
  ds_read_b64_tr_b16 a[24:25], v2 offset:24576
  buffer_load_dwordx4 a[200:203], v8, s[4:7], s48 offen offset:1024 sc1
  v_mfma_f32_16x16x32_bf16 v[84:87], a[40:43], a[132:135], v[84:87]
  ds_read_b64_tr_b16 a[26:27], v2 offset:28672
  v_mfma_f32_16x16x32_bf16 v[92:95], a[44:47], a[132:135], v[92:95]
  ds_read_b64_tr_b16 a[12:13], v3 offset:16384
  v_mfma_f32_16x16x32_bf16 v[92:95], a[60:63], a[140:143], v[92:95]
  ds_read_b64_tr_b16 a[14:15], v3 offset:20480
  v_mfma_f32_16x16x32_bf16 v[88:91], a[60:63], a[136:139], v[88:91]
  ds_read_b64_tr_b16 a[28:29], v3 offset:24576
  buffer_load_dwordx4 a[204:207], v9, s[4:7], s48 offen offset:1024 sc1
  v_mfma_f32_16x16x32_bf16 v[88:91], a[44:47], a[128:131], v[88:91]
  ds_read_b64_tr_b16 a[30:31], v3 offset:28672
  s_waitcnt vmcnt(24) lgkmcnt(8)
  v_mfma_f32_16x16x32_bf16 v[32:35], a[0:3], a[144:147], v[32:35]
  ds_read_b64_tr_b16 a[32:33], v0 offset:17408
  s_add_u32 m0, s79, 114688
  v_mfma_f32_16x16x32_bf16 v[32:35], a[16:19], a[152:155], v[32:35]
  ds_read_b64_tr_b16 a[34:35], v0 offset:21504
  s_add_u32 s92, s92, 196608
  v_mfma_f32_16x16x32_bf16 v[36:39], a[16:19], a[156:159], v[36:39]
  ds_read_b64_tr_b16 a[48:49], v0 offset:25600
  buffer_load_dwordx4 v252, s[80:83], s92 offen lds
  v_mfma_f32_16x16x32_bf16 v[36:39], a[0:3], a[148:151], v[36:39]
  ds_read_b64_tr_b16 a[50:51], v0 offset:29696
  v_mfma_f32_16x16x32_bf16 v[44:47], a[4:7], a[148:151], v[44:47]
  ds_read_b64_tr_b16 a[36:37], v1 offset:17408
  v_mfma_f32_16x16x32_bf16 v[44:47], a[20:23], a[156:159], v[44:47]
  ds_read_b64_tr_b16 a[38:39], v1 offset:21504
  v_mfma_f32_16x16x32_bf16 v[40:43], a[20:23], a[152:155], v[40:43]
  ds_read_b64_tr_b16 a[52:53], v1 offset:25600
  buffer_load_dwordx4 v252, s[84:87], s92 offen offset:1024 lds
  v_mfma_f32_16x16x32_bf16 v[40:43], a[4:7], a[144:147], v[40:43]
  ds_read_b64_tr_b16 a[54:55], v1 offset:29696
  s_waitcnt lgkmcnt(8)
  v_mfma_f32_16x16x32_bf16 v[48:51], a[8:11], a[144:147], v[48:51]
  ds_read_b64_tr_b16 a[40:41], v2 offset:17408
  v_mfma_f32_16x16x32_bf16 v[48:51], a[24:27], a[152:155], v[48:51]
  ds_read_b64_tr_b16 a[42:43], v2 offset:21504
  v_mfma_f32_16x16x32_bf16 v[52:55], a[24:27], a[156:159], v[52:55]
  ds_read_b64_tr_b16 a[56:57], v2 offset:25600
  buffer_load_dwordx4 a[208:211], v8, s[4:7], s48 offen offset:2048 sc1
  v_mfma_f32_16x16x32_bf16 v[52:55], a[8:11], a[148:151], v[52:55]
  ds_read_b64_tr_b16 a[58:59], v2 offset:29696
  v_mfma_f32_16x16x32_bf16 v[60:63], a[12:15], a[148:151], v[60:63]
  ds_read_b64_tr_b16 a[44:45], v3 offset:17408
  v_mfma_f32_16x16x32_bf16 v[60:63], a[28:31], a[156:159], v[60:63]
  ds_read_b64_tr_b16 a[46:47], v3 offset:21504
  v_mfma_f32_16x16x32_bf16 v[56:59], a[28:31], a[152:155], v[56:59]
  ds_read_b64_tr_b16 a[60:61], v3 offset:25600
  buffer_load_dwordx4 a[212:215], v9, s[4:7], s48 offen offset:2048 sc1
  v_mfma_f32_16x16x32_bf16 v[56:59], a[12:15], a[144:147], v[56:59]
  ds_read_b64_tr_b16 a[62:63], v3 offset:29696
  s_waitcnt lgkmcnt(8)
  v_mfma_f32_16x16x32_bf16 v[64:67], a[32:35], a[144:147], v[64:67]
  ds_read_b64_tr_b16 a[0:1], v0 offset:32768
  s_add_u32 m0, s79, 122880
  v_mfma_f32_16x16x32_bf16 v[64:67], a[48:51], a[152:155], v[64:67]
  ds_read_b64_tr_b16 a[2:3], v0 offset:36864
  s_add_u32 s92, s92, 262144
  v_mfma_f32_16x16x32_bf16 v[68:71], a[48:51], a[156:159], v[68:71]
  ds_read_b64_tr_b16 a[16:17], v0 offset:40960
  buffer_load_dwordx4 v252, s[80:83], s92 offen lds
  v_mfma_f32_16x16x32_bf16 v[68:71], a[32:35], a[148:151], v[68:71]
  ds_read_b64_tr_b16 a[18:19], v0 offset:45056
  v_mfma_f32_16x16x32_bf16 v[76:79], a[36:39], a[148:151], v[76:79]
  ds_read_b64_tr_b16 a[4:5], v1 offset:32768
  v_mfma_f32_16x16x32_bf16 v[76:79], a[52:55], a[156:159], v[76:79]
  ds_read_b64_tr_b16 a[6:7], v1 offset:36864
  v_mfma_f32_16x16x32_bf16 v[72:75], a[52:55], a[152:155], v[72:75]
  ds_read_b64_tr_b16 a[20:21], v1 offset:40960
  buffer_load_dwordx4 v252, s[84:87], s92 offen offset:1024 lds
  v_mfma_f32_16x16x32_bf16 v[72:75], a[36:39], a[144:147], v[72:75]
  ds_read_b64_tr_b16 a[22:23], v1 offset:45056
  s_waitcnt lgkmcnt(8)
  v_mfma_f32_16x16x32_bf16 v[80:83], a[40:43], a[144:147], v[80:83]
  ds_read_b64_tr_b16 a[8:9], v2 offset:32768
  v_mfma_f32_16x16x32_bf16 v[80:83], a[56:59], a[152:155], v[80:83]
  ds_read_b64_tr_b16 a[10:11], v2 offset:36864
  v_mfma_f32_16x16x32_bf16 v[84:87], a[56:59], a[156:159], v[84:87]
  ds_read_b64_tr_b16 a[24:25], v2 offset:40960
  buffer_load_dwordx4 a[216:219], v8, s[4:7], s48 offen offset:3072 sc1
  v_mfma_f32_16x16x32_bf16 v[84:87], a[40:43], a[148:151], v[84:87]
  ds_read_b64_tr_b16 a[26:27], v2 offset:45056
  v_mfma_f32_16x16x32_bf16 v[92:95], a[44:47], a[148:151], v[92:95]
  ds_read_b64_tr_b16 a[12:13], v3 offset:32768
  v_mfma_f32_16x16x32_bf16 v[92:95], a[60:63], a[156:159], v[92:95]
  ds_read_b64_tr_b16 a[14:15], v3 offset:36864
  v_mfma_f32_16x16x32_bf16 v[88:91], a[60:63], a[152:155], v[88:91]
  ds_read_b64_tr_b16 a[28:29], v3 offset:40960
  buffer_load_dwordx4 a[220:223], v9, s[4:7], s48 offen offset:3072 sc1
  v_mfma_f32_16x16x32_bf16 v[88:91], a[44:47], a[144:147], v[88:91]
  ds_read_b64_tr_b16 a[30:31], v3 offset:45056
  s_waitcnt vmcnt(24) lgkmcnt(8)
  v_mfma_f32_16x16x32_bf16 v[32:35], a[0:3], a[160:163], v[32:35]
  s_waitcnt vmcnt(26)
  s_barrier
  ds_read_b64_tr_b16 a[32:33], v0 offset:33792
  s_add_u32 m0, s79, 0
  v_mfma_f32_16x16x32_bf16 v[32:35], a[16:19], a[168:171], v[32:35]
  s_add_u32 s92, s92, -3407872
  ds_read_b64_tr_b16 a[34:35], v0 offset:37888
  s_add_u32 s92, s92, s78
  v_mfma_f32_16x16x32_bf16 v[36:39], a[16:19], a[172:175], v[36:39]
  ds_read_b64_tr_b16 a[48:49], v0 offset:41984
  buffer_load_dwordx4 v252, s[80:83], s92 offen lds
  v_mfma_f32_16x16x32_bf16 v[36:39], a[0:3], a[164:167], v[36:39]
  ds_read_b64_tr_b16 a[50:51], v0 offset:46080
  v_mfma_f32_16x16x32_bf16 v[44:47], a[4:7], a[164:167], v[44:47]
  ds_read_b64_tr_b16 a[36:37], v1 offset:33792
  v_mfma_f32_16x16x32_bf16 v[44:47], a[20:23], a[172:175], v[44:47]
  ds_read_b64_tr_b16 a[38:39], v1 offset:37888
  v_mfma_f32_16x16x32_bf16 v[40:43], a[20:23], a[168:171], v[40:43]
  ds_read_b64_tr_b16 a[52:53], v1 offset:41984
  buffer_load_dwordx4 v252, s[84:87], s92 offen offset:1024 lds
  v_mfma_f32_16x16x32_bf16 v[40:43], a[4:7], a[160:163], v[40:43]
  ds_read_b64_tr_b16 a[54:55], v1 offset:46080
  s_waitcnt lgkmcnt(8)
  v_mfma_f32_16x16x32_bf16 v[48:51], a[8:11], a[160:163], v[48:51]
  ds_read_b64_tr_b16 a[40:41], v2 offset:33792
  v_mfma_f32_16x16x32_bf16 v[48:51], a[24:27], a[168:171], v[48:51]
  ds_read_b64_tr_b16 a[42:43], v2 offset:37888
  s_add_u32 s48, s48, 4096
  v_mfma_f32_16x16x32_bf16 v[52:55], a[24:27], a[172:175], v[52:55]
  ds_read_b64_tr_b16 a[56:57], v2 offset:41984
  buffer_load_dwordx4 a[224:227], v8, s[4:7], s48 offen offset:0 sc1
  v_mfma_f32_16x16x32_bf16 v[52:55], a[8:11], a[164:167], v[52:55]
  ds_read_b64_tr_b16 a[58:59], v2 offset:46080
  v_mfma_f32_16x16x32_bf16 v[60:63], a[12:15], a[164:167], v[60:63]
  ds_read_b64_tr_b16 a[44:45], v3 offset:33792
  v_mfma_f32_16x16x32_bf16 v[60:63], a[28:31], a[172:175], v[60:63]
  ds_read_b64_tr_b16 a[46:47], v3 offset:37888
  v_mfma_f32_16x16x32_bf16 v[56:59], a[28:31], a[168:171], v[56:59]
  ds_read_b64_tr_b16 a[60:61], v3 offset:41984
  buffer_load_dwordx4 a[228:231], v9, s[4:7], s48 offen offset:0 sc1
  v_mfma_f32_16x16x32_bf16 v[56:59], a[12:15], a[160:163], v[56:59]
  ds_read_b64_tr_b16 a[62:63], v3 offset:46080
  s_waitcnt lgkmcnt(8)
  v_mfma_f32_16x16x32_bf16 v[64:67], a[32:35], a[160:163], v[64:67]
  ds_read_b64_tr_b16 a[0:1], v0 offset:49152
  s_add_u32 m0, s79, 8192
  v_mfma_f32_16x16x32_bf16 v[64:67], a[48:51], a[168:171], v[64:67]
  ds_read_b64_tr_b16 a[2:3], v0 offset:53248
  s_add_u32 s92, s92, 458752
  v_mfma_f32_16x16x32_bf16 v[68:71], a[48:51], a[172:175], v[68:71]
  ds_read_b64_tr_b16 a[16:17], v0 offset:57344
  buffer_load_dwordx4 v252, s[80:83], s92 offen lds
  v_mfma_f32_16x16x32_bf16 v[68:71], a[32:35], a[164:167], v[68:71]
  ds_read_b64_tr_b16 a[18:19], v0 offset:61440
  v_mfma_f32_16x16x32_bf16 v[76:79], a[36:39], a[164:167], v[76:79]
  ds_read_b64_tr_b16 a[4:5], v1 offset:49152
  v_mfma_f32_16x16x32_bf16 v[76:79], a[52:55], a[172:175], v[76:79]
  ds_read_b64_tr_b16 a[6:7], v1 offset:53248
  v_mfma_f32_16x16x32_bf16 v[72:75], a[52:55], a[168:171], v[72:75]
  ds_read_b64_tr_b16 a[20:21], v1 offset:57344
  buffer_load_dwordx4 v252, s[84:87], s92 offen offset:1024 lds
  v_mfma_f32_16x16x32_bf16 v[72:75], a[36:39], a[160:163], v[72:75]
  ds_read_b64_tr_b16 a[22:23], v1 offset:61440
  s_waitcnt lgkmcnt(8)
  v_mfma_f32_16x16x32_bf16 v[80:83], a[40:43], a[160:163], v[80:83]
  ds_read_b64_tr_b16 a[8:9], v2 offset:49152
  v_mfma_f32_16x16x32_bf16 v[80:83], a[56:59], a[168:171], v[80:83]
  ds_read_b64_tr_b16 a[10:11], v2 offset:53248
  v_mfma_f32_16x16x32_bf16 v[84:87], a[56:59], a[172:175], v[84:87]
  ds_read_b64_tr_b16 a[24:25], v2 offset:57344
  buffer_load_dwordx4 a[232:235], v8, s[4:7], s48 offen offset:1024 sc1
  v_mfma_f32_16x16x32_bf16 v[84:87], a[40:43], a[164:167], v[84:87]
  ds_read_b64_tr_b16 a[26:27], v2 offset:61440
  v_mfma_f32_16x16x32_bf16 v[92:95], a[44:47], a[164:167], v[92:95]
  ds_read_b64_tr_b16 a[12:13], v3 offset:49152
  v_mfma_f32_16x16x32_bf16 v[92:95], a[60:63], a[172:175], v[92:95]
  ds_read_b64_tr_b16 a[14:15], v3 offset:53248
  v_mfma_f32_16x16x32_bf16 v[88:91], a[60:63], a[168:171], v[88:91]
  ds_read_b64_tr_b16 a[28:29], v3 offset:57344
  buffer_load_dwordx4 a[236:239], v9, s[4:7], s48 offen offset:1024 sc1
  v_mfma_f32_16x16x32_bf16 v[88:91], a[44:47], a[160:163], v[88:91]
  ds_read_b64_tr_b16 a[30:31], v3 offset:61440
  s_waitcnt vmcnt(24) lgkmcnt(8)
  v_mfma_f32_16x16x32_bf16 v[32:35], a[0:3], a[176:179], v[32:35]
  ds_read_b64_tr_b16 a[32:33], v0 offset:50176
  s_add_u32 m0, s79, 16384
  v_mfma_f32_16x16x32_bf16 v[32:35], a[16:19], a[184:187], v[32:35]
  ds_read_b64_tr_b16 a[34:35], v0 offset:54272
  s_add_u32 s92, s92, 458752
  v_mfma_f32_16x16x32_bf16 v[36:39], a[16:19], a[188:191], v[36:39]
  ds_read_b64_tr_b16 a[48:49], v0 offset:58368
  buffer_load_dwordx4 v252, s[80:83], s92 offen lds
  v_mfma_f32_16x16x32_bf16 v[36:39], a[0:3], a[180:183], v[36:39]
  ds_read_b64_tr_b16 a[50:51], v0 offset:62464
  v_mfma_f32_16x16x32_bf16 v[44:47], a[4:7], a[180:183], v[44:47]
  ds_read_b64_tr_b16 a[36:37], v1 offset:50176
  v_mfma_f32_16x16x32_bf16 v[44:47], a[20:23], a[188:191], v[44:47]
  ds_read_b64_tr_b16 a[38:39], v1 offset:54272
  v_mfma_f32_16x16x32_bf16 v[40:43], a[20:23], a[184:187], v[40:43]
  ds_read_b64_tr_b16 a[52:53], v1 offset:58368
  buffer_load_dwordx4 v252, s[84:87], s92 offen offset:1024 lds
  v_mfma_f32_16x16x32_bf16 v[40:43], a[4:7], a[176:179], v[40:43]
  ds_read_b64_tr_b16 a[54:55], v1 offset:62464
  s_waitcnt lgkmcnt(8)
  v_mfma_f32_16x16x32_bf16 v[48:51], a[8:11], a[176:179], v[48:51]
  ds_read_b64_tr_b16 a[40:41], v2 offset:50176
  v_mfma_f32_16x16x32_bf16 v[48:51], a[24:27], a[184:187], v[48:51]
  ds_read_b64_tr_b16 a[42:43], v2 offset:54272
  v_mfma_f32_16x16x32_bf16 v[52:55], a[24:27], a[188:191], v[52:55]
  ds_read_b64_tr_b16 a[56:57], v2 offset:58368
  buffer_load_dwordx4 a[240:243], v8, s[4:7], s48 offen offset:2048 sc1
  v_mfma_f32_16x16x32_bf16 v[52:55], a[8:11], a[180:183], v[52:55]
  ds_read_b64_tr_b16 a[58:59], v2 offset:62464
  v_mfma_f32_16x16x32_bf16 v[60:63], a[12:15], a[180:183], v[60:63]
  ds_read_b64_tr_b16 a[44:45], v3 offset:50176
  v_mfma_f32_16x16x32_bf16 v[60:63], a[28:31], a[188:191], v[60:63]
  ds_read_b64_tr_b16 a[46:47], v3 offset:54272
  v_mfma_f32_16x16x32_bf16 v[56:59], a[28:31], a[184:187], v[56:59]
  ds_read_b64_tr_b16 a[60:61], v3 offset:58368
  buffer_load_dwordx4 a[244:247], v9, s[4:7], s48 offen offset:2048 sc1
  v_mfma_f32_16x16x32_bf16 v[56:59], a[12:15], a[176:179], v[56:59]
  ds_read_b64_tr_b16 a[62:63], v3 offset:62464
  s_waitcnt lgkmcnt(8)
  v_mfma_f32_16x16x32_bf16 v[64:67], a[32:35], a[176:179], v[64:67]
  ds_read_b64_tr_b16 a[0:1], v4 offset:0
  s_add_u32 m0, s79, 24576
  v_mfma_f32_16x16x32_bf16 v[64:67], a[48:51], a[184:187], v[64:67]
  ds_read_b64_tr_b16 a[2:3], v4 offset:4096
  s_add_u32 s92, s92, 458752
  v_mfma_f32_16x16x32_bf16 v[68:71], a[48:51], a[188:191], v[68:71]
  ds_read_b64_tr_b16 a[16:17], v4 offset:8192
  buffer_load_dwordx4 v252, s[80:83], s92 offen lds
  v_mfma_f32_16x16x32_bf16 v[68:71], a[32:35], a[180:183], v[68:71]
  ds_read_b64_tr_b16 a[18:19], v4 offset:12288
  v_mfma_f32_16x16x32_bf16 v[76:79], a[36:39], a[180:183], v[76:79]
  ds_read_b64_tr_b16 a[4:5], v5 offset:0
  v_mfma_f32_16x16x32_bf16 v[76:79], a[52:55], a[188:191], v[76:79]
  ds_read_b64_tr_b16 a[6:7], v5 offset:4096
  v_mfma_f32_16x16x32_bf16 v[72:75], a[52:55], a[184:187], v[72:75]
  ds_read_b64_tr_b16 a[20:21], v5 offset:8192
  buffer_load_dwordx4 v252, s[84:87], s92 offen offset:1024 lds
  v_mfma_f32_16x16x32_bf16 v[72:75], a[36:39], a[176:179], v[72:75]
  ds_read_b64_tr_b16 a[22:23], v5 offset:12288
  s_waitcnt lgkmcnt(8)
  v_mfma_f32_16x16x32_bf16 v[80:83], a[40:43], a[176:179], v[80:83]
  ds_read_b64_tr_b16 a[8:9], v6 offset:0
  v_mfma_f32_16x16x32_bf16 v[80:83], a[56:59], a[184:187], v[80:83]
  ds_read_b64_tr_b16 a[10:11], v6 offset:4096
  v_mfma_f32_16x16x32_bf16 v[84:87], a[56:59], a[188:191], v[84:87]
  ds_read_b64_tr_b16 a[24:25], v6 offset:8192
  buffer_load_dwordx4 a[248:251], v8, s[4:7], s48 offen offset:3072 sc1
  v_mfma_f32_16x16x32_bf16 v[84:87], a[40:43], a[180:183], v[84:87]
  ds_read_b64_tr_b16 a[26:27], v6 offset:12288
  v_mfma_f32_16x16x32_bf16 v[92:95], a[44:47], a[180:183], v[92:95]
  ds_read_b64_tr_b16 a[12:13], v7 offset:0
  v_mfma_f32_16x16x32_bf16 v[92:95], a[60:63], a[188:191], v[92:95]
  ds_read_b64_tr_b16 a[14:15], v7 offset:4096
  v_mfma_f32_16x16x32_bf16 v[88:91], a[60:63], a[184:187], v[88:91]
  ds_read_b64_tr_b16 a[28:29], v7 offset:8192
  buffer_load_dwordx4 a[252:255], v9, s[4:7], s48 offen offset:3072 sc1
  v_mfma_f32_16x16x32_bf16 v[88:91], a[44:47], a[176:179], v[88:91]
  ds_read_b64_tr_b16 a[30:31], v7 offset:12288
  s_waitcnt vmcnt(24) lgkmcnt(8)
  v_mfma_f32_16x16x32_bf16 v[32:35], a[0:3], a[192:195], v[32:35]
  s_waitcnt vmcnt(26)
  s_barrier
  ds_read_b64_tr_b16 a[32:33], v4 offset:16384
  v_mfma_f32_16x16x32_bf16 v[32:35], a[16:19], a[200:203], v[32:35]
  s_add_u32 m0, s79, 32768
  ds_read_b64_tr_b16 a[34:35], v4 offset:20480
  s_add_u32 s92, s92, 458752
  v_mfma_f32_16x16x32_bf16 v[36:39], a[16:19], a[204:207], v[36:39]
  ds_read_b64_tr_b16 a[48:49], v4 offset:24576
  buffer_load_dwordx4 v252, s[80:83], s92 offen lds
  v_mfma_f32_16x16x32_bf16 v[36:39], a[0:3], a[196:199], v[36:39]
  ds_read_b64_tr_b16 a[50:51], v4 offset:28672
  v_mfma_f32_16x16x32_bf16 v[44:47], a[4:7], a[196:199], v[44:47]
  ds_read_b64_tr_b16 a[36:37], v5 offset:16384
  buffer_load_dwordx4 v252, s[84:87], s92 offen offset:1024 lds
  v_mfma_f32_16x16x32_bf16 v[44:47], a[20:23], a[204:207], v[44:47]
  ds_read_b64_tr_b16 a[38:39], v5 offset:20480
  s_add_u32 s48, s48, 4096
  v_mfma_f32_16x16x32_bf16 v[40:43], a[20:23], a[200:203], v[40:43]
  ds_read_b64_tr_b16 a[52:53], v5 offset:24576
  buffer_load_dwordx4 a[128:131], v8, s[4:7], s48 offen offset:0 sc1
  v_mfma_f32_16x16x32_bf16 v[40:43], a[4:7], a[192:195], v[40:43]
  ds_read_b64_tr_b16 a[54:55], v5 offset:28672
  s_waitcnt lgkmcnt(8)
  v_mfma_f32_16x16x32_bf16 v[48:51], a[8:11], a[192:195], v[48:51]
  s_add_u32 m0, s79, 40960
  ds_read_b64_tr_b16 a[40:41], v6 offset:16384
  buffer_load_dwordx4 a[132:135], v9, s[4:7], s48 offen offset:0 sc1
  v_mfma_f32_16x16x32_bf16 v[48:51], a[24:27], a[200:203], v[48:51]
  ds_read_b64_tr_b16 a[42:43], v6 offset:20480
  s_add_u32 s92, s92, 458752
  v_mfma_f32_16x16x32_bf16 v[52:55], a[24:27], a[204:207], v[52:55]
  ds_read_b64_tr_b16 a[56:57], v6 offset:24576
  buffer_load_dwordx4 v252, s[80:83], s92 offen lds
  v_mfma_f32_16x16x32_bf16 v[52:55], a[8:11], a[196:199], v[52:55]
  ds_read_b64_tr_b16 a[58:59], v6 offset:28672
  v_mfma_f32_16x16x32_bf16 v[60:63], a[12:15], a[196:199], v[60:63]
  ds_read_b64_tr_b16 a[44:45], v7 offset:16384
  buffer_load_dwordx4 v252, s[84:87], s92 offen offset:1024 lds
  v_mfma_f32_16x16x32_bf16 v[60:63], a[28:31], a[204:207], v[60:63]
  ds_read_b64_tr_b16 a[46:47], v7 offset:20480
  v_mfma_f32_16x16x32_bf16 v[56:59], a[28:31], a[200:203], v[56:59]
  ds_read_b64_tr_b16 a[60:61], v7 offset:24576
  buffer_load_dwordx4 a[136:139], v8, s[4:7], s48 offen offset:1024 sc1
  v_mfma_f32_16x16x32_bf16 v[56:59], a[12:15], a[192:195], v[56:59]
  s_waitcnt vmcnt(23) lgkmcnt(7)
  ds_read_b64_tr_b16 a[62:63], v7 offset:28672
  buffer_load_dwordx4 a[140:143], v9, s[4:7], s48 offen offset:1024 sc1
  v_mfma_f32_16x16x32_bf16 v[32:35], a[32:35], a[208:211], v[32:35]
  ds_read_b64_tr_b16 a[0:1], v4 offset:32768
  s_add_u32 m0, s79, 49152
  v_mfma_f32_16x16x32_bf16 v[32:35], a[48:51], a[216:219], v[32:35]
  ds_read_b64_tr_b16 a[2:3], v4 offset:36864
  s_add_u32 s92, s92, 458752
  v_mfma_f32_16x16x32_bf16 v[36:39], a[48:51], a[220:223], v[36:39]
  ds_read_b64_tr_b16 a[16:17], v4 offset:40960
  buffer_load_dwordx4 v252, s[80:83], s92 offen lds
  v_mfma_f32_16x16x32_bf16 v[36:39], a[32:35], a[212:215], v[36:39]
  ds_read_b64_tr_b16 a[18:19], v4 offset:45056
  v_mfma_f32_16x16x32_bf16 v[44:47], a[36:39], a[212:215], v[44:47]
  ds_read_b64_tr_b16 a[4:5], v5 offset:32768
  buffer_load_dwordx4 v252, s[84:87], s92 offen offset:1024 lds
  v_mfma_f32_16x16x32_bf16 v[44:47], a[52:55], a[220:223], v[44:47]
  ds_read_b64_tr_b16 a[6:7], v5 offset:36864
  v_mfma_f32_16x16x32_bf16 v[40:43], a[52:55], a[216:219], v[40:43]
  ds_read_b64_tr_b16 a[20:21], v5 offset:40960
  buffer_load_dwordx4 a[144:147], v8, s[4:7], s48 offen offset:2048 sc1
  v_mfma_f32_16x16x32_bf16 v[40:43], a[36:39], a[208:211], v[40:43]
  ds_read_b64_tr_b16 a[22:23], v5 offset:45056
  s_waitcnt lgkmcnt(8)
  v_mfma_f32_16x16x32_bf16 v[48:51], a[40:43], a[208:211], v[48:51]
  s_add_u32 m0, s79, 57344
  ds_read_b64_tr_b16 a[8:9], v6 offset:32768
  buffer_load_dwordx4 a[148:151], v9, s[4:7], s48 offen offset:2048 sc1
  v_mfma_f32_16x16x32_bf16 v[48:51], a[56:59], a[216:219], v[48:51]
  ds_read_b64_tr_b16 a[10:11], v6 offset:36864
  s_add_u32 s92, s92, 458752
  v_mfma_f32_16x16x32_bf16 v[52:55], a[56:59], a[220:223], v[52:55]
  ds_read_b64_tr_b16 a[24:25], v6 offset:40960
  buffer_load_dwordx4 v252, s[80:83], s92 offen lds
  v_mfma_f32_16x16x32_bf16 v[52:55], a[40:43], a[212:215], v[52:55]
  ds_read_b64_tr_b16 a[26:27], v6 offset:45056
  v_mfma_f32_16x16x32_bf16 v[60:63], a[44:47], a[212:215], v[60:63]
  ds_read_b64_tr_b16 a[12:13], v7 offset:32768
  buffer_load_dwordx4 v252, s[84:87], s92 offen offset:1024 lds
  v_mfma_f32_16x16x32_bf16 v[60:63], a[60:63], a[220:223], v[60:63]
  ds_read_b64_tr_b16 a[14:15], v7 offset:36864
  v_mfma_f32_16x16x32_bf16 v[56:59], a[60:63], a[216:219], v[56:59]
  ds_read_b64_tr_b16 a[28:29], v7 offset:40960
  buffer_load_dwordx4 a[152:155], v8, s[4:7], s48 offen offset:3072 sc1
  v_mfma_f32_16x16x32_bf16 v[56:59], a[44:47], a[208:211], v[56:59]
  s_waitcnt vmcnt(23) lgkmcnt(7)
  ds_read_b64_tr_b16 a[30:31], v7 offset:45056
  buffer_load_dwordx4 a[156:159], v9, s[4:7], s48 offen offset:3072 sc1
  v_mfma_f32_16x16x32_bf16 v[32:35], a[0:3], a[224:227], v[32:35]
  s_waitcnt vmcnt(26)
  s_barrier
  ds_read_b64_tr_b16 a[32:33], v4 offset:49152
  v_mfma_f32_16x16x32_bf16 v[32:35], a[16:19], a[232:235], v[32:35]
  ds_read_b64_tr_b16 a[34:35], v4 offset:53248
  s_add_u32 s48, s48, 4096
  v_mfma_f32_16x16x32_bf16 v[36:39], a[16:19], a[236:239], v[36:39]
  ds_read_b64_tr_b16 a[48:49], v4 offset:57344
  buffer_load_dwordx4 a[160:163], v8, s[4:7], s48 offen offset:0 sc1
  v_mfma_f32_16x16x32_bf16 v[36:39], a[0:3], a[228:231], v[36:39]
  ds_read_b64_tr_b16 a[50:51], v4 offset:61440
  v_mfma_f32_16x16x32_bf16 v[44:47], a[4:7], a[228:231], v[44:47]
  ds_read_b64_tr_b16 a[36:37], v5 offset:49152
  v_mfma_f32_16x16x32_bf16 v[44:47], a[20:23], a[236:239], v[44:47]
  ds_read_b64_tr_b16 a[38:39], v5 offset:53248
  v_mfma_f32_16x16x32_bf16 v[40:43], a[20:23], a[232:235], v[40:43]
  ds_read_b64_tr_b16 a[52:53], v5 offset:57344
  buffer_load_dwordx4 a[164:167], v9, s[4:7], s48 offen offset:0 sc1
  v_mfma_f32_16x16x32_bf16 v[40:43], a[4:7], a[224:227], v[40:43]
  ds_read_b64_tr_b16 a[54:55], v5 offset:61440
  s_waitcnt lgkmcnt(8)
  v_mfma_f32_16x16x32_bf16 v[48:51], a[8:11], a[224:227], v[48:51]
  ds_read_b64_tr_b16 a[40:41], v6 offset:49152
  v_mfma_f32_16x16x32_bf16 v[48:51], a[24:27], a[232:235], v[48:51]
  ds_read_b64_tr_b16 a[42:43], v6 offset:53248
  v_mfma_f32_16x16x32_bf16 v[52:55], a[24:27], a[236:239], v[52:55]
  ds_read_b64_tr_b16 a[56:57], v6 offset:57344
  buffer_load_dwordx4 a[168:171], v8, s[4:7], s48 offen offset:1024 sc1
  v_mfma_f32_16x16x32_bf16 v[52:55], a[8:11], a[228:231], v[52:55]
  ds_read_b64_tr_b16 a[58:59], v6 offset:61440
  v_mfma_f32_16x16x32_bf16 v[60:63], a[12:15], a[228:231], v[60:63]
  ds_read_b64_tr_b16 a[44:45], v7 offset:49152
  v_mfma_f32_16x16x32_bf16 v[60:63], a[28:31], a[236:239], v[60:63]
  ds_read_b64_tr_b16 a[46:47], v7 offset:53248
  v_mfma_f32_16x16x32_bf16 v[56:59], a[28:31], a[232:235], v[56:59]
  ds_read_b64_tr_b16 a[60:61], v7 offset:57344
  buffer_load_dwordx4 a[172:175], v9, s[4:7], s48 offen offset:1024 sc1
  v_mfma_f32_16x16x32_bf16 v[56:59], a[12:15], a[224:227], v[56:59]
  ds_read_b64_tr_b16 a[62:63], v7 offset:61440
  s_waitcnt vmcnt(20) lgkmcnt(8)
  v_mfma_f32_16x16x32_bf16 v[32:35], a[32:35], a[240:243], v[32:35]
  ds_read_b64_tr_b16 a[0:1], v0 offset:0
  v_mfma_f32_16x16x32_bf16 v[32:35], a[48:51], a[248:251], v[32:35]
  ds_read_b64_tr_b16 a[2:3], v0 offset:4096
  v_mfma_f32_16x16x32_bf16 v[36:39], a[48:51], a[252:255], v[36:39]
  ds_read_b64_tr_b16 a[16:17], v0 offset:8192
  buffer_load_dwordx4 a[176:179], v8, s[4:7], s48 offen offset:2048 sc1
  v_mfma_f32_16x16x32_bf16 v[36:39], a[32:35], a[244:247], v[36:39]
  ds_read_b64_tr_b16 a[18:19], v0 offset:12288
  v_mfma_f32_16x16x32_bf16 v[44:47], a[36:39], a[244:247], v[44:47]
  ds_read_b64_tr_b16 a[4:5], v1 offset:0
  v_mfma_f32_16x16x32_bf16 v[44:47], a[52:55], a[252:255], v[44:47]
  ds_read_b64_tr_b16 a[6:7], v1 offset:4096
  v_mfma_f32_16x16x32_bf16 v[40:43], a[52:55], a[248:251], v[40:43]
  ds_read_b64_tr_b16 a[20:21], v1 offset:8192
  buffer_load_dwordx4 a[180:183], v9, s[4:7], s48 offen offset:2048 sc1
  v_mfma_f32_16x16x32_bf16 v[40:43], a[36:39], a[240:243], v[40:43]
  ds_read_b64_tr_b16 a[22:23], v1 offset:12288
  s_waitcnt lgkmcnt(8)
  v_mfma_f32_16x16x32_bf16 v[48:51], a[40:43], a[240:243], v[48:51]
  ds_read_b64_tr_b16 a[8:9], v2 offset:0
  v_mfma_f32_16x16x32_bf16 v[48:51], a[56:59], a[248:251], v[48:51]
  ds_read_b64_tr_b16 a[10:11], v2 offset:4096
  v_mfma_f32_16x16x32_bf16 v[52:55], a[56:59], a[252:255], v[52:55]
  ds_read_b64_tr_b16 a[24:25], v2 offset:8192
  buffer_load_dwordx4 a[184:187], v8, s[4:7], s48 offen offset:3072 sc1
  v_mfma_f32_16x16x32_bf16 v[52:55], a[40:43], a[244:247], v[52:55]
  ds_read_b64_tr_b16 a[26:27], v2 offset:12288
  v_mfma_f32_16x16x32_bf16 v[60:63], a[44:47], a[244:247], v[60:63]
  ds_read_b64_tr_b16 a[12:13], v3 offset:0
  v_mfma_f32_16x16x32_bf16 v[60:63], a[60:63], a[252:255], v[60:63]
  ds_read_b64_tr_b16 a[14:15], v3 offset:4096
  v_mfma_f32_16x16x32_bf16 v[56:59], a[60:63], a[248:251], v[56:59]
  ds_read_b64_tr_b16 a[28:29], v3 offset:8192
  buffer_load_dwordx4 a[188:191], v9, s[4:7], s48 offen offset:3072 sc1
  v_mfma_f32_16x16x32_bf16 v[56:59], a[44:47], a[240:243], v[56:59]
  ds_read_b64_tr_b16 a[30:31], v3 offset:12288
  s_waitcnt vmcnt(16) lgkmcnt(8)
  v_mfma_f32_16x16x32_bf16 v[32:35], a[0:3], a[128:131], v[32:35]
  s_waitcnt vmcnt(18)
  s_barrier
  ds_read_b64_tr_b16 a[32:33], v0 offset:16384
  v_mfma_f32_16x16x32_bf16 v[32:35], a[16:19], a[136:139], v[32:35]
  ds_read_b64_tr_b16 a[34:35], v0 offset:20480
  v_mfma_f32_16x16x32_bf16 v[36:39], a[16:19], a[140:143], v[36:39]
  ds_read_b64_tr_b16 a[48:49], v0 offset:24576
  v_mfma_f32_16x16x32_bf16 v[36:39], a[0:3], a[132:135], v[36:39]
  ds_read_b64_tr_b16 a[50:51], v0 offset:28672
  v_mfma_f32_16x16x32_bf16 v[44:47], a[4:7], a[132:135], v[44:47]
  ds_read_b64_tr_b16 a[36:37], v1 offset:16384
  v_mfma_f32_16x16x32_bf16 v[44:47], a[20:23], a[140:143], v[44:47]
  ds_read_b64_tr_b16 a[38:39], v1 offset:20480
  v_mfma_f32_16x16x32_bf16 v[40:43], a[20:23], a[136:139], v[40:43]
  ds_read_b64_tr_b16 a[52:53], v1 offset:24576
  v_mfma_f32_16x16x32_bf16 v[40:43], a[4:7], a[128:131], v[40:43]
  ds_read_b64_tr_b16 a[54:55], v1 offset:28672
  s_waitcnt lgkmcnt(8)
  v_mfma_f32_16x16x32_bf16 v[48:51], a[8:11], a[128:131], v[48:51]
  ds_read_b64_tr_b16 a[40:41], v2 offset:16384
  v_mfma_f32_16x16x32_bf16 v[48:51], a[24:27], a[136:139], v[48:51]
  ds_read_b64_tr_b16 a[42:43], v2 offset:20480
  v_mfma_f32_16x16x32_bf16 v[52:55], a[24:27], a[140:143], v[52:55]
  ds_read_b64_tr_b16 a[56:57], v2 offset:24576
  v_mfma_f32_16x16x32_bf16 v[52:55], a[8:11], a[132:135], v[52:55]
  ds_read_b64_tr_b16 a[58:59], v2 offset:28672
  v_mfma_f32_16x16x32_bf16 v[60:63], a[12:15], a[132:135], v[60:63]
  ds_read_b64_tr_b16 a[44:45], v3 offset:16384
  v_mfma_f32_16x16x32_bf16 v[60:63], a[28:31], a[140:143], v[60:63]
  ds_read_b64_tr_b16 a[46:47], v3 offset:20480
  v_mfma_f32_16x16x32_bf16 v[56:59], a[28:31], a[136:139], v[56:59]
  ds_read_b64_tr_b16 a[60:61], v3 offset:24576
  v_mfma_f32_16x16x32_bf16 v[56:59], a[12:15], a[128:131], v[56:59]
  ds_read_b64_tr_b16 a[62:63], v3 offset:28672
  s_waitcnt vmcnt(8) lgkmcnt(8)
  v_mfma_f32_16x16x32_bf16 v[32:35], a[32:35], a[144:147], v[32:35]
  ds_read_b64_tr_b16 a[0:1], v0 offset:32768
  v_mfma_f32_16x16x32_bf16 v[32:35], a[48:51], a[152:155], v[32:35]
  ds_read_b64_tr_b16 a[2:3], v0 offset:36864
  v_mfma_f32_16x16x32_bf16 v[36:39], a[48:51], a[156:159], v[36:39]
  ds_read_b64_tr_b16 a[16:17], v0 offset:40960
  v_mfma_f32_16x16x32_bf16 v[36:39], a[32:35], a[148:151], v[36:39]
  ds_read_b64_tr_b16 a[18:19], v0 offset:45056
  v_mfma_f32_16x16x32_bf16 v[44:47], a[36:39], a[148:151], v[44:47]
  ds_read_b64_tr_b16 a[4:5], v1 offset:32768
  v_mfma_f32_16x16x32_bf16 v[44:47], a[52:55], a[156:159], v[44:47]
  ds_read_b64_tr_b16 a[6:7], v1 offset:36864
  v_mfma_f32_16x16x32_bf16 v[40:43], a[52:55], a[152:155], v[40:43]
  ds_read_b64_tr_b16 a[20:21], v1 offset:40960
  v_mfma_f32_16x16x32_bf16 v[40:43], a[36:39], a[144:147], v[40:43]
  ds_read_b64_tr_b16 a[22:23], v1 offset:45056
  s_waitcnt lgkmcnt(8)
  v_mfma_f32_16x16x32_bf16 v[48:51], a[40:43], a[144:147], v[48:51]
  ds_read_b64_tr_b16 a[8:9], v2 offset:32768
  v_mfma_f32_16x16x32_bf16 v[48:51], a[56:59], a[152:155], v[48:51]
  ds_read_b64_tr_b16 a[10:11], v2 offset:36864
  v_mfma_f32_16x16x32_bf16 v[52:55], a[56:59], a[156:159], v[52:55]
  ds_read_b64_tr_b16 a[24:25], v2 offset:40960
  v_mfma_f32_16x16x32_bf16 v[52:55], a[40:43], a[148:151], v[52:55]
  ds_read_b64_tr_b16 a[26:27], v2 offset:45056
  v_mfma_f32_16x16x32_bf16 v[60:63], a[44:47], a[148:151], v[60:63]
  ds_read_b64_tr_b16 a[12:13], v3 offset:32768
  v_mfma_f32_16x16x32_bf16 v[60:63], a[60:63], a[156:159], v[60:63]
  ds_read_b64_tr_b16 a[14:15], v3 offset:36864
  v_mfma_f32_16x16x32_bf16 v[56:59], a[60:63], a[152:155], v[56:59]
  ds_read_b64_tr_b16 a[28:29], v3 offset:40960
  v_mfma_f32_16x16x32_bf16 v[56:59], a[44:47], a[144:147], v[56:59]
  ds_read_b64_tr_b16 a[30:31], v3 offset:45056
  s_waitcnt vmcnt(4) lgkmcnt(8)
  v_mfma_f32_16x16x32_bf16 v[32:35], a[0:3], a[160:163], v[32:35]
  s_waitcnt vmcnt(10)
  s_barrier
  ds_read_b64_tr_b16 a[32:33], v0 offset:49152
  v_mfma_f32_16x16x32_bf16 v[32:35], a[16:19], a[168:171], v[32:35]
  ds_read_b64_tr_b16 a[34:35], v0 offset:53248
  v_mfma_f32_16x16x32_bf16 v[36:39], a[16:19], a[172:175], v[36:39]
  ds_read_b64_tr_b16 a[48:49], v0 offset:57344
  v_mfma_f32_16x16x32_bf16 v[36:39], a[0:3], a[164:167], v[36:39]
  ds_read_b64_tr_b16 a[50:51], v0 offset:61440
  v_mfma_f32_16x16x32_bf16 v[44:47], a[4:7], a[164:167], v[44:47]
  ds_read_b64_tr_b16 a[36:37], v1 offset:49152
  v_mfma_f32_16x16x32_bf16 v[44:47], a[20:23], a[172:175], v[44:47]
  ds_read_b64_tr_b16 a[38:39], v1 offset:53248
  v_mfma_f32_16x16x32_bf16 v[40:43], a[20:23], a[168:171], v[40:43]
  ds_read_b64_tr_b16 a[52:53], v1 offset:57344
  v_mfma_f32_16x16x32_bf16 v[40:43], a[4:7], a[160:163], v[40:43]
  ds_read_b64_tr_b16 a[54:55], v1 offset:61440
  s_waitcnt lgkmcnt(8)
  v_mfma_f32_16x16x32_bf16 v[48:51], a[8:11], a[160:163], v[48:51]
  ds_read_b64_tr_b16 a[40:41], v2 offset:49152
  v_mfma_f32_16x16x32_bf16 v[48:51], a[24:27], a[168:171], v[48:51]
  ds_read_b64_tr_b16 a[42:43], v2 offset:53248
  v_mfma_f32_16x16x32_bf16 v[52:55], a[24:27], a[172:175], v[52:55]
  ds_read_b64_tr_b16 a[56:57], v2 offset:57344
  v_mfma_f32_16x16x32_bf16 v[52:55], a[8:11], a[164:167], v[52:55]
  ds_read_b64_tr_b16 a[58:59], v2 offset:61440
  v_mfma_f32_16x16x32_bf16 v[60:63], a[12:15], a[164:167], v[60:63]
  ds_read_b64_tr_b16 a[44:45], v3 offset:49152
  v_mfma_f32_16x16x32_bf16 v[60:63], a[28:31], a[172:175], v[60:63]
  ds_read_b64_tr_b16 a[46:47], v3 offset:53248
  v_mfma_f32_16x16x32_bf16 v[56:59], a[28:31], a[168:171], v[56:59]
  ds_read_b64_tr_b16 a[60:61], v3 offset:57344
  v_mfma_f32_16x16x32_bf16 v[56:59], a[12:15], a[160:163], v[56:59]
  ds_read_b64_tr_b16 a[62:63], v3 offset:61440
  s_waitcnt vmcnt(0) lgkmcnt(8)
  v_mfma_f32_16x16x32_bf16 v[32:35], a[32:35], a[176:179], v[32:35]
  ds_read_b64_tr_b16 a[0:1], v4 offset:1024
  v_mfma_f32_16x16x32_bf16 v[32:35], a[48:51], a[184:187], v[32:35]
  ds_read_b64_tr_b16 a[2:3], v4 offset:5120
  v_mfma_f32_16x16x32_bf16 v[36:39], a[48:51], a[188:191], v[36:39]
  ds_read_b64_tr_b16 a[16:17], v4 offset:9216
  v_mfma_f32_16x16x32_bf16 v[36:39], a[32:35], a[180:183], v[36:39]
  ds_read_b64_tr_b16 a[18:19], v4 offset:13312
  v_mfma_f32_16x16x32_bf16 v[44:47], a[36:39], a[180:183], v[44:47]
  ds_read_b64_tr_b16 a[4:5], v5 offset:1024
  v_mfma_f32_16x16x32_bf16 v[44:47], a[52:55], a[188:191], v[44:47]
  ds_read_b64_tr_b16 a[6:7], v5 offset:5120
  v_mfma_f32_16x16x32_bf16 v[40:43], a[52:55], a[184:187], v[40:43]
  ds_read_b64_tr_b16 a[20:21], v5 offset:9216
  v_mfma_f32_16x16x32_bf16 v[40:43], a[36:39], a[176:179], v[40:43]
  ds_read_b64_tr_b16 a[22:23], v5 offset:13312
  s_waitcnt lgkmcnt(8)
  v_mfma_f32_16x16x32_bf16 v[48:51], a[40:43], a[176:179], v[48:51]
  ds_read_b64_tr_b16 a[8:9], v6 offset:1024
  v_mfma_f32_16x16x32_bf16 v[48:51], a[56:59], a[184:187], v[48:51]
  ds_read_b64_tr_b16 a[10:11], v6 offset:5120
  v_mfma_f32_16x16x32_bf16 v[52:55], a[56:59], a[188:191], v[52:55]
  ds_read_b64_tr_b16 a[24:25], v6 offset:9216
  v_mfma_f32_16x16x32_bf16 v[52:55], a[40:43], a[180:183], v[52:55]
  ds_read_b64_tr_b16 a[26:27], v6 offset:13312
  v_mfma_f32_16x16x32_bf16 v[60:63], a[44:47], a[180:183], v[60:63]
  ds_read_b64_tr_b16 a[12:13], v7 offset:1024
  v_mfma_f32_16x16x32_bf16 v[60:63], a[60:63], a[188:191], v[60:63]
  ds_read_b64_tr_b16 a[14:15], v7 offset:5120
  v_mfma_f32_16x16x32_bf16 v[56:59], a[60:63], a[184:187], v[56:59]
  ds_read_b64_tr_b16 a[28:29], v7 offset:9216
  v_mfma_f32_16x16x32_bf16 v[56:59], a[44:47], a[176:179], v[56:59]
  ds_read_b64_tr_b16 a[30:31], v7 offset:13312
  s_waitcnt lgkmcnt(8)
  v_mfma_f32_16x16x32_bf16 v[64:67], a[0:3], a[192:195], v[64:67]
  s_lshl_b32 s45, s2, 2
  ds_read_b64_tr_b16 a[32:33], v4 offset:17408
  s_add_u32 s45, s45, s40
  v_mfma_f32_16x16x32_bf16 v[64:67], a[16:19], a[200:203], v[64:67]
  s_lshl_b32 s45, s45, 12
  ds_read_b64_tr_b16 a[34:35], v4 offset:21504
  s_xor_b32 s44, s45, 32768
  v_mfma_f32_16x16x32_bf16 v[68:71], a[16:19], a[204:207], v[68:71]
  s_add_u32 s43, s42, 28311552
  ds_read_b64_tr_b16 a[48:49], v4 offset:25600
  s_add_u32 s44, s44, s43
  v_mfma_f32_16x16x32_bf16 v[68:71], a[0:3], a[196:199], v[68:71]
  s_add_u32 s45, s45, s43
  ds_read_b64_tr_b16 a[50:51], v4 offset:29696
  v_cvt_pk_bf16_f32 v16, v32, v33
  v_mfma_f32_16x16x32_bf16 v[76:79], a[4:7], a[196:199], v[76:79]
  ds_read_b64_tr_b16 a[36:37], v5 offset:17408
  v_cvt_pk_bf16_f32 v17, v34, v35
  v_cvt_pk_bf16_f32 v18, v40, v41
  v_mfma_f32_16x16x32_bf16 v[76:79], a[20:23], a[204:207], v[76:79]
  ds_read_b64_tr_b16 a[38:39], v5 offset:21504
  v_cvt_pk_bf16_f32 v19, v42, v43
  buffer_store_dwordx4 v[16:19], v8, s[4:7], s44 offen offset:0 sc1
  v_mfma_f32_16x16x32_bf16 v[72:75], a[20:23], a[200:203], v[72:75]
  ds_read_b64_tr_b16 a[52:53], v5 offset:25600
  v_cvt_pk_bf16_f32 v24, v36, v37
  v_cvt_pk_bf16_f32 v25, v38, v39
  v_mfma_f32_16x16x32_bf16 v[72:75], a[4:7], a[192:195], v[72:75]
  s_waitcnt lgkmcnt(7)
  ds_read_b64_tr_b16 a[54:55], v5 offset:29696
  v_cvt_pk_bf16_f32 v26, v44, v45
  v_cvt_pk_bf16_f32 v27, v46, v47
  v_mfma_f32_16x16x32_bf16 v[80:83], a[8:11], a[192:195], v[80:83]
  ds_read_b64_tr_b16 a[40:41], v6 offset:17408
  buffer_store_dwordx4 v[24:27], v8, s[4:7], s44 offen offset:2048 sc1
  v_cvt_pk_bf16_f32 v20, v48, v49
  v_mfma_f32_16x16x32_bf16 v[80:83], a[24:27], a[200:203], v[80:83]
  ds_read_b64_tr_b16 a[42:43], v6 offset:21504
  v_cvt_pk_bf16_f32 v21, v50, v51
  v_cvt_pk_bf16_f32 v22, v56, v57
  v_mfma_f32_16x16x32_bf16 v[84:87], a[24:27], a[204:207], v[84:87]
  ds_read_b64_tr_b16 a[56:57], v6 offset:25600
  v_cvt_pk_bf16_f32 v23, v58, v59
  buffer_store_dwordx4 v[20:23], v8, s[4:7], s44 offen offset:1024 sc1
  v_mfma_f32_16x16x32_bf16 v[84:87], a[8:11], a[196:199], v[84:87]
  ds_read_b64_tr_b16 a[58:59], v6 offset:29696
  v_cvt_pk_bf16_f32 v28, v52, v53
  v_cvt_pk_bf16_f32 v29, v54, v55
  v_mfma_f32_16x16x32_bf16 v[92:95], a[12:15], a[196:199], v[92:95]
  ds_read_b64_tr_b16 a[44:45], v7 offset:17408
  v_cvt_pk_bf16_f32 v30, v60, v61
  v_cvt_pk_bf16_f32 v31, v62, v63
  v_mfma_f32_16x16x32_bf16 v[92:95], a[28:31], a[204:207], v[92:95]
  ds_read_b64_tr_b16 a[46:47], v7 offset:21504
  buffer_store_dwordx4 v[28:31], v8, s[4:7], s44 offen offset:3072 sc1
  v_mfma_f32_16x16x32_bf16 v[88:91], a[28:31], a[200:203], v[88:91]
  ds_read_b64_tr_b16 a[60:61], v7 offset:25600
  v_mfma_f32_16x16x32_bf16 v[88:91], a[12:15], a[192:195], v[88:91]
  ds_read_b64_tr_b16 a[62:63], v7 offset:29696
  s_waitcnt lgkmcnt(8)
  v_mfma_f32_16x16x32_bf16 v[64:67], a[32:35], a[208:211], v[64:67]
  ds_read_b64_tr_b16 a[0:1], v4 offset:33792
  v_mfma_f32_16x16x32_bf16 v[64:67], a[48:51], a[216:219], v[64:67]
  ds_read_b64_tr_b16 a[2:3], v4 offset:37888
  v_mfma_f32_16x16x32_bf16 v[68:71], a[48:51], a[220:223], v[68:71]
  ds_read_b64_tr_b16 a[16:17], v4 offset:41984
  v_mfma_f32_16x16x32_bf16 v[68:71], a[32:35], a[212:215], v[68:71]
  ds_read_b64_tr_b16 a[18:19], v4 offset:46080
  v_mfma_f32_16x16x32_bf16 v[76:79], a[36:39], a[212:215], v[76:79]
  ds_read_b64_tr_b16 a[4:5], v5 offset:33792
  v_mfma_f32_16x16x32_bf16 v[76:79], a[52:55], a[220:223], v[76:79]
  ds_read_b64_tr_b16 a[6:7], v5 offset:37888
  v_mfma_f32_16x16x32_bf16 v[72:75], a[52:55], a[216:219], v[72:75]
  ds_read_b64_tr_b16 a[20:21], v5 offset:41984
  v_mfma_f32_16x16x32_bf16 v[72:75], a[36:39], a[208:211], v[72:75]
  ds_read_b64_tr_b16 a[22:23], v5 offset:46080
  s_waitcnt lgkmcnt(8)
  v_mfma_f32_16x16x32_bf16 v[80:83], a[40:43], a[208:211], v[80:83]
  ds_read_b64_tr_b16 a[8:9], v6 offset:33792
  v_mfma_f32_16x16x32_bf16 v[80:83], a[56:59], a[216:219], v[80:83]
  ds_read_b64_tr_b16 a[10:11], v6 offset:37888
  v_mfma_f32_16x16x32_bf16 v[84:87], a[56:59], a[220:223], v[84:87]
  ds_read_b64_tr_b16 a[24:25], v6 offset:41984
  v_mfma_f32_16x16x32_bf16 v[84:87], a[40:43], a[212:215], v[84:87]
  ds_read_b64_tr_b16 a[26:27], v6 offset:46080
  v_mfma_f32_16x16x32_bf16 v[92:95], a[44:47], a[212:215], v[92:95]
  ds_read_b64_tr_b16 a[12:13], v7 offset:33792
  v_mfma_f32_16x16x32_bf16 v[92:95], a[60:63], a[220:223], v[92:95]
  ds_read_b64_tr_b16 a[14:15], v7 offset:37888
  v_mfma_f32_16x16x32_bf16 v[88:91], a[60:63], a[216:219], v[88:91]
  ds_read_b64_tr_b16 a[28:29], v7 offset:41984
  v_mfma_f32_16x16x32_bf16 v[88:91], a[44:47], a[208:211], v[88:91]
  ds_read_b64_tr_b16 a[30:31], v7 offset:46080
  s_waitcnt lgkmcnt(8)
  v_mfma_f32_16x16x32_bf16 v[64:67], a[0:3], a[224:227], v[64:67]
  ds_read_b64_tr_b16 a[32:33], v4 offset:50176
  v_mfma_f32_16x16x32_bf16 v[64:67], a[16:19], a[232:235], v[64:67]
  ds_read_b64_tr_b16 a[34:35], v4 offset:54272
  v_mfma_f32_16x16x32_bf16 v[68:71], a[16:19], a[236:239], v[68:71]
  ds_read_b64_tr_b16 a[48:49], v4 offset:58368
  v_mfma_f32_16x16x32_bf16 v[68:71], a[0:3], a[228:231], v[68:71]
  ds_read_b64_tr_b16 a[50:51], v4 offset:62464
  v_mfma_f32_16x16x32_bf16 v[76:79], a[4:7], a[228:231], v[76:79]
  ds_read_b64_tr_b16 a[36:37], v5 offset:50176
  v_mfma_f32_16x16x32_bf16 v[76:79], a[20:23], a[236:239], v[76:79]
  ds_read_b64_tr_b16 a[38:39], v5 offset:54272
  v_mfma_f32_16x16x32_bf16 v[72:75], a[20:23], a[232:235], v[72:75]
  ds_read_b64_tr_b16 a[52:53], v5 offset:58368
  v_mfma_f32_16x16x32_bf16 v[72:75], a[4:7], a[224:227], v[72:75]
  ds_read_b64_tr_b16 a[54:55], v5 offset:62464
  s_waitcnt lgkmcnt(8)
  v_mfma_f32_16x16x32_bf16 v[80:83], a[8:11], a[224:227], v[80:83]
  ds_read_b64_tr_b16 a[40:41], v6 offset:50176
  v_mfma_f32_16x16x32_bf16 v[80:83], a[24:27], a[232:235], v[80:83]
  ds_read_b64_tr_b16 a[42:43], v6 offset:54272
  v_mfma_f32_16x16x32_bf16 v[84:87], a[24:27], a[236:239], v[84:87]
  ds_read_b64_tr_b16 a[56:57], v6 offset:58368
  v_mfma_f32_16x16x32_bf16 v[84:87], a[8:11], a[228:231], v[84:87]
  ds_read_b64_tr_b16 a[58:59], v6 offset:62464
  v_mfma_f32_16x16x32_bf16 v[92:95], a[12:15], a[228:231], v[92:95]
  ds_read_b64_tr_b16 a[44:45], v7 offset:50176
  v_mfma_f32_16x16x32_bf16 v[92:95], a[28:31], a[236:239], v[92:95]
  ds_read_b64_tr_b16 a[46:47], v7 offset:54272
  v_mfma_f32_16x16x32_bf16 v[88:91], a[28:31], a[232:235], v[88:91]
  ds_read_b64_tr_b16 a[60:61], v7 offset:58368
  v_mfma_f32_16x16x32_bf16 v[88:91], a[12:15], a[224:227], v[88:91]
  ds_read_b64_tr_b16 a[62:63], v7 offset:62464
  s_waitcnt lgkmcnt(8)
  v_mfma_f32_16x16x32_bf16 v[64:67], a[32:35], a[240:243], v[64:67]
  ds_read_b64_tr_b16 a[0:1], v0 offset:1024
  v_mfma_f32_16x16x32_bf16 v[64:67], a[48:51], a[248:251], v[64:67]
  ds_read_b64_tr_b16 a[2:3], v0 offset:5120
  v_mfma_f32_16x16x32_bf16 v[68:71], a[48:51], a[252:255], v[68:71]
  ds_read_b64_tr_b16 a[16:17], v0 offset:9216
  v_mfma_f32_16x16x32_bf16 v[68:71], a[32:35], a[244:247], v[68:71]
  ds_read_b64_tr_b16 a[18:19], v0 offset:13312
  v_mfma_f32_16x16x32_bf16 v[76:79], a[36:39], a[244:247], v[76:79]
  ds_read_b64_tr_b16 a[4:5], v1 offset:1024
  v_mfma_f32_16x16x32_bf16 v[76:79], a[52:55], a[252:255], v[76:79]
  ds_read_b64_tr_b16 a[6:7], v1 offset:5120
  v_mfma_f32_16x16x32_bf16 v[72:75], a[52:55], a[248:251], v[72:75]
  ds_read_b64_tr_b16 a[20:21], v1 offset:9216
  v_mfma_f32_16x16x32_bf16 v[72:75], a[36:39], a[240:243], v[72:75]
  ds_read_b64_tr_b16 a[22:23], v1 offset:13312
  s_waitcnt lgkmcnt(8)
  v_mfma_f32_16x16x32_bf16 v[80:83], a[40:43], a[240:243], v[80:83]
  ds_read_b64_tr_b16 a[8:9], v2 offset:1024
  v_mfma_f32_16x16x32_bf16 v[80:83], a[56:59], a[248:251], v[80:83]
  ds_read_b64_tr_b16 a[10:11], v2 offset:5120
  v_mfma_f32_16x16x32_bf16 v[84:87], a[56:59], a[252:255], v[84:87]
  ds_read_b64_tr_b16 a[24:25], v2 offset:9216
  v_mfma_f32_16x16x32_bf16 v[84:87], a[40:43], a[244:247], v[84:87]
  ds_read_b64_tr_b16 a[26:27], v2 offset:13312
  v_mfma_f32_16x16x32_bf16 v[92:95], a[44:47], a[244:247], v[92:95]
  ds_read_b64_tr_b16 a[12:13], v3 offset:1024
  v_mfma_f32_16x16x32_bf16 v[92:95], a[60:63], a[252:255], v[92:95]
  ds_read_b64_tr_b16 a[14:15], v3 offset:5120
  v_mfma_f32_16x16x32_bf16 v[88:91], a[60:63], a[248:251], v[88:91]
  ds_read_b64_tr_b16 a[28:29], v3 offset:9216
  v_mfma_f32_16x16x32_bf16 v[88:91], a[44:47], a[240:243], v[88:91]
  ds_read_b64_tr_b16 a[30:31], v3 offset:13312
  s_waitcnt lgkmcnt(8)
  v_mfma_f32_16x16x32_bf16 v[64:67], a[0:3], a[128:131], v[64:67]
  ds_read_b64_tr_b16 a[32:33], v0 offset:17408
  v_mfma_f32_16x16x32_bf16 v[64:67], a[16:19], a[136:139], v[64:67]
  ds_read_b64_tr_b16 a[34:35], v0 offset:21504
  v_mfma_f32_16x16x32_bf16 v[68:71], a[16:19], a[140:143], v[68:71]
  ds_read_b64_tr_b16 a[48:49], v0 offset:25600
  v_mfma_f32_16x16x32_bf16 v[68:71], a[0:3], a[132:135], v[68:71]
  ds_read_b64_tr_b16 a[50:51], v0 offset:29696
  v_mfma_f32_16x16x32_bf16 v[76:79], a[4:7], a[132:135], v[76:79]
  ds_read_b64_tr_b16 a[36:37], v1 offset:17408
  v_mfma_f32_16x16x32_bf16 v[76:79], a[20:23], a[140:143], v[76:79]
  ds_read_b64_tr_b16 a[38:39], v1 offset:21504
  v_mfma_f32_16x16x32_bf16 v[72:75], a[20:23], a[136:139], v[72:75]
  ds_read_b64_tr_b16 a[52:53], v1 offset:25600
  v_mfma_f32_16x16x32_bf16 v[72:75], a[4:7], a[128:131], v[72:75]
  ds_read_b64_tr_b16 a[54:55], v1 offset:29696
  s_waitcnt lgkmcnt(8)
  v_mfma_f32_16x16x32_bf16 v[80:83], a[8:11], a[128:131], v[80:83]
  ds_read_b64_tr_b16 a[40:41], v2 offset:17408
  v_mfma_f32_16x16x32_bf16 v[80:83], a[24:27], a[136:139], v[80:83]
  ds_read_b64_tr_b16 a[42:43], v2 offset:21504
  v_mfma_f32_16x16x32_bf16 v[84:87], a[24:27], a[140:143], v[84:87]
  ds_read_b64_tr_b16 a[56:57], v2 offset:25600
  v_mfma_f32_16x16x32_bf16 v[84:87], a[8:11], a[132:135], v[84:87]
  ds_read_b64_tr_b16 a[58:59], v2 offset:29696
  v_mfma_f32_16x16x32_bf16 v[92:95], a[12:15], a[132:135], v[92:95]
  ds_read_b64_tr_b16 a[44:45], v3 offset:17408
  v_mfma_f32_16x16x32_bf16 v[92:95], a[28:31], a[140:143], v[92:95]
  ds_read_b64_tr_b16 a[46:47], v3 offset:21504
  v_mfma_f32_16x16x32_bf16 v[88:91], a[28:31], a[136:139], v[88:91]
  ds_read_b64_tr_b16 a[60:61], v3 offset:25600
  v_mfma_f32_16x16x32_bf16 v[88:91], a[12:15], a[128:131], v[88:91]
  ds_read_b64_tr_b16 a[62:63], v3 offset:29696
  s_waitcnt lgkmcnt(8)
  v_mfma_f32_16x16x32_bf16 v[64:67], a[32:35], a[144:147], v[64:67]
  ds_read_b64_tr_b16 a[0:1], v0 offset:33792
  buffer_load_dwordx4 v[96:99], v8, s[4:7], s45 offen offset:0 sc1
  v_mfma_f32_16x16x32_bf16 v[64:67], a[48:51], a[152:155], v[64:67]
  ds_read_b64_tr_b16 a[2:3], v0 offset:37888
  v_mfma_f32_16x16x32_bf16 v[68:71], a[48:51], a[156:159], v[68:71]
  ds_read_b64_tr_b16 a[16:17], v0 offset:41984
  buffer_load_dwordx4 v[100:103], v8, s[4:7], s45 offen offset:1024 sc1
  v_mfma_f32_16x16x32_bf16 v[68:71], a[32:35], a[148:151], v[68:71]
  ds_read_b64_tr_b16 a[18:19], v0 offset:46080
  v_mfma_f32_16x16x32_bf16 v[76:79], a[36:39], a[148:151], v[76:79]
  ds_read_b64_tr_b16 a[4:5], v1 offset:33792
  buffer_load_dwordx4 v[104:107], v8, s[4:7], s45 offen offset:2048 sc1
  v_mfma_f32_16x16x32_bf16 v[76:79], a[52:55], a[156:159], v[76:79]
  ds_read_b64_tr_b16 a[6:7], v1 offset:37888
  v_mfma_f32_16x16x32_bf16 v[72:75], a[52:55], a[152:155], v[72:75]
  ds_read_b64_tr_b16 a[20:21], v1 offset:41984
  buffer_load_dwordx4 v[108:111], v8, s[4:7], s45 offen offset:3072 sc1
  v_mfma_f32_16x16x32_bf16 v[72:75], a[36:39], a[144:147], v[72:75]
  ds_read_b64_tr_b16 a[22:23], v1 offset:46080
  s_waitcnt lgkmcnt(8)
  v_mfma_f32_16x16x32_bf16 v[80:83], a[40:43], a[144:147], v[80:83]
  ds_read_b64_tr_b16 a[8:9], v2 offset:33792
  v_mfma_f32_16x16x32_bf16 v[80:83], a[56:59], a[152:155], v[80:83]
  ds_read_b64_tr_b16 a[10:11], v2 offset:37888
  v_mfma_f32_16x16x32_bf16 v[84:87], a[56:59], a[156:159], v[84:87]
  ds_read_b64_tr_b16 a[24:25], v2 offset:41984
  v_mfma_f32_16x16x32_bf16 v[84:87], a[40:43], a[148:151], v[84:87]
  ds_read_b64_tr_b16 a[26:27], v2 offset:46080
  v_mfma_f32_16x16x32_bf16 v[92:95], a[44:47], a[148:151], v[92:95]
  ds_read_b64_tr_b16 a[12:13], v3 offset:33792
  v_mfma_f32_16x16x32_bf16 v[92:95], a[60:63], a[156:159], v[92:95]
  ds_read_b64_tr_b16 a[14:15], v3 offset:37888
  v_mfma_f32_16x16x32_bf16 v[88:91], a[60:63], a[152:155], v[88:91]
  ds_read_b64_tr_b16 a[28:29], v3 offset:41984
  v_mfma_f32_16x16x32_bf16 v[88:91], a[44:47], a[144:147], v[88:91]
  ds_read_b64_tr_b16 a[30:31], v3 offset:46080
  s_waitcnt lgkmcnt(8)
  v_mfma_f32_16x16x32_bf16 v[64:67], a[0:3], a[160:163], v[64:67]
  ds_read_b64_tr_b16 a[32:33], v0 offset:50176
  v_mfma_f32_16x16x32_bf16 v[64:67], a[16:19], a[168:171], v[64:67]
  ds_read_b64_tr_b16 a[34:35], v0 offset:54272
  v_mfma_f32_16x16x32_bf16 v[68:71], a[16:19], a[172:175], v[68:71]
  ds_read_b64_tr_b16 a[48:49], v0 offset:58368
  v_mfma_f32_16x16x32_bf16 v[68:71], a[0:3], a[164:167], v[68:71]
  ds_read_b64_tr_b16 a[50:51], v0 offset:62464
  v_mfma_f32_16x16x32_bf16 v[76:79], a[4:7], a[164:167], v[76:79]
  ds_read_b64_tr_b16 a[36:37], v1 offset:50176
  v_mfma_f32_16x16x32_bf16 v[76:79], a[20:23], a[172:175], v[76:79]
  ds_read_b64_tr_b16 a[38:39], v1 offset:54272
  v_mfma_f32_16x16x32_bf16 v[72:75], a[20:23], a[168:171], v[72:75]
  ds_read_b64_tr_b16 a[52:53], v1 offset:58368
  v_mfma_f32_16x16x32_bf16 v[72:75], a[4:7], a[160:163], v[72:75]
  ds_read_b64_tr_b16 a[54:55], v1 offset:62464
  s_waitcnt lgkmcnt(8)
  v_mfma_f32_16x16x32_bf16 v[80:83], a[8:11], a[160:163], v[80:83]
  ds_read_b64_tr_b16 a[40:41], v2 offset:50176
  v_mfma_f32_16x16x32_bf16 v[80:83], a[24:27], a[168:171], v[80:83]
  ds_read_b64_tr_b16 a[42:43], v2 offset:54272
  v_mfma_f32_16x16x32_bf16 v[84:87], a[24:27], a[172:175], v[84:87]
  ds_read_b64_tr_b16 a[56:57], v2 offset:58368
  v_mfma_f32_16x16x32_bf16 v[84:87], a[8:11], a[164:167], v[84:87]
  ds_read_b64_tr_b16 a[58:59], v2 offset:62464
  v_mfma_f32_16x16x32_bf16 v[92:95], a[12:15], a[164:167], v[92:95]
  ds_read_b64_tr_b16 a[44:45], v3 offset:50176
  v_mfma_f32_16x16x32_bf16 v[92:95], a[28:31], a[172:175], v[92:95]
  ds_read_b64_tr_b16 a[46:47], v3 offset:54272
  v_mfma_f32_16x16x32_bf16 v[88:91], a[28:31], a[168:171], v[88:91]
  ds_read_b64_tr_b16 a[60:61], v3 offset:58368
  v_mfma_f32_16x16x32_bf16 v[88:91], a[12:15], a[160:163], v[88:91]
  ds_read_b64_tr_b16 a[62:63], v3 offset:62464
  s_waitcnt lgkmcnt(8)
  v_mfma_f32_16x16x32_bf16 v[64:67], a[32:35], a[176:179], v[64:67]
  v_mfma_f32_16x16x32_bf16 v[64:67], a[48:51], a[184:187], v[64:67]
  v_mfma_f32_16x16x32_bf16 v[68:71], a[48:51], a[188:191], v[68:71]
  v_mfma_f32_16x16x32_bf16 v[68:71], a[32:35], a[180:183], v[68:71]
  v_mfma_f32_16x16x32_bf16 v[76:79], a[36:39], a[180:183], v[76:79]
  v_mfma_f32_16x16x32_bf16 v[76:79], a[52:55], a[188:191], v[76:79]
  v_mfma_f32_16x16x32_bf16 v[72:75], a[52:55], a[184:187], v[72:75]
  v_mfma_f32_16x16x32_bf16 v[72:75], a[36:39], a[176:179], v[72:75]
  s_waitcnt lgkmcnt(0)
  v_mfma_f32_16x16x32_bf16 v[80:83], a[40:43], a[176:179], v[80:83]
  v_mfma_f32_16x16x32_bf16 v[80:83], a[56:59], a[184:187], v[80:83]
  s_barrier
  v_mfma_f32_16x16x32_bf16 v[84:87], a[56:59], a[188:191], v[84:87]
  v_mfma_f32_16x16x32_bf16 v[84:87], a[40:43], a[180:183], v[84:87]
  v_mfma_f32_16x16x32_bf16 v[92:95], a[44:47], a[180:183], v[92:95]
  v_mfma_f32_16x16x32_bf16 v[92:95], a[60:63], a[188:191], v[92:95]
  v_mfma_f32_16x16x32_bf16 v[88:91], a[60:63], a[184:187], v[88:91]
  v_mfma_f32_16x16x32_bf16 v[88:91], a[44:47], a[176:179], v[88:91]
  s_mov_b32 s43, 0x40000
Lp4_mb:
  s_waitcnt vmcnt(0)
  v_max3_u32 v112, v96, v97, v98
  v_max3_u32 v113, v99, v100, v101
  v_max3_u32 v112, v112, v102, v103
  v_max3_u32 v113, v113, v104, v105
  v_max3_u32 v112, v112, v106, v107
  v_max3_u32 v113, v113, v108, v109
  v_max3_u32 v112, v112, v110, v111
  v_max_u32 v112, v112, v113
  v_cmp_eq_u32 vcc, -1, v112
  s_cbranch_vccz Lp4_mbok
  buffer_load_dwordx4 v[96:99], v8, s[4:7], s45 offen offset:0 sc1
  buffer_load_dwordx4 v[100:103], v8, s[4:7], s45 offen offset:1024 sc1
  buffer_load_dwordx4 v[104:107], v8, s[4:7], s45 offen offset:2048 sc1
  buffer_load_dwordx4 v[108:111], v8, s[4:7], s45 offen offset:3072 sc1
  s_sub_u32 s43, s43, 1
  s_cmp_lg_u32 s43, 0
  s_cbranch_scc1 Lp4_mb
  s_waitcnt vmcnt(0)
Lp4_mbok:
  s_add_u32 s46, s76, 37748736
  s_add_u32 s47, s46, 32768
  s_lshl_b32 s48, s49, 11
  s_lshl_b32 s43, s53, 7
  s_add_u32 s48, s48, s43
  s_add_u32 s48, s48, 65011712
  s_cmp_lg_u32 s41, 0
  s_cbranch_scc1 Lfinal
  v_lshlrev_b32 v112, 16, v96
  v_and_b32 v113, 0xffff0000, v96
  v_lshlrev_b32 v114, 16, v97
  v_and_b32 v115, 0xffff0000, v97
  v_lshlrev_b32 v116, 16, v98
  v_and_b32 v117, 0xffff0000, v98
  v_lshlrev_b32 v118, 16, v99
  v_and_b32 v119, 0xffff0000, v99
  v_pk_add_f32 v[64:65], v[64:65], v[112:113]
  v_pk_add_f32 v[66:67], v[66:67], v[114:115]
  v_pk_add_f32 v[72:73], v[72:73], v[116:117]
  v_pk_add_f32 v[74:75], v[74:75], v[118:119]
  v_cvt_pk_bf16_f32 v16, v64, v65
  v_cvt_pk_bf16_f32 v17, v66, v67
  v_cvt_pk_bf16_f32 v18, v72, v73
  v_cvt_pk_bf16_f32 v19, v74, v75
  buffer_store_dwordx4 v[16:19], v8, s[4:7], s46 offen offset:0 sc1
  v_lshlrev_b32 v112, 16, v104
  v_and_b32 v113, 0xffff0000, v104
  v_lshlrev_b32 v114, 16, v105
  v_and_b32 v115, 0xffff0000, v105
  v_lshlrev_b32 v116, 16, v106
  v_and_b32 v117, 0xffff0000, v106
  v_lshlrev_b32 v118, 16, v107
  v_and_b32 v119, 0xffff0000, v107
  v_pk_add_f32 v[68:69], v[68:69], v[112:113]
  v_pk_add_f32 v[70:71], v[70:71], v[114:115]
  v_pk_add_f32 v[76:77], v[76:77], v[116:117]
  v_pk_add_f32 v[78:79], v[78:79], v[118:119]
  v_cvt_pk_bf16_f32 v24, v68, v69
  v_cvt_pk_bf16_f32 v25, v70, v71
  v_cvt_pk_bf16_f32 v26, v76, v77
  v_cvt_pk_bf16_f32 v27, v78, v79
  buffer_store_dwordx4 v[24:27], v8, s[4:7], s47 offen offset:0 sc1
  v_lshlrev_b32 v112, 16, v100
  v_and_b32 v113, 0xffff0000, v100
  v_lshlrev_b32 v114, 16, v101
  v_and_b32 v115, 0xffff0000, v101
  v_lshlrev_b32 v116, 16, v102
  v_and_b32 v117, 0xffff0000, v102
  v_lshlrev_b32 v118, 16, v103
  v_and_b32 v119, 0xffff0000, v103
  v_pk_add_f32 v[80:81], v[80:81], v[112:113]
  v_pk_add_f32 v[82:83], v[82:83], v[114:115]
  v_pk_add_f32 v[88:89], v[88:89], v[116:117]
  v_pk_add_f32 v[90:91], v[90:91], v[118:119]
  v_cvt_pk_bf16_f32 v20, v80, v81
  v_cvt_pk_bf16_f32 v21, v82, v83
  v_cvt_pk_bf16_f32 v22, v88, v89
  v_cvt_pk_bf16_f32 v23, v90, v91
  buffer_store_dwordx4 v[20:23], v8, s[4:7], s46 offen offset:1024 sc1
  v_lshlrev_b32 v112, 16, v108
  v_and_b32 v113, 0xffff0000, v108
  v_lshlrev_b32 v114, 16, v109
  v_and_b32 v115, 0xffff0000, v109
  v_lshlrev_b32 v116, 16, v110
  v_and_b32 v117, 0xffff0000, v110
  v_lshlrev_b32 v118, 16, v111
  v_and_b32 v119, 0xffff0000, v111
  v_pk_add_f32 v[84:85], v[84:85], v[112:113]
  v_pk_add_f32 v[86:87], v[86:87], v[114:115]
  v_pk_add_f32 v[92:93], v[92:93], v[116:117]
  v_pk_add_f32 v[94:95], v[94:95], v[118:119]
  v_cvt_pk_bf16_f32 v28, v84, v85
  v_cvt_pk_bf16_f32 v29, v86, v87
  v_cvt_pk_bf16_f32 v30, v92, v93
  v_cvt_pk_bf16_f32 v31, v94, v95
  buffer_store_dwordx4 v[28:31], v8, s[4:7], s47 offen offset:1024 sc1
  v_mov_b32 v128, 0x3f803f80
  v_mov_b32 v129, 0x3f803f80
  v_mov_b32 v130, 0x3f803f80
  v_mov_b32 v131, 0x3f803f80
  v_and_b32 v148, 15, v253
  v_lshrrev_b32 v149, 4, v253
  v_mfma_f32_16x16x32_bf16 v[132:135], v[128:131], v[16:19], 0
  v_mfma_f32_16x16x32_bf16 v[136:139], v[16:19], v[16:19], 0
  v_mfma_f32_16x16x32_bf16 v[140:143], v[128:131], v[24:27], 0
  v_mfma_f32_16x16x32_bf16 v[144:147], v[24:27], v[24:27], 0
  v_mfma_f32_16x16x32_bf16 v[132:135], v[128:131], v[20:23], v[132:135]
  v_mfma_f32_16x16x32_bf16 v[136:139], v[20:23], v[20:23], v[136:139]
  v_mfma_f32_16x16x32_bf16 v[140:143], v[128:131], v[28:31], v[140:143]
  v_mfma_f32_16x16x32_bf16 v[144:147], v[28:31], v[28:31], v[144:147]
  v_lshrrev_b32 v128, 2, v148
  v_cmp_eq_u32 s[64:65], v128, v149
  v_and_b32 v128, 3, v148
  v_cmp_eq_u32 s[66:67], 1, v128
  v_cmp_eq_u32 s[68:69], 2, v128
  v_cmp_eq_u32 s[70:71], 3, v128
  v_lshlrev_b32 v148, 3, v148
  v_mov_b32 v149, 0x7ffffff0
  s_nop 0
  v_cndmask_b32 v148, v149, v148, s[64:65]
  v_cndmask_b32 v133, v136, v137, s[66:67]
  v_cndmask_b32 v133, v133, v138, s[68:69]
  v_cndmask_b32 v133, v133, v139, s[70:71]
  buffer_store_dwordx2 v[132:133], v148, s[4:7], s48 offen offset:0 sc1
  v_cndmask_b32 v141, v144, v145, s[66:67]
  v_cndmask_b32 v141, v141, v146, s[68:69]
  v_cndmask_b32 v141, v141, v147, s[70:71]
  buffer_store_dwordx2 v[140:141], v148, s[4:7], s48 offen offset:2048 sc1
  s_lshl_b32 s77, s52, 7
  s_add_u32 s77, s77, 27792384
  s_mov_b32 s41, 1
  s_mov_b32 s42, 0x2400000
  s_mov_b32 s28, s4
  s_mov_b32 s29, s5
  s_mov_b32 s30, 0x10000000
  s_lshr_b32 s57, s40, 1
  s_and_b32 s58, s40, 1
  s_lshl_b32 s71, s50, 3
  s_mov_b32 s67, 0
  s_lshl_b32 s62, s40, 12
  s_mul_i32 s63, s40, 6144
  s_add_u32 s76, s63, 139264
  s_and_b32 s43, s50, 7
  s_cmp_lg_u32 s43, 0
  s_cselect_b32 s43, 1, 0
  s_sub_u32 s72, s71, s43
  v_lshrrev_b32 v2, 3, v253
  v_bfe_u32 v3, v253, 1, 2
  v_lshrrev_b32 v4, 4, v253
  v_xor_b32 v3, v3, v4
  v_and_b32 v5, 1, v253
  v_mov_b32 v6, v2
  s_lshl_b32 s43, s40, 4
  v_mul_u32_u24 v6, 6144, v6
  v_lshl_add_u32 v6, v3, 5, v6
  v_lshl_add_u32 v124, v5, 4, v6
  v_add_u32 v125, 48128, v124
  s_mul_i32 s43, s43, 6144
  s_lshl_b32 s60, s51, 7
  s_add_u32 s60, s60, s43
  v_and_b32 v3, 7, v253
  s_lshl_b32 s43, s40, 1
  s_add_u32 s43, s43, s71
  v_lshlrev_b32 v120, 4, v253
  v_mov_b32 v121, v120
  v_add_u32 v122, 30720, v120
  v_add_u32 v123, 30720, v120
  v_lshlrev_b32 v5, 8, v2
  v_lshl_add_u32 v5, v3, 4, v5
  v_add_u32 v126, 128, v5
  s_lshl_b32 s43, s43, 15
  s_mov_b32 s44, 37748736
  s_add_u32 s59, s43, s44
  s_lshl_b32 s43, s72, 15
  s_add_u32 s73, s43, s44
  s_movk_i32 s61, 2048
  v_and_b32 v2, 15, v253
  v_lshrrev_b32 v3, 4, v253
  v_and_b32 v4, 7, v253
  v_lshlrev_b32 v6, 4, v253
  v_add_u32 v7, 1024, v6
  v_lshlrev_b32 v5, 7, v3
  v_lshl_add_u32 v8, v4, 4, v5
  v_add_u32 v9, 512, v8
  s_lshl_b32 s43, s57, 13
  s_add_u32 s43, s43, 73728
  v_add_u32 v112, s43, v6
  v_add_u32 v113, s43, v7
  s_cmp_eq_u32 s57, 0
  s_cselect_b64 vcc, 0, -1
  s_movk_i32 s43, 1024
  s_cselect_b32 s64, s43, 16384
  s_cselect_b32 s65, s43, -32768
  s_mov_b32 s43, 122880
  s_cselect_b32 s43, s43, 79872
  v_cndmask_b32 v8, v8, v6, vcc
  v_cndmask_b32 v9, v9, v7, vcc
  v_add_u32 v114, s43, v8
  v_add_u32 v115, s43, v9
  v_lshrrev_b32 v2, 2, v253
  v_bfe_u32 v3, v253, 3, 2
  v_and_b32 v4, 3, v253
  v_lshlrev_b32 v4, 3, v4
  v_lshl_add_u32 v4, v2, 7, v4
  s_lshl_b32 s43, s58, 1
  v_xor_b32 v5, s43, v3
  v_lshl_add_u32 v116, v5, 5, v4
  v_xor_b32 v5, 1, v5
  v_lshl_add_u32 v117, v5, 5, v4
  v_add_u32 v118, 49152, v116
  v_add_u32 v119, 49152, v117
  s_mov_b32 s84, s16
  s_mov_b32 s85, s17
  s_mov_b32 s86, 7340032
  s_mov_b32 s87, 0x20000
  s_mov_b32 s3, 0
  s_mov_b32 s88, 63
  s_mov_b32 s100, 0
  v_mov_b32 v238, 0x40000000
  s_waitcnt vmcnt(0)
  s_barrier
  s_cmp_lg_u32 s40, 0
  s_cbranch_scc1 Lsig19
  v_mov_b32 v250, 1
  s_mov_b64 exec, 1
  buffer_atomic_add v250, v251, s[4:7], s77 offen sc1
  s_mov_b64 exec, -1
Lsig19:
  s_add_u32 s44, s67, 0
  s_and_b32 s44, s44, 15
  s_mul_i32 s45, s44, 393216
  s_add_u32 s69, s45, s60
  s_add_u32 s70, s69, 4096
  s_add_u32 m0, s63, 0
  s_nop 0
  buffer_load_dwordx4 v124, s[8:11], s69 offen offset:0  lds
  buffer_load_dwordx4 v125, s[8:11], s69 offen offset:1024  lds
  buffer_load_dwordx4 v124, s[8:11], s69 offen offset:2048  lds
  buffer_load_dwordx4 v125, s[8:11], s69 offen offset:3072  lds
  s_add_u32 m0, s63, 4096
  s_nop 0
  buffer_load_dwordx4 v124, s[8:11], s70 offen offset:0  lds
  buffer_load_dwordx4 v125, s[8:11], s70 offen offset:1024  lds
  s_add_u32 s44, s67, 1
  s_and_b32 s44, s44, 15
  s_mul_i32 s45, s44, 393216
  s_add_u32 s69, s45, s60
  s_add_u32 s70, s69, 4096
  s_add_u32 m0, s63, 24576
  s_nop 0
  buffer_load_dwordx4 v124, s[8:11], s69 offen offset:0  lds
  buffer_load_dwordx4 v125, s[8:11], s69 offen offset:1024  lds
  buffer_load_dwordx4 v124, s[8:11], s69 offen offset:2048  lds
  buffer_load_dwordx4 v125, s[8:11], s69 offen offset:3072  lds
  s_add_u32 m0, s63, 28672
  s_nop 0
  buffer_load_dwordx4 v124, s[8:11], s70 offen offset:0  lds
  buffer_load_dwordx4 v125, s[8:11], s70 offen offset:1024  lds
  s_add_u32 s44, s67, 2
  s_and_b32 s44, s44, 15
  s_mul_i32 s45, s44, 393216
  s_add_u32 s69, s45, s60
  s_add_u32 s70, s69, 4096
  s_add_u32 m0, s63, 49152
  s_nop 0
  buffer_load_dwordx4 v124, s[8:11], s69 offen offset:0  lds
  buffer_load_dwordx4 v125, s[8:11], s69 offen offset:1024  lds
  buffer_load_dwordx4 v124, s[8:11], s69 offen offset:2048  lds
  buffer_load_dwordx4 v125, s[8:11], s69 offen offset:3072  lds
  s_add_u32 m0, s63, 53248
  s_nop 0
  buffer_load_dwordx4 v124, s[8:11], s70 offen offset:0  lds
  buffer_load_dwordx4 v125, s[8:11], s70 offen offset:1024  lds
  v_mov_b32 v0, 0
  v_mov_b32 v1, 0
  v_mov_b32 v2, 0
  v_mov_b32 v3, 0
  v_mov_b32 v4, 0
  v_mov_b32 v5, 0
  v_mov_b32 v6, 0
  v_mov_b32 v7, 0
  v_mov_b32 v8, 0
  v_mov_b32 v9, 0
  v_mov_b32 v10, 0
  v_mov_b32 v11, 0
  v_mov_b32 v12, 0
  v_mov_b32 v13, 0
  v_mov_b32 v14, 0
  v_mov_b32 v15, 0
  v_mov_b32 v16, 0
  v_mov_b32 v17, 0
  v_mov_b32 v18, 0
  v_mov_b32 v19, 0
  v_mov_b32 v20, 0
  v_mov_b32 v21, 0
  v_mov_b32 v22, 0
  v_mov_b32 v23, 0
  v_mov_b32 v24, 0
  v_mov_b32 v25, 0
  v_mov_b32 v26, 0
  v_mov_b32 v27, 0
  v_mov_b32 v28, 0
  v_mov_b32 v29, 0
  v_mov_b32 v30, 0
  v_mov_b32 v31, 0
  v_mov_b32 v32, 0
  v_mov_b32 v33, 0
  v_mov_b32 v34, 0
  v_mov_b32 v35, 0
  v_mov_b32 v36, 0
  v_mov_b32 v37, 0
  v_mov_b32 v38, 0
  v_mov_b32 v39, 0
  v_mov_b32 v40, 0
  v_mov_b32 v41, 0
  v_mov_b32 v42, 0
  v_mov_b32 v43, 0
  v_mov_b32 v44, 0
  v_mov_b32 v45, 0
  v_mov_b32 v46, 0
  v_mov_b32 v47, 0
  v_mov_b32 v48, 0
  v_mov_b32 v49, 0
  v_mov_b32 v50, 0
  v_mov_b32 v51, 0
  v_mov_b32 v52, 0
  v_mov_b32 v53, 0
  v_mov_b32 v54, 0
  v_mov_b32 v55, 0
  v_mov_b32 v56, 0
  v_mov_b32 v57, 0
  v_mov_b32 v58, 0
  v_mov_b32 v59, 0
  v_mov_b32 v60, 0
  v_mov_b32 v61, 0
  v_mov_b32 v62, 0
  v_mov_b32 v63, 0
  v_mov_b32 v64, 0
  v_mov_b32 v65, 0
  v_mov_b32 v66, 0
  v_mov_b32 v67, 0
  v_mov_b32 v68, 0
  v_mov_b32 v69, 0
  v_mov_b32 v70, 0
  v_mov_b32 v71, 0
  v_mov_b32 v72, 0
  v_mov_b32 v73, 0
  v_mov_b32 v74, 0
  v_mov_b32 v75, 0
  v_mov_b32 v76, 0
  v_mov_b32 v77, 0
  v_mov_b32 v78, 0
  v_mov_b32 v79, 0
  v_mov_b32 v80, 0
  v_mov_b32 v81, 0
  v_mov_b32 v82, 0
  v_mov_b32 v83, 0
  v_mov_b32 v84, 0
  v_mov_b32 v85, 0
  v_mov_b32 v86, 0
  v_mov_b32 v87, 0
  v_mov_b32 v88, 0
  v_mov_b32 v89, 0
  v_mov_b32 v90, 0
  v_mov_b32 v91, 0
  v_mov_b32 v92, 0
  v_mov_b32 v93, 0
  v_mov_b32 v94, 0
  v_mov_b32 v95, 0
  v_mov_b32 v96, 0
  v_mov_b32 v97, 0
  v_mov_b32 v98, 0
  v_mov_b32 v99, 0
  v_mov_b32 v100, 0
  v_mov_b32 v101, 0
  v_mov_b32 v102, 0
  v_mov_b32 v103, 0
  v_mov_b32 v104, 0
  v_mov_b32 v105, 0
  v_mov_b32 v106, 0
  v_mov_b32 v107, 0
  v_mov_b32 v108, 0
  v_mov_b32 v109, 0
  v_mov_b32 v110, 0
  v_mov_b32 v111, 0
  s_lshl_b32 s77, s50, 7
  s_add_u32 s77, s77, 27792256
  s_and_b32 s43, s50, 7
  s_cmp_eq_u32 s43, 0
  s_cselect_b32 s43, 0x80, 0
  v_lshlrev_b32 v249, 7, v253
  v_or_b32 v249, s43, v249
  s_branch Llayer
Lfinal:
  v_and_b32 v128, 15, v253
  v_lshrrev_b32 v129, 4, v253
  v_lshrrev_b32 v130, 1, v129
  v_and_b32 v129, 1, v129
  v_lshl_add_u32 v129, v129, 1, v130
  v_and_b32 v130, 7, v253
  v_xor_b32 v129, v129, v130
  v_lshlrev_b32 v129, 4, v129
  v_lshl_add_u32 v128, v128, 7, v129
  s_lshl_b32 s43, s40, 12
  v_add_u32 v128, s43, v128
  v_xor_b32 v129, 64, v128
  v_lshlrev_b32 v112, 16, v96
  v_and_b32 v113, 0xffff0000, v96
  v_lshlrev_b32 v114, 16, v97
  v_and_b32 v115, 0xffff0000, v97
  v_lshlrev_b32 v116, 16, v98
  v_and_b32 v117, 0xffff0000, v98
  v_lshlrev_b32 v118, 16, v99
  v_and_b32 v119, 0xffff0000, v99
  v_pk_add_f32 v[64:65], v[64:65], v[112:113]
  v_pk_add_f32 v[66:67], v[66:67], v[114:115]
  v_pk_add_f32 v[72:73], v[72:73], v[116:117]
  v_pk_add_f32 v[74:75], v[74:75], v[118:119]
  v_cvt_pk_bf16_f32 v16, v64, v65
  v_cvt_pk_bf16_f32 v17, v66, v67
  v_cvt_pk_bf16_f32 v18, v72, v73
  v_cvt_pk_bf16_f32 v19, v74, v75
  s_nop 1
  v_permlane16_swap_b32 v16, v18
  v_permlane16_swap_b32 v17, v19
  ds_write_b128 v128, v[16:19] offset:0
  v_lshlrev_b32 v112, 16, v104
  v_and_b32 v113, 0xffff0000, v104
  v_lshlrev_b32 v114, 16, v105
  v_and_b32 v115, 0xffff0000, v105
  v_lshlrev_b32 v116, 16, v106
  v_and_b32 v117, 0xffff0000, v106
  v_lshlrev_b32 v118, 16, v107
  v_and_b32 v119, 0xffff0000, v107
  v_pk_add_f32 v[68:69], v[68:69], v[112:113]
  v_pk_add_f32 v[70:71], v[70:71], v[114:115]
  v_pk_add_f32 v[76:77], v[76:77], v[116:117]
  v_pk_add_f32 v[78:79], v[78:79], v[118:119]
  v_cvt_pk_bf16_f32 v24, v68, v69
  v_cvt_pk_bf16_f32 v25, v70, v71
  v_cvt_pk_bf16_f32 v26, v76, v77
  v_cvt_pk_bf16_f32 v27, v78, v79
  s_nop 1
  v_permlane16_swap_b32 v24, v26
  v_permlane16_swap_b32 v25, v27
  ds_write_b128 v128, v[24:27] offset:2048
  v_lshlrev_b32 v112, 16, v100
  v_and_b32 v113, 0xffff0000, v100
  v_lshlrev_b32 v114, 16, v101
  v_and_b32 v115, 0xffff0000, v101
  v_lshlrev_b32 v116, 16, v102
  v_and_b32 v117, 0xffff0000, v102
  v_lshlrev_b32 v118, 16, v103
  v_and_b32 v119, 0xffff0000, v103
  v_pk_add_f32 v[80:81], v[80:81], v[112:113]
  v_pk_add_f32 v[82:83], v[82:83], v[114:115]
  v_pk_add_f32 v[88:89], v[88:89], v[116:117]
  v_pk_add_f32 v[90:91], v[90:91], v[118:119]
  v_cvt_pk_bf16_f32 v20, v80, v81
  v_cvt_pk_bf16_f32 v21, v82, v83
  v_cvt_pk_bf16_f32 v22, v88, v89
  v_cvt_pk_bf16_f32 v23, v90, v91
  s_nop 1
  v_permlane16_swap_b32 v20, v22
  v_permlane16_swap_b32 v21, v23
  ds_write_b128 v129, v[20:23] offset:0
  v_lshlrev_b32 v112, 16, v108
  v_and_b32 v113, 0xffff0000, v108
  v_lshlrev_b32 v114, 16, v109
  v_and_b32 v115, 0xffff0000, v109
  v_lshlrev_b32 v116, 16, v110
  v_and_b32 v117, 0xffff0000, v110
  v_lshlrev_b32 v118, 16, v111
  v_and_b32 v119, 0xffff0000, v111
  v_pk_add_f32 v[84:85], v[84:85], v[112:113]
  v_pk_add_f32 v[86:87], v[86:87], v[114:115]
  v_pk_add_f32 v[92:93], v[92:93], v[116:117]
  v_pk_add_f32 v[94:95], v[94:95], v[118:119]
  v_cvt_pk_bf16_f32 v28, v84, v85
  v_cvt_pk_bf16_f32 v29, v86, v87
  v_cvt_pk_bf16_f32 v30, v92, v93
  v_cvt_pk_bf16_f32 v31, v94, v95
  s_nop 1
  v_permlane16_swap_b32 v28, v30
  v_permlane16_swap_b32 v29, v31
  ds_write_b128 v129, v[28:31] offset:2048
  v_lshrrev_b32 v131, 3, v253
  v_xor_b32 v132, v131, v130
  v_lshlrev_b32 v132, 4, v132
  v_lshl_add_u32 v132, v131, 7, v132
  v_add_u32 v132, s43, v132
  ds_read_b128 v[96:99], v132 offset:0
  ds_read_b128 v[100:103], v132 offset:1024
  ds_read_b128 v[104:107], v132 offset:2048
  ds_read_b128 v[108:111], v132 offset:3072
  v_lshlrev_b32 v130, 4, v130
  v_lshl_add_u32 v130, v131, 12, v130
  s_and_b32 s43, s49, 63
  s_lshl_b32 s43, s43, 16
  s_lshr_b32 s46, s49, 6
  s_lshl_b32 s46, s46, 11
  s_add_u32 s46, s46, s43
  s_lshl_b32 s43, s53, 7
  s_add_u32 s46, s46, s43
  s_waitcnt lgkmcnt(3)
  buffer_store_dwordx4 v[96:99], v130, s[32:35], s46 offen sc1
  s_add_u32 s46, s46, 32768
  s_waitcnt lgkmcnt(2)
  buffer_store_dwordx4 v[100:103], v130, s[32:35], s46 offen sc1
  s_add_u32 s46, s46, 32768
  s_waitcnt lgkmcnt(1)
  buffer_store_dwordx4 v[104:107], v130, s[32:35], s46 offen sc1
  s_add_u32 s46, s46, 32768
  s_waitcnt lgkmcnt(0)
  buffer_store_dwordx4 v[108:111], v130, s[32:35], s46 offen sc1
  s_add_u32 s46, s46, 32768
Lend:
  s_endpgm
Lside_sub:
  s_cmp_eq_u32 s90, 1
  s_cbranch_scc0 Lside_l
  s_cmp_lg_u32 s40, 0
  s_cbranch_scc1 Lside_a
  s_and_b32 s43, s2, 1
  s_lshl_b32 s43, s43, 7
  v_mov_b32 v250, 1
  s_mov_b64 exec, 1
  buffer_atomic_add v250, v251, s[36:39], s43 offen sc1
  s_mov_b64 exec, -1
Lside_a:
  s_add_u32 s88, s88, 3
  s_add_u32 s90, s90, 1
  s_setpc_b64 s[78:79]
Lside_l:
  buffer_load_dwordx4 a[240:243], v239, s[12:15], s89 offen
  s_add_u32 s89, s89, 1024
  s_cmp_eq_u32 s90, 0
  s_cbranch_scc0 Lside_b
  buffer_load_dwordx4 a[176:179], v238, s[84:87], s100 offen
  s_add_u32 s100, s100, 57344
  buffer_load_dwordx4 a[180:183], v238, s[84:87], s100 offen
  s_add_u32 s100, s100, 57344
  buffer_load_dwordx4 a[184:187], v238, s[84:87], s100 offen
  s_add_u32 s100, s100, 57344
  buffer_load_dwordx4 a[188:191], v238, s[84:87], s100 offen
  s_add_u32 s100, s100, 57344
  buffer_load_dwordx4 a[192:195], v238, s[84:87], s100 offen
  s_add_u32 s100, s100, 57344
  buffer_load_dwordx4 a[196:199], v238, s[84:87], s100 offen
  s_add_u32 s100, s100, 57344
  buffer_load_dwordx4 a[200:203], v238, s[84:87], s100 offen
  s_add_u32 s100, s100, 57344
  buffer_load_dwordx4 a[204:207], v238, s[84:87], s100 offen
  s_add_u32 s100, s100, 57344
  s_add_u32 s100, s100, 3211264
  s_add_u32 s88, s88, 3
  s_add_u32 s90, s90, 1
  s_setpc_b64 s[78:79]
Lside_b:
  buffer_load_dwordx4 a[208:211], v238, s[84:87], s100 offen
  s_add_u32 s100, s100, 57344
  buffer_load_dwordx4 a[212:215], v238, s[84:87], s100 offen
  s_add_u32 s100, s100, 57344
  buffer_load_dwordx4 a[216:219], v238, s[84:87], s100 offen
  s_add_u32 s100, s100, 57344
  buffer_load_dwordx4 a[220:223], v238, s[84:87], s100 offen
  s_add_u32 s100, s100, 57344
  buffer_load_dwordx4 a[224:227], v238, s[84:87], s100 offen
  s_add_u32 s100, s100, 57344
  buffer_load_dwordx4 a[228:231], v238, s[84:87], s100 offen
  s_add_u32 s100, s100, 57344
  buffer_load_dwordx4 a[232:235], v238, s[84:87], s100 offen
  s_add_u32 s100, s100, 57344
  buffer_load_dwordx4 a[236:239], v238, s[84:87], s100 offen
  s_add_u32 s100, s100, 57344
  s_mov_b32 s88, 63
  s_setpc_b64 s[78:79]
Lcode_end:
.fill (Lpc0 + 69632 - Lcode_end)/4, 4, 0xbf810000
.section .rodata,"a"
.p2align 6
.amdhsa_kernel interleave_layers__sliding_local_dilated__swiglu_ffn__prompt_kernel
  .amdhsa_next_free_vgpr 512
  .amdhsa_next_free_sgpr 102
  .amdhsa_accum_offset 256
  .amdhsa_group_segment_fixed_size 0
  .amdhsa_kernarg_size 80
  .amdhsa_user_sgpr_count 2
  .amdhsa_user_sgpr_kernarg_segment_ptr 1
  .amdhsa_system_sgpr_workgroup_id_x 1
  .amdhsa_float_denorm_mode_32 3
.end_amdhsa_kernel
```

```asm
; @launch grid=(256,1,1) block=(256,1,1) lds=163840
.amdgcn_target "amdgcn-amd-amdhsa--gfx950"
.text
.globl interleave_layers__sliding_local_dilated__swiglu_ffn__prompt_kernel
.p2align 8
.type interleave_layers__sliding_local_dilated__swiglu_ffn__prompt_kernel,@function
interleave_layers__sliding_local_dilated__swiglu_ffn__prompt_kernel:
  s_cmp_lt_u32 s2, 256
  s_cbranch_scc1 Lgo
  s_endpgm
Lgo:
  s_load_dwordx2 s[28:29], s[0:1], 0
  s_load_dwordx2 s[8:9], s[0:1], 8
  s_getpc_b64 s[44:45]
Lpc0:
  s_bfe_u32 s43, s2, 0x40003
  s_lshl_b32 s43, s43, 12
  v_lshl_add_u32 v2, v0, 4, s43
  s_and_b32 s44, s44, 0xffffff80
  global_load_dwordx4 a[240:243], v2, s[44:45]
  v_lshrrev_b32 v1, 6, v0
  v_and_b32 v253, 63, v0
  v_readfirstlane_b32 s40, v1
  v_mov_b32 v251, 0
  s_mov_b32 s30, 0x400000
  s_mov_b32 s31, 0x20000
  s_mov_b32 s10, 0x600000
  s_mov_b32 s11, 0x20000
  s_and_b32 s44, s2, 1
  s_bfe_u32 s45, s2, 0x20001
  s_lshr_b32 s46, s2, 3
  s_lshl_b32 s47, s44, 3
  s_and_b32 s43, s46, 7
  s_add_u32 s50, s47, s43
  s_lshl_b32 s43, s45, 2
  s_lshr_b32 s51, s46, 3
  s_add_u32 s51, s51, s43
  s_lshr_b32 s57, s40, 1
  s_and_b32 s58, s40, 1
  s_lshl_b32 s71, s50, 3
  s_add_u32 s67, s50, s51
  s_and_b32 s67, s67, 15
  s_lshl_b32 s62, s40, 12
  s_mul_i32 s63, s40, 6144
  s_add_u32 s76, s63, 139264
  s_and_b32 s43, s50, 7
  s_cmp_lg_u32 s43, 0
  s_cselect_b32 s43, 1, 0
  s_sub_u32 s72, s71, s43
  v_lshrrev_b32 v2, 3, v253
  v_bfe_u32 v3, v253, 1, 2
  v_lshrrev_b32 v4, 4, v253
  v_xor_b32 v3, v3, v4
  v_and_b32 v5, 1, v253
  v_lshrrev_b32 v6, 5, v253
  v_lshl_add_u32 v6, v6, 2, v2
  s_lshl_b32 s43, s57, 5
  s_lshl_b32 s44, s58, 2
  s_add_u32 s43, s43, s44
  v_mul_u32_u24 v6, 6144, v6
  v_lshl_add_u32 v6, v3, 5, v6
  v_lshl_add_u32 v124, v5, 4, v6
  v_add_u32 v125, 97280, v124
  s_mul_i32 s43, s43, 6144
  s_lshl_b32 s60, s51, 7
  s_add_u32 s60, s60, s43
  v_and_b32 v3, 7, v253
  s_lshl_b32 s43, s40, 1
  s_add_u32 s43, s43, s71
  v_add_u32 v5, 0, v4
  v_xor_b32 v5, v5, v3
  v_lshlrev_b32 v5, 4, v5
  v_lshl_add_u32 v5, v2, 12, v5
  v_add_u32 v120, 0, v5
  v_add_u32 v5, 4, v4
  v_xor_b32 v5, v5, v3
  v_lshlrev_b32 v5, 4, v5
  v_lshl_add_u32 v5, v2, 12, v5
  v_add_u32 v121, 31744, v5
  v_add_u32 v5, 0, v4
  v_xor_b32 v5, v5, v3
  v_lshlrev_b32 v5, 4, v5
  v_lshl_add_u32 v5, v2, 12, v5
  v_add_u32 v122, 63488, v5
  v_add_u32 v5, 4, v4
  v_xor_b32 v5, v5, v3
  v_lshlrev_b32 v5, 4, v5
  v_lshl_add_u32 v5, v2, 12, v5
  v_add_u32 v123, 95232, v5
  v_and_b32 v5, 6, v2
  v_xor_b32 v5, v5, v3
  v_lshlrev_b32 v5, 4, v5
  v_lshl_add_u32 v5, v2, 12, v5
  v_add_u32 v126, 32768, v5
  s_lshr_b32 s44, s50, 3
  s_lshl_b32 s44, s44, 11
  s_and_b32 s43, s43, 63
  s_lshl_b32 s43, s43, 16
  s_add_u32 s59, s43, s44
  s_and_b32 s43, s72, 63
  s_lshl_b32 s43, s43, 16
  s_add_u32 s73, s43, s44
  s_movk_i32 s61, 128
  s_waitcnt lgkmcnt(0)
  s_add_u32 s44, s67, 0
  s_and_b32 s44, s44, 15
  s_mul_i32 s45, s44, s61
  s_add_u32 s68, s45, s59
  s_add_u32 m0, s62, 73728
  s_nop 0
  buffer_load_dwordx4 v120, s[28:31], s68 offen offset:0 sc1  lds
  buffer_load_dwordx4 v121, s[28:31], s68 offen offset:1024 sc1  lds
  buffer_load_dwordx4 v122, s[28:31], s68 offen offset:2048 sc1  lds
  buffer_load_dwordx4 v123, s[28:31], s68 offen offset:3072 sc1  lds
  s_add_u32 s44, s67, 0
  s_and_b32 s44, s44, 15
  s_mul_i32 s45, s44, 393216
  s_add_u32 s69, s45, s60
  s_add_u32 s70, s69, 4096
  s_add_u32 m0, s63, 0
  s_nop 0
  buffer_load_dwordx4 v124, s[8:11], s69 offen offset:0  lds
  buffer_load_dwordx4 v125, s[8:11], s69 offen offset:1024  lds
  buffer_load_dwordx4 v124, s[8:11], s69 offen offset:2048  lds
  buffer_load_dwordx4 v125, s[8:11], s69 offen offset:3072  lds
  s_add_u32 m0, s63, 4096
  s_nop 0
  buffer_load_dwordx4 v124, s[8:11], s70 offen offset:0  lds
  buffer_load_dwordx4 v125, s[8:11], s70 offen offset:1024  lds
  s_add_u32 s44, s67, s40
  s_add_u32 s44, s44, 0
  s_and_b32 s44, s44, 15
  s_mul_i32 s44, s44, s61
  s_lshl_b32 s45, s40, 10
  s_add_u32 m0, s45, 122880
  s_add_u32 s44, s44, s73
  buffer_load_dwordx4 v126, s[28:31], s44 offen sc1 lds
  s_load_dwordx2 s[4:5], s[0:1], 72
  s_load_dwordx2 s[12:13], s[0:1], 16
  s_load_dwordx2 s[16:17], s[0:1], 32
  s_load_dwordx2 s[20:21], s[0:1], 40
  s_load_dwordx2 s[24:25], s[0:1], 48
  s_load_dwordx2 s[32:33], s[0:1], 56
  s_load_dwordx2 s[36:37], s[0:1], 64
  s_mov_b32 s6, 0x10000000
  s_mov_b32 s7, 0x20000
  s_mov_b32 s14, 0x200000
  s_mov_b32 s15, 0x20000
  s_mov_b32 s18, 0x700000
  s_mov_b32 s19, 0x20000
  s_mov_b32 s22, 0x700000
  s_mov_b32 s23, 0x20000
  s_mov_b32 s26, 0x700000
  s_mov_b32 s27, 0x20000
  s_mov_b32 s34, 0x400000
  s_mov_b32 s35, 0x20000
  s_mov_b32 s38, 0x100
  s_mov_b32 s39, 0x20000
  s_mov_b32 s41, 0
  s_mov_b32 s42, 0
  s_and_b32 s44, s2, 1
  s_bfe_u32 s45, s2, 0x20001
  s_lshr_b32 s46, s2, 3
  s_lshl_b32 s47, s44, 3
  s_lshr_b32 s43, s45, 1
  s_lshl_b32 s43, s43, 2
  s_add_u32 s52, s47, s43
  s_and_b32 s48, s46, 3
  s_add_u32 s52, s52, s48
  s_and_b32 s43, s45, 1
  s_lshr_b32 s49, s46, 2
  s_lshl_b32 s53, s49, 1
  s_add_u32 s53, s53, s43
  s_lshl_b32 s43, s44, 2
  s_add_u32 s54, s43, s48
  s_lshl_b32 s43, s45, 3
  s_add_u32 s55, s43, s49
  v_lshrrev_b32 v2, 3, v253
  v_bfe_u32 v3, v253, 1, 2
  v_lshrrev_b32 v4, 4, v253
  v_xor_b32 v3, v3, v4
  v_and_b32 v4, 1, v253
  v_lshlrev_b32 v2, 11, v2
  v_lshl_add_u32 v2, v3, 5, v2
  v_lshl_add_u32 v252, v4, 4, v2
  s_waitcnt lgkmcnt(0)
  s_lshr_b32 s43, s2, 7
  s_mul_i32 s43, s43, 37748736
  s_and_b32 s44, s2, 127
  s_lshl_b32 s44, s44, 7
  s_add_u32 s43, s43, s44
  s_add_u32 s43, s43, 27787264
  buffer_store_dword v251, v251, s[4:7], s43 offen sc1
  v_and_b32 v2, 15, v253
  v_lshrrev_b32 v3, 4, v253
  v_and_b32 v4, 7, v253
  v_lshrrev_b32 v5, 1, v2
  v_xor_b32 v5, v5, v3
  v_lshlrev_b32 v5, 4, v5
  v_lshl_add_u32 v6, v2, 7, v5
  v_xor_b32 v7, 64, v6
  v_and_b32 v5, 6, v4
  v_xor_b32 v5, v5, v3
  v_lshlrev_b32 v5, 4, v5
  v_lshl_add_u32 v8, v4, 7, v5
  v_xor_b32 v9, 64, v8
  s_lshl_b32 s43, s57, 13
  s_add_u32 s43, s43, 73728
  v_add_u32 v112, s43, v6
  v_add_u32 v113, s43, v7
  v_add_u32 v114, 122880, v8
  v_add_u32 v115, 122880, v9
  s_lshl_b32 s43, s52, 3
  s_lshl_b32 s44, s40, 1
  s_add_u32 s43, s43, s44
  v_lshlrev_b32 v187, 12, v2
  v_and_b32 v5, 1, v3
  v_lshl_add_u32 v187, v5, 5, v187
  v_lshrrev_b32 v5, 1, v3
  v_lshl_add_u32 v187, v5, 4, v187
  s_lshr_b32 s44, s43, 6
  s_lshl_b32 s44, s44, 11
  s_and_b32 s43, s43, 63
  s_lshl_b32 s43, s43, 16
  s_add_u32 s43, s43, s44
  s_lshl_b32 s44, s53, 7
  s_add_u32 s64, s43, s44
  s_movk_i32 s65, 64
  v_lshrrev_b32 v2, 2, v253
  v_bfe_u32 v3, v253, 3, 2
  v_and_b32 v4, 3, v253
  v_lshlrev_b32 v4, 3, v4
  v_lshl_add_u32 v4, v2, 7, v4
  s_lshl_b32 s43, s58, 1
  s_or_b32 s43, s43, s57
  v_xor_b32 v5, s43, v3
  v_lshl_add_u32 v116, v5, 5, v4
  v_xor_b32 v5, 1, v5
  v_lshl_add_u32 v117, v5, 5, v4
  v_add_u32 v118, 49152, v116
  v_add_u32 v119, 49152, v117
  v_mov_b32 v0, 0
  v_mov_b32 v1, 0
  v_mov_b32 v2, 0
  v_mov_b32 v3, 0
  v_mov_b32 v4, 0
  v_mov_b32 v5, 0
  v_mov_b32 v6, 0
  v_mov_b32 v7, 0
  v_mov_b32 v8, 0
  v_mov_b32 v9, 0
  v_mov_b32 v10, 0
  v_mov_b32 v11, 0
  v_mov_b32 v12, 0
  v_mov_b32 v13, 0
  v_mov_b32 v14, 0
  v_mov_b32 v15, 0
  v_mov_b32 v16, 0
  v_mov_b32 v17, 0
  v_mov_b32 v18, 0
  v_mov_b32 v19, 0
  v_mov_b32 v20, 0
  v_mov_b32 v21, 0
  v_mov_b32 v22, 0
  v_mov_b32 v23, 0
  v_mov_b32 v24, 0
  v_mov_b32 v25, 0
  v_mov_b32 v26, 0
  v_mov_b32 v27, 0
  v_mov_b32 v28, 0
  v_mov_b32 v29, 0
  v_mov_b32 v30, 0
  v_mov_b32 v31, 0
  v_mov_b32 v32, 0
  v_mov_b32 v33, 0
  v_mov_b32 v34, 0
  v_mov_b32 v35, 0
  v_mov_b32 v36, 0
  v_mov_b32 v37, 0
  v_mov_b32 v38, 0
  v_mov_b32 v39, 0
  v_mov_b32 v40, 0
  v_mov_b32 v41, 0
  v_mov_b32 v42, 0
  v_mov_b32 v43, 0
  v_mov_b32 v44, 0
  v_mov_b32 v45, 0
  v_mov_b32 v46, 0
  v_mov_b32 v47, 0
  v_mov_b32 v48, 0
  v_mov_b32 v49, 0
  v_mov_b32 v50, 0
  v_mov_b32 v51, 0
  v_mov_b32 v52, 0
  v_mov_b32 v53, 0
  v_mov_b32 v54, 0
  v_mov_b32 v55, 0
  v_mov_b32 v56, 0
  v_mov_b32 v57, 0
  v_mov_b32 v58, 0
  v_mov_b32 v59, 0
  v_mov_b32 v60, 0
  v_mov_b32 v61, 0
  v_mov_b32 v62, 0
  v_mov_b32 v63, 0
  v_mov_b32 v64, 0
  v_mov_b32 v65, 0
  v_mov_b32 v66, 0
  v_mov_b32 v67, 0
  v_mov_b32 v68, 0
  v_mov_b32 v69, 0
  v_mov_b32 v70, 0
  v_mov_b32 v71, 0
  v_mov_b32 v72, 0
  v_mov_b32 v73, 0
  v_mov_b32 v74, 0
  v_mov_b32 v75, 0
  v_mov_b32 v76, 0
  v_mov_b32 v77, 0
  v_mov_b32 v78, 0
  v_mov_b32 v79, 0
  v_mov_b32 v80, 0
  v_mov_b32 v81, 0
  v_mov_b32 v82, 0
  v_mov_b32 v83, 0
  v_mov_b32 v84, 0
  v_mov_b32 v85, 0
  v_mov_b32 v86, 0
  v_mov_b32 v87, 0
  v_mov_b32 v88, 0
  v_mov_b32 v89, 0
  v_mov_b32 v90, 0
  v_mov_b32 v91, 0
  v_mov_b32 v92, 0
  v_mov_b32 v93, 0
  v_mov_b32 v94, 0
  v_mov_b32 v95, 0
  v_mov_b32 v96, 0
  v_mov_b32 v97, 0
  v_mov_b32 v98, 0
  v_mov_b32 v99, 0
  v_mov_b32 v100, 0
  v_mov_b32 v101, 0
  v_mov_b32 v102, 0
  v_mov_b32 v103, 0
  v_and_b32 v235, 15, v253
  v_lshrrev_b32 v236, 4, v253
  v_lshlrev_b32 v236, 2, v236
  v_sub_u32 v235, v235, v236
  v_mov_b32 v237, 0xf149f2ca
  v_subrev_u32 v238, 0, v235
  v_cmp_gt_u32 vcc, 8, v238
  v_add_u32 v238, 16, v238
  v_cmp_gt_u32 s[78:79], 8, v238
  v_cndmask_b32 v132, v237, 0, vcc
  s_nop 0
  v_cndmask_b32 v136, v237, 0, s[78:79]
  v_subrev_u32 v238, 1, v235
  v_cmp_gt_u32 vcc, 8, v238
  v_add_u32 v238, 16, v238
  v_cmp_gt_u32 s[78:79], 8, v238
  v_cndmask_b32 v133, v237, 0, vcc
  s_nop 0
  v_cndmask_b32 v137, v237, 0, s[78:79]
  v_subrev_u32 v238, 2, v235
  v_cmp_gt_u32 vcc, 8, v238
  v_add_u32 v238, 16, v238
  v_cmp_gt_u32 s[78:79], 8, v238
  v_cndmask_b32 v134, v237, 0, vcc
  s_nop 0
  v_cndmask_b32 v138, v237, 0, s[78:79]
  v_subrev_u32 v238, 3, v235
  v_cmp_gt_u32 vcc, 8, v238
  v_add_u32 v238, 16, v238
  v_cmp_gt_u32 s[78:79], 8, v238
  v_cndmask_b32 v135, v237, 0, vcc
  s_nop 0
  v_cndmask_b32 v139, v237, 0, s[78:79]
  v_lshlrev_b32 v232, 4, v253
  v_add_u32 v232, 149504, v232
  ds_write_b128 v232, v[132:135]
  ds_write_b128 v232, v[136:139] offset:1024
  s_lshr_b32 s46, s2, 3
  s_cmp_ge_u32 s46, 14
  s_cselect_b32 s44, 14, 0
  s_cselect_b32 s45, 1, 0
  s_cselect_b32 s84, s20, s16
  s_cselect_b32 s85, s21, s17
  s_mov_b32 s86, 7340032
  s_mov_b32 s87, 0x20000
  s_sub_u32 s44, s46, s44
  s_bfe_u32 s47, s2, 0x20001
  s_mul_i32 s47, s47, 14
  s_add_u32 s44, s44, s47
  s_and_b32 s47, s2, 1
  s_lshl_b32 s48, s47, 1
  s_add_u32 s48, s48, s45
  s_mul_i32 s48, s48, 14336
  s_lshl_b32 s49, s44, 8
  s_add_u32 s48, s48, s49
  s_add_u32 s101, s48, 27918336
  s_lshl_b32 s47, s47, 2
  s_add_u32 s47, s47, s40
  s_mul_i32 s47, s47, 458752
  s_lshl_b32 s44, s44, 7
  s_add_u32 s100, s47, s44
  s_cmp_lt_u32 s46, 28
  s_cselect_b32 s3, 1, 0
  s_cmp_eq_u32 s41, 0
  s_cselect_b32 s3, s3, 0
  v_lshrrev_b32 v238, 3, v253
  v_mul_u32_u24 v238, 7168, v238
  v_and_b32 v239, 7, v253
  v_lshl_add_u32 v238, v239, 4, v238
  s_cmp_eq_u32 s3, 0
  s_cselect_b32 s43, 0x40000000, 0
  v_or_b32 v238, s43, v238
  v_lshlrev_b32 v239, 4, v253
  s_lshl_b32 s43, s2, 2
  s_add_u32 s43, s43, s40
  s_lshl_b32 s89, s43, 11
  s_mul_i32 s43, s46, 43
  s_lshr_b32 s43, s43, 8
  s_mul_i32 s43, s43, 6
  s_sub_u32 s43, s46, s43
  s_add_u32 s43, s43, 5
  s_cmp_eq_u32 s41, 0
  s_cselect_b32 s88, s43, 63
  s_mov_b32 s90, 0
  s_lshl_b32 s43, s58, 12
  v_add_u32 v132, s43, v112
  v_add_u32 v133, s43, v113
  v_and_b32 v128, 15, v253
  v_lshrrev_b32 v129, 4, v253
  v_cmp_eq_u32 vcc, 0, v128
  v_lshlrev_b32 v129, 4, v129
  v_mov_b32 v130, 0x40000000
  v_cndmask_b32 v136, v130, v129, vcc
  v_mov_b32 v156, 0x3f803f80
  v_mov_b32 v157, 0x3f803f80
  v_mov_b32 v158, 0x3f803f80
  v_mov_b32 v159, 0x3f803f80
  s_lshl_b32 s43, s40, 1
  s_add_u32 s43, s43, s71
  s_lshl_b32 s48, s43, 11
  s_lshl_b32 s43, s67, 7
  s_add_u32 s48, s48, s43
  s_add_u32 s48, s48, 27262976
  s_lshl_b32 s43, s51, 2
  s_lshl_b32 s44, s58, 1
  s_add_u32 s43, s43, s44
  s_add_u32 s43, s43, s57
  s_lshl_b32 s43, s43, 6
  s_mul_i32 s49, s67, 12288
  s_add_u32 s49, s49, s43
  s_add_u32 s49, s49, 27983872
  s_add_u32 s44, s67, 1
  s_and_b32 s44, s44, 15
  s_mul_i32 s45, s44, s61
  s_add_u32 s68, s45, s59
  s_add_u32 m0, s62, 90112
  s_nop 0
  buffer_load_dwordx4 v120, s[28:31], s68 offen offset:0 sc1  lds
  buffer_load_dwordx4 v121, s[28:31], s68 offen offset:1024 sc1  lds
  buffer_load_dwordx4 v122, s[28:31], s68 offen offset:2048 sc1  lds
  buffer_load_dwordx4 v123, s[28:31], s68 offen offset:3072 sc1  lds
  s_waitcnt vmcnt(5)
  s_barrier
  ds_read_b128 v[140:143], v132 offset:0
  ds_read_b128 v[144:147], v133 offset:0
  ds_read_b128 v[148:151], v132 offset:2048
  ds_read_b128 v[152:155], v133 offset:2048
  ds_read_b64_tr_b16 a[40:41], v116 offset:0
  ds_read_b64_tr_b16 a[42:43], v116 offset:6144
  ds_read_b64_tr_b16 a[64:65], v116 offset:12288
  ds_read_b64_tr_b16 a[66:67], v116 offset:18432
  ds_read_b128 a[4:7], v112 offset:0
  ds_read_b128 a[24:27], v113 offset:0
  ds_read_b128 a[8:11], v112 offset:2048
  ds_read_b128 a[28:31], v113 offset:2048
  ds_read_b128 a[12:15], v112 offset:4096
  ds_read_b128 a[32:35], v113 offset:4096
  ds_read_b128 a[16:19], v112 offset:6144
  ds_read_b128 a[36:39], v113 offset:6144
  ds_read_b64_tr_b16 a[44:45], v117 offset:0
  ds_read_b64_tr_b16 a[46:47], v117 offset:6144
  ds_read_b64_tr_b16 a[68:69], v117 offset:12288
  ds_read_b64_tr_b16 a[70:71], v117 offset:18432
  ds_read_b128 a[0:3], v114 offset:0
  ds_read_b128 a[20:23], v115 offset:0
  ds_read_b64_tr_b16 a[48:49], v116 offset:2048
  ds_read_b64_tr_b16 a[50:51], v116 offset:8192
  ds_read_b64_tr_b16 a[72:73], v116 offset:14336
  ds_read_b64_tr_b16 a[74:75], v116 offset:20480
  ds_read_b64_tr_b16 a[52:53], v117 offset:2048
  ds_read_b64_tr_b16 a[54:55], v117 offset:8192
  ds_read_b64_tr_b16 a[76:77], v117 offset:14336
  ds_read_b64_tr_b16 a[78:79], v117 offset:20480
  ds_read_b64_tr_b16 a[56:57], v116 offset:4096
  ds_read_b64_tr_b16 a[58:59], v116 offset:10240
  ds_read_b64_tr_b16 a[80:81], v116 offset:16384
  ds_read_b64_tr_b16 a[82:83], v116 offset:22528
  ds_read_b64_tr_b16 a[60:61], v117 offset:4096
  ds_read_b64_tr_b16 a[62:63], v117 offset:10240
  ds_read_b64_tr_b16 a[84:85], v117 offset:16384
  ds_read_b64_tr_b16 a[86:87], v117 offset:22528
  s_add_u32 s44, s67, 1
  s_and_b32 s44, s44, 15
  s_mul_i32 s45, s44, 393216
  s_add_u32 s69, s45, s60
  s_add_u32 s70, s69, 4096
  s_add_u32 m0, s63, 24576
  s_nop 0
  buffer_load_dwordx4 v124, s[8:11], s69 offen offset:0  lds
  buffer_load_dwordx4 v125, s[8:11], s69 offen offset:1024  lds
  buffer_load_dwordx4 v124, s[8:11], s69 offen offset:2048  lds
  buffer_load_dwordx4 v125, s[8:11], s69 offen offset:3072  lds
  s_add_u32 m0, s63, 28672
  s_nop 0
  buffer_load_dwordx4 v124, s[8:11], s70 offen offset:0  lds
  buffer_load_dwordx4 v125, s[8:11], s70 offen offset:1024  lds
  s_waitcnt lgkmcnt(0)
  v_mfma_f32_16x16x32_bf16 v[160:163], a[40:43], v[156:159], 0
  v_mfma_f32_16x16x32_bf16 v[164:167], a[48:51], v[156:159], 0
  v_mfma_f32_16x16x32_bf16 v[168:171], a[56:59], v[156:159], 0
  v_mfma_f32_16x16x32_bf16 v[160:163], a[64:67], v[156:159], v[160:163]
  v_mfma_f32_16x16x32_bf16 v[164:167], a[72:75], v[156:159], v[164:167]
  v_mfma_f32_16x16x32_bf16 v[168:171], a[80:83], v[156:159], v[168:171]
  v_mov_b32 v192, 0x3f803f80
  v_mov_b32 v193, 0x3f803f80
  v_mov_b32 v194, 0x3f803f80
  v_mov_b32 v195, 0x3f803f80
  v_and_b32 v212, 15, v253
  v_lshrrev_b32 v213, 4, v253
  v_mfma_f32_16x16x32_bf16 v[196:199], v[192:195], v[140:143], 0
  v_mfma_f32_16x16x32_bf16 v[200:203], v[140:143], v[140:143], 0
  v_mfma_f32_16x16x32_bf16 v[204:207], v[192:195], v[148:151], 0
  v_mfma_f32_16x16x32_bf16 v[208:211], v[148:151], v[148:151], 0
  v_mfma_f32_16x16x32_bf16 v[196:199], v[192:195], v[144:147], v[196:199]
  v_mfma_f32_16x16x32_bf16 v[200:203], v[144:147], v[144:147], v[200:203]
  v_mfma_f32_16x16x32_bf16 v[204:207], v[192:195], v[152:155], v[204:207]
  v_mfma_f32_16x16x32_bf16 v[208:211], v[152:155], v[152:155], v[208:211]
  v_lshrrev_b32 v192, 2, v212
  v_cmp_eq_u32 s[80:81], v192, v213
  v_and_b32 v192, 3, v212
  v_cmp_eq_u32 s[82:83], 1, v192
  v_cmp_eq_u32 s[92:93], 2, v192
  v_cmp_eq_u32 s[46:47], 3, v192
  v_lshlrev_b32 v212, 3, v212
  v_mov_b32 v213, 0x7ffffff0
  s_nop 0
  v_cndmask_b32 v212, v213, v212, s[80:81]
  v_cndmask_b32 v197, v200, v201, s[82:83]
  v_cndmask_b32 v197, v197, v202, s[92:93]
  v_cndmask_b32 v197, v197, v203, s[46:47]
  buffer_store_dwordx2 v[196:197], v212, s[4:7], s48 offen offset:0 sc1
  v_cndmask_b32 v205, v208, v209, s[82:83]
  v_cndmask_b32 v205, v205, v210, s[92:93]
  v_cndmask_b32 v205, v205, v211, s[46:47]
  buffer_store_dwordx2 v[204:205], v212, s[4:7], s48 offen offset:2048 sc1
  buffer_store_dwordx4 v[160:163], v136, s[4:7], s49 offen sc1
  s_add_u32 s49, s49, 4096
  buffer_store_dwordx4 v[164:167], v136, s[4:7], s49 offen sc1
  s_add_u32 s49, s49, 4096
  buffer_store_dwordx4 v[168:171], v136, s[4:7], s49 offen sc1
  s_add_u32 s49, s49, 4096
  s_add_u32 s44, s67, s40
  s_add_u32 s44, s44, 4
  s_and_b32 s44, s44, 15
  s_mul_i32 s44, s44, s61
  s_lshl_b32 s45, s40, 10
  s_add_u32 m0, s45, 126976
  s_add_u32 s44, s44, s73
  buffer_load_dwordx4 v126, s[28:31], s44 offen sc1 lds
  s_add_u32 s44, s67, s40
  s_add_u32 s44, s44, 8
  s_and_b32 s44, s44, 15
  s_mul_i32 s44, s44, s61
  s_lshl_b32 s45, s40, 10
  s_add_u32 m0, s45, 131072
  s_add_u32 s44, s44, s73
  buffer_load_dwordx4 v126, s[28:31], s44 offen sc1 lds
  s_add_u32 s44, s67, s40
  s_add_u32 s44, s44, 12
  s_and_b32 s44, s44, 15
  s_mul_i32 s44, s44, s61
  s_lshl_b32 s45, s40, 10
  s_add_u32 m0, s45, 135168
  s_add_u32 s44, s44, s73
  buffer_load_dwordx4 v126, s[28:31], s44 offen sc1 lds
  s_add_u32 s44, s67, 2
  s_and_b32 s44, s44, 15
  s_mul_i32 s45, s44, 393216
  s_add_u32 s69, s45, s60
  s_add_u32 s70, s69, 4096
  s_add_u32 m0, s63, 49152
  s_nop 0
  buffer_load_dwordx4 v124, s[8:11], s69 offen offset:0  lds
  buffer_load_dwordx4 v125, s[8:11], s69 offen offset:1024  lds
  buffer_load_dwordx4 v124, s[8:11], s69 offen offset:2048  lds
  buffer_load_dwordx4 v125, s[8:11], s69 offen offset:3072  lds
  s_add_u32 m0, s63, 53248
  s_nop 0
  buffer_load_dwordx4 v124, s[8:11], s70 offen offset:0  lds
  buffer_load_dwordx4 v125, s[8:11], s70 offen offset:1024  lds
  s_add_u32 s44, s67, 2
  s_and_b32 s44, s44, 15
  s_mul_i32 s45, s44, s61
  s_add_u32 s68, s45, s59
  s_add_u32 m0, s62, 106496
  s_nop 0
  buffer_load_dwordx4 v120, s[28:31], s68 offen offset:0 sc1  lds
  buffer_load_dwordx4 v121, s[28:31], s68 offen offset:1024 sc1  lds
  buffer_load_dwordx4 v122, s[28:31], s68 offen offset:2048 sc1  lds
  buffer_load_dwordx4 v123, s[28:31], s68 offen offset:3072 sc1  lds
  s_branch Lp1_common
Llayer:
  s_cmp_lg_u32 s40, 0
  s_cbranch_scc1 Lpdn2
  s_mov_b32 s43, 0x40000
  s_mov_b64 exec, 3
Lpol1:
  buffer_load_dword v250, v249, s[4:7], s77 offen sc1
  s_waitcnt vmcnt(0)
  v_cmp_gt_u32 vcc, 16, v250
  s_cbranch_vccz Lpdn2
  s_sub_u32 s43, s43, 1
  s_cmp_lg_u32 s43, 0
  s_cbranch_scc1 Lpol1
Lpdn2:
  s_mov_b64 exec, -1
  s_waitcnt vmcnt(0) lgkmcnt(0)
  s_barrier
  s_add_u32 s44, s67, s40
  s_add_u32 s44, s44, 0
  s_and_b32 s44, s44, 15
  s_mul_i32 s44, s44, s61
  s_lshl_b32 s45, s40, 10
  s_add_u32 m0, s45, 122880
  s_add_u32 s44, s44, s73
  buffer_load_dwordx4 v126, s[28:31], s44 offen sc1 lds
  s_add_u32 s44, s67, 0
  s_and_b32 s44, s44, 15
  s_mul_i32 s45, s44, s61
  s_add_u32 s68, s45, s59
  s_add_u32 m0, s62, 73728
  s_nop 0
  buffer_load_dwordx4 v120, s[28:31], s68 offen offset:0 sc1  lds
  buffer_load_dwordx4 v121, s[28:31], s68 offen offset:1024 sc1  lds
  buffer_load_dwordx4 v122, s[28:31], s68 offen offset:2048 sc1  lds
  buffer_load_dwordx4 v123, s[28:31], s68 offen offset:3072 sc1  lds
  s_add_u32 s44, s67, 1
  s_and_b32 s44, s44, 15
  s_mul_i32 s45, s44, s61
  s_add_u32 s68, s45, s59
  s_add_u32 m0, s62, 90112
  s_nop 0
  buffer_load_dwordx4 v120, s[28:31], s68 offen offset:0 sc1  lds
  buffer_load_dwordx4 v121, s[28:31], s68 offen offset:1024 sc1  lds
  buffer_load_dwordx4 v122, s[28:31], s68 offen offset:2048 sc1  lds
  buffer_load_dwordx4 v123, s[28:31], s68 offen offset:3072 sc1  lds
  s_waitcnt vmcnt(4)
  s_barrier
  ds_read_b64_tr_b16 a[40:41], v116 offset:0
  ds_read_b64_tr_b16 a[42:43], v116 offset:6144
  ds_read_b64_tr_b16 a[64:65], v116 offset:12288
  ds_read_b64_tr_b16 a[66:67], v116 offset:18432
  ds_read_b128 a[4:7], v112 offset:0
  ds_read_b128 a[24:27], v113 offset:0
  ds_read_b128 a[8:11], v112 offset:2048
  ds_read_b128 a[28:31], v113 offset:2048
  ds_read_b128 a[12:15], v112 offset:4096
  ds_read_b128 a[32:35], v113 offset:4096
  ds_read_b128 a[16:19], v112 offset:6144
  ds_read_b128 a[36:39], v113 offset:6144
  ds_read_b64_tr_b16 a[44:45], v117 offset:0
  ds_read_b64_tr_b16 a[46:47], v117 offset:6144
  ds_read_b64_tr_b16 a[68:69], v117 offset:12288
  ds_read_b64_tr_b16 a[70:71], v117 offset:18432
  ds_read_b128 a[0:3], v114 offset:0
  ds_read_b128 a[20:23], v115 offset:0
  ds_read_b64_tr_b16 a[48:49], v116 offset:2048
  ds_read_b64_tr_b16 a[50:51], v116 offset:8192
  ds_read_b64_tr_b16 a[72:73], v116 offset:14336
  ds_read_b64_tr_b16 a[74:75], v116 offset:20480
  ds_read_b64_tr_b16 a[52:53], v117 offset:2048
  ds_read_b64_tr_b16 a[54:55], v117 offset:8192
  ds_read_b64_tr_b16 a[76:77], v117 offset:14336
  ds_read_b64_tr_b16 a[78:79], v117 offset:20480
  ds_read_b64_tr_b16 a[56:57], v116 offset:4096
  ds_read_b64_tr_b16 a[58:59], v116 offset:10240
  ds_read_b64_tr_b16 a[80:81], v116 offset:16384
  ds_read_b64_tr_b16 a[82:83], v116 offset:22528
  ds_read_b64_tr_b16 a[60:61], v117 offset:4096
  ds_read_b64_tr_b16 a[62:63], v117 offset:10240
  ds_read_b64_tr_b16 a[84:85], v117 offset:16384
  ds_read_b64_tr_b16 a[86:87], v117 offset:22528
  s_add_u32 s44, s67, s40
  s_add_u32 s44, s44, 4
  s_and_b32 s44, s44, 15
  s_mul_i32 s44, s44, s61
  s_lshl_b32 s45, s40, 10
  s_add_u32 m0, s45, 126976
  s_add_u32 s44, s44, s73
  buffer_load_dwordx4 v126, s[28:31], s44 offen sc1 lds
  s_add_u32 s44, s67, s40
  s_add_u32 s44, s44, 8
  s_and_b32 s44, s44, 15
  s_mul_i32 s44, s44, s61
  s_lshl_b32 s45, s40, 10
  s_add_u32 m0, s45, 131072
  s_add_u32 s44, s44, s73
  buffer_load_dwordx4 v126, s[28:31], s44 offen sc1 lds
  s_add_u32 s44, s67, s40
  s_add_u32 s44, s44, 12
  s_and_b32 s44, s44, 15
  s_mul_i32 s44, s44, s61
  s_lshl_b32 s45, s40, 10
  s_add_u32 m0, s45, 135168
  s_add_u32 s44, s44, s73
  buffer_load_dwordx4 v126, s[28:31], s44 offen sc1 lds
  s_add_u32 s44, s67, 2
  s_and_b32 s44, s44, 15
  s_mul_i32 s45, s44, s61
  s_add_u32 s68, s45, s59
  s_add_u32 m0, s62, 106496
  s_nop 0
  buffer_load_dwordx4 v120, s[28:31], s68 offen offset:0 sc1  lds
  buffer_load_dwordx4 v121, s[28:31], s68 offen offset:1024 sc1  lds
  buffer_load_dwordx4 v122, s[28:31], s68 offen offset:2048 sc1  lds
  buffer_load_dwordx4 v123, s[28:31], s68 offen offset:3072 sc1  lds
Lp1_common:
  s_mov_b32 s66, 4
  s_add_u32 s44, s67, 3
  s_and_b32 s44, s44, 15
  s_mul_i32 s45, s44, s61
  s_add_u32 s68, s45, s59
  s_mov_b32 s56, 2
.p2align 3
Lp1_loop:
  s_waitcnt lgkmcnt(15)
  v_mfma_f32_16x16x32_bf16 v[0:3], a[40:43], a[4:7], v[0:3]
  s_mul_i32 s45, s44, 393216
  v_mfma_f32_16x16x32_bf16 v[0:3], a[64:67], a[24:27], v[0:3]
  s_add_u32 s69, s45, s60
  v_mfma_f32_16x16x32_bf16 v[4:7], a[64:67], a[28:31], v[4:7]
  s_add_u32 s70, s69, 4096
  v_mfma_f32_16x16x32_bf16 v[4:7], a[40:43], a[8:11], v[4:7]
  v_mfma_f32_16x16x32_bf16 v[8:11], a[40:43], a[12:15], v[8:11]
  v_mfma_f32_16x16x32_bf16 v[8:11], a[64:67], a[32:35], v[8:11]
  v_mfma_f32_16x16x32_bf16 v[12:15], a[64:67], a[36:39], v[12:15]
  v_mfma_f32_16x16x32_bf16 v[12:15], a[40:43], a[16:19], v[12:15]
  v_mfma_f32_16x16x32_bf16 v[28:31], a[44:47], a[16:19], v[28:31]
  v_mfma_f32_16x16x32_bf16 v[28:31], a[68:71], a[36:39], v[28:31]
  v_mfma_f32_16x16x32_bf16 v[24:27], a[68:71], a[32:35], v[24:27]
  s_waitcnt vmcnt(7) lgkmcnt(0)
  s_barrier
  ds_read_b64_tr_b16 a[128:129], v116 offset:24576
  v_mfma_f32_16x16x32_bf16 v[24:27], a[44:47], a[12:15], v[24:27]
  s_add_u32 m0, s62, 73728
  ds_read_b64_tr_b16 a[130:131], v116 offset:30720
  v_mfma_f32_16x16x32_bf16 v[20:23], a[44:47], a[8:11], v[20:23]
  ds_read_b64_tr_b16 a[152:153], v116 offset:36864
  buffer_load_dwordx4 v120, s[28:31], s68 offen offset:0 sc1  lds
  v_mfma_f32_16x16x32_bf16 v[20:23], a[68:71], a[28:31], v[20:23]
  ds_read_b64_tr_b16 a[154:155], v116 offset:43008
  v_mfma_f32_16x16x32_bf16 v[16:19], a[68:71], a[24:27], v[16:19]
  ds_read_b128 a[92:95], v112 offset:16384
  v_mfma_f32_16x16x32_bf16 v[16:19], a[44:47], a[4:7], v[16:19]
  ds_read_b128 a[112:115], v113 offset:16384
  v_mfma_f32_16x16x32_bf16 v[96:99], a[48:51], a[0:3], v[96:99]
  ds_read_b128 a[96:99], v112 offset:18432
  buffer_load_dwordx4 v121, s[28:31], s68 offen offset:1024 sc1  lds
  v_mfma_f32_16x16x32_bf16 v[96:99], a[72:75], a[20:23], v[96:99]
  ds_read_b128 a[116:119], v113 offset:18432
  v_mfma_f32_16x16x32_bf16 v[32:35], a[72:75], a[24:27], v[32:35]
  ds_read_b128 a[100:103], v112 offset:20480
  v_mfma_f32_16x16x32_bf16 v[32:35], a[48:51], a[4:7], v[32:35]
  ds_read_b128 a[120:123], v113 offset:20480
  v_mfma_f32_16x16x32_bf16 v[36:39], a[48:51], a[8:11], v[36:39]
  ds_read_b128 a[104:107], v112 offset:22528
  buffer_load_dwordx4 v122, s[28:31], s68 offen offset:2048 sc1  lds
  v_mfma_f32_16x16x32_bf16 v[36:39], a[72:75], a[28:31], v[36:39]
  ds_read_b128 a[124:127], v113 offset:22528
  v_mfma_f32_16x16x32_bf16 v[40:43], a[72:75], a[32:35], v[40:43]
  ds_read_b64_tr_b16 a[132:133], v117 offset:24576
  v_mfma_f32_16x16x32_bf16 v[40:43], a[48:51], a[12:15], v[40:43]
  ds_read_b64_tr_b16 a[134:135], v117 offset:30720
  v_mfma_f32_16x16x32_bf16 v[44:47], a[48:51], a[16:19], v[44:47]
  ds_read_b64_tr_b16 a[156:157], v117 offset:36864
  buffer_load_dwordx4 v123, s[28:31], s68 offen offset:3072 sc1  lds
  v_mfma_f32_16x16x32_bf16 v[44:47], a[72:75], a[36:39], v[44:47]
  ds_read_b64_tr_b16 a[158:159], v117 offset:43008
  v_mfma_f32_16x16x32_bf16 v[60:63], a[76:79], a[36:39], v[60:63]
  ds_read_b128 a[88:91], v114 offset:1024
  v_mfma_f32_16x16x32_bf16 v[60:63], a[52:55], a[16:19], v[60:63]
  s_add_u32 m0, s63, 0
  ds_read_b128 a[108:111], v115 offset:1024
  v_mfma_f32_16x16x32_bf16 v[56:59], a[52:55], a[12:15], v[56:59]
  ds_read_b64_tr_b16 a[136:137], v116 offset:26624
  buffer_load_dwordx4 v124, s[8:11], s69 offen offset:0  lds
  v_mfma_f32_16x16x32_bf16 v[56:59], a[76:79], a[32:35], v[56:59]
  ds_read_b64_tr_b16 a[138:139], v116 offset:32768
  v_mfma_f32_16x16x32_bf16 v[52:55], a[76:79], a[28:31], v[52:55]
  s_add_u32 s44, s44, 1
  ds_read_b64_tr_b16 a[160:161], v116 offset:38912
  v_mfma_f32_16x16x32_bf16 v[52:55], a[52:55], a[8:11], v[52:55]
  s_and_b32 s44, s44, 15
  ds_read_b64_tr_b16 a[162:163], v116 offset:45056
  v_mfma_f32_16x16x32_bf16 v[48:51], a[52:55], a[4:7], v[48:51]
  s_add_u32 s66, s66, 1
  ds_read_b64_tr_b16 a[140:141], v117 offset:26624
  buffer_load_dwordx4 v125, s[8:11], s69 offen offset:1024  lds
  v_mfma_f32_16x16x32_bf16 v[48:51], a[76:79], a[24:27], v[48:51]
  s_mul_i32 s45, s44, s61
  ds_read_b64_tr_b16 a[142:143], v117 offset:32768
  v_mfma_f32_16x16x32_bf16 v[100:103], a[20:23], a[80:83], v[100:103]
  s_add_u32 s68, s45, s59
  ds_read_b64_tr_b16 a[164:165], v117 offset:38912
  v_mfma_f32_16x16x32_bf16 v[100:103], a[0:3], a[56:59], v[100:103]
  ds_read_b64_tr_b16 a[166:167], v117 offset:45056
  v_mfma_f32_16x16x32_bf16 v[64:67], a[4:7], a[56:59], v[64:67]
  ds_read_b64_tr_b16 a[144:145], v116 offset:28672
  buffer_load_dwordx4 v124, s[8:11], s69 offen offset:2048  lds
  v_mfma_f32_16x16x32_bf16 v[64:67], a[24:27], a[80:83], v[64:67]
  ds_read_b64_tr_b16 a[146:147], v116 offset:34816
  v_mfma_f32_16x16x32_bf16 v[68:71], a[28:31], a[80:83], v[68:71]
  ds_read_b64_tr_b16 a[168:169], v116 offset:40960
  v_mfma_f32_16x16x32_bf16 v[68:71], a[8:11], a[56:59], v[68:71]
  ds_read_b64_tr_b16 a[170:171], v116 offset:47104
  v_mfma_f32_16x16x32_bf16 v[72:75], a[12:15], a[56:59], v[72:75]
  ds_read_b64_tr_b16 a[148:149], v117 offset:28672
  buffer_load_dwordx4 v125, s[8:11], s69 offen offset:3072  lds
  v_mfma_f32_16x16x32_bf16 v[72:75], a[32:35], a[80:83], v[72:75]
  ds_read_b64_tr_b16 a[150:151], v117 offset:34816
  v_mfma_f32_16x16x32_bf16 v[76:79], a[36:39], a[80:83], v[76:79]
  ds_read_b64_tr_b16 a[172:173], v117 offset:40960
  v_mfma_f32_16x16x32_bf16 v[76:79], a[16:19], a[56:59], v[76:79]
  s_add_u32 m0, s63, 4096
  ds_read_b64_tr_b16 a[174:175], v117 offset:47104
  v_mfma_f32_16x16x32_bf16 v[92:95], a[16:19], a[60:63], v[92:95]
  buffer_load_dwordx4 v124, s[8:11], s70 offen offset:0  lds
  v_mfma_f32_16x16x32_bf16 v[92:95], a[36:39], a[84:87], v[92:95]
  v_mfma_f32_16x16x32_bf16 v[88:91], a[32:35], a[84:87], v[88:91]
  v_mfma_f32_16x16x32_bf16 v[88:91], a[12:15], a[60:63], v[88:91]
  v_mfma_f32_16x16x32_bf16 v[84:87], a[8:11], a[60:63], v[84:87]
  buffer_load_dwordx4 v125, s[8:11], s70 offen offset:1024  lds
  v_mfma_f32_16x16x32_bf16 v[84:87], a[28:31], a[84:87], v[84:87]
  v_mfma_f32_16x16x32_bf16 v[80:83], a[24:27], a[84:87], v[80:83]
  v_mfma_f32_16x16x32_bf16 v[80:83], a[4:7], a[60:63], v[80:83]
  s_cmp_eq_u32 s66, s88
  s_cbranch_scc0 Lside_skip0
  s_call_b64 s[78:79], Lside_sub
Lside_skip0:
  s_waitcnt lgkmcnt(15)
  v_mfma_f32_16x16x32_bf16 v[0:3], a[128:131], a[92:95], v[0:3]
  s_mul_i32 s45, s44, 393216
  v_mfma_f32_16x16x32_bf16 v[0:3], a[152:155], a[112:115], v[0:3]
  s_add_u32 s69, s45, s60
  v_mfma_f32_16x16x32_bf16 v[4:7], a[152:155], a[116:119], v[4:7]
  s_add_u32 s70, s69, 4096
  v_mfma_f32_16x16x32_bf16 v[4:7], a[128:131], a[96:99], v[4:7]
  v_mfma_f32_16x16x32_bf16 v[8:11], a[128:131], a[100:103], v[8:11]
  v_mfma_f32_16x16x32_bf16 v[8:11], a[152:155], a[120:123], v[8:11]
  v_mfma_f32_16x16x32_bf16 v[12:15], a[152:155], a[124:127], v[12:15]
  v_mfma_f32_16x16x32_bf16 v[12:15], a[128:131], a[104:107], v[12:15]
  v_mfma_f32_16x16x32_bf16 v[28:31], a[132:135], a[104:107], v[28:31]
  v_mfma_f32_16x16x32_bf16 v[28:31], a[156:159], a[124:127], v[28:31]
  v_mfma_f32_16x16x32_bf16 v[24:27], a[156:159], a[120:123], v[24:27]
  s_waitcnt vmcnt(10) lgkmcnt(0)
  s_barrier
  ds_read_b64_tr_b16 a[40:41], v118 offset:0
  v_mfma_f32_16x16x32_bf16 v[24:27], a[132:135], a[100:103], v[24:27]
  s_add_u32 m0, s62, 90112
  ds_read_b64_tr_b16 a[42:43], v118 offset:6144
  v_mfma_f32_16x16x32_bf16 v[20:23], a[132:135], a[96:99], v[20:23]
  ds_read_b64_tr_b16 a[64:65], v118 offset:12288
  buffer_load_dwordx4 v120, s[28:31], s68 offen offset:0 sc1  lds
  v_mfma_f32_16x16x32_bf16 v[20:23], a[156:159], a[116:119], v[20:23]
  ds_read_b64_tr_b16 a[66:67], v118 offset:18432
  v_mfma_f32_16x16x32_bf16 v[16:19], a[156:159], a[112:115], v[16:19]
  ds_read_b128 a[4:7], v112 offset:32768
  v_mfma_f32_16x16x32_bf16 v[16:19], a[132:135], a[92:95], v[16:19]
  ds_read_b128 a[24:27], v113 offset:32768
  v_mfma_f32_16x16x32_bf16 v[96:99], a[136:139], a[88:91], v[96:99]
  ds_read_b128 a[8:11], v112 offset:34816
  buffer_load_dwordx4 v121, s[28:31], s68 offen offset:1024 sc1  lds
  v_mfma_f32_16x16x32_bf16 v[96:99], a[160:163], a[108:111], v[96:99]
  ds_read_b128 a[28:31], v113 offset:34816
  v_mfma_f32_16x16x32_bf16 v[32:35], a[160:163], a[112:115], v[32:35]
  ds_read_b128 a[12:15], v112 offset:36864
  v_mfma_f32_16x16x32_bf16 v[32:35], a[136:139], a[92:95], v[32:35]
  ds_read_b128 a[32:35], v113 offset:36864
  v_mfma_f32_16x16x32_bf16 v[36:39], a[136:139], a[96:99], v[36:39]
  ds_read_b128 a[16:19], v112 offset:38912
  buffer_load_dwordx4 v122, s[28:31], s68 offen offset:2048 sc1  lds
  v_mfma_f32_16x16x32_bf16 v[36:39], a[160:163], a[116:119], v[36:39]
  ds_read_b128 a[36:39], v113 offset:38912
  v_mfma_f32_16x16x32_bf16 v[40:43], a[160:163], a[120:123], v[40:43]
  ds_read_b64_tr_b16 a[44:45], v119 offset:0
  v_mfma_f32_16x16x32_bf16 v[40:43], a[136:139], a[100:103], v[40:43]
  ds_read_b64_tr_b16 a[46:47], v119 offset:6144
  v_mfma_f32_16x16x32_bf16 v[44:47], a[136:139], a[104:107], v[44:47]
  ds_read_b64_tr_b16 a[68:69], v119 offset:12288
  buffer_load_dwordx4 v123, s[28:31], s68 offen offset:3072 sc1  lds
  v_mfma_f32_16x16x32_bf16 v[44:47], a[160:163], a[124:127], v[44:47]
  ds_read_b64_tr_b16 a[70:71], v119 offset:18432
  v_mfma_f32_16x16x32_bf16 v[60:63], a[164:167], a[124:127], v[60:63]
  ds_read_b128 a[0:3], v114 offset:2048
  v_mfma_f32_16x16x32_bf16 v[60:63], a[140:143], a[104:107], v[60:63]
  s_add_u32 m0, s63, 24576
  ds_read_b128 a[20:23], v115 offset:2048
  v_mfma_f32_16x16x32_bf16 v[56:59], a[140:143], a[100:103], v[56:59]
  ds_read_b64_tr_b16 a[48:49], v118 offset:2048
  buffer_load_dwordx4 v124, s[8:11], s69 offen offset:0  lds
  v_mfma_f32_16x16x32_bf16 v[56:59], a[164:167], a[120:123], v[56:59]
  ds_read_b64_tr_b16 a[50:51], v118 offset:8192
  v_mfma_f32_16x16x32_bf16 v[52:55], a[164:167], a[116:119], v[52:55]
  s_add_u32 s44, s44, 1
  ds_read_b64_tr_b16 a[72:73], v118 offset:14336
  v_mfma_f32_16x16x32_bf16 v[52:55], a[140:143], a[96:99], v[52:55]
  s_and_b32 s44, s44, 15
  ds_read_b64_tr_b16 a[74:75], v118 offset:20480
  v_mfma_f32_16x16x32_bf16 v[48:51], a[140:143], a[92:95], v[48:51]
  s_add_u32 s66, s66, 1
  ds_read_b64_tr_b16 a[52:53], v119 offset:2048
  buffer_load_dwordx4 v125, s[8:11], s69 offen offset:1024  lds
  v_mfma_f32_16x16x32_bf16 v[48:51], a[164:167], a[112:115], v[48:51]
  s_mul_i32 s45, s44, s61
  ds_read_b64_tr_b16 a[54:55], v119 offset:8192
  v_mfma_f32_16x16x32_bf16 v[100:103], a[108:111], a[168:171], v[100:103]
  s_add_u32 s68, s45, s59
  ds_read_b64_tr_b16 a[76:77], v119 offset:14336
  v_mfma_f32_16x16x32_bf16 v[100:103], a[88:91], a[144:147], v[100:103]
  ds_read_b64_tr_b16 a[78:79], v119 offset:20480
  v_mfma_f32_16x16x32_bf16 v[64:67], a[92:95], a[144:147], v[64:67]
  ds_read_b64_tr_b16 a[56:57], v118 offset:4096
  buffer_load_dwordx4 v124, s[8:11], s69 offen offset:2048  lds
  v_mfma_f32_16x16x32_bf16 v[64:67], a[112:115], a[168:171], v[64:67]
  ds_read_b64_tr_b16 a[58:59], v118 offset:10240
  v_mfma_f32_16x16x32_bf16 v[68:71], a[116:119], a[168:171], v[68:71]
  ds_read_b64_tr_b16 a[80:81], v118 offset:16384
  v_mfma_f32_16x16x32_bf16 v[68:71], a[96:99], a[144:147], v[68:71]
  ds_read_b64_tr_b16 a[82:83], v118 offset:22528
  v_mfma_f32_16x16x32_bf16 v[72:75], a[100:103], a[144:147], v[72:75]
  ds_read_b64_tr_b16 a[60:61], v119 offset:4096
  buffer_load_dwordx4 v125, s[8:11], s69 offen offset:3072  lds
  v_mfma_f32_16x16x32_bf16 v[72:75], a[120:123], a[168:171], v[72:75]
  ds_read_b64_tr_b16 a[62:63], v119 offset:10240
  v_mfma_f32_16x16x32_bf16 v[76:79], a[124:127], a[168:171], v[76:79]
  ds_read_b64_tr_b16 a[84:85], v119 offset:16384
  v_mfma_f32_16x16x32_bf16 v[76:79], a[104:107], a[144:147], v[76:79]
  s_add_u32 m0, s63, 28672
  ds_read_b64_tr_b16 a[86:87], v119 offset:22528
  v_mfma_f32_16x16x32_bf16 v[92:95], a[104:107], a[148:151], v[92:95]
  buffer_load_dwordx4 v124, s[8:11], s70 offen offset:0  lds
  v_mfma_f32_16x16x32_bf16 v[92:95], a[124:127], a[172:175], v[92:95]
  v_mfma_f32_16x16x32_bf16 v[88:91], a[120:123], a[172:175], v[88:91]
  v_mfma_f32_16x16x32_bf16 v[88:91], a[100:103], a[148:151], v[88:91]
  v_mfma_f32_16x16x32_bf16 v[84:87], a[96:99], a[148:151], v[84:87]
  buffer_load_dwordx4 v125, s[8:11], s70 offen offset:1024  lds
  v_mfma_f32_16x16x32_bf16 v[84:87], a[116:119], a[172:175], v[84:87]
  v_mfma_f32_16x16x32_bf16 v[80:83], a[112:115], a[172:175], v[80:83]
  v_mfma_f32_16x16x32_bf16 v[80:83], a[92:95], a[148:151], v[80:83]
  s_cmp_eq_u32 s66, s88
  s_cbranch_scc0 Lside_skip1
  s_call_b64 s[78:79], Lside_sub
Lside_skip1:
  s_waitcnt lgkmcnt(15)
  v_mfma_f32_16x16x32_bf16 v[0:3], a[40:43], a[4:7], v[0:3]
  s_mul_i32 s45, s44, 393216
  v_mfma_f32_16x16x32_bf16 v[0:3], a[64:67], a[24:27], v[0:3]
  s_add_u32 s69, s45, s60
  v_mfma_f32_16x16x32_bf16 v[4:7], a[64:67], a[28:31], v[4:7]
  s_add_u32 s70, s69, 4096
  v_mfma_f32_16x16x32_bf16 v[4:7], a[40:43], a[8:11], v[4:7]
  v_mfma_f32_16x16x32_bf16 v[8:11], a[40:43], a[12:15], v[8:11]
  v_mfma_f32_16x16x32_bf16 v[8:11], a[64:67], a[32:35], v[8:11]
  v_mfma_f32_16x16x32_bf16 v[12:15], a[64:67], a[36:39], v[12:15]
  v_mfma_f32_16x16x32_bf16 v[12:15], a[40:43], a[16:19], v[12:15]
  v_mfma_f32_16x16x32_bf16 v[28:31], a[44:47], a[16:19], v[28:31]
  v_mfma_f32_16x16x32_bf16 v[28:31], a[68:71], a[36:39], v[28:31]
  v_mfma_f32_16x16x32_bf16 v[24:27], a[68:71], a[32:35], v[24:27]
  s_waitcnt vmcnt(10) lgkmcnt(0)
  s_barrier
  ds_read_b64_tr_b16 a[128:129], v116 offset:0
  v_mfma_f32_16x16x32_bf16 v[24:27], a[44:47], a[12:15], v[24:27]
  s_add_u32 m0, s62, 106496
  ds_read_b64_tr_b16 a[130:131], v116 offset:6144
  v_mfma_f32_16x16x32_bf16 v[20:23], a[44:47], a[8:11], v[20:23]
  ds_read_b64_tr_b16 a[152:153], v116 offset:12288
  buffer_load_dwordx4 v120, s[28:31], s68 offen offset:0 sc1  lds
  v_mfma_f32_16x16x32_bf16 v[20:23], a[68:71], a[28:31], v[20:23]
  ds_read_b64_tr_b16 a[154:155], v116 offset:18432
  v_mfma_f32_16x16x32_bf16 v[16:19], a[68:71], a[24:27], v[16:19]
  ds_read_b128 a[92:95], v112 offset:0
  v_mfma_f32_16x16x32_bf16 v[16:19], a[44:47], a[4:7], v[16:19]
  ds_read_b128 a[112:115], v113 offset:0
  v_mfma_f32_16x16x32_bf16 v[96:99], a[48:51], a[0:3], v[96:99]
  ds_read_b128 a[96:99], v112 offset:2048
  buffer_load_dwordx4 v121, s[28:31], s68 offen offset:1024 sc1  lds
  v_mfma_f32_16x16x32_bf16 v[96:99], a[72:75], a[20:23], v[96:99]
  ds_read_b128 a[116:119], v113 offset:2048
  v_mfma_f32_16x16x32_bf16 v[32:35], a[72:75], a[24:27], v[32:35]
  ds_read_b128 a[100:103], v112 offset:4096
  v_mfma_f32_16x16x32_bf16 v[32:35], a[48:51], a[4:7], v[32:35]
  ds_read_b128 a[120:123], v113 offset:4096
  v_mfma_f32_16x16x32_bf16 v[36:39], a[48:51], a[8:11], v[36:39]
  ds_read_b128 a[104:107], v112 offset:6144
  buffer_load_dwordx4 v122, s[28:31], s68 offen offset:2048 sc1  lds
  v_mfma_f32_16x16x32_bf16 v[36:39], a[72:75], a[28:31], v[36:39]
  ds_read_b128 a[124:127], v113 offset:6144
  v_mfma_f32_16x16x32_bf16 v[40:43], a[72:75], a[32:35], v[40:43]
  ds_read_b64_tr_b16 a[132:133], v117 offset:0
  v_mfma_f32_16x16x32_bf16 v[40:43], a[48:51], a[12:15], v[40:43]
  ds_read_b64_tr_b16 a[134:135], v117 offset:6144
  v_mfma_f32_16x16x32_bf16 v[44:47], a[48:51], a[16:19], v[44:47]
  ds_read_b64_tr_b16 a[156:157], v117 offset:12288
  buffer_load_dwordx4 v123, s[28:31], s68 offen offset:3072 sc1  lds
  v_mfma_f32_16x16x32_bf16 v[44:47], a[72:75], a[36:39], v[44:47]
  ds_read_b64_tr_b16 a[158:159], v117 offset:18432
  v_mfma_f32_16x16x32_bf16 v[60:63], a[76:79], a[36:39], v[60:63]
  ds_read_b128 a[88:91], v114 offset:3072
  v_mfma_f32_16x16x32_bf16 v[60:63], a[52:55], a[16:19], v[60:63]
  s_add_u32 m0, s63, 49152
  ds_read_b128 a[108:111], v115 offset:3072
  v_mfma_f32_16x16x32_bf16 v[56:59], a[52:55], a[12:15], v[56:59]
  ds_read_b64_tr_b16 a[136:137], v116 offset:2048
  buffer_load_dwordx4 v124, s[8:11], s69 offen offset:0  lds
  v_mfma_f32_16x16x32_bf16 v[56:59], a[76:79], a[32:35], v[56:59]
  ds_read_b64_tr_b16 a[138:139], v116 offset:8192
  v_mfma_f32_16x16x32_bf16 v[52:55], a[76:79], a[28:31], v[52:55]
  s_add_u32 s44, s44, 1
  ds_read_b64_tr_b16 a[160:161], v116 offset:14336
  v_mfma_f32_16x16x32_bf16 v[52:55], a[52:55], a[8:11], v[52:55]
  s_and_b32 s44, s44, 15
  ds_read_b64_tr_b16 a[162:163], v116 offset:20480
  v_mfma_f32_16x16x32_bf16 v[48:51], a[52:55], a[4:7], v[48:51]
  s_add_u32 s66, s66, 1
  ds_read_b64_tr_b16 a[140:141], v117 offset:2048
  buffer_load_dwordx4 v125, s[8:11], s69 offen offset:1024  lds
  v_mfma_f32_16x16x32_bf16 v[48:51], a[76:79], a[24:27], v[48:51]
  s_mul_i32 s45, s44, s61
  ds_read_b64_tr_b16 a[142:143], v117 offset:8192
  v_mfma_f32_16x16x32_bf16 v[100:103], a[20:23], a[80:83], v[100:103]
  s_add_u32 s68, s45, s59
  ds_read_b64_tr_b16 a[164:165], v117 offset:14336
  v_mfma_f32_16x16x32_bf16 v[100:103], a[0:3], a[56:59], v[100:103]
  ds_read_b64_tr_b16 a[166:167], v117 offset:20480
  v_mfma_f32_16x16x32_bf16 v[64:67], a[4:7], a[56:59], v[64:67]
  ds_read_b64_tr_b16 a[144:145], v116 offset:4096
  buffer_load_dwordx4 v124, s[8:11], s69 offen offset:2048  lds
  v_mfma_f32_16x16x32_bf16 v[64:67], a[24:27], a[80:83], v[64:67]
  ds_read_b64_tr_b16 a[146:147], v116 offset:10240
  v_mfma_f32_16x16x32_bf16 v[68:71], a[28:31], a[80:83], v[68:71]
  ds_read_b64_tr_b16 a[168:169], v116 offset:16384
  v_mfma_f32_16x16x32_bf16 v[68:71], a[8:11], a[56:59], v[68:71]
  ds_read_b64_tr_b16 a[170:171], v116 offset:22528
  v_mfma_f32_16x16x32_bf16 v[72:75], a[12:15], a[56:59], v[72:75]
  ds_read_b64_tr_b16 a[148:149], v117 offset:4096
  buffer_load_dwordx4 v125, s[8:11], s69 offen offset:3072  lds
  v_mfma_f32_16x16x32_bf16 v[72:75], a[32:35], a[80:83], v[72:75]
  ds_read_b64_tr_b16 a[150:151], v117 offset:10240
  v_mfma_f32_16x16x32_bf16 v[76:79], a[36:39], a[80:83], v[76:79]
  ds_read_b64_tr_b16 a[172:173], v117 offset:16384
  v_mfma_f32_16x16x32_bf16 v[76:79], a[16:19], a[56:59], v[76:79]
  s_add_u32 m0, s63, 53248
  ds_read_b64_tr_b16 a[174:175], v117 offset:22528
  v_mfma_f32_16x16x32_bf16 v[92:95], a[16:19], a[60:63], v[92:95]
  buffer_load_dwordx4 v124, s[8:11], s70 offen offset:0  lds
  v_mfma_f32_16x16x32_bf16 v[92:95], a[36:39], a[84:87], v[92:95]
  v_mfma_f32_16x16x32_bf16 v[88:91], a[32:35], a[84:87], v[88:91]
  v_mfma_f32_16x16x32_bf16 v[88:91], a[12:15], a[60:63], v[88:91]
  v_mfma_f32_16x16x32_bf16 v[84:87], a[8:11], a[60:63], v[84:87]
  buffer_load_dwordx4 v125, s[8:11], s70 offen offset:1024  lds
  v_mfma_f32_16x16x32_bf16 v[84:87], a[28:31], a[84:87], v[84:87]
  v_mfma_f32_16x16x32_bf16 v[80:83], a[24:27], a[84:87], v[80:83]
  v_mfma_f32_16x16x32_bf16 v[80:83], a[4:7], a[60:63], v[80:83]
  s_cmp_eq_u32 s66, s88
  s_cbranch_scc0 Lside_skip2
  s_call_b64 s[78:79], Lside_sub
Lside_skip2:
  s_waitcnt lgkmcnt(15)
  v_mfma_f32_16x16x32_bf16 v[0:3], a[128:131], a[92:95], v[0:3]
  s_mul_i32 s45, s44, 393216
  v_mfma_f32_16x16x32_bf16 v[0:3], a[152:155], a[112:115], v[0:3]
  s_add_u32 s69, s45, s60
  v_mfma_f32_16x16x32_bf16 v[4:7], a[152:155], a[116:119], v[4:7]
  s_add_u32 s70, s69, 4096
  v_mfma_f32_16x16x32_bf16 v[4:7], a[128:131], a[96:99], v[4:7]
  v_mfma_f32_16x16x32_bf16 v[8:11], a[128:131], a[100:103], v[8:11]
  v_mfma_f32_16x16x32_bf16 v[8:11], a[152:155], a[120:123], v[8:11]
  v_mfma_f32_16x16x32_bf16 v[12:15], a[152:155], a[124:127], v[12:15]
  v_mfma_f32_16x16x32_bf16 v[12:15], a[128:131], a[104:107], v[12:15]
  v_mfma_f32_16x16x32_bf16 v[28:31], a[132:135], a[104:107], v[28:31]
  v_mfma_f32_16x16x32_bf16 v[28:31], a[156:159], a[124:127], v[28:31]
  v_mfma_f32_16x16x32_bf16 v[24:27], a[156:159], a[120:123], v[24:27]
  s_waitcnt vmcnt(10) lgkmcnt(0)
  s_barrier
  ds_read_b64_tr_b16 a[40:41], v116 offset:24576
  v_mfma_f32_16x16x32_bf16 v[24:27], a[132:135], a[100:103], v[24:27]
  s_add_u32 m0, s62, 73728
  ds_read_b64_tr_b16 a[42:43], v116 offset:30720
  v_mfma_f32_16x16x32_bf16 v[20:23], a[132:135], a[96:99], v[20:23]
  ds_read_b64_tr_b16 a[64:65], v116 offset:36864
  buffer_load_dwordx4 v120, s[28:31], s68 offen offset:0 sc1  lds
  v_mfma_f32_16x16x32_bf16 v[20:23], a[156:159], a[116:119], v[20:23]
  ds_read_b64_tr_b16 a[66:67], v116 offset:43008
  v_mfma_f32_16x16x32_bf16 v[16:19], a[156:159], a[112:115], v[16:19]
  ds_read_b128 a[4:7], v112 offset:16384
  v_mfma_f32_16x16x32_bf16 v[16:19], a[132:135], a[92:95], v[16:19]
  ds_read_b128 a[24:27], v113 offset:16384
  v_mfma_f32_16x16x32_bf16 v[96:99], a[136:139], a[88:91], v[96:99]
  ds_read_b128 a[8:11], v112 offset:18432
  buffer_load_dwordx4 v121, s[28:31], s68 offen offset:1024 sc1  lds
  v_mfma_f32_16x16x32_bf16 v[96:99], a[160:163], a[108:111], v[96:99]
  ds_read_b128 a[28:31], v113 offset:18432
  v_mfma_f32_16x16x32_bf16 v[32:35], a[160:163], a[112:115], v[32:35]
  ds_read_b128 a[12:15], v112 offset:20480
  v_mfma_f32_16x16x32_bf16 v[32:35], a[136:139], a[92:95], v[32:35]
  ds_read_b128 a[32:35], v113 offset:20480
  v_mfma_f32_16x16x32_bf16 v[36:39], a[136:139], a[96:99], v[36:39]
  ds_read_b128 a[16:19], v112 offset:22528
  buffer_load_dwordx4 v122, s[28:31], s68 offen offset:2048 sc1  lds
  v_mfma_f32_16x16x32_bf16 v[36:39], a[160:163], a[116:119], v[36:39]
  ds_read_b128 a[36:39], v113 offset:22528
  v_mfma_f32_16x16x32_bf16 v[40:43], a[160:163], a[120:123], v[40:43]
  ds_read_b64_tr_b16 a[44:45], v117 offset:24576
  v_mfma_f32_16x16x32_bf16 v[40:43], a[136:139], a[100:103], v[40:43]
  ds_read_b64_tr_b16 a[46:47], v117 offset:30720
  v_mfma_f32_16x16x32_bf16 v[44:47], a[136:139], a[104:107], v[44:47]
  ds_read_b64_tr_b16 a[68:69], v117 offset:36864
  buffer_load_dwordx4 v123, s[28:31], s68 offen offset:3072 sc1  lds
  v_mfma_f32_16x16x32_bf16 v[44:47], a[160:163], a[124:127], v[44:47]
  ds_read_b64_tr_b16 a[70:71], v117 offset:43008
  v_mfma_f32_16x16x32_bf16 v[60:63], a[164:167], a[124:127], v[60:63]
  ds_read_b128 a[0:3], v114 offset:4096
  v_mfma_f32_16x16x32_bf16 v[60:63], a[140:143], a[104:107], v[60:63]
  s_add_u32 m0, s63, 0
  ds_read_b128 a[20:23], v115 offset:4096
  v_mfma_f32_16x16x32_bf16 v[56:59], a[140:143], a[100:103], v[56:59]
  ds_read_b64_tr_b16 a[48:49], v116 offset:26624
  buffer_load_dwordx4 v124, s[8:11], s69 offen offset:0  lds
  v_mfma_f32_16x16x32_bf16 v[56:59], a[164:167], a[120:123], v[56:59]
  ds_read_b64_tr_b16 a[50:51], v116 offset:32768
  v_mfma_f32_16x16x32_bf16 v[52:55], a[164:167], a[116:119], v[52:55]
  s_add_u32 s44, s44, 1
  ds_read_b64_tr_b16 a[72:73], v116 offset:38912
  v_mfma_f32_16x16x32_bf16 v[52:55], a[140:143], a[96:99], v[52:55]
  s_and_b32 s44, s44, 15
  ds_read_b64_tr_b16 a[74:75], v116 offset:45056
  v_mfma_f32_16x16x32_bf16 v[48:51], a[140:143], a[92:95], v[48:51]
  s_add_u32 s66, s66, 1
  ds_read_b64_tr_b16 a[52:53], v117 offset:26624
  buffer_load_dwordx4 v125, s[8:11], s69 offen offset:1024  lds
  v_mfma_f32_16x16x32_bf16 v[48:51], a[164:167], a[112:115], v[48:51]
  s_mul_i32 s45, s44, s61
  ds_read_b64_tr_b16 a[54:55], v117 offset:32768
  v_mfma_f32_16x16x32_bf16 v[100:103], a[108:111], a[168:171], v[100:103]
  s_add_u32 s68, s45, s59
  ds_read_b64_tr_b16 a[76:77], v117 offset:38912
  v_mfma_f32_16x16x32_bf16 v[100:103], a[88:91], a[144:147], v[100:103]
  ds_read_b64_tr_b16 a[78:79], v117 offset:45056
  v_mfma_f32_16x16x32_bf16 v[64:67], a[92:95], a[144:147], v[64:67]
  ds_read_b64_tr_b16 a[56:57], v116 offset:28672
  buffer_load_dwordx4 v124, s[8:11], s69 offen offset:2048  lds
  v_mfma_f32_16x16x32_bf16 v[64:67], a[112:115], a[168:171], v[64:67]
  ds_read_b64_tr_b16 a[58:59], v116 offset:34816
  v_mfma_f32_16x16x32_bf16 v[68:71], a[116:119], a[168:171], v[68:71]
  ds_read_b64_tr_b16 a[80:81], v116 offset:40960
  v_mfma_f32_16x16x32_bf16 v[68:71], a[96:99], a[144:147], v[68:71]
  ds_read_b64_tr_b16 a[82:83], v116 offset:47104
  v_mfma_f32_16x16x32_bf16 v[72:75], a[100:103], a[144:147], v[72:75]
  ds_read_b64_tr_b16 a[60:61], v117 offset:28672
  buffer_load_dwordx4 v125, s[8:11], s69 offen offset:3072  lds
  v_mfma_f32_16x16x32_bf16 v[72:75], a[120:123], a[168:171], v[72:75]
  ds_read_b64_tr_b16 a[62:63], v117 offset:34816
  v_mfma_f32_16x16x32_bf16 v[76:79], a[124:127], a[168:171], v[76:79]
  ds_read_b64_tr_b16 a[84:85], v117 offset:40960
  v_mfma_f32_16x16x32_bf16 v[76:79], a[104:107], a[144:147], v[76:79]
  s_add_u32 m0, s63, 4096
  ds_read_b64_tr_b16 a[86:87], v117 offset:47104
  v_mfma_f32_16x16x32_bf16 v[92:95], a[104:107], a[148:151], v[92:95]
  buffer_load_dwordx4 v124, s[8:11], s70 offen offset:0  lds
  v_mfma_f32_16x16x32_bf16 v[92:95], a[124:127], a[172:175], v[92:95]
  v_mfma_f32_16x16x32_bf16 v[88:91], a[120:123], a[172:175], v[88:91]
  v_mfma_f32_16x16x32_bf16 v[88:91], a[100:103], a[148:151], v[88:91]
  v_mfma_f32_16x16x32_bf16 v[84:87], a[96:99], a[148:151], v[84:87]
  buffer_load_dwordx4 v125, s[8:11], s70 offen offset:1024  lds
  v_mfma_f32_16x16x32_bf16 v[84:87], a[116:119], a[172:175], v[84:87]
  v_mfma_f32_16x16x32_bf16 v[80:83], a[112:115], a[172:175], v[80:83]
  v_mfma_f32_16x16x32_bf16 v[80:83], a[92:95], a[148:151], v[80:83]
  s_cmp_eq_u32 s66, s88
  s_cbranch_scc0 Lside_skip3
  s_call_b64 s[78:79], Lside_sub
Lside_skip3:
  s_waitcnt lgkmcnt(15)
  v_mfma_f32_16x16x32_bf16 v[0:3], a[40:43], a[4:7], v[0:3]
  s_mul_i32 s45, s44, 393216
  v_mfma_f32_16x16x32_bf16 v[0:3], a[64:67], a[24:27], v[0:3]
  s_add_u32 s69, s45, s60
  v_mfma_f32_16x16x32_bf16 v[4:7], a[64:67], a[28:31], v[4:7]
  s_add_u32 s70, s69, 4096
  v_mfma_f32_16x16x32_bf16 v[4:7], a[40:43], a[8:11], v[4:7]
  v_mfma_f32_16x16x32_bf16 v[8:11], a[40:43], a[12:15], v[8:11]
  v_mfma_f32_16x16x32_bf16 v[8:11], a[64:67], a[32:35], v[8:11]
  v_mfma_f32_16x16x32_bf16 v[12:15], a[64:67], a[36:39], v[12:15]
  v_mfma_f32_16x16x32_bf16 v[12:15], a[40:43], a[16:19], v[12:15]
  v_mfma_f32_16x16x32_bf16 v[28:31], a[44:47], a[16:19], v[28:31]
  v_mfma_f32_16x16x32_bf16 v[28:31], a[68:71], a[36:39], v[28:31]
  v_mfma_f32_16x16x32_bf16 v[24:27], a[68:71], a[32:35], v[24:27]
  s_waitcnt vmcnt(10) lgkmcnt(0)
  s_barrier
  ds_read_b64_tr_b16 a[128:129], v118 offset:0
  v_mfma_f32_16x16x32_bf16 v[24:27], a[44:47], a[12:15], v[24:27]
  s_add_u32 m0, s62, 90112
  ds_read_b64_tr_b16 a[130:131], v118 offset:6144
  v_mfma_f32_16x16x32_bf16 v[20:23], a[44:47], a[8:11], v[20:23]
  ds_read_b64_tr_b16 a[152:153], v118 offset:12288
  buffer_load_dwordx4 v120, s[28:31], s68 offen offset:0 sc1  lds
  v_mfma_f32_16x16x32_bf16 v[20:23], a[68:71], a[28:31], v[20:23]
  ds_read_b64_tr_b16 a[154:155], v118 offset:18432
  v_mfma_f32_16x16x32_bf16 v[16:19], a[68:71], a[24:27], v[16:19]
  ds_read_b128 a[92:95], v112 offset:32768
  v_mfma_f32_16x16x32_bf16 v[16:19], a[44:47], a[4:7], v[16:19]
  ds_read_b128 a[112:115], v113 offset:32768
  v_mfma_f32_16x16x32_bf16 v[96:99], a[48:51], a[0:3], v[96:99]
  ds_read_b128 a[96:99], v112 offset:34816
  buffer_load_dwordx4 v121, s[28:31], s68 offen offset:1024 sc1  lds
  v_mfma_f32_16x16x32_bf16 v[96:99], a[72:75], a[20:23], v[96:99]
  ds_read_b128 a[116:119], v113 offset:34816
  v_mfma_f32_16x16x32_bf16 v[32:35], a[72:75], a[24:27], v[32:35]
  ds_read_b128 a[100:103], v112 offset:36864
  v_mfma_f32_16x16x32_bf16 v[32:35], a[48:51], a[4:7], v[32:35]
  ds_read_b128 a[120:123], v113 offset:36864
  v_mfma_f32_16x16x32_bf16 v[36:39], a[48:51], a[8:11], v[36:39]
  ds_read_b128 a[104:107], v112 offset:38912
  buffer_load_dwordx4 v122, s[28:31], s68 offen offset:2048 sc1  lds
  v_mfma_f32_16x16x32_bf16 v[36:39], a[72:75], a[28:31], v[36:39]
  ds_read_b128 a[124:127], v113 offset:38912
  v_mfma_f32_16x16x32_bf16 v[40:43], a[72:75], a[32:35], v[40:43]
  ds_read_b64_tr_b16 a[132:133], v119 offset:0
  v_mfma_f32_16x16x32_bf16 v[40:43], a[48:51], a[12:15], v[40:43]
  ds_read_b64_tr_b16 a[134:135], v119 offset:6144
  v_mfma_f32_16x16x32_bf16 v[44:47], a[48:51], a[16:19], v[44:47]
  ds_read_b64_tr_b16 a[156:157], v119 offset:12288
  buffer_load_dwordx4 v123, s[28:31], s68 offen offset:3072 sc1  lds
  v_mfma_f32_16x16x32_bf16 v[44:47], a[72:75], a[36:39], v[44:47]
  ds_read_b64_tr_b16 a[158:159], v119 offset:18432
  v_mfma_f32_16x16x32_bf16 v[60:63], a[76:79], a[36:39], v[60:63]
  ds_read_b128 a[88:91], v114 offset:5120
  v_mfma_f32_16x16x32_bf16 v[60:63], a[52:55], a[16:19], v[60:63]
  s_add_u32 m0, s63, 24576
  ds_read_b128 a[108:111], v115 offset:5120
  v_mfma_f32_16x16x32_bf16 v[56:59], a[52:55], a[12:15], v[56:59]
  ds_read_b64_tr_b16 a[136:137], v118 offset:2048
  buffer_load_dwordx4 v124, s[8:11], s69 offen offset:0  lds
  v_mfma_f32_16x16x32_bf16 v[56:59], a[76:79], a[32:35], v[56:59]
  ds_read_b64_tr_b16 a[138:139], v118 offset:8192
  v_mfma_f32_16x16x32_bf16 v[52:55], a[76:79], a[28:31], v[52:55]
  s_add_u32 s44, s44, 1
  ds_read_b64_tr_b16 a[160:161], v118 offset:14336
  v_mfma_f32_16x16x32_bf16 v[52:55], a[52:55], a[8:11], v[52:55]
  s_and_b32 s44, s44, 15
  ds_read_b64_tr_b16 a[162:163], v118 offset:20480
  v_mfma_f32_16x16x32_bf16 v[48:51], a[52:55], a[4:7], v[48:51]
  s_add_u32 s66, s66, 1
  ds_read_b64_tr_b16 a[140:141], v119 offset:2048
  buffer_load_dwordx4 v125, s[8:11], s69 offen offset:1024  lds
  v_mfma_f32_16x16x32_bf16 v[48:51], a[76:79], a[24:27], v[48:51]
  s_mul_i32 s45, s44, s61
  ds_read_b64_tr_b16 a[142:143], v119 offset:8192
  v_mfma_f32_16x16x32_bf16 v[100:103], a[20:23], a[80:83], v[100:103]
  s_add_u32 s68, s45, s59
  ds_read_b64_tr_b16 a[164:165], v119 offset:14336
  v_mfma_f32_16x16x32_bf16 v[100:103], a[0:3], a[56:59], v[100:103]
  ds_read_b64_tr_b16 a[166:167], v119 offset:20480
  v_mfma_f32_16x16x32_bf16 v[64:67], a[4:7], a[56:59], v[64:67]
  ds_read_b64_tr_b16 a[144:145], v118 offset:4096
  buffer_load_dwordx4 v124, s[8:11], s69 offen offset:2048  lds
  v_mfma_f32_16x16x32_bf16 v[64:67], a[24:27], a[80:83], v[64:67]
  ds_read_b64_tr_b16 a[146:147], v118 offset:10240
  v_mfma_f32_16x16x32_bf16 v[68:71], a[28:31], a[80:83], v[68:71]
  ds_read_b64_tr_b16 a[168:169], v118 offset:16384
  v_mfma_f32_16x16x32_bf16 v[68:71], a[8:11], a[56:59], v[68:71]
  ds_read_b64_tr_b16 a[170:171], v118 offset:22528
  v_mfma_f32_16x16x32_bf16 v[72:75], a[12:15], a[56:59], v[72:75]
  ds_read_b64_tr_b16 a[148:149], v119 offset:4096
  buffer_load_dwordx4 v125, s[8:11], s69 offen offset:3072  lds
  v_mfma_f32_16x16x32_bf16 v[72:75], a[32:35], a[80:83], v[72:75]
  ds_read_b64_tr_b16 a[150:151], v119 offset:10240
  v_mfma_f32_16x16x32_bf16 v[76:79], a[36:39], a[80:83], v[76:79]
  ds_read_b64_tr_b16 a[172:173], v119 offset:16384
  v_mfma_f32_16x16x32_bf16 v[76:79], a[16:19], a[56:59], v[76:79]
  s_add_u32 m0, s63, 28672
  ds_read_b64_tr_b16 a[174:175], v119 offset:22528
  v_mfma_f32_16x16x32_bf16 v[92:95], a[16:19], a[60:63], v[92:95]
  buffer_load_dwordx4 v124, s[8:11], s70 offen offset:0  lds
  v_mfma_f32_16x16x32_bf16 v[92:95], a[36:39], a[84:87], v[92:95]
  v_mfma_f32_16x16x32_bf16 v[88:91], a[32:35], a[84:87], v[88:91]
  v_mfma_f32_16x16x32_bf16 v[88:91], a[12:15], a[60:63], v[88:91]
  v_mfma_f32_16x16x32_bf16 v[84:87], a[8:11], a[60:63], v[84:87]
  buffer_load_dwordx4 v125, s[8:11], s70 offen offset:1024  lds
  v_mfma_f32_16x16x32_bf16 v[84:87], a[28:31], a[84:87], v[84:87]
  v_mfma_f32_16x16x32_bf16 v[80:83], a[24:27], a[84:87], v[80:83]
  v_mfma_f32_16x16x32_bf16 v[80:83], a[4:7], a[60:63], v[80:83]
  s_cmp_eq_u32 s66, s88
  s_cbranch_scc0 Lside_skip4
  s_call_b64 s[78:79], Lside_sub
Lside_skip4:
  s_waitcnt lgkmcnt(15)
  v_mfma_f32_16x16x32_bf16 v[0:3], a[128:131], a[92:95], v[0:3]
  s_mul_i32 s45, s44, 393216
  v_mfma_f32_16x16x32_bf16 v[0:3], a[152:155], a[112:115], v[0:3]
  s_add_u32 s69, s45, s60
  v_mfma_f32_16x16x32_bf16 v[4:7], a[152:155], a[116:119], v[4:7]
  s_add_u32 s70, s69, 4096
  v_mfma_f32_16x16x32_bf16 v[4:7], a[128:131], a[96:99], v[4:7]
  v_mfma_f32_16x16x32_bf16 v[8:11], a[128:131], a[100:103], v[8:11]
  v_mfma_f32_16x16x32_bf16 v[8:11], a[152:155], a[120:123], v[8:11]
  v_mfma_f32_16x16x32_bf16 v[12:15], a[152:155], a[124:127], v[12:15]
  v_mfma_f32_16x16x32_bf16 v[12:15], a[128:131], a[104:107], v[12:15]
  v_mfma_f32_16x16x32_bf16 v[28:31], a[132:135], a[104:107], v[28:31]
  v_mfma_f32_16x16x32_bf16 v[28:31], a[156:159], a[124:127], v[28:31]
  v_mfma_f32_16x16x32_bf16 v[24:27], a[156:159], a[120:123], v[24:27]
  s_waitcnt vmcnt(10) lgkmcnt(0)
  s_barrier
  ds_read_b64_tr_b16 a[40:41], v116 offset:0
  v_mfma_f32_16x16x32_bf16 v[24:27], a[132:135], a[100:103], v[24:27]
  s_add_u32 m0, s62, 106496
  ds_read_b64_tr_b16 a[42:43], v116 offset:6144
  v_mfma_f32_16x16x32_bf16 v[20:23], a[132:135], a[96:99], v[20:23]
  ds_read_b64_tr_b16 a[64:65], v116 offset:12288
  buffer_load_dwordx4 v120, s[28:31], s68 offen offset:0 sc1  lds
  v_mfma_f32_16x16x32_bf16 v[20:23], a[156:159], a[116:119], v[20:23]
  ds_read_b64_tr_b16 a[66:67], v116 offset:18432
  v_mfma_f32_16x16x32_bf16 v[16:19], a[156:159], a[112:115], v[16:19]
  ds_read_b128 a[4:7], v112 offset:0
  v_mfma_f32_16x16x32_bf16 v[16:19], a[132:135], a[92:95], v[16:19]
  ds_read_b128 a[24:27], v113 offset:0
  v_mfma_f32_16x16x32_bf16 v[96:99], a[136:139], a[88:91], v[96:99]
  ds_read_b128 a[8:11], v112 offset:2048
  buffer_load_dwordx4 v121, s[28:31], s68 offen offset:1024 sc1  lds
  v_mfma_f32_16x16x32_bf16 v[96:99], a[160:163], a[108:111], v[96:99]
  ds_read_b128 a[28:31], v113 offset:2048
  v_mfma_f32_16x16x32_bf16 v[32:35], a[160:163], a[112:115], v[32:35]
  ds_read_b128 a[12:15], v112 offset:4096
  v_mfma_f32_16x16x32_bf16 v[32:35], a[136:139], a[92:95], v[32:35]
  ds_read_b128 a[32:35], v113 offset:4096
  v_mfma_f32_16x16x32_bf16 v[36:39], a[136:139], a[96:99], v[36:39]
  ds_read_b128 a[16:19], v112 offset:6144
  buffer_load_dwordx4 v122, s[28:31], s68 offen offset:2048 sc1  lds
  v_mfma_f32_16x16x32_bf16 v[36:39], a[160:163], a[116:119], v[36:39]
  ds_read_b128 a[36:39], v113 offset:6144
  v_mfma_f32_16x16x32_bf16 v[40:43], a[160:163], a[120:123], v[40:43]
  ds_read_b64_tr_b16 a[44:45], v117 offset:0
  v_mfma_f32_16x16x32_bf16 v[40:43], a[136:139], a[100:103], v[40:43]
  ds_read_b64_tr_b16 a[46:47], v117 offset:6144
  v_mfma_f32_16x16x32_bf16 v[44:47], a[136:139], a[104:107], v[44:47]
  ds_read_b64_tr_b16 a[68:69], v117 offset:12288
  buffer_load_dwordx4 v123, s[28:31], s68 offen offset:3072 sc1  lds
  v_mfma_f32_16x16x32_bf16 v[44:47], a[160:163], a[124:127], v[44:47]
  ds_read_b64_tr_b16 a[70:71], v117 offset:18432
  v_mfma_f32_16x16x32_bf16 v[60:63], a[164:167], a[124:127], v[60:63]
  ds_read_b128 a[0:3], v114 offset:6144
  v_add_u32 v114, 6144, v114
  v_mfma_f32_16x16x32_bf16 v[60:63], a[140:143], a[104:107], v[60:63]
  s_add_u32 m0, s63, 49152
  ds_read_b128 a[20:23], v115 offset:6144
  v_add_u32 v115, 6144, v115
  v_mfma_f32_16x16x32_bf16 v[56:59], a[140:143], a[100:103], v[56:59]
  ds_read_b64_tr_b16 a[48:49], v116 offset:2048
  buffer_load_dwordx4 v124, s[8:11], s69 offen offset:0  lds
  v_mfma_f32_16x16x32_bf16 v[56:59], a[164:167], a[120:123], v[56:59]
  ds_read_b64_tr_b16 a[50:51], v116 offset:8192
  v_mfma_f32_16x16x32_bf16 v[52:55], a[164:167], a[116:119], v[52:55]
  s_add_u32 s44, s44, 1
  ds_read_b64_tr_b16 a[72:73], v116 offset:14336
  v_mfma_f32_16x16x32_bf16 v[52:55], a[140:143], a[96:99], v[52:55]
  s_and_b32 s44, s44, 15
  ds_read_b64_tr_b16 a[74:75], v116 offset:20480
  v_mfma_f32_16x16x32_bf16 v[48:51], a[140:143], a[92:95], v[48:51]
  s_add_u32 s66, s66, 1
  ds_read_b64_tr_b16 a[52:53], v117 offset:2048
  buffer_load_dwordx4 v125, s[8:11], s69 offen offset:1024  lds
  v_mfma_f32_16x16x32_bf16 v[48:51], a[164:167], a[112:115], v[48:51]
  s_mul_i32 s45, s44, s61
  ds_read_b64_tr_b16 a[54:55], v117 offset:8192
  v_mfma_f32_16x16x32_bf16 v[100:103], a[108:111], a[168:171], v[100:103]
  s_add_u32 s68, s45, s59
  ds_read_b64_tr_b16 a[76:77], v117 offset:14336
  v_mfma_f32_16x16x32_bf16 v[100:103], a[88:91], a[144:147], v[100:103]
  ds_read_b64_tr_b16 a[78:79], v117 offset:20480
  v_mfma_f32_16x16x32_bf16 v[64:67], a[92:95], a[144:147], v[64:67]
  ds_read_b64_tr_b16 a[56:57], v116 offset:4096
  buffer_load_dwordx4 v124, s[8:11], s69 offen offset:2048  lds
  v_mfma_f32_16x16x32_bf16 v[64:67], a[112:115], a[168:171], v[64:67]
  ds_read_b64_tr_b16 a[58:59], v116 offset:10240
  v_mfma_f32_16x16x32_bf16 v[68:71], a[116:119], a[168:171], v[68:71]
  ds_read_b64_tr_b16 a[80:81], v116 offset:16384
  v_mfma_f32_16x16x32_bf16 v[68:71], a[96:99], a[144:147], v[68:71]
  ds_read_b64_tr_b16 a[82:83], v116 offset:22528
  v_mfma_f32_16x16x32_bf16 v[72:75], a[100:103], a[144:147], v[72:75]
  ds_read_b64_tr_b16 a[60:61], v117 offset:4096
  buffer_load_dwordx4 v125, s[8:11], s69 offen offset:3072  lds
  v_mfma_f32_16x16x32_bf16 v[72:75], a[120:123], a[168:171], v[72:75]
  ds_read_b64_tr_b16 a[62:63], v117 offset:10240
  v_mfma_f32_16x16x32_bf16 v[76:79], a[124:127], a[168:171], v[76:79]
  ds_read_b64_tr_b16 a[84:85], v117 offset:16384
  v_mfma_f32_16x16x32_bf16 v[76:79], a[104:107], a[144:147], v[76:79]
  s_add_u32 m0, s63, 53248
  ds_read_b64_tr_b16 a[86:87], v117 offset:22528
  v_mfma_f32_16x16x32_bf16 v[92:95], a[104:107], a[148:151], v[92:95]
  buffer_load_dwordx4 v124, s[8:11], s70 offen offset:0  lds
  v_mfma_f32_16x16x32_bf16 v[92:95], a[124:127], a[172:175], v[92:95]
  v_mfma_f32_16x16x32_bf16 v[88:91], a[120:123], a[172:175], v[88:91]
  v_mfma_f32_16x16x32_bf16 v[88:91], a[100:103], a[148:151], v[88:91]
  v_mfma_f32_16x16x32_bf16 v[84:87], a[96:99], a[148:151], v[84:87]
  buffer_load_dwordx4 v125, s[8:11], s70 offen offset:1024  lds
  v_mfma_f32_16x16x32_bf16 v[84:87], a[116:119], a[172:175], v[84:87]
  v_mfma_f32_16x16x32_bf16 v[80:83], a[112:115], a[172:175], v[80:83]
  v_mfma_f32_16x16x32_bf16 v[80:83], a[92:95], a[148:151], v[80:83]
  s_cmp_eq_u32 s66, s88
  s_cbranch_scc0 Lside_skip5
  s_call_b64 s[78:79], Lside_sub
Lside_skip5:
  s_sub_u32 s56, s56, 1
  s_cmp_lg_u32 s56, 0
  s_cbranch_scc1 Lp1_loop
Lmk_Lp1_loop_tail:
  s_waitcnt lgkmcnt(15)
  v_mfma_f32_16x16x32_bf16 v[0:3], a[40:43], a[4:7], v[0:3]
  s_mul_i32 s45, s44, 393216
  v_and_b32 v240, 1, v253
  v_lshlrev_b32 v240, 7, v240
  v_mfma_f32_16x16x32_bf16 v[0:3], a[64:67], a[24:27], v[0:3]
  s_add_u32 s69, s45, s60
  v_mfma_f32_16x16x32_bf16 v[4:7], a[64:67], a[28:31], v[4:7]
  s_add_u32 s70, s69, 4096
  buffer_load_dword v127, v240, s[36:39], 0 offen sc1
  v_mfma_f32_16x16x32_bf16 v[4:7], a[40:43], a[8:11], v[4:7]
  s_lshl_b32 s43, s57, 2
  v_mfma_f32_16x16x32_bf16 v[8:11], a[40:43], a[12:15], v[8:11]
  s_add_u32 s74, s71, s43
  v_mfma_f32_16x16x32_bf16 v[8:11], a[64:67], a[32:35], v[8:11]
  s_add_u32 s45, s42, 27262976
  v_mfma_f32_16x16x32_bf16 v[12:15], a[64:67], a[36:39], v[12:15]
  s_lshl_b32 s44, s72, 11
  v_mfma_f32_16x16x32_bf16 v[12:15], a[40:43], a[16:19], v[12:15]
  s_add_u32 s77, s44, s45
  v_mfma_f32_16x16x32_bf16 v[28:31], a[44:47], a[16:19], v[28:31]
  s_lshl_b32 s44, s40, 1
  v_mfma_f32_16x16x32_bf16 v[28:31], a[68:71], a[36:39], v[28:31]
  s_add_u32 s44, s44, s71
  v_mfma_f32_16x16x32_bf16 v[24:27], a[68:71], a[32:35], v[24:27]
  s_waitcnt vmcnt(11) lgkmcnt(0)
  s_barrier
  ds_read_b64_tr_b16 a[128:129], v116 offset:24576
  v_mfma_f32_16x16x32_bf16 v[24:27], a[44:47], a[12:15], v[24:27]
  s_add_u32 m0, s62, 73728
  ds_read_b64_tr_b16 a[130:131], v116 offset:30720
  v_mfma_f32_16x16x32_bf16 v[20:23], a[44:47], a[8:11], v[20:23]
  s_lshl_b32 s44, s44, 11
  ds_read_b64_tr_b16 a[152:153], v116 offset:36864
  buffer_load_dwordx4 v120, s[28:31], s68 offen offset:0 sc1  lds
  v_mfma_f32_16x16x32_bf16 v[20:23], a[68:71], a[28:31], v[20:23]
  s_add_u32 s78, s44, s45
  ds_read_b64_tr_b16 a[154:155], v116 offset:43008
  v_mfma_f32_16x16x32_bf16 v[16:19], a[68:71], a[24:27], v[16:19]
  s_lshl_b32 s43, s51, 1
  ds_read_b128 a[92:95], v112 offset:16384
  v_mfma_f32_16x16x32_bf16 v[16:19], a[44:47], a[4:7], v[16:19]
  s_add_u32 s75, s43, s58
  ds_read_b128 a[112:115], v113 offset:16384
  v_mfma_f32_16x16x32_bf16 v[96:99], a[48:51], a[0:3], v[96:99]
  s_lshl_b32 s43, s75, 7
  ds_read_b128 a[96:99], v112 offset:18432
  buffer_load_dwordx4 v121, s[28:31], s68 offen offset:1024 sc1  lds
  v_mfma_f32_16x16x32_bf16 v[96:99], a[72:75], a[20:23], v[96:99]
  s_add_u32 s46, s43, 27983872
  ds_read_b128 a[116:119], v113 offset:18432
  v_mfma_f32_16x16x32_bf16 v[32:35], a[72:75], a[24:27], v[32:35]
  s_lshl_b32 s43, s57, 6
  ds_read_b128 a[100:103], v112 offset:20480
  v_mfma_f32_16x16x32_bf16 v[32:35], a[48:51], a[4:7], v[32:35]
  ds_read_b128 a[120:123], v113 offset:20480
  v_mfma_f32_16x16x32_bf16 v[36:39], a[48:51], a[8:11], v[36:39]
  ds_read_b128 a[104:107], v112 offset:22528
  buffer_load_dwordx4 v122, s[28:31], s68 offen offset:2048 sc1  lds
  v_mfma_f32_16x16x32_bf16 v[36:39], a[72:75], a[28:31], v[36:39]
  ds_read_b128 a[124:127], v113 offset:22528
  v_mfma_f32_16x16x32_bf16 v[40:43], a[72:75], a[32:35], v[40:43]
  ds_read_b64_tr_b16 a[132:133], v117 offset:24576
  v_mfma_f32_16x16x32_bf16 v[40:43], a[48:51], a[12:15], v[40:43]
  ds_read_b64_tr_b16 a[134:135], v117 offset:30720
  v_mfma_f32_16x16x32_bf16 v[44:47], a[48:51], a[16:19], v[44:47]
  ds_read_b64_tr_b16 a[156:157], v117 offset:36864
  buffer_load_dwordx4 v123, s[28:31], s68 offen offset:3072 sc1  lds
  v_mfma_f32_16x16x32_bf16 v[44:47], a[72:75], a[36:39], v[44:47]
  ds_read_b64_tr_b16 a[158:159], v117 offset:43008
  v_mfma_f32_16x16x32_bf16 v[60:63], a[76:79], a[36:39], v[60:63]
  ds_read_b128 a[88:91], v114 offset:1024
  v_mfma_f32_16x16x32_bf16 v[60:63], a[52:55], a[16:19], v[60:63]
  s_add_u32 m0, s63, 0
  ds_read_b128 a[108:111], v115 offset:1024
  v_mfma_f32_16x16x32_bf16 v[56:59], a[52:55], a[12:15], v[56:59]
  ds_read_b64_tr_b16 a[136:137], v116 offset:26624
  buffer_load_dwordx4 v124, s[8:11], s69 offen offset:0  lds
  v_mfma_f32_16x16x32_bf16 v[56:59], a[76:79], a[32:35], v[56:59]
  ds_read_b64_tr_b16 a[138:139], v116 offset:32768
  v_mfma_f32_16x16x32_bf16 v[52:55], a[76:79], a[28:31], v[52:55]
  ds_read_b64_tr_b16 a[160:161], v116 offset:38912
  v_lshlrev_b32 v121, 3, v253
  v_mfma_f32_16x16x32_bf16 v[52:55], a[52:55], a[8:11], v[52:55]
  ds_read_b64_tr_b16 a[162:163], v116 offset:45056
  v_lshlrev_b32 v120, 4, v253
  v_mfma_f32_16x16x32_bf16 v[48:51], a[52:55], a[4:7], v[48:51]
  ds_read_b64_tr_b16 a[140:141], v117 offset:26624
  buffer_load_dwordx4 v125, s[8:11], s69 offen offset:1024  lds
  v_mfma_f32_16x16x32_bf16 v[48:51], a[76:79], a[24:27], v[48:51]
  ds_read_b64_tr_b16 a[142:143], v117 offset:32768
  v_xor_b32 v126, s43, v120
  v_mfma_f32_16x16x32_bf16 v[100:103], a[20:23], a[80:83], v[100:103]
  ds_read_b64_tr_b16 a[164:165], v117 offset:38912
  v_add_u32 v126, s76, v126
  v_mfma_f32_16x16x32_bf16 v[100:103], a[0:3], a[56:59], v[100:103]
  ds_read_b64_tr_b16 a[166:167], v117 offset:45056
  v_bfe_u32 v122, v253, 3, 2
  v_mfma_f32_16x16x32_bf16 v[64:67], a[4:7], a[56:59], v[64:67]
  ds_read_b64_tr_b16 a[144:145], v116 offset:28672
  buffer_load_dwordx4 v124, s[8:11], s69 offen offset:2048  lds
  v_mfma_f32_16x16x32_bf16 v[64:67], a[24:27], a[80:83], v[64:67]
  ds_read_b64_tr_b16 a[146:147], v116 offset:34816
  v_lshrrev_b32 v123, 5, v253
  v_mfma_f32_16x16x32_bf16 v[68:71], a[28:31], a[80:83], v[68:71]
  ds_read_b64_tr_b16 a[168:169], v116 offset:40960
  v_mad_u32_u24 v122, v123, 3, v122
  v_mfma_f32_16x16x32_bf16 v[68:71], a[8:11], a[56:59], v[68:71]
  ds_read_b64_tr_b16 a[170:171], v116 offset:47104
  v_and_b32 v123, 7, v253
  v_mfma_f32_16x16x32_bf16 v[72:75], a[12:15], a[56:59], v[72:75]
  ds_read_b64_tr_b16 a[148:149], v117 offset:28672
  buffer_load_dwordx4 v125, s[8:11], s69 offen offset:3072  lds
  v_mfma_f32_16x16x32_bf16 v[72:75], a[32:35], a[80:83], v[72:75]
  ds_read_b64_tr_b16 a[150:151], v117 offset:34816
  v_lshlrev_b32 v123, 4, v123
  v_mfma_f32_16x16x32_bf16 v[76:79], a[36:39], a[80:83], v[76:79]
  ds_read_b64_tr_b16 a[172:173], v117 offset:40960
  v_lshl_add_u32 v122, v122, 12, v123
  v_mfma_f32_16x16x32_bf16 v[76:79], a[16:19], a[56:59], v[76:79]
  s_add_u32 m0, s63, 4096
  ds_read_b64_tr_b16 a[174:175], v117 offset:47104
  v_mfma_f32_16x16x32_bf16 v[92:95], a[16:19], a[60:63], v[92:95]
  buffer_load_dwordx4 v124, s[8:11], s70 offen offset:0  lds
  v_mfma_f32_16x16x32_bf16 v[92:95], a[36:39], a[84:87], v[92:95]
  v_mfma_f32_16x16x32_bf16 v[88:91], a[32:35], a[84:87], v[88:91]
  v_mfma_f32_16x16x32_bf16 v[88:91], a[12:15], a[60:63], v[88:91]
  s_waitcnt vmcnt(9)
  v_cmp_gt_u32 vcc, 128, v127
  s_cbranch_vccz Lcdn4
  s_mov_b32 s43, 0x40000
Lchk3:
  s_sleep 8
  buffer_load_dword v127, v240, s[36:39], 0 offen sc1
  s_waitcnt vmcnt(0)
  v_cmp_gt_u32 vcc, 128, v127
  s_cbranch_vccz Lcdn4
  s_sub_u32 s43, s43, 1
  s_cmp_lg_u32 s43, 0
  s_cbranch_scc1 Lchk3
Lcdn4:
  v_mfma_f32_16x16x32_bf16 v[84:87], a[8:11], a[60:63], v[84:87]
  buffer_load_dwordx4 v125, s[8:11], s70 offen offset:1024  lds
  v_mfma_f32_16x16x32_bf16 v[84:87], a[28:31], a[84:87], v[84:87]
  v_mfma_f32_16x16x32_bf16 v[80:83], a[24:27], a[84:87], v[80:83]
  v_mfma_f32_16x16x32_bf16 v[80:83], a[4:7], a[60:63], v[80:83]
  s_waitcnt lgkmcnt(15)
  v_mfma_f32_16x16x32_bf16 v[0:3], a[128:131], a[92:95], v[0:3]
  s_cmp_lg_u32 s41, 0
  s_cbranch_scc1 Lp1_csl0
  buffer_load_dwordx4 v[200:203], v122, s[4:7], s46 offen sc1
  s_add_u32 s46, s46, 24576
  buffer_load_dwordx4 v[204:207], v122, s[4:7], s46 offen sc1
  s_add_u32 s46, s46, 24576
Lp1_csl0:
  v_mfma_f32_16x16x32_bf16 v[0:3], a[152:155], a[112:115], v[0:3]
  s_lshl_b32 s88, s53, 7
  s_lshl_b32 s92, s40, 14
  s_add_u32 s88, s88, s92
  v_mfma_f32_16x16x32_bf16 v[4:7], a[152:155], a[116:119], v[4:7]
  s_lshl_b32 s89, s40, 10
  s_and_b32 s92, s52, 3
  v_mfma_f32_16x16x32_bf16 v[4:7], a[128:131], a[96:99], v[4:7]
  s_lshl_b32 s91, s92, 19
  buffer_load_dwordx2 v[128:129], v121, s[4:7], s78 offen offset:0 sc1
  v_add_u32 v186, s88, v252
  v_mfma_f32_16x16x32_bf16 v[8:11], a[128:131], a[100:103], v[8:11]
  s_mul_i32 s92, s92, 0
  s_lshr_b32 s93, s2, 5
  s_add_u32 s92, s92, s93
  v_mfma_f32_16x16x32_bf16 v[8:11], a[152:155], a[120:123], v[8:11]
  s_cmp_ge_u32 s92, 8
  s_cselect_b32 s93, 8, 0
  s_sub_u32 s92, s92, s93
  s_cmp_ge_u32 s92, 8
  s_cselect_b32 s93, 8, 0
  s_sub_u32 s92, s92, s93
  s_lshl_b32 s93, 1, s92
  v_mfma_f32_16x16x32_bf16 v[12:15], a[152:155], a[124:127], v[12:15]
  s_cmp_lg_u32 s41, 0
  s_cbranch_scc1 Lp1_csl1
  buffer_load_dwordx4 v[208:211], v122, s[4:7], s46 offen sc1
  s_add_u32 s46, s46, 24576
  buffer_load_dwordx4 v[212:215], v122, s[4:7], s46 offen sc1
  s_add_u32 s46, s46, 24576
Lp1_csl1:
  s_lshr_b32 s92, s93, 8
  s_or_b32 s93, s93, s92
  v_mfma_f32_16x16x32_bf16 v[12:15], a[128:131], a[104:107], v[12:15]
  s_add_u32 s92, s91, 524288
  buffer_load_dwordx2 v[130:131], v121, s[4:7], s78 offen offset:512 sc1
  s_bitcmp1_b32 s93, 0
  s_cselect_b32 s80, s92, s91
  v_mfma_f32_16x16x32_bf16 v[28:31], a[132:135], a[104:107], v[28:31]
  s_bitcmp1_b32 s93, 1
  s_cselect_b32 s81, s92, s91
  s_bitcmp1_b32 s93, 2
  s_cselect_b32 s82, s92, s91
  s_bitcmp1_b32 s93, 3
  s_cselect_b32 s83, s92, s91
  v_mfma_f32_16x16x32_bf16 v[28:31], a[156:159], a[124:127], v[28:31]
  s_bitcmp1_b32 s93, 4
  s_cselect_b32 s84, s92, s91
  s_bitcmp1_b32 s93, 5
  s_cselect_b32 s85, s92, s91
  s_bitcmp1_b32 s93, 6
  s_cselect_b32 s86, s92, s91
  v_mfma_f32_16x16x32_bf16 v[24:27], a[156:159], a[120:123], v[24:27]
  s_waitcnt lgkmcnt(0)
  s_barrier
  ds_read_b64_tr_b16 a[40:41], v118 offset:0
  v_mfma_f32_16x16x32_bf16 v[24:27], a[132:135], a[100:103], v[24:27]
  s_bitcmp1_b32 s93, 7
  s_cselect_b32 s87, s92, s91
  ds_read_b64_tr_b16 a[42:43], v118 offset:6144
  buffer_load_dwordx2 v[132:133], v121, s[4:7], s78 offen offset:1024 sc1
  v_mfma_f32_16x16x32_bf16 v[20:23], a[132:135], a[96:99], v[20:23]
  s_cmp_lg_u32 s41, 0
  s_cbranch_scc1 Lp1_csl2
  buffer_load_dwordx4 v[216:219], v122, s[4:7], s46 offen sc1
  s_add_u32 s46, s46, 24576
  buffer_load_dwordx4 v[220:223], v122, s[4:7], s46 offen sc1
  s_add_u32 s46, s46, 24576
Lp1_csl2:
  ds_read_b64_tr_b16 a[64:65], v118 offset:12288
  v_mfma_f32_16x16x32_bf16 v[20:23], a[156:159], a[116:119], v[20:23]
  ds_read_b64_tr_b16 a[66:67], v118 offset:18432
  v_mfma_f32_16x16x32_bf16 v[16:19], a[156:159], a[112:115], v[16:19]
  ds_read_b128 a[4:7], v112 offset:32768
  v_mfma_f32_16x16x32_bf16 v[16:19], a[132:135], a[92:95], v[16:19]
  ds_read_b128 a[24:27], v113 offset:32768
  buffer_load_dwordx2 v[134:135], v121, s[4:7], s78 offen offset:1536 sc1
  v_mfma_f32_16x16x32_bf16 v[96:99], a[136:139], a[88:91], v[96:99]
  ds_read_b128 a[8:11], v112 offset:34816
  v_mfma_f32_16x16x32_bf16 v[96:99], a[160:163], a[108:111], v[96:99]
  ds_read_b128 a[28:31], v113 offset:34816
  v_mfma_f32_16x16x32_bf16 v[32:35], a[160:163], a[112:115], v[32:35]
  s_cmp_lg_u32 s41, 0
  s_cbranch_scc1 Lp1_csl3
  buffer_load_dwordx4 v[224:227], v122, s[4:7], s46 offen sc1
  s_add_u32 s46, s46, 24576
  buffer_load_dwordx4 v[228:231], v122, s[4:7], s46 offen sc1
  s_add_u32 s46, s46, 24576
Lp1_csl3:
  ds_read_b128 a[12:15], v112 offset:36864
  v_mfma_f32_16x16x32_bf16 v[32:35], a[136:139], a[92:95], v[32:35]
  ds_read_b128 a[32:35], v113 offset:36864
  buffer_load_dwordx2 v[136:137], v121, s[4:7], s78 offen offset:2048 sc1
  v_mfma_f32_16x16x32_bf16 v[36:39], a[136:139], a[96:99], v[36:39]
  ds_read_b128 a[16:19], v112 offset:38912
  v_mfma_f32_16x16x32_bf16 v[36:39], a[160:163], a[116:119], v[36:39]
  ds_read_b128 a[36:39], v113 offset:38912
  v_mfma_f32_16x16x32_bf16 v[40:43], a[160:163], a[120:123], v[40:43]
  ds_read_b64_tr_b16 a[44:45], v119 offset:0
  v_mfma_f32_16x16x32_bf16 v[40:43], a[136:139], a[100:103], v[40:43]
  ds_read_b64_tr_b16 a[46:47], v119 offset:6144
  buffer_load_dwordx2 v[138:139], v121, s[4:7], s78 offen offset:2560 sc1
  v_mfma_f32_16x16x32_bf16 v[44:47], a[136:139], a[104:107], v[44:47]
  ds_read_b64_tr_b16 a[68:69], v119 offset:12288
  v_lshrrev_b32 v240, 4, v253
  v_mfma_f32_16x16x32_bf16 v[44:47], a[160:163], a[124:127], v[44:47]
  ds_read_b64_tr_b16 a[70:71], v119 offset:18432
  v_lshlrev_b32 v124, 4, v240
  v_mfma_f32_16x16x32_bf16 v[60:63], a[164:167], a[124:127], v[60:63]
  ds_read_b128 a[0:3], v114 offset:2048
  v_and_b32 v125, 15, v253
  v_mfma_f32_16x16x32_bf16 v[60:63], a[140:143], a[104:107], v[60:63]
  ds_read_b128 a[20:23], v115 offset:2048
  buffer_load_dwordx2 v[140:141], v121, s[4:7], s78 offen offset:3072 sc1
  v_mfma_f32_16x16x32_bf16 v[56:59], a[140:143], a[100:103], v[56:59]
  ds_read_b64_tr_b16 a[48:49], v118 offset:2048
  v_lshlrev_b32 v125, 2, v125
  v_mfma_f32_16x16x32_bf16 v[56:59], a[164:167], a[120:123], v[56:59]
  s_lshl_b32 s43, s57, 9
  ds_read_b64_tr_b16 a[50:51], v118 offset:8192
  v_add_u32 v164, 155648, v124
  v_mfma_f32_16x16x32_bf16 v[52:55], a[164:167], a[116:119], v[52:55]
  ds_read_b64_tr_b16 a[72:73], v118 offset:14336
  v_add_u32 v166, 155648, v125
  v_mfma_f32_16x16x32_bf16 v[52:55], a[140:143], a[96:99], v[52:55]
  ds_read_b64_tr_b16 a[74:75], v118 offset:20480
  buffer_load_dwordx2 v[142:143], v121, s[4:7], s78 offen offset:3584 sc1
  v_mfma_f32_16x16x32_bf16 v[48:51], a[140:143], a[92:95], v[48:51]
  ds_read_b64_tr_b16 a[52:53], v119 offset:2048
  v_add_u32 v165, s43, v164
  v_mfma_f32_16x16x32_bf16 v[48:51], a[164:167], a[112:115], v[48:51]
  ds_read_b64_tr_b16 a[54:55], v119 offset:8192
  v_add_u32 v167, s43, v166
  v_mfma_f32_16x16x32_bf16 v[100:103], a[108:111], a[168:171], v[100:103]
  s_lshl_b32 s43, s40, 1
  ds_read_b64_tr_b16 a[76:77], v119 offset:14336
  v_mfma_f32_16x16x32_bf16 v[100:103], a[88:91], a[144:147], v[100:103]
  s_add_u32 s43, s43, 1
  ds_read_b64_tr_b16 a[78:79], v119 offset:20480
  buffer_load_dwordx2 v[144:145], v121, s[4:7], s77 offen offset:0 sc1
  v_mfma_f32_16x16x32_bf16 v[64:67], a[92:95], a[144:147], v[64:67]
  ds_read_b64_tr_b16 a[56:57], v118 offset:4096
  v_add_u32 v241, s43, v240
  v_mfma_f32_16x16x32_bf16 v[64:67], a[112:115], a[168:171], v[64:67]
  ds_read_b64_tr_b16 a[58:59], v118 offset:10240
  v_cmp_gt_u32 vcc, 2, v240
  v_mfma_f32_16x16x32_bf16 v[68:71], a[116:119], a[168:171], v[68:71]
  ds_read_b64_tr_b16 a[80:81], v118 offset:16384
  v_and_b32 v240, 1, v240
  v_mfma_f32_16x16x32_bf16 v[68:71], a[96:99], a[144:147], v[68:71]
  ds_read_b64_tr_b16 a[82:83], v118 offset:22528
  buffer_load_dwordx2 v[146:147], v121, s[4:7], s77 offen offset:512 sc1
  v_mfma_f32_16x16x32_bf16 v[72:75], a[100:103], a[144:147], v[72:75]
  ds_read_b64_tr_b16 a[60:61], v119 offset:4096
  v_mul_u32_u24 v240, 9, v240
  v_mfma_f32_16x16x32_bf16 v[72:75], a[120:123], a[168:171], v[72:75]
  ds_read_b64_tr_b16 a[62:63], v119 offset:10240
  v_cndmask_b32 v240, v240, v241, vcc
  v_mfma_f32_16x16x32_bf16 v[76:79], a[124:127], a[168:171], v[76:79]
  ds_read_b64_tr_b16 a[84:85], v119 offset:16384
  v_lshl_add_u32 v122, v240, 7, v166
  v_mfma_f32_16x16x32_bf16 v[76:79], a[104:107], a[144:147], v[76:79]
  ds_read_b64_tr_b16 a[86:87], v119 offset:22528
  buffer_load_dwordx2 v[148:149], v121, s[4:7], s77 offen offset:1024 sc1
  v_mfma_f32_16x16x32_bf16 v[92:95], a[104:107], a[148:151], v[92:95]
  v_add_u32 v124, s76, v124
  v_add_u32 v125, s76, v125
  v_mfma_f32_16x16x32_bf16 v[92:95], a[124:127], a[172:175], v[92:95]
  v_add_u32 v123, 149504, v120
  v_mfma_f32_16x16x32_bf16 v[88:91], a[120:123], a[172:175], v[88:91]
  v_mfma_f32_16x16x32_bf16 v[88:91], a[100:103], a[148:151], v[88:91]
  buffer_load_dwordx2 v[150:151], v121, s[4:7], s77 offen offset:1536 sc1
  v_mfma_f32_16x16x32_bf16 v[84:87], a[96:99], a[148:151], v[84:87]
  v_mfma_f32_16x16x32_bf16 v[84:87], a[116:119], a[172:175], v[84:87]
  v_mfma_f32_16x16x32_bf16 v[80:83], a[112:115], a[172:175], v[80:83]
  v_mfma_f32_16x16x32_bf16 v[80:83], a[92:95], a[148:151], v[80:83]
  s_waitcnt lgkmcnt(15)
  v_mfma_f32_16x16x32_bf16 v[0:3], a[40:43], a[4:7], v[0:3]
  s_lshl_b32 s44, s2, 2
  s_add_u32 s44, s44, s40
  s_lshl_b32 s44, s44, 12
  v_mfma_f32_16x16x32_bf16 v[0:3], a[64:67], a[24:27], v[0:3]
  s_add_u32 s44, s44, s42
  v_mfma_f32_16x16x32_bf16 v[4:7], a[64:67], a[28:31], v[4:7]
  s_add_u32 s44, s44, 28311552
  v_mov_b32 v244, -1
  v_mov_b32 v245, -1
  v_mfma_f32_16x16x32_bf16 v[4:7], a[40:43], a[8:11], v[4:7]
  v_mov_b32 v246, -1
  v_mov_b32 v247, -1
  v_mfma_f32_16x16x32_bf16 v[8:11], a[40:43], a[12:15], v[8:11]
  v_mfma_f32_16x16x32_bf16 v[8:11], a[64:67], a[32:35], v[8:11]
  v_mfma_f32_16x16x32_bf16 v[12:15], a[64:67], a[36:39], v[12:15]
  s_waitcnt vmcnt(8)
  v_add_u32 v198, 1024, v125
  v_add_f32 v128, v128, v130
  v_mfma_f32_16x16x32_bf16 v[12:15], a[40:43], a[16:19], v[12:15]
  v_add_f32 v129, v129, v131
  v_add_f32 v132, v132, v134
  v_mfma_f32_16x16x32_bf16 v[28:31], a[44:47], a[16:19], v[28:31]
  buffer_store_dwordx4 v[244:247], v120, s[4:7], s44 offen offset:0 sc1
  v_add_f32 v133, v133, v135
  v_mfma_f32_16x16x32_bf16 v[28:31], a[68:71], a[36:39], v[28:31]
  v_add_f32 v128, v128, v132
  v_add_f32 v129, v129, v133
  v_mfma_f32_16x16x32_bf16 v[24:27], a[68:71], a[32:35], v[24:27]
  s_waitcnt lgkmcnt(0)
  s_barrier
  ds_read_b64_tr_b16 a[128:129], v116 offset:0
  s_waitcnt vmcnt(5)
  s_cmp_lg_u32 s41, 0
  s_cbranch_scc1 Lp1_css
  v_pk_add_f32 v[200:201], v[200:201], v[216:217]
  v_pk_add_f32 v[202:203], v[202:203], v[218:219]
  v_pk_add_f32 v[204:205], v[204:205], v[220:221]
  v_pk_add_f32 v[206:207], v[206:207], v[222:223]
  v_pk_add_f32 v[208:209], v[208:209], v[224:225]
  v_pk_add_f32 v[210:211], v[210:211], v[226:227]
  v_pk_add_f32 v[212:213], v[212:213], v[228:229]
  v_pk_add_f32 v[214:215], v[214:215], v[230:231]
  v_pk_add_f32 v[200:201], v[200:201], v[208:209]
  v_pk_add_f32 v[202:203], v[202:203], v[210:211]
  v_pk_add_f32 v[204:205], v[204:205], v[212:213]
  v_pk_add_f32 v[206:207], v[206:207], v[214:215]
  v_pk_add_f32 v[200:201], v[200:201], v[204:205]
  v_pk_add_f32 v[202:203], v[202:203], v[206:207]
  v_mov_b32 v204, v200
  v_mov_b32 v205, v201
  v_mov_b32 v206, v202
  v_mov_b32 v207, v203
  v_permlane32_swap_b32 v200, v204
  v_permlane32_swap_b32 v201, v205
  v_permlane32_swap_b32 v202, v206
  v_permlane32_swap_b32 v203, v207
  v_add_f32 v200, v200, v204
  v_add_f32 v201, v201, v205
  v_add_f32 v202, v202, v206
  v_add_f32 v203, v203, v207
  ds_write_b128 v126, v[200:203] offset:1024
Lp1_css:
  v_mfma_f32_16x16x32_bf16 v[24:27], a[44:47], a[12:15], v[24:27]
  ds_read_b64_tr_b16 a[130:131], v116 offset:6144
  ds_read_b128 v[168:171], v124 offset:1024
  v_mfma_f32_16x16x32_bf16 v[20:23], a[44:47], a[8:11], v[20:23]
  ds_read_b64_tr_b16 a[152:153], v116 offset:12288
  buffer_store_dwordx4 v[244:247], v120, s[4:7], s44 offen offset:1024 sc1
  v_mfma_f32_16x16x32_bf16 v[20:23], a[68:71], a[28:31], v[20:23]
  ds_read_b64_tr_b16 a[154:155], v116 offset:18432
  ds_read_b128 v[172:175], v124 offset:1088
  v_mfma_f32_16x16x32_bf16 v[16:19], a[68:71], a[24:27], v[16:19]
  ds_read_b128 a[92:95], v112 offset:0
  ds_read_b128 v[176:179], v124 offset:1152
  v_mfma_f32_16x16x32_bf16 v[16:19], a[44:47], a[4:7], v[16:19]
  ds_read_b128 a[112:115], v113 offset:0
  ds_read_b128 v[180:183], v124 offset:1216
  v_mfma_f32_16x16x32_bf16 v[96:99], a[48:51], a[0:3], v[96:99]
  ds_read_b128 a[96:99], v112 offset:2048
  buffer_store_dwordx4 v[244:247], v120, s[4:7], s44 offen offset:2048 sc1
  v_mfma_f32_16x16x32_bf16 v[96:99], a[72:75], a[20:23], v[96:99]
  ds_read_b128 a[116:119], v113 offset:2048
  ds_read2_b32 v[184:185], v198 offset0:64 offset1:80
  v_mfma_f32_16x16x32_bf16 v[32:35], a[72:75], a[24:27], v[32:35]
  s_xor_b32 s47, s40, 2
  ds_read_b128 a[100:103], v112 offset:4096
  s_mul_i32 s47, s47, 6144
  v_mfma_f32_16x16x32_bf16 v[32:35], a[48:51], a[4:7], v[32:35]
  s_add_u32 s47, s47, 139264
  ds_read_b128 a[120:123], v113 offset:4096
  s_add_u32 s49, s47, 3072
  v_mfma_f32_16x16x32_bf16 v[36:39], a[48:51], a[8:11], v[36:39]
  s_add_u32 s79, s47, 2048
  ds_read_b128 a[104:107], v112 offset:6144
  buffer_store_dwordx4 v[244:247], v120, s[4:7], s44 offen offset:3072 sc1
  v_mfma_f32_16x16x32_bf16 v[36:39], a[72:75], a[28:31], v[36:39]
  s_cmp_eq_u32 s57, 0
  s_cselect_b32 s49, s76, s49
  s_cselect_b32 s79, s47, s79
  ds_read_b128 a[124:127], v113 offset:6144
  v_add_u32 v198, s49, v121
  v_mfma_f32_16x16x32_bf16 v[40:43], a[72:75], a[32:35], v[40:43]
  ds_read_b64_tr_b16 a[132:133], v117 offset:0
  v_add_u32 v199, s79, v121
  v_mfma_f32_16x16x32_bf16 v[40:43], a[48:51], a[12:15], v[40:43]
  ds_read_b64_tr_b16 a[134:135], v117 offset:6144
  v_add_u32 v121, s76, v121
  v_mfma_f32_16x16x32_bf16 v[44:47], a[48:51], a[16:19], v[44:47]
  ds_read_b64_tr_b16 a[156:157], v117 offset:12288
  buffer_load_dwordx4 a[240:243], v187, s[28:31], s64 offen sc1
  v_mfma_f32_16x16x32_bf16 v[44:47], a[72:75], a[36:39], v[44:47]
  s_add_u32 s64, s64, s65
  ds_read_b64_tr_b16 a[158:159], v117 offset:18432
  v_add_f32 v136, v136, v138
  v_mfma_f32_16x16x32_bf16 v[60:63], a[76:79], a[36:39], v[60:63]
  ds_read_b128 a[88:91], v114 offset:3072
  v_add_f32 v137, v137, v139
  v_mfma_f32_16x16x32_bf16 v[60:63], a[52:55], a[16:19], v[60:63]
  ds_read_b128 a[108:111], v115 offset:3072
  v_add_f32 v140, v140, v142
  v_mfma_f32_16x16x32_bf16 v[56:59], a[52:55], a[12:15], v[56:59]
  ds_read_b64_tr_b16 a[136:137], v116 offset:2048
  v_add_f32 v141, v141, v143
  v_mfma_f32_16x16x32_bf16 v[56:59], a[76:79], a[32:35], v[56:59]
  ds_read_b64_tr_b16 a[138:139], v116 offset:8192
  v_add_f32 v136, v136, v140
  v_mfma_f32_16x16x32_bf16 v[52:55], a[76:79], a[28:31], v[52:55]
  ds_read_b64_tr_b16 a[160:161], v116 offset:14336
  v_add_f32 v137, v137, v141
  v_mfma_f32_16x16x32_bf16 v[52:55], a[52:55], a[8:11], v[52:55]
  s_waitcnt vmcnt(5)
  ds_read_b64_tr_b16 a[162:163], v116 offset:20480
  v_add_f32 v144, v144, v146
  v_mfma_f32_16x16x32_bf16 v[48:51], a[52:55], a[4:7], v[48:51]
  ds_read_b64_tr_b16 a[140:141], v117 offset:2048
  buffer_load_dwordx4 a[244:247], v187, s[28:31], s64 offen sc1
  v_mfma_f32_16x16x32_bf16 v[48:51], a[76:79], a[24:27], v[48:51]
  s_lshr_b32 s45, 0x10000, s41
  s_sub_u32 s45, s45, s65
  s_add_u32 s64, s64, s45
  ds_read_b64_tr_b16 a[142:143], v117 offset:8192
  v_add_f32 v145, v145, v147
  v_mfma_f32_16x16x32_bf16 v[100:103], a[20:23], a[80:83], v[100:103]
  ds_read_b64_tr_b16 a[164:165], v117 offset:14336
  v_add_f32 v148, v148, v150
  v_mfma_f32_16x16x32_bf16 v[100:103], a[0:3], a[56:59], v[100:103]
  ds_read_b64_tr_b16 a[166:167], v117 offset:20480
  v_add_f32 v149, v149, v151
  v_mfma_f32_16x16x32_bf16 v[64:67], a[4:7], a[56:59], v[64:67]
  ds_read_b64_tr_b16 a[144:145], v116 offset:4096
  v_add_f32 v144, v144, v148
  v_mfma_f32_16x16x32_bf16 v[64:67], a[24:27], a[80:83], v[64:67]
  ds_read_b64_tr_b16 a[146:147], v116 offset:10240
  v_add_f32 v145, v145, v149
  v_mfma_f32_16x16x32_bf16 v[68:71], a[28:31], a[80:83], v[68:71]
  s_mov_b32 s48, 0x3a800000
  ds_read_b64_tr_b16 a[168:169], v116 offset:16384
  v_mov_b32 v240, 0x3727c5ac
  v_mfma_f32_16x16x32_bf16 v[68:71], a[8:11], a[56:59], v[68:71]
  ds_read_b64_tr_b16 a[170:171], v116 offset:22528
  v_permlane32_swap_b32 v136, v130
  v_mfma_f32_16x16x32_bf16 v[72:75], a[12:15], a[56:59], v[72:75]
  ds_read_b64_tr_b16 a[148:149], v117 offset:4096
  buffer_load_dwordx4 a[248:251], v187, s[28:31], s64 offen sc1
  v_mfma_f32_16x16x32_bf16 v[72:75], a[32:35], a[80:83], v[72:75]
  s_add_u32 s64, s64, s65
  ds_read_b64_tr_b16 a[150:151], v117 offset:10240
  v_permlane32_swap_b32 v137, v131
  v_mfma_f32_16x16x32_bf16 v[76:79], a[36:39], a[80:83], v[76:79]
  ds_read_b64_tr_b16 a[172:173], v117 offset:16384
  v_permlane32_swap_b32 v128, v144
  v_mfma_f32_16x16x32_bf16 v[76:79], a[16:19], a[56:59], v[76:79]
  ds_read_b64_tr_b16 a[174:175], v117 offset:22528
  v_permlane32_swap_b32 v129, v145
  v_mfma_f32_16x16x32_bf16 v[92:95], a[16:19], a[60:63], v[92:95]
  v_add_f32 v136, v136, v130
  v_add_f32 v128, v128, v144
  v_mfma_f32_16x16x32_bf16 v[92:95], a[36:39], a[84:87], v[92:95]
  v_add_f32 v137, v137, v131
  v_add_f32 v129, v129, v145
  v_mfma_f32_16x16x32_bf16 v[88:91], a[32:35], a[84:87], v[88:91]
  v_permlane16_swap_b32 v128, v136
  v_mfma_f32_16x16x32_bf16 v[88:91], a[12:15], a[60:63], v[88:91]
  s_nop 0
  v_permlane16_swap_b32 v129, v137
  v_add_f32 v128, v128, v136
  v_mfma_f32_16x16x32_bf16 v[84:87], a[8:11], a[60:63], v[84:87]
  buffer_load_dwordx4 a[252:255], v187, s[28:31], s64 offen sc1
  v_add_f32 v129, v129, v137
  v_mfma_f32_16x16x32_bf16 v[84:87], a[28:31], a[84:87], v[84:87]
  s_add_u32 s64, s64, s65
  v_mul_f32 v128, 0xba800000, v128
  v_fma_f32 v129, v129, s48, v240
  v_mfma_f32_16x16x32_bf16 v[80:83], a[24:27], a[84:87], v[80:83]
  v_fma_f32 v129, -v128, v128, v129
  v_max_f32 v129, v129, v240
  v_mfma_f32_16x16x32_bf16 v[80:83], a[4:7], a[60:63], v[80:83]
  v_rsq_f32 v129, v129
  s_nop 0
  s_waitcnt lgkmcnt(15)
  v_mfma_f32_16x16x32_bf16 v[0:3], a[128:131], a[92:95], v[0:3]
  s_add_u32 m0, s89, 40960
  ds_write2_b32 v122, v128, v129 offset0:0 offset1:16
  v_mfma_f32_16x16x32_bf16 v[0:3], a[152:155], a[112:115], v[0:3]
  s_add_u32 s92, s82, 655360
  v_mfma_f32_16x16x32_bf16 v[4:7], a[152:155], a[116:119], v[4:7]
  s_and_b32 s92, s92, 0x1fffff
  v_mfma_f32_16x16x32_bf16 v[4:7], a[128:131], a[96:99], v[4:7]
  buffer_load_dwordx4 v186, s[12:15], s92 offen lds
  v_mfma_f32_16x16x32_bf16 v[8:11], a[128:131], a[100:103], v[8:11]
  v_mfma_f32_16x16x32_bf16 v[8:11], a[152:155], a[120:123], v[8:11]
  v_mfma_f32_16x16x32_bf16 v[12:15], a[152:155], a[124:127], v[12:15]
  s_add_u32 m0, s89, 45056
  v_mfma_f32_16x16x32_bf16 v[12:15], a[128:131], a[104:107], v[12:15]
  s_add_u32 s92, s83, 720896
  v_mfma_f32_16x16x32_bf16 v[28:31], a[132:135], a[104:107], v[28:31]
  s_and_b32 s92, s92, 0x1fffff
  v_mfma_f32_16x16x32_bf16 v[28:31], a[156:159], a[124:127], v[28:31]
  buffer_load_dwordx4 v186, s[12:15], s92 offen lds
  v_mfma_f32_16x16x32_bf16 v[24:27], a[156:159], a[120:123], v[24:27]
  s_waitcnt lgkmcnt(0)
  s_barrier
  ds_read2_b32 v[190:191], v167 offset0:32 offset1:48
  ds_read2_b32 v[192:193], v167 offset0:64 offset1:80
  v_mfma_f32_16x16x32_bf16 v[24:27], a[132:135], a[100:103], v[24:27]
  ds_read2_b32 v[194:195], v167 offset0:96 offset1:112
  ds_read2_b32 v[196:197], v167 offset0:128 offset1:144
  v_mfma_f32_16x16x32_bf16 v[20:23], a[132:135], a[96:99], v[20:23]
  s_add_u32 m0, s89, 49152
  ds_read2_b32 v[188:189], v166 offset0:0 offset1:16
  ds_read_b128 v[128:131], v123
  v_mfma_f32_16x16x32_bf16 v[20:23], a[156:159], a[116:119], v[20:23]
  s_add_u32 s92, s84, 786432
  ds_read_b128 v[132:135], v123 offset:1024
  ds_read_b128 v[200:203], v164 offset:0
  v_mfma_f32_16x16x32_bf16 v[16:19], a[156:159], a[112:115], v[16:19]
  s_and_b32 s92, s92, 0x1fffff
  ds_read_b128 v[220:223], v164 offset:64
  ds_read_b128 v[216:219], v165 offset:512
  v_mfma_f32_16x16x32_bf16 v[16:19], a[132:135], a[92:95], v[16:19]
  buffer_load_dwordx4 v186, s[12:15], s92 offen lds
  ds_read_b128 v[236:239], v165 offset:576
  v_mfma_f32_16x16x32_bf16 v[96:99], a[136:139], a[88:91], v[96:99]
  ds_read_b128 v[204:207], v165 offset:128
  ds_read_b128 v[224:227], v165 offset:192
  v_mfma_f32_16x16x32_bf16 v[96:99], a[160:163], a[108:111], v[96:99]
  ds_read_b128 v[208:211], v165 offset:256
  ds_read_b128 v[228:231], v165 offset:320
  v_mfma_f32_16x16x32_bf16 v[32:35], a[160:163], a[112:115], v[32:35]
  s_add_u32 m0, s89, 53248
  ds_read_b128 v[212:215], v165 offset:384
  ds_read_b128 v[232:235], v165 offset:448
  v_mfma_f32_16x16x32_bf16 v[32:35], a[136:139], a[92:95], v[32:35]
  s_add_u32 s92, s85, 851968
  s_and_b32 s43, s50, 7
  s_or_b32 s43, s43, s57
  v_mfma_f32_16x16x32_bf16 v[36:39], a[136:139], a[96:99], v[36:39]
  s_cselect_b64 s[46:47], -1, 0
  s_and_b32 s92, s92, 0x1fffff
  v_mov_b32 v245, 0xf149f2ca
  v_mfma_f32_16x16x32_bf16 v[36:39], a[160:163], a[116:119], v[36:39]
  s_waitcnt lgkmcnt(10)
  buffer_load_dwordx4 v186, s[12:15], s92 offen lds
  v_fmac_f32 v12, v168, v196
  v_mfma_f32_16x16x32_bf16 v[40:43], a[160:163], a[120:123], v[40:43]
  v_fmac_f32 v13, v169, v196
  v_fmac_f32 v14, v170, v196
  v_mfma_f32_16x16x32_bf16 v[40:43], a[136:139], a[100:103], v[40:43]
  v_fmac_f32 v15, v171, v196
  v_fmac_f32 v28, v172, v196
  v_mfma_f32_16x16x32_bf16 v[44:47], a[136:139], a[104:107], v[44:47]
  s_add_u32 m0, s89, 57344
  v_fmac_f32 v29, v173, v196
  v_fmac_f32 v30, v174, v196
  v_mfma_f32_16x16x32_bf16 v[44:47], a[160:163], a[124:127], v[44:47]
  s_add_u32 s92, s86, 917504
  v_fmac_f32 v31, v175, v196
  v_cvt_pk_bf16_f32 v12, v12, v13
  v_mfma_f32_16x16x32_bf16 v[60:63], a[164:167], a[124:127], v[60:63]
  s_and_b32 s92, s92, 0x1fffff
  v_cvt_pk_bf16_f32 v13, v14, v15
  v_cvt_pk_bf16_f32 v14, v28, v29
  v_mfma_f32_16x16x32_bf16 v[60:63], a[140:143], a[104:107], v[60:63]
  buffer_load_dwordx4 v186, s[12:15], s92 offen lds
  v_cvt_pk_bf16_f32 v15, v30, v31
  v_mfma_f32_16x16x32_bf16 v[56:59], a[140:143], a[100:103], v[56:59]
  v_fmac_f32 v8, v168, v194
  v_fmac_f32 v9, v169, v194
  v_mfma_f32_16x16x32_bf16 v[56:59], a[164:167], a[120:123], v[56:59]
  v_fmac_f32 v10, v170, v194
  v_fmac_f32 v11, v171, v194
  v_mfma_f32_16x16x32_bf16 v[52:55], a[164:167], a[116:119], v[52:55]
  s_add_u32 m0, s89, 61440
  v_fmac_f32 v24, v172, v194
  v_fmac_f32 v25, v173, v194
  v_mfma_f32_16x16x32_bf16 v[52:55], a[140:143], a[96:99], v[52:55]
  s_add_u32 s92, s87, 983040
  v_fmac_f32 v26, v174, v194
  v_fmac_f32 v27, v175, v194
  v_mfma_f32_16x16x32_bf16 v[48:51], a[140:143], a[92:95], v[48:51]
  s_and_b32 s92, s92, 0x1fffff
  v_cvt_pk_bf16_f32 v8, v8, v9
  v_cvt_pk_bf16_f32 v9, v10, v11
  v_mfma_f32_16x16x32_bf16 v[48:51], a[164:167], a[112:115], v[48:51]
  buffer_load_dwordx4 v186, s[12:15], s92 offen lds
  v_cvt_pk_bf16_f32 v10, v24, v25
  v_mfma_f32_16x16x32_bf16 v[100:103], a[108:111], a[168:171], v[100:103]
  v_cvt_pk_bf16_f32 v11, v26, v27
  v_fmac_f32 v4, v168, v192
  v_mfma_f32_16x16x32_bf16 v[100:103], a[88:91], a[144:147], v[100:103]
  v_fmac_f32 v5, v169, v192
  v_fmac_f32 v6, v170, v192
  v_mfma_f32_16x16x32_bf16 v[64:67], a[92:95], a[144:147], v[64:67]
  s_add_u32 m0, s89, 65536
  v_fmac_f32 v7, v171, v192
  v_fmac_f32 v20, v172, v192
  v_mfma_f32_16x16x32_bf16 v[64:67], a[112:115], a[168:171], v[64:67]
  s_add_u32 s92, s80, 1048576
  v_fmac_f32 v21, v173, v192
  v_fmac_f32 v22, v174, v192
  v_mfma_f32_16x16x32_bf16 v[68:71], a[116:119], a[168:171], v[68:71]
  s_and_b32 s92, s92, 0x1fffff
  v_fmac_f32 v23, v175, v192
  v_cvt_pk_bf16_f32 v4, v4, v5
  v_mfma_f32_16x16x32_bf16 v[68:71], a[96:99], a[144:147], v[68:71]
  buffer_load_dwordx4 v186, s[12:15], s92 offen lds
  v_cvt_pk_bf16_f32 v5, v6, v7
  v_mfma_f32_16x16x32_bf16 v[72:75], a[100:103], a[144:147], v[72:75]
  v_cvt_pk_bf16_f32 v6, v20, v21
  v_cvt_pk_bf16_f32 v7, v22, v23
  v_mfma_f32_16x16x32_bf16 v[72:75], a[120:123], a[168:171], v[72:75]
  v_fmac_f32 v0, v168, v190
  v_fmac_f32 v1, v169, v190
  v_mfma_f32_16x16x32_bf16 v[76:79], a[124:127], a[168:171], v[76:79]
  s_add_u32 m0, s89, 69632
  v_fmac_f32 v2, v170, v190
  v_fmac_f32 v3, v171, v190
  v_mfma_f32_16x16x32_bf16 v[76:79], a[104:107], a[144:147], v[76:79]
  s_add_u32 s92, s81, 1114112
  v_fmac_f32 v16, v172, v190
  v_fmac_f32 v17, v173, v190
  v_mfma_f32_16x16x32_bf16 v[92:95], a[104:107], a[148:151], v[92:95]
  s_and_b32 s92, s92, 0x1fffff
  v_fmac_f32 v18, v174, v190
  v_fmac_f32 v19, v175, v190
  v_mfma_f32_16x16x32_bf16 v[92:95], a[124:127], a[172:175], v[92:95]
  buffer_load_dwordx4 v186, s[12:15], s92 offen lds
  v_cvt_pk_bf16_f32 v0, v0, v1
  v_mfma_f32_16x16x32_bf16 v[88:91], a[120:123], a[172:175], v[88:91]
  v_cvt_pk_bf16_f32 v1, v2, v3
  v_cvt_pk_bf16_f32 v2, v16, v17
  v_mfma_f32_16x16x32_bf16 v[88:91], a[100:103], a[148:151], v[88:91]
  v_cvt_pk_bf16_f32 v3, v18, v19
  v_cndmask_b32 v136, v245, v132, s[46:47]
  v_mfma_f32_16x16x32_bf16 v[84:87], a[96:99], a[148:151], v[84:87]
  v_mov_b32 v160, 0x3f803f80
  v_mul_f32 v108, 0x3e8293ee, v191
  v_mfma_f32_16x16x32_bf16 v[84:87], a[116:119], a[172:175], v[84:87]
  v_cndmask_b32 v137, v245, v133, s[46:47]
  v_mov_b32 v161, 0x3f803f80
  v_mfma_f32_16x16x32_bf16 v[80:83], a[112:115], a[172:175], v[80:83]
  v_mul_f32 v109, 0x3e8293ee, v193
  v_cndmask_b32 v138, v245, v134, s[46:47]
  v_mfma_f32_16x16x32_bf16 v[80:83], a[92:95], a[148:151], v[80:83]
  v_mov_b32 v162, 0x3f803f80
  v_mul_f32 v110, 0x3e8293ee, v195
Lmk_p1epi:
  v_cndmask_b32 v139, v245, v135, s[46:47]
  v_mov_b32 v163, 0x3f803f80
  v_mul_f32 v111, 0x3e8293ee, v197
  s_waitcnt lgkmcnt(0)
  v_pk_fma_f32 v[96:97], v[176:177], v[188:189], v[96:97] op_sel:[0,0,0] op_sel_hi:[1,0,1]
  v_pk_fma_f32 v[98:99], v[178:179], v[188:189], v[98:99] op_sel:[0,0,0] op_sel_hi:[1,0,1]
  v_pk_mul_f32 v[96:97], v[96:97], v[188:189] op_sel:[0,1] op_sel_hi:[1,1]
  v_pk_mul_f32 v[98:99], v[98:99], v[188:189] op_sel:[0,1] op_sel_hi:[1,1]
  v_cvt_pk_bf16_f32 v96, v96, v97
  v_cvt_pk_bf16_f32 v97, v98, v99
  v_pk_fma_f32 v[44:45], v[176:177], v[196:197], v[44:45] op_sel:[0,0,0] op_sel_hi:[1,0,1]
  v_pk_fma_f32 v[46:47], v[178:179], v[196:197], v[46:47] op_sel:[0,0,0] op_sel_hi:[1,0,1]
  v_pk_fma_f32 v[60:61], v[180:181], v[196:197], v[60:61] op_sel:[0,0,0] op_sel_hi:[1,0,1]
  v_pk_fma_f32 v[62:63], v[182:183], v[196:197], v[62:63] op_sel:[0,0,0] op_sel_hi:[1,0,1]
  v_pk_mul_f32 v[44:45], v[44:45], v[196:197] op_sel:[0,1] op_sel_hi:[1,1]
  v_pk_mul_f32 v[46:47], v[46:47], v[196:197] op_sel:[0,1] op_sel_hi:[1,1]
  v_pk_mul_f32 v[60:61], v[60:61], v[196:197] op_sel:[0,1] op_sel_hi:[1,1]
  v_pk_mul_f32 v[62:63], v[62:63], v[196:197] op_sel:[0,1] op_sel_hi:[1,1]
  v_cvt_pk_bf16_f32 v44, v44, v45
  v_cvt_pk_bf16_f32 v45, v46, v47
  v_cvt_pk_bf16_f32 v46, v60, v61
  v_cvt_pk_bf16_f32 v47, v62, v63
  v_pk_fma_f32 v[100:101], v[200:201], v[184:185], v[100:101] op_sel:[0,0,0] op_sel_hi:[1,0,1]
  v_pk_fma_f32 v[102:103], v[202:203], v[184:185], v[102:103] op_sel:[0,0,0] op_sel_hi:[1,0,1]
  v_pk_mul_f32 v[100:101], v[100:101], v[220:221]
  v_pk_mul_f32 v[102:103], v[102:103], v[222:223]
  v_cvt_pk_bf16_f32 v100, v100, v101
  v_cvt_pk_bf16_f32 v101, v102, v103
  v_pk_fma_f32 v[76:77], v[216:217], v[184:185], v[76:77] op_sel:[0,0,0] op_sel_hi:[1,0,1]
  v_pk_fma_f32 v[78:79], v[218:219], v[184:185], v[78:79] op_sel:[0,0,0] op_sel_hi:[1,0,1]
  v_pk_fma_f32 v[92:93], v[216:217], v[184:185], v[92:93] op_sel:[0,1,0] op_sel_hi:[1,1,1]
  v_pk_fma_f32 v[94:95], v[218:219], v[184:185], v[94:95] op_sel:[0,1,0] op_sel_hi:[1,1,1]
  v_pk_mul_f32 v[76:77], v[76:77], v[236:237]
  v_pk_mul_f32 v[78:79], v[78:79], v[238:239]
  v_pk_mul_f32 v[92:93], v[92:93], v[236:237]
  v_pk_mul_f32 v[94:95], v[94:95], v[238:239]
  v_cvt_pk_bf16_f32 v148, v76, v77
  v_cvt_pk_bf16_f32 v149, v78, v79
  v_cvt_pk_bf16_f32 v158, v92, v93
  v_cvt_pk_bf16_f32 v159, v94, v95
  ds_write2st64_b64 v121, v[96:97], v[100:101] offset0:0 offset1:1
  ds_write2st64_b64 v121, v[44:45], v[148:149] offset0:4 offset1:5
  ds_write2st64_b64 v121, v[46:47], v[158:159] offset0:6 offset1:7
  s_add_u32 m0, s89, 0
  s_add_u32 s92, s80, 0
  s_and_b32 s92, s92, 0x1fffff
  buffer_load_dwordx4 v186, s[12:15], s92 offen lds
  v_pk_fma_f32 v[40:41], v[176:177], v[194:195], v[40:41] op_sel:[0,0,0] op_sel_hi:[1,0,1]
  v_pk_fma_f32 v[42:43], v[178:179], v[194:195], v[42:43] op_sel:[0,0,0] op_sel_hi:[1,0,1]
  v_pk_fma_f32 v[56:57], v[180:181], v[194:195], v[56:57] op_sel:[0,0,0] op_sel_hi:[1,0,1]
  v_pk_fma_f32 v[58:59], v[182:183], v[194:195], v[58:59] op_sel:[0,0,0] op_sel_hi:[1,0,1]
  v_pk_mul_f32 v[40:41], v[40:41], v[194:195] op_sel:[0,1] op_sel_hi:[1,1]
  v_pk_mul_f32 v[42:43], v[42:43], v[194:195] op_sel:[0,1] op_sel_hi:[1,1]
  v_pk_mul_f32 v[56:57], v[56:57], v[194:195] op_sel:[0,1] op_sel_hi:[1,1]
  v_pk_mul_f32 v[58:59], v[58:59], v[194:195] op_sel:[0,1] op_sel_hi:[1,1]
  v_cvt_pk_bf16_f32 v40, v40, v41
  v_cvt_pk_bf16_f32 v41, v42, v43
  v_cvt_pk_bf16_f32 v42, v56, v57
  v_cvt_pk_bf16_f32 v43, v58, v59
  s_add_u32 m0, s89, 4096
  s_add_u32 s92, s81, 65536
  s_and_b32 s92, s92, 0x1fffff
  buffer_load_dwordx4 v186, s[12:15], s92 offen lds
  v_pk_fma_f32 v[36:37], v[176:177], v[192:193], v[36:37] op_sel:[0,0,0] op_sel_hi:[1,0,1]
  v_pk_fma_f32 v[38:39], v[178:179], v[192:193], v[38:39] op_sel:[0,0,0] op_sel_hi:[1,0,1]
  v_pk_fma_f32 v[52:53], v[180:181], v[192:193], v[52:53] op_sel:[0,0,0] op_sel_hi:[1,0,1]
  v_pk_fma_f32 v[54:55], v[182:183], v[192:193], v[54:55] op_sel:[0,0,0] op_sel_hi:[1,0,1]
  v_pk_mul_f32 v[36:37], v[36:37], v[192:193] op_sel:[0,1] op_sel_hi:[1,1]
  v_pk_mul_f32 v[38:39], v[38:39], v[192:193] op_sel:[0,1] op_sel_hi:[1,1]
  v_pk_mul_f32 v[52:53], v[52:53], v[192:193] op_sel:[0,1] op_sel_hi:[1,1]
  v_pk_mul_f32 v[54:55], v[54:55], v[192:193] op_sel:[0,1] op_sel_hi:[1,1]
  v_cvt_pk_bf16_f32 v36, v36, v37
  v_cvt_pk_bf16_f32 v37, v38, v39
  v_cvt_pk_bf16_f32 v38, v52, v53
  v_cvt_pk_bf16_f32 v39, v54, v55
  s_add_u32 m0, s89, 8192
  s_add_u32 s92, s82, 131072
  s_and_b32 s92, s92, 0x1fffff
  buffer_load_dwordx4 v186, s[12:15], s92 offen lds
  v_pk_fma_f32 v[32:33], v[176:177], v[190:191], v[32:33] op_sel:[0,0,0] op_sel_hi:[1,0,1]
  v_pk_fma_f32 v[34:35], v[178:179], v[190:191], v[34:35] op_sel:[0,0,0] op_sel_hi:[1,0,1]
  v_pk_fma_f32 v[48:49], v[180:181], v[190:191], v[48:49] op_sel:[0,0,0] op_sel_hi:[1,0,1]
  v_pk_fma_f32 v[50:51], v[182:183], v[190:191], v[50:51] op_sel:[0,0,0] op_sel_hi:[1,0,1]
  v_pk_mul_f32 v[32:33], v[32:33], v[190:191] op_sel:[0,1] op_sel_hi:[1,1]
  v_pk_mul_f32 v[34:35], v[34:35], v[190:191] op_sel:[0,1] op_sel_hi:[1,1]
  v_pk_mul_f32 v[48:49], v[48:49], v[190:191] op_sel:[0,1] op_sel_hi:[1,1]
  v_pk_mul_f32 v[50:51], v[50:51], v[190:191] op_sel:[0,1] op_sel_hi:[1,1]
  v_cvt_pk_bf16_f32 v32, v32, v33
  v_cvt_pk_bf16_f32 v33, v34, v35
  v_cvt_pk_bf16_f32 v34, v48, v49
  v_cvt_pk_bf16_f32 v35, v50, v51
  s_waitcnt lgkmcnt(0)
  s_barrier
  ds_read_b64 v[104:105], v198
  ds_read_b64 v[106:107], v199
  ds_read_b64 v[140:141], v198 offset:512
  ds_read_b64 v[150:151], v199 offset:512
  v_mfma_f32_16x16x32_bf16 v[60:63], v[44:47], v[12:15], v[128:131]
  v_mfma_f32_16x16x32_bf16 v[28:31], v[40:43], v[12:15], v[132:135]
  v_mfma_f32_16x16x32_bf16 v[56:59], v[40:43], v[8:11], v[128:131]
  v_mfma_f32_16x16x32_bf16 v[24:27], v[36:39], v[8:11], v[132:135]
  v_mfma_f32_16x16x32_bf16 v[52:55], v[36:39], v[4:7], v[128:131]
  v_mfma_f32_16x16x32_bf16 v[20:23], v[32:35], v[4:7], v[132:135]
  v_mfma_f32_16x16x32_bf16 v[48:51], v[32:35], v[0:3], v[128:131]
  s_waitcnt lgkmcnt(0)
  v_mfma_f32_16x16x32_bf16 v[16:19], v[104:107], v[0:3], v[136:139]
  s_add_u32 m0, s89, 12288
  s_add_u32 s92, s83, 196608
  s_and_b32 s92, s92, 0x1fffff
  buffer_load_dwordx4 v186, s[12:15], s92 offen lds
  v_pk_fma_f32 v[64:65], v[204:205], v[184:185], v[64:65] op_sel:[0,0,0] op_sel_hi:[1,0,1]
  v_pk_fma_f32 v[66:67], v[206:207], v[184:185], v[66:67] op_sel:[0,0,0] op_sel_hi:[1,0,1]
  v_pk_fma_f32 v[80:81], v[204:205], v[184:185], v[80:81] op_sel:[0,1,0] op_sel_hi:[1,1,1]
  v_pk_fma_f32 v[82:83], v[206:207], v[184:185], v[82:83] op_sel:[0,1,0] op_sel_hi:[1,1,1]
  v_pk_mul_f32 v[64:65], v[64:65], v[224:225]
  v_pk_mul_f32 v[66:67], v[66:67], v[226:227]
  v_pk_mul_f32 v[80:81], v[80:81], v[224:225]
  v_pk_mul_f32 v[82:83], v[82:83], v[226:227]
  v_cvt_pk_bf16_f32 v142, v64, v65
  v_cvt_pk_bf16_f32 v143, v66, v67
  v_cvt_pk_bf16_f32 v152, v80, v81
  v_cvt_pk_bf16_f32 v153, v82, v83
  s_add_u32 m0, s89, 16384
  s_add_u32 s92, s84, 262144
  s_and_b32 s92, s92, 0x1fffff
  buffer_load_dwordx4 v186, s[12:15], s92 offen lds
  v_pk_fma_f32 v[68:69], v[208:209], v[184:185], v[68:69] op_sel:[0,0,0] op_sel_hi:[1,0,1]
  v_pk_fma_f32 v[70:71], v[210:211], v[184:185], v[70:71] op_sel:[0,0,0] op_sel_hi:[1,0,1]
  v_pk_fma_f32 v[84:85], v[208:209], v[184:185], v[84:85] op_sel:[0,1,0] op_sel_hi:[1,1,1]
  v_pk_fma_f32 v[86:87], v[210:211], v[184:185], v[86:87] op_sel:[0,1,0] op_sel_hi:[1,1,1]
  v_pk_mul_f32 v[68:69], v[68:69], v[228:229]
  v_pk_mul_f32 v[70:71], v[70:71], v[230:231]
  v_pk_mul_f32 v[84:85], v[84:85], v[228:229]
  v_pk_mul_f32 v[86:87], v[86:87], v[230:231]
  v_cvt_pk_bf16_f32 v144, v68, v69
  v_cvt_pk_bf16_f32 v145, v70, v71
  v_cvt_pk_bf16_f32 v154, v84, v85
  v_cvt_pk_bf16_f32 v155, v86, v87
  s_add_u32 m0, s89, 20480
  s_add_u32 s92, s85, 327680
  s_and_b32 s92, s92, 0x1fffff
  buffer_load_dwordx4 v186, s[12:15], s92 offen lds
  v_pk_fma_f32 v[72:73], v[212:213], v[184:185], v[72:73] op_sel:[0,0,0] op_sel_hi:[1,0,1]
  v_pk_fma_f32 v[74:75], v[214:215], v[184:185], v[74:75] op_sel:[0,0,0] op_sel_hi:[1,0,1]
  v_pk_fma_f32 v[88:89], v[212:213], v[184:185], v[88:89] op_sel:[0,1,0] op_sel_hi:[1,1,1]
  v_pk_fma_f32 v[90:91], v[214:215], v[184:185], v[90:91] op_sel:[0,1,0] op_sel_hi:[1,1,1]
  v_pk_mul_f32 v[72:73], v[72:73], v[232:233]
  v_pk_mul_f32 v[74:75], v[74:75], v[234:235]
  v_pk_mul_f32 v[88:89], v[88:89], v[232:233]
  v_pk_mul_f32 v[90:91], v[90:91], v[234:235]
  v_cvt_pk_bf16_f32 v146, v72, v73
  v_cvt_pk_bf16_f32 v147, v74, v75
  v_cvt_pk_bf16_f32 v156, v88, v89
  v_cvt_pk_bf16_f32 v157, v90, v91
  s_add_u32 m0, s89, 24576
  s_add_u32 s92, s86, 393216
  s_and_b32 s92, s92, 0x1fffff
  buffer_load_dwordx4 v186, s[12:15], s92 offen lds
  s_cmp_eq_u32 s57, 0
  s_cbranch_scc1 Lp1_nsw
  v_swap_b32 v140, v150
  v_swap_b32 v141, v151
  v_swap_b32 v142, v152
  v_swap_b32 v143, v153
  v_swap_b32 v144, v154
  v_swap_b32 v145, v155
  v_swap_b32 v146, v156
  v_swap_b32 v147, v157
  v_swap_b32 v148, v158
  v_swap_b32 v149, v159
Lp1_nsw:
  v_max3_f32 v240, v16, v17, v18
  v_max3_f32 v241, v20, v21, v22
  v_max3_f32 v242, v24, v25, v26
  v_max3_f32 v243, v28, v29, v30
  v_max3_f32 v240, v240, v19, v48
  v_max3_f32 v241, v241, v23, v52
  v_max3_f32 v242, v242, v27, v56
  v_max3_f32 v243, v243, v31, v60
  v_max3_f32 v240, v240, v49, v50
  v_max3_f32 v241, v241, v53, v54
  v_max3_f32 v242, v242, v57, v58
  v_max3_f32 v243, v243, v61, v62
  v_max_f32 v240, v240, v51
  v_max_f32 v241, v241, v55
  v_max_f32 v242, v242, v59
  v_max_f32 v243, v243, v63
  v_mov_b32 v244, v240
  v_mov_b32 v245, v241
  v_mov_b32 v246, v242
  v_mov_b32 v247, v243
  v_permlane32_swap_b32 v240, v244
  v_permlane32_swap_b32 v241, v245
  v_permlane32_swap_b32 v242, v246
  v_permlane32_swap_b32 v243, v247
  v_max_f32 v240, v240, v244
  v_max_f32 v241, v241, v245
  v_max_f32 v242, v242, v246
  v_max_f32 v243, v243, v247
  v_mov_b32 v244, v240
  v_mov_b32 v245, v241
  v_mov_b32 v246, v242
  v_mov_b32 v247, v243
  v_permlane16_swap_b32 v240, v244
  v_permlane16_swap_b32 v241, v245
  v_permlane16_swap_b32 v242, v246
  v_permlane16_swap_b32 v243, v247
  v_max_f32 v240, v240, v244
  v_max_f32 v241, v241, v245
  v_max_f32 v242, v242, v246
  v_max_f32 v243, v243, v247
  v_pk_mul_f32 v[240:241], v[240:241], v[108:109] neg_lo:[0,1] neg_hi:[0,1]
  v_pk_mul_f32 v[242:243], v[242:243], v[110:111] neg_lo:[0,1] neg_hi:[0,1]
  v_pk_fma_f32 v[16:17], v[16:17], v[108:109], v[240:241] op_sel:[0,0,0] op_sel_hi:[1,0,0]
  v_pk_fma_f32 v[18:19], v[18:19], v[108:109], v[240:241] op_sel:[0,0,0] op_sel_hi:[1,0,0]
  v_pk_fma_f32 v[48:49], v[48:49], v[108:109], v[240:241] op_sel:[0,0,0] op_sel_hi:[1,0,0]
  v_pk_fma_f32 v[50:51], v[50:51], v[108:109], v[240:241] op_sel:[0,0,0] op_sel_hi:[1,0,0]
  v_exp_f32 v16, v16
  v_exp_f32 v17, v17
  v_exp_f32 v18, v18
  v_exp_f32 v19, v19
  v_exp_f32 v48, v48
  v_exp_f32 v49, v49
  v_exp_f32 v50, v50
  v_exp_f32 v51, v51
  v_cvt_pk_bf16_f32 v0, v16, v17
  v_cvt_pk_bf16_f32 v1, v18, v19
  v_cvt_pk_bf16_f32 v2, v48, v49
  v_cvt_pk_bf16_f32 v3, v50, v51
  s_add_u32 m0, s89, 28672
  s_add_u32 s92, s87, 458752
  s_and_b32 s92, s92, 0x1fffff
  buffer_load_dwordx4 v186, s[12:15], s92 offen lds
  v_pk_fma_f32 v[20:21], v[20:21], v[108:109], v[240:241] op_sel:[0,1,1] op_sel_hi:[1,1,1]
  v_pk_fma_f32 v[22:23], v[22:23], v[108:109], v[240:241] op_sel:[0,1,1] op_sel_hi:[1,1,1]
  v_pk_fma_f32 v[52:53], v[52:53], v[108:109], v[240:241] op_sel:[0,1,1] op_sel_hi:[1,1,1]
  v_pk_fma_f32 v[54:55], v[54:55], v[108:109], v[240:241] op_sel:[0,1,1] op_sel_hi:[1,1,1]
  v_exp_f32 v20, v20
  v_exp_f32 v21, v21
  v_exp_f32 v22, v22
  v_exp_f32 v23, v23
  v_exp_f32 v52, v52
  v_exp_f32 v53, v53
  v_exp_f32 v54, v54
  v_exp_f32 v55, v55
  v_cvt_pk_bf16_f32 v4, v20, v21
  v_cvt_pk_bf16_f32 v5, v22, v23
  v_cvt_pk_bf16_f32 v6, v52, v53
  v_cvt_pk_bf16_f32 v7, v54, v55
  s_add_u32 m0, s89, 32768
  s_add_u32 s92, s80, 524288
  s_and_b32 s92, s92, 0x1fffff
  buffer_load_dwordx4 v186, s[12:15], s92 offen lds
  v_pk_fma_f32 v[24:25], v[24:25], v[110:111], v[242:243] op_sel:[0,0,0] op_sel_hi:[1,0,0]
  v_pk_fma_f32 v[26:27], v[26:27], v[110:111], v[242:243] op_sel:[0,0,0] op_sel_hi:[1,0,0]
  v_pk_fma_f32 v[56:57], v[56:57], v[110:111], v[242:243] op_sel:[0,0,0] op_sel_hi:[1,0,0]
  v_pk_fma_f32 v[58:59], v[58:59], v[110:111], v[242:243] op_sel:[0,0,0] op_sel_hi:[1,0,0]
  v_exp_f32 v24, v24
  v_exp_f32 v25, v25
  v_exp_f32 v26, v26
  v_exp_f32 v27, v27
  v_exp_f32 v56, v56
  v_exp_f32 v57, v57
  v_exp_f32 v58, v58
  v_exp_f32 v59, v59
  v_cvt_pk_bf16_f32 v8, v24, v25
  v_cvt_pk_bf16_f32 v9, v26, v27
  v_cvt_pk_bf16_f32 v10, v56, v57
  v_cvt_pk_bf16_f32 v11, v58, v59
  v_pk_fma_f32 v[28:29], v[28:29], v[110:111], v[242:243] op_sel:[0,1,1] op_sel_hi:[1,1,1]
  v_pk_fma_f32 v[30:31], v[30:31], v[110:111], v[242:243] op_sel:[0,1,1] op_sel_hi:[1,1,1]
  v_pk_fma_f32 v[60:61], v[60:61], v[110:111], v[242:243] op_sel:[0,1,1] op_sel_hi:[1,1,1]
  v_pk_fma_f32 v[62:63], v[62:63], v[110:111], v[242:243] op_sel:[0,1,1] op_sel_hi:[1,1,1]
  v_exp_f32 v28, v28
  v_exp_f32 v29, v29
  v_exp_f32 v30, v30
  v_exp_f32 v31, v31
  v_exp_f32 v60, v60
  v_exp_f32 v61, v61
  v_exp_f32 v62, v62
  v_exp_f32 v63, v63
  v_cvt_pk_bf16_f32 v12, v28, v29
  v_cvt_pk_bf16_f32 v13, v30, v31
  v_cvt_pk_bf16_f32 v14, v60, v61
  v_cvt_pk_bf16_f32 v15, v62, v63
  s_add_u32 m0, s89, 36864
  s_add_u32 s92, s81, 589824
  s_and_b32 s92, s92, 0x1fffff
  buffer_load_dwordx4 v186, s[12:15], s92 offen lds
  v_mfma_f32_16x16x32_bf16 v[32:35], v[160:163], v[0:3], 0
  s_lshl_b32 s43, s74, 15
  s_lshl_b32 s44, s75, 10
  v_mfma_f32_16x16x32_bf16 v[36:39], v[160:163], v[4:7], 0
  s_add_u32 s43, s43, s44
  s_add_u32 s43, s43, s42
  v_mfma_f32_16x16x32_bf16 v[40:43], v[160:163], v[8:11], 0
  s_add_u32 s46, s43, 8388608
  s_add_u32 s47, s46, 32768
  v_mfma_f32_16x16x32_bf16 v[44:47], v[160:163], v[12:15], 0
  s_add_u32 s48, s47, 32768
  s_add_u32 s49, s48, 32768
  v_mfma_f32_16x16x32_bf16 v[64:67], v[140:143], v[0:3], 0
  s_lshl_b32 s77, s50, 1
  v_mfma_f32_16x16x32_bf16 v[80:83], v[150:153], v[0:3], 0
  s_lshr_b32 s43, s51, 3
  v_mfma_f32_16x16x32_bf16 v[68:71], v[142:145], v[4:7], 0
  s_add_u32 s77, s77, s43
  v_mfma_f32_16x16x32_bf16 v[84:87], v[152:155], v[4:7], 0
  s_lshl_b32 s77, s77, 7
  v_mfma_f32_16x16x32_bf16 v[72:75], v[144:147], v[8:11], 0
  s_add_u32 s77, s77, s42
  v_rcp_f32 v32, v32
  v_mfma_f32_16x16x32_bf16 v[88:91], v[154:157], v[8:11], 0
  s_add_u32 s77, s77, 27787264
  v_rcp_f32 v36, v36
  v_mfma_f32_16x16x32_bf16 v[76:79], v[146:149], v[12:15], 0
  v_rcp_f32 v40, v40
  v_mfma_f32_16x16x32_bf16 v[92:95], v[156:159], v[12:15], 0
  v_rcp_f32 v44, v44
  v_pk_mul_f32 v[64:65], v[64:65], v[32:33] op_sel:[0,0] op_sel_hi:[1,0]
  v_pk_mul_f32 v[66:67], v[66:67], v[32:33] op_sel:[0,0] op_sel_hi:[1,0]
  v_pk_mul_f32 v[80:81], v[80:81], v[32:33] op_sel:[0,0] op_sel_hi:[1,0]
  v_pk_mul_f32 v[82:83], v[82:83], v[32:33] op_sel:[0,0] op_sel_hi:[1,0]
  v_cvt_pk_bf16_f32 v16, v64, v65
  v_cvt_pk_bf16_f32 v17, v66, v67
  v_cvt_pk_bf16_f32 v18, v80, v81
  v_cvt_pk_bf16_f32 v19, v82, v83
  buffer_store_dwordx4 v[16:19], v120, s[4:7], s46 offen sc1
  v_pk_mul_f32 v[68:69], v[68:69], v[36:37] op_sel:[0,0] op_sel_hi:[1,0]
  v_pk_mul_f32 v[70:71], v[70:71], v[36:37] op_sel:[0,0] op_sel_hi:[1,0]
  v_pk_mul_f32 v[84:85], v[84:85], v[36:37] op_sel:[0,0] op_sel_hi:[1,0]
  v_pk_mul_f32 v[86:87], v[86:87], v[36:37] op_sel:[0,0] op_sel_hi:[1,0]
  v_cvt_pk_bf16_f32 v20, v68, v69
  v_cvt_pk_bf16_f32 v21, v70, v71
  v_cvt_pk_bf16_f32 v22, v84, v85
  v_cvt_pk_bf16_f32 v23, v86, v87
  buffer_store_dwordx4 v[20:23], v120, s[4:7], s47 offen sc1
  v_pk_mul_f32 v[72:73], v[72:73], v[40:41] op_sel:[0,0] op_sel_hi:[1,0]
  v_pk_mul_f32 v[74:75], v[74:75], v[40:41] op_sel:[0,0] op_sel_hi:[1,0]
  v_pk_mul_f32 v[88:89], v[88:89], v[40:41] op_sel:[0,0] op_sel_hi:[1,0]
  v_pk_mul_f32 v[90:91], v[90:91], v[40:41] op_sel:[0,0] op_sel_hi:[1,0]
  v_cvt_pk_bf16_f32 v24, v72, v73
  v_cvt_pk_bf16_f32 v25, v74, v75
  v_cvt_pk_bf16_f32 v26, v88, v89
  v_cvt_pk_bf16_f32 v27, v90, v91
  buffer_store_dwordx4 v[24:27], v120, s[4:7], s48 offen sc1
  v_pk_mul_f32 v[76:77], v[76:77], v[44:45] op_sel:[0,0] op_sel_hi:[1,0]
  v_pk_mul_f32 v[78:79], v[78:79], v[44:45] op_sel:[0,0] op_sel_hi:[1,0]
  v_pk_mul_f32 v[92:93], v[92:93], v[44:45] op_sel:[0,0] op_sel_hi:[1,0]
  v_pk_mul_f32 v[94:95], v[94:95], v[44:45] op_sel:[0,0] op_sel_hi:[1,0]
  v_cvt_pk_bf16_f32 v28, v76, v77
  v_cvt_pk_bf16_f32 v29, v78, v79
  v_cvt_pk_bf16_f32 v30, v92, v93
  v_cvt_pk_bf16_f32 v31, v94, v95
  buffer_store_dwordx4 v[28:31], v120, s[4:7], s49 offen sc1
Lmk_p1end:
  s_lshl_b32 s58, s52, 3
  s_lshl_b32 s43, s40, 1
  s_add_u32 s58, s58, s43
  s_lshl_b32 s59, s58, 15
  s_lshl_b32 s43, s53, 11
  s_add_u32 s59, s59, s43
  s_add_u32 s59, s59, s42
  v_lshlrev_b32 v48, 4, v253
  v_add_u32 v49, 32768, v48
  s_waitcnt vmcnt(22)
  v_accvgpr_read_b32 v52, a240
  v_accvgpr_read_b32 v53, a241
  v_accvgpr_read_b32 v54, a242
  v_accvgpr_read_b32 v55, a243
  v_accvgpr_read_b32 v56, a244
  v_accvgpr_read_b32 v57, a245
  v_accvgpr_read_b32 v58, a246
  v_accvgpr_read_b32 v59, a247
  v_accvgpr_read_b32 v60, a248
  v_accvgpr_read_b32 v61, a249
  v_accvgpr_read_b32 v62, a250
  v_accvgpr_read_b32 v63, a251
  v_accvgpr_read_b32 v64, a252
  v_accvgpr_read_b32 v65, a253
  v_accvgpr_read_b32 v66, a254
  v_accvgpr_read_b32 v67, a255
  s_cmp_lg_u32 s41, 0
  s_cbranch_scc1 Lp2_res
  v_permlane16_swap_b32 v52, v54
  v_permlane16_swap_b32 v53, v55
  v_permlane16_swap_b32 v56, v58
  v_permlane16_swap_b32 v57, v59
  v_permlane16_swap_b32 v60, v62
  v_permlane16_swap_b32 v61, v63
  v_permlane16_swap_b32 v64, v66
  v_permlane16_swap_b32 v65, v67
Lp2_res:
  s_mul_i32 s57, s58, 32768
  s_add_u32 s57, s57, s42
  s_add_u32 s57, s57, 8388608
  s_mov_b32 s60, 0
  v_lshrrev_b32 v2, 2, v253
  v_bfe_u32 v3, v253, 3, 2
  v_and_b32 v4, 3, v253
  v_lshlrev_b32 v4, 3, v4
  v_lshl_add_u32 v4, v2, 7, v4
  v_xor_b32 v5, 0, v3
  v_lshl_add_u32 v40, v5, 5, v4
  v_xor_b32 v5, 1, v3
  v_lshl_add_u32 v41, v5, 5, v4
  v_xor_b32 v5, 2, v3
  v_lshl_add_u32 v42, v5, 5, v4
  v_xor_b32 v5, 3, v3
  v_lshl_add_u32 v43, v5, 5, v4
  s_cmp_eq_u32 s3, 0
  s_cbranch_scc1 Lsd6
  v_accvgpr_read_b32 v236, a176
  v_accvgpr_read_b32 v237, a177
  v_accvgpr_read_b32 v238, a178
  v_accvgpr_read_b32 v239, a179
  v_lshlrev_b32 v224, 16, v236
  v_and_b32 v225, 0xffff0000, v236
  v_lshlrev_b32 v226, 16, v237
  v_and_b32 v227, 0xffff0000, v237
  v_lshlrev_b32 v228, 16, v238
  v_and_b32 v229, 0xffff0000, v238
  v_lshlrev_b32 v230, 16, v239
  v_and_b32 v231, 0xffff0000, v239
  v_accvgpr_read_b32 v236, a180
  v_accvgpr_read_b32 v237, a181
  v_accvgpr_read_b32 v238, a182
  v_accvgpr_read_b32 v239, a183
  v_lshlrev_b32 v232, 16, v236
  v_and_b32 v233, 0xffff0000, v236
  v_pk_add_f32 v[224:225], v[224:225], v[232:233]
  v_lshlrev_b32 v232, 16, v237
  v_and_b32 v233, 0xffff0000, v237
  v_pk_add_f32 v[226:227], v[226:227], v[232:233]
  v_lshlrev_b32 v232, 16, v238
  v_and_b32 v233, 0xffff0000, v238
  v_pk_add_f32 v[228:229], v[228:229], v[232:233]
  v_lshlrev_b32 v232, 16, v239
  v_and_b32 v233, 0xffff0000, v239
  v_pk_add_f32 v[230:231], v[230:231], v[232:233]
  v_accvgpr_read_b32 v236, a184
  v_accvgpr_read_b32 v237, a185
  v_accvgpr_read_b32 v238, a186
  v_accvgpr_read_b32 v239, a187
  v_lshlrev_b32 v232, 16, v236
  v_and_b32 v233, 0xffff0000, v236
  v_pk_add_f32 v[224:225], v[224:225], v[232:233]
  v_lshlrev_b32 v232, 16, v237
  v_and_b32 v233, 0xffff0000, v237
  v_pk_add_f32 v[226:227], v[226:227], v[232:233]
  v_lshlrev_b32 v232, 16, v238
  v_and_b32 v233, 0xffff0000, v238
  v_pk_add_f32 v[228:229], v[228:229], v[232:233]
  v_lshlrev_b32 v232, 16, v239
  v_and_b32 v233, 0xffff0000, v239
  v_pk_add_f32 v[230:231], v[230:231], v[232:233]
  v_accvgpr_read_b32 v236, a188
  v_accvgpr_read_b32 v237, a189
  v_accvgpr_read_b32 v238, a190
  v_accvgpr_read_b32 v239, a191
  v_lshlrev_b32 v232, 16, v236
  v_and_b32 v233, 0xffff0000, v236
  v_pk_add_f32 v[224:225], v[224:225], v[232:233]
  v_lshlrev_b32 v232, 16, v237
  v_and_b32 v233, 0xffff0000, v237
  v_pk_add_f32 v[226:227], v[226:227], v[232:233]
  v_lshlrev_b32 v232, 16, v238
  v_and_b32 v233, 0xffff0000, v238
  v_pk_add_f32 v[228:229], v[228:229], v[232:233]
  v_lshlrev_b32 v232, 16, v239
  v_and_b32 v233, 0xffff0000, v239
  v_pk_add_f32 v[230:231], v[230:231], v[232:233]
  v_accvgpr_read_b32 v236, a192
  v_accvgpr_read_b32 v237, a193
  v_accvgpr_read_b32 v238, a194
  v_accvgpr_read_b32 v239, a195
  v_lshlrev_b32 v232, 16, v236
  v_and_b32 v233, 0xffff0000, v236
  v_pk_add_f32 v[224:225], v[224:225], v[232:233]
  v_lshlrev_b32 v232, 16, v237
  v_and_b32 v233, 0xffff0000, v237
  v_pk_add_f32 v[226:227], v[226:227], v[232:233]
  v_lshlrev_b32 v232, 16, v238
  v_and_b32 v233, 0xffff0000, v238
  v_pk_add_f32 v[228:229], v[228:229], v[232:233]
  v_lshlrev_b32 v232, 16, v239
  v_and_b32 v233, 0xffff0000, v239
  v_pk_add_f32 v[230:231], v[230:231], v[232:233]
  v_accvgpr_read_b32 v236, a196
  v_accvgpr_read_b32 v237, a197
  v_accvgpr_read_b32 v238, a198
  v_accvgpr_read_b32 v239, a199
  v_lshlrev_b32 v232, 16, v236
  v_and_b32 v233, 0xffff0000, v236
  v_pk_add_f32 v[224:225], v[224:225], v[232:233]
  v_lshlrev_b32 v232, 16, v237
  v_and_b32 v233, 0xffff0000, v237
  v_pk_add_f32 v[226:227], v[226:227], v[232:233]
  v_lshlrev_b32 v232, 16, v238
  v_and_b32 v233, 0xffff0000, v238
  v_pk_add_f32 v[228:229], v[228:229], v[232:233]
  v_lshlrev_b32 v232, 16, v239
  v_and_b32 v233, 0xffff0000, v239
  v_pk_add_f32 v[230:231], v[230:231], v[232:233]
  v_accvgpr_read_b32 v236, a200
  v_accvgpr_read_b32 v237, a201
  v_accvgpr_read_b32 v238, a202
  v_accvgpr_read_b32 v239, a203
  v_lshlrev_b32 v232, 16, v236
  v_and_b32 v233, 0xffff0000, v236
  v_pk_add_f32 v[224:225], v[224:225], v[232:233]
  v_lshlrev_b32 v232, 16, v237
  v_and_b32 v233, 0xffff0000, v237
  v_pk_add_f32 v[226:227], v[226:227], v[232:233]
  v_lshlrev_b32 v232, 16, v238
  v_and_b32 v233, 0xffff0000, v238
  v_pk_add_f32 v[228:229], v[228:229], v[232:233]
  v_lshlrev_b32 v232, 16, v239
  v_and_b32 v233, 0xffff0000, v239
  v_pk_add_f32 v[230:231], v[230:231], v[232:233]
  v_accvgpr_read_b32 v236, a204
  v_accvgpr_read_b32 v237, a205
  v_accvgpr_read_b32 v238, a206
  v_accvgpr_read_b32 v239, a207
  v_lshlrev_b32 v232, 16, v236
  v_and_b32 v233, 0xffff0000, v236
  v_pk_add_f32 v[224:225], v[224:225], v[232:233]
  v_lshlrev_b32 v232, 16, v237
  v_and_b32 v233, 0xffff0000, v237
  v_pk_add_f32 v[226:227], v[226:227], v[232:233]
  v_lshlrev_b32 v232, 16, v238
  v_and_b32 v233, 0xffff0000, v238
  v_pk_add_f32 v[228:229], v[228:229], v[232:233]
  v_lshlrev_b32 v232, 16, v239
  v_and_b32 v233, 0xffff0000, v239
  v_pk_add_f32 v[230:231], v[230:231], v[232:233]
Lsd6:
  s_waitcnt vmcnt(0)
  s_barrier
  s_cmp_lg_u32 s40, 0
  s_cbranch_scc1 Lsig5
  v_mov_b32 v250, 1
  s_mov_b64 exec, 1
  buffer_atomic_add v250, v251, s[4:7], s77 offen sc1
  s_mov_b64 exec, -1
Lsig5:
  s_add_u32 m0, s89, 73728
  s_add_u32 s92, s82, 1179648
  s_and_b32 s92, s92, 0x1fffff
  buffer_load_dwordx4 v186, s[12:15], s92 offen lds
  s_add_u32 m0, s89, 77824
  s_add_u32 s92, s83, 1245184
  s_and_b32 s92, s92, 0x1fffff
  buffer_load_dwordx4 v186, s[12:15], s92 offen lds
  s_add_u32 m0, s89, 81920
  s_add_u32 s92, s84, 1310720
  s_and_b32 s92, s92, 0x1fffff
  buffer_load_dwordx4 v186, s[12:15], s92 offen lds
  s_add_u32 m0, s89, 86016
  s_add_u32 s92, s85, 1376256
  s_and_b32 s92, s92, 0x1fffff
  buffer_load_dwordx4 v186, s[12:15], s92 offen lds
  s_add_u32 m0, s89, 90112
  s_add_u32 s92, s86, 1441792
  s_and_b32 s92, s92, 0x1fffff
  buffer_load_dwordx4 v186, s[12:15], s92 offen lds
  s_add_u32 m0, s89, 94208
  s_add_u32 s92, s87, 1507328
  s_and_b32 s92, s92, 0x1fffff
  buffer_load_dwordx4 v186, s[12:15], s92 offen lds
  s_add_u32 m0, s89, 98304
  s_add_u32 s92, s80, 1572864
  s_and_b32 s92, s92, 0x1fffff
  buffer_load_dwordx4 v186, s[12:15], s92 offen lds
  s_add_u32 m0, s89, 102400
  s_add_u32 s92, s81, 1638400
  s_and_b32 s92, s92, 0x1fffff
  buffer_load_dwordx4 v186, s[12:15], s92 offen lds
  s_add_u32 m0, s89, 106496
  s_add_u32 s92, s82, 1703936
  s_and_b32 s92, s92, 0x1fffff
  buffer_load_dwordx4 v186, s[12:15], s92 offen lds
  s_add_u32 m0, s89, 110592
  s_add_u32 s92, s83, 1769472
  s_and_b32 s92, s92, 0x1fffff
  buffer_load_dwordx4 v186, s[12:15], s92 offen lds
  s_add_u32 m0, s89, 114688
  s_add_u32 s92, s84, 1835008
  s_and_b32 s92, s92, 0x1fffff
  buffer_load_dwordx4 v186, s[12:15], s92 offen lds
  s_add_u32 m0, s89, 118784
  s_add_u32 s92, s85, 1900544
  s_and_b32 s92, s92, 0x1fffff
  buffer_load_dwordx4 v186, s[12:15], s92 offen lds
  s_add_u32 m0, s89, 122880
  s_add_u32 s92, s86, 1966080
  s_and_b32 s92, s92, 0x1fffff
  buffer_load_dwordx4 v186, s[12:15], s92 offen lds
  s_add_u32 m0, s89, 126976
  s_add_u32 s92, s87, 2031616
  s_and_b32 s92, s92, 0x1fffff
  buffer_load_dwordx4 v186, s[12:15], s92 offen lds
  v_lshlrev_b32 v0, 16, v52
  v_and_b32 v1, 0xffff0000, v52
  v_lshlrev_b32 v2, 16, v53
  v_and_b32 v3, 0xffff0000, v53
  v_lshlrev_b32 v8, 16, v54
  v_and_b32 v9, 0xffff0000, v54
  v_lshlrev_b32 v10, 16, v55
  v_and_b32 v11, 0xffff0000, v55
  v_lshlrev_b32 v16, 16, v56
  v_and_b32 v17, 0xffff0000, v56
  v_lshlrev_b32 v18, 16, v57
  v_and_b32 v19, 0xffff0000, v57
  v_lshlrev_b32 v24, 16, v58
  v_and_b32 v25, 0xffff0000, v58
  v_lshlrev_b32 v26, 16, v59
  v_and_b32 v27, 0xffff0000, v59
  v_lshlrev_b32 v4, 16, v60
  v_and_b32 v5, 0xffff0000, v60
  v_lshlrev_b32 v6, 16, v61
  v_and_b32 v7, 0xffff0000, v61
  v_lshlrev_b32 v12, 16, v62
  v_and_b32 v13, 0xffff0000, v62
  v_lshlrev_b32 v14, 16, v63
  v_and_b32 v15, 0xffff0000, v63
  v_lshlrev_b32 v20, 16, v64
  v_and_b32 v21, 0xffff0000, v64
  v_lshlrev_b32 v22, 16, v65
  v_and_b32 v23, 0xffff0000, v65
  v_lshlrev_b32 v28, 16, v66
  v_and_b32 v29, 0xffff0000, v66
  v_lshlrev_b32 v30, 16, v67
  v_and_b32 v31, 0xffff0000, v67
  s_cmp_eq_u32 s3, 0
  s_cbranch_scc1 Lsd7
  v_accvgpr_read_b32 v236, a208
  v_accvgpr_read_b32 v237, a209
  v_accvgpr_read_b32 v238, a210
  v_accvgpr_read_b32 v239, a211
  v_lshlrev_b32 v232, 16, v236
  v_and_b32 v233, 0xffff0000, v236
  v_pk_add_f32 v[224:225], v[224:225], v[232:233]
  v_lshlrev_b32 v232, 16, v237
  v_and_b32 v233, 0xffff0000, v237
  v_pk_add_f32 v[226:227], v[226:227], v[232:233]
  v_lshlrev_b32 v232, 16, v238
  v_and_b32 v233, 0xffff0000, v238
  v_pk_add_f32 v[228:229], v[228:229], v[232:233]
  v_lshlrev_b32 v232, 16, v239
  v_and_b32 v233, 0xffff0000, v239
  v_pk_add_f32 v[230:231], v[230:231], v[232:233]
  v_accvgpr_read_b32 v236, a212
  v_accvgpr_read_b32 v237, a213
  v_accvgpr_read_b32 v238, a214
  v_accvgpr_read_b32 v239, a215
  v_lshlrev_b32 v232, 16, v236
  v_and_b32 v233, 0xffff0000, v236
  v_pk_add_f32 v[224:225], v[224:225], v[232:233]
  v_lshlrev_b32 v232, 16, v237
  v_and_b32 v233, 0xffff0000, v237
  v_pk_add_f32 v[226:227], v[226:227], v[232:233]
  v_lshlrev_b32 v232, 16, v238
  v_and_b32 v233, 0xffff0000, v238
  v_pk_add_f32 v[228:229], v[228:229], v[232:233]
  v_lshlrev_b32 v232, 16, v239
  v_and_b32 v233, 0xffff0000, v239
  v_pk_add_f32 v[230:231], v[230:231], v[232:233]
  v_accvgpr_read_b32 v236, a216
  v_accvgpr_read_b32 v237, a217
  v_accvgpr_read_b32 v238, a218
  v_accvgpr_read_b32 v239, a219
  v_lshlrev_b32 v232, 16, v236
  v_and_b32 v233, 0xffff0000, v236
  v_pk_add_f32 v[224:225], v[224:225], v[232:233]
  v_lshlrev_b32 v232, 16, v237
  v_and_b32 v233, 0xffff0000, v237
  v_pk_add_f32 v[226:227], v[226:227], v[232:233]
  v_lshlrev_b32 v232, 16, v238
  v_and_b32 v233, 0xffff0000, v238
  v_pk_add_f32 v[228:229], v[228:229], v[232:233]
  v_lshlrev_b32 v232, 16, v239
  v_and_b32 v233, 0xffff0000, v239
  v_pk_add_f32 v[230:231], v[230:231], v[232:233]
  v_accvgpr_read_b32 v236, a220
  v_accvgpr_read_b32 v237, a221
  v_accvgpr_read_b32 v238, a222
  v_accvgpr_read_b32 v239, a223
  v_lshlrev_b32 v232, 16, v236
  v_and_b32 v233, 0xffff0000, v236
  v_pk_add_f32 v[224:225], v[224:225], v[232:233]
  v_lshlrev_b32 v232, 16, v237
  v_and_b32 v233, 0xffff0000, v237
  v_pk_add_f32 v[226:227], v[226:227], v[232:233]
  v_lshlrev_b32 v232, 16, v238
  v_and_b32 v233, 0xffff0000, v238
  v_pk_add_f32 v[228:229], v[228:229], v[232:233]
  v_lshlrev_b32 v232, 16, v239
  v_and_b32 v233, 0xffff0000, v239
  v_pk_add_f32 v[230:231], v[230:231], v[232:233]
  v_accvgpr_read_b32 v236, a224
  v_accvgpr_read_b32 v237, a225
  v_accvgpr_read_b32 v238, a226
  v_accvgpr_read_b32 v239, a227
  v_lshlrev_b32 v232, 16, v236
  v_and_b32 v233, 0xffff0000, v236
  v_pk_add_f32 v[224:225], v[224:225], v[232:233]
  v_lshlrev_b32 v232, 16, v237
  v_and_b32 v233, 0xffff0000, v237
  v_pk_add_f32 v[226:227], v[226:227], v[232:233]
  v_lshlrev_b32 v232, 16, v238
  v_and_b32 v233, 0xffff0000, v238
  v_pk_add_f32 v[228:229], v[228:229], v[232:233]
  v_lshlrev_b32 v232, 16, v239
  v_and_b32 v233, 0xffff0000, v239
  v_pk_add_f32 v[230:231], v[230:231], v[232:233]
  v_accvgpr_read_b32 v236, a228
  v_accvgpr_read_b32 v237, a229
  v_accvgpr_read_b32 v238, a230
  v_accvgpr_read_b32 v239, a231
  v_lshlrev_b32 v232, 16, v236
  v_and_b32 v233, 0xffff0000, v236
  v_pk_add_f32 v[224:225], v[224:225], v[232:233]
  v_lshlrev_b32 v232, 16, v237
  v_and_b32 v233, 0xffff0000, v237
  v_pk_add_f32 v[226:227], v[226:227], v[232:233]
  v_lshlrev_b32 v232, 16, v238
  v_and_b32 v233, 0xffff0000, v238
  v_pk_add_f32 v[228:229], v[228:229], v[232:233]
  v_lshlrev_b32 v232, 16, v239
  v_and_b32 v233, 0xffff0000, v239
  v_pk_add_f32 v[230:231], v[230:231], v[232:233]
  v_accvgpr_read_b32 v236, a232
  v_accvgpr_read_b32 v237, a233
  v_accvgpr_read_b32 v238, a234
  v_accvgpr_read_b32 v239, a235
  v_lshlrev_b32 v232, 16, v236
  v_and_b32 v233, 0xffff0000, v236
  v_pk_add_f32 v[224:225], v[224:225], v[232:233]
  v_lshlrev_b32 v232, 16, v237
  v_and_b32 v233, 0xffff0000, v237
  v_pk_add_f32 v[226:227], v[226:227], v[232:233]
  v_lshlrev_b32 v232, 16, v238
  v_and_b32 v233, 0xffff0000, v238
  v_pk_add_f32 v[228:229], v[228:229], v[232:233]
  v_lshlrev_b32 v232, 16, v239
  v_and_b32 v233, 0xffff0000, v239
  v_pk_add_f32 v[230:231], v[230:231], v[232:233]
  v_accvgpr_read_b32 v236, a236
  v_accvgpr_read_b32 v237, a237
  v_accvgpr_read_b32 v238, a238
  v_accvgpr_read_b32 v239, a239
  v_lshlrev_b32 v232, 16, v236
  v_and_b32 v233, 0xffff0000, v236
  v_pk_add_f32 v[224:225], v[224:225], v[232:233]
  v_lshlrev_b32 v232, 16, v237
  v_and_b32 v233, 0xffff0000, v237
  v_pk_add_f32 v[226:227], v[226:227], v[232:233]
  v_lshlrev_b32 v232, 16, v238
  v_and_b32 v233, 0xffff0000, v238
  v_pk_add_f32 v[228:229], v[228:229], v[232:233]
  v_lshlrev_b32 v232, 16, v239
  v_and_b32 v233, 0xffff0000, v239
  v_pk_add_f32 v[230:231], v[230:231], v[232:233]
  v_mov_b32 v232, v224
  v_mov_b32 v233, v225
  v_mov_b32 v234, v226
  v_mov_b32 v235, v227
  v_mov_b32 v236, v228
  v_mov_b32 v237, v229
  v_mov_b32 v238, v230
  v_mov_b32 v239, v231
  v_permlane32_swap_b32 v224, v232
  v_permlane32_swap_b32 v225, v233
  v_permlane32_swap_b32 v226, v234
  v_permlane32_swap_b32 v227, v235
  v_permlane32_swap_b32 v228, v236
  v_permlane32_swap_b32 v229, v237
  v_permlane32_swap_b32 v230, v238
  v_permlane32_swap_b32 v231, v239
  v_add_f32 v224, v224, v232
  v_add_f32 v225, v225, v233
  v_add_f32 v226, v226, v234
  v_add_f32 v227, v227, v235
  v_add_f32 v228, v228, v236
  v_add_f32 v229, v229, v237
  v_add_f32 v230, v230, v238
  v_add_f32 v231, v231, v239
  v_mov_b32 v232, v224
  v_mov_b32 v233, v225
  v_mov_b32 v234, v226
  v_mov_b32 v235, v227
  v_mov_b32 v236, v228
  v_mov_b32 v237, v229
  v_mov_b32 v238, v230
  v_mov_b32 v239, v231
  v_permlane16_swap_b32 v224, v232
  v_permlane16_swap_b32 v225, v233
  v_permlane16_swap_b32 v226, v234
  v_permlane16_swap_b32 v227, v235
  v_permlane16_swap_b32 v228, v236
  v_permlane16_swap_b32 v229, v237
  v_permlane16_swap_b32 v230, v238
  v_permlane16_swap_b32 v231, v239
  v_add_f32 v224, v224, v232
  v_add_f32 v225, v225, v233
  v_add_f32 v226, v226, v234
  v_add_f32 v227, v227, v235
  v_add_f32 v228, v228, v236
  v_add_f32 v229, v229, v237
  v_add_f32 v230, v230, v238
  v_add_f32 v231, v231, v239
  v_and_b32 v232, 7, v253
  s_lshl_b32 s43, s40, 8
  s_add_u32 s43, s43, 143360
  v_add_f32_dpp v224, v224, v224 row_ror:8 row_mask:0xf bank_mask:0xf
  v_add_f32_dpp v225, v225, v225 row_ror:8 row_mask:0xf bank_mask:0xf
  v_add_f32_dpp v226, v226, v226 row_ror:8 row_mask:0xf bank_mask:0xf
  v_add_f32_dpp v227, v227, v227 row_ror:8 row_mask:0xf bank_mask:0xf
  v_add_f32_dpp v228, v228, v228 row_ror:8 row_mask:0xf bank_mask:0xf
  v_add_f32_dpp v229, v229, v229 row_ror:8 row_mask:0xf bank_mask:0xf
  v_add_f32_dpp v230, v230, v230 row_ror:8 row_mask:0xf bank_mask:0xf
  v_add_f32_dpp v231, v231, v231 row_ror:8 row_mask:0xf bank_mask:0xf
  v_lshl_add_u32 v232, v232, 5, s43
  ds_write_b128 v232, v[224:227]
  ds_write_b128 v232, v[228:231] offset:16
Lsd7:
  s_lshl_b32 s77, s52, 8
  s_add_u32 s77, s77, 27787264
  v_lshlrev_b32 v249, 7, v253
  s_add_u32 s77, s77, s42
  s_cmp_lg_u32 s40, 0
  s_cbranch_scc1 Lpdn9
  s_mov_b32 s43, 0x40000
  s_mov_b64 exec, 3
Lpol8:
  buffer_load_dword v250, v249, s[4:7], s77 offen sc1
  s_waitcnt vmcnt(0)
  v_cmp_gt_u32 vcc, 8, v250
  s_cbranch_vccz Lpdn9
  s_sub_u32 s43, s43, 1
  s_cmp_lg_u32 s43, 0
  s_cbranch_scc1 Lpol8
Lpdn9:
  s_mov_b64 exec, -1
  s_waitcnt vmcnt(0) lgkmcnt(0)
  s_barrier
  s_cmp_eq_u32 s40, 1
  s_cselect_b32 s3, s3, 0
  s_cmp_eq_u32 s3, 0
  s_cbranch_scc1 Lsd10
  v_lshlrev_b32 v232, 2, v253
  v_add_u32 v233, 143360, v232
  ds_read_b32 v234, v233 offset:0
  ds_read_b32 v235, v233 offset:256
  ds_read_b32 v236, v233 offset:512
  ds_read_b32 v237, v233 offset:768
  s_waitcnt lgkmcnt(0)
  v_add_f32 v234, v234, v235
  v_add_f32 v236, v236, v237
  v_add_f32 v234, v234, v236
  buffer_store_dword v234, v232, s[4:7], s101 offen sc1
Lsd10:
  s_lshr_b32 s93, s80, 6
  s_add_u32 s93, s93, s60
  s_and_b32 s93, s93, 0x7fff
  s_add_u32 s93, s93, s57
  buffer_load_dwordx4 a[0:3], v48, s[4:7], s93 offen sc1
  buffer_load_dwordx4 a[4:7], v49, s[4:7], s93 offen sc1
  s_add_u32 s60, s60, 1024
  s_lshr_b32 s93, s81, 6
  s_add_u32 s93, s93, s60
  s_and_b32 s93, s93, 0x7fff
  s_add_u32 s93, s93, s57
  buffer_load_dwordx4 a[8:11], v48, s[4:7], s93 offen sc1
  buffer_load_dwordx4 a[12:15], v49, s[4:7], s93 offen sc1
  s_add_u32 s60, s60, 1024
  s_lshr_b32 s93, s82, 6
  s_add_u32 s93, s93, s60
  s_and_b32 s93, s93, 0x7fff
  s_add_u32 s93, s93, s57
  buffer_load_dwordx4 a[16:19], v48, s[4:7], s93 offen sc1
  buffer_load_dwordx4 a[20:23], v49, s[4:7], s93 offen sc1
  s_add_u32 s60, s60, 1024
  s_lshr_b32 s93, s83, 6
  s_add_u32 s93, s93, s60
  s_and_b32 s93, s93, 0x7fff
  s_add_u32 s93, s93, s57
  buffer_load_dwordx4 a[24:27], v48, s[4:7], s93 offen sc1
  buffer_load_dwordx4 a[28:31], v49, s[4:7], s93 offen sc1
  s_add_u32 s60, s60, 1024
  s_lshr_b32 s93, s84, 6
  s_add_u32 s93, s93, s60
  s_and_b32 s93, s93, 0x7fff
  s_add_u32 s93, s93, s57
  buffer_load_dwordx4 a[32:35], v48, s[4:7], s93 offen sc1
  buffer_load_dwordx4 a[36:39], v49, s[4:7], s93 offen sc1
  s_add_u32 s60, s60, 1024
  s_lshr_b32 s93, s85, 6
  s_add_u32 s93, s93, s60
  s_and_b32 s93, s93, 0x7fff
  s_add_u32 s93, s93, s57
  buffer_load_dwordx4 a[40:43], v48, s[4:7], s93 offen sc1
  buffer_load_dwordx4 a[44:47], v49, s[4:7], s93 offen sc1
  s_add_u32 s60, s60, 1024
  ds_read_b64_tr_b16 a[112:113], v40 offset:0
  ds_read_b64_tr_b16 a[114:115], v40 offset:2048
  ds_read_b64_tr_b16 a[128:129], v40 offset:4096
  ds_read_b64_tr_b16 a[130:131], v40 offset:6144
  ds_read_b64_tr_b16 a[116:117], v41 offset:0
  ds_read_b64_tr_b16 a[118:119], v41 offset:2048
  ds_read_b64_tr_b16 a[132:133], v41 offset:4096
  ds_read_b64_tr_b16 a[134:135], v41 offset:6144
  ds_read_b64_tr_b16 a[120:121], v42 offset:0
  ds_read_b64_tr_b16 a[122:123], v42 offset:2048
  ds_read_b64_tr_b16 a[136:137], v42 offset:4096
  ds_read_b64_tr_b16 a[138:139], v42 offset:6144
  ds_read_b64_tr_b16 a[124:125], v43 offset:0
  ds_read_b64_tr_b16 a[126:127], v43 offset:2048
  ds_read_b64_tr_b16 a[140:141], v43 offset:4096
  ds_read_b64_tr_b16 a[142:143], v43 offset:6144
  s_mov_b32 s56, 3
.p2align 3
Lp2_loop:
  s_waitcnt vmcnt(8) lgkmcnt(12)
  v_mfma_f32_16x16x32_bf16 v[0:3], a[112:115], a[0:3], v[0:3]
  ds_read_b64_tr_b16 a[144:145], v40 offset:8192
  v_mfma_f32_16x16x32_bf16 v[0:3], a[128:131], a[8:11], v[0:3]
  s_lshr_b32 s93, s86, 6
  ds_read_b64_tr_b16 a[146:147], v40 offset:10240
  s_add_u32 s93, s93, s60
  s_and_b32 s93, s93, 0x7fff
  s_add_u32 s93, s93, s57
  buffer_load_dwordx4 a[48:51], v48, s[4:7], s93 offen sc1
  v_mfma_f32_16x16x32_bf16 v[4:7], a[128:131], a[12:15], v[4:7]
  ds_read_b64_tr_b16 a[160:161], v40 offset:12288
  v_mfma_f32_16x16x32_bf16 v[4:7], a[112:115], a[4:7], v[4:7]
  ds_read_b64_tr_b16 a[162:163], v40 offset:14336
  s_waitcnt lgkmcnt(12)
  v_mfma_f32_16x16x32_bf16 v[12:15], a[116:119], a[4:7], v[12:15]
  s_add_u32 s60, s60, 1024
  ds_read_b64_tr_b16 a[148:149], v41 offset:8192
  buffer_load_dwordx4 a[52:55], v49, s[4:7], s93 offen sc1
  v_mfma_f32_16x16x32_bf16 v[12:15], a[132:135], a[12:15], v[12:15]
  ds_read_b64_tr_b16 a[150:151], v41 offset:10240
  v_mfma_f32_16x16x32_bf16 v[8:11], a[132:135], a[8:11], v[8:11]
  ds_read_b64_tr_b16 a[164:165], v41 offset:12288
  v_mfma_f32_16x16x32_bf16 v[8:11], a[116:119], a[0:3], v[8:11]
  ds_read_b64_tr_b16 a[166:167], v41 offset:14336
  s_waitcnt lgkmcnt(12)
  v_mfma_f32_16x16x32_bf16 v[16:19], a[120:123], a[0:3], v[16:19]
  s_lshr_b32 s93, s87, 6
  ds_read_b64_tr_b16 a[152:153], v42 offset:8192
  s_add_u32 s93, s93, s60
  s_and_b32 s93, s93, 0x7fff
  s_add_u32 s93, s93, s57
  buffer_load_dwordx4 a[56:59], v48, s[4:7], s93 offen sc1
  v_mfma_f32_16x16x32_bf16 v[16:19], a[136:139], a[8:11], v[16:19]
  ds_read_b64_tr_b16 a[154:155], v42 offset:10240
  v_mfma_f32_16x16x32_bf16 v[20:23], a[136:139], a[12:15], v[20:23]
  ds_read_b64_tr_b16 a[168:169], v42 offset:12288
  v_mfma_f32_16x16x32_bf16 v[20:23], a[120:123], a[4:7], v[20:23]
  s_add_u32 s60, s60, 1024
  ds_read_b64_tr_b16 a[170:171], v42 offset:14336
  buffer_load_dwordx4 a[60:63], v49, s[4:7], s93 offen sc1
  s_waitcnt lgkmcnt(12)
  v_mfma_f32_16x16x32_bf16 v[28:31], a[124:127], a[4:7], v[28:31]
  ds_read_b64_tr_b16 a[156:157], v43 offset:8192
  v_mfma_f32_16x16x32_bf16 v[28:31], a[140:143], a[12:15], v[28:31]
  ds_read_b64_tr_b16 a[158:159], v43 offset:10240
  v_mfma_f32_16x16x32_bf16 v[24:27], a[140:143], a[8:11], v[24:27]
  ds_read_b64_tr_b16 a[172:173], v43 offset:12288
  v_mfma_f32_16x16x32_bf16 v[24:27], a[124:127], a[0:3], v[24:27]
  ds_read_b64_tr_b16 a[174:175], v43 offset:14336
  s_waitcnt vmcnt(8) lgkmcnt(12)
  v_mfma_f32_16x16x32_bf16 v[0:3], a[144:147], a[16:19], v[0:3]
  ds_read_b64_tr_b16 a[112:113], v40 offset:16384
  v_mfma_f32_16x16x32_bf16 v[0:3], a[160:163], a[24:27], v[0:3]
  s_lshr_b32 s93, s80, 6
  ds_read_b64_tr_b16 a[114:115], v40 offset:18432
  s_add_u32 s93, s93, s60
  s_and_b32 s93, s93, 0x7fff
  s_add_u32 s93, s93, s57
  buffer_load_dwordx4 a[0:3], v48, s[4:7], s93 offen sc1
  v_mfma_f32_16x16x32_bf16 v[4:7], a[160:163], a[28:31], v[4:7]
  ds_read_b64_tr_b16 a[128:129], v40 offset:20480
  v_mfma_f32_16x16x32_bf16 v[4:7], a[144:147], a[20:23], v[4:7]
  ds_read_b64_tr_b16 a[130:131], v40 offset:22528
  s_waitcnt lgkmcnt(12)
  v_mfma_f32_16x16x32_bf16 v[12:15], a[148:151], a[20:23], v[12:15]
  s_add_u32 s60, s60, 1024
  ds_read_b64_tr_b16 a[116:117], v41 offset:16384
  buffer_load_dwordx4 a[4:7], v49, s[4:7], s93 offen sc1
  v_mfma_f32_16x16x32_bf16 v[12:15], a[164:167], a[28:31], v[12:15]
  ds_read_b64_tr_b16 a[118:119], v41 offset:18432
  v_mfma_f32_16x16x32_bf16 v[8:11], a[164:167], a[24:27], v[8:11]
  ds_read_b64_tr_b16 a[132:133], v41 offset:20480
  v_mfma_f32_16x16x32_bf16 v[8:11], a[148:151], a[16:19], v[8:11]
  ds_read_b64_tr_b16 a[134:135], v41 offset:22528
  s_waitcnt lgkmcnt(12)
  v_mfma_f32_16x16x32_bf16 v[16:19], a[152:155], a[16:19], v[16:19]
  s_lshr_b32 s93, s81, 6
  ds_read_b64_tr_b16 a[120:121], v42 offset:16384
  s_add_u32 s93, s93, s60
  s_and_b32 s93, s93, 0x7fff
  s_add_u32 s93, s93, s57
  buffer_load_dwordx4 a[8:11], v48, s[4:7], s93 offen sc1
  v_mfma_f32_16x16x32_bf16 v[16:19], a[168:171], a[24:27], v[16:19]
  ds_read_b64_tr_b16 a[122:123], v42 offset:18432
  v_mfma_f32_16x16x32_bf16 v[20:23], a[168:171], a[28:31], v[20:23]
  ds_read_b64_tr_b16 a[136:137], v42 offset:20480
  v_mfma_f32_16x16x32_bf16 v[20:23], a[152:155], a[20:23], v[20:23]
  s_add_u32 s60, s60, 1024
  ds_read_b64_tr_b16 a[138:139], v42 offset:22528
  buffer_load_dwordx4 a[12:15], v49, s[4:7], s93 offen sc1
  s_waitcnt lgkmcnt(12)
  v_mfma_f32_16x16x32_bf16 v[28:31], a[156:159], a[20:23], v[28:31]
  ds_read_b64_tr_b16 a[124:125], v43 offset:16384
  v_mfma_f32_16x16x32_bf16 v[28:31], a[172:175], a[28:31], v[28:31]
  ds_read_b64_tr_b16 a[126:127], v43 offset:18432
  v_mfma_f32_16x16x32_bf16 v[24:27], a[172:175], a[24:27], v[24:27]
  ds_read_b64_tr_b16 a[140:141], v43 offset:20480
  v_mfma_f32_16x16x32_bf16 v[24:27], a[156:159], a[16:19], v[24:27]
  ds_read_b64_tr_b16 a[142:143], v43 offset:22528
  s_waitcnt vmcnt(8) lgkmcnt(12)
  v_mfma_f32_16x16x32_bf16 v[0:3], a[112:115], a[32:35], v[0:3]
  ds_read_b64_tr_b16 a[144:145], v40 offset:24576
  v_mfma_f32_16x16x32_bf16 v[0:3], a[128:131], a[40:43], v[0:3]
  s_lshr_b32 s93, s82, 6
  ds_read_b64_tr_b16 a[146:147], v40 offset:26624
  s_add_u32 s93, s93, s60
  s_and_b32 s93, s93, 0x7fff
  s_add_u32 s93, s93, s57
  buffer_load_dwordx4 a[16:19], v48, s[4:7], s93 offen sc1
  v_mfma_f32_16x16x32_bf16 v[4:7], a[128:131], a[44:47], v[4:7]
  ds_read_b64_tr_b16 a[160:161], v40 offset:28672
  v_mfma_f32_16x16x32_bf16 v[4:7], a[112:115], a[36:39], v[4:7]
  s_waitcnt lgkmcnt(11)
  ds_read_b64_tr_b16 a[162:163], v40 offset:30720
  v_add_u32 v40, 32768, v40
  v_mfma_f32_16x16x32_bf16 v[12:15], a[116:119], a[36:39], v[12:15]
  s_add_u32 s60, s60, 1024
  ds_read_b64_tr_b16 a[148:149], v41 offset:24576
  buffer_load_dwordx4 a[20:23], v49, s[4:7], s93 offen sc1
  v_mfma_f32_16x16x32_bf16 v[12:15], a[132:135], a[44:47], v[12:15]
  ds_read_b64_tr_b16 a[150:151], v41 offset:26624
  v_mfma_f32_16x16x32_bf16 v[8:11], a[132:135], a[40:43], v[8:11]
  ds_read_b64_tr_b16 a[164:165], v41 offset:28672
  v_mfma_f32_16x16x32_bf16 v[8:11], a[116:119], a[32:35], v[8:11]
  s_waitcnt lgkmcnt(11)
  ds_read_b64_tr_b16 a[166:167], v41 offset:30720
  v_add_u32 v41, 32768, v41
  v_mfma_f32_16x16x32_bf16 v[16:19], a[120:123], a[32:35], v[16:19]
  s_lshr_b32 s93, s83, 6
  ds_read_b64_tr_b16 a[152:153], v42 offset:24576
  s_add_u32 s93, s93, s60
  s_and_b32 s93, s93, 0x7fff
  s_add_u32 s93, s93, s57
  buffer_load_dwordx4 a[24:27], v48, s[4:7], s93 offen sc1
  v_mfma_f32_16x16x32_bf16 v[16:19], a[136:139], a[40:43], v[16:19]
  ds_read_b64_tr_b16 a[154:155], v42 offset:26624
  v_mfma_f32_16x16x32_bf16 v[20:23], a[136:139], a[44:47], v[20:23]
  ds_read_b64_tr_b16 a[168:169], v42 offset:28672
  v_mfma_f32_16x16x32_bf16 v[20:23], a[120:123], a[36:39], v[20:23]
  s_add_u32 s60, s60, 1024
  ds_read_b64_tr_b16 a[170:171], v42 offset:30720
  buffer_load_dwordx4 a[28:31], v49, s[4:7], s93 offen sc1
  v_add_u32 v42, 32768, v42
  s_waitcnt lgkmcnt(12)
  v_mfma_f32_16x16x32_bf16 v[28:31], a[124:127], a[36:39], v[28:31]
  ds_read_b64_tr_b16 a[156:157], v43 offset:24576
  v_mfma_f32_16x16x32_bf16 v[28:31], a[140:143], a[44:47], v[28:31]
  ds_read_b64_tr_b16 a[158:159], v43 offset:26624
  v_mfma_f32_16x16x32_bf16 v[24:27], a[140:143], a[40:43], v[24:27]
  ds_read_b64_tr_b16 a[172:173], v43 offset:28672
  v_mfma_f32_16x16x32_bf16 v[24:27], a[124:127], a[32:35], v[24:27]
  s_waitcnt vmcnt(8) lgkmcnt(11)
  ds_read_b64_tr_b16 a[174:175], v43 offset:30720
  v_add_u32 v43, 32768, v43
  v_mfma_f32_16x16x32_bf16 v[0:3], a[144:147], a[48:51], v[0:3]
  ds_read_b64_tr_b16 a[112:113], v40 offset:0
  v_mfma_f32_16x16x32_bf16 v[0:3], a[160:163], a[56:59], v[0:3]
  s_lshr_b32 s93, s84, 6
  ds_read_b64_tr_b16 a[114:115], v40 offset:2048
  s_add_u32 s93, s93, s60
  s_and_b32 s93, s93, 0x7fff
  s_add_u32 s93, s93, s57
  buffer_load_dwordx4 a[32:35], v48, s[4:7], s93 offen sc1
  v_mfma_f32_16x16x32_bf16 v[4:7], a[160:163], a[60:63], v[4:7]
  ds_read_b64_tr_b16 a[128:129], v40 offset:4096
  v_mfma_f32_16x16x32_bf16 v[4:7], a[144:147], a[52:55], v[4:7]
  ds_read_b64_tr_b16 a[130:131], v40 offset:6144
  s_waitcnt lgkmcnt(12)
  v_mfma_f32_16x16x32_bf16 v[12:15], a[148:151], a[52:55], v[12:15]
  s_add_u32 s60, s60, 1024
  ds_read_b64_tr_b16 a[116:117], v41 offset:0
  buffer_load_dwordx4 a[36:39], v49, s[4:7], s93 offen sc1
  v_mfma_f32_16x16x32_bf16 v[12:15], a[164:167], a[60:63], v[12:15]
  ds_read_b64_tr_b16 a[118:119], v41 offset:2048
  v_mfma_f32_16x16x32_bf16 v[8:11], a[164:167], a[56:59], v[8:11]
  ds_read_b64_tr_b16 a[132:133], v41 offset:4096
  v_mfma_f32_16x16x32_bf16 v[8:11], a[148:151], a[48:51], v[8:11]
  ds_read_b64_tr_b16 a[134:135], v41 offset:6144
  s_waitcnt lgkmcnt(12)
  v_mfma_f32_16x16x32_bf16 v[16:19], a[152:155], a[48:51], v[16:19]
  s_lshr_b32 s93, s85, 6
  ds_read_b64_tr_b16 a[120:121], v42 offset:0
  s_add_u32 s93, s93, s60
  s_and_b32 s93, s93, 0x7fff
  s_add_u32 s93, s93, s57
  buffer_load_dwordx4 a[40:43], v48, s[4:7], s93 offen sc1
  v_mfma_f32_16x16x32_bf16 v[16:19], a[168:171], a[56:59], v[16:19]
  ds_read_b64_tr_b16 a[122:123], v42 offset:2048
  v_mfma_f32_16x16x32_bf16 v[20:23], a[168:171], a[60:63], v[20:23]
  ds_read_b64_tr_b16 a[136:137], v42 offset:4096
  v_mfma_f32_16x16x32_bf16 v[20:23], a[152:155], a[52:55], v[20:23]
  s_add_u32 s60, s60, 1024
  ds_read_b64_tr_b16 a[138:139], v42 offset:6144
  buffer_load_dwordx4 a[44:47], v49, s[4:7], s93 offen sc1
  s_waitcnt lgkmcnt(12)
  v_mfma_f32_16x16x32_bf16 v[28:31], a[156:159], a[52:55], v[28:31]
  ds_read_b64_tr_b16 a[124:125], v43 offset:0
  v_mfma_f32_16x16x32_bf16 v[28:31], a[172:175], a[60:63], v[28:31]
  ds_read_b64_tr_b16 a[126:127], v43 offset:2048
  v_mfma_f32_16x16x32_bf16 v[24:27], a[172:175], a[56:59], v[24:27]
  ds_read_b64_tr_b16 a[140:141], v43 offset:4096
  v_mfma_f32_16x16x32_bf16 v[24:27], a[156:159], a[48:51], v[24:27]
  s_sub_u32 s56, s56, 1
  ds_read_b64_tr_b16 a[142:143], v43 offset:6144
  s_cmp_lg_u32 s56, 0
  s_cbranch_scc1 Lp2_loop
Lmk_Lp2_loop_tail:
  s_waitcnt vmcnt(8) lgkmcnt(12)
  v_mfma_f32_16x16x32_bf16 v[0:3], a[112:115], a[0:3], v[0:3]
  ds_read_b64_tr_b16 a[144:145], v40 offset:8192
  v_mfma_f32_16x16x32_bf16 v[0:3], a[128:131], a[8:11], v[0:3]
  s_lshr_b32 s93, s86, 6
  ds_read_b64_tr_b16 a[146:147], v40 offset:10240
  s_add_u32 s93, s93, s60
  s_and_b32 s93, s93, 0x7fff
  s_add_u32 s93, s93, s57
  buffer_load_dwordx4 a[48:51], v48, s[4:7], s93 offen sc1
  v_mfma_f32_16x16x32_bf16 v[4:7], a[128:131], a[12:15], v[4:7]
  ds_read_b64_tr_b16 a[160:161], v40 offset:12288
  v_mfma_f32_16x16x32_bf16 v[4:7], a[112:115], a[4:7], v[4:7]
  ds_read_b64_tr_b16 a[162:163], v40 offset:14336
  s_waitcnt lgkmcnt(12)
  v_mfma_f32_16x16x32_bf16 v[12:15], a[116:119], a[4:7], v[12:15]
  s_add_u32 s60, s60, 1024
  ds_read_b64_tr_b16 a[148:149], v41 offset:8192
  buffer_load_dwordx4 a[52:55], v49, s[4:7], s93 offen sc1
  v_mfma_f32_16x16x32_bf16 v[12:15], a[132:135], a[12:15], v[12:15]
  ds_read_b64_tr_b16 a[150:151], v41 offset:10240
  v_mfma_f32_16x16x32_bf16 v[8:11], a[132:135], a[8:11], v[8:11]
  ds_read_b64_tr_b16 a[164:165], v41 offset:12288
  v_mfma_f32_16x16x32_bf16 v[8:11], a[116:119], a[0:3], v[8:11]
  ds_read_b64_tr_b16 a[166:167], v41 offset:14336
  s_waitcnt lgkmcnt(12)
  v_mfma_f32_16x16x32_bf16 v[16:19], a[120:123], a[0:3], v[16:19]
  s_lshr_b32 s93, s87, 6
  ds_read_b64_tr_b16 a[152:153], v42 offset:8192
  s_add_u32 s93, s93, s60
  s_and_b32 s93, s93, 0x7fff
  s_add_u32 s93, s93, s57
  buffer_load_dwordx4 a[56:59], v48, s[4:7], s93 offen sc1
  v_mfma_f32_16x16x32_bf16 v[16:19], a[136:139], a[8:11], v[16:19]
  ds_read_b64_tr_b16 a[154:155], v42 offset:10240
  v_mfma_f32_16x16x32_bf16 v[20:23], a[136:139], a[12:15], v[20:23]
  ds_read_b64_tr_b16 a[168:169], v42 offset:12288
  v_mfma_f32_16x16x32_bf16 v[20:23], a[120:123], a[4:7], v[20:23]
  s_add_u32 s60, s60, 1024
  ds_read_b64_tr_b16 a[170:171], v42 offset:14336
  buffer_load_dwordx4 a[60:63], v49, s[4:7], s93 offen sc1
  s_waitcnt lgkmcnt(12)
  v_mfma_f32_16x16x32_bf16 v[28:31], a[124:127], a[4:7], v[28:31]
  ds_read_b64_tr_b16 a[156:157], v43 offset:8192
  v_mfma_f32_16x16x32_bf16 v[28:31], a[140:143], a[12:15], v[28:31]
  ds_read_b64_tr_b16 a[158:159], v43 offset:10240
  v_mfma_f32_16x16x32_bf16 v[24:27], a[140:143], a[8:11], v[24:27]
  ds_read_b64_tr_b16 a[172:173], v43 offset:12288
  v_mfma_f32_16x16x32_bf16 v[24:27], a[124:127], a[0:3], v[24:27]
  ds_read_b64_tr_b16 a[174:175], v43 offset:14336
  s_waitcnt vmcnt(8) lgkmcnt(12)
  v_mfma_f32_16x16x32_bf16 v[0:3], a[144:147], a[16:19], v[0:3]
  s_barrier
  ds_read_b64_tr_b16 a[112:113], v40 offset:16384
  v_mfma_f32_16x16x32_bf16 v[0:3], a[160:163], a[24:27], v[0:3]
  ds_read_b64_tr_b16 a[114:115], v40 offset:18432
  v_mfma_f32_16x16x32_bf16 v[4:7], a[160:163], a[28:31], v[4:7]
  ds_read_b64_tr_b16 a[128:129], v40 offset:20480
  v_mfma_f32_16x16x32_bf16 v[4:7], a[144:147], a[20:23], v[4:7]
  ds_read_b64_tr_b16 a[130:131], v40 offset:22528
  s_waitcnt lgkmcnt(12)
  v_mfma_f32_16x16x32_bf16 v[12:15], a[148:151], a[20:23], v[12:15]
  ds_read_b64_tr_b16 a[116:117], v41 offset:16384
  v_mfma_f32_16x16x32_bf16 v[12:15], a[164:167], a[28:31], v[12:15]
  ds_read_b64_tr_b16 a[118:119], v41 offset:18432
  v_mfma_f32_16x16x32_bf16 v[8:11], a[164:167], a[24:27], v[8:11]
  ds_read_b64_tr_b16 a[132:133], v41 offset:20480
  v_mfma_f32_16x16x32_bf16 v[8:11], a[148:151], a[16:19], v[8:11]
  ds_read_b64_tr_b16 a[134:135], v41 offset:22528
  s_waitcnt lgkmcnt(12)
  v_mfma_f32_16x16x32_bf16 v[16:19], a[152:155], a[16:19], v[16:19]
  ds_read_b64_tr_b16 a[120:121], v42 offset:16384
  v_mfma_f32_16x16x32_bf16 v[16:19], a[168:171], a[24:27], v[16:19]
  ds_read_b64_tr_b16 a[122:123], v42 offset:18432
  v_mfma_f32_16x16x32_bf16 v[20:23], a[168:171], a[28:31], v[20:23]
  ds_read_b64_tr_b16 a[136:137], v42 offset:20480
  v_mfma_f32_16x16x32_bf16 v[20:23], a[152:155], a[20:23], v[20:23]
  ds_read_b64_tr_b16 a[138:139], v42 offset:22528
  s_waitcnt lgkmcnt(12)
  v_mfma_f32_16x16x32_bf16 v[28:31], a[156:159], a[20:23], v[28:31]
  ds_read_b64_tr_b16 a[124:125], v43 offset:16384
  v_mfma_f32_16x16x32_bf16 v[28:31], a[172:175], a[28:31], v[28:31]
  ds_read_b64_tr_b16 a[126:127], v43 offset:18432
  v_mfma_f32_16x16x32_bf16 v[24:27], a[172:175], a[24:27], v[24:27]
  ds_read_b64_tr_b16 a[140:141], v43 offset:20480
  v_mfma_f32_16x16x32_bf16 v[24:27], a[156:159], a[16:19], v[24:27]
  ds_read_b64_tr_b16 a[142:143], v43 offset:22528
  s_waitcnt vmcnt(4) lgkmcnt(12)
  v_mfma_f32_16x16x32_bf16 v[0:3], a[112:115], a[32:35], v[0:3]
  ds_read_b64_tr_b16 a[144:145], v40 offset:24576
  v_mfma_f32_16x16x32_bf16 v[0:3], a[128:131], a[40:43], v[0:3]
  ds_read_b64_tr_b16 a[146:147], v40 offset:26624
  v_mfma_f32_16x16x32_bf16 v[4:7], a[128:131], a[44:47], v[4:7]
  ds_read_b64_tr_b16 a[160:161], v40 offset:28672
  v_mfma_f32_16x16x32_bf16 v[4:7], a[112:115], a[36:39], v[4:7]
  s_waitcnt lgkmcnt(11)
  ds_read_b64_tr_b16 a[162:163], v40 offset:30720
  v_add_u32 v40, 32768, v40
  v_mfma_f32_16x16x32_bf16 v[12:15], a[116:119], a[36:39], v[12:15]
  ds_read_b64_tr_b16 a[148:149], v41 offset:24576
  v_mfma_f32_16x16x32_bf16 v[12:15], a[132:135], a[44:47], v[12:15]
  ds_read_b64_tr_b16 a[150:151], v41 offset:26624
  v_mfma_f32_16x16x32_bf16 v[8:11], a[132:135], a[40:43], v[8:11]
  ds_read_b64_tr_b16 a[164:165], v41 offset:28672
  v_mfma_f32_16x16x32_bf16 v[8:11], a[116:119], a[32:35], v[8:11]
  s_waitcnt lgkmcnt(11)
  ds_read_b64_tr_b16 a[166:167], v41 offset:30720
  v_add_u32 v41, 32768, v41
  v_mfma_f32_16x16x32_bf16 v[16:19], a[120:123], a[32:35], v[16:19]
  ds_read_b64_tr_b16 a[152:153], v42 offset:24576
  v_mfma_f32_16x16x32_bf16 v[16:19], a[136:139], a[40:43], v[16:19]
  ds_read_b64_tr_b16 a[154:155], v42 offset:26624
  v_mfma_f32_16x16x32_bf16 v[20:23], a[136:139], a[44:47], v[20:23]
  ds_read_b64_tr_b16 a[168:169], v42 offset:28672
  v_mfma_f32_16x16x32_bf16 v[20:23], a[120:123], a[36:39], v[20:23]
  s_waitcnt lgkmcnt(11)
  ds_read_b64_tr_b16 a[170:171], v42 offset:30720
  v_add_u32 v42, 32768, v42
  v_mfma_f32_16x16x32_bf16 v[28:31], a[124:127], a[36:39], v[28:31]
  ds_read_b64_tr_b16 a[156:157], v43 offset:24576
  v_mfma_f32_16x16x32_bf16 v[28:31], a[140:143], a[44:47], v[28:31]
  ds_read_b64_tr_b16 a[158:159], v43 offset:26624
  v_mfma_f32_16x16x32_bf16 v[24:27], a[140:143], a[40:43], v[24:27]
  ds_read_b64_tr_b16 a[172:173], v43 offset:28672
  v_mfma_f32_16x16x32_bf16 v[24:27], a[124:127], a[32:35], v[24:27]
  s_waitcnt vmcnt(0) lgkmcnt(11)
  ds_read_b64_tr_b16 a[174:175], v43 offset:30720
  v_add_u32 v43, 32768, v43
  v_mfma_f32_16x16x32_bf16 v[0:3], a[144:147], a[48:51], v[0:3]
  v_mfma_f32_16x16x32_bf16 v[0:3], a[160:163], a[56:59], v[0:3]
  v_mfma_f32_16x16x32_bf16 v[4:7], a[160:163], a[60:63], v[4:7]
  v_mfma_f32_16x16x32_bf16 v[4:7], a[144:147], a[52:55], v[4:7]
  s_waitcnt lgkmcnt(8)
  v_mfma_f32_16x16x32_bf16 v[12:15], a[148:151], a[52:55], v[12:15]
  v_mfma_f32_16x16x32_bf16 v[12:15], a[164:167], a[60:63], v[12:15]
  v_mfma_f32_16x16x32_bf16 v[8:11], a[164:167], a[56:59], v[8:11]
  v_mfma_f32_16x16x32_bf16 v[8:11], a[148:151], a[48:51], v[8:11]
  s_waitcnt lgkmcnt(4)
  v_mfma_f32_16x16x32_bf16 v[16:19], a[152:155], a[48:51], v[16:19]
  v_mfma_f32_16x16x32_bf16 v[16:19], a[168:171], a[56:59], v[16:19]
  v_mfma_f32_16x16x32_bf16 v[20:23], a[168:171], a[60:63], v[20:23]
  v_mfma_f32_16x16x32_bf16 v[20:23], a[152:155], a[52:55], v[20:23]
  s_waitcnt lgkmcnt(0)
  v_mfma_f32_16x16x32_bf16 v[28:31], a[156:159], a[52:55], v[28:31]
  v_mfma_f32_16x16x32_bf16 v[28:31], a[172:175], a[60:63], v[28:31]
  v_mfma_f32_16x16x32_bf16 v[24:27], a[172:175], a[56:59], v[24:27]
  v_mfma_f32_16x16x32_bf16 v[24:27], a[156:159], a[48:51], v[24:27]
  s_add_u32 s46, s59, 4194304
  s_add_u32 s47, s46, 32768
  s_lshl_b32 s48, s58, 11
  s_lshl_b32 s43, s53, 7
  s_add_u32 s48, s48, s43
  s_add_u32 s48, s48, s42
  s_add_u32 s48, s48, 27525120
  s_nop 0
  v_cvt_pk_bf16_f32 v52, v0, v1
  v_cvt_pk_bf16_f32 v53, v2, v3
  v_cvt_pk_bf16_f32 v54, v8, v9
  v_cvt_pk_bf16_f32 v55, v10, v11
  buffer_store_dwordx4 v[52:55], v48, s[4:7], s46 offen offset:0 sc1
  v_cvt_pk_bf16_f32 v60, v4, v5
  v_cvt_pk_bf16_f32 v61, v6, v7
  v_cvt_pk_bf16_f32 v62, v12, v13
  v_cvt_pk_bf16_f32 v63, v14, v15
  buffer_store_dwordx4 v[60:63], v48, s[4:7], s47 offen offset:0 sc1
  v_cvt_pk_bf16_f32 v56, v16, v17
  v_cvt_pk_bf16_f32 v57, v18, v19
  v_cvt_pk_bf16_f32 v58, v24, v25
  v_cvt_pk_bf16_f32 v59, v26, v27
  buffer_store_dwordx4 v[56:59], v48, s[4:7], s46 offen offset:1024 sc1
  v_cvt_pk_bf16_f32 v64, v20, v21
  v_cvt_pk_bf16_f32 v65, v22, v23
  v_cvt_pk_bf16_f32 v66, v28, v29
  v_cvt_pk_bf16_f32 v67, v30, v31
  buffer_store_dwordx4 v[64:67], v48, s[4:7], s47 offen offset:1024 sc1
  v_mov_b32 v72, 0x3f803f80
  v_mov_b32 v73, 0x3f803f80
  v_mov_b32 v74, 0x3f803f80
  v_mov_b32 v75, 0x3f803f80
  v_and_b32 v92, 15, v253
  v_lshrrev_b32 v93, 4, v253
  v_mfma_f32_16x16x32_bf16 v[76:79], v[72:75], v[52:55], 0
  v_mfma_f32_16x16x32_bf16 v[80:83], v[52:55], v[52:55], 0
  v_mfma_f32_16x16x32_bf16 v[84:87], v[72:75], v[60:63], 0
  v_mfma_f32_16x16x32_bf16 v[88:91], v[60:63], v[60:63], 0
  v_mfma_f32_16x16x32_bf16 v[76:79], v[72:75], v[56:59], v[76:79]
  v_mfma_f32_16x16x32_bf16 v[80:83], v[56:59], v[56:59], v[80:83]
  v_mfma_f32_16x16x32_bf16 v[84:87], v[72:75], v[64:67], v[84:87]
  v_mfma_f32_16x16x32_bf16 v[88:91], v[64:67], v[64:67], v[88:91]
  v_lshrrev_b32 v72, 2, v92
  v_cmp_eq_u32 s[64:65], v72, v93
  v_and_b32 v72, 3, v92
  v_cmp_eq_u32 s[66:67], 1, v72
  v_cmp_eq_u32 s[68:69], 2, v72
  v_cmp_eq_u32 s[70:71], 3, v72
  v_lshlrev_b32 v92, 3, v92
  v_mov_b32 v93, 0x7ffffff0
  s_nop 0
  v_cndmask_b32 v92, v93, v92, s[64:65]
  v_cndmask_b32 v77, v80, v81, s[66:67]
  v_cndmask_b32 v77, v77, v82, s[68:69]
  v_cndmask_b32 v77, v77, v83, s[70:71]
  buffer_store_dwordx2 v[76:77], v92, s[4:7], s48 offen offset:0 sc1
  v_cndmask_b32 v85, v88, v89, s[66:67]
  v_cndmask_b32 v85, v85, v90, s[68:69]
  v_cndmask_b32 v85, v85, v91, s[70:71]
  buffer_store_dwordx2 v[84:85], v92, s[4:7], s48 offen offset:2048 sc1
  s_lshr_b32 s77, s52, 1
  s_lshl_b32 s77, s77, 7
  s_add_u32 s77, s77, s42
  s_add_u32 s77, s77, 27791360
  s_and_b32 s66, s55, 1
  v_lshrrev_b32 v2, 4, v253
  v_bfe_u32 v3, v253, 1, 3
  v_and_b32 v4, 1, v253
  v_lshlrev_b32 v4, 4, v4
  v_mul_u32_u24 v5, 7168, v2
  v_add_u32 v5, v5, v4
  s_cmp_eq_u32 s66, 0
  s_cselect_b32 s44, 7, 0
  v_mov_b32 v7, 0x40000000
  v_add_u32 v6, 0, v2
  v_xor_b32 v6, v6, v3
  v_cmp_eq_u32 vcc, s44, v6
  v_lshl_add_u32 v6, v6, 5, v5
  v_add_u32 v6, 0, v6
  v_cndmask_b32 v232, v6, v7, vcc
  v_add_u32 v6, 4, v2
  v_xor_b32 v6, v6, v3
  v_cmp_eq_u32 vcc, s44, v6
  v_lshl_add_u32 v6, v6, 5, v5
  v_add_u32 v6, 27648, v6
  v_cndmask_b32 v233, v6, v7, vcc
  v_add_u32 v6, 0, v2
  v_xor_b32 v6, v6, v3
  v_cmp_eq_u32 vcc, s44, v6
  v_lshl_add_u32 v6, v6, 5, v5
  v_add_u32 v6, 55296, v6
  v_cndmask_b32 v234, v6, v7, vcc
  v_add_u32 v6, 4, v2
  v_xor_b32 v6, v6, v3
  v_cmp_eq_u32 vcc, s44, v6
  v_lshl_add_u32 v6, v6, 5, v5
  v_add_u32 v6, 82944, v6
  v_cndmask_b32 v235, v6, v7, vcc
  s_mul_i32 s67, s55, 224
  s_and_b32 s67, s67, 0xffffffc0
  s_mul_i32 s43, s40, 114688
  s_add_u32 s67, s67, s43
  s_lshl_b32 s68, s40, 12
  v_lshlrev_b32 v231, 4, v253
  s_lshl_b32 s43, s41, 30
  v_or_b32 v236, s43, v231
  s_lshl_b32 s43, s2, 2
  s_add_u32 s43, s43, s40
  s_mul_i32 s70, s43, 7168
  s_lshl_b32 s69, s54, 2
  s_add_u32 s69, s69, s40
  s_lshl_b32 s72, s69, 17
  s_add_u32 s72, s72, s42
  s_add_u32 s72, s72, 4194304
  s_add_u32 s73, s72, 32768
  s_add_u32 s74, s73, 32768
  s_add_u32 s75, s74, 32768
  s_lshl_b32 s71, s40, 11
  s_add_u32 s71, s71, 131072
  v_lshrrev_b32 v2, 2, v253
  v_and_b32 v3, 7, v2
  v_and_b32 v4, 3, v253
  v_lshlrev_b32 v5, 3, v4
  v_lshl_add_u32 v5, v2, 8, v5
  s_lshl_b32 s43, s66, 1
  s_cmp_eq_u32 s66, 0
  s_cselect_b32 s45, 6, 1
  s_add_u32 s46, s43, 0
  v_xor_b32 v6, s46, v3
  v_lshl_add_u32 v224, v6, 5, v5
  s_add_u32 s46, s43, 1
  v_xor_b32 v6, s46, v3
  v_lshl_add_u32 v225, v6, 5, v5
  s_add_u32 s46, s43, 2
  v_xor_b32 v6, s46, v3
  v_lshl_add_u32 v226, v6, 5, v5
  s_add_u32 s46, s43, 3
  v_xor_b32 v6, s46, v3
  v_lshl_add_u32 v227, v6, 5, v5
  s_add_u32 s46, s43, 4
  v_xor_b32 v6, s46, v3
  v_lshl_add_u32 v228, v6, 5, v5
  s_add_u32 s46, s43, 5
  v_xor_b32 v6, s46, v3
  v_lshl_add_u32 v229, v6, 5, v5
  v_xor_b32 v6, s45, v3
  v_lshl_add_u32 v230, v6, 5, v5
  s_mul_i32 s46, s55, 448
  s_add_u32 s46, s46, 27918336
  s_add_u32 s47, s46, 28672
  s_lshr_b32 s48, s55, 3
  s_lshl_b32 s48, s48, 7
  s_add_u32 s48, s48, 27794432
  s_lshl_b32 s44, s69, 13
  s_add_u32 s44, s44, s42
  s_add_u32 s44, s44, 27525120
  s_add_u32 s45, s44, 4096
  s_waitcnt vmcnt(0)
  s_barrier
  s_cmp_lg_u32 s40, 0
  s_cbranch_scc1 Lsig11
  v_mov_b32 v250, 1
  s_mov_b64 exec, 1
  buffer_atomic_add v250, v251, s[4:7], s77 offen sc1
  s_mov_b64 exec, -1
Lsig11:
  s_cmp_eq_u32 s3, 0
  s_cbranch_scc1 Lsd12
  s_bfe_u32 s43, s2, 0x20001
  s_lshl_b32 s43, s43, 7
  s_add_u32 s43, s43, 27794432
  v_mov_b32 v250, 1
  s_mov_b64 exec, 1
  buffer_atomic_add v250, v251, s[4:7], s43 offen sc1
  s_mov_b64 exec, -1
Lsd12:
  s_add_u32 m0, s68, 0
  s_nop 0
  buffer_load_dwordx4 v232, s[16:19], s67 offen offset:0  lds
  buffer_load_dwordx4 v233, s[16:19], s67 offen offset:1024  lds
  buffer_load_dwordx4 v234, s[16:19], s67 offen offset:2048  lds
  buffer_load_dwordx4 v235, s[16:19], s67 offen offset:3072  lds
  s_add_u32 m0, s68, 16384
  s_nop 0
  buffer_load_dwordx4 v232, s[20:23], s67 offen offset:0  lds
  buffer_load_dwordx4 v233, s[20:23], s67 offen offset:1024  lds
  buffer_load_dwordx4 v234, s[20:23], s67 offen offset:2048  lds
  buffer_load_dwordx4 v235, s[20:23], s67 offen offset:3072  lds
  s_add_u32 s67, s67, 458752
  s_add_u32 m0, s68, 32768
  s_nop 0
  buffer_load_dwordx4 v232, s[16:19], s67 offen offset:0  lds
  buffer_load_dwordx4 v233, s[16:19], s67 offen offset:1024  lds
  buffer_load_dwordx4 v234, s[16:19], s67 offen offset:2048  lds
  buffer_load_dwordx4 v235, s[16:19], s67 offen offset:3072  lds
  s_add_u32 m0, s68, 49152
  s_nop 0
  buffer_load_dwordx4 v232, s[20:23], s67 offen offset:0  lds
  buffer_load_dwordx4 v233, s[20:23], s67 offen offset:1024  lds
  buffer_load_dwordx4 v234, s[20:23], s67 offen offset:2048  lds
  buffer_load_dwordx4 v235, s[20:23], s67 offen offset:3072  lds
  s_add_u32 s67, s67, 458752
  s_xor_b32 s68, s68, 0x10000
  s_lshl_b32 s77, s54, 7
  s_add_u32 s77, s77, s42
  s_add_u32 s77, s77, 27791360
  s_cmp_lg_u32 s40, 0
  s_cbranch_scc1 Lpdn14
  s_mov_b32 s43, 0x40000
  s_mov_b64 exec, 1
Lpol13:
  buffer_load_dword v250, v251, s[4:7], s77 offen sc1
  s_waitcnt vmcnt(0)
  v_cmp_gt_u32 vcc, 32, v250
  s_cbranch_vccz Lpdn14
  s_sub_u32 s43, s43, 1
  s_cmp_lg_u32 s43, 0
  s_cbranch_scc1 Lpol13
Lpdn14:
  s_mov_b64 exec, -1
  s_waitcnt vmcnt(0) lgkmcnt(0)
  s_barrier
  buffer_load_dwordx4 a[0:3], v231, s[4:7], s72 offen offset:0 sc1
  buffer_load_dwordx4 a[16:19], v231, s[4:7], s72 offen offset:1024 sc1
  buffer_load_dwordx4 a[4:7], v231, s[4:7], s73 offen offset:0 sc1
  buffer_load_dwordx4 a[20:23], v231, s[4:7], s73 offen offset:1024 sc1
  buffer_load_dwordx4 a[8:11], v231, s[4:7], s74 offen offset:0 sc1
  buffer_load_dwordx4 a[24:27], v231, s[4:7], s74 offen offset:1024 sc1
  buffer_load_dwordx4 a[12:15], v231, s[4:7], s75 offen offset:0 sc1
  buffer_load_dwordx4 a[28:31], v231, s[4:7], s75 offen offset:1024 sc1
  ds_read_b64_tr_b16 a[64:65], v224 offset:0
  ds_read_b64_tr_b16 a[66:67], v224 offset:4096
  ds_read_b64_tr_b16 a[68:69], v224 offset:8192
  ds_read_b64_tr_b16 a[70:71], v224 offset:12288
  ds_read_b64_tr_b16 a[72:73], v224 offset:16384
  ds_read_b64_tr_b16 a[74:75], v224 offset:20480
  ds_read_b64_tr_b16 a[76:77], v224 offset:24576
  ds_read_b64_tr_b16 a[78:79], v224 offset:28672
Lmk_p3s0:
  s_waitcnt vmcnt(6) lgkmcnt(4)
  v_mfma_f32_16x16x32_bf16 v[0:3], a[64:67], a[0:3], 0
  ds_read_b64_tr_b16 a[80:81], v225 offset:0
  v_mfma_f32_16x16x32_bf16 v[0:3], a[68:71], a[16:19], v[0:3]
  s_waitcnt vmcnt(4)
  v_mfma_f32_16x16x32_bf16 v[4:7], a[68:71], a[20:23], 0
  ds_read_b64_tr_b16 a[82:83], v225 offset:4096
  v_mfma_f32_16x16x32_bf16 v[4:7], a[64:67], a[4:7], v[4:7]
  s_waitcnt vmcnt(2)
  v_mfma_f32_16x16x32_bf16 v[8:11], a[64:67], a[8:11], 0
  ds_read_b64_tr_b16 a[84:85], v225 offset:8192
  v_mfma_f32_16x16x32_bf16 v[8:11], a[68:71], a[24:27], v[8:11]
  s_waitcnt vmcnt(0)
  v_mfma_f32_16x16x32_bf16 v[12:15], a[68:71], a[28:31], 0
  ds_read_b64_tr_b16 a[86:87], v225 offset:12288
  v_mfma_f32_16x16x32_bf16 v[12:15], a[64:67], a[12:15], v[12:15]
  s_waitcnt lgkmcnt(4)
  v_mfma_f32_16x16x32_bf16 v[28:31], a[72:75], a[12:15], 0
  ds_read_b64_tr_b16 a[88:89], v225 offset:16384
  v_mfma_f32_16x16x32_bf16 v[28:31], a[76:79], a[28:31], v[28:31]
  buffer_load_dwordx4 a[32:35], v231, s[4:7], s72 offen offset:2048 sc1
  v_mfma_f32_16x16x32_bf16 v[24:27], a[76:79], a[24:27], 0
  ds_read_b64_tr_b16 a[90:91], v225 offset:20480
  v_mfma_f32_16x16x32_bf16 v[24:27], a[72:75], a[8:11], v[24:27]
  v_mfma_f32_16x16x32_bf16 v[20:23], a[72:75], a[4:7], 0
  ds_read_b64_tr_b16 a[92:93], v225 offset:24576
  v_mfma_f32_16x16x32_bf16 v[20:23], a[76:79], a[20:23], v[20:23]
  buffer_load_dwordx4 a[48:51], v231, s[4:7], s72 offen offset:3072 sc1
  v_mfma_f32_16x16x32_bf16 v[16:19], a[76:79], a[16:19], 0
  ds_read_b64_tr_b16 a[94:95], v225 offset:28672
  s_add_u32 s72, s72, 4096
  v_mfma_f32_16x16x32_bf16 v[16:19], a[72:75], a[0:3], v[16:19]
  s_waitcnt lgkmcnt(4)
  v_mfma_f32_16x16x32_bf16 v[32:35], a[80:83], a[0:3], 0
  ds_read_b64_tr_b16 a[64:65], v226 offset:0
  v_mfma_f32_16x16x32_bf16 v[32:35], a[84:87], a[16:19], v[32:35]
  buffer_load_dwordx4 a[36:39], v231, s[4:7], s73 offen offset:2048 sc1
  v_mfma_f32_16x16x32_bf16 v[36:39], a[84:87], a[20:23], 0
  ds_read_b64_tr_b16 a[66:67], v226 offset:4096
  v_mfma_f32_16x16x32_bf16 v[36:39], a[80:83], a[4:7], v[36:39]
  v_mfma_f32_16x16x32_bf16 v[40:43], a[80:83], a[8:11], 0
  ds_read_b64_tr_b16 a[68:69], v226 offset:8192
  v_mfma_f32_16x16x32_bf16 v[40:43], a[84:87], a[24:27], v[40:43]
  buffer_load_dwordx4 a[52:55], v231, s[4:7], s73 offen offset:3072 sc1
  v_mfma_f32_16x16x32_bf16 v[44:47], a[84:87], a[28:31], 0
  ds_read_b64_tr_b16 a[70:71], v226 offset:12288
  s_add_u32 s73, s73, 4096
  v_mfma_f32_16x16x32_bf16 v[44:47], a[80:83], a[12:15], v[44:47]
  s_waitcnt lgkmcnt(4)
  v_mfma_f32_16x16x32_bf16 v[60:63], a[88:91], a[12:15], 0
  ds_read_b64_tr_b16 a[72:73], v226 offset:16384
  v_mfma_f32_16x16x32_bf16 v[60:63], a[92:95], a[28:31], v[60:63]
  buffer_load_dwordx4 a[40:43], v231, s[4:7], s74 offen offset:2048 sc1
  v_mfma_f32_16x16x32_bf16 v[56:59], a[92:95], a[24:27], 0
  ds_read_b64_tr_b16 a[74:75], v226 offset:20480
  v_mfma_f32_16x16x32_bf16 v[56:59], a[88:91], a[8:11], v[56:59]
  v_mfma_f32_16x16x32_bf16 v[52:55], a[88:91], a[4:7], 0
  ds_read_b64_tr_b16 a[76:77], v226 offset:24576
  v_mfma_f32_16x16x32_bf16 v[52:55], a[92:95], a[20:23], v[52:55]
  buffer_load_dwordx4 a[56:59], v231, s[4:7], s74 offen offset:3072 sc1
  v_mfma_f32_16x16x32_bf16 v[48:51], a[92:95], a[16:19], 0
  ds_read_b64_tr_b16 a[78:79], v226 offset:28672
  s_add_u32 s74, s74, 4096
  v_mfma_f32_16x16x32_bf16 v[48:51], a[88:91], a[0:3], v[48:51]
  s_waitcnt lgkmcnt(4)
  v_mfma_f32_16x16x32_bf16 v[64:67], a[64:67], a[0:3], 0
  ds_read_b64_tr_b16 a[80:81], v227 offset:0
  v_mfma_f32_16x16x32_bf16 v[64:67], a[68:71], a[16:19], v[64:67]
  buffer_load_dwordx4 a[44:47], v231, s[4:7], s75 offen offset:2048 sc1
  v_mfma_f32_16x16x32_bf16 v[68:71], a[68:71], a[20:23], 0
  ds_read_b64_tr_b16 a[82:83], v227 offset:4096
  v_mfma_f32_16x16x32_bf16 v[68:71], a[64:67], a[4:7], v[68:71]
  v_mfma_f32_16x16x32_bf16 v[72:75], a[64:67], a[8:11], 0
  ds_read_b64_tr_b16 a[84:85], v227 offset:8192
  v_mfma_f32_16x16x32_bf16 v[72:75], a[68:71], a[24:27], v[72:75]
  buffer_load_dwordx4 a[60:63], v231, s[4:7], s75 offen offset:3072 sc1
  v_mfma_f32_16x16x32_bf16 v[76:79], a[68:71], a[28:31], 0
  ds_read_b64_tr_b16 a[86:87], v227 offset:12288
  s_add_u32 s75, s75, 4096
  v_mfma_f32_16x16x32_bf16 v[76:79], a[64:67], a[12:15], v[76:79]
  s_waitcnt lgkmcnt(4)
  v_mfma_f32_16x16x32_bf16 v[92:95], a[72:75], a[12:15], 0
  ds_read_b64_tr_b16 a[88:89], v227 offset:16384
  s_add_u32 m0, s68, 32768
  v_mfma_f32_16x16x32_bf16 v[92:95], a[76:79], a[28:31], v[92:95]
  buffer_load_dwordx4 v231, s[4:7], s44 offen offset:0 sc1 lds
  v_mfma_f32_16x16x32_bf16 v[88:91], a[76:79], a[24:27], 0
  ds_read_b64_tr_b16 a[90:91], v227 offset:20480
  v_mfma_f32_16x16x32_bf16 v[88:91], a[72:75], a[8:11], v[88:91]
  v_mfma_f32_16x16x32_bf16 v[84:87], a[72:75], a[4:7], 0
  ds_read_b64_tr_b16 a[92:93], v227 offset:24576
  v_mfma_f32_16x16x32_bf16 v[84:87], a[76:79], a[20:23], v[84:87]
  buffer_load_dwordx4 v231, s[4:7], s44 offen offset:1024 sc1 lds
  v_mfma_f32_16x16x32_bf16 v[80:83], a[76:79], a[16:19], 0
  ds_read_b64_tr_b16 a[94:95], v227 offset:28672
  v_mfma_f32_16x16x32_bf16 v[80:83], a[72:75], a[0:3], v[80:83]
  s_waitcnt lgkmcnt(4)
  v_mfma_f32_16x16x32_bf16 v[96:99], a[80:83], a[0:3], 0
  ds_read_b64_tr_b16 a[64:65], v228 offset:0
  v_mfma_f32_16x16x32_bf16 v[96:99], a[84:87], a[16:19], v[96:99]
  buffer_load_dwordx4 v231, s[4:7], s44 offen offset:2048 sc1 lds
  v_mfma_f32_16x16x32_bf16 v[100:103], a[84:87], a[20:23], 0
  ds_read_b64_tr_b16 a[66:67], v228 offset:4096
  v_mfma_f32_16x16x32_bf16 v[100:103], a[80:83], a[4:7], v[100:103]
  v_mfma_f32_16x16x32_bf16 v[104:107], a[80:83], a[8:11], 0
  ds_read_b64_tr_b16 a[68:69], v228 offset:8192
  v_mfma_f32_16x16x32_bf16 v[104:107], a[84:87], a[24:27], v[104:107]
  buffer_load_dwordx4 v231, s[4:7], s44 offen offset:3072 sc1 lds
  v_mfma_f32_16x16x32_bf16 v[108:111], a[84:87], a[28:31], 0
  ds_read_b64_tr_b16 a[70:71], v228 offset:12288
  v_mfma_f32_16x16x32_bf16 v[108:111], a[80:83], a[12:15], v[108:111]
  s_waitcnt lgkmcnt(4)
  v_mfma_f32_16x16x32_bf16 v[124:127], a[88:91], a[12:15], 0
  ds_read_b64_tr_b16 a[72:73], v228 offset:16384
  s_add_u32 m0, s68, 49152
  v_mfma_f32_16x16x32_bf16 v[124:127], a[92:95], a[28:31], v[124:127]
  buffer_load_dwordx4 v231, s[4:7], s45 offen offset:0 sc1 lds
  v_mfma_f32_16x16x32_bf16 v[120:123], a[92:95], a[24:27], 0
  ds_read_b64_tr_b16 a[74:75], v228 offset:20480
  v_mfma_f32_16x16x32_bf16 v[120:123], a[88:91], a[8:11], v[120:123]
  v_mfma_f32_16x16x32_bf16 v[116:119], a[88:91], a[4:7], 0
  ds_read_b64_tr_b16 a[76:77], v228 offset:24576
  v_mfma_f32_16x16x32_bf16 v[116:119], a[92:95], a[20:23], v[116:119]
  buffer_load_dwordx4 v231, s[4:7], s45 offen offset:1024 sc1 lds
  v_mfma_f32_16x16x32_bf16 v[112:115], a[92:95], a[16:19], 0
  ds_read_b64_tr_b16 a[78:79], v228 offset:28672
  v_mfma_f32_16x16x32_bf16 v[112:115], a[88:91], a[0:3], v[112:115]
  s_waitcnt lgkmcnt(4)
  v_mfma_f32_16x16x32_bf16 v[128:131], a[64:67], a[0:3], 0
  ds_read_b64_tr_b16 a[80:81], v229 offset:0
  v_mfma_f32_16x16x32_bf16 v[128:131], a[68:71], a[16:19], v[128:131]
  buffer_load_dwordx4 v231, s[4:7], s45 offen offset:2048 sc1 lds
  v_mfma_f32_16x16x32_bf16 v[132:135], a[68:71], a[20:23], 0
  ds_read_b64_tr_b16 a[82:83], v229 offset:4096
  v_mfma_f32_16x16x32_bf16 v[132:135], a[64:67], a[4:7], v[132:135]
  v_mfma_f32_16x16x32_bf16 v[136:139], a[64:67], a[8:11], 0
  ds_read_b64_tr_b16 a[84:85], v229 offset:8192
  v_mfma_f32_16x16x32_bf16 v[136:139], a[68:71], a[24:27], v[136:139]
  buffer_load_dwordx4 v231, s[4:7], s45 offen offset:3072 sc1 lds
  v_mfma_f32_16x16x32_bf16 v[140:143], a[68:71], a[28:31], 0
  ds_read_b64_tr_b16 a[86:87], v229 offset:12288
  v_mfma_f32_16x16x32_bf16 v[140:143], a[64:67], a[12:15], v[140:143]
  s_waitcnt lgkmcnt(4)
  v_mfma_f32_16x16x32_bf16 v[156:159], a[72:75], a[12:15], 0
  ds_read_b64_tr_b16 a[88:89], v229 offset:16384
  v_mfma_f32_16x16x32_bf16 v[156:159], a[76:79], a[28:31], v[156:159]
  v_mfma_f32_16x16x32_bf16 v[152:155], a[76:79], a[24:27], 0
  ds_read_b64_tr_b16 a[90:91], v229 offset:20480
  s_add_u32 m0, s68, 0
  v_mfma_f32_16x16x32_bf16 v[152:155], a[72:75], a[8:11], v[152:155]
  buffer_load_dwordx4 v232, s[16:19], s67 offen offset:0  lds
  v_mfma_f32_16x16x32_bf16 v[148:151], a[72:75], a[4:7], 0
  ds_read_b64_tr_b16 a[92:93], v229 offset:24576
  v_mfma_f32_16x16x32_bf16 v[148:151], a[76:79], a[20:23], v[148:151]
  v_mfma_f32_16x16x32_bf16 v[144:147], a[76:79], a[16:19], 0
  ds_read_b64_tr_b16 a[94:95], v229 offset:28672
  v_mfma_f32_16x16x32_bf16 v[144:147], a[72:75], a[0:3], v[144:147]
  buffer_load_dwordx4 v233, s[16:19], s67 offen offset:1024  lds
  s_waitcnt lgkmcnt(4)
  v_mfma_f32_16x16x32_bf16 v[160:163], a[80:83], a[0:3], 0
  ds_read_b64_tr_b16 a[64:65], v230 offset:0
  v_mfma_f32_16x16x32_bf16 v[160:163], a[84:87], a[16:19], v[160:163]
  v_mfma_f32_16x16x32_bf16 v[164:167], a[84:87], a[20:23], 0
  ds_read_b64_tr_b16 a[66:67], v230 offset:4096
  v_mfma_f32_16x16x32_bf16 v[164:167], a[80:83], a[4:7], v[164:167]
  buffer_load_dwordx4 v234, s[16:19], s67 offen offset:2048  lds
  v_mfma_f32_16x16x32_bf16 v[168:171], a[80:83], a[8:11], 0
  ds_read_b64_tr_b16 a[68:69], v230 offset:8192
  v_mfma_f32_16x16x32_bf16 v[168:171], a[84:87], a[24:27], v[168:171]
  v_mfma_f32_16x16x32_bf16 v[172:175], a[84:87], a[28:31], 0
  ds_read_b64_tr_b16 a[70:71], v230 offset:12288
  v_mfma_f32_16x16x32_bf16 v[172:175], a[80:83], a[12:15], v[172:175]
  buffer_load_dwordx4 v235, s[16:19], s67 offen offset:3072  lds
  s_waitcnt lgkmcnt(4)
  v_mfma_f32_16x16x32_bf16 v[188:191], a[88:91], a[12:15], 0
  ds_read_b64_tr_b16 a[72:73], v230 offset:16384
  v_mfma_f32_16x16x32_bf16 v[188:191], a[92:95], a[28:31], v[188:191]
  v_mfma_f32_16x16x32_bf16 v[184:187], a[92:95], a[24:27], 0
  ds_read_b64_tr_b16 a[74:75], v230 offset:20480
  s_add_u32 m0, s68, 16384
  v_mfma_f32_16x16x32_bf16 v[184:187], a[88:91], a[8:11], v[184:187]
  buffer_load_dwordx4 v232, s[20:23], s67 offen offset:0  lds
  v_mfma_f32_16x16x32_bf16 v[180:183], a[88:91], a[4:7], 0
  ds_read_b64_tr_b16 a[76:77], v230 offset:24576
  v_mfma_f32_16x16x32_bf16 v[180:183], a[92:95], a[20:23], v[180:183]
  v_mfma_f32_16x16x32_bf16 v[176:179], a[92:95], a[16:19], 0
  ds_read_b64_tr_b16 a[78:79], v230 offset:28672
  v_mfma_f32_16x16x32_bf16 v[176:179], a[88:91], a[0:3], v[176:179]
  buffer_load_dwordx4 v233, s[20:23], s67 offen offset:1024  lds
  s_waitcnt lgkmcnt(4)
  v_mfma_f32_16x16x32_bf16 v[192:195], a[64:67], a[0:3], 0
  s_barrier
  ds_read_b64_tr_b16 a[80:81], v224 offset:32768
  v_mfma_f32_16x16x32_bf16 v[192:195], a[68:71], a[16:19], v[192:195]
  v_mfma_f32_16x16x32_bf16 v[196:199], a[68:71], a[20:23], 0
  ds_read_b64_tr_b16 a[82:83], v224 offset:36864
  v_mfma_f32_16x16x32_bf16 v[196:199], a[64:67], a[4:7], v[196:199]
  buffer_load_dwordx4 v234, s[20:23], s67 offen offset:2048  lds
  v_mfma_f32_16x16x32_bf16 v[200:203], a[64:67], a[8:11], 0
  ds_read_b64_tr_b16 a[84:85], v224 offset:40960
  v_mfma_f32_16x16x32_bf16 v[200:203], a[68:71], a[24:27], v[200:203]
  v_mfma_f32_16x16x32_bf16 v[204:207], a[68:71], a[28:31], 0
  ds_read_b64_tr_b16 a[86:87], v224 offset:45056
  v_mfma_f32_16x16x32_bf16 v[204:207], a[64:67], a[12:15], v[204:207]
  buffer_load_dwordx4 v235, s[20:23], s67 offen offset:3072  lds
  s_waitcnt lgkmcnt(4)
  v_mfma_f32_16x16x32_bf16 v[220:223], a[72:75], a[12:15], 0
  ds_read_b64_tr_b16 a[88:89], v224 offset:49152
  s_add_u32 s67, s67, 458752
  v_mfma_f32_16x16x32_bf16 v[220:223], a[76:79], a[28:31], v[220:223]
  v_mfma_f32_16x16x32_bf16 v[216:219], a[76:79], a[24:27], 0
  ds_read_b64_tr_b16 a[90:91], v224 offset:53248
  v_mfma_f32_16x16x32_bf16 v[216:219], a[72:75], a[8:11], v[216:219]
  v_mfma_f32_16x16x32_bf16 v[212:215], a[72:75], a[4:7], 0
  ds_read_b64_tr_b16 a[92:93], v224 offset:57344
  buffer_load_dwordx4 a[96:99], v236, s[24:27], s70 offen
  v_mfma_f32_16x16x32_bf16 v[212:215], a[76:79], a[20:23], v[212:215]
  s_add_u32 s70, s70, 1024
  v_mfma_f32_16x16x32_bf16 v[208:211], a[76:79], a[16:19], 0
  ds_read_b64_tr_b16 a[94:95], v224 offset:61440
  v_xor_b32 v224, 0x10000, v224
  v_mfma_f32_16x16x32_bf16 v[208:211], a[72:75], a[0:3], v[208:211]
Lmk_p3s1:
  s_waitcnt vmcnt(17) lgkmcnt(4)
  v_mfma_f32_16x16x32_bf16 v[0:3], a[80:83], a[32:35], v[0:3]
  ds_read_b64_tr_b16 a[64:65], v225 offset:32768
  v_mfma_f32_16x16x32_bf16 v[0:3], a[84:87], a[48:51], v[0:3]
  v_mfma_f32_16x16x32_bf16 v[4:7], a[84:87], a[52:55], v[4:7]
  ds_read_b64_tr_b16 a[66:67], v225 offset:36864
  v_mfma_f32_16x16x32_bf16 v[4:7], a[80:83], a[36:39], v[4:7]
  buffer_load_dwordx4 a[0:3], v231, s[4:7], s72 offen offset:0 sc1
  v_mfma_f32_16x16x32_bf16 v[8:11], a[80:83], a[40:43], v[8:11]
  ds_read_b64_tr_b16 a[68:69], v225 offset:40960
  v_mfma_f32_16x16x32_bf16 v[8:11], a[84:87], a[56:59], v[8:11]
  s_add_u32 s43, s68, 32768
  v_lshlrev_b32 v250, 3, v253
  v_mfma_f32_16x16x32_bf16 v[12:15], a[84:87], a[60:63], v[12:15]
  ds_read_b64_tr_b16 a[70:71], v225 offset:45056
  v_add_u32 v250, s43, v250
  v_mfma_f32_16x16x32_bf16 v[12:15], a[80:83], a[44:47], v[12:15]
  s_waitcnt lgkmcnt(4)
  v_mfma_f32_16x16x32_bf16 v[28:31], a[88:91], a[44:47], v[28:31]
  ds_read_b64_tr_b16 a[72:73], v225 offset:49152
  v_mfma_f32_16x16x32_bf16 v[28:31], a[92:95], a[60:63], v[28:31]
  v_mfma_f32_16x16x32_bf16 v[24:27], a[92:95], a[56:59], v[24:27]
  ds_read_b64_tr_b16 a[74:75], v225 offset:53248
  buffer_load_dwordx4 a[16:19], v231, s[4:7], s72 offen offset:1024 sc1
  v_mfma_f32_16x16x32_bf16 v[24:27], a[88:91], a[40:43], v[24:27]
  v_mfma_f32_16x16x32_bf16 v[20:23], a[88:91], a[36:39], v[20:23]
  ds_read_b64_tr_b16 a[76:77], v225 offset:57344
  v_mfma_f32_16x16x32_bf16 v[20:23], a[92:95], a[52:55], v[20:23]
  s_waitcnt vmcnt(11)
  ds_read_b64 v[238:239], v250 offset:0
  v_mfma_f32_16x16x32_bf16 v[16:19], a[92:95], a[48:51], v[16:19]
  ds_read_b64_tr_b16 a[78:79], v225 offset:61440
  ds_read_b64 v[240:241], v250 offset:2048
  v_xor_b32 v225, 0x10000, v225
  v_mfma_f32_16x16x32_bf16 v[16:19], a[88:91], a[32:35], v[16:19]
  ds_read_b64 v[242:243], v250 offset:16384
  s_waitcnt lgkmcnt(7)
  v_mfma_f32_16x16x32_bf16 v[32:35], a[64:67], a[32:35], v[32:35]
  ds_read_b64_tr_b16 a[80:81], v226 offset:32768
  ds_read_b64 v[244:245], v250 offset:18432
  v_mfma_f32_16x16x32_bf16 v[32:35], a[68:71], a[48:51], v[32:35]
  buffer_load_dwordx4 a[4:7], v231, s[4:7], s73 offen offset:0 sc1
  ds_read_b64 v[246:247], v250 offset:512
  v_mfma_f32_16x16x32_bf16 v[36:39], a[68:71], a[52:55], v[36:39]
  ds_read_b64_tr_b16 a[82:83], v226 offset:36864
  v_mfma_f32_16x16x32_bf16 v[36:39], a[64:67], a[36:39], v[36:39]
  v_mfma_f32_16x16x32_bf16 v[40:43], a[64:67], a[40:43], v[40:43]
  ds_read_b64_tr_b16 a[84:85], v226 offset:40960
  ds_read_b64 v[248:249], v250 offset:2560
  v_mfma_f32_16x16x32_bf16 v[40:43], a[68:71], a[56:59], v[40:43]
  v_mfma_f32_16x16x32_bf16 v[44:47], a[68:71], a[60:63], v[44:47]
  s_waitcnt lgkmcnt(3)
  ds_read_b64_tr_b16 a[86:87], v226 offset:45056
  v_add_f32 v238, v238, v246
  v_add_f32 v239, v239, v247
  v_mfma_f32_16x16x32_bf16 v[44:47], a[64:67], a[44:47], v[44:47]
  ds_read_b64 v[246:247], v250 offset:16896
  v_mfma_f32_16x16x32_bf16 v[60:63], a[72:75], a[44:47], v[60:63]
  ds_read_b64_tr_b16 a[88:89], v226 offset:49152
  buffer_load_dwordx4 a[20:23], v231, s[4:7], s73 offen offset:1024 sc1
  v_mfma_f32_16x16x32_bf16 v[60:63], a[76:79], a[60:63], v[60:63]
  s_waitcnt lgkmcnt(3)
  v_add_f32 v240, v240, v248
  v_add_f32 v241, v241, v249
  v_mfma_f32_16x16x32_bf16 v[56:59], a[76:79], a[56:59], v[56:59]
  ds_read_b64_tr_b16 a[90:91], v226 offset:53248
  ds_read_b64 v[248:249], v250 offset:18944
  v_mfma_f32_16x16x32_bf16 v[56:59], a[72:75], a[40:43], v[56:59]
  v_mfma_f32_16x16x32_bf16 v[52:55], a[72:75], a[36:39], v[52:55]
  s_waitcnt lgkmcnt(3)
  ds_read_b64_tr_b16 a[92:93], v226 offset:57344
  v_add_f32 v242, v242, v246
  v_add_f32 v243, v243, v247
  v_mfma_f32_16x16x32_bf16 v[52:55], a[76:79], a[52:55], v[52:55]
  ds_read_b64 v[246:247], v250 offset:1024
  v_mfma_f32_16x16x32_bf16 v[48:51], a[76:79], a[48:51], v[48:51]
  ds_read_b64_tr_b16 a[94:95], v226 offset:61440
  v_xor_b32 v226, 0x10000, v226
  v_mfma_f32_16x16x32_bf16 v[48:51], a[72:75], a[32:35], v[48:51]
  s_waitcnt lgkmcnt(3)
  buffer_load_dwordx4 a[8:11], v231, s[4:7], s74 offen offset:0 sc1
  v_add_f32 v244, v244, v248
  v_add_f32 v245, v245, v249
  v_mfma_f32_16x16x32_bf16 v[64:67], a[80:83], a[32:35], v[64:67]
  ds_read_b64_tr_b16 a[64:65], v227 offset:32768
  ds_read_b64 v[248:249], v250 offset:3072
  v_mfma_f32_16x16x32_bf16 v[64:67], a[84:87], a[48:51], v[64:67]
  v_mfma_f32_16x16x32_bf16 v[68:71], a[84:87], a[52:55], v[68:71]
  s_waitcnt lgkmcnt(3)
  ds_read_b64_tr_b16 a[66:67], v227 offset:36864
  v_add_f32 v238, v238, v246
  v_add_f32 v239, v239, v247
  v_mfma_f32_16x16x32_bf16 v[68:71], a[80:83], a[36:39], v[68:71]
  ds_read_b64 v[246:247], v250 offset:17408
  v_mfma_f32_16x16x32_bf16 v[72:75], a[80:83], a[40:43], v[72:75]
  ds_read_b64_tr_b16 a[68:69], v227 offset:40960
  v_mfma_f32_16x16x32_bf16 v[72:75], a[84:87], a[56:59], v[72:75]
  s_waitcnt lgkmcnt(3)
  v_add_f32 v240, v240, v248
  v_add_f32 v241, v241, v249
  v_mfma_f32_16x16x32_bf16 v[76:79], a[84:87], a[60:63], v[76:79]
  ds_read_b64_tr_b16 a[70:71], v227 offset:45056
  buffer_load_dwordx4 a[24:27], v231, s[4:7], s74 offen offset:1024 sc1
  ds_read_b64 v[248:249], v250 offset:19456
  v_mfma_f32_16x16x32_bf16 v[76:79], a[80:83], a[44:47], v[76:79]
  v_mfma_f32_16x16x32_bf16 v[92:95], a[88:91], a[44:47], v[92:95]
  s_waitcnt lgkmcnt(3)
  ds_read_b64_tr_b16 a[72:73], v227 offset:49152
  v_add_f32 v242, v242, v246
  v_add_f32 v243, v243, v247
  v_mfma_f32_16x16x32_bf16 v[92:95], a[92:95], a[60:63], v[92:95]
  ds_read_b64 v[246:247], v250 offset:1536
  v_mfma_f32_16x16x32_bf16 v[88:91], a[92:95], a[56:59], v[88:91]
  ds_read_b64_tr_b16 a[74:75], v227 offset:53248
  v_mfma_f32_16x16x32_bf16 v[88:91], a[88:91], a[40:43], v[88:91]
  s_waitcnt lgkmcnt(3)
  v_add_f32 v244, v244, v248
  v_add_f32 v245, v245, v249
  v_mfma_f32_16x16x32_bf16 v[84:87], a[88:91], a[36:39], v[84:87]
  ds_read_b64_tr_b16 a[76:77], v227 offset:57344
  ds_read_b64 v[248:249], v250 offset:3584
  v_mfma_f32_16x16x32_bf16 v[84:87], a[92:95], a[52:55], v[84:87]
  buffer_load_dwordx4 a[12:15], v231, s[4:7], s75 offen offset:0 sc1
  v_mfma_f32_16x16x32_bf16 v[80:83], a[92:95], a[48:51], v[80:83]
  s_waitcnt lgkmcnt(3)
  ds_read_b64_tr_b16 a[78:79], v227 offset:61440
  v_xor_b32 v227, 0x10000, v227
  v_add_f32 v238, v238, v246
  v_add_f32 v239, v239, v247
  v_mfma_f32_16x16x32_bf16 v[80:83], a[88:91], a[32:35], v[80:83]
  ds_read_b64 v[246:247], v250 offset:17920
  buffer_load_dword v237, v251, s[4:7], s48 offen sc1
  v_mfma_f32_16x16x32_bf16 v[96:99], a[64:67], a[32:35], v[96:99]
  ds_read_b64_tr_b16 a[80:81], v228 offset:32768
  v_mfma_f32_16x16x32_bf16 v[96:99], a[68:71], a[48:51], v[96:99]
  s_waitcnt lgkmcnt(3)
  v_add_f32 v240, v240, v248
  v_add_f32 v241, v241, v249
  v_mfma_f32_16x16x32_bf16 v[100:103], a[68:71], a[52:55], v[100:103]
  ds_read_b64_tr_b16 a[82:83], v228 offset:36864
  ds_read_b64 v[248:249], v250 offset:19968
  v_mfma_f32_16x16x32_bf16 v[100:103], a[64:67], a[36:39], v[100:103]
  v_mfma_f32_16x16x32_bf16 v[104:107], a[64:67], a[40:43], v[104:107]
  s_waitcnt lgkmcnt(3)
  ds_read_b64_tr_b16 a[84:85], v228 offset:40960
  buffer_load_dwordx4 a[28:31], v231, s[4:7], s75 offen offset:1024 sc1
  v_add_f32 v242, v242, v246
  v_add_f32 v243, v243, v247
  v_mfma_f32_16x16x32_bf16 v[104:107], a[68:71], a[56:59], v[104:107]
  buffer_load_dwordx4 a[96:99], v236, s[24:27], s70 offen
  v_mfma_f32_16x16x32_bf16 v[108:111], a[68:71], a[60:63], v[108:111]
  ds_read_b64_tr_b16 a[86:87], v228 offset:45056
  s_add_u32 s70, s70, 1024
  v_mfma_f32_16x16x32_bf16 v[108:111], a[64:67], a[44:47], v[108:111]
  s_waitcnt lgkmcnt(2)
  v_add_f32 v244, v244, v248
  v_add_f32 v245, v245, v249
  v_mfma_f32_16x16x32_bf16 v[124:127], a[72:75], a[44:47], v[124:127]
  ds_read_b64_tr_b16 a[88:89], v228 offset:49152
  s_mov_b32 s43, 0x3a800000
  v_mfma_f32_16x16x32_bf16 v[124:127], a[76:79], a[60:63], v[124:127]
  v_mov_b32 v250, 0x3727c5ac
  v_lshlrev_b32 v246, 2, v253
  v_mfma_f32_16x16x32_bf16 v[120:123], a[76:79], a[56:59], v[120:123]
  ds_read_b64_tr_b16 a[90:91], v228 offset:53248
  s_add_u32 m0, s68, 32768
  v_mfma_f32_16x16x32_bf16 v[120:123], a[72:75], a[40:43], v[120:123]
  buffer_load_dwordx4 v232, s[16:19], s67 offen offset:0  lds
  v_add_u32 v246, s71, v246
  v_mfma_f32_16x16x32_bf16 v[116:119], a[72:75], a[36:39], v[116:119]
  ds_read_b64_tr_b16 a[92:93], v228 offset:57344
  v_permlane32_swap_b32 v238, v242
  v_mfma_f32_16x16x32_bf16 v[116:119], a[76:79], a[52:55], v[116:119]
  v_permlane32_swap_b32 v239, v243
  v_permlane32_swap_b32 v240, v244
  v_mfma_f32_16x16x32_bf16 v[112:115], a[76:79], a[48:51], v[112:115]
  ds_read_b64_tr_b16 a[94:95], v228 offset:61440
  v_xor_b32 v228, 0x10000, v228
  v_permlane32_swap_b32 v241, v245
  v_mfma_f32_16x16x32_bf16 v[112:115], a[72:75], a[32:35], v[112:115]
  s_waitcnt lgkmcnt(4)
  v_add_f32 v238, v238, v242
  v_add_f32 v240, v240, v244
  v_mfma_f32_16x16x32_bf16 v[128:131], a[80:83], a[32:35], v[128:131]
  ds_read_b64_tr_b16 a[64:65], v229 offset:32768
  v_add_f32 v239, v239, v243
  v_mfma_f32_16x16x32_bf16 v[128:131], a[84:87], a[48:51], v[128:131]
  v_add_f32 v241, v241, v245
  v_and_b32 v247, 0xffffff3f, v246
  v_mfma_f32_16x16x32_bf16 v[132:135], a[84:87], a[52:55], v[132:135]
  ds_read_b64_tr_b16 a[66:67], v229 offset:36864
  buffer_load_dwordx4 v233, s[16:19], s67 offen offset:1024  lds
  v_mfma_f32_16x16x32_bf16 v[132:135], a[80:83], a[36:39], v[132:135]
  v_permlane16_swap_b32 v238, v240
  v_permlane16_swap_b32 v239, v241
  v_mfma_f32_16x16x32_bf16 v[136:139], a[80:83], a[40:43], v[136:139]
  ds_read_b64_tr_b16 a[68:69], v229 offset:40960
  v_add_f32 v238, v238, v240
  v_mfma_f32_16x16x32_bf16 v[136:139], a[84:87], a[56:59], v[136:139]
  v_add_f32 v239, v239, v241
  v_add_u32 v247, 1024, v247
  v_mfma_f32_16x16x32_bf16 v[140:143], a[84:87], a[60:63], v[140:143]
  ds_read_b64_tr_b16 a[70:71], v229 offset:45056
  v_mul_f32 v238, 0xba800000, v238
  v_mfma_f32_16x16x32_bf16 v[140:143], a[80:83], a[44:47], v[140:143]
  s_waitcnt lgkmcnt(4)
  v_fma_f32 v239, v239, s43, v250
  v_fma_f32 v239, -v238, v238, v239
  v_mfma_f32_16x16x32_bf16 v[156:159], a[88:91], a[44:47], v[156:159]
  ds_read_b64_tr_b16 a[72:73], v229 offset:49152
  v_max_f32 v239, v239, v250
  v_mfma_f32_16x16x32_bf16 v[156:159], a[92:95], a[60:63], v[156:159]
  buffer_load_dwordx4 v234, s[16:19], s67 offen offset:2048  lds
  v_rsq_f32 v240, v239
  v_mfma_f32_16x16x32_bf16 v[152:155], a[92:95], a[56:59], v[152:155]
  ds_read_b64_tr_b16 a[74:75], v229 offset:53248
  ds_write_b32 v246, v238 offset:1024
  v_mfma_f32_16x16x32_bf16 v[152:155], a[88:91], a[40:43], v[152:155]
  ds_write_b32 v246, v239 offset:1536
  v_mul_f32 v240, 0xbfb8aa3b, v240
  v_mfma_f32_16x16x32_bf16 v[148:151], a[88:91], a[36:39], v[148:151]
  ds_read_b64_tr_b16 a[76:77], v229 offset:57344
  ds_write_b32 v246, v240 offset:1280
  v_mfma_f32_16x16x32_bf16 v[148:151], a[92:95], a[52:55], v[148:151]
  ds_read2_b32 v[238:239], v247 offset0:0 offset1:16
  ds_read2_b32 v[240:241], v247 offset0:32 offset1:48
  v_mfma_f32_16x16x32_bf16 v[144:147], a[92:95], a[48:51], v[144:147]
  ds_read_b64_tr_b16 a[78:79], v229 offset:61440
  v_xor_b32 v229, 0x10000, v229
  v_lshrrev_b32 v250, 3, v253
  v_mfma_f32_16x16x32_bf16 v[144:147], a[88:91], a[32:35], v[144:147]
  s_waitcnt lgkmcnt(9)
  v_add_u32 v250, s66, v250
  v_cmp_ne_u32 vcc, 7, v250
  v_mfma_f32_16x16x32_bf16 v[160:163], a[64:67], a[32:35], v[160:163]
  ds_read_b64_tr_b16 a[80:81], v230 offset:32768
  buffer_load_dwordx4 v235, s[16:19], s67 offen offset:3072  lds
  v_mfma_f32_16x16x32_bf16 v[160:163], a[68:71], a[48:51], v[160:163]
  v_bfe_u32 v242, v253, 2, 1
  v_mul_u32_u24 v242, 14336, v242
  v_mfma_f32_16x16x32_bf16 v[164:167], a[68:71], a[52:55], v[164:167]
  ds_read_b64_tr_b16 a[82:83], v230 offset:36864
  v_cndmask_b32 v250, 0, v250, vcc
  v_mfma_f32_16x16x32_bf16 v[164:167], a[64:67], a[36:39], v[164:167]
  v_lshl_add_u32 v250, v250, 6, v242
  v_and_b32 v242, 3, v253
  v_mfma_f32_16x16x32_bf16 v[168:171], a[64:67], a[40:43], v[168:171]
  ds_read_b64_tr_b16 a[84:85], v230 offset:40960
  v_lshl_add_u32 v250, v242, 4, v250
  v_mfma_f32_16x16x32_bf16 v[168:171], a[68:71], a[56:59], v[168:171]
  s_waitcnt vmcnt(6)
  v_cmp_gt_u32 vcc, 56, v237
  s_cbranch_vccz Lcdn16
  s_mov_b32 s43, 0x40000
Lchk15:
  s_sleep 8
  buffer_load_dword v237, v251, s[4:7], s48 offen sc1
  s_waitcnt vmcnt(0)
  v_cmp_gt_u32 vcc, 56, v237
  s_cbranch_vccz Lcdn16
  s_sub_u32 s43, s43, 1
  s_cmp_lg_u32 s43, 0
  s_cbranch_scc1 Lchk15
Lcdn16:
  buffer_load_dwordx4 v[242:245], v250, s[4:7], s46 offen sc1
  v_mfma_f32_16x16x32_bf16 v[172:175], a[68:71], a[60:63], v[172:175]
  ds_read_b64_tr_b16 a[86:87], v230 offset:45056
  s_add_u32 m0, s68, 49152
  v_mfma_f32_16x16x32_bf16 v[172:175], a[64:67], a[44:47], v[172:175]
  s_waitcnt lgkmcnt(4)
  buffer_load_dwordx4 v232, s[20:23], s67 offen offset:0  lds
  buffer_load_dwordx4 v[246:249], v250, s[4:7], s47 offen sc1
  v_mfma_f32_16x16x32_bf16 v[188:191], a[72:75], a[44:47], v[188:191]
  ds_read_b64_tr_b16 a[88:89], v230 offset:49152
  v_lshrrev_b32 v237, 4, v253
  v_mfma_f32_16x16x32_bf16 v[188:191], a[76:79], a[60:63], v[188:191]
  v_lshlrev_b32 v237, 4, v237
  v_add_u32 v237, s71, v237
  v_mfma_f32_16x16x32_bf16 v[184:187], a[76:79], a[56:59], v[184:187]
  ds_read_b64_tr_b16 a[90:91], v230 offset:53248
  v_add_u32 v250, s71, v231
  v_mfma_f32_16x16x32_bf16 v[184:187], a[72:75], a[40:43], v[184:187]
  v_mfma_f32_16x16x32_bf16 v[180:183], a[72:75], a[36:39], v[180:183]
  ds_read_b64_tr_b16 a[92:93], v230 offset:57344
  v_mfma_f32_16x16x32_bf16 v[180:183], a[76:79], a[52:55], v[180:183]
  v_mfma_f32_16x16x32_bf16 v[176:179], a[76:79], a[48:51], v[176:179]
  ds_read_b64_tr_b16 a[94:95], v230 offset:61440
  buffer_load_dwordx4 v233, s[20:23], s67 offen offset:1024  lds
  v_xor_b32 v230, 0x10000, v230
  v_mfma_f32_16x16x32_bf16 v[176:179], a[72:75], a[32:35], v[176:179]
  s_waitcnt lgkmcnt(4)
  v_mfma_f32_16x16x32_bf16 v[192:195], a[80:83], a[32:35], v[192:195]
  s_barrier
  ds_read_b64_tr_b16 a[64:65], v224 offset:0
  v_mfma_f32_16x16x32_bf16 v[192:195], a[84:87], a[48:51], v[192:195]
  v_mfma_f32_16x16x32_bf16 v[196:199], a[84:87], a[52:55], v[196:199]
  ds_read_b64_tr_b16 a[66:67], v224 offset:4096
  v_mfma_f32_16x16x32_bf16 v[196:199], a[80:83], a[36:39], v[196:199]
  v_mfma_f32_16x16x32_bf16 v[200:203], a[80:83], a[40:43], v[200:203]
  ds_read_b64_tr_b16 a[68:69], v224 offset:8192
  v_mfma_f32_16x16x32_bf16 v[200:203], a[84:87], a[56:59], v[200:203]
  buffer_load_dwordx4 v234, s[20:23], s67 offen offset:2048  lds
  v_mfma_f32_16x16x32_bf16 v[204:207], a[84:87], a[60:63], v[204:207]
  ds_read_b64_tr_b16 a[70:71], v224 offset:12288
  v_mfma_f32_16x16x32_bf16 v[204:207], a[80:83], a[44:47], v[204:207]
  s_waitcnt lgkmcnt(4)
  v_mfma_f32_16x16x32_bf16 v[220:223], a[88:91], a[44:47], v[220:223]
  ds_read_b64_tr_b16 a[72:73], v224 offset:16384
  v_mfma_f32_16x16x32_bf16 v[220:223], a[92:95], a[60:63], v[220:223]
  v_mfma_f32_16x16x32_bf16 v[216:219], a[92:95], a[56:59], v[216:219]
  ds_read_b64_tr_b16 a[74:75], v224 offset:20480
  v_mfma_f32_16x16x32_bf16 v[216:219], a[88:91], a[40:43], v[216:219]
  v_mfma_f32_16x16x32_bf16 v[212:215], a[88:91], a[36:39], v[212:215]
  ds_read_b64_tr_b16 a[76:77], v224 offset:24576
  buffer_load_dwordx4 v235, s[20:23], s67 offen offset:3072  lds
  v_mfma_f32_16x16x32_bf16 v[212:215], a[92:95], a[52:55], v[212:215]
  s_add_u32 s67, s67, 458752
  s_xor_b32 s68, s68, 0x10000
  v_mfma_f32_16x16x32_bf16 v[208:211], a[92:95], a[48:51], v[208:211]
  ds_read_b64_tr_b16 a[78:79], v224 offset:28672
  v_mfma_f32_16x16x32_bf16 v[208:211], a[88:91], a[32:35], v[208:211]
  s_mov_b32 s56, 5
.p2align 3
Lp3_loop:
  s_waitcnt vmcnt(8) lgkmcnt(4)
  v_mfma_f32_16x16x32_bf16 v[0:3], a[64:67], a[0:3], v[0:3]
  ds_read_b64_tr_b16 a[80:81], v225 offset:0
  v_mfma_f32_16x16x32_bf16 v[0:3], a[68:71], a[16:19], v[0:3]
  v_mfma_f32_16x16x32_bf16 v[4:7], a[68:71], a[20:23], v[4:7]
  ds_read_b64_tr_b16 a[82:83], v225 offset:4096
  v_mfma_f32_16x16x32_bf16 v[4:7], a[64:67], a[4:7], v[4:7]
  buffer_load_dwordx4 a[32:35], v231, s[4:7], s72 offen offset:2048 sc1
  v_mfma_f32_16x16x32_bf16 v[8:11], a[64:67], a[8:11], v[8:11]
  ds_read_b64_tr_b16 a[84:85], v225 offset:8192
  v_mfma_f32_16x16x32_bf16 v[8:11], a[68:71], a[24:27], v[8:11]
  v_mfma_f32_16x16x32_bf16 v[12:15], a[68:71], a[28:31], v[12:15]
  ds_read_b64_tr_b16 a[86:87], v225 offset:12288
  v_mfma_f32_16x16x32_bf16 v[12:15], a[64:67], a[12:15], v[12:15]
  s_waitcnt lgkmcnt(4)
  v_mfma_f32_16x16x32_bf16 v[28:31], a[72:75], a[12:15], v[28:31]
  ds_read_b64_tr_b16 a[88:89], v225 offset:16384
  v_mfma_f32_16x16x32_bf16 v[28:31], a[76:79], a[28:31], v[28:31]
  v_mfma_f32_16x16x32_bf16 v[24:27], a[76:79], a[24:27], v[24:27]
  ds_read_b64_tr_b16 a[90:91], v225 offset:20480
  buffer_load_dwordx4 a[48:51], v231, s[4:7], s72 offen offset:3072 sc1
  v_mfma_f32_16x16x32_bf16 v[24:27], a[72:75], a[8:11], v[24:27]
  s_add_u32 s72, s72, 4096
  v_mfma_f32_16x16x32_bf16 v[20:23], a[72:75], a[4:7], v[20:23]
  ds_read_b64_tr_b16 a[92:93], v225 offset:24576
  v_mfma_f32_16x16x32_bf16 v[20:23], a[76:79], a[20:23], v[20:23]
  v_mfma_f32_16x16x32_bf16 v[16:19], a[76:79], a[16:19], v[16:19]
  ds_read_b64_tr_b16 a[94:95], v225 offset:28672
  v_mfma_f32_16x16x32_bf16 v[16:19], a[72:75], a[0:3], v[16:19]
  s_waitcnt lgkmcnt(4)
  v_mfma_f32_16x16x32_bf16 v[32:35], a[80:83], a[0:3], v[32:35]
  ds_read_b64_tr_b16 a[64:65], v226 offset:0
  v_mfma_f32_16x16x32_bf16 v[32:35], a[84:87], a[16:19], v[32:35]
  buffer_load_dwordx4 a[36:39], v231, s[4:7], s73 offen offset:2048 sc1
  v_mfma_f32_16x16x32_bf16 v[36:39], a[84:87], a[20:23], v[36:39]
  ds_read_b64_tr_b16 a[66:67], v226 offset:4096
  v_mfma_f32_16x16x32_bf16 v[36:39], a[80:83], a[4:7], v[36:39]
  v_mfma_f32_16x16x32_bf16 v[40:43], a[80:83], a[8:11], v[40:43]
  ds_read_b64_tr_b16 a[68:69], v226 offset:8192
  v_mfma_f32_16x16x32_bf16 v[40:43], a[84:87], a[24:27], v[40:43]
  v_mfma_f32_16x16x32_bf16 v[44:47], a[84:87], a[28:31], v[44:47]
  ds_read_b64_tr_b16 a[70:71], v226 offset:12288
  v_mfma_f32_16x16x32_bf16 v[44:47], a[80:83], a[12:15], v[44:47]
  s_waitcnt lgkmcnt(4)
  v_mfma_f32_16x16x32_bf16 v[60:63], a[88:91], a[12:15], v[60:63]
  ds_read_b64_tr_b16 a[72:73], v226 offset:16384
  buffer_load_dwordx4 a[52:55], v231, s[4:7], s73 offen offset:3072 sc1
  v_mfma_f32_16x16x32_bf16 v[60:63], a[92:95], a[28:31], v[60:63]
  s_add_u32 s73, s73, 4096
  v_mfma_f32_16x16x32_bf16 v[56:59], a[92:95], a[24:27], v[56:59]
  ds_read_b64_tr_b16 a[74:75], v226 offset:20480
  v_mfma_f32_16x16x32_bf16 v[56:59], a[88:91], a[8:11], v[56:59]
  v_mfma_f32_16x16x32_bf16 v[52:55], a[88:91], a[4:7], v[52:55]
  ds_read_b64_tr_b16 a[76:77], v226 offset:24576
  v_mfma_f32_16x16x32_bf16 v[52:55], a[92:95], a[20:23], v[52:55]
  v_mfma_f32_16x16x32_bf16 v[48:51], a[92:95], a[16:19], v[48:51]
  ds_read_b64_tr_b16 a[78:79], v226 offset:28672
  v_mfma_f32_16x16x32_bf16 v[48:51], a[88:91], a[0:3], v[48:51]
  buffer_load_dwordx4 a[40:43], v231, s[4:7], s74 offen offset:2048 sc1
  s_waitcnt lgkmcnt(4)
  v_mfma_f32_16x16x32_bf16 v[64:67], a[64:67], a[0:3], v[64:67]
  ds_read_b64_tr_b16 a[80:81], v227 offset:0
  v_mfma_f32_16x16x32_bf16 v[64:67], a[68:71], a[16:19], v[64:67]
  v_mfma_f32_16x16x32_bf16 v[68:71], a[68:71], a[20:23], v[68:71]
  ds_read_b64_tr_b16 a[82:83], v227 offset:4096
  v_mfma_f32_16x16x32_bf16 v[68:71], a[64:67], a[4:7], v[68:71]
  v_mfma_f32_16x16x32_bf16 v[72:75], a[64:67], a[8:11], v[72:75]
  ds_read_b64_tr_b16 a[84:85], v227 offset:8192
  v_mfma_f32_16x16x32_bf16 v[72:75], a[68:71], a[24:27], v[72:75]
  v_mfma_f32_16x16x32_bf16 v[76:79], a[68:71], a[28:31], v[76:79]
  ds_read_b64_tr_b16 a[86:87], v227 offset:12288
  buffer_load_dwordx4 a[56:59], v231, s[4:7], s74 offen offset:3072 sc1
  v_mfma_f32_16x16x32_bf16 v[76:79], a[64:67], a[12:15], v[76:79]
  s_add_u32 s74, s74, 4096
  s_waitcnt lgkmcnt(4)
  v_mfma_f32_16x16x32_bf16 v[92:95], a[72:75], a[12:15], v[92:95]
  ds_read_b64_tr_b16 a[88:89], v227 offset:16384
  v_mfma_f32_16x16x32_bf16 v[92:95], a[76:79], a[28:31], v[92:95]
  v_mfma_f32_16x16x32_bf16 v[88:91], a[76:79], a[24:27], v[88:91]
  ds_read_b64_tr_b16 a[90:91], v227 offset:20480
  v_mfma_f32_16x16x32_bf16 v[88:91], a[72:75], a[8:11], v[88:91]
  v_mfma_f32_16x16x32_bf16 v[84:87], a[72:75], a[4:7], v[84:87]
  ds_read_b64_tr_b16 a[92:93], v227 offset:24576
  v_mfma_f32_16x16x32_bf16 v[84:87], a[76:79], a[20:23], v[84:87]
  buffer_load_dwordx4 a[44:47], v231, s[4:7], s75 offen offset:2048 sc1
  v_mfma_f32_16x16x32_bf16 v[80:83], a[76:79], a[16:19], v[80:83]
  ds_read_b64_tr_b16 a[94:95], v227 offset:28672
  v_mfma_f32_16x16x32_bf16 v[80:83], a[72:75], a[0:3], v[80:83]
  s_waitcnt lgkmcnt(4)
  v_mfma_f32_16x16x32_bf16 v[96:99], a[80:83], a[0:3], v[96:99]
  ds_read_b64_tr_b16 a[64:65], v228 offset:0
  v_mfma_f32_16x16x32_bf16 v[96:99], a[84:87], a[16:19], v[96:99]
  v_mfma_f32_16x16x32_bf16 v[100:103], a[84:87], a[20:23], v[100:103]
  ds_read_b64_tr_b16 a[66:67], v228 offset:4096
  v_mfma_f32_16x16x32_bf16 v[100:103], a[80:83], a[4:7], v[100:103]
  v_mfma_f32_16x16x32_bf16 v[104:107], a[80:83], a[8:11], v[104:107]
  ds_read_b64_tr_b16 a[68:69], v228 offset:8192
  buffer_load_dwordx4 a[60:63], v231, s[4:7], s75 offen offset:3072 sc1
  v_mfma_f32_16x16x32_bf16 v[104:107], a[84:87], a[24:27], v[104:107]
  s_add_u32 s75, s75, 4096
  buffer_load_dwordx4 a[96:99], v236, s[24:27], s70 offen
  v_mfma_f32_16x16x32_bf16 v[108:111], a[84:87], a[28:31], v[108:111]
  ds_read_b64_tr_b16 a[70:71], v228 offset:12288
  s_add_u32 s70, s70, 1024
  v_mfma_f32_16x16x32_bf16 v[108:111], a[80:83], a[12:15], v[108:111]
  s_waitcnt lgkmcnt(4)
  v_mfma_f32_16x16x32_bf16 v[124:127], a[88:91], a[12:15], v[124:127]
  ds_read_b64_tr_b16 a[72:73], v228 offset:16384
  v_mfma_f32_16x16x32_bf16 v[124:127], a[92:95], a[28:31], v[124:127]
  v_mfma_f32_16x16x32_bf16 v[120:123], a[92:95], a[24:27], v[120:123]
  ds_read_b64_tr_b16 a[74:75], v228 offset:20480
  s_add_u32 m0, s68, 0
  v_mfma_f32_16x16x32_bf16 v[120:123], a[88:91], a[8:11], v[120:123]
  buffer_load_dwordx4 v232, s[16:19], s67 offen offset:0  lds
  v_mfma_f32_16x16x32_bf16 v[116:119], a[88:91], a[4:7], v[116:119]
  ds_read_b64_tr_b16 a[76:77], v228 offset:24576
  v_mfma_f32_16x16x32_bf16 v[116:119], a[92:95], a[20:23], v[116:119]
  v_mfma_f32_16x16x32_bf16 v[112:115], a[92:95], a[16:19], v[112:115]
  ds_read_b64_tr_b16 a[78:79], v228 offset:28672
  v_mfma_f32_16x16x32_bf16 v[112:115], a[88:91], a[0:3], v[112:115]
  s_waitcnt lgkmcnt(4)
  v_mfma_f32_16x16x32_bf16 v[128:131], a[64:67], a[0:3], v[128:131]
  ds_read_b64_tr_b16 a[80:81], v229 offset:0
  v_mfma_f32_16x16x32_bf16 v[128:131], a[68:71], a[16:19], v[128:131]
  v_mfma_f32_16x16x32_bf16 v[132:135], a[68:71], a[20:23], v[132:135]
  ds_read_b64_tr_b16 a[82:83], v229 offset:4096
  buffer_load_dwordx4 v233, s[16:19], s67 offen offset:1024  lds
  v_mfma_f32_16x16x32_bf16 v[132:135], a[64:67], a[4:7], v[132:135]
  v_mfma_f32_16x16x32_bf16 v[136:139], a[64:67], a[8:11], v[136:139]
  ds_read_b64_tr_b16 a[84:85], v229 offset:8192
  v_mfma_f32_16x16x32_bf16 v[136:139], a[68:71], a[24:27], v[136:139]
  v_mfma_f32_16x16x32_bf16 v[140:143], a[68:71], a[28:31], v[140:143]
  ds_read_b64_tr_b16 a[86:87], v229 offset:12288
  v_mfma_f32_16x16x32_bf16 v[140:143], a[64:67], a[12:15], v[140:143]
  s_waitcnt lgkmcnt(4)
  v_mfma_f32_16x16x32_bf16 v[156:159], a[72:75], a[12:15], v[156:159]
  ds_read_b64_tr_b16 a[88:89], v229 offset:16384
  v_mfma_f32_16x16x32_bf16 v[156:159], a[76:79], a[28:31], v[156:159]
  buffer_load_dwordx4 v234, s[16:19], s67 offen offset:2048  lds
  v_mfma_f32_16x16x32_bf16 v[152:155], a[76:79], a[24:27], v[152:155]
  ds_read_b64_tr_b16 a[90:91], v229 offset:20480
  v_mfma_f32_16x16x32_bf16 v[152:155], a[72:75], a[8:11], v[152:155]
  v_mfma_f32_16x16x32_bf16 v[148:151], a[72:75], a[4:7], v[148:151]
  ds_read_b64_tr_b16 a[92:93], v229 offset:24576
  v_mfma_f32_16x16x32_bf16 v[148:151], a[76:79], a[20:23], v[148:151]
  v_mfma_f32_16x16x32_bf16 v[144:147], a[76:79], a[16:19], v[144:147]
  ds_read_b64_tr_b16 a[94:95], v229 offset:28672
  v_mfma_f32_16x16x32_bf16 v[144:147], a[72:75], a[0:3], v[144:147]
  s_waitcnt lgkmcnt(4)
  v_mfma_f32_16x16x32_bf16 v[160:163], a[80:83], a[0:3], v[160:163]
  ds_read_b64_tr_b16 a[64:65], v230 offset:0
  buffer_load_dwordx4 v235, s[16:19], s67 offen offset:3072  lds
  v_mfma_f32_16x16x32_bf16 v[160:163], a[84:87], a[16:19], v[160:163]
  v_mfma_f32_16x16x32_bf16 v[164:167], a[84:87], a[20:23], v[164:167]
  ds_read_b64_tr_b16 a[66:67], v230 offset:4096
  v_mfma_f32_16x16x32_bf16 v[164:167], a[80:83], a[4:7], v[164:167]
  v_mfma_f32_16x16x32_bf16 v[168:171], a[80:83], a[8:11], v[168:171]
  ds_read_b64_tr_b16 a[68:69], v230 offset:8192
  v_mfma_f32_16x16x32_bf16 v[168:171], a[84:87], a[24:27], v[168:171]
  v_mfma_f32_16x16x32_bf16 v[172:175], a[84:87], a[28:31], v[172:175]
  ds_read_b64_tr_b16 a[70:71], v230 offset:12288
  s_add_u32 m0, s68, 16384
  v_mfma_f32_16x16x32_bf16 v[172:175], a[80:83], a[12:15], v[172:175]
  buffer_load_dwordx4 v232, s[20:23], s67 offen offset:0  lds
  s_waitcnt lgkmcnt(4)
  v_mfma_f32_16x16x32_bf16 v[188:191], a[88:91], a[12:15], v[188:191]
  ds_read_b64_tr_b16 a[72:73], v230 offset:16384
  v_mfma_f32_16x16x32_bf16 v[188:191], a[92:95], a[28:31], v[188:191]
  v_mfma_f32_16x16x32_bf16 v[184:187], a[92:95], a[24:27], v[184:187]
  ds_read_b64_tr_b16 a[74:75], v230 offset:20480
  v_mfma_f32_16x16x32_bf16 v[184:187], a[88:91], a[8:11], v[184:187]
  v_mfma_f32_16x16x32_bf16 v[180:183], a[88:91], a[4:7], v[180:183]
  ds_read_b64_tr_b16 a[76:77], v230 offset:24576
  v_mfma_f32_16x16x32_bf16 v[180:183], a[92:95], a[20:23], v[180:183]
  v_mfma_f32_16x16x32_bf16 v[176:179], a[92:95], a[16:19], v[176:179]
  ds_read_b64_tr_b16 a[78:79], v230 offset:28672
  buffer_load_dwordx4 v233, s[20:23], s67 offen offset:1024  lds
  v_mfma_f32_16x16x32_bf16 v[176:179], a[88:91], a[0:3], v[176:179]
  s_waitcnt lgkmcnt(4)
  v_mfma_f32_16x16x32_bf16 v[192:195], a[64:67], a[0:3], v[192:195]
  s_waitcnt vmcnt(15)
  s_barrier
  ds_read_b64_tr_b16 a[80:81], v224 offset:32768
  v_mfma_f32_16x16x32_bf16 v[192:195], a[68:71], a[16:19], v[192:195]
  v_mfma_f32_16x16x32_bf16 v[196:199], a[68:71], a[20:23], v[196:199]
  ds_read_b64_tr_b16 a[82:83], v224 offset:36864
  v_mfma_f32_16x16x32_bf16 v[196:199], a[64:67], a[4:7], v[196:199]
  v_mfma_f32_16x16x32_bf16 v[200:203], a[64:67], a[8:11], v[200:203]
  ds_read_b64_tr_b16 a[84:85], v224 offset:40960
  v_mfma_f32_16x16x32_bf16 v[200:203], a[68:71], a[24:27], v[200:203]
  buffer_load_dwordx4 v234, s[20:23], s67 offen offset:2048  lds
  v_mfma_f32_16x16x32_bf16 v[204:207], a[68:71], a[28:31], v[204:207]
  ds_read_b64_tr_b16 a[86:87], v224 offset:45056
  v_mfma_f32_16x16x32_bf16 v[204:207], a[64:67], a[12:15], v[204:207]
  s_waitcnt lgkmcnt(4)
  v_mfma_f32_16x16x32_bf16 v[220:223], a[72:75], a[12:15], v[220:223]
  ds_read_b64_tr_b16 a[88:89], v224 offset:49152
  v_mfma_f32_16x16x32_bf16 v[220:223], a[76:79], a[28:31], v[220:223]
  v_mfma_f32_16x16x32_bf16 v[216:219], a[76:79], a[24:27], v[216:219]
  ds_read_b64_tr_b16 a[90:91], v224 offset:53248
  v_mfma_f32_16x16x32_bf16 v[216:219], a[72:75], a[8:11], v[216:219]
  v_mfma_f32_16x16x32_bf16 v[212:215], a[72:75], a[4:7], v[212:215]
  ds_read_b64_tr_b16 a[92:93], v224 offset:57344
  buffer_load_dwordx4 v235, s[20:23], s67 offen offset:3072  lds
  v_mfma_f32_16x16x32_bf16 v[212:215], a[76:79], a[20:23], v[212:215]
  s_add_u32 s67, s67, 458752
  v_mfma_f32_16x16x32_bf16 v[208:211], a[76:79], a[16:19], v[208:211]
  ds_read_b64_tr_b16 a[94:95], v224 offset:61440
  v_xor_b32 v224, 0x10000, v224
  v_mfma_f32_16x16x32_bf16 v[208:211], a[72:75], a[0:3], v[208:211]
  s_waitcnt vmcnt(9) lgkmcnt(4)
  v_mfma_f32_16x16x32_bf16 v[0:3], a[80:83], a[32:35], v[0:3]
  ds_read_b64_tr_b16 a[64:65], v225 offset:32768
  v_mfma_f32_16x16x32_bf16 v[0:3], a[84:87], a[48:51], v[0:3]
  v_mfma_f32_16x16x32_bf16 v[4:7], a[84:87], a[52:55], v[4:7]
  ds_read_b64_tr_b16 a[66:67], v225 offset:36864
  v_mfma_f32_16x16x32_bf16 v[4:7], a[80:83], a[36:39], v[4:7]
  buffer_load_dwordx4 a[0:3], v231, s[4:7], s72 offen offset:0 sc1
  v_mfma_f32_16x16x32_bf16 v[8:11], a[80:83], a[40:43], v[8:11]
  ds_read_b64_tr_b16 a[68:69], v225 offset:40960
  v_mfma_f32_16x16x32_bf16 v[8:11], a[84:87], a[56:59], v[8:11]
  v_mfma_f32_16x16x32_bf16 v[12:15], a[84:87], a[60:63], v[12:15]
  ds_read_b64_tr_b16 a[70:71], v225 offset:45056
  v_mfma_f32_16x16x32_bf16 v[12:15], a[80:83], a[44:47], v[12:15]
  s_waitcnt lgkmcnt(4)
  v_mfma_f32_16x16x32_bf16 v[28:31], a[88:91], a[44:47], v[28:31]
  ds_read_b64_tr_b16 a[72:73], v225 offset:49152
  v_mfma_f32_16x16x32_bf16 v[28:31], a[92:95], a[60:63], v[28:31]
  v_mfma_f32_16x16x32_bf16 v[24:27], a[92:95], a[56:59], v[24:27]
  ds_read_b64_tr_b16 a[74:75], v225 offset:53248
  buffer_load_dwordx4 a[16:19], v231, s[4:7], s72 offen offset:1024 sc1
  v_mfma_f32_16x16x32_bf16 v[24:27], a[88:91], a[40:43], v[24:27]
  v_mfma_f32_16x16x32_bf16 v[20:23], a[88:91], a[36:39], v[20:23]
  ds_read_b64_tr_b16 a[76:77], v225 offset:57344
  v_mfma_f32_16x16x32_bf16 v[20:23], a[92:95], a[52:55], v[20:23]
  v_mfma_f32_16x16x32_bf16 v[16:19], a[92:95], a[48:51], v[16:19]
  ds_read_b64_tr_b16 a[78:79], v225 offset:61440
  v_xor_b32 v225, 0x10000, v225
  v_mfma_f32_16x16x32_bf16 v[16:19], a[88:91], a[32:35], v[16:19]
  s_waitcnt lgkmcnt(4)
  v_mfma_f32_16x16x32_bf16 v[32:35], a[64:67], a[32:35], v[32:35]
  ds_read_b64_tr_b16 a[80:81], v226 offset:32768
  v_mfma_f32_16x16x32_bf16 v[32:35], a[68:71], a[48:51], v[32:35]
  buffer_load_dwordx4 a[4:7], v231, s[4:7], s73 offen offset:0 sc1
  v_mfma_f32_16x16x32_bf16 v[36:39], a[68:71], a[52:55], v[36:39]
  ds_read_b64_tr_b16 a[82:83], v226 offset:36864
  v_mfma_f32_16x16x32_bf16 v[36:39], a[64:67], a[36:39], v[36:39]
  v_mfma_f32_16x16x32_bf16 v[40:43], a[64:67], a[40:43], v[40:43]
  ds_read_b64_tr_b16 a[84:85], v226 offset:40960
  v_mfma_f32_16x16x32_bf16 v[40:43], a[68:71], a[56:59], v[40:43]
  v_mfma_f32_16x16x32_bf16 v[44:47], a[68:71], a[60:63], v[44:47]
  ds_read_b64_tr_b16 a[86:87], v226 offset:45056
  v_mfma_f32_16x16x32_bf16 v[44:47], a[64:67], a[44:47], v[44:47]
  s_waitcnt lgkmcnt(4)
  v_mfma_f32_16x16x32_bf16 v[60:63], a[72:75], a[44:47], v[60:63]
  ds_read_b64_tr_b16 a[88:89], v226 offset:49152
  buffer_load_dwordx4 a[20:23], v231, s[4:7], s73 offen offset:1024 sc1
  v_mfma_f32_16x16x32_bf16 v[60:63], a[76:79], a[60:63], v[60:63]
  v_mfma_f32_16x16x32_bf16 v[56:59], a[76:79], a[56:59], v[56:59]
  ds_read_b64_tr_b16 a[90:91], v226 offset:53248
  v_mfma_f32_16x16x32_bf16 v[56:59], a[72:75], a[40:43], v[56:59]
  v_mfma_f32_16x16x32_bf16 v[52:55], a[72:75], a[36:39], v[52:55]
  ds_read_b64_tr_b16 a[92:93], v226 offset:57344
  v_mfma_f32_16x16x32_bf16 v[52:55], a[76:79], a[52:55], v[52:55]
  v_mfma_f32_16x16x32_bf16 v[48:51], a[76:79], a[48:51], v[48:51]
  ds_read_b64_tr_b16 a[94:95], v226 offset:61440
  v_xor_b32 v226, 0x10000, v226
  v_mfma_f32_16x16x32_bf16 v[48:51], a[72:75], a[32:35], v[48:51]
  buffer_load_dwordx4 a[8:11], v231, s[4:7], s74 offen offset:0 sc1
  s_waitcnt lgkmcnt(4)
  v_mfma_f32_16x16x32_bf16 v[64:67], a[80:83], a[32:35], v[64:67]
  ds_read_b64_tr_b16 a[64:65], v227 offset:32768
  v_mfma_f32_16x16x32_bf16 v[64:67], a[84:87], a[48:51], v[64:67]
  v_mfma_f32_16x16x32_bf16 v[68:71], a[84:87], a[52:55], v[68:71]
  ds_read_b64_tr_b16 a[66:67], v227 offset:36864
  v_mfma_f32_16x16x32_bf16 v[68:71], a[80:83], a[36:39], v[68:71]
  v_mfma_f32_16x16x32_bf16 v[72:75], a[80:83], a[40:43], v[72:75]
  ds_read_b64_tr_b16 a[68:69], v227 offset:40960
  v_mfma_f32_16x16x32_bf16 v[72:75], a[84:87], a[56:59], v[72:75]
  v_mfma_f32_16x16x32_bf16 v[76:79], a[84:87], a[60:63], v[76:79]
  ds_read_b64_tr_b16 a[70:71], v227 offset:45056
  buffer_load_dwordx4 a[24:27], v231, s[4:7], s74 offen offset:1024 sc1
  v_mfma_f32_16x16x32_bf16 v[76:79], a[80:83], a[44:47], v[76:79]
  s_waitcnt lgkmcnt(4)
  v_mfma_f32_16x16x32_bf16 v[92:95], a[88:91], a[44:47], v[92:95]
  ds_read_b64_tr_b16 a[72:73], v227 offset:49152
  v_mfma_f32_16x16x32_bf16 v[92:95], a[92:95], a[60:63], v[92:95]
  v_mfma_f32_16x16x32_bf16 v[88:91], a[92:95], a[56:59], v[88:91]
  ds_read_b64_tr_b16 a[74:75], v227 offset:53248
  v_mfma_f32_16x16x32_bf16 v[88:91], a[88:91], a[40:43], v[88:91]
  v_mfma_f32_16x16x32_bf16 v[84:87], a[88:91], a[36:39], v[84:87]
  ds_read_b64_tr_b16 a[76:77], v227 offset:57344
  v_mfma_f32_16x16x32_bf16 v[84:87], a[92:95], a[52:55], v[84:87]
  buffer_load_dwordx4 a[12:15], v231, s[4:7], s75 offen offset:0 sc1
  v_mfma_f32_16x16x32_bf16 v[80:83], a[92:95], a[48:51], v[80:83]
  ds_read_b64_tr_b16 a[78:79], v227 offset:61440
  v_xor_b32 v227, 0x10000, v227
  v_mfma_f32_16x16x32_bf16 v[80:83], a[88:91], a[32:35], v[80:83]
  s_waitcnt lgkmcnt(4)
  v_mfma_f32_16x16x32_bf16 v[96:99], a[64:67], a[32:35], v[96:99]
  ds_read_b64_tr_b16 a[80:81], v228 offset:32768
  v_mfma_f32_16x16x32_bf16 v[96:99], a[68:71], a[48:51], v[96:99]
  v_mfma_f32_16x16x32_bf16 v[100:103], a[68:71], a[52:55], v[100:103]
  ds_read_b64_tr_b16 a[82:83], v228 offset:36864
  v_mfma_f32_16x16x32_bf16 v[100:103], a[64:67], a[36:39], v[100:103]
  v_mfma_f32_16x16x32_bf16 v[104:107], a[64:67], a[40:43], v[104:107]
  ds_read_b64_tr_b16 a[84:85], v228 offset:40960
  buffer_load_dwordx4 a[28:31], v231, s[4:7], s75 offen offset:1024 sc1
  v_mfma_f32_16x16x32_bf16 v[104:107], a[68:71], a[56:59], v[104:107]
  v_mfma_f32_16x16x32_bf16 v[108:111], a[68:71], a[60:63], v[108:111]
  ds_read_b64_tr_b16 a[86:87], v228 offset:45056
  v_mfma_f32_16x16x32_bf16 v[108:111], a[64:67], a[44:47], v[108:111]
  s_waitcnt lgkmcnt(4)
  v_mfma_f32_16x16x32_bf16 v[124:127], a[72:75], a[44:47], v[124:127]
  ds_read_b64_tr_b16 a[88:89], v228 offset:49152
  v_mfma_f32_16x16x32_bf16 v[124:127], a[76:79], a[60:63], v[124:127]
  v_mfma_f32_16x16x32_bf16 v[120:123], a[76:79], a[56:59], v[120:123]
  ds_read_b64_tr_b16 a[90:91], v228 offset:53248
  s_add_u32 m0, s68, 32768
  v_mfma_f32_16x16x32_bf16 v[120:123], a[72:75], a[40:43], v[120:123]
  buffer_load_dwordx4 v232, s[16:19], s67 offen offset:0  lds
  v_mfma_f32_16x16x32_bf16 v[116:119], a[72:75], a[36:39], v[116:119]
  ds_read_b64_tr_b16 a[92:93], v228 offset:57344
  v_mfma_f32_16x16x32_bf16 v[116:119], a[76:79], a[52:55], v[116:119]
  v_mfma_f32_16x16x32_bf16 v[112:115], a[76:79], a[48:51], v[112:115]
  ds_read_b64_tr_b16 a[94:95], v228 offset:61440
  v_xor_b32 v228, 0x10000, v228
  v_mfma_f32_16x16x32_bf16 v[112:115], a[72:75], a[32:35], v[112:115]
  s_waitcnt lgkmcnt(4)
  v_mfma_f32_16x16x32_bf16 v[128:131], a[80:83], a[32:35], v[128:131]
  ds_read_b64_tr_b16 a[64:65], v229 offset:32768
  v_mfma_f32_16x16x32_bf16 v[128:131], a[84:87], a[48:51], v[128:131]
  v_mfma_f32_16x16x32_bf16 v[132:135], a[84:87], a[52:55], v[132:135]
  ds_read_b64_tr_b16 a[66:67], v229 offset:36864
  buffer_load_dwordx4 v233, s[16:19], s67 offen offset:1024  lds
  v_mfma_f32_16x16x32_bf16 v[132:135], a[80:83], a[36:39], v[132:135]
  v_mfma_f32_16x16x32_bf16 v[136:139], a[80:83], a[40:43], v[136:139]
  ds_read_b64_tr_b16 a[68:69], v229 offset:40960
  v_mfma_f32_16x16x32_bf16 v[136:139], a[84:87], a[56:59], v[136:139]
  v_mfma_f32_16x16x32_bf16 v[140:143], a[84:87], a[60:63], v[140:143]
  ds_read_b64_tr_b16 a[70:71], v229 offset:45056
  v_mfma_f32_16x16x32_bf16 v[140:143], a[80:83], a[44:47], v[140:143]
  s_waitcnt lgkmcnt(4)
  v_mfma_f32_16x16x32_bf16 v[156:159], a[88:91], a[44:47], v[156:159]
  ds_read_b64_tr_b16 a[72:73], v229 offset:49152
  v_mfma_f32_16x16x32_bf16 v[156:159], a[92:95], a[60:63], v[156:159]
  buffer_load_dwordx4 v234, s[16:19], s67 offen offset:2048  lds
  v_mfma_f32_16x16x32_bf16 v[152:155], a[92:95], a[56:59], v[152:155]
  ds_read_b64_tr_b16 a[74:75], v229 offset:53248
  v_mfma_f32_16x16x32_bf16 v[152:155], a[88:91], a[40:43], v[152:155]
  v_mfma_f32_16x16x32_bf16 v[148:151], a[88:91], a[36:39], v[148:151]
  ds_read_b64_tr_b16 a[76:77], v229 offset:57344
  v_mfma_f32_16x16x32_bf16 v[148:151], a[92:95], a[52:55], v[148:151]
  v_mfma_f32_16x16x32_bf16 v[144:147], a[92:95], a[48:51], v[144:147]
  ds_read_b64_tr_b16 a[78:79], v229 offset:61440
  v_xor_b32 v229, 0x10000, v229
  v_mfma_f32_16x16x32_bf16 v[144:147], a[88:91], a[32:35], v[144:147]
  s_waitcnt lgkmcnt(4)
  v_mfma_f32_16x16x32_bf16 v[160:163], a[64:67], a[32:35], v[160:163]
  ds_read_b64_tr_b16 a[80:81], v230 offset:32768
  buffer_load_dwordx4 v235, s[16:19], s67 offen offset:3072  lds
  v_mfma_f32_16x16x32_bf16 v[160:163], a[68:71], a[48:51], v[160:163]
  v_mfma_f32_16x16x32_bf16 v[164:167], a[68:71], a[52:55], v[164:167]
  ds_read_b64_tr_b16 a[82:83], v230 offset:36864
  v_mfma_f32_16x16x32_bf16 v[164:167], a[64:67], a[36:39], v[164:167]
  v_mfma_f32_16x16x32_bf16 v[168:171], a[64:67], a[40:43], v[168:171]
  ds_read_b64_tr_b16 a[84:85], v230 offset:40960
  v_mfma_f32_16x16x32_bf16 v[168:171], a[68:71], a[56:59], v[168:171]
  v_mfma_f32_16x16x32_bf16 v[172:175], a[68:71], a[60:63], v[172:175]
  ds_read_b64_tr_b16 a[86:87], v230 offset:45056
  s_add_u32 m0, s68, 49152
  v_mfma_f32_16x16x32_bf16 v[172:175], a[64:67], a[44:47], v[172:175]
  buffer_load_dwordx4 v232, s[20:23], s67 offen offset:0  lds
  s_waitcnt lgkmcnt(4)
  v_mfma_f32_16x16x32_bf16 v[188:191], a[72:75], a[44:47], v[188:191]
  ds_read_b64_tr_b16 a[88:89], v230 offset:49152
  v_mfma_f32_16x16x32_bf16 v[188:191], a[76:79], a[60:63], v[188:191]
  v_mfma_f32_16x16x32_bf16 v[184:187], a[76:79], a[56:59], v[184:187]
  ds_read_b64_tr_b16 a[90:91], v230 offset:53248
  v_mfma_f32_16x16x32_bf16 v[184:187], a[72:75], a[40:43], v[184:187]
  v_mfma_f32_16x16x32_bf16 v[180:183], a[72:75], a[36:39], v[180:183]
  ds_read_b64_tr_b16 a[92:93], v230 offset:57344
  v_mfma_f32_16x16x32_bf16 v[180:183], a[76:79], a[52:55], v[180:183]
  v_mfma_f32_16x16x32_bf16 v[176:179], a[76:79], a[48:51], v[176:179]
  ds_read_b64_tr_b16 a[94:95], v230 offset:61440
  buffer_load_dwordx4 v233, s[20:23], s67 offen offset:1024  lds
  v_xor_b32 v230, 0x10000, v230
  v_mfma_f32_16x16x32_bf16 v[176:179], a[72:75], a[32:35], v[176:179]
  s_waitcnt lgkmcnt(4)
  v_mfma_f32_16x16x32_bf16 v[192:195], a[80:83], a[32:35], v[192:195]
  s_waitcnt vmcnt(14)
  s_barrier
  ds_read_b64_tr_b16 a[64:65], v224 offset:0
  v_mfma_f32_16x16x32_bf16 v[192:195], a[84:87], a[48:51], v[192:195]
  v_mfma_f32_16x16x32_bf16 v[196:199], a[84:87], a[52:55], v[196:199]
  ds_read_b64_tr_b16 a[66:67], v224 offset:4096
  v_mfma_f32_16x16x32_bf16 v[196:199], a[80:83], a[36:39], v[196:199]
  v_mfma_f32_16x16x32_bf16 v[200:203], a[80:83], a[40:43], v[200:203]
  ds_read_b64_tr_b16 a[68:69], v224 offset:8192
  v_mfma_f32_16x16x32_bf16 v[200:203], a[84:87], a[56:59], v[200:203]
  buffer_load_dwordx4 v234, s[20:23], s67 offen offset:2048  lds
  v_mfma_f32_16x16x32_bf16 v[204:207], a[84:87], a[60:63], v[204:207]
  ds_read_b64_tr_b16 a[70:71], v224 offset:12288
  v_mfma_f32_16x16x32_bf16 v[204:207], a[80:83], a[44:47], v[204:207]
  s_waitcnt lgkmcnt(4)
  v_mfma_f32_16x16x32_bf16 v[220:223], a[88:91], a[44:47], v[220:223]
  ds_read_b64_tr_b16 a[72:73], v224 offset:16384
  v_mfma_f32_16x16x32_bf16 v[220:223], a[92:95], a[60:63], v[220:223]
  v_mfma_f32_16x16x32_bf16 v[216:219], a[92:95], a[56:59], v[216:219]
  ds_read_b64_tr_b16 a[74:75], v224 offset:20480
  v_mfma_f32_16x16x32_bf16 v[216:219], a[88:91], a[40:43], v[216:219]
  v_mfma_f32_16x16x32_bf16 v[212:215], a[88:91], a[36:39], v[212:215]
  ds_read_b64_tr_b16 a[76:77], v224 offset:24576
  buffer_load_dwordx4 v235, s[20:23], s67 offen offset:3072  lds
  v_mfma_f32_16x16x32_bf16 v[212:215], a[92:95], a[52:55], v[212:215]
  s_add_u32 s67, s67, 458752
  s_xor_b32 s68, s68, 0x10000
  v_mfma_f32_16x16x32_bf16 v[208:211], a[92:95], a[48:51], v[208:211]
  ds_read_b64_tr_b16 a[78:79], v224 offset:28672
  v_mfma_f32_16x16x32_bf16 v[208:211], a[88:91], a[32:35], v[208:211]
  s_sub_u32 s56, s56, 1
  s_cmp_lg_u32 s56, 0
  s_cbranch_scc1 Lp3_loop
Lmk_Lp3_loop_tail:
  s_waitcnt vmcnt(8) lgkmcnt(4)
  v_mfma_f32_16x16x32_bf16 v[0:3], a[64:67], a[0:3], v[0:3]
  ds_read_b64_tr_b16 a[80:81], v225 offset:0
  v_add_f32 v242, v242, v246
  v_mfma_f32_16x16x32_bf16 v[0:3], a[68:71], a[16:19], v[0:3]
  v_add_f32 v243, v243, v247
  v_add_f32 v244, v244, v248
  v_mfma_f32_16x16x32_bf16 v[4:7], a[68:71], a[20:23], v[4:7]
  ds_read_b64_tr_b16 a[82:83], v225 offset:4096
  v_add_f32 v245, v245, v249
  v_mfma_f32_16x16x32_bf16 v[4:7], a[64:67], a[4:7], v[4:7]
  buffer_load_dwordx4 a[32:35], v231, s[4:7], s72 offen offset:2048 sc1
  ds_write_b128 v250, v[242:245]
  v_mfma_f32_16x16x32_bf16 v[8:11], a[64:67], a[8:11], v[8:11]
  ds_read_b64_tr_b16 a[84:85], v225 offset:8192
  v_mfma_f32_16x16x32_bf16 v[8:11], a[68:71], a[24:27], v[8:11]
  v_mfma_f32_16x16x32_bf16 v[12:15], a[68:71], a[28:31], v[12:15]
  ds_read_b64_tr_b16 a[86:87], v225 offset:12288
  v_mfma_f32_16x16x32_bf16 v[12:15], a[64:67], a[12:15], v[12:15]
  buffer_load_dwordx4 a[48:51], v231, s[4:7], s72 offen offset:3072 sc1
  s_waitcnt lgkmcnt(5)
  v_mfma_f32_16x16x32_bf16 v[28:31], a[72:75], a[12:15], v[28:31]
  s_add_u32 s72, s72, 4096
  ds_read_b64_tr_b16 a[88:89], v225 offset:16384
  v_mfma_f32_16x16x32_bf16 v[28:31], a[76:79], a[28:31], v[28:31]
  ds_read_b128 v[246:249], v237 offset:384
  v_mfma_f32_16x16x32_bf16 v[24:27], a[76:79], a[24:27], v[24:27]
  ds_read_b64_tr_b16 a[90:91], v225 offset:20480
  v_mfma_f32_16x16x32_bf16 v[24:27], a[72:75], a[8:11], v[24:27]
  v_mfma_f32_16x16x32_bf16 v[20:23], a[72:75], a[4:7], v[20:23]
  ds_read_b64_tr_b16 a[92:93], v225 offset:24576
  v_mfma_f32_16x16x32_bf16 v[20:23], a[76:79], a[20:23], v[20:23]
  buffer_load_dwordx4 a[36:39], v231, s[4:7], s73 offen offset:2048 sc1
  v_mfma_f32_16x16x32_bf16 v[16:19], a[76:79], a[16:19], v[16:19]
  ds_read_b64_tr_b16 a[94:95], v225 offset:28672
  v_mfma_f32_16x16x32_bf16 v[16:19], a[72:75], a[0:3], v[16:19]
  s_waitcnt lgkmcnt(5)
  v_mfma_f32_16x16x32_bf16 v[32:35], a[80:83], a[0:3], v[32:35]
  s_waitcnt lgkmcnt(3)
  ds_read_b64_tr_b16 a[64:65], v226 offset:0
  v_fmac_f32 v96, v246, v238
  v_mfma_f32_16x16x32_bf16 v[32:35], a[84:87], a[16:19], v[32:35]
  buffer_load_dwordx4 a[52:55], v231, s[4:7], s73 offen offset:3072 sc1
  ds_read_b128 v[242:245], v237 offset:0
  v_mfma_f32_16x16x32_bf16 v[36:39], a[84:87], a[20:23], v[36:39]
  s_add_u32 s73, s73, 4096
  ds_read_b64_tr_b16 a[66:67], v226 offset:4096
  v_fmac_f32 v97, v247, v238
  v_mfma_f32_16x16x32_bf16 v[36:39], a[80:83], a[4:7], v[36:39]
  v_fmac_f32 v98, v248, v238
  v_fmac_f32 v99, v249, v238
  v_mfma_f32_16x16x32_bf16 v[40:43], a[80:83], a[8:11], v[40:43]
  s_xor_b32 s93, s53, 1
  ds_read_b64_tr_b16 a[68:69], v226 offset:8192
  v_fmac_f32 v100, v246, v239
  v_mfma_f32_16x16x32_bf16 v[40:43], a[84:87], a[24:27], v[40:43]
  s_lshl_b32 s93, s93, 7
  v_fmac_f32 v101, v247, v239
  v_fmac_f32 v102, v248, v239
  v_mfma_f32_16x16x32_bf16 v[44:47], a[84:87], a[28:31], v[44:47]
  s_add_u32 s80, s24, s93
  s_addc_u32 s81, s25, 0
  ds_read_b64_tr_b16 a[70:71], v226 offset:12288
  v_fmac_f32 v103, v249, v239
  v_mfma_f32_16x16x32_bf16 v[44:47], a[80:83], a[12:15], v[44:47]
  s_sub_u32 s82, 7340032, s93
  buffer_load_dwordx4 a[40:43], v231, s[4:7], s74 offen offset:2048 sc1
  v_fmac_f32 v104, v246, v240
  s_waitcnt lgkmcnt(5)
  v_mfma_f32_16x16x32_bf16 v[60:63], a[88:91], a[12:15], v[60:63]
  s_mov_b32 s83, 0x20000
  ds_read_b64_tr_b16 a[72:73], v226 offset:16384
  v_fmac_f32 v105, v247, v240
  v_mfma_f32_16x16x32_bf16 v[60:63], a[92:95], a[28:31], v[60:63]
  s_lshl_b32 s93, s53, 7
  v_fmac_f32 v106, v248, v240
  v_fmac_f32 v107, v249, v240
  v_mfma_f32_16x16x32_bf16 v[56:59], a[92:95], a[24:27], v[56:59]
  s_add_u32 s84, s24, s93
  s_addc_u32 s85, s25, 0
  ds_read_b64_tr_b16 a[74:75], v226 offset:20480
  v_fmac_f32 v108, v246, v241
  v_mfma_f32_16x16x32_bf16 v[56:59], a[88:91], a[8:11], v[56:59]
  s_sub_u32 s84, s84, 1024
  s_subb_u32 s85, s85, 0
  buffer_load_dwordx4 a[56:59], v231, s[4:7], s74 offen offset:3072 sc1
  v_fmac_f32 v109, v247, v241
  v_mfma_f32_16x16x32_bf16 v[52:55], a[88:91], a[4:7], v[52:55]
  s_add_u32 s74, s74, 4096
  ds_read_b64_tr_b16 a[76:77], v226 offset:24576
  v_fmac_f32 v110, v248, v241
  v_mfma_f32_16x16x32_bf16 v[52:55], a[92:95], a[20:23], v[52:55]
  s_sub_u32 s86, 7341056, s93
  v_fmac_f32 v111, v249, v241
  v_mfma_f32_16x16x32_bf16 v[48:51], a[92:95], a[16:19], v[48:51]
  s_mov_b32 s87, 0x20000
  ds_read_b64_tr_b16 a[78:79], v226 offset:28672
  v_mfma_f32_16x16x32_bf16 v[48:51], a[88:91], a[0:3], v[48:51]
  s_and_b32 s93, s53, 1
  s_waitcnt lgkmcnt(4)
  v_mfma_f32_16x16x32_bf16 v[64:67], a[64:67], a[0:3], v[64:67]
  ds_read_b64_tr_b16 a[80:81], v227 offset:0
  v_fmac_f32 v0, v242, v238
  v_mfma_f32_16x16x32_bf16 v[64:67], a[68:71], a[16:19], v[64:67]
  s_mul_i32 s92, s93, 3670016
  buffer_load_dwordx4 a[44:47], v231, s[4:7], s75 offen offset:2048 sc1
  ds_read_b128 v[246:249], v237 offset:64
  v_mfma_f32_16x16x32_bf16 v[68:71], a[68:71], a[20:23], v[68:71]
  s_lshl_b32 s93, s40, 14
  ds_read_b64_tr_b16 a[82:83], v227 offset:4096
  v_fmac_f32 v1, v243, v238
  v_mfma_f32_16x16x32_bf16 v[68:71], a[64:67], a[4:7], v[68:71]
  s_add_u32 s92, s92, s93
  v_fmac_f32 v2, v244, v238
  v_fmac_f32 v3, v245, v238
  v_mfma_f32_16x16x32_bf16 v[72:75], a[64:67], a[8:11], v[72:75]
  s_lshl_b32 s79, s40, 11
  ds_read_b64_tr_b16 a[84:85], v227 offset:8192
  v_fmac_f32 v4, v242, v239
  v_mfma_f32_16x16x32_bf16 v[72:75], a[68:71], a[24:27], v[72:75]
  s_cmp_eq_u32 s40, 1
  s_cselect_b32 s78, 16384, 0
  buffer_load_dwordx4 a[60:63], v231, s[4:7], s75 offen offset:3072 sc1
  v_fmac_f32 v5, v243, v239
  v_mfma_f32_16x16x32_bf16 v[76:79], a[68:71], a[28:31], v[76:79]
  s_add_u32 s75, s75, 4096
  ds_read_b64_tr_b16 a[86:87], v227 offset:12288
  v_fmac_f32 v6, v244, v239
  v_mfma_f32_16x16x32_bf16 v[76:79], a[64:67], a[12:15], v[76:79]
  s_cmp_eq_u32 s40, 2
  s_cselect_b32 s78, -16384, s78
  v_fmac_f32 v7, v245, v239
  v_fmac_f32 v8, v242, v240
  s_waitcnt lgkmcnt(5)
  v_mfma_f32_16x16x32_bf16 v[92:95], a[72:75], a[12:15], v[92:95]
  s_mul_i32 s43, s69, 458752
  ds_read_b64_tr_b16 a[88:89], v227 offset:16384
  v_fmac_f32 v9, v243, v240
  v_mfma_f32_16x16x32_bf16 v[92:95], a[76:79], a[28:31], v[92:95]
  s_lshr_b32 s45, s55, 4
  v_fmac_f32 v10, v244, v240
  v_fmac_f32 v11, v245, v240
  v_mfma_f32_16x16x32_bf16 v[88:91], a[76:79], a[24:27], v[88:91]
  s_add_u32 m0, s68, 0
  ds_read_b64_tr_b16 a[90:91], v227 offset:20480
  v_fmac_f32 v12, v242, v241
  v_mfma_f32_16x16x32_bf16 v[88:91], a[72:75], a[8:11], v[88:91]
  s_mul_i32 s45, s45, 57344
  buffer_load_dwordx4 v232, s[16:19], s67 offen offset:0  lds
  v_fmac_f32 v13, v243, v241
  v_mfma_f32_16x16x32_bf16 v[84:87], a[72:75], a[4:7], v[84:87]
  s_add_u32 s43, s43, s45
  ds_read_b64_tr_b16 a[92:93], v227 offset:24576
  v_fmac_f32 v14, v244, v241
  v_mfma_f32_16x16x32_bf16 v[84:87], a[76:79], a[20:23], v[84:87]
  s_add_u32 s43, s43, 0
  v_fmac_f32 v15, v245, v241
  v_mfma_f32_16x16x32_bf16 v[80:83], a[76:79], a[16:19], v[80:83]
  s_add_u32 s43, s43, 12582912
  ds_read_b64_tr_b16 a[94:95], v227 offset:28672
  v_mfma_f32_16x16x32_bf16 v[80:83], a[72:75], a[0:3], v[80:83]
  s_and_b32 s44, s55, 15
  buffer_load_dwordx4 v233, s[16:19], s67 offen offset:1024  lds
  s_waitcnt lgkmcnt(4)
  v_mfma_f32_16x16x32_bf16 v[96:99], a[80:83], a[0:3], v[96:99]
  ds_read_b64_tr_b16 a[64:65], v228 offset:0
  v_fmac_f32 v16, v246, v238
  v_mfma_f32_16x16x32_bf16 v[96:99], a[84:87], a[16:19], v[96:99]
  s_lshl_b32 s45, s44, 10
  ds_read_b128 v[242:245], v237 offset:128
  v_fmac_f32 v17, v247, v238
  v_mfma_f32_16x16x32_bf16 v[100:103], a[84:87], a[20:23], v[100:103]
  s_add_u32 s57, s43, s45
  ds_read_b64_tr_b16 a[66:67], v228 offset:4096
  v_fmac_f32 v18, v248, v238
  v_mfma_f32_16x16x32_bf16 v[100:103], a[80:83], a[4:7], v[100:103]
  s_lshl_b32 s45, s44, 9
  v_fmac_f32 v19, v249, v238
  v_fmac_f32 v20, v246, v239
  v_mfma_f32_16x16x32_bf16 v[104:107], a[80:83], a[8:11], v[104:107]
  s_add_u32 s61, s43, s45
  ds_read_b64_tr_b16 a[68:69], v228 offset:8192
  v_fmac_f32 v21, v247, v239
  v_mfma_f32_16x16x32_bf16 v[104:107], a[84:87], a[24:27], v[104:107]
  s_add_u32 s61, s61, 49152
  buffer_load_dwordx4 v234, s[16:19], s67 offen offset:2048  lds
  v_fmac_f32 v22, v248, v239
  v_mfma_f32_16x16x32_bf16 v[108:111], a[84:87], a[28:31], v[108:111]
  s_add_u32 s62, s61, 229376
  ds_read_b64_tr_b16 a[70:71], v228 offset:12288
  v_fmac_f32 v23, v249, v239
  v_mfma_f32_16x16x32_bf16 v[108:111], a[80:83], a[12:15], v[108:111]
  s_add_u32 s58, s57, 114688
  v_fmac_f32 v24, v246, v240
  v_fmac_f32 v25, v247, v240
  s_waitcnt lgkmcnt(5)
  v_mfma_f32_16x16x32_bf16 v[124:127], a[88:91], a[12:15], v[124:127]
  s_add_u32 s59, s58, 114688
  ds_read_b64_tr_b16 a[72:73], v228 offset:16384
  v_fmac_f32 v26, v248, v240
  v_mfma_f32_16x16x32_bf16 v[124:127], a[92:95], a[28:31], v[124:127]
  s_add_u32 s60, s59, 114688
  buffer_load_dwordx4 v235, s[16:19], s67 offen offset:3072  lds
  v_fmac_f32 v27, v249, v240
  v_mfma_f32_16x16x32_bf16 v[120:123], a[92:95], a[24:27], v[120:123]
  s_lshl_b32 s77, s54, 1
  ds_read_b64_tr_b16 a[74:75], v228 offset:20480
  v_fmac_f32 v28, v246, v241
  v_mfma_f32_16x16x32_bf16 v[120:123], a[88:91], a[8:11], v[120:123]
  s_lshr_b32 s43, s55, 4
  v_fmac_f32 v29, v247, v241
  v_fmac_f32 v30, v248, v241
  v_mfma_f32_16x16x32_bf16 v[116:119], a[88:91], a[4:7], v[116:119]
  s_add_u32 s77, s77, s43
  ds_read_b64_tr_b16 a[76:77], v228 offset:24576
  v_fmac_f32 v31, v249, v241
  v_mfma_f32_16x16x32_bf16 v[116:119], a[92:95], a[20:23], v[116:119]
  s_lshl_b32 s77, s77, 7
  v_mfma_f32_16x16x32_bf16 v[112:115], a[92:95], a[16:19], v[112:115]
  s_add_u32 m0, s68, 16384
  ds_read_b64_tr_b16 a[78:79], v228 offset:28672
  v_mfma_f32_16x16x32_bf16 v[112:115], a[88:91], a[0:3], v[112:115]
  s_add_u32 s77, s77, s42
  buffer_load_dwordx4 v232, s[20:23], s67 offen offset:0  lds
  s_waitcnt lgkmcnt(4)
  v_mfma_f32_16x16x32_bf16 v[128:131], a[64:67], a[0:3], v[128:131]
  ds_read_b64_tr_b16 a[80:81], v229 offset:0
  v_fmac_f32 v32, v242, v238
  v_mfma_f32_16x16x32_bf16 v[128:131], a[68:71], a[16:19], v[128:131]
  s_add_u32 s77, s77, 27795456
  ds_read_b128 v[246:249], v237 offset:192
  v_fmac_f32 v33, v243, v238
  v_mfma_f32_16x16x32_bf16 v[132:135], a[68:71], a[20:23], v[132:135]
  s_and_b32 s43, s53, 1
  ds_read_b64_tr_b16 a[82:83], v229 offset:4096
  v_fmac_f32 v34, v244, v238
  v_mfma_f32_16x16x32_bf16 v[132:135], a[64:67], a[4:7], v[132:135]
  s_and_b32 s64, s52, 14
  buffer_load_dwordx4 v233, s[20:23], s67 offen offset:1024  lds
  v_fmac_f32 v35, v245, v238
  v_mfma_f32_16x16x32_bf16 v[136:139], a[64:67], a[8:11], v[136:139]
  s_add_u32 s64, s64, s43
  ds_read_b64_tr_b16 a[84:85], v229 offset:8192
  v_fmac_f32 v36, v242, v239
  v_mfma_f32_16x16x32_bf16 v[136:139], a[68:71], a[24:27], v[136:139]
  s_lshl_b32 s64, s64, 7
  v_fmac_f32 v37, v243, v239
  v_fmac_f32 v38, v244, v239
  v_mfma_f32_16x16x32_bf16 v[140:143], a[68:71], a[28:31], v[140:143]
  s_add_u32 s64, s64, s42
  ds_read_b64_tr_b16 a[86:87], v229 offset:12288
  v_fmac_f32 v39, v245, v239
  v_mfma_f32_16x16x32_bf16 v[140:143], a[64:67], a[12:15], v[140:143]
  s_add_u32 s64, s64, 27795456
  v_fmac_f32 v40, v242, v240
  v_fmac_f32 v41, v243, v240
  s_waitcnt lgkmcnt(5)
  v_mfma_f32_16x16x32_bf16 v[156:159], a[72:75], a[12:15], v[156:159]
  s_lshl_b32 s49, s52, 3
  ds_read_b64_tr_b16 a[88:89], v229 offset:16384
  v_fmac_f32 v42, v244, v240
  v_mfma_f32_16x16x32_bf16 v[156:159], a[76:79], a[28:31], v[156:159]
  s_lshl_b32 s43, s40, 1
  buffer_load_dwordx4 v234, s[20:23], s67 offen offset:2048  lds
  v_fmac_f32 v43, v245, v240
  v_mfma_f32_16x16x32_bf16 v[152:155], a[76:79], a[24:27], v[152:155]
  s_add_u32 s49, s49, s43
  ds_read_b64_tr_b16 a[90:91], v229 offset:20480
  v_fmac_f32 v44, v242, v241
  v_mfma_f32_16x16x32_bf16 v[152:155], a[72:75], a[8:11], v[152:155]
  s_lshl_b32 s76, s49, 15
  v_fmac_f32 v45, v243, v241
  v_fmac_f32 v46, v244, v241
  v_mfma_f32_16x16x32_bf16 v[148:151], a[72:75], a[4:7], v[148:151]
  s_lshl_b32 s43, s53, 11
  ds_read_b64_tr_b16 a[92:93], v229 offset:24576
  v_fmac_f32 v47, v245, v241
  v_mfma_f32_16x16x32_bf16 v[148:151], a[76:79], a[20:23], v[148:151]
  s_add_u32 s76, s76, s43
  buffer_load_dwordx4 v235, s[20:23], s67 offen offset:3072  lds
  v_mfma_f32_16x16x32_bf16 v[144:147], a[76:79], a[16:19], v[144:147]
  s_add_u32 s67, s67, 458752
  ds_read_b64_tr_b16 a[94:95], v229 offset:28672
  v_mfma_f32_16x16x32_bf16 v[144:147], a[72:75], a[0:3], v[144:147]
  s_add_u32 s76, s76, s42
  s_waitcnt lgkmcnt(4)
  v_mfma_f32_16x16x32_bf16 v[160:163], a[80:83], a[0:3], v[160:163]
  ds_read_b64_tr_b16 a[64:65], v230 offset:0
  v_fmac_f32 v48, v246, v238
  v_mfma_f32_16x16x32_bf16 v[160:163], a[84:87], a[16:19], v[160:163]
  s_add_u32 s46, s76, 4194304
  ds_read_b128 v[242:245], v237 offset:256
  v_fmac_f32 v49, v247, v238
  v_mfma_f32_16x16x32_bf16 v[164:167], a[84:87], a[20:23], v[164:167]
  s_add_u32 s47, s46, 32768
  ds_read_b64_tr_b16 a[66:67], v230 offset:4096
  v_fmac_f32 v50, v248, v238
  v_mfma_f32_16x16x32_bf16 v[164:167], a[80:83], a[4:7], v[164:167]
  s_mul_i32 s48, s49, 114688
  buffer_load_dwordx4 a[192:195], v231, s[4:7], s72 offen offset:0 sc1
  v_fmac_f32 v51, v249, v238
  v_mfma_f32_16x16x32_bf16 v[168:171], a[80:83], a[8:11], v[168:171]
  s_and_b32 s43, s53, 1
  ds_read_b64_tr_b16 a[68:69], v230 offset:8192
  v_fmac_f32 v52, v246, v239
  v_mfma_f32_16x16x32_bf16 v[168:171], a[84:87], a[24:27], v[168:171]
  s_mul_i32 s44, s43, 57344
  v_fmac_f32 v53, v247, v239
  v_fmac_f32 v54, v248, v239
  v_mfma_f32_16x16x32_bf16 v[172:175], a[84:87], a[28:31], v[172:175]
  s_add_u32 s48, s48, s44
  ds_read_b64_tr_b16 a[70:71], v230 offset:12288
  v_fmac_f32 v55, v249, v239
  v_mfma_f32_16x16x32_bf16 v[172:175], a[80:83], a[12:15], v[172:175]
  s_add_u32 s48, s48, 0
  buffer_load_dwordx4 a[208:211], v231, s[4:7], s72 offen offset:1024 sc1
  v_fmac_f32 v56, v246, v240
  s_waitcnt lgkmcnt(5)
  v_mfma_f32_16x16x32_bf16 v[188:191], a[88:91], a[12:15], v[188:191]
  s_add_u32 s48, s48, 12582912
  ds_read_b64_tr_b16 a[72:73], v230 offset:16384
  v_fmac_f32 v57, v247, v240
  v_mfma_f32_16x16x32_bf16 v[188:191], a[92:95], a[28:31], v[188:191]
  v_fmac_f32 v58, v248, v240
  v_fmac_f32 v59, v249, v240
  v_mfma_f32_16x16x32_bf16 v[184:187], a[92:95], a[24:27], v[184:187]
  ds_read_b64_tr_b16 a[74:75], v230 offset:20480
  v_fmac_f32 v60, v246, v241
  v_mfma_f32_16x16x32_bf16 v[184:187], a[88:91], a[8:11], v[184:187]
  v_fmac_f32 v61, v247, v241
  v_fmac_f32 v62, v248, v241
  v_mfma_f32_16x16x32_bf16 v[180:183], a[88:91], a[4:7], v[180:183]
  ds_read_b64_tr_b16 a[76:77], v230 offset:24576
  v_fmac_f32 v63, v249, v241
  v_mfma_f32_16x16x32_bf16 v[180:183], a[92:95], a[20:23], v[180:183]
  buffer_load_dwordx4 a[196:199], v231, s[4:7], s73 offen offset:0 sc1
  v_mfma_f32_16x16x32_bf16 v[176:179], a[92:95], a[16:19], v[176:179]
  ds_read_b64_tr_b16 a[78:79], v230 offset:28672
  v_mfma_f32_16x16x32_bf16 v[176:179], a[88:91], a[0:3], v[176:179]
  s_waitcnt lgkmcnt(4)
  v_mfma_f32_16x16x32_bf16 v[192:195], a[64:67], a[0:3], v[192:195]
  s_waitcnt vmcnt(19)
  s_barrier
  ds_read_b64_tr_b16 a[80:81], v224 offset:32768
  v_mfma_f32_16x16x32_bf16 v[192:195], a[68:71], a[16:19], v[192:195]
  buffer_load_dwordx4 a[212:215], v231, s[4:7], s73 offen offset:1024 sc1
  ds_read_b128 v[246:249], v237 offset:320
  v_mfma_f32_16x16x32_bf16 v[196:199], a[68:71], a[20:23], v[196:199]
  ds_read_b64_tr_b16 a[82:83], v224 offset:36864
  v_fmac_f32 v64, v242, v238
  v_mfma_f32_16x16x32_bf16 v[196:199], a[64:67], a[4:7], v[196:199]
  v_fmac_f32 v65, v243, v238
  v_fmac_f32 v66, v244, v238
  v_mfma_f32_16x16x32_bf16 v[200:203], a[64:67], a[8:11], v[200:203]
  ds_read_b64_tr_b16 a[84:85], v224 offset:40960
  v_fmac_f32 v67, v245, v238
  v_mfma_f32_16x16x32_bf16 v[200:203], a[68:71], a[24:27], v[200:203]
  v_fmac_f32 v68, v242, v239
  v_fmac_f32 v69, v243, v239
  v_mfma_f32_16x16x32_bf16 v[204:207], a[68:71], a[28:31], v[204:207]
  ds_read_b64_tr_b16 a[86:87], v224 offset:45056
  v_fmac_f32 v70, v244, v239
  v_mfma_f32_16x16x32_bf16 v[204:207], a[64:67], a[12:15], v[204:207]
  s_waitcnt lgkmcnt(5)
  buffer_load_dwordx4 a[200:203], v231, s[4:7], s74 offen offset:0 sc1
  v_fmac_f32 v71, v245, v239
  v_mfma_f32_16x16x32_bf16 v[220:223], a[72:75], a[12:15], v[220:223]
  ds_read_b64_tr_b16 a[88:89], v224 offset:49152
  v_fmac_f32 v72, v242, v240
  v_mfma_f32_16x16x32_bf16 v[220:223], a[76:79], a[28:31], v[220:223]
  v_fmac_f32 v73, v243, v240
  v_fmac_f32 v74, v244, v240
  v_mfma_f32_16x16x32_bf16 v[216:219], a[76:79], a[24:27], v[216:219]
  ds_read_b64_tr_b16 a[90:91], v224 offset:53248
  v_fmac_f32 v75, v245, v240
  v_mfma_f32_16x16x32_bf16 v[216:219], a[72:75], a[8:11], v[216:219]
  buffer_load_dwordx4 a[216:219], v231, s[4:7], s74 offen offset:1024 sc1
  v_fmac_f32 v76, v242, v241
  v_mfma_f32_16x16x32_bf16 v[212:215], a[72:75], a[4:7], v[212:215]
  ds_read_b64_tr_b16 a[92:93], v224 offset:57344
  v_fmac_f32 v77, v243, v241
  v_mfma_f32_16x16x32_bf16 v[212:215], a[76:79], a[20:23], v[212:215]
  v_fmac_f32 v78, v244, v241
  v_fmac_f32 v79, v245, v241
  v_mfma_f32_16x16x32_bf16 v[208:211], a[76:79], a[16:19], v[208:211]
  ds_read_b64_tr_b16 a[94:95], v224 offset:61440
  v_xor_b32 v224, 0x10000, v224
  v_mfma_f32_16x16x32_bf16 v[208:211], a[72:75], a[0:3], v[208:211]
  s_waitcnt vmcnt(20) lgkmcnt(4)
  v_mfma_f32_16x16x32_bf16 v[0:3], a[80:83], a[32:35], v[0:3]
  ds_read_b64_tr_b16 a[64:65], v225 offset:32768
  v_fmac_f32 v80, v246, v238
  v_mfma_f32_16x16x32_bf16 v[0:3], a[84:87], a[48:51], v[0:3]
  s_waitcnt vmcnt(18)
  buffer_load_dwordx4 a[204:207], v231, s[4:7], s75 offen offset:0 sc1
  ds_read_b128 v[242:245], v237 offset:448
  v_mfma_f32_16x16x32_bf16 v[4:7], a[84:87], a[52:55], v[4:7]
  ds_read_b64_tr_b16 a[66:67], v225 offset:36864
  v_fmac_f32 v81, v247, v238
  v_mfma_f32_16x16x32_bf16 v[4:7], a[80:83], a[36:39], v[4:7]
  s_waitcnt vmcnt(17)
  v_fmac_f32 v82, v248, v238
  v_fmac_f32 v83, v249, v238
  v_mfma_f32_16x16x32_bf16 v[8:11], a[80:83], a[40:43], v[8:11]
  ds_read_b64_tr_b16 a[68:69], v225 offset:40960
  v_fmac_f32 v84, v246, v239
  v_mfma_f32_16x16x32_bf16 v[8:11], a[84:87], a[56:59], v[8:11]
  s_waitcnt vmcnt(15)
  buffer_load_dwordx4 a[220:223], v231, s[4:7], s75 offen offset:1024 sc1
  v_fmac_f32 v85, v247, v239
  v_mfma_f32_16x16x32_bf16 v[12:15], a[84:87], a[60:63], v[12:15]
  ds_read_b64_tr_b16 a[70:71], v225 offset:45056
  v_fmac_f32 v86, v248, v239
  v_mfma_f32_16x16x32_bf16 v[12:15], a[80:83], a[44:47], v[12:15]
  s_waitcnt lgkmcnt(5)
  v_fmac_f32 v87, v249, v239
  v_fmac_f32 v88, v246, v240
  v_mfma_f32_16x16x32_bf16 v[28:31], a[88:91], a[44:47], v[28:31]
  ds_read_b64_tr_b16 a[72:73], v225 offset:49152
  v_fmac_f32 v89, v247, v240
  v_mfma_f32_16x16x32_bf16 v[28:31], a[92:95], a[60:63], v[28:31]
  v_fmac_f32 v90, v248, v240
  v_fmac_f32 v91, v249, v240
  v_mfma_f32_16x16x32_bf16 v[24:27], a[92:95], a[56:59], v[24:27]
  s_add_u32 m0, s68, 32768
  ds_read_b64_tr_b16 a[74:75], v225 offset:53248
  v_fmac_f32 v92, v246, v241
  v_mfma_f32_16x16x32_bf16 v[24:27], a[88:91], a[40:43], v[24:27]
  buffer_load_dwordx4 v232, s[16:19], s67 offen offset:0  lds
  v_fmac_f32 v93, v247, v241
  v_mfma_f32_16x16x32_bf16 v[20:23], a[88:91], a[36:39], v[20:23]
  ds_read_b64_tr_b16 a[76:77], v225 offset:57344
  v_fmac_f32 v94, v248, v241
  v_mfma_f32_16x16x32_bf16 v[20:23], a[92:95], a[52:55], v[20:23]
  v_fmac_f32 v95, v249, v241
  v_mfma_f32_16x16x32_bf16 v[16:19], a[92:95], a[48:51], v[16:19]
  ds_read_b64_tr_b16 a[78:79], v225 offset:61440
  v_xor_b32 v225, 0x10000, v225
  v_mfma_f32_16x16x32_bf16 v[16:19], a[88:91], a[32:35], v[16:19]
  buffer_load_dwordx4 v233, s[16:19], s67 offen offset:1024  lds
  s_waitcnt lgkmcnt(4)
  v_mfma_f32_16x16x32_bf16 v[32:35], a[64:67], a[32:35], v[32:35]
  ds_read_b64_tr_b16 a[80:81], v226 offset:32768
  v_fmac_f32 v112, v242, v238
  v_mfma_f32_16x16x32_bf16 v[32:35], a[68:71], a[48:51], v[32:35]
  ds_read_b128 v[246:249], v237 offset:512
  v_fmac_f32 v113, v243, v238
  v_mfma_f32_16x16x32_bf16 v[36:39], a[68:71], a[52:55], v[36:39]
  ds_read_b64_tr_b16 a[82:83], v226 offset:36864
  v_fmac_f32 v114, v244, v238
  v_mfma_f32_16x16x32_bf16 v[36:39], a[64:67], a[36:39], v[36:39]
  v_fmac_f32 v115, v245, v238
  v_fmac_f32 v116, v242, v239
  v_mfma_f32_16x16x32_bf16 v[40:43], a[64:67], a[40:43], v[40:43]
  ds_read_b64_tr_b16 a[84:85], v226 offset:40960
  v_fmac_f32 v117, v243, v239
  v_mfma_f32_16x16x32_bf16 v[40:43], a[68:71], a[56:59], v[40:43]
  buffer_load_dwordx4 v234, s[16:19], s67 offen offset:2048  lds
  v_fmac_f32 v118, v244, v239
  v_mfma_f32_16x16x32_bf16 v[44:47], a[68:71], a[60:63], v[44:47]
  ds_read_b64_tr_b16 a[86:87], v226 offset:45056
  v_fmac_f32 v119, v245, v239
  v_mfma_f32_16x16x32_bf16 v[44:47], a[64:67], a[44:47], v[44:47]
  s_waitcnt lgkmcnt(5)
  v_fmac_f32 v120, v242, v240
  v_fmac_f32 v121, v243, v240
  v_mfma_f32_16x16x32_bf16 v[60:63], a[72:75], a[44:47], v[60:63]
  ds_read_b64_tr_b16 a[88:89], v226 offset:49152
  v_fmac_f32 v122, v244, v240
  v_mfma_f32_16x16x32_bf16 v[60:63], a[76:79], a[60:63], v[60:63]
  buffer_load_dwordx4 v235, s[16:19], s67 offen offset:3072  lds
  v_fmac_f32 v123, v245, v240
  v_mfma_f32_16x16x32_bf16 v[56:59], a[76:79], a[56:59], v[56:59]
  ds_read_b64_tr_b16 a[90:91], v226 offset:53248
  v_fmac_f32 v124, v242, v241
  v_mfma_f32_16x16x32_bf16 v[56:59], a[72:75], a[40:43], v[56:59]
  v_fmac_f32 v125, v243, v241
  v_fmac_f32 v126, v244, v241
  v_mfma_f32_16x16x32_bf16 v[52:55], a[72:75], a[36:39], v[52:55]
  ds_read_b64_tr_b16 a[92:93], v226 offset:57344
  v_fmac_f32 v127, v245, v241
  v_mfma_f32_16x16x32_bf16 v[52:55], a[76:79], a[52:55], v[52:55]
  v_mfma_f32_16x16x32_bf16 v[48:51], a[76:79], a[48:51], v[48:51]
  s_add_u32 m0, s68, 49152
  ds_read_b64_tr_b16 a[94:95], v226 offset:61440
  v_xor_b32 v226, 0x10000, v226
  v_mfma_f32_16x16x32_bf16 v[48:51], a[72:75], a[32:35], v[48:51]
  buffer_load_dwordx4 v232, s[20:23], s67 offen offset:0  lds
  s_waitcnt lgkmcnt(4)
  v_mfma_f32_16x16x32_bf16 v[64:67], a[80:83], a[32:35], v[64:67]
  ds_read_b64_tr_b16 a[64:65], v227 offset:32768
  v_fmac_f32 v128, v246, v238
  v_mfma_f32_16x16x32_bf16 v[64:67], a[84:87], a[48:51], v[64:67]
  ds_read_b128 v[242:245], v237 offset:576
  v_fmac_f32 v129, v247, v238
  v_mfma_f32_16x16x32_bf16 v[68:71], a[84:87], a[52:55], v[68:71]
  ds_read_b64_tr_b16 a[66:67], v227 offset:36864
  v_fmac_f32 v130, v248, v238
  v_mfma_f32_16x16x32_bf16 v[68:71], a[80:83], a[36:39], v[68:71]
  buffer_load_dwordx4 v233, s[20:23], s67 offen offset:1024  lds
  v_fmac_f32 v131, v249, v238
  v_mfma_f32_16x16x32_bf16 v[72:75], a[80:83], a[40:43], v[72:75]
  ds_read_b64_tr_b16 a[68:69], v227 offset:40960
  v_fmac_f32 v132, v246, v239
  v_mfma_f32_16x16x32_bf16 v[72:75], a[84:87], a[56:59], v[72:75]
  v_fmac_f32 v133, v247, v239
  v_fmac_f32 v134, v248, v239
  v_mfma_f32_16x16x32_bf16 v[76:79], a[84:87], a[60:63], v[76:79]
  ds_read_b64_tr_b16 a[70:71], v227 offset:45056
  v_fmac_f32 v135, v249, v239
  v_mfma_f32_16x16x32_bf16 v[76:79], a[80:83], a[44:47], v[76:79]
  s_waitcnt lgkmcnt(5)
  v_fmac_f32 v136, v246, v240
  v_fmac_f32 v137, v247, v240
  v_mfma_f32_16x16x32_bf16 v[92:95], a[88:91], a[44:47], v[92:95]
  ds_read_b64_tr_b16 a[72:73], v227 offset:49152
  v_fmac_f32 v138, v248, v240
  v_mfma_f32_16x16x32_bf16 v[92:95], a[92:95], a[60:63], v[92:95]
  buffer_load_dwordx4 v234, s[20:23], s67 offen offset:2048  lds
  v_fmac_f32 v139, v249, v240
  v_mfma_f32_16x16x32_bf16 v[88:91], a[92:95], a[56:59], v[88:91]
  ds_read_b64_tr_b16 a[74:75], v227 offset:53248
  v_fmac_f32 v140, v246, v241
  v_mfma_f32_16x16x32_bf16 v[88:91], a[88:91], a[40:43], v[88:91]
  v_fmac_f32 v141, v247, v241
  v_fmac_f32 v142, v248, v241
  v_mfma_f32_16x16x32_bf16 v[84:87], a[88:91], a[36:39], v[84:87]
  ds_read_b64_tr_b16 a[76:77], v227 offset:57344
  v_fmac_f32 v143, v249, v241
  v_mfma_f32_16x16x32_bf16 v[84:87], a[92:95], a[52:55], v[84:87]
  buffer_load_dwordx4 v235, s[20:23], s67 offen offset:3072  lds
  v_mfma_f32_16x16x32_bf16 v[80:83], a[92:95], a[48:51], v[80:83]
  s_add_u32 s67, s67, 458752
  s_xor_b32 s68, s68, 0x10000
  ds_read_b64_tr_b16 a[78:79], v227 offset:61440
  v_xor_b32 v227, 0x10000, v227
  v_mfma_f32_16x16x32_bf16 v[80:83], a[88:91], a[32:35], v[80:83]
  s_waitcnt lgkmcnt(4)
  v_mfma_f32_16x16x32_bf16 v[96:99], a[64:67], a[32:35], v[96:99]
  s_waitcnt vmcnt(16)
  s_barrier
  ds_read_b64_tr_b16 a[80:81], v224 offset:0
  v_mfma_f32_16x16x32_bf16 v[96:99], a[68:71], a[48:51], v[96:99]
  ds_read_b128 v[246:249], v237 offset:640
  v_fmac_f32 v144, v242, v238
  v_mfma_f32_16x16x32_bf16 v[100:103], a[68:71], a[52:55], v[100:103]
  ds_read_b64_tr_b16 a[82:83], v224 offset:4096
  v_fmac_f32 v145, v243, v238
  v_mfma_f32_16x16x32_bf16 v[100:103], a[64:67], a[36:39], v[100:103]
  buffer_load_dwordx4 a[224:227], v231, s[4:7], s72 offen offset:2048 sc1
  v_fmac_f32 v146, v244, v238
  v_mfma_f32_16x16x32_bf16 v[104:107], a[64:67], a[40:43], v[104:107]
  ds_read_b64_tr_b16 a[84:85], v224 offset:8192
  v_fmac_f32 v147, v245, v238
  v_mfma_f32_16x16x32_bf16 v[104:107], a[68:71], a[56:59], v[104:107]
  v_fmac_f32 v148, v242, v239
  v_fmac_f32 v149, v243, v239
  v_mfma_f32_16x16x32_bf16 v[108:111], a[68:71], a[60:63], v[108:111]
  ds_read_b64_tr_b16 a[86:87], v224 offset:12288
  v_fmac_f32 v150, v244, v239
  v_mfma_f32_16x16x32_bf16 v[108:111], a[64:67], a[44:47], v[108:111]
  s_waitcnt lgkmcnt(5)
  buffer_load_dwordx4 a[240:243], v231, s[4:7], s72 offen offset:3072 sc1
  v_fmac_f32 v151, v245, v239
  v_mfma_f32_16x16x32_bf16 v[124:127], a[72:75], a[44:47], v[124:127]
  s_add_u32 s72, s72, 4096
  ds_read_b64_tr_b16 a[88:89], v224 offset:16384
  v_fmac_f32 v152, v242, v240
  v_mfma_f32_16x16x32_bf16 v[124:127], a[76:79], a[60:63], v[124:127]
  v_fmac_f32 v153, v243, v240
  v_fmac_f32 v154, v244, v240
  v_mfma_f32_16x16x32_bf16 v[120:123], a[76:79], a[56:59], v[120:123]
  ds_read_b64_tr_b16 a[90:91], v224 offset:20480
  v_fmac_f32 v155, v245, v240
  v_mfma_f32_16x16x32_bf16 v[120:123], a[72:75], a[40:43], v[120:123]
  v_fmac_f32 v156, v242, v241
  v_fmac_f32 v157, v243, v241
  v_mfma_f32_16x16x32_bf16 v[116:119], a[72:75], a[36:39], v[116:119]
  ds_read_b64_tr_b16 a[92:93], v224 offset:24576
  v_fmac_f32 v158, v244, v241
  v_mfma_f32_16x16x32_bf16 v[116:119], a[76:79], a[52:55], v[116:119]
  buffer_load_dwordx4 a[228:231], v231, s[4:7], s73 offen offset:2048 sc1
  v_fmac_f32 v159, v245, v241
  v_mfma_f32_16x16x32_bf16 v[112:115], a[76:79], a[48:51], v[112:115]
  ds_read_b64_tr_b16 a[94:95], v224 offset:28672
  v_mfma_f32_16x16x32_bf16 v[112:115], a[72:75], a[32:35], v[112:115]
  s_waitcnt vmcnt(17) lgkmcnt(4)
  v_mfma_f32_16x16x32_bf16 v[0:3], a[80:83], a[192:195], v[0:3]
  ds_read_b64_tr_b16 a[64:65], v225 offset:0
  v_fmac_f32 v160, v246, v238
  v_mfma_f32_16x16x32_bf16 v[0:3], a[84:87], a[208:211], v[0:3]
  s_waitcnt vmcnt(15)
  buffer_load_dwordx4 a[244:247], v231, s[4:7], s73 offen offset:3072 sc1
  ds_read_b128 v[242:245], v237 offset:704
  v_mfma_f32_16x16x32_bf16 v[4:7], a[84:87], a[212:215], v[4:7]
  s_add_u32 s73, s73, 4096
  ds_read_b64_tr_b16 a[66:67], v225 offset:4096
  v_fmac_f32 v161, v247, v238
  v_mfma_f32_16x16x32_bf16 v[4:7], a[80:83], a[196:199], v[4:7]
  s_waitcnt vmcnt(14)
  v_fmac_f32 v162, v248, v238
  v_fmac_f32 v163, v249, v238
  v_mfma_f32_16x16x32_bf16 v[8:11], a[80:83], a[200:203], v[8:11]
  ds_read_b64_tr_b16 a[68:69], v225 offset:8192
  v_fmac_f32 v164, v246, v239
  v_mfma_f32_16x16x32_bf16 v[8:11], a[84:87], a[216:219], v[8:11]
  s_waitcnt vmcnt(12)
  v_fmac_f32 v165, v247, v239
  v_fmac_f32 v166, v248, v239
  v_mfma_f32_16x16x32_bf16 v[12:15], a[84:87], a[220:223], v[12:15]
  ds_read_b64_tr_b16 a[70:71], v225 offset:12288
  v_fmac_f32 v167, v249, v239
  v_mfma_f32_16x16x32_bf16 v[12:15], a[80:83], a[204:207], v[12:15]
  s_waitcnt lgkmcnt(5)
  buffer_load_dwordx4 a[232:235], v231, s[4:7], s74 offen offset:2048 sc1
  v_fmac_f32 v168, v246, v240
  v_mfma_f32_16x16x32_bf16 v[28:31], a[88:91], a[204:207], v[28:31]
  ds_read_b64_tr_b16 a[72:73], v225 offset:16384
  v_fmac_f32 v169, v247, v240
  v_mfma_f32_16x16x32_bf16 v[28:31], a[92:95], a[220:223], v[28:31]
  v_fmac_f32 v170, v248, v240
  v_fmac_f32 v171, v249, v240
  v_mfma_f32_16x16x32_bf16 v[24:27], a[92:95], a[216:219], v[24:27]
  ds_read_b64_tr_b16 a[74:75], v225 offset:20480
  v_fmac_f32 v172, v246, v241
  v_mfma_f32_16x16x32_bf16 v[24:27], a[88:91], a[200:203], v[24:27]
  buffer_load_dwordx4 a[248:251], v231, s[4:7], s74 offen offset:3072 sc1
  v_fmac_f32 v173, v247, v241
  v_mfma_f32_16x16x32_bf16 v[20:23], a[88:91], a[196:199], v[20:23]
  s_add_u32 s74, s74, 4096
  ds_read_b64_tr_b16 a[76:77], v225 offset:24576
  v_fmac_f32 v174, v248, v241
  v_mfma_f32_16x16x32_bf16 v[20:23], a[92:95], a[212:215], v[20:23]
  v_fmac_f32 v175, v249, v241
  v_mfma_f32_16x16x32_bf16 v[16:19], a[92:95], a[208:211], v[16:19]
  ds_read_b64_tr_b16 a[78:79], v225 offset:28672
  v_mfma_f32_16x16x32_bf16 v[16:19], a[88:91], a[192:195], v[16:19]
  s_waitcnt lgkmcnt(4)
  v_mfma_f32_16x16x32_bf16 v[32:35], a[64:67], a[192:195], v[32:35]
  ds_read_b64_tr_b16 a[80:81], v226 offset:0
  v_fmac_f32 v176, v242, v238
  v_mfma_f32_16x16x32_bf16 v[32:35], a[68:71], a[208:211], v[32:35]
  buffer_load_dwordx4 a[236:239], v231, s[4:7], s75 offen offset:2048 sc1
  ds_read_b128 v[246:249], v237 offset:768
  v_mfma_f32_16x16x32_bf16 v[36:39], a[68:71], a[212:215], v[36:39]
  ds_read_b64_tr_b16 a[82:83], v226 offset:4096
  v_fmac_f32 v177, v243, v238
  v_mfma_f32_16x16x32_bf16 v[36:39], a[64:67], a[196:199], v[36:39]
  v_fmac_f32 v178, v244, v238
  v_fmac_f32 v179, v245, v238
  v_mfma_f32_16x16x32_bf16 v[40:43], a[64:67], a[200:203], v[40:43]
  ds_read_b64_tr_b16 a[84:85], v226 offset:8192
  v_fmac_f32 v180, v242, v239
  v_mfma_f32_16x16x32_bf16 v[40:43], a[68:71], a[216:219], v[40:43]
  buffer_load_dwordx4 a[252:255], v231, s[4:7], s75 offen offset:3072 sc1
  v_fmac_f32 v181, v243, v239
  v_mfma_f32_16x16x32_bf16 v[44:47], a[68:71], a[220:223], v[44:47]
  s_add_u32 s75, s75, 4096
  ds_read_b64_tr_b16 a[86:87], v226 offset:12288
  v_fmac_f32 v182, v244, v239
  v_mfma_f32_16x16x32_bf16 v[44:47], a[64:67], a[204:207], v[44:47]
  s_waitcnt lgkmcnt(5)
  v_fmac_f32 v183, v245, v239
  v_fmac_f32 v184, v242, v240
  v_mfma_f32_16x16x32_bf16 v[60:63], a[72:75], a[204:207], v[60:63]
  ds_read_b64_tr_b16 a[88:89], v226 offset:16384
  v_fmac_f32 v185, v243, v240
  v_mfma_f32_16x16x32_bf16 v[60:63], a[76:79], a[220:223], v[60:63]
  v_fmac_f32 v186, v244, v240
  v_fmac_f32 v187, v245, v240
  v_mfma_f32_16x16x32_bf16 v[56:59], a[76:79], a[216:219], v[56:59]
  ds_read_b64_tr_b16 a[90:91], v226 offset:20480
  v_fmac_f32 v188, v242, v241
  v_mfma_f32_16x16x32_bf16 v[56:59], a[72:75], a[200:203], v[56:59]
  s_add_u32 m0, s79, 0
  v_fmac_f32 v189, v243, v241
  v_fmac_f32 v190, v244, v241
  v_mfma_f32_16x16x32_bf16 v[52:55], a[72:75], a[196:199], v[52:55]
  s_add_u32 s92, s92, 0
  ds_read_b64_tr_b16 a[92:93], v226 offset:24576
  v_fmac_f32 v191, v245, v241
  v_mfma_f32_16x16x32_bf16 v[52:55], a[76:79], a[212:215], v[52:55]
  buffer_load_dwordx4 v252, s[80:83], s92 offen lds
  v_mfma_f32_16x16x32_bf16 v[48:51], a[76:79], a[208:211], v[48:51]
  ds_read_b64_tr_b16 a[94:95], v226 offset:28672
  v_mfma_f32_16x16x32_bf16 v[48:51], a[72:75], a[192:195], v[48:51]
  s_waitcnt lgkmcnt(4)
  v_mfma_f32_16x16x32_bf16 v[64:67], a[80:83], a[192:195], v[64:67]
  ds_read_b64_tr_b16 a[64:65], v228 offset:32768
  v_fmac_f32 v192, v246, v238
  v_mfma_f32_16x16x32_bf16 v[64:67], a[84:87], a[208:211], v[64:67]
  ds_read_b128 v[242:245], v237 offset:832
  v_fmac_f32 v193, v247, v238
  v_mfma_f32_16x16x32_bf16 v[68:71], a[84:87], a[212:215], v[68:71]
  ds_read_b64_tr_b16 a[66:67], v228 offset:36864
  v_fmac_f32 v194, v248, v238
  v_mfma_f32_16x16x32_bf16 v[68:71], a[80:83], a[196:199], v[68:71]
  buffer_load_dwordx4 v252, s[84:87], s92 offen offset:1024 lds
  v_fmac_f32 v195, v249, v238
  v_fmac_f32 v196, v246, v239
  v_mfma_f32_16x16x32_bf16 v[72:75], a[80:83], a[200:203], v[72:75]
  ds_read_b64_tr_b16 a[68:69], v228 offset:40960
  v_fmac_f32 v197, v247, v239
  v_mfma_f32_16x16x32_bf16 v[72:75], a[84:87], a[216:219], v[72:75]
  v_fmac_f32 v198, v248, v239
  v_fmac_f32 v199, v249, v239
  v_mfma_f32_16x16x32_bf16 v[76:79], a[84:87], a[220:223], v[76:79]
  ds_read_b64_tr_b16 a[70:71], v228 offset:45056
  v_fmac_f32 v200, v246, v240
  v_mfma_f32_16x16x32_bf16 v[76:79], a[80:83], a[204:207], v[76:79]
  s_add_u32 m0, s79, 8192
  v_fmac_f32 v201, v247, v240
  v_fmac_f32 v202, v248, v240
  s_waitcnt lgkmcnt(5)
  v_mfma_f32_16x16x32_bf16 v[92:95], a[88:91], a[204:207], v[92:95]
  s_add_u32 s92, s92, 262144
  ds_read_b64_tr_b16 a[72:73], v228 offset:49152
  v_fmac_f32 v203, v249, v240
  v_mfma_f32_16x16x32_bf16 v[92:95], a[92:95], a[220:223], v[92:95]
  buffer_load_dwordx4 v252, s[80:83], s92 offen lds
  v_fmac_f32 v204, v246, v241
  v_fmac_f32 v205, v247, v241
  v_mfma_f32_16x16x32_bf16 v[88:91], a[92:95], a[216:219], v[88:91]
  ds_read_b64_tr_b16 a[74:75], v228 offset:53248
  v_fmac_f32 v206, v248, v241
  v_mfma_f32_16x16x32_bf16 v[88:91], a[88:91], a[200:203], v[88:91]
  v_fmac_f32 v207, v249, v241
  v_mfma_f32_16x16x32_bf16 v[84:87], a[88:91], a[196:199], v[84:87]
  ds_read_b64_tr_b16 a[76:77], v228 offset:57344
  v_mfma_f32_16x16x32_bf16 v[84:87], a[92:95], a[212:215], v[84:87]
  v_mfma_f32_16x16x32_bf16 v[80:83], a[92:95], a[208:211], v[80:83]
  ds_read_b64_tr_b16 a[78:79], v228 offset:61440
  v_xor_b32 v228, 0x10000, v228
  v_mfma_f32_16x16x32_bf16 v[80:83], a[88:91], a[192:195], v[80:83]
  buffer_load_dwordx4 v252, s[84:87], s92 offen offset:1024 lds
  s_waitcnt lgkmcnt(4)
  v_mfma_f32_16x16x32_bf16 v[128:131], a[64:67], a[32:35], v[128:131]
  s_waitcnt vmcnt(12)
  s_barrier
  ds_read_b64_tr_b16 a[80:81], v224 offset:32768
  v_mfma_f32_16x16x32_bf16 v[128:131], a[68:71], a[48:51], v[128:131]
  v_fmac_f32 v208, v242, v238
  v_fmac_f32 v209, v243, v238
  v_mfma_f32_16x16x32_bf16 v[132:135], a[68:71], a[52:55], v[132:135]
  ds_read_b64_tr_b16 a[82:83], v224 offset:36864
  v_fmac_f32 v210, v244, v238
  v_mfma_f32_16x16x32_bf16 v[132:135], a[64:67], a[36:39], v[132:135]
  s_add_u32 m0, s79, 16384
  v_fmac_f32 v211, v245, v238
  v_fmac_f32 v212, v242, v239
  v_mfma_f32_16x16x32_bf16 v[136:139], a[64:67], a[40:43], v[136:139]
  s_add_u32 s92, s92, 196608
  ds_read_b64_tr_b16 a[84:85], v224 offset:40960
  v_fmac_f32 v213, v243, v239
  v_mfma_f32_16x16x32_bf16 v[136:139], a[68:71], a[56:59], v[136:139]
  buffer_load_dwordx4 v252, s[80:83], s92 offen lds
  v_fmac_f32 v214, v244, v239
  v_fmac_f32 v215, v245, v239
  v_mfma_f32_16x16x32_bf16 v[140:143], a[68:71], a[60:63], v[140:143]
  ds_read_b64_tr_b16 a[86:87], v224 offset:45056
  v_fmac_f32 v216, v242, v240
  v_mfma_f32_16x16x32_bf16 v[140:143], a[64:67], a[44:47], v[140:143]
  s_waitcnt lgkmcnt(4)
  v_fmac_f32 v217, v243, v240
  v_fmac_f32 v218, v244, v240
  v_mfma_f32_16x16x32_bf16 v[156:159], a[72:75], a[44:47], v[156:159]
  ds_read_b64_tr_b16 a[88:89], v224 offset:49152
  v_fmac_f32 v219, v245, v240
  v_mfma_f32_16x16x32_bf16 v[156:159], a[76:79], a[60:63], v[156:159]
  v_fmac_f32 v220, v242, v241
  v_fmac_f32 v221, v243, v241
  v_mfma_f32_16x16x32_bf16 v[152:155], a[76:79], a[56:59], v[152:155]
  ds_read_b64_tr_b16 a[90:91], v224 offset:53248
  v_fmac_f32 v222, v244, v241
  v_mfma_f32_16x16x32_bf16 v[152:155], a[72:75], a[40:43], v[152:155]
  buffer_load_dwordx4 v252, s[84:87], s92 offen offset:1024 lds
  v_fmac_f32 v223, v245, v241
  v_mfma_f32_16x16x32_bf16 v[148:151], a[72:75], a[36:39], v[148:151]
  ds_read_b64_tr_b16 a[92:93], v224 offset:57344
  v_mfma_f32_16x16x32_bf16 v[148:151], a[76:79], a[52:55], v[148:151]
  v_mfma_f32_16x16x32_bf16 v[144:147], a[76:79], a[48:51], v[144:147]
  ds_read_b64_tr_b16 a[94:95], v224 offset:61440
  v_mfma_f32_16x16x32_bf16 v[144:147], a[72:75], a[32:35], v[144:147]
  s_add_u32 m0, s79, 24576
  s_waitcnt vmcnt(12) lgkmcnt(4)
  v_mfma_f32_16x16x32_bf16 v[0:3], a[80:83], a[224:227], v[0:3]
  s_add_u32 s92, s92, 262144
  ds_read_b64_tr_b16 a[64:65], v229 offset:32768
  v_and_b32 v236, 31, v253
  v_mfma_f32_16x16x32_bf16 v[0:3], a[84:87], a[240:243], v[0:3]
  s_waitcnt vmcnt(10)
  buffer_load_dwordx4 v252, s[80:83], s92 offen lds
  v_lshlrev_b32 v236, 4, v236
  v_mfma_f32_16x16x32_bf16 v[4:7], a[84:87], a[244:247], v[4:7]
  ds_read_b64_tr_b16 a[66:67], v229 offset:36864
  v_lshrrev_b32 v250, 5, v253
  v_mfma_f32_16x16x32_bf16 v[4:7], a[80:83], a[228:231], v[4:7]
  s_mov_b32 s43, 114688
  v_mad_u32_u24 v236, v250, s43, v236
  v_and_b32 v250, 15, v253
  s_waitcnt vmcnt(9)
  v_mfma_f32_16x16x32_bf16 v[8:11], a[80:83], a[232:235], v[8:11]
  s_add_u32 s43, s71, 1024
  ds_read_b64_tr_b16 a[68:69], v229 offset:40960
  v_lshl_add_u32 v250, v250, 2, s43
  v_mfma_f32_16x16x32_bf16 v[8:11], a[84:87], a[248:251], v[8:11]
  s_waitcnt vmcnt(7)
  ds_read2_b32 v[238:239], v250 offset0:64 offset1:80
  ds_read2_b32 v[240:241], v250 offset0:96 offset1:112
  v_mfma_f32_16x16x32_bf16 v[12:15], a[84:87], a[252:255], v[12:15]
  ds_read_b64_tr_b16 a[70:71], v229 offset:45056
  ds_read2_b32 v[232:233], v250 offset0:128 offset1:144
  v_mfma_f32_16x16x32_bf16 v[12:15], a[80:83], a[236:239], v[12:15]
  s_waitcnt lgkmcnt(7)
  buffer_load_dwordx4 v252, s[84:87], s92 offen offset:1024 lds
  ds_read2_b32 v[234:235], v250 offset0:160 offset1:176
  v_mfma_f32_16x16x32_bf16 v[28:31], a[88:91], a[236:239], v[28:31]
  ds_read_b64_tr_b16 a[72:73], v229 offset:49152
  v_mfma_f32_16x16x32_bf16 v[28:31], a[92:95], a[252:255], v[28:31]
  v_mfma_f32_16x16x32_bf16 v[24:27], a[92:95], a[248:251], v[24:27]
  ds_read_b64_tr_b16 a[74:75], v229 offset:53248
  v_mfma_f32_16x16x32_bf16 v[24:27], a[88:91], a[232:235], v[24:27]
  v_mfma_f32_16x16x32_bf16 v[20:23], a[88:91], a[228:231], v[20:23]
  ds_read_b64_tr_b16 a[76:77], v229 offset:57344
  v_mfma_f32_16x16x32_bf16 v[20:23], a[92:95], a[244:247], v[20:23]
  v_mfma_f32_16x16x32_bf16 v[16:19], a[92:95], a[240:243], v[16:19]
  ds_read_b64_tr_b16 a[78:79], v229 offset:61440
  v_xor_b32 v229, 0x10000, v229
  v_mfma_f32_16x16x32_bf16 v[16:19], a[88:91], a[224:227], v[16:19]
  s_waitcnt lgkmcnt(6)
  v_mfma_f32_16x16x32_bf16 v[160:163], a[64:67], a[32:35], v[160:163]
  ds_read_b64_tr_b16 a[80:81], v225 offset:32768
  v_mfma_f32_16x16x32_bf16 v[160:163], a[68:71], a[48:51], v[160:163]
  v_mfma_f32_16x16x32_bf16 v[164:167], a[68:71], a[52:55], v[164:167]
  s_waitcnt lgkmcnt(5)
  ds_read_b64_tr_b16 a[82:83], v225 offset:36864
  v_mfma_f32_16x16x32_bf16 v[164:167], a[64:67], a[36:39], v[164:167]
  v_pk_mul_f32 v[242:243], v[0:1], v[238:239] op_sel:[0,0] op_sel_hi:[1,0]
  v_pk_mul_f32 v[244:245], v[2:3], v[238:239] op_sel:[0,0] op_sel_hi:[1,0]
  v_pk_mul_f32 v[0:1], v[0:1], v[16:17]
  v_pk_mul_f32 v[2:3], v[2:3], v[18:19]
  v_mfma_f32_16x16x32_bf16 v[168:171], a[64:67], a[40:43], v[168:171]
  ds_read_b64_tr_b16 a[84:85], v225 offset:40960
  v_mfma_f32_16x16x32_bf16 v[168:171], a[68:71], a[56:59], v[168:171]
  v_mfma_f32_16x16x32_bf16 v[172:175], a[68:71], a[60:63], v[172:175]
  ds_read_b64_tr_b16 a[86:87], v225 offset:45056
  v_mfma_f32_16x16x32_bf16 v[172:175], a[64:67], a[44:47], v[172:175]
  s_waitcnt lgkmcnt(4)
  v_mfma_f32_16x16x32_bf16 v[188:191], a[72:75], a[44:47], v[188:191]
  v_exp_f32 v242, v242
  v_mfma_f32_16x16x32_bf16 v[188:191], a[76:79], a[60:63], v[188:191]
  v_exp_f32 v243, v243
  v_mfma_f32_16x16x32_bf16 v[184:187], a[76:79], a[56:59], v[184:187]
  ds_read_b64_tr_b16 a[88:89], v225 offset:49152
  ds_read_b64_tr_b16 a[90:91], v225 offset:53248
  v_mfma_f32_16x16x32_bf16 v[184:187], a[72:75], a[40:43], v[184:187]
  v_exp_f32 v244, v244
  v_exp_f32 v245, v245
  s_nop 0
  v_pk_fma_f32 v[242:243], v[242:243], v[232:233], v[232:233] op_sel:[0,0,0] op_sel_hi:[1,0,0]
  v_pk_fma_f32 v[244:245], v[244:245], v[232:233], v[232:233] op_sel:[0,0,0] op_sel_hi:[1,0,0]
  v_pk_mul_f32 v[246:247], v[4:5], v[238:239] op_sel:[0,1] op_sel_hi:[1,1]
  v_pk_mul_f32 v[248:249], v[6:7], v[238:239] op_sel:[0,1] op_sel_hi:[1,1]
  v_pk_mul_f32 v[4:5], v[4:5], v[20:21]
  v_pk_mul_f32 v[6:7], v[6:7], v[22:23]
  v_rcp_f32 v242, v242
  v_mfma_f32_16x16x32_bf16 v[180:183], a[72:75], a[36:39], v[180:183]
  v_rcp_f32 v243, v243
  v_mfma_f32_16x16x32_bf16 v[180:183], a[76:79], a[52:55], v[180:183]
  v_rcp_f32 v244, v244
  v_mfma_f32_16x16x32_bf16 v[176:179], a[76:79], a[48:51], v[176:179]
  ds_read_b64_tr_b16 a[92:93], v225 offset:57344
  v_mfma_f32_16x16x32_bf16 v[176:179], a[72:75], a[32:35], v[176:179]
  ds_read_b64_tr_b16 a[94:95], v225 offset:61440
  s_waitcnt lgkmcnt(4)
  v_mfma_f32_16x16x32_bf16 v[32:35], a[80:83], a[224:227], v[32:35]
  v_exp_f32 v246, v246
  v_mfma_f32_16x16x32_bf16 v[32:35], a[84:87], a[240:243], v[32:35]
  v_exp_f32 v247, v247
  v_mfma_f32_16x16x32_bf16 v[36:39], a[84:87], a[244:247], v[36:39]
  ds_read_b64_tr_b16 a[64:65], v230 offset:32768
  ds_read_b64_tr_b16 a[66:67], v230 offset:36864
  v_mfma_f32_16x16x32_bf16 v[36:39], a[80:83], a[228:231], v[36:39]
  v_exp_f32 v248, v248
  v_exp_f32 v249, v249
  v_rcp_f32 v245, v245
  v_pk_fma_f32 v[246:247], v[246:247], v[232:233], v[232:233] op_sel:[0,1,1] op_sel_hi:[1,1,1]
  v_pk_fma_f32 v[248:249], v[248:249], v[232:233], v[232:233] op_sel:[0,1,1] op_sel_hi:[1,1,1]
  v_pk_mul_f32 v[0:1], v[0:1], v[242:243]
  v_pk_mul_f32 v[2:3], v[2:3], v[244:245]
  v_pk_mul_f32 v[242:243], v[8:9], v[240:241] op_sel:[0,0] op_sel_hi:[1,0]
  v_pk_mul_f32 v[244:245], v[10:11], v[240:241] op_sel:[0,0] op_sel_hi:[1,0]
  v_pk_mul_f32 v[8:9], v[8:9], v[24:25]
  v_pk_mul_f32 v[10:11], v[10:11], v[26:27]
  v_rcp_f32 v246, v246
  v_mfma_f32_16x16x32_bf16 v[40:43], a[80:83], a[232:235], v[40:43]
  v_rcp_f32 v247, v247
  v_mfma_f32_16x16x32_bf16 v[40:43], a[84:87], a[248:251], v[40:43]
  v_rcp_f32 v248, v248
  v_mfma_f32_16x16x32_bf16 v[44:47], a[84:87], a[252:255], v[44:47]
  ds_read_b64_tr_b16 a[68:69], v230 offset:40960
  v_cvt_pk_bf16_f32 v16, v0, v1
  v_mfma_f32_16x16x32_bf16 v[44:47], a[80:83], a[236:239], v[44:47]
  s_waitcnt lgkmcnt(3)
  ds_read_b64_tr_b16 a[70:71], v230 offset:45056
  v_cvt_pk_bf16_f32 v17, v2, v3
  v_mfma_f32_16x16x32_bf16 v[60:63], a[88:91], a[236:239], v[60:63]
  v_exp_f32 v242, v242
  v_mfma_f32_16x16x32_bf16 v[60:63], a[92:95], a[252:255], v[60:63]
  v_exp_f32 v243, v243
  v_mfma_f32_16x16x32_bf16 v[56:59], a[92:95], a[248:251], v[56:59]
  ds_read_b64_tr_b16 a[72:73], v230 offset:49152
  ds_read_b64_tr_b16 a[74:75], v230 offset:53248
  v_mfma_f32_16x16x32_bf16 v[56:59], a[88:91], a[232:235], v[56:59]
  v_exp_f32 v244, v244
  v_exp_f32 v245, v245
  v_rcp_f32 v249, v249
  v_pk_fma_f32 v[242:243], v[242:243], v[234:235], v[234:235] op_sel:[0,0,0] op_sel_hi:[1,0,0]
  v_pk_fma_f32 v[244:245], v[244:245], v[234:235], v[234:235] op_sel:[0,0,0] op_sel_hi:[1,0,0]
  v_pk_mul_f32 v[4:5], v[4:5], v[246:247]
  v_pk_mul_f32 v[6:7], v[6:7], v[248:249]
  v_pk_mul_f32 v[246:247], v[12:13], v[240:241] op_sel:[0,1] op_sel_hi:[1,1]
  v_pk_mul_f32 v[248:249], v[14:15], v[240:241] op_sel:[0,1] op_sel_hi:[1,1]
  v_pk_mul_f32 v[12:13], v[12:13], v[28:29]
  v_pk_mul_f32 v[14:15], v[14:15], v[30:31]
  v_rcp_f32 v242, v242
  v_mfma_f32_16x16x32_bf16 v[52:55], a[88:91], a[228:231], v[52:55]
  v_rcp_f32 v243, v243
  v_mfma_f32_16x16x32_bf16 v[52:55], a[92:95], a[244:247], v[52:55]
  v_rcp_f32 v244, v244
  v_mfma_f32_16x16x32_bf16 v[48:51], a[92:95], a[240:243], v[48:51]
  ds_read_b64_tr_b16 a[76:77], v230 offset:57344
  v_cvt_pk_bf16_f32 v20, v4, v5
  v_mfma_f32_16x16x32_bf16 v[48:51], a[88:91], a[224:227], v[48:51]
  s_waitcnt lgkmcnt(3)
  ds_read_b64_tr_b16 a[78:79], v230 offset:61440
  v_xor_b32 v230, 0x10000, v230
  v_cvt_pk_bf16_f32 v21, v6, v7
  v_mfma_f32_16x16x32_bf16 v[192:195], a[64:67], a[32:35], v[192:195]
  v_exp_f32 v246, v246
  v_mfma_f32_16x16x32_bf16 v[192:195], a[68:71], a[48:51], v[192:195]
  v_exp_f32 v247, v247
  v_mfma_f32_16x16x32_bf16 v[196:199], a[68:71], a[52:55], v[196:199]
  ds_read_b64_tr_b16 a[80:81], v226 offset:32768
  ds_read_b64_tr_b16 a[82:83], v226 offset:36864
  v_mfma_f32_16x16x32_bf16 v[196:199], a[64:67], a[36:39], v[196:199]
  v_exp_f32 v248, v248
  v_exp_f32 v249, v249
  v_rcp_f32 v245, v245
  v_pk_fma_f32 v[246:247], v[246:247], v[234:235], v[234:235] op_sel:[0,1,1] op_sel_hi:[1,1,1]
  v_pk_fma_f32 v[248:249], v[248:249], v[234:235], v[234:235] op_sel:[0,1,1] op_sel_hi:[1,1,1]
  v_pk_mul_f32 v[8:9], v[8:9], v[242:243]
  v_pk_mul_f32 v[10:11], v[10:11], v[244:245]
  v_pk_mul_f32 v[242:243], v[32:33], v[238:239] op_sel:[0,0] op_sel_hi:[1,0]
  v_pk_mul_f32 v[244:245], v[34:35], v[238:239] op_sel:[0,0] op_sel_hi:[1,0]
  v_pk_mul_f32 v[32:33], v[32:33], v[48:49]
  v_pk_mul_f32 v[34:35], v[34:35], v[50:51]
  v_rcp_f32 v246, v246
  v_mfma_f32_16x16x32_bf16 v[200:203], a[64:67], a[40:43], v[200:203]
  v_rcp_f32 v247, v247
  v_mfma_f32_16x16x32_bf16 v[200:203], a[68:71], a[56:59], v[200:203]
  v_rcp_f32 v248, v248
  v_mfma_f32_16x16x32_bf16 v[204:207], a[68:71], a[60:63], v[204:207]
  ds_read_b64_tr_b16 a[84:85], v226 offset:40960
  v_cvt_pk_bf16_f32 v24, v8, v9
  v_mfma_f32_16x16x32_bf16 v[204:207], a[64:67], a[44:47], v[204:207]
  s_waitcnt lgkmcnt(3)
  ds_read_b64_tr_b16 a[86:87], v226 offset:45056
  v_cvt_pk_bf16_f32 v25, v10, v11
  v_mfma_f32_16x16x32_bf16 v[220:223], a[72:75], a[44:47], v[220:223]
  v_exp_f32 v242, v242
  v_mfma_f32_16x16x32_bf16 v[220:223], a[76:79], a[60:63], v[220:223]
  v_exp_f32 v243, v243
  v_mfma_f32_16x16x32_bf16 v[216:219], a[76:79], a[56:59], v[216:219]
  ds_read_b64_tr_b16 a[88:89], v226 offset:49152
  ds_read_b64_tr_b16 a[90:91], v226 offset:53248
  v_mfma_f32_16x16x32_bf16 v[216:219], a[72:75], a[40:43], v[216:219]
  v_exp_f32 v244, v244
  v_exp_f32 v245, v245
  v_rcp_f32 v249, v249
  v_pk_fma_f32 v[242:243], v[242:243], v[232:233], v[232:233] op_sel:[0,0,0] op_sel_hi:[1,0,0]
  v_pk_fma_f32 v[244:245], v[244:245], v[232:233], v[232:233] op_sel:[0,0,0] op_sel_hi:[1,0,0]
  v_pk_mul_f32 v[12:13], v[12:13], v[246:247]
  v_pk_mul_f32 v[14:15], v[14:15], v[248:249]
  v_pk_mul_f32 v[246:247], v[36:37], v[238:239] op_sel:[0,1] op_sel_hi:[1,1]
  v_pk_mul_f32 v[248:249], v[38:39], v[238:239] op_sel:[0,1] op_sel_hi:[1,1]
  v_pk_mul_f32 v[36:37], v[36:37], v[52:53]
  v_pk_mul_f32 v[38:39], v[38:39], v[54:55]
  v_rcp_f32 v242, v242
  v_mfma_f32_16x16x32_bf16 v[212:215], a[72:75], a[36:39], v[212:215]
  v_rcp_f32 v243, v243
  v_mfma_f32_16x16x32_bf16 v[212:215], a[76:79], a[52:55], v[212:215]
  v_rcp_f32 v244, v244
  v_mfma_f32_16x16x32_bf16 v[208:211], a[76:79], a[48:51], v[208:211]
  ds_read_b64_tr_b16 a[92:93], v226 offset:57344
  v_cvt_pk_bf16_f32 v28, v12, v13
  v_mfma_f32_16x16x32_bf16 v[208:211], a[72:75], a[32:35], v[208:211]
  s_waitcnt lgkmcnt(3)
  ds_read_b64_tr_b16 a[94:95], v226 offset:61440
  v_cvt_pk_bf16_f32 v29, v14, v15
  v_mfma_f32_16x16x32_bf16 v[64:67], a[80:83], a[224:227], v[64:67]
  v_exp_f32 v246, v246
  v_mfma_f32_16x16x32_bf16 v[64:67], a[84:87], a[240:243], v[64:67]
  v_exp_f32 v247, v247
  v_mfma_f32_16x16x32_bf16 v[68:71], a[84:87], a[244:247], v[68:71]
  ds_read_b64_tr_b16 a[64:65], v227 offset:0
  ds_read_b64_tr_b16 a[66:67], v227 offset:4096
  v_mfma_f32_16x16x32_bf16 v[68:71], a[80:83], a[228:231], v[68:71]
  v_exp_f32 v248, v248
  v_exp_f32 v249, v249
  v_rcp_f32 v245, v245
  v_pk_fma_f32 v[246:247], v[246:247], v[232:233], v[232:233] op_sel:[0,1,1] op_sel_hi:[1,1,1]
  v_pk_fma_f32 v[248:249], v[248:249], v[232:233], v[232:233] op_sel:[0,1,1] op_sel_hi:[1,1,1]
  v_pk_mul_f32 v[32:33], v[32:33], v[242:243]
  v_pk_mul_f32 v[34:35], v[34:35], v[244:245]
  v_pk_mul_f32 v[242:243], v[40:41], v[240:241] op_sel:[0,0] op_sel_hi:[1,0]
  v_pk_mul_f32 v[244:245], v[42:43], v[240:241] op_sel:[0,0] op_sel_hi:[1,0]
  v_pk_mul_f32 v[40:41], v[40:41], v[56:57]
  v_pk_mul_f32 v[42:43], v[42:43], v[58:59]
  v_rcp_f32 v246, v246
  v_mfma_f32_16x16x32_bf16 v[72:75], a[80:83], a[232:235], v[72:75]
  v_rcp_f32 v247, v247
  v_mfma_f32_16x16x32_bf16 v[72:75], a[84:87], a[248:251], v[72:75]
  v_rcp_f32 v248, v248
  v_mfma_f32_16x16x32_bf16 v[76:79], a[84:87], a[252:255], v[76:79]
  ds_read_b64_tr_b16 a[68:69], v227 offset:8192
  v_cvt_pk_bf16_f32 v18, v32, v33
  v_mfma_f32_16x16x32_bf16 v[76:79], a[80:83], a[236:239], v[76:79]
  s_waitcnt lgkmcnt(3)
  ds_read_b64_tr_b16 a[70:71], v227 offset:12288
  v_cvt_pk_bf16_f32 v19, v34, v35
  v_mfma_f32_16x16x32_bf16 v[92:95], a[88:91], a[236:239], v[92:95]
  buffer_store_dwordx4 v[16:19], v231, s[4:7], s57 offen sc1
  s_add_u32 s57, s57, 16384
  v_exp_f32 v242, v242
  v_mfma_f32_16x16x32_bf16 v[92:95], a[92:95], a[252:255], v[92:95]
  v_exp_f32 v243, v243
  v_mfma_f32_16x16x32_bf16 v[88:91], a[92:95], a[248:251], v[88:91]
  ds_read_b64_tr_b16 a[72:73], v227 offset:16384
  ds_read_b64_tr_b16 a[74:75], v227 offset:20480
  v_mfma_f32_16x16x32_bf16 v[88:91], a[88:91], a[232:235], v[88:91]
  v_exp_f32 v244, v244
  v_exp_f32 v245, v245
  v_rcp_f32 v249, v249
  v_pk_fma_f32 v[242:243], v[242:243], v[234:235], v[234:235] op_sel:[0,0,0] op_sel_hi:[1,0,0]
  v_pk_fma_f32 v[244:245], v[244:245], v[234:235], v[234:235] op_sel:[0,0,0] op_sel_hi:[1,0,0]
  v_pk_mul_f32 v[36:37], v[36:37], v[246:247]
  v_pk_mul_f32 v[38:39], v[38:39], v[248:249]
  v_pk_mul_f32 v[246:247], v[44:45], v[240:241] op_sel:[0,1] op_sel_hi:[1,1]
  v_pk_mul_f32 v[248:249], v[46:47], v[240:241] op_sel:[0,1] op_sel_hi:[1,1]
  v_pk_mul_f32 v[44:45], v[44:45], v[60:61]
  v_pk_mul_f32 v[46:47], v[46:47], v[62:63]
  v_rcp_f32 v242, v242
  v_mfma_f32_16x16x32_bf16 v[84:87], a[88:91], a[228:231], v[84:87]
  v_rcp_f32 v243, v243
  v_mfma_f32_16x16x32_bf16 v[84:87], a[92:95], a[244:247], v[84:87]
  v_rcp_f32 v244, v244
  v_mfma_f32_16x16x32_bf16 v[80:83], a[92:95], a[240:243], v[80:83]
  ds_read_b64_tr_b16 a[76:77], v227 offset:24576
  v_cvt_pk_bf16_f32 v22, v36, v37
  v_mfma_f32_16x16x32_bf16 v[80:83], a[88:91], a[224:227], v[80:83]
  s_waitcnt lgkmcnt(3)
  ds_read_b64_tr_b16 a[78:79], v227 offset:28672
  v_cvt_pk_bf16_f32 v23, v38, v39
  v_mfma_f32_16x16x32_bf16 v[96:99], a[64:67], a[192:195], v[96:99]
  buffer_store_dwordx4 v[20:23], v231, s[4:7], s58 offen sc1
  s_add_u32 s58, s58, 16384
  v_exp_f32 v246, v246
  v_mfma_f32_16x16x32_bf16 v[96:99], a[68:71], a[208:211], v[96:99]
  v_exp_f32 v247, v247
  v_mfma_f32_16x16x32_bf16 v[100:103], a[68:71], a[212:215], v[100:103]
  ds_read_b64_tr_b16 a[80:81], v227 offset:32768
  ds_read_b64_tr_b16 a[82:83], v227 offset:36864
  v_mfma_f32_16x16x32_bf16 v[100:103], a[64:67], a[196:199], v[100:103]
  v_exp_f32 v248, v248
  v_exp_f32 v249, v249
  v_rcp_f32 v245, v245
  v_pk_fma_f32 v[246:247], v[246:247], v[234:235], v[234:235] op_sel:[0,1,1] op_sel_hi:[1,1,1]
  v_pk_fma_f32 v[248:249], v[248:249], v[234:235], v[234:235] op_sel:[0,1,1] op_sel_hi:[1,1,1]
  v_pk_mul_f32 v[40:41], v[40:41], v[242:243]
  v_pk_mul_f32 v[42:43], v[42:43], v[244:245]
  v_pk_mul_f32 v[242:243], v[64:65], v[238:239] op_sel:[0,0] op_sel_hi:[1,0]
  v_pk_mul_f32 v[244:245], v[66:67], v[238:239] op_sel:[0,0] op_sel_hi:[1,0]
  v_pk_mul_f32 v[64:65], v[64:65], v[80:81]
  v_pk_mul_f32 v[66:67], v[66:67], v[82:83]
  v_rcp_f32 v246, v246
  v_mfma_f32_16x16x32_bf16 v[104:107], a[64:67], a[200:203], v[104:107]
  v_rcp_f32 v247, v247
  v_mfma_f32_16x16x32_bf16 v[104:107], a[68:71], a[216:219], v[104:107]
  v_rcp_f32 v248, v248
  v_mfma_f32_16x16x32_bf16 v[108:111], a[68:71], a[220:223], v[108:111]
  ds_read_b64_tr_b16 a[84:85], v227 offset:40960
  v_cvt_pk_bf16_f32 v26, v40, v41
  v_mfma_f32_16x16x32_bf16 v[108:111], a[64:67], a[204:207], v[108:111]
  s_waitcnt lgkmcnt(3)
  ds_read_b64_tr_b16 a[86:87], v227 offset:45056
  v_cvt_pk_bf16_f32 v27, v42, v43
  v_mfma_f32_16x16x32_bf16 v[124:127], a[72:75], a[204:207], v[124:127]
  buffer_store_dwordx4 v[24:27], v231, s[4:7], s59 offen sc1
  s_add_u32 s59, s59, 16384
  v_exp_f32 v242, v242
  v_mfma_f32_16x16x32_bf16 v[124:127], a[76:79], a[220:223], v[124:127]
  v_exp_f32 v243, v243
  v_mfma_f32_16x16x32_bf16 v[120:123], a[76:79], a[216:219], v[120:123]
  ds_read_b64_tr_b16 a[88:89], v227 offset:49152
  ds_read_b64_tr_b16 a[90:91], v227 offset:53248
  v_mfma_f32_16x16x32_bf16 v[120:123], a[72:75], a[200:203], v[120:123]
  v_exp_f32 v244, v244
  v_exp_f32 v245, v245
  v_rcp_f32 v249, v249
  v_pk_fma_f32 v[242:243], v[242:243], v[232:233], v[232:233] op_sel:[0,0,0] op_sel_hi:[1,0,0]
  v_pk_fma_f32 v[244:245], v[244:245], v[232:233], v[232:233] op_sel:[0,0,0] op_sel_hi:[1,0,0]
  v_pk_mul_f32 v[44:45], v[44:45], v[246:247]
  v_pk_mul_f32 v[46:47], v[46:47], v[248:249]
  v_pk_mul_f32 v[246:247], v[68:69], v[238:239] op_sel:[0,1] op_sel_hi:[1,1]
  v_pk_mul_f32 v[248:249], v[70:71], v[238:239] op_sel:[0,1] op_sel_hi:[1,1]
  v_pk_mul_f32 v[68:69], v[68:69], v[84:85]
  v_pk_mul_f32 v[70:71], v[70:71], v[86:87]
  v_rcp_f32 v242, v242
  v_mfma_f32_16x16x32_bf16 v[116:119], a[72:75], a[196:199], v[116:119]
  v_rcp_f32 v243, v243
  v_mfma_f32_16x16x32_bf16 v[116:119], a[76:79], a[212:215], v[116:119]
  v_rcp_f32 v244, v244
  v_mfma_f32_16x16x32_bf16 v[112:115], a[76:79], a[208:211], v[112:115]
  ds_read_b64_tr_b16 a[92:93], v227 offset:57344
  v_cvt_pk_bf16_f32 v30, v44, v45
  v_mfma_f32_16x16x32_bf16 v[112:115], a[72:75], a[192:195], v[112:115]
  s_waitcnt lgkmcnt(3)
  ds_read_b64_tr_b16 a[94:95], v227 offset:61440
  v_cvt_pk_bf16_f32 v31, v46, v47
  v_mfma_f32_16x16x32_bf16 v[96:99], a[80:83], a[224:227], v[96:99]
  buffer_store_dwordx4 v[28:31], v231, s[4:7], s60 offen sc1
  s_add_u32 s60, s60, 16384
  v_exp_f32 v246, v246
  v_mfma_f32_16x16x32_bf16 v[96:99], a[84:87], a[240:243], v[96:99]
  v_exp_f32 v247, v247
  v_mfma_f32_16x16x32_bf16 v[100:103], a[84:87], a[244:247], v[100:103]
  ds_read_b64_tr_b16 a[64:65], v228 offset:0
  ds_read_b64_tr_b16 a[66:67], v228 offset:4096
  v_mfma_f32_16x16x32_bf16 v[100:103], a[80:83], a[228:231], v[100:103]
  v_exp_f32 v248, v248
  v_exp_f32 v249, v249
  v_rcp_f32 v245, v245
  v_pk_fma_f32 v[246:247], v[246:247], v[232:233], v[232:233] op_sel:[0,1,1] op_sel_hi:[1,1,1]
  v_pk_fma_f32 v[248:249], v[248:249], v[232:233], v[232:233] op_sel:[0,1,1] op_sel_hi:[1,1,1]
  v_pk_mul_f32 v[64:65], v[64:65], v[242:243]
  v_pk_mul_f32 v[66:67], v[66:67], v[244:245]
  v_pk_mul_f32 v[242:243], v[72:73], v[240:241] op_sel:[0,0] op_sel_hi:[1,0]
  v_pk_mul_f32 v[244:245], v[74:75], v[240:241] op_sel:[0,0] op_sel_hi:[1,0]
  v_pk_mul_f32 v[72:73], v[72:73], v[88:89]
  v_pk_mul_f32 v[74:75], v[74:75], v[90:91]
  v_rcp_f32 v246, v246
  v_mfma_f32_16x16x32_bf16 v[104:107], a[80:83], a[232:235], v[104:107]
  v_rcp_f32 v247, v247
  v_lshlrev_b32 v8, 4, v253
  v_mfma_f32_16x16x32_bf16 v[104:107], a[84:87], a[248:251], v[104:107]
  v_rcp_f32 v248, v248
  v_add_u32 v9, 114688, v8
  v_mfma_f32_16x16x32_bf16 v[108:111], a[84:87], a[252:255], v[108:111]
  ds_read_b64_tr_b16 a[68:69], v228 offset:8192
  v_cvt_pk_bf16_f32 v80, v64, v65
  v_mfma_f32_16x16x32_bf16 v[108:111], a[80:83], a[236:239], v[108:111]
  s_waitcnt lgkmcnt(3)
  ds_read_b64_tr_b16 a[70:71], v228 offset:12288
  v_cvt_pk_bf16_f32 v81, v66, v67
  v_mfma_f32_16x16x32_bf16 v[124:127], a[88:91], a[236:239], v[124:127]
  buffer_load_dwordx4 v[16:19], v8, s[4:7], s46 offen offset:0 sc1
  v_exp_f32 v242, v242
  v_mfma_f32_16x16x32_bf16 v[124:127], a[92:95], a[252:255], v[124:127]
  buffer_load_dwordx4 v[20:23], v8, s[4:7], s46 offen offset:1024 sc1
  v_exp_f32 v243, v243
  v_mfma_f32_16x16x32_bf16 v[120:123], a[92:95], a[248:251], v[120:123]
  ds_read_b64_tr_b16 a[72:73], v228 offset:16384
  ds_read_b64_tr_b16 a[74:75], v228 offset:20480
  v_mfma_f32_16x16x32_bf16 v[120:123], a[88:91], a[232:235], v[120:123]
  v_exp_f32 v244, v244
  v_exp_f32 v245, v245
  v_rcp_f32 v249, v249
  v_pk_fma_f32 v[242:243], v[242:243], v[234:235], v[234:235] op_sel:[0,0,0] op_sel_hi:[1,0,0]
  v_pk_fma_f32 v[244:245], v[244:245], v[234:235], v[234:235] op_sel:[0,0,0] op_sel_hi:[1,0,0]
  v_pk_mul_f32 v[68:69], v[68:69], v[246:247]
  v_pk_mul_f32 v[70:71], v[70:71], v[248:249]
  v_pk_mul_f32 v[246:247], v[76:77], v[240:241] op_sel:[0,1] op_sel_hi:[1,1]
  v_pk_mul_f32 v[248:249], v[78:79], v[240:241] op_sel:[0,1] op_sel_hi:[1,1]
  v_pk_mul_f32 v[76:77], v[76:77], v[92:93]
  v_pk_mul_f32 v[78:79], v[78:79], v[94:95]
  v_rcp_f32 v242, v242
  v_mfma_f32_16x16x32_bf16 v[116:119], a[88:91], a[228:231], v[116:119]
  buffer_load_dwordx4 v[24:27], v8, s[4:7], s47 offen offset:0 sc1
  v_rcp_f32 v243, v243
  v_mfma_f32_16x16x32_bf16 v[116:119], a[92:95], a[244:247], v[116:119]
  buffer_load_dwordx4 v[28:31], v8, s[4:7], s47 offen offset:1024 sc1
  v_rcp_f32 v244, v244
  v_mfma_f32_16x16x32_bf16 v[112:115], a[92:95], a[240:243], v[112:115]
  ds_read_b64_tr_b16 a[76:77], v228 offset:24576
  v_cvt_pk_bf16_f32 v84, v68, v69
  v_mfma_f32_16x16x32_bf16 v[112:115], a[88:91], a[224:227], v[112:115]
  s_waitcnt lgkmcnt(3)
  ds_read_b64_tr_b16 a[78:79], v228 offset:28672
  v_cvt_pk_bf16_f32 v85, v70, v71
  v_mfma_f32_16x16x32_bf16 v[128:131], a[64:67], a[192:195], v[128:131]
  v_exp_f32 v246, v246
  v_bfe_u32 v11, v253, 2, 3
  v_mfma_f32_16x16x32_bf16 v[128:131], a[68:71], a[208:211], v[128:131]
  v_exp_f32 v247, v247
  v_bfe_u32 v12, v253, 3, 2
  v_mfma_f32_16x16x32_bf16 v[132:135], a[68:71], a[212:215], v[132:135]
  ds_read_b64_tr_b16 a[80:81], v228 offset:32768
  ds_read_b64_tr_b16 a[82:83], v228 offset:36864
  v_mfma_f32_16x16x32_bf16 v[132:135], a[64:67], a[196:199], v[132:135]
  v_exp_f32 v248, v248
  v_exp_f32 v249, v249
  v_rcp_f32 v245, v245
  v_pk_fma_f32 v[246:247], v[246:247], v[234:235], v[234:235] op_sel:[0,1,1] op_sel_hi:[1,1,1]
  v_pk_fma_f32 v[248:249], v[248:249], v[234:235], v[234:235] op_sel:[0,1,1] op_sel_hi:[1,1,1]
  v_pk_mul_f32 v[72:73], v[72:73], v[242:243]
  v_pk_mul_f32 v[74:75], v[74:75], v[244:245]
  v_pk_mul_f32 v[242:243], v[96:97], v[238:239] op_sel:[0,0] op_sel_hi:[1,0]
  v_pk_mul_f32 v[244:245], v[98:99], v[238:239] op_sel:[0,0] op_sel_hi:[1,0]
  v_pk_mul_f32 v[96:97], v[96:97], v[112:113]
  v_pk_mul_f32 v[98:99], v[98:99], v[114:115]
  v_rcp_f32 v246, v246
  v_mfma_f32_16x16x32_bf16 v[136:139], a[64:67], a[200:203], v[136:139]
  v_rcp_f32 v247, v247
  v_and_b32 v13, 3, v253
  v_mfma_f32_16x16x32_bf16 v[136:139], a[68:71], a[216:219], v[136:139]
  v_rcp_f32 v248, v248
  v_lshlrev_b32 v13, 3, v13
  v_mfma_f32_16x16x32_bf16 v[140:143], a[68:71], a[220:223], v[140:143]
  ds_read_b64_tr_b16 a[84:85], v228 offset:40960
  v_cvt_pk_bf16_f32 v88, v72, v73
  v_mfma_f32_16x16x32_bf16 v[140:143], a[64:67], a[204:207], v[140:143]
  s_waitcnt lgkmcnt(3)
  ds_read_b64_tr_b16 a[86:87], v228 offset:45056
  v_cvt_pk_bf16_f32 v89, v74, v75
  v_mfma_f32_16x16x32_bf16 v[156:159], a[72:75], a[204:207], v[156:159]
  v_exp_f32 v242, v242
  v_lshl_add_u32 v13, v11, 7, v13
  v_mfma_f32_16x16x32_bf16 v[156:159], a[76:79], a[220:223], v[156:159]
  v_exp_f32 v243, v243
  v_lshrrev_b32 v11, 5, v253
  v_mfma_f32_16x16x32_bf16 v[152:155], a[76:79], a[216:219], v[152:155]
  ds_read_b64_tr_b16 a[88:89], v228 offset:49152
  ds_read_b64_tr_b16 a[90:91], v228 offset:53248
  v_mfma_f32_16x16x32_bf16 v[152:155], a[72:75], a[200:203], v[152:155]
  v_exp_f32 v244, v244
  v_exp_f32 v245, v245
  v_rcp_f32 v249, v249
  v_pk_fma_f32 v[242:243], v[242:243], v[232:233], v[232:233] op_sel:[0,0,0] op_sel_hi:[1,0,0]
  v_pk_fma_f32 v[244:245], v[244:245], v[232:233], v[232:233] op_sel:[0,0,0] op_sel_hi:[1,0,0]
  v_pk_mul_f32 v[76:77], v[76:77], v[246:247]
  v_pk_mul_f32 v[78:79], v[78:79], v[248:249]
  v_pk_mul_f32 v[246:247], v[100:101], v[238:239] op_sel:[0,1] op_sel_hi:[1,1]
  v_pk_mul_f32 v[248:249], v[102:103], v[238:239] op_sel:[0,1] op_sel_hi:[1,1]
  v_pk_mul_f32 v[100:101], v[100:101], v[116:117]
  v_pk_mul_f32 v[102:103], v[102:103], v[118:119]
  v_rcp_f32 v242, v242
  v_mfma_f32_16x16x32_bf16 v[148:151], a[72:75], a[196:199], v[148:151]
  s_waitcnt vmcnt(4)
  s_barrier
  s_cmp_lg_u32 s40, 0
  s_cbranch_scc1 Lsgf17
  v_mov_b32 v250, 1
  s_mov_b64 exec, 1
  buffer_atomic_add v250, v251, s[4:7], s77 offen sc1
  s_mov_b64 exec, -1
Lsgf17:
  s_add_u32 s77, s77, 2048
  v_rcp_f32 v243, v243
  v_lshl_add_u32 v13, v11, 11, v13
  v_mfma_f32_16x16x32_bf16 v[148:151], a[76:79], a[212:215], v[148:151]
  s_add_u32 m0, s79, 32768
  v_rcp_f32 v244, v244
  v_xor_b32 v11, 0, v12
  v_mfma_f32_16x16x32_bf16 v[144:147], a[76:79], a[208:211], v[144:147]
  s_add_u32 s92, s92, 196608
  ds_read_b64_tr_b16 a[92:93], v228 offset:57344
  v_cvt_pk_bf16_f32 v92, v76, v77
  v_mfma_f32_16x16x32_bf16 v[144:147], a[72:75], a[192:195], v[144:147]
  s_waitcnt lgkmcnt(3)
  ds_read_b64_tr_b16 a[94:95], v228 offset:61440
  v_cvt_pk_bf16_f32 v93, v78, v79
  v_mfma_f32_16x16x32_bf16 v[128:131], a[80:83], a[224:227], v[128:131]
  buffer_load_dwordx4 v252, s[80:83], s92 offen lds
  v_exp_f32 v246, v246
  v_mfma_f32_16x16x32_bf16 v[128:131], a[84:87], a[240:243], v[128:131]
  buffer_load_dwordx4 v252, s[84:87], s92 offen offset:1024 lds
  v_exp_f32 v247, v247
  v_mfma_f32_16x16x32_bf16 v[132:135], a[84:87], a[244:247], v[132:135]
  ds_read_b64_tr_b16 a[64:65], v229 offset:0
  ds_read_b64_tr_b16 a[66:67], v229 offset:4096
  v_mfma_f32_16x16x32_bf16 v[132:135], a[80:83], a[228:231], v[132:135]
  v_exp_f32 v248, v248
  v_exp_f32 v249, v249
  v_rcp_f32 v245, v245
  v_pk_fma_f32 v[246:247], v[246:247], v[232:233], v[232:233] op_sel:[0,1,1] op_sel_hi:[1,1,1]
  v_pk_fma_f32 v[248:249], v[248:249], v[232:233], v[232:233] op_sel:[0,1,1] op_sel_hi:[1,1,1]
  v_pk_mul_f32 v[96:97], v[96:97], v[242:243]
  v_pk_mul_f32 v[98:99], v[98:99], v[244:245]
  v_pk_mul_f32 v[242:243], v[104:105], v[240:241] op_sel:[0,0] op_sel_hi:[1,0]
  v_pk_mul_f32 v[244:245], v[106:107], v[240:241] op_sel:[0,0] op_sel_hi:[1,0]
  v_pk_mul_f32 v[104:105], v[104:105], v[120:121]
  v_pk_mul_f32 v[106:107], v[106:107], v[122:123]
  v_rcp_f32 v246, v246
  v_mfma_f32_16x16x32_bf16 v[136:139], a[80:83], a[232:235], v[136:139]
  s_add_u32 m0, s79, 40960
  v_rcp_f32 v247, v247
  v_lshl_add_u32 v0, v11, 5, v13
  v_mfma_f32_16x16x32_bf16 v[136:139], a[84:87], a[248:251], v[136:139]
  s_add_u32 s92, s92, 262144
  buffer_load_dwordx4 v252, s[80:83], s92 offen lds
  v_rcp_f32 v248, v248
  v_mfma_f32_16x16x32_bf16 v[140:143], a[84:87], a[252:255], v[140:143]
  ds_read_b64_tr_b16 a[68:69], v229 offset:8192
  v_cvt_pk_bf16_f32 v82, v96, v97
  v_mfma_f32_16x16x32_bf16 v[140:143], a[80:83], a[236:239], v[140:143]
  s_waitcnt lgkmcnt(3)
  ds_read_b64_tr_b16 a[70:71], v229 offset:12288
  v_cvt_pk_bf16_f32 v83, v98, v99
  v_mfma_f32_16x16x32_bf16 v[156:159], a[88:91], a[236:239], v[156:159]
  buffer_load_dwordx4 v252, s[84:87], s92 offen offset:1024 lds
  buffer_store_dwordx4 v[80:83], v231, s[4:7], s57 offen sc1
  s_add_u32 s57, s57, 16384
  v_exp_f32 v242, v242
  v_mfma_f32_16x16x32_bf16 v[156:159], a[92:95], a[252:255], v[156:159]
  v_exp_f32 v243, v243
  v_add_u32 v4, 0x10000, v0
  v_mfma_f32_16x16x32_bf16 v[152:155], a[92:95], a[248:251], v[152:155]
  ds_read_b64_tr_b16 a[72:73], v229 offset:16384
  ds_read_b64_tr_b16 a[74:75], v229 offset:20480
  v_mfma_f32_16x16x32_bf16 v[152:155], a[88:91], a[232:235], v[152:155]
  v_exp_f32 v244, v244
  v_exp_f32 v245, v245
  v_rcp_f32 v249, v249
  v_pk_fma_f32 v[242:243], v[242:243], v[234:235], v[234:235] op_sel:[0,0,0] op_sel_hi:[1,0,0]
  v_pk_fma_f32 v[244:245], v[244:245], v[234:235], v[234:235] op_sel:[0,0,0] op_sel_hi:[1,0,0]
  v_pk_mul_f32 v[100:101], v[100:101], v[246:247]
  v_pk_mul_f32 v[102:103], v[102:103], v[248:249]
  v_pk_mul_f32 v[246:247], v[108:109], v[240:241] op_sel:[0,1] op_sel_hi:[1,1]
  v_pk_mul_f32 v[248:249], v[110:111], v[240:241] op_sel:[0,1] op_sel_hi:[1,1]
  v_pk_mul_f32 v[108:109], v[108:109], v[124:125]
  v_pk_mul_f32 v[110:111], v[110:111], v[126:127]
  v_rcp_f32 v242, v242
  v_mfma_f32_16x16x32_bf16 v[148:151], a[88:91], a[228:231], v[148:151]
  s_add_u32 m0, s79, 49152
  v_rcp_f32 v243, v243
  v_xor_b32 v11, 1, v12
  v_mfma_f32_16x16x32_bf16 v[148:151], a[92:95], a[244:247], v[148:151]
  s_add_u32 s92, s92, 196608
  buffer_load_dwordx4 v252, s[80:83], s92 offen lds
  v_rcp_f32 v244, v244
  v_mfma_f32_16x16x32_bf16 v[144:147], a[92:95], a[240:243], v[144:147]
  ds_read_b64_tr_b16 a[76:77], v229 offset:24576
  v_cvt_pk_bf16_f32 v86, v100, v101
  v_mfma_f32_16x16x32_bf16 v[144:147], a[88:91], a[224:227], v[144:147]
  s_waitcnt lgkmcnt(3)
  ds_read_b64_tr_b16 a[78:79], v229 offset:28672
  v_cvt_pk_bf16_f32 v87, v102, v103
  v_mfma_f32_16x16x32_bf16 v[160:163], a[64:67], a[192:195], v[160:163]
  buffer_load_dwordx4 v252, s[84:87], s92 offen offset:1024 lds
  buffer_store_dwordx4 v[84:87], v231, s[4:7], s58 offen sc1
  s_add_u32 s58, s58, 16384
  v_exp_f32 v246, v246
  v_mfma_f32_16x16x32_bf16 v[160:163], a[68:71], a[208:211], v[160:163]
  v_exp_f32 v247, v247
  v_lshl_add_u32 v1, v11, 5, v13
  v_mfma_f32_16x16x32_bf16 v[164:167], a[68:71], a[212:215], v[164:167]
  ds_read_b64_tr_b16 a[80:81], v229 offset:32768
  ds_read_b64_tr_b16 a[82:83], v229 offset:36864
  v_mfma_f32_16x16x32_bf16 v[164:167], a[64:67], a[196:199], v[164:167]
  v_exp_f32 v248, v248
  v_exp_f32 v249, v249
  v_rcp_f32 v245, v245
  v_pk_fma_f32 v[246:247], v[246:247], v[234:235], v[234:235] op_sel:[0,1,1] op_sel_hi:[1,1,1]
  v_pk_fma_f32 v[248:249], v[248:249], v[234:235], v[234:235] op_sel:[0,1,1] op_sel_hi:[1,1,1]
  v_pk_mul_f32 v[104:105], v[104:105], v[242:243]
  v_pk_mul_f32 v[106:107], v[106:107], v[244:245]
  v_pk_mul_f32 v[242:243], v[128:129], v[238:239] op_sel:[0,0] op_sel_hi:[1,0]
  v_pk_mul_f32 v[244:245], v[130:131], v[238:239] op_sel:[0,0] op_sel_hi:[1,0]
  v_pk_mul_f32 v[128:129], v[128:129], v[144:145]
  v_pk_mul_f32 v[130:131], v[130:131], v[146:147]
  v_rcp_f32 v246, v246
  v_mfma_f32_16x16x32_bf16 v[168:171], a[64:67], a[200:203], v[168:171]
  s_add_u32 m0, s79, 57344
  v_rcp_f32 v247, v247
  v_add_u32 v5, 0x10000, v1
  v_mfma_f32_16x16x32_bf16 v[168:171], a[68:71], a[216:219], v[168:171]
  s_add_u32 s92, s92, 262144
  buffer_load_dwordx4 v252, s[80:83], s92 offen lds
  v_rcp_f32 v248, v248
  v_mfma_f32_16x16x32_bf16 v[172:175], a[68:71], a[220:223], v[172:175]
  ds_read_b64_tr_b16 a[84:85], v229 offset:40960
  v_cvt_pk_bf16_f32 v90, v104, v105
  v_mfma_f32_16x16x32_bf16 v[172:175], a[64:67], a[204:207], v[172:175]
  s_waitcnt lgkmcnt(3)
  ds_read_b64_tr_b16 a[86:87], v229 offset:45056
  v_cvt_pk_bf16_f32 v91, v106, v107
  v_mfma_f32_16x16x32_bf16 v[188:191], a[72:75], a[204:207], v[188:191]
  buffer_load_dwordx4 v252, s[84:87], s92 offen offset:1024 lds
  buffer_store_dwordx4 v[88:91], v231, s[4:7], s59 offen sc1
  s_add_u32 s59, s59, 16384
  v_exp_f32 v242, v242
  v_mfma_f32_16x16x32_bf16 v[188:191], a[76:79], a[220:223], v[188:191]
  v_exp_f32 v243, v243
  v_xor_b32 v11, 2, v12
  v_mfma_f32_16x16x32_bf16 v[184:187], a[76:79], a[216:219], v[184:187]
  ds_read_b64_tr_b16 a[88:89], v229 offset:49152
  ds_read_b64_tr_b16 a[90:91], v229 offset:53248
  v_mfma_f32_16x16x32_bf16 v[184:187], a[72:75], a[200:203], v[184:187]
  v_exp_f32 v244, v244
  v_exp_f32 v245, v245
  v_rcp_f32 v249, v249
  v_pk_fma_f32 v[242:243], v[242:243], v[232:233], v[232:233] op_sel:[0,0,0] op_sel_hi:[1,0,0]
  v_pk_fma_f32 v[244:245], v[244:245], v[232:233], v[232:233] op_sel:[0,0,0] op_sel_hi:[1,0,0]
  v_pk_mul_f32 v[108:109], v[108:109], v[246:247]
  v_pk_mul_f32 v[110:111], v[110:111], v[248:249]
  v_pk_mul_f32 v[246:247], v[132:133], v[238:239] op_sel:[0,1] op_sel_hi:[1,1]
  v_pk_mul_f32 v[248:249], v[134:135], v[238:239] op_sel:[0,1] op_sel_hi:[1,1]
  v_pk_mul_f32 v[132:133], v[132:133], v[148:149]
  v_pk_mul_f32 v[134:135], v[134:135], v[150:151]
  v_rcp_f32 v242, v242
  v_mfma_f32_16x16x32_bf16 v[180:183], a[72:75], a[196:199], v[180:183]
  buffer_load_dword v10, v251, s[4:7], s64 offen sc1
  v_rcp_f32 v243, v243
  v_mfma_f32_16x16x32_bf16 v[180:183], a[76:79], a[212:215], v[180:183]
  v_rcp_f32 v244, v244
  v_lshl_add_u32 v2, v11, 5, v13
  v_mfma_f32_16x16x32_bf16 v[176:179], a[76:79], a[208:211], v[176:179]
  ds_read_b64_tr_b16 a[92:93], v229 offset:57344
  v_cvt_pk_bf16_f32 v94, v108, v109
  v_mfma_f32_16x16x32_bf16 v[176:179], a[72:75], a[192:195], v[176:179]
  s_waitcnt lgkmcnt(3)
  ds_read_b64_tr_b16 a[94:95], v229 offset:61440
  v_cvt_pk_bf16_f32 v95, v110, v111
  v_mfma_f32_16x16x32_bf16 v[160:163], a[80:83], a[224:227], v[160:163]
  buffer_store_dwordx4 v[92:95], v231, s[4:7], s60 offen sc1
  s_add_u32 s60, s60, 16384
  v_exp_f32 v246, v246
  v_mfma_f32_16x16x32_bf16 v[160:163], a[84:87], a[240:243], v[160:163]
  v_exp_f32 v247, v247
  v_add_u32 v6, 0x10000, v2
  v_mfma_f32_16x16x32_bf16 v[164:167], a[84:87], a[244:247], v[164:167]
  ds_read_b64_tr_b16 a[64:65], v230 offset:0
  ds_read_b64_tr_b16 a[66:67], v230 offset:4096
  v_mfma_f32_16x16x32_bf16 v[164:167], a[80:83], a[228:231], v[164:167]
  v_exp_f32 v248, v248
  v_exp_f32 v249, v249
  v_rcp_f32 v245, v245
  v_pk_fma_f32 v[246:247], v[246:247], v[232:233], v[232:233] op_sel:[0,1,1] op_sel_hi:[1,1,1]
  v_pk_fma_f32 v[248:249], v[248:249], v[232:233], v[232:233] op_sel:[0,1,1] op_sel_hi:[1,1,1]
  v_pk_mul_f32 v[128:129], v[128:129], v[242:243]
  v_pk_mul_f32 v[130:131], v[130:131], v[244:245]
  v_pk_mul_f32 v[242:243], v[136:137], v[240:241] op_sel:[0,0] op_sel_hi:[1,0]
  v_pk_mul_f32 v[244:245], v[138:139], v[240:241] op_sel:[0,0] op_sel_hi:[1,0]
  v_pk_mul_f32 v[136:137], v[136:137], v[152:153]
  v_pk_mul_f32 v[138:139], v[138:139], v[154:155]
  v_rcp_f32 v246, v246
  v_mfma_f32_16x16x32_bf16 v[168:171], a[80:83], a[232:235], v[168:171]
  v_rcp_f32 v247, v247
  v_xor_b32 v11, 3, v12
  v_mfma_f32_16x16x32_bf16 v[168:171], a[84:87], a[248:251], v[168:171]
  v_rcp_f32 v248, v248
  v_lshl_add_u32 v3, v11, 5, v13
  v_mfma_f32_16x16x32_bf16 v[172:175], a[84:87], a[252:255], v[172:175]
  ds_read_b64_tr_b16 a[68:69], v230 offset:8192
  v_cvt_pk_bf16_f32 v144, v128, v129
  v_mfma_f32_16x16x32_bf16 v[172:175], a[80:83], a[236:239], v[172:175]
  s_waitcnt lgkmcnt(3)
  ds_read_b64_tr_b16 a[70:71], v230 offset:12288
  v_cvt_pk_bf16_f32 v145, v130, v131
  v_mfma_f32_16x16x32_bf16 v[188:191], a[88:91], a[236:239], v[188:191]
  v_exp_f32 v242, v242
  v_add_u32 v7, 0x10000, v3
  v_mfma_f32_16x16x32_bf16 v[188:191], a[92:95], a[252:255], v[188:191]
  v_exp_f32 v243, v243
  v_mfma_f32_16x16x32_bf16 v[184:187], a[92:95], a[248:251], v[184:187]
  ds_read_b64_tr_b16 a[72:73], v230 offset:16384
  ds_read_b64_tr_b16 a[74:75], v230 offset:20480
  v_mfma_f32_16x16x32_bf16 v[184:187], a[88:91], a[232:235], v[184:187]
  v_exp_f32 v244, v244
  v_exp_f32 v245, v245
  v_rcp_f32 v249, v249
  v_pk_fma_f32 v[242:243], v[242:243], v[234:235], v[234:235] op_sel:[0,0,0] op_sel_hi:[1,0,0]
  v_pk_fma_f32 v[244:245], v[244:245], v[234:235], v[234:235] op_sel:[0,0,0] op_sel_hi:[1,0,0]
  v_pk_mul_f32 v[132:133], v[132:133], v[246:247]
  v_pk_mul_f32 v[134:135], v[134:135], v[248:249]
  v_pk_mul_f32 v[246:247], v[140:141], v[240:241] op_sel:[0,1] op_sel_hi:[1,1]
  v_pk_mul_f32 v[248:249], v[142:143], v[240:241] op_sel:[0,1] op_sel_hi:[1,1]
  v_pk_mul_f32 v[140:141], v[140:141], v[156:157]
  v_pk_mul_f32 v[142:143], v[142:143], v[158:159]
  v_rcp_f32 v242, v242
  v_mfma_f32_16x16x32_bf16 v[180:183], a[88:91], a[228:231], v[180:183]
  v_rcp_f32 v243, v243
  v_mfma_f32_16x16x32_bf16 v[180:183], a[92:95], a[244:247], v[180:183]
  v_rcp_f32 v244, v244
  v_mfma_f32_16x16x32_bf16 v[176:179], a[92:95], a[240:243], v[176:179]
  ds_read_b64_tr_b16 a[76:77], v230 offset:24576
  v_cvt_pk_bf16_f32 v148, v132, v133
  v_mfma_f32_16x16x32_bf16 v[176:179], a[88:91], a[224:227], v[176:179]
  s_waitcnt lgkmcnt(3)
  ds_read_b64_tr_b16 a[78:79], v230 offset:28672
  v_cvt_pk_bf16_f32 v149, v134, v135
  v_mfma_f32_16x16x32_bf16 v[192:195], a[64:67], a[192:195], v[192:195]
  v_exp_f32 v246, v246
  v_mfma_f32_16x16x32_bf16 v[192:195], a[68:71], a[208:211], v[192:195]
  v_exp_f32 v247, v247
  v_mfma_f32_16x16x32_bf16 v[196:199], a[68:71], a[212:215], v[196:199]
  ds_read_b64_tr_b16 a[80:81], v230 offset:32768
  ds_read_b64_tr_b16 a[82:83], v230 offset:36864
  v_mfma_f32_16x16x32_bf16 v[196:199], a[64:67], a[196:199], v[196:199]
  v_exp_f32 v248, v248
  v_exp_f32 v249, v249
  v_rcp_f32 v245, v245
  v_pk_fma_f32 v[246:247], v[246:247], v[234:235], v[234:235] op_sel:[0,1,1] op_sel_hi:[1,1,1]
  v_pk_fma_f32 v[248:249], v[248:249], v[234:235], v[234:235] op_sel:[0,1,1] op_sel_hi:[1,1,1]
  v_pk_mul_f32 v[136:137], v[136:137], v[242:243]
  v_pk_mul_f32 v[138:139], v[138:139], v[244:245]
  v_pk_mul_f32 v[242:243], v[160:161], v[238:239] op_sel:[0,0] op_sel_hi:[1,0]
  v_pk_mul_f32 v[244:245], v[162:163], v[238:239] op_sel:[0,0] op_sel_hi:[1,0]
  v_pk_mul_f32 v[160:161], v[160:161], v[176:177]
  v_pk_mul_f32 v[162:163], v[162:163], v[178:179]
  v_rcp_f32 v246, v246
  v_mfma_f32_16x16x32_bf16 v[200:203], a[64:67], a[200:203], v[200:203]
  s_waitcnt vmcnt(1)
  v_cmp_gt_u32 vcc, 16, v10
  s_cbranch_vccz Lp4a_ok
  s_mov_b32 s43, 0x40000
Lp4a_sp:
  s_sleep 10
  buffer_load_dword v10, v251, s[4:7], s64 offen sc1
  s_waitcnt vmcnt(0)
  v_cmp_gt_u32 vcc, 16, v10
  s_cbranch_vccz Lp4a_ok
  s_sub_u32 s43, s43, 1
  s_cmp_lg_u32 s43, 0
  s_cbranch_scc1 Lp4a_sp
Lp4a_ok:
  s_add_u32 s64, s64, 2048
  buffer_load_dwordx4 a[128:131], v8, s[4:7], s48 offen offset:0 sc1
  v_rcp_f32 v247, v247
  v_mfma_f32_16x16x32_bf16 v[200:203], a[68:71], a[216:219], v[200:203]
  buffer_load_dwordx4 a[132:135], v9, s[4:7], s48 offen offset:0 sc1
  v_rcp_f32 v248, v248
  v_mfma_f32_16x16x32_bf16 v[204:207], a[68:71], a[220:223], v[204:207]
  ds_read_b64_tr_b16 a[84:85], v230 offset:40960
  v_cvt_pk_bf16_f32 v152, v136, v137
  v_mfma_f32_16x16x32_bf16 v[204:207], a[64:67], a[204:207], v[204:207]
  s_waitcnt lgkmcnt(3)
  ds_read_b64_tr_b16 a[86:87], v230 offset:45056
  v_cvt_pk_bf16_f32 v153, v138, v139
  v_mfma_f32_16x16x32_bf16 v[220:223], a[72:75], a[204:207], v[220:223]
  buffer_load_dwordx4 a[136:139], v8, s[4:7], s48 offen offset:1024 sc1
  v_exp_f32 v242, v242
  v_mfma_f32_16x16x32_bf16 v[220:223], a[76:79], a[220:223], v[220:223]
  v_exp_f32 v243, v243
  v_mfma_f32_16x16x32_bf16 v[216:219], a[76:79], a[216:219], v[216:219]
  ds_read_b64_tr_b16 a[88:89], v230 offset:49152
  ds_read_b64_tr_b16 a[90:91], v230 offset:53248
  v_mfma_f32_16x16x32_bf16 v[216:219], a[72:75], a[200:203], v[216:219]
  v_exp_f32 v244, v244
  v_exp_f32 v245, v245
  v_rcp_f32 v249, v249
  v_pk_fma_f32 v[242:243], v[242:243], v[232:233], v[232:233] op_sel:[0,0,0] op_sel_hi:[1,0,0]
  v_pk_fma_f32 v[244:245], v[244:245], v[232:233], v[232:233] op_sel:[0,0,0] op_sel_hi:[1,0,0]
  v_pk_mul_f32 v[140:141], v[140:141], v[246:247]
  v_pk_mul_f32 v[142:143], v[142:143], v[248:249]
  v_pk_mul_f32 v[246:247], v[164:165], v[238:239] op_sel:[0,1] op_sel_hi:[1,1]
  v_pk_mul_f32 v[248:249], v[166:167], v[238:239] op_sel:[0,1] op_sel_hi:[1,1]
  v_pk_mul_f32 v[164:165], v[164:165], v[180:181]
  v_pk_mul_f32 v[166:167], v[166:167], v[182:183]
  v_rcp_f32 v242, v242
  v_mfma_f32_16x16x32_bf16 v[212:215], a[72:75], a[196:199], v[212:215]
  buffer_load_dwordx4 a[140:143], v9, s[4:7], s48 offen offset:1024 sc1
  v_rcp_f32 v243, v243
  v_mfma_f32_16x16x32_bf16 v[212:215], a[76:79], a[212:215], v[212:215]
  buffer_load_dwordx4 a[144:147], v8, s[4:7], s48 offen offset:2048 sc1
  v_rcp_f32 v244, v244
  v_mfma_f32_16x16x32_bf16 v[208:211], a[76:79], a[208:211], v[208:211]
  ds_read_b64_tr_b16 a[92:93], v230 offset:57344
  v_cvt_pk_bf16_f32 v156, v140, v141
  v_mfma_f32_16x16x32_bf16 v[208:211], a[72:75], a[192:195], v[208:211]
  s_waitcnt lgkmcnt(3)
  ds_read_b64_tr_b16 a[94:95], v230 offset:61440
  v_cvt_pk_bf16_f32 v157, v142, v143
  v_mfma_f32_16x16x32_bf16 v[192:195], a[80:83], a[224:227], v[192:195]
  buffer_load_dwordx4 a[148:151], v9, s[4:7], s48 offen offset:2048 sc1
  v_exp_f32 v246, v246
  v_mfma_f32_16x16x32_bf16 v[192:195], a[84:87], a[240:243], v[192:195]
  v_exp_f32 v247, v247
  v_mfma_f32_16x16x32_bf16 v[196:199], a[84:87], a[244:247], v[196:199]
  v_mfma_f32_16x16x32_bf16 v[196:199], a[80:83], a[228:231], v[196:199]
  v_exp_f32 v248, v248
  v_exp_f32 v249, v249
  v_rcp_f32 v245, v245
  v_pk_fma_f32 v[246:247], v[246:247], v[232:233], v[232:233] op_sel:[0,1,1] op_sel_hi:[1,1,1]
  v_pk_fma_f32 v[248:249], v[248:249], v[232:233], v[232:233] op_sel:[0,1,1] op_sel_hi:[1,1,1]
  v_pk_mul_f32 v[160:161], v[160:161], v[242:243]
  v_pk_mul_f32 v[162:163], v[162:163], v[244:245]
  v_pk_mul_f32 v[242:243], v[168:169], v[240:241] op_sel:[0,0] op_sel_hi:[1,0]
  v_pk_mul_f32 v[244:245], v[170:171], v[240:241] op_sel:[0,0] op_sel_hi:[1,0]
  v_pk_mul_f32 v[168:169], v[168:169], v[184:185]
  v_pk_mul_f32 v[170:171], v[170:171], v[186:187]
  v_rcp_f32 v246, v246
  v_mfma_f32_16x16x32_bf16 v[200:203], a[80:83], a[232:235], v[200:203]
  s_waitcnt vmcnt(6)
  s_barrier
  s_cmp_lg_u32 s40, 0
  s_cbranch_scc1 Lsgf18
  v_mov_b32 v250, 1
  s_mov_b64 exec, 1
  buffer_atomic_add v250, v251, s[4:7], s77 offen sc1
  s_mov_b64 exec, -1
Lsgf18:
  s_add_u32 s77, s77, 2048
  buffer_load_dwordx4 a[152:155], v8, s[4:7], s48 offen offset:3072 sc1
  v_rcp_f32 v247, v247
  v_mfma_f32_16x16x32_bf16 v[200:203], a[84:87], a[248:251], v[200:203]
  buffer_load_dwordx4 a[156:159], v9, s[4:7], s48 offen offset:3072 sc1
  v_rcp_f32 v248, v248
  v_mfma_f32_16x16x32_bf16 v[204:207], a[84:87], a[252:255], v[204:207]
  s_add_u32 s48, s48, 4096
  v_cvt_pk_bf16_f32 v146, v160, v161
  v_mfma_f32_16x16x32_bf16 v[204:207], a[80:83], a[236:239], v[204:207]
  v_cvt_pk_bf16_f32 v147, v162, v163
  s_waitcnt lgkmcnt(0)
  v_mfma_f32_16x16x32_bf16 v[220:223], a[88:91], a[236:239], v[220:223]
  buffer_load_dwordx4 a[160:163], v8, s[4:7], s48 offen offset:0 sc1
  buffer_store_dwordx4 v[144:147], v231, s[4:7], s57 offen sc1
  s_add_u32 s57, s57, 16384
  v_exp_f32 v242, v242
  v_mfma_f32_16x16x32_bf16 v[220:223], a[92:95], a[252:255], v[220:223]
  v_exp_f32 v243, v243
  v_mfma_f32_16x16x32_bf16 v[216:219], a[92:95], a[248:251], v[216:219]
  v_mfma_f32_16x16x32_bf16 v[216:219], a[88:91], a[232:235], v[216:219]
  v_exp_f32 v244, v244
  v_exp_f32 v245, v245
  v_rcp_f32 v249, v249
  v_pk_fma_f32 v[242:243], v[242:243], v[234:235], v[234:235] op_sel:[0,0,0] op_sel_hi:[1,0,0]
  v_pk_fma_f32 v[244:245], v[244:245], v[234:235], v[234:235] op_sel:[0,0,0] op_sel_hi:[1,0,0]
  v_pk_mul_f32 v[164:165], v[164:165], v[246:247]
  v_pk_mul_f32 v[166:167], v[166:167], v[248:249]
  v_pk_mul_f32 v[246:247], v[172:173], v[240:241] op_sel:[0,1] op_sel_hi:[1,1]
  v_pk_mul_f32 v[248:249], v[174:175], v[240:241] op_sel:[0,1] op_sel_hi:[1,1]
  v_pk_mul_f32 v[172:173], v[172:173], v[188:189]
  v_pk_mul_f32 v[174:175], v[174:175], v[190:191]
  v_rcp_f32 v242, v242
  v_mfma_f32_16x16x32_bf16 v[212:215], a[88:91], a[228:231], v[212:215]
  v_mfma_f32_16x16x32_bf16 v[212:215], a[92:95], a[244:247], v[212:215]
  v_mfma_f32_16x16x32_bf16 v[208:211], a[92:95], a[240:243], v[208:211]
  v_mfma_f32_16x16x32_bf16 v[208:211], a[88:91], a[224:227], v[208:211]
  ds_read_b64_tr_b16 a[0:1], v0 offset:0
  ds_read_b64_tr_b16 a[2:3], v0 offset:4096
  ds_read_b64_tr_b16 a[16:17], v0 offset:8192
  ds_read_b64_tr_b16 a[18:19], v0 offset:12288
  ds_read_b64_tr_b16 a[4:5], v1 offset:0
  ds_read_b64_tr_b16 a[6:7], v1 offset:4096
  ds_read_b64_tr_b16 a[20:21], v1 offset:8192
  ds_read_b64_tr_b16 a[22:23], v1 offset:12288
  ds_read_b64_tr_b16 a[8:9], v2 offset:0
  ds_read_b64_tr_b16 a[10:11], v2 offset:4096
  ds_read_b64_tr_b16 a[24:25], v2 offset:8192
  ds_read_b64_tr_b16 a[26:27], v2 offset:12288
  ds_read_b64_tr_b16 a[12:13], v3 offset:0
  ds_read_b64_tr_b16 a[14:15], v3 offset:4096
  ds_read_b64_tr_b16 a[28:29], v3 offset:8192
  ds_read_b64_tr_b16 a[30:31], v3 offset:12288
  buffer_load_dwordx4 a[164:167], v9, s[4:7], s48 offen offset:0 sc1
  buffer_load_dwordx4 a[168:171], v8, s[4:7], s48 offen offset:1024 sc1
  v_rcp_f32 v243, v243
  v_rcp_f32 v244, v244
  v_cvt_pk_bf16_f32 v150, v164, v165
  v_cvt_pk_bf16_f32 v151, v166, v167
  buffer_load_dwordx4 a[172:175], v9, s[4:7], s48 offen offset:1024 sc1
  buffer_store_dwordx4 v[148:151], v231, s[4:7], s58 offen sc1
  s_add_u32 s58, s58, 16384
  v_exp_f32 v246, v246
  v_exp_f32 v247, v247
  v_exp_f32 v248, v248
  v_exp_f32 v249, v249
  v_rcp_f32 v245, v245
  v_pk_fma_f32 v[246:247], v[246:247], v[234:235], v[234:235] op_sel:[0,1,1] op_sel_hi:[1,1,1]
  v_pk_fma_f32 v[248:249], v[248:249], v[234:235], v[234:235] op_sel:[0,1,1] op_sel_hi:[1,1,1]
  v_pk_mul_f32 v[168:169], v[168:169], v[242:243]
  v_pk_mul_f32 v[170:171], v[170:171], v[244:245]
  v_pk_mul_f32 v[242:243], v[192:193], v[238:239] op_sel:[0,0] op_sel_hi:[1,0]
  v_pk_mul_f32 v[244:245], v[194:195], v[238:239] op_sel:[0,0] op_sel_hi:[1,0]
  v_pk_mul_f32 v[192:193], v[192:193], v[208:209]
  v_pk_mul_f32 v[194:195], v[194:195], v[210:211]
  v_rcp_f32 v246, v246
  buffer_load_dwordx4 a[176:179], v8, s[4:7], s48 offen offset:2048 sc1
  buffer_load_dwordx4 a[180:183], v9, s[4:7], s48 offen offset:2048 sc1
  v_rcp_f32 v247, v247
  v_rcp_f32 v248, v248
  v_cvt_pk_bf16_f32 v154, v168, v169
  v_cvt_pk_bf16_f32 v155, v170, v171
  buffer_load_dwordx4 a[184:187], v8, s[4:7], s48 offen offset:3072 sc1
  buffer_load_dwordx4 a[188:191], v9, s[4:7], s48 offen offset:3072 sc1
  buffer_store_dwordx4 v[152:155], v231, s[4:7], s59 offen sc1
  s_add_u32 s59, s59, 16384
  v_exp_f32 v242, v242
  v_exp_f32 v243, v243
  v_exp_f32 v244, v244
  v_exp_f32 v245, v245
  v_rcp_f32 v249, v249
  v_pk_fma_f32 v[242:243], v[242:243], v[232:233], v[232:233] op_sel:[0,0,0] op_sel_hi:[1,0,0]
  v_pk_fma_f32 v[244:245], v[244:245], v[232:233], v[232:233] op_sel:[0,0,0] op_sel_hi:[1,0,0]
  v_pk_mul_f32 v[172:173], v[172:173], v[246:247]
  v_pk_mul_f32 v[174:175], v[174:175], v[248:249]
  v_pk_mul_f32 v[246:247], v[196:197], v[238:239] op_sel:[0,1] op_sel_hi:[1,1]
  v_pk_mul_f32 v[248:249], v[198:199], v[238:239] op_sel:[0,1] op_sel_hi:[1,1]
  v_pk_mul_f32 v[196:197], v[196:197], v[212:213]
  v_pk_mul_f32 v[198:199], v[198:199], v[214:215]
  v_rcp_f32 v242, v242
  s_add_u32 m0, s79, 65536
  s_add_u32 s92, s92, 196608
  v_rcp_f32 v243, v243
  v_rcp_f32 v244, v244
  v_cvt_pk_bf16_f32 v158, v172, v173
  v_cvt_pk_bf16_f32 v159, v174, v175
  buffer_load_dwordx4 v252, s[80:83], s92 offen lds
  buffer_load_dwordx4 v252, s[84:87], s92 offen offset:1024 lds
  buffer_store_dwordx4 v[156:159], v231, s[4:7], s60 offen sc1
  s_add_u32 s60, s60, 16384
  v_exp_f32 v246, v246
  v_exp_f32 v247, v247
  v_exp_f32 v248, v248
  v_exp_f32 v249, v249
  v_rcp_f32 v245, v245
  v_pk_fma_f32 v[246:247], v[246:247], v[232:233], v[232:233] op_sel:[0,1,1] op_sel_hi:[1,1,1]
  v_pk_fma_f32 v[248:249], v[248:249], v[232:233], v[232:233] op_sel:[0,1,1] op_sel_hi:[1,1,1]
  v_pk_mul_f32 v[192:193], v[192:193], v[242:243]
  v_pk_mul_f32 v[194:195], v[194:195], v[244:245]
  v_pk_mul_f32 v[242:243], v[200:201], v[240:241] op_sel:[0,0] op_sel_hi:[1,0]
  v_pk_mul_f32 v[244:245], v[202:203], v[240:241] op_sel:[0,0] op_sel_hi:[1,0]
  v_pk_mul_f32 v[200:201], v[200:201], v[216:217]
  v_pk_mul_f32 v[202:203], v[202:203], v[218:219]
  v_rcp_f32 v246, v246
  s_add_u32 m0, s79, 73728
  s_add_u32 s92, s92, 262144
  v_rcp_f32 v247, v247
  v_rcp_f32 v248, v248
  v_cvt_pk_bf16_f32 v208, v192, v193
  v_cvt_pk_bf16_f32 v209, v194, v195
  buffer_load_dwordx4 v252, s[80:83], s92 offen lds
  buffer_load_dwordx4 v252, s[84:87], s92 offen offset:1024 lds
  v_exp_f32 v242, v242
  v_exp_f32 v243, v243
  v_exp_f32 v244, v244
  v_exp_f32 v245, v245
  v_rcp_f32 v249, v249
  v_pk_fma_f32 v[242:243], v[242:243], v[234:235], v[234:235] op_sel:[0,0,0] op_sel_hi:[1,0,0]
  v_pk_fma_f32 v[244:245], v[244:245], v[234:235], v[234:235] op_sel:[0,0,0] op_sel_hi:[1,0,0]
  v_pk_mul_f32 v[196:197], v[196:197], v[246:247]
  v_pk_mul_f32 v[198:199], v[198:199], v[248:249]
  v_pk_mul_f32 v[246:247], v[204:205], v[240:241] op_sel:[0,1] op_sel_hi:[1,1]
  v_pk_mul_f32 v[248:249], v[206:207], v[240:241] op_sel:[0,1] op_sel_hi:[1,1]
  v_pk_mul_f32 v[204:205], v[204:205], v[220:221]
  v_pk_mul_f32 v[206:207], v[206:207], v[222:223]
  v_rcp_f32 v242, v242
  s_add_u32 m0, s79, 81920
  s_add_u32 s92, s92, 196608
  v_rcp_f32 v243, v243
  v_rcp_f32 v244, v244
  v_cvt_pk_bf16_f32 v210, v196, v197
  v_cvt_pk_bf16_f32 v211, v198, v199
  buffer_load_dwordx4 v252, s[80:83], s92 offen lds
  buffer_load_dwordx4 v252, s[84:87], s92 offen offset:1024 lds
  s_nop 1
  v_permlane32_swap_b32 v208, v210
  v_permlane32_swap_b32 v209, v211
  buffer_store_dwordx4 v[208:211], v236, s[4:7], s61 offen sc1
  v_exp_f32 v246, v246
  v_exp_f32 v247, v247
  v_exp_f32 v248, v248
  v_exp_f32 v249, v249
  v_rcp_f32 v245, v245
  v_pk_fma_f32 v[246:247], v[246:247], v[234:235], v[234:235] op_sel:[0,1,1] op_sel_hi:[1,1,1]
  v_pk_fma_f32 v[248:249], v[248:249], v[234:235], v[234:235] op_sel:[0,1,1] op_sel_hi:[1,1,1]
  v_pk_mul_f32 v[200:201], v[200:201], v[242:243]
  v_pk_mul_f32 v[202:203], v[202:203], v[244:245]
  v_rcp_f32 v246, v246
  s_add_u32 m0, s79, 90112
  s_add_u32 s92, s92, 262144
  v_rcp_f32 v247, v247
  v_rcp_f32 v248, v248
  v_cvt_pk_bf16_f32 v216, v200, v201
  v_cvt_pk_bf16_f32 v217, v202, v203
  buffer_load_dwordx4 v252, s[80:83], s92 offen lds
  buffer_load_dwordx4 v252, s[84:87], s92 offen offset:1024 lds
  v_rcp_f32 v249, v249
  s_nop 0
  v_pk_mul_f32 v[204:205], v[204:205], v[246:247]
  v_pk_mul_f32 v[206:207], v[206:207], v[248:249]
  v_cvt_pk_bf16_f32 v218, v204, v205
  v_cvt_pk_bf16_f32 v219, v206, v207
  s_nop 1
  v_permlane32_swap_b32 v216, v218
  v_permlane32_swap_b32 v217, v219
  buffer_store_dwordx4 v[216:219], v236, s[4:7], s62 offen sc1
  v_pk_mul_f32 v[32:33], v[250:251], 0 op_sel:[1,0] op_sel_hi:[1,0]
  v_pk_mul_f32 v[34:35], v[250:251], 0 op_sel:[1,0] op_sel_hi:[1,0]
  v_pk_mul_f32 v[36:37], v[250:251], 0 op_sel:[1,0] op_sel_hi:[1,0]
  v_pk_mul_f32 v[38:39], v[250:251], 0 op_sel:[1,0] op_sel_hi:[1,0]
  v_pk_mul_f32 v[40:41], v[250:251], 0 op_sel:[1,0] op_sel_hi:[1,0]
  v_pk_mul_f32 v[42:43], v[250:251], 0 op_sel:[1,0] op_sel_hi:[1,0]
  v_pk_mul_f32 v[44:45], v[250:251], 0 op_sel:[1,0] op_sel_hi:[1,0]
  v_pk_mul_f32 v[46:47], v[250:251], 0 op_sel:[1,0] op_sel_hi:[1,0]
  v_pk_mul_f32 v[48:49], v[250:251], 0 op_sel:[1,0] op_sel_hi:[1,0]
  v_pk_mul_f32 v[50:51], v[250:251], 0 op_sel:[1,0] op_sel_hi:[1,0]
  v_pk_mul_f32 v[52:53], v[250:251], 0 op_sel:[1,0] op_sel_hi:[1,0]
  v_pk_mul_f32 v[54:55], v[250:251], 0 op_sel:[1,0] op_sel_hi:[1,0]
  v_pk_mul_f32 v[56:57], v[250:251], 0 op_sel:[1,0] op_sel_hi:[1,0]
  v_pk_mul_f32 v[58:59], v[250:251], 0 op_sel:[1,0] op_sel_hi:[1,0]
  v_pk_mul_f32 v[60:61], v[250:251], 0 op_sel:[1,0] op_sel_hi:[1,0]
  v_pk_mul_f32 v[62:63], v[250:251], 0 op_sel:[1,0] op_sel_hi:[1,0]
  v_lshlrev_b32 v64, 16, v16
  v_and_b32 v65, 0xffff0000, v16
  v_lshlrev_b32 v66, 16, v17
  v_and_b32 v67, 0xffff0000, v17
  v_lshlrev_b32 v72, 16, v18
  v_and_b32 v73, 0xffff0000, v18
  v_lshlrev_b32 v74, 16, v19
  v_and_b32 v75, 0xffff0000, v19
  v_lshlrev_b32 v80, 16, v20
  v_and_b32 v81, 0xffff0000, v20
  v_lshlrev_b32 v82, 16, v21
  v_and_b32 v83, 0xffff0000, v21
  v_lshlrev_b32 v88, 16, v22
  v_and_b32 v89, 0xffff0000, v22
  v_lshlrev_b32 v90, 16, v23
  v_and_b32 v91, 0xffff0000, v23
  v_lshlrev_b32 v68, 16, v24
  v_and_b32 v69, 0xffff0000, v24
  v_lshlrev_b32 v70, 16, v25
  v_and_b32 v71, 0xffff0000, v25
  v_lshlrev_b32 v76, 16, v26
  v_and_b32 v77, 0xffff0000, v26
  v_lshlrev_b32 v78, 16, v27
  v_and_b32 v79, 0xffff0000, v27
  v_lshlrev_b32 v84, 16, v28
  v_and_b32 v85, 0xffff0000, v28
  v_lshlrev_b32 v86, 16, v29
  v_and_b32 v87, 0xffff0000, v29
  v_lshlrev_b32 v92, 16, v30
  v_and_b32 v93, 0xffff0000, v30
  v_lshlrev_b32 v94, 16, v31
  v_and_b32 v95, 0xffff0000, v31
  s_mov_b32 s56, 2
.p2align 3
Lp4_loop:
  s_waitcnt vmcnt(24) lgkmcnt(8)
  v_mfma_f32_16x16x32_bf16 v[32:35], a[0:3], a[128:131], v[32:35]
  s_waitcnt vmcnt(26)
  s_barrier
  ds_read_b64_tr_b16 a[32:33], v0 offset:1024
  v_mfma_f32_16x16x32_bf16 v[32:35], a[16:19], a[136:139], v[32:35]
  s_add_u32 m0, s79, 98304
  ds_read_b64_tr_b16 a[34:35], v0 offset:5120
  s_add_u32 s92, s92, 196608
  v_mfma_f32_16x16x32_bf16 v[36:39], a[16:19], a[140:143], v[36:39]
  ds_read_b64_tr_b16 a[48:49], v0 offset:9216
  buffer_load_dwordx4 v252, s[80:83], s92 offen lds
  v_mfma_f32_16x16x32_bf16 v[36:39], a[0:3], a[132:135], v[36:39]
  ds_read_b64_tr_b16 a[50:51], v0 offset:13312
  v_mfma_f32_16x16x32_bf16 v[44:47], a[4:7], a[132:135], v[44:47]
  ds_read_b64_tr_b16 a[36:37], v1 offset:1024
  v_mfma_f32_16x16x32_bf16 v[44:47], a[20:23], a[140:143], v[44:47]
  ds_read_b64_tr_b16 a[38:39], v1 offset:5120
  v_mfma_f32_16x16x32_bf16 v[40:43], a[20:23], a[136:139], v[40:43]
  ds_read_b64_tr_b16 a[52:53], v1 offset:9216
  buffer_load_dwordx4 v252, s[84:87], s92 offen offset:1024 lds
  v_mfma_f32_16x16x32_bf16 v[40:43], a[4:7], a[128:131], v[40:43]
  ds_read_b64_tr_b16 a[54:55], v1 offset:13312
  s_waitcnt lgkmcnt(8)
  v_mfma_f32_16x16x32_bf16 v[48:51], a[8:11], a[128:131], v[48:51]
  ds_read_b64_tr_b16 a[40:41], v2 offset:1024
  v_mfma_f32_16x16x32_bf16 v[48:51], a[24:27], a[136:139], v[48:51]
  ds_read_b64_tr_b16 a[42:43], v2 offset:5120
  s_add_u32 s48, s48, 4096
  v_mfma_f32_16x16x32_bf16 v[52:55], a[24:27], a[140:143], v[52:55]
  ds_read_b64_tr_b16 a[56:57], v2 offset:9216
  buffer_load_dwordx4 a[192:195], v8, s[4:7], s48 offen offset:0 sc1
  v_mfma_f32_16x16x32_bf16 v[52:55], a[8:11], a[132:135], v[52:55]
  ds_read_b64_tr_b16 a[58:59], v2 offset:13312
  v_mfma_f32_16x16x32_bf16 v[60:63], a[12:15], a[132:135], v[60:63]
  ds_read_b64_tr_b16 a[44:45], v3 offset:1024
  v_mfma_f32_16x16x32_bf16 v[60:63], a[28:31], a[140:143], v[60:63]
  ds_read_b64_tr_b16 a[46:47], v3 offset:5120
  v_mfma_f32_16x16x32_bf16 v[56:59], a[28:31], a[136:139], v[56:59]
  ds_read_b64_tr_b16 a[60:61], v3 offset:9216
  buffer_load_dwordx4 a[196:199], v9, s[4:7], s48 offen offset:0 sc1
  v_mfma_f32_16x16x32_bf16 v[56:59], a[12:15], a[128:131], v[56:59]
  ds_read_b64_tr_b16 a[62:63], v3 offset:13312
  s_waitcnt lgkmcnt(8)
  v_mfma_f32_16x16x32_bf16 v[64:67], a[32:35], a[128:131], v[64:67]
  ds_read_b64_tr_b16 a[0:1], v0 offset:16384
  s_add_u32 m0, s79, 106496
  v_mfma_f32_16x16x32_bf16 v[64:67], a[48:51], a[136:139], v[64:67]
  ds_read_b64_tr_b16 a[2:3], v0 offset:20480
  s_add_u32 s92, s92, 262144
  v_mfma_f32_16x16x32_bf16 v[68:71], a[48:51], a[140:143], v[68:71]
  ds_read_b64_tr_b16 a[16:17], v0 offset:24576
  buffer_load_dwordx4 v252, s[80:83], s92 offen lds
  v_mfma_f32_16x16x32_bf16 v[68:71], a[32:35], a[132:135], v[68:71]
  ds_read_b64_tr_b16 a[18:19], v0 offset:28672
  v_mfma_f32_16x16x32_bf16 v[76:79], a[36:39], a[132:135], v[76:79]
  ds_read_b64_tr_b16 a[4:5], v1 offset:16384
  v_mfma_f32_16x16x32_bf16 v[76:79], a[52:55], a[140:143], v[76:79]
  ds_read_b64_tr_b16 a[6:7], v1 offset:20480
  v_mfma_f32_16x16x32_bf16 v[72:75], a[52:55], a[136:139], v[72:75]
  ds_read_b64_tr_b16 a[20:21], v1 offset:24576
  buffer_load_dwordx4 v252, s[84:87], s92 offen offset:1024 lds
  v_mfma_f32_16x16x32_bf16 v[72:75], a[36:39], a[128:131], v[72:75]
  ds_read_b64_tr_b16 a[22:23], v1 offset:28672
  s_waitcnt lgkmcnt(8)
  v_mfma_f32_16x16x32_bf16 v[80:83], a[40:43], a[128:131], v[80:83]
  ds_read_b64_tr_b16 a[8:9], v2 offset:16384
  v_mfma_f32_16x16x32_bf16 v[80:83], a[56:59], a[136:139], v[80:83]
  ds_read_b64_tr_b16 a[10:11], v2 offset:20480
  v_mfma_f32_16x16x32_bf16 v[84:87], a[56:59], a[140:143], v[84:87]
  ds_read_b64_tr_b16 a[24:25], v2 offset:24576
  buffer_load_dwordx4 a[200:203], v8, s[4:7], s48 offen offset:1024 sc1
  v_mfma_f32_16x16x32_bf16 v[84:87], a[40:43], a[132:135], v[84:87]
  ds_read_b64_tr_b16 a[26:27], v2 offset:28672
  v_mfma_f32_16x16x32_bf16 v[92:95], a[44:47], a[132:135], v[92:95]
  ds_read_b64_tr_b16 a[12:13], v3 offset:16384
  v_mfma_f32_16x16x32_bf16 v[92:95], a[60:63], a[140:143], v[92:95]
  ds_read_b64_tr_b16 a[14:15], v3 offset:20480
  v_mfma_f32_16x16x32_bf16 v[88:91], a[60:63], a[136:139], v[88:91]
  ds_read_b64_tr_b16 a[28:29], v3 offset:24576
  buffer_load_dwordx4 a[204:207], v9, s[4:7], s48 offen offset:1024 sc1
  v_mfma_f32_16x16x32_bf16 v[88:91], a[44:47], a[128:131], v[88:91]
  ds_read_b64_tr_b16 a[30:31], v3 offset:28672
  s_waitcnt vmcnt(24) lgkmcnt(8)
  v_mfma_f32_16x16x32_bf16 v[32:35], a[0:3], a[144:147], v[32:35]
  ds_read_b64_tr_b16 a[32:33], v0 offset:17408
  s_add_u32 m0, s79, 114688
  v_mfma_f32_16x16x32_bf16 v[32:35], a[16:19], a[152:155], v[32:35]
  ds_read_b64_tr_b16 a[34:35], v0 offset:21504
  s_add_u32 s92, s92, 196608
  v_mfma_f32_16x16x32_bf16 v[36:39], a[16:19], a[156:159], v[36:39]
  ds_read_b64_tr_b16 a[48:49], v0 offset:25600
  buffer_load_dwordx4 v252, s[80:83], s92 offen lds
  v_mfma_f32_16x16x32_bf16 v[36:39], a[0:3], a[148:151], v[36:39]
  ds_read_b64_tr_b16 a[50:51], v0 offset:29696
  v_mfma_f32_16x16x32_bf16 v[44:47], a[4:7], a[148:151], v[44:47]
  ds_read_b64_tr_b16 a[36:37], v1 offset:17408
  v_mfma_f32_16x16x32_bf16 v[44:47], a[20:23], a[156:159], v[44:47]
  ds_read_b64_tr_b16 a[38:39], v1 offset:21504
  v_mfma_f32_16x16x32_bf16 v[40:43], a[20:23], a[152:155], v[40:43]
  ds_read_b64_tr_b16 a[52:53], v1 offset:25600
  buffer_load_dwordx4 v252, s[84:87], s92 offen offset:1024 lds
  v_mfma_f32_16x16x32_bf16 v[40:43], a[4:7], a[144:147], v[40:43]
  ds_read_b64_tr_b16 a[54:55], v1 offset:29696
  s_waitcnt lgkmcnt(8)
  v_mfma_f32_16x16x32_bf16 v[48:51], a[8:11], a[144:147], v[48:51]
  ds_read_b64_tr_b16 a[40:41], v2 offset:17408
  v_mfma_f32_16x16x32_bf16 v[48:51], a[24:27], a[152:155], v[48:51]
  ds_read_b64_tr_b16 a[42:43], v2 offset:21504
  v_mfma_f32_16x16x32_bf16 v[52:55], a[24:27], a[156:159], v[52:55]
  ds_read_b64_tr_b16 a[56:57], v2 offset:25600
  buffer_load_dwordx4 a[208:211], v8, s[4:7], s48 offen offset:2048 sc1
  v_mfma_f32_16x16x32_bf16 v[52:55], a[8:11], a[148:151], v[52:55]
  ds_read_b64_tr_b16 a[58:59], v2 offset:29696
  v_mfma_f32_16x16x32_bf16 v[60:63], a[12:15], a[148:151], v[60:63]
  ds_read_b64_tr_b16 a[44:45], v3 offset:17408
  v_mfma_f32_16x16x32_bf16 v[60:63], a[28:31], a[156:159], v[60:63]
  ds_read_b64_tr_b16 a[46:47], v3 offset:21504
  v_mfma_f32_16x16x32_bf16 v[56:59], a[28:31], a[152:155], v[56:59]
  ds_read_b64_tr_b16 a[60:61], v3 offset:25600
  buffer_load_dwordx4 a[212:215], v9, s[4:7], s48 offen offset:2048 sc1
  v_mfma_f32_16x16x32_bf16 v[56:59], a[12:15], a[144:147], v[56:59]
  ds_read_b64_tr_b16 a[62:63], v3 offset:29696
  s_waitcnt lgkmcnt(8)
  v_mfma_f32_16x16x32_bf16 v[64:67], a[32:35], a[144:147], v[64:67]
  ds_read_b64_tr_b16 a[0:1], v0 offset:32768
  s_add_u32 m0, s79, 122880
  v_mfma_f32_16x16x32_bf16 v[64:67], a[48:51], a[152:155], v[64:67]
  ds_read_b64_tr_b16 a[2:3], v0 offset:36864
  s_add_u32 s92, s92, 262144
  v_mfma_f32_16x16x32_bf16 v[68:71], a[48:51], a[156:159], v[68:71]
  ds_read_b64_tr_b16 a[16:17], v0 offset:40960
  buffer_load_dwordx4 v252, s[80:83], s92 offen lds
  v_mfma_f32_16x16x32_bf16 v[68:71], a[32:35], a[148:151], v[68:71]
  ds_read_b64_tr_b16 a[18:19], v0 offset:45056
  v_mfma_f32_16x16x32_bf16 v[76:79], a[36:39], a[148:151], v[76:79]
  ds_read_b64_tr_b16 a[4:5], v1 offset:32768
  v_mfma_f32_16x16x32_bf16 v[76:79], a[52:55], a[156:159], v[76:79]
  ds_read_b64_tr_b16 a[6:7], v1 offset:36864
  v_mfma_f32_16x16x32_bf16 v[72:75], a[52:55], a[152:155], v[72:75]
  ds_read_b64_tr_b16 a[20:21], v1 offset:40960
  buffer_load_dwordx4 v252, s[84:87], s92 offen offset:1024 lds
  v_mfma_f32_16x16x32_bf16 v[72:75], a[36:39], a[144:147], v[72:75]
  ds_read_b64_tr_b16 a[22:23], v1 offset:45056
  s_waitcnt lgkmcnt(8)
  v_mfma_f32_16x16x32_bf16 v[80:83], a[40:43], a[144:147], v[80:83]
  ds_read_b64_tr_b16 a[8:9], v2 offset:32768
  v_mfma_f32_16x16x32_bf16 v[80:83], a[56:59], a[152:155], v[80:83]
  ds_read_b64_tr_b16 a[10:11], v2 offset:36864
  v_mfma_f32_16x16x32_bf16 v[84:87], a[56:59], a[156:159], v[84:87]
  ds_read_b64_tr_b16 a[24:25], v2 offset:40960
  buffer_load_dwordx4 a[216:219], v8, s[4:7], s48 offen offset:3072 sc1
  v_mfma_f32_16x16x32_bf16 v[84:87], a[40:43], a[148:151], v[84:87]
  ds_read_b64_tr_b16 a[26:27], v2 offset:45056
  v_mfma_f32_16x16x32_bf16 v[92:95], a[44:47], a[148:151], v[92:95]
  ds_read_b64_tr_b16 a[12:13], v3 offset:32768
  v_mfma_f32_16x16x32_bf16 v[92:95], a[60:63], a[156:159], v[92:95]
  ds_read_b64_tr_b16 a[14:15], v3 offset:36864
  v_mfma_f32_16x16x32_bf16 v[88:91], a[60:63], a[152:155], v[88:91]
  ds_read_b64_tr_b16 a[28:29], v3 offset:40960
  buffer_load_dwordx4 a[220:223], v9, s[4:7], s48 offen offset:3072 sc1
  v_mfma_f32_16x16x32_bf16 v[88:91], a[44:47], a[144:147], v[88:91]
  ds_read_b64_tr_b16 a[30:31], v3 offset:45056
  s_waitcnt vmcnt(24) lgkmcnt(8)
  v_mfma_f32_16x16x32_bf16 v[32:35], a[0:3], a[160:163], v[32:35]
  s_waitcnt vmcnt(22)
  s_barrier
  ds_read_b64_tr_b16 a[32:33], v0 offset:33792
  v_mfma_f32_16x16x32_bf16 v[32:35], a[16:19], a[168:171], v[32:35]
  s_add_u32 m0, s79, 0
  ds_read_b64_tr_b16 a[34:35], v0 offset:37888
  s_add_u32 s92, s92, -3407872
  v_mfma_f32_16x16x32_bf16 v[36:39], a[16:19], a[172:175], v[36:39]
  ds_read_b64_tr_b16 a[48:49], v0 offset:41984
  buffer_load_dwordx4 v252, s[80:83], s92 offen lds
  v_mfma_f32_16x16x32_bf16 v[36:39], a[0:3], a[164:167], v[36:39]
  ds_read_b64_tr_b16 a[50:51], v0 offset:46080
  v_mfma_f32_16x16x32_bf16 v[44:47], a[4:7], a[164:167], v[44:47]
  ds_read_b64_tr_b16 a[36:37], v1 offset:33792
  v_mfma_f32_16x16x32_bf16 v[44:47], a[20:23], a[172:175], v[44:47]
  ds_read_b64_tr_b16 a[38:39], v1 offset:37888
  v_mfma_f32_16x16x32_bf16 v[40:43], a[20:23], a[168:171], v[40:43]
  ds_read_b64_tr_b16 a[52:53], v1 offset:41984
  buffer_load_dwordx4 v252, s[84:87], s92 offen offset:1024 lds
  v_mfma_f32_16x16x32_bf16 v[40:43], a[4:7], a[160:163], v[40:43]
  ds_read_b64_tr_b16 a[54:55], v1 offset:46080
  s_waitcnt lgkmcnt(8)
  v_mfma_f32_16x16x32_bf16 v[48:51], a[8:11], a[160:163], v[48:51]
  ds_read_b64_tr_b16 a[40:41], v2 offset:33792
  v_mfma_f32_16x16x32_bf16 v[48:51], a[24:27], a[168:171], v[48:51]
  ds_read_b64_tr_b16 a[42:43], v2 offset:37888
  s_add_u32 s48, s48, 4096
  v_mfma_f32_16x16x32_bf16 v[52:55], a[24:27], a[172:175], v[52:55]
  ds_read_b64_tr_b16 a[56:57], v2 offset:41984
  buffer_load_dwordx4 a[224:227], v8, s[4:7], s48 offen offset:0 sc1
  v_mfma_f32_16x16x32_bf16 v[52:55], a[8:11], a[164:167], v[52:55]
  ds_read_b64_tr_b16 a[58:59], v2 offset:46080
  v_mfma_f32_16x16x32_bf16 v[60:63], a[12:15], a[164:167], v[60:63]
  ds_read_b64_tr_b16 a[44:45], v3 offset:33792
  v_mfma_f32_16x16x32_bf16 v[60:63], a[28:31], a[172:175], v[60:63]
  ds_read_b64_tr_b16 a[46:47], v3 offset:37888
  v_mfma_f32_16x16x32_bf16 v[56:59], a[28:31], a[168:171], v[56:59]
  ds_read_b64_tr_b16 a[60:61], v3 offset:41984
  buffer_load_dwordx4 a[228:231], v9, s[4:7], s48 offen offset:0 sc1
  v_mfma_f32_16x16x32_bf16 v[56:59], a[12:15], a[160:163], v[56:59]
  ds_read_b64_tr_b16 a[62:63], v3 offset:46080
  s_waitcnt lgkmcnt(8)
  v_mfma_f32_16x16x32_bf16 v[64:67], a[32:35], a[160:163], v[64:67]
  s_add_u32 m0, s79, 8192
  ds_read_b64_tr_b16 a[0:1], v0 offset:49152
  buffer_load_dword v10, v251, s[4:7], s64 offen sc1
  v_mfma_f32_16x16x32_bf16 v[64:67], a[48:51], a[168:171], v[64:67]
  ds_read_b64_tr_b16 a[2:3], v0 offset:53248
  s_add_u32 s92, s92, 262144
  v_mfma_f32_16x16x32_bf16 v[68:71], a[48:51], a[172:175], v[68:71]
  ds_read_b64_tr_b16 a[16:17], v0 offset:57344
  buffer_load_dwordx4 v252, s[80:83], s92 offen lds
  v_mfma_f32_16x16x32_bf16 v[68:71], a[32:35], a[164:167], v[68:71]
  ds_read_b64_tr_b16 a[18:19], v0 offset:61440
  v_mfma_f32_16x16x32_bf16 v[76:79], a[36:39], a[164:167], v[76:79]
  ds_read_b64_tr_b16 a[4:5], v1 offset:49152
  v_mfma_f32_16x16x32_bf16 v[76:79], a[52:55], a[172:175], v[76:79]
  ds_read_b64_tr_b16 a[6:7], v1 offset:53248
  v_mfma_f32_16x16x32_bf16 v[72:75], a[52:55], a[168:171], v[72:75]
  ds_read_b64_tr_b16 a[20:21], v1 offset:57344
  buffer_load_dwordx4 v252, s[84:87], s92 offen offset:1024 lds
  v_mfma_f32_16x16x32_bf16 v[72:75], a[36:39], a[160:163], v[72:75]
  ds_read_b64_tr_b16 a[22:23], v1 offset:61440
  s_waitcnt lgkmcnt(8)
  v_mfma_f32_16x16x32_bf16 v[80:83], a[40:43], a[160:163], v[80:83]
  ds_read_b64_tr_b16 a[8:9], v2 offset:49152
  v_mfma_f32_16x16x32_bf16 v[80:83], a[56:59], a[168:171], v[80:83]
  ds_read_b64_tr_b16 a[10:11], v2 offset:53248
  v_mfma_f32_16x16x32_bf16 v[84:87], a[56:59], a[172:175], v[84:87]
  ds_read_b64_tr_b16 a[24:25], v2 offset:57344
  buffer_load_dwordx4 a[232:235], v8, s[4:7], s48 offen offset:1024 sc1
  v_mfma_f32_16x16x32_bf16 v[84:87], a[40:43], a[164:167], v[84:87]
  ds_read_b64_tr_b16 a[26:27], v2 offset:61440
  v_mfma_f32_16x16x32_bf16 v[92:95], a[44:47], a[164:167], v[92:95]
  ds_read_b64_tr_b16 a[12:13], v3 offset:49152
  v_mfma_f32_16x16x32_bf16 v[92:95], a[60:63], a[172:175], v[92:95]
  ds_read_b64_tr_b16 a[14:15], v3 offset:53248
  v_mfma_f32_16x16x32_bf16 v[88:91], a[60:63], a[168:171], v[88:91]
  ds_read_b64_tr_b16 a[28:29], v3 offset:57344
  buffer_load_dwordx4 a[236:239], v9, s[4:7], s48 offen offset:1024 sc1
  v_mfma_f32_16x16x32_bf16 v[88:91], a[44:47], a[160:163], v[88:91]
  ds_read_b64_tr_b16 a[30:31], v3 offset:61440
  s_waitcnt vmcnt(25) lgkmcnt(8)
  v_mfma_f32_16x16x32_bf16 v[32:35], a[0:3], a[176:179], v[32:35]
  ds_read_b64_tr_b16 a[32:33], v0 offset:50176
  s_add_u32 m0, s79, 16384
  v_mfma_f32_16x16x32_bf16 v[32:35], a[16:19], a[184:187], v[32:35]
  ds_read_b64_tr_b16 a[34:35], v0 offset:54272
  s_add_u32 s92, s92, 196608
  v_mfma_f32_16x16x32_bf16 v[36:39], a[16:19], a[188:191], v[36:39]
  ds_read_b64_tr_b16 a[48:49], v0 offset:58368
  buffer_load_dwordx4 v252, s[80:83], s92 offen lds
  v_mfma_f32_16x16x32_bf16 v[36:39], a[0:3], a[180:183], v[36:39]
  ds_read_b64_tr_b16 a[50:51], v0 offset:62464
  v_mfma_f32_16x16x32_bf16 v[44:47], a[4:7], a[180:183], v[44:47]
  ds_read_b64_tr_b16 a[36:37], v1 offset:50176
  v_mfma_f32_16x16x32_bf16 v[44:47], a[20:23], a[188:191], v[44:47]
  ds_read_b64_tr_b16 a[38:39], v1 offset:54272
  v_mfma_f32_16x16x32_bf16 v[40:43], a[20:23], a[184:187], v[40:43]
  ds_read_b64_tr_b16 a[52:53], v1 offset:58368
  buffer_load_dwordx4 v252, s[84:87], s92 offen offset:1024 lds
  v_mfma_f32_16x16x32_bf16 v[40:43], a[4:7], a[176:179], v[40:43]
  ds_read_b64_tr_b16 a[54:55], v1 offset:62464
  s_waitcnt lgkmcnt(8)
  v_mfma_f32_16x16x32_bf16 v[48:51], a[8:11], a[176:179], v[48:51]
  ds_read_b64_tr_b16 a[40:41], v2 offset:50176
  v_mfma_f32_16x16x32_bf16 v[48:51], a[24:27], a[184:187], v[48:51]
  ds_read_b64_tr_b16 a[42:43], v2 offset:54272
  v_mfma_f32_16x16x32_bf16 v[52:55], a[24:27], a[188:191], v[52:55]
  ds_read_b64_tr_b16 a[56:57], v2 offset:58368
  buffer_load_dwordx4 a[240:243], v8, s[4:7], s48 offen offset:2048 sc1
  v_mfma_f32_16x16x32_bf16 v[52:55], a[8:11], a[180:183], v[52:55]
  ds_read_b64_tr_b16 a[58:59], v2 offset:62464
  v_mfma_f32_16x16x32_bf16 v[60:63], a[12:15], a[180:183], v[60:63]
  ds_read_b64_tr_b16 a[44:45], v3 offset:50176
  v_mfma_f32_16x16x32_bf16 v[60:63], a[28:31], a[188:191], v[60:63]
  ds_read_b64_tr_b16 a[46:47], v3 offset:54272
  v_mfma_f32_16x16x32_bf16 v[56:59], a[28:31], a[184:187], v[56:59]
  ds_read_b64_tr_b16 a[60:61], v3 offset:58368
  buffer_load_dwordx4 a[244:247], v9, s[4:7], s48 offen offset:2048 sc1
  v_mfma_f32_16x16x32_bf16 v[56:59], a[12:15], a[176:179], v[56:59]
  ds_read_b64_tr_b16 a[62:63], v3 offset:62464
  s_waitcnt lgkmcnt(8)
  v_mfma_f32_16x16x32_bf16 v[64:67], a[32:35], a[176:179], v[64:67]
  ds_read_b64_tr_b16 a[0:1], v4 offset:0
  s_add_u32 m0, s79, 24576
  v_mfma_f32_16x16x32_bf16 v[64:67], a[48:51], a[184:187], v[64:67]
  ds_read_b64_tr_b16 a[2:3], v4 offset:4096
  s_add_u32 s92, s92, 262144
  v_mfma_f32_16x16x32_bf16 v[68:71], a[48:51], a[188:191], v[68:71]
  ds_read_b64_tr_b16 a[16:17], v4 offset:8192
  buffer_load_dwordx4 v252, s[80:83], s92 offen lds
  v_mfma_f32_16x16x32_bf16 v[68:71], a[32:35], a[180:183], v[68:71]
  ds_read_b64_tr_b16 a[18:19], v4 offset:12288
  v_mfma_f32_16x16x32_bf16 v[76:79], a[36:39], a[180:183], v[76:79]
  ds_read_b64_tr_b16 a[4:5], v5 offset:0
  v_mfma_f32_16x16x32_bf16 v[76:79], a[52:55], a[188:191], v[76:79]
  ds_read_b64_tr_b16 a[6:7], v5 offset:4096
  v_mfma_f32_16x16x32_bf16 v[72:75], a[52:55], a[184:187], v[72:75]
  ds_read_b64_tr_b16 a[20:21], v5 offset:8192
  buffer_load_dwordx4 v252, s[84:87], s92 offen offset:1024 lds
  v_mfma_f32_16x16x32_bf16 v[72:75], a[36:39], a[176:179], v[72:75]
  ds_read_b64_tr_b16 a[22:23], v5 offset:12288
  s_waitcnt lgkmcnt(8)
  v_mfma_f32_16x16x32_bf16 v[80:83], a[40:43], a[176:179], v[80:83]
  ds_read_b64_tr_b16 a[8:9], v6 offset:0
  v_mfma_f32_16x16x32_bf16 v[80:83], a[56:59], a[184:187], v[80:83]
  ds_read_b64_tr_b16 a[10:11], v6 offset:4096
  v_mfma_f32_16x16x32_bf16 v[84:87], a[56:59], a[188:191], v[84:87]
  ds_read_b64_tr_b16 a[24:25], v6 offset:8192
  buffer_load_dwordx4 a[248:251], v8, s[4:7], s48 offen offset:3072 sc1
  v_mfma_f32_16x16x32_bf16 v[84:87], a[40:43], a[180:183], v[84:87]
  ds_read_b64_tr_b16 a[26:27], v6 offset:12288
  v_mfma_f32_16x16x32_bf16 v[92:95], a[44:47], a[180:183], v[92:95]
  ds_read_b64_tr_b16 a[12:13], v7 offset:0
  v_mfma_f32_16x16x32_bf16 v[92:95], a[60:63], a[188:191], v[92:95]
  ds_read_b64_tr_b16 a[14:15], v7 offset:4096
  v_mfma_f32_16x16x32_bf16 v[88:91], a[60:63], a[184:187], v[88:91]
  ds_read_b64_tr_b16 a[28:29], v7 offset:8192
  buffer_load_dwordx4 a[252:255], v9, s[4:7], s48 offen offset:3072 sc1
  v_mfma_f32_16x16x32_bf16 v[88:91], a[44:47], a[176:179], v[88:91]
  ds_read_b64_tr_b16 a[30:31], v7 offset:12288
  s_waitcnt vmcnt(25) lgkmcnt(8)
  v_mfma_f32_16x16x32_bf16 v[32:35], a[0:3], a[192:195], v[32:35]
  s_waitcnt vmcnt(27)
  s_barrier
  s_xor_b32 s43, s56, 2
  s_or_b32 s43, s43, s40
  s_cbranch_scc1 Lp3_sgl
  v_mov_b32 v250, 1
  s_mov_b64 exec, 1
  buffer_atomic_add v250, v251, s[4:7], s77 offen sc1
  s_mov_b64 exec, -1
Lp3_sgl:
  ds_read_b64_tr_b16 a[32:33], v4 offset:1024
  s_waitcnt vmcnt(12)
  v_cmp_gt_u32 vcc, 16, v10
  s_cbranch_vccz Lp4b_ok
  s_mov_b32 s43, 0x40000
Lp4b_sp:
  s_sleep 10
  buffer_load_dword v10, v251, s[4:7], s64 offen sc1
  s_waitcnt vmcnt(0)
  v_cmp_gt_u32 vcc, 16, v10
  s_cbranch_vccz Lp4b_ok
  s_sub_u32 s43, s43, 1
  s_cmp_lg_u32 s43, 0
  s_cbranch_scc1 Lp4b_sp
Lp4b_ok:
  s_add_u32 s64, s64, 2048
  s_add_u32 m0, s79, 32768
  v_mfma_f32_16x16x32_bf16 v[32:35], a[16:19], a[200:203], v[32:35]
  ds_read_b64_tr_b16 a[34:35], v4 offset:5120
  s_add_u32 s92, s92, 196608
  v_mfma_f32_16x16x32_bf16 v[36:39], a[16:19], a[204:207], v[36:39]
  ds_read_b64_tr_b16 a[48:49], v4 offset:9216
  buffer_load_dwordx4 v252, s[80:83], s92 offen lds
  v_mfma_f32_16x16x32_bf16 v[36:39], a[0:3], a[196:199], v[36:39]
  ds_read_b64_tr_b16 a[50:51], v4 offset:13312
  v_mfma_f32_16x16x32_bf16 v[44:47], a[4:7], a[196:199], v[44:47]
  ds_read_b64_tr_b16 a[36:37], v5 offset:1024
  v_mfma_f32_16x16x32_bf16 v[44:47], a[20:23], a[204:207], v[44:47]
  ds_read_b64_tr_b16 a[38:39], v5 offset:5120
  v_mfma_f32_16x16x32_bf16 v[40:43], a[20:23], a[200:203], v[40:43]
  ds_read_b64_tr_b16 a[52:53], v5 offset:9216
  buffer_load_dwordx4 v252, s[84:87], s92 offen offset:1024 lds
  v_mfma_f32_16x16x32_bf16 v[40:43], a[4:7], a[192:195], v[40:43]
  ds_read_b64_tr_b16 a[54:55], v5 offset:13312
  s_waitcnt lgkmcnt(8)
  v_mfma_f32_16x16x32_bf16 v[48:51], a[8:11], a[192:195], v[48:51]
  ds_read_b64_tr_b16 a[40:41], v6 offset:1024
  v_mfma_f32_16x16x32_bf16 v[48:51], a[24:27], a[200:203], v[48:51]
  ds_read_b64_tr_b16 a[42:43], v6 offset:5120
  s_add_u32 s48, s48, 4096
  v_mfma_f32_16x16x32_bf16 v[52:55], a[24:27], a[204:207], v[52:55]
  ds_read_b64_tr_b16 a[56:57], v6 offset:9216
  buffer_load_dwordx4 a[128:131], v8, s[4:7], s48 offen offset:0 sc1
  v_mfma_f32_16x16x32_bf16 v[52:55], a[8:11], a[196:199], v[52:55]
  ds_read_b64_tr_b16 a[58:59], v6 offset:13312
  v_mfma_f32_16x16x32_bf16 v[60:63], a[12:15], a[196:199], v[60:63]
  ds_read_b64_tr_b16 a[44:45], v7 offset:1024
  v_mfma_f32_16x16x32_bf16 v[60:63], a[28:31], a[204:207], v[60:63]
  ds_read_b64_tr_b16 a[46:47], v7 offset:5120
  v_mfma_f32_16x16x32_bf16 v[56:59], a[28:31], a[200:203], v[56:59]
  ds_read_b64_tr_b16 a[60:61], v7 offset:9216
  buffer_load_dwordx4 a[132:135], v9, s[4:7], s48 offen offset:0 sc1
  v_mfma_f32_16x16x32_bf16 v[56:59], a[12:15], a[192:195], v[56:59]
  ds_read_b64_tr_b16 a[62:63], v7 offset:13312
  s_waitcnt lgkmcnt(8)
  v_mfma_f32_16x16x32_bf16 v[64:67], a[32:35], a[192:195], v[64:67]
  ds_read_b64_tr_b16 a[0:1], v4 offset:16384
  s_add_u32 m0, s79, 40960
  v_mfma_f32_16x16x32_bf16 v[64:67], a[48:51], a[200:203], v[64:67]
  ds_read_b64_tr_b16 a[2:3], v4 offset:20480
  s_add_u32 s92, s92, 262144
  v_mfma_f32_16x16x32_bf16 v[68:71], a[48:51], a[204:207], v[68:71]
  ds_read_b64_tr_b16 a[16:17], v4 offset:24576
  buffer_load_dwordx4 v252, s[80:83], s92 offen lds
  v_mfma_f32_16x16x32_bf16 v[68:71], a[32:35], a[196:199], v[68:71]
  ds_read_b64_tr_b16 a[18:19], v4 offset:28672
  v_mfma_f32_16x16x32_bf16 v[76:79], a[36:39], a[196:199], v[76:79]
  ds_read_b64_tr_b16 a[4:5], v5 offset:16384
  v_mfma_f32_16x16x32_bf16 v[76:79], a[52:55], a[204:207], v[76:79]
  ds_read_b64_tr_b16 a[6:7], v5 offset:20480
  v_mfma_f32_16x16x32_bf16 v[72:75], a[52:55], a[200:203], v[72:75]
  ds_read_b64_tr_b16 a[20:21], v5 offset:24576
  buffer_load_dwordx4 v252, s[84:87], s92 offen offset:1024 lds
  v_mfma_f32_16x16x32_bf16 v[72:75], a[36:39], a[192:195], v[72:75]
  ds_read_b64_tr_b16 a[22:23], v5 offset:28672
  s_waitcnt lgkmcnt(8)
  v_mfma_f32_16x16x32_bf16 v[80:83], a[40:43], a[192:195], v[80:83]
  ds_read_b64_tr_b16 a[8:9], v6 offset:16384
  v_mfma_f32_16x16x32_bf16 v[80:83], a[56:59], a[200:203], v[80:83]
  ds_read_b64_tr_b16 a[10:11], v6 offset:20480
  v_mfma_f32_16x16x32_bf16 v[84:87], a[56:59], a[204:207], v[84:87]
  ds_read_b64_tr_b16 a[24:25], v6 offset:24576
  buffer_load_dwordx4 a[136:139], v8, s[4:7], s48 offen offset:1024 sc1
  v_mfma_f32_16x16x32_bf16 v[84:87], a[40:43], a[196:199], v[84:87]
  ds_read_b64_tr_b16 a[26:27], v6 offset:28672
  v_mfma_f32_16x16x32_bf16 v[92:95], a[44:47], a[196:199], v[92:95]
  ds_read_b64_tr_b16 a[12:13], v7 offset:16384
  v_mfma_f32_16x16x32_bf16 v[92:95], a[60:63], a[204:207], v[92:95]
  ds_read_b64_tr_b16 a[14:15], v7 offset:20480
  v_mfma_f32_16x16x32_bf16 v[88:91], a[60:63], a[200:203], v[88:91]
  ds_read_b64_tr_b16 a[28:29], v7 offset:24576
  buffer_load_dwordx4 a[140:143], v9, s[4:7], s48 offen offset:1024 sc1
  v_mfma_f32_16x16x32_bf16 v[88:91], a[44:47], a[192:195], v[88:91]
  ds_read_b64_tr_b16 a[30:31], v7 offset:28672
  s_waitcnt vmcnt(25) lgkmcnt(8)
  v_mfma_f32_16x16x32_bf16 v[32:35], a[0:3], a[208:211], v[32:35]
  ds_read_b64_tr_b16 a[32:33], v4 offset:17408
  s_add_u32 m0, s79, 49152
  v_mfma_f32_16x16x32_bf16 v[32:35], a[16:19], a[216:219], v[32:35]
  ds_read_b64_tr_b16 a[34:35], v4 offset:21504
  s_add_u32 s92, s92, 196608
  v_mfma_f32_16x16x32_bf16 v[36:39], a[16:19], a[220:223], v[36:39]
  ds_read_b64_tr_b16 a[48:49], v4 offset:25600
  buffer_load_dwordx4 v252, s[80:83], s92 offen lds
  v_mfma_f32_16x16x32_bf16 v[36:39], a[0:3], a[212:215], v[36:39]
  ds_read_b64_tr_b16 a[50:51], v4 offset:29696
  v_mfma_f32_16x16x32_bf16 v[44:47], a[4:7], a[212:215], v[44:47]
  ds_read_b64_tr_b16 a[36:37], v5 offset:17408
  v_mfma_f32_16x16x32_bf16 v[44:47], a[20:23], a[220:223], v[44:47]
  ds_read_b64_tr_b16 a[38:39], v5 offset:21504
  v_mfma_f32_16x16x32_bf16 v[40:43], a[20:23], a[216:219], v[40:43]
  ds_read_b64_tr_b16 a[52:53], v5 offset:25600
  buffer_load_dwordx4 v252, s[84:87], s92 offen offset:1024 lds
  v_mfma_f32_16x16x32_bf16 v[40:43], a[4:7], a[208:211], v[40:43]
  ds_read_b64_tr_b16 a[54:55], v5 offset:29696
  s_waitcnt lgkmcnt(8)
  v_mfma_f32_16x16x32_bf16 v[48:51], a[8:11], a[208:211], v[48:51]
  ds_read_b64_tr_b16 a[40:41], v6 offset:17408
  v_mfma_f32_16x16x32_bf16 v[48:51], a[24:27], a[216:219], v[48:51]
  ds_read_b64_tr_b16 a[42:43], v6 offset:21504
  v_mfma_f32_16x16x32_bf16 v[52:55], a[24:27], a[220:223], v[52:55]
  ds_read_b64_tr_b16 a[56:57], v6 offset:25600
  buffer_load_dwordx4 a[144:147], v8, s[4:7], s48 offen offset:2048 sc1
  v_mfma_f32_16x16x32_bf16 v[52:55], a[8:11], a[212:215], v[52:55]
  ds_read_b64_tr_b16 a[58:59], v6 offset:29696
  v_mfma_f32_16x16x32_bf16 v[60:63], a[12:15], a[212:215], v[60:63]
  ds_read_b64_tr_b16 a[44:45], v7 offset:17408
  v_mfma_f32_16x16x32_bf16 v[60:63], a[28:31], a[220:223], v[60:63]
  ds_read_b64_tr_b16 a[46:47], v7 offset:21504
  v_mfma_f32_16x16x32_bf16 v[56:59], a[28:31], a[216:219], v[56:59]
  ds_read_b64_tr_b16 a[60:61], v7 offset:25600
  buffer_load_dwordx4 a[148:151], v9, s[4:7], s48 offen offset:2048 sc1
  v_mfma_f32_16x16x32_bf16 v[56:59], a[12:15], a[208:211], v[56:59]
  ds_read_b64_tr_b16 a[62:63], v7 offset:29696
  s_waitcnt lgkmcnt(8)
  v_mfma_f32_16x16x32_bf16 v[64:67], a[32:35], a[208:211], v[64:67]
  ds_read_b64_tr_b16 a[0:1], v4 offset:32768
  s_add_u32 m0, s79, 57344
  v_mfma_f32_16x16x32_bf16 v[64:67], a[48:51], a[216:219], v[64:67]
  ds_read_b64_tr_b16 a[2:3], v4 offset:36864
  s_add_u32 s92, s92, 262144
  v_mfma_f32_16x16x32_bf16 v[68:71], a[48:51], a[220:223], v[68:71]
  ds_read_b64_tr_b16 a[16:17], v4 offset:40960
  buffer_load_dwordx4 v252, s[80:83], s92 offen lds
  v_mfma_f32_16x16x32_bf16 v[68:71], a[32:35], a[212:215], v[68:71]
  ds_read_b64_tr_b16 a[18:19], v4 offset:45056
  v_mfma_f32_16x16x32_bf16 v[76:79], a[36:39], a[212:215], v[76:79]
  ds_read_b64_tr_b16 a[4:5], v5 offset:32768
  v_mfma_f32_16x16x32_bf16 v[76:79], a[52:55], a[220:223], v[76:79]
  ds_read_b64_tr_b16 a[6:7], v5 offset:36864
  v_mfma_f32_16x16x32_bf16 v[72:75], a[52:55], a[216:219], v[72:75]
  ds_read_b64_tr_b16 a[20:21], v5 offset:40960
  buffer_load_dwordx4 v252, s[84:87], s92 offen offset:1024 lds
  v_mfma_f32_16x16x32_bf16 v[72:75], a[36:39], a[208:211], v[72:75]
  ds_read_b64_tr_b16 a[22:23], v5 offset:45056
  s_waitcnt lgkmcnt(8)
  v_mfma_f32_16x16x32_bf16 v[80:83], a[40:43], a[208:211], v[80:83]
  ds_read_b64_tr_b16 a[8:9], v6 offset:32768
  v_mfma_f32_16x16x32_bf16 v[80:83], a[56:59], a[216:219], v[80:83]
  ds_read_b64_tr_b16 a[10:11], v6 offset:36864
  v_mfma_f32_16x16x32_bf16 v[84:87], a[56:59], a[220:223], v[84:87]
  ds_read_b64_tr_b16 a[24:25], v6 offset:40960
  buffer_load_dwordx4 a[152:155], v8, s[4:7], s48 offen offset:3072 sc1
  v_mfma_f32_16x16x32_bf16 v[84:87], a[40:43], a[212:215], v[84:87]
  ds_read_b64_tr_b16 a[26:27], v6 offset:45056
  v_mfma_f32_16x16x32_bf16 v[92:95], a[44:47], a[212:215], v[92:95]
  ds_read_b64_tr_b16 a[12:13], v7 offset:32768
  v_mfma_f32_16x16x32_bf16 v[92:95], a[60:63], a[220:223], v[92:95]
  ds_read_b64_tr_b16 a[14:15], v7 offset:36864
  v_mfma_f32_16x16x32_bf16 v[88:91], a[60:63], a[216:219], v[88:91]
  ds_read_b64_tr_b16 a[28:29], v7 offset:40960
  buffer_load_dwordx4 a[156:159], v9, s[4:7], s48 offen offset:3072 sc1
  v_mfma_f32_16x16x32_bf16 v[88:91], a[44:47], a[208:211], v[88:91]
  ds_read_b64_tr_b16 a[30:31], v7 offset:45056
  s_waitcnt vmcnt(24) lgkmcnt(8)
  v_mfma_f32_16x16x32_bf16 v[32:35], a[0:3], a[224:227], v[32:35]
  s_waitcnt vmcnt(26)
  s_barrier
  ds_read_b64_tr_b16 a[32:33], v4 offset:33792
  v_mfma_f32_16x16x32_bf16 v[32:35], a[16:19], a[232:235], v[32:35]
  s_add_u32 m0, s79, 65536
  ds_read_b64_tr_b16 a[34:35], v4 offset:37888
  s_add_u32 s92, s92, 196608
  v_mfma_f32_16x16x32_bf16 v[36:39], a[16:19], a[236:239], v[36:39]
  ds_read_b64_tr_b16 a[48:49], v4 offset:41984
  buffer_load_dwordx4 v252, s[80:83], s92 offen lds
  v_mfma_f32_16x16x32_bf16 v[36:39], a[0:3], a[228:231], v[36:39]
  ds_read_b64_tr_b16 a[50:51], v4 offset:46080
  v_mfma_f32_16x16x32_bf16 v[44:47], a[4:7], a[228:231], v[44:47]
  ds_read_b64_tr_b16 a[36:37], v5 offset:33792
  v_mfma_f32_16x16x32_bf16 v[44:47], a[20:23], a[236:239], v[44:47]
  ds_read_b64_tr_b16 a[38:39], v5 offset:37888
  v_mfma_f32_16x16x32_bf16 v[40:43], a[20:23], a[232:235], v[40:43]
  ds_read_b64_tr_b16 a[52:53], v5 offset:41984
  buffer_load_dwordx4 v252, s[84:87], s92 offen offset:1024 lds
  v_mfma_f32_16x16x32_bf16 v[40:43], a[4:7], a[224:227], v[40:43]
  ds_read_b64_tr_b16 a[54:55], v5 offset:46080
  s_waitcnt lgkmcnt(8)
  v_mfma_f32_16x16x32_bf16 v[48:51], a[8:11], a[224:227], v[48:51]
  ds_read_b64_tr_b16 a[40:41], v6 offset:33792
  v_mfma_f32_16x16x32_bf16 v[48:51], a[24:27], a[232:235], v[48:51]
  ds_read_b64_tr_b16 a[42:43], v6 offset:37888
  s_add_u32 s48, s48, 4096
  v_mfma_f32_16x16x32_bf16 v[52:55], a[24:27], a[236:239], v[52:55]
  ds_read_b64_tr_b16 a[56:57], v6 offset:41984
  buffer_load_dwordx4 a[160:163], v8, s[4:7], s48 offen offset:0 sc1
  v_mfma_f32_16x16x32_bf16 v[52:55], a[8:11], a[228:231], v[52:55]
  ds_read_b64_tr_b16 a[58:59], v6 offset:46080
  v_mfma_f32_16x16x32_bf16 v[60:63], a[12:15], a[228:231], v[60:63]
  ds_read_b64_tr_b16 a[44:45], v7 offset:33792
  v_mfma_f32_16x16x32_bf16 v[60:63], a[28:31], a[236:239], v[60:63]
  ds_read_b64_tr_b16 a[46:47], v7 offset:37888
  v_mfma_f32_16x16x32_bf16 v[56:59], a[28:31], a[232:235], v[56:59]
  ds_read_b64_tr_b16 a[60:61], v7 offset:41984
  buffer_load_dwordx4 a[164:167], v9, s[4:7], s48 offen offset:0 sc1
  v_mfma_f32_16x16x32_bf16 v[56:59], a[12:15], a[224:227], v[56:59]
  ds_read_b64_tr_b16 a[62:63], v7 offset:46080
  s_waitcnt lgkmcnt(8)
  v_mfma_f32_16x16x32_bf16 v[64:67], a[32:35], a[224:227], v[64:67]
  ds_read_b64_tr_b16 a[0:1], v4 offset:49152
  s_add_u32 m0, s79, 73728
  v_mfma_f32_16x16x32_bf16 v[64:67], a[48:51], a[232:235], v[64:67]
  ds_read_b64_tr_b16 a[2:3], v4 offset:53248
  s_add_u32 s92, s92, 262144
  v_mfma_f32_16x16x32_bf16 v[68:71], a[48:51], a[236:239], v[68:71]
  ds_read_b64_tr_b16 a[16:17], v4 offset:57344
  buffer_load_dwordx4 v252, s[80:83], s92 offen lds
  v_mfma_f32_16x16x32_bf16 v[68:71], a[32:35], a[228:231], v[68:71]
  ds_read_b64_tr_b16 a[18:19], v4 offset:61440
  v_mfma_f32_16x16x32_bf16 v[76:79], a[36:39], a[228:231], v[76:79]
  ds_read_b64_tr_b16 a[4:5], v5 offset:49152
  v_mfma_f32_16x16x32_bf16 v[76:79], a[52:55], a[236:239], v[76:79]
  ds_read_b64_tr_b16 a[6:7], v5 offset:53248
  v_mfma_f32_16x16x32_bf16 v[72:75], a[52:55], a[232:235], v[72:75]
  ds_read_b64_tr_b16 a[20:21], v5 offset:57344
  buffer_load_dwordx4 v252, s[84:87], s92 offen offset:1024 lds
  v_mfma_f32_16x16x32_bf16 v[72:75], a[36:39], a[224:227], v[72:75]
  ds_read_b64_tr_b16 a[22:23], v5 offset:61440
  s_waitcnt lgkmcnt(8)
  v_mfma_f32_16x16x32_bf16 v[80:83], a[40:43], a[224:227], v[80:83]
  ds_read_b64_tr_b16 a[8:9], v6 offset:49152
  v_mfma_f32_16x16x32_bf16 v[80:83], a[56:59], a[232:235], v[80:83]
  ds_read_b64_tr_b16 a[10:11], v6 offset:53248
  v_mfma_f32_16x16x32_bf16 v[84:87], a[56:59], a[236:239], v[84:87]
  ds_read_b64_tr_b16 a[24:25], v6 offset:57344
  buffer_load_dwordx4 a[168:171], v8, s[4:7], s48 offen offset:1024 sc1
  v_mfma_f32_16x16x32_bf16 v[84:87], a[40:43], a[228:231], v[84:87]
  ds_read_b64_tr_b16 a[26:27], v6 offset:61440
  v_mfma_f32_16x16x32_bf16 v[92:95], a[44:47], a[228:231], v[92:95]
  ds_read_b64_tr_b16 a[12:13], v7 offset:49152
  v_mfma_f32_16x16x32_bf16 v[92:95], a[60:63], a[236:239], v[92:95]
  ds_read_b64_tr_b16 a[14:15], v7 offset:53248
  v_mfma_f32_16x16x32_bf16 v[88:91], a[60:63], a[232:235], v[88:91]
  ds_read_b64_tr_b16 a[28:29], v7 offset:57344
  buffer_load_dwordx4 a[172:175], v9, s[4:7], s48 offen offset:1024 sc1
  v_mfma_f32_16x16x32_bf16 v[88:91], a[44:47], a[224:227], v[88:91]
  ds_read_b64_tr_b16 a[30:31], v7 offset:61440
  s_waitcnt vmcnt(24) lgkmcnt(8)
  v_mfma_f32_16x16x32_bf16 v[32:35], a[0:3], a[240:243], v[32:35]
  ds_read_b64_tr_b16 a[32:33], v4 offset:50176
  s_add_u32 m0, s79, 81920
  v_mfma_f32_16x16x32_bf16 v[32:35], a[16:19], a[248:251], v[32:35]
  ds_read_b64_tr_b16 a[34:35], v4 offset:54272
  s_add_u32 s92, s92, 196608
  v_mfma_f32_16x16x32_bf16 v[36:39], a[16:19], a[252:255], v[36:39]
  ds_read_b64_tr_b16 a[48:49], v4 offset:58368
  buffer_load_dwordx4 v252, s[80:83], s92 offen lds
  v_mfma_f32_16x16x32_bf16 v[36:39], a[0:3], a[244:247], v[36:39]
  ds_read_b64_tr_b16 a[50:51], v4 offset:62464
  v_mfma_f32_16x16x32_bf16 v[44:47], a[4:7], a[244:247], v[44:47]
  ds_read_b64_tr_b16 a[36:37], v5 offset:50176
  v_mfma_f32_16x16x32_bf16 v[44:47], a[20:23], a[252:255], v[44:47]
  ds_read_b64_tr_b16 a[38:39], v5 offset:54272
  v_mfma_f32_16x16x32_bf16 v[40:43], a[20:23], a[248:251], v[40:43]
  ds_read_b64_tr_b16 a[52:53], v5 offset:58368
  buffer_load_dwordx4 v252, s[84:87], s92 offen offset:1024 lds
  v_mfma_f32_16x16x32_bf16 v[40:43], a[4:7], a[240:243], v[40:43]
  ds_read_b64_tr_b16 a[54:55], v5 offset:62464
  s_waitcnt lgkmcnt(8)
  v_mfma_f32_16x16x32_bf16 v[48:51], a[8:11], a[240:243], v[48:51]
  ds_read_b64_tr_b16 a[40:41], v6 offset:50176
  v_mfma_f32_16x16x32_bf16 v[48:51], a[24:27], a[248:251], v[48:51]
  ds_read_b64_tr_b16 a[42:43], v6 offset:54272
  v_mfma_f32_16x16x32_bf16 v[52:55], a[24:27], a[252:255], v[52:55]
  ds_read_b64_tr_b16 a[56:57], v6 offset:58368
  buffer_load_dwordx4 a[176:179], v8, s[4:7], s48 offen offset:2048 sc1
  v_mfma_f32_16x16x32_bf16 v[52:55], a[8:11], a[244:247], v[52:55]
  ds_read_b64_tr_b16 a[58:59], v6 offset:62464
  v_mfma_f32_16x16x32_bf16 v[60:63], a[12:15], a[244:247], v[60:63]
  ds_read_b64_tr_b16 a[44:45], v7 offset:50176
  v_mfma_f32_16x16x32_bf16 v[60:63], a[28:31], a[252:255], v[60:63]
  ds_read_b64_tr_b16 a[46:47], v7 offset:54272
  v_mfma_f32_16x16x32_bf16 v[56:59], a[28:31], a[248:251], v[56:59]
  ds_read_b64_tr_b16 a[60:61], v7 offset:58368
  buffer_load_dwordx4 a[180:183], v9, s[4:7], s48 offen offset:2048 sc1
  v_mfma_f32_16x16x32_bf16 v[56:59], a[12:15], a[240:243], v[56:59]
  ds_read_b64_tr_b16 a[62:63], v7 offset:62464
  s_waitcnt lgkmcnt(8)
  v_mfma_f32_16x16x32_bf16 v[64:67], a[32:35], a[240:243], v[64:67]
  ds_read_b64_tr_b16 a[0:1], v0 offset:0
  s_add_u32 m0, s79, 90112
  v_mfma_f32_16x16x32_bf16 v[64:67], a[48:51], a[248:251], v[64:67]
  ds_read_b64_tr_b16 a[2:3], v0 offset:4096
  s_add_u32 s92, s92, 262144
  v_mfma_f32_16x16x32_bf16 v[68:71], a[48:51], a[252:255], v[68:71]
  ds_read_b64_tr_b16 a[16:17], v0 offset:8192
  buffer_load_dwordx4 v252, s[80:83], s92 offen lds
  v_mfma_f32_16x16x32_bf16 v[68:71], a[32:35], a[244:247], v[68:71]
  ds_read_b64_tr_b16 a[18:19], v0 offset:12288
  v_mfma_f32_16x16x32_bf16 v[76:79], a[36:39], a[244:247], v[76:79]
  ds_read_b64_tr_b16 a[4:5], v1 offset:0
  v_mfma_f32_16x16x32_bf16 v[76:79], a[52:55], a[252:255], v[76:79]
  ds_read_b64_tr_b16 a[6:7], v1 offset:4096
  v_mfma_f32_16x16x32_bf16 v[72:75], a[52:55], a[248:251], v[72:75]
  ds_read_b64_tr_b16 a[20:21], v1 offset:8192
  buffer_load_dwordx4 v252, s[84:87], s92 offen offset:1024 lds
  v_mfma_f32_16x16x32_bf16 v[72:75], a[36:39], a[240:243], v[72:75]
  ds_read_b64_tr_b16 a[22:23], v1 offset:12288
  s_waitcnt lgkmcnt(8)
  v_mfma_f32_16x16x32_bf16 v[80:83], a[40:43], a[240:243], v[80:83]
  ds_read_b64_tr_b16 a[8:9], v2 offset:0
  v_mfma_f32_16x16x32_bf16 v[80:83], a[56:59], a[248:251], v[80:83]
  ds_read_b64_tr_b16 a[10:11], v2 offset:4096
  v_mfma_f32_16x16x32_bf16 v[84:87], a[56:59], a[252:255], v[84:87]
  ds_read_b64_tr_b16 a[24:25], v2 offset:8192
  buffer_load_dwordx4 a[184:187], v8, s[4:7], s48 offen offset:3072 sc1
  v_mfma_f32_16x16x32_bf16 v[84:87], a[40:43], a[244:247], v[84:87]
  ds_read_b64_tr_b16 a[26:27], v2 offset:12288
  v_mfma_f32_16x16x32_bf16 v[92:95], a[44:47], a[244:247], v[92:95]
  ds_read_b64_tr_b16 a[12:13], v3 offset:0
  v_mfma_f32_16x16x32_bf16 v[92:95], a[60:63], a[252:255], v[92:95]
  ds_read_b64_tr_b16 a[14:15], v3 offset:4096
  v_mfma_f32_16x16x32_bf16 v[88:91], a[60:63], a[248:251], v[88:91]
  ds_read_b64_tr_b16 a[28:29], v3 offset:8192
  buffer_load_dwordx4 a[188:191], v9, s[4:7], s48 offen offset:3072 sc1
  v_mfma_f32_16x16x32_bf16 v[88:91], a[44:47], a[240:243], v[88:91]
  s_sub_u32 s56, s56, 1
  ds_read_b64_tr_b16 a[30:31], v3 offset:12288
  s_cmp_lg_u32 s56, 0
  s_cbranch_scc1 Lp4_loop
Lmk_Lp4_loop_tail:
  s_waitcnt vmcnt(24) lgkmcnt(8)
  v_mfma_f32_16x16x32_bf16 v[32:35], a[0:3], a[128:131], v[32:35]
  s_waitcnt vmcnt(26)
  s_barrier
  ds_read_b64_tr_b16 a[32:33], v0 offset:1024
  v_mfma_f32_16x16x32_bf16 v[32:35], a[16:19], a[136:139], v[32:35]
  s_add_u32 m0, s79, 98304
  ds_read_b64_tr_b16 a[34:35], v0 offset:5120
  s_add_u32 s92, s92, 196608
  v_mfma_f32_16x16x32_bf16 v[36:39], a[16:19], a[140:143], v[36:39]
  ds_read_b64_tr_b16 a[48:49], v0 offset:9216
  buffer_load_dwordx4 v252, s[80:83], s92 offen lds
  v_mfma_f32_16x16x32_bf16 v[36:39], a[0:3], a[132:135], v[36:39]
  ds_read_b64_tr_b16 a[50:51], v0 offset:13312
  v_mfma_f32_16x16x32_bf16 v[44:47], a[4:7], a[132:135], v[44:47]
  ds_read_b64_tr_b16 a[36:37], v1 offset:1024
  v_mfma_f32_16x16x32_bf16 v[44:47], a[20:23], a[140:143], v[44:47]
  ds_read_b64_tr_b16 a[38:39], v1 offset:5120
  v_mfma_f32_16x16x32_bf16 v[40:43], a[20:23], a[136:139], v[40:43]
  ds_read_b64_tr_b16 a[52:53], v1 offset:9216
  buffer_load_dwordx4 v252, s[84:87], s92 offen offset:1024 lds
  v_mfma_f32_16x16x32_bf16 v[40:43], a[4:7], a[128:131], v[40:43]
  ds_read_b64_tr_b16 a[54:55], v1 offset:13312
  s_waitcnt lgkmcnt(8)
  v_mfma_f32_16x16x32_bf16 v[48:51], a[8:11], a[128:131], v[48:51]
  ds_read_b64_tr_b16 a[40:41], v2 offset:1024
  v_mfma_f32_16x16x32_bf16 v[48:51], a[24:27], a[136:139], v[48:51]
  ds_read_b64_tr_b16 a[42:43], v2 offset:5120
  s_add_u32 s48, s48, 4096
  v_mfma_f32_16x16x32_bf16 v[52:55], a[24:27], a[140:143], v[52:55]
  ds_read_b64_tr_b16 a[56:57], v2 offset:9216
  buffer_load_dwordx4 a[192:195], v8, s[4:7], s48 offen offset:0 sc1
  v_mfma_f32_16x16x32_bf16 v[52:55], a[8:11], a[132:135], v[52:55]
  ds_read_b64_tr_b16 a[58:59], v2 offset:13312
  v_mfma_f32_16x16x32_bf16 v[60:63], a[12:15], a[132:135], v[60:63]
  ds_read_b64_tr_b16 a[44:45], v3 offset:1024
  v_mfma_f32_16x16x32_bf16 v[60:63], a[28:31], a[140:143], v[60:63]
  ds_read_b64_tr_b16 a[46:47], v3 offset:5120
  v_mfma_f32_16x16x32_bf16 v[56:59], a[28:31], a[136:139], v[56:59]
  ds_read_b64_tr_b16 a[60:61], v3 offset:9216
  buffer_load_dwordx4 a[196:199], v9, s[4:7], s48 offen offset:0 sc1
  v_mfma_f32_16x16x32_bf16 v[56:59], a[12:15], a[128:131], v[56:59]
  ds_read_b64_tr_b16 a[62:63], v3 offset:13312
  s_waitcnt lgkmcnt(8)
  v_mfma_f32_16x16x32_bf16 v[64:67], a[32:35], a[128:131], v[64:67]
  ds_read_b64_tr_b16 a[0:1], v0 offset:16384
  s_add_u32 m0, s79, 106496
  v_mfma_f32_16x16x32_bf16 v[64:67], a[48:51], a[136:139], v[64:67]
  ds_read_b64_tr_b16 a[2:3], v0 offset:20480
  s_add_u32 s92, s92, 262144
  v_mfma_f32_16x16x32_bf16 v[68:71], a[48:51], a[140:143], v[68:71]
  ds_read_b64_tr_b16 a[16:17], v0 offset:24576
  buffer_load_dwordx4 v252, s[80:83], s92 offen lds
  v_mfma_f32_16x16x32_bf16 v[68:71], a[32:35], a[132:135], v[68:71]
  ds_read_b64_tr_b16 a[18:19], v0 offset:28672
  v_mfma_f32_16x16x32_bf16 v[76:79], a[36:39], a[132:135], v[76:79]
  ds_read_b64_tr_b16 a[4:5], v1 offset:16384
  v_mfma_f32_16x16x32_bf16 v[76:79], a[52:55], a[140:143], v[76:79]
  ds_read_b64_tr_b16 a[6:7], v1 offset:20480
  v_mfma_f32_16x16x32_bf16 v[72:75], a[52:55], a[136:139], v[72:75]
  ds_read_b64_tr_b16 a[20:21], v1 offset:24576
  buffer_load_dwordx4 v252, s[84:87], s92 offen offset:1024 lds
  v_mfma_f32_16x16x32_bf16 v[72:75], a[36:39], a[128:131], v[72:75]
  ds_read_b64_tr_b16 a[22:23], v1 offset:28672
  s_waitcnt lgkmcnt(8)
  v_mfma_f32_16x16x32_bf16 v[80:83], a[40:43], a[128:131], v[80:83]
  ds_read_b64_tr_b16 a[8:9], v2 offset:16384
  v_mfma_f32_16x16x32_bf16 v[80:83], a[56:59], a[136:139], v[80:83]
  ds_read_b64_tr_b16 a[10:11], v2 offset:20480
  v_mfma_f32_16x16x32_bf16 v[84:87], a[56:59], a[140:143], v[84:87]
  ds_read_b64_tr_b16 a[24:25], v2 offset:24576
  buffer_load_dwordx4 a[200:203], v8, s[4:7], s48 offen offset:1024 sc1
  v_mfma_f32_16x16x32_bf16 v[84:87], a[40:43], a[132:135], v[84:87]
  ds_read_b64_tr_b16 a[26:27], v2 offset:28672
  v_mfma_f32_16x16x32_bf16 v[92:95], a[44:47], a[132:135], v[92:95]
  ds_read_b64_tr_b16 a[12:13], v3 offset:16384
  v_mfma_f32_16x16x32_bf16 v[92:95], a[60:63], a[140:143], v[92:95]
  ds_read_b64_tr_b16 a[14:15], v3 offset:20480
  v_mfma_f32_16x16x32_bf16 v[88:91], a[60:63], a[136:139], v[88:91]
  ds_read_b64_tr_b16 a[28:29], v3 offset:24576
  buffer_load_dwordx4 a[204:207], v9, s[4:7], s48 offen offset:1024 sc1
  v_mfma_f32_16x16x32_bf16 v[88:91], a[44:47], a[128:131], v[88:91]
  ds_read_b64_tr_b16 a[30:31], v3 offset:28672
  s_waitcnt vmcnt(24) lgkmcnt(8)
  v_mfma_f32_16x16x32_bf16 v[32:35], a[0:3], a[144:147], v[32:35]
  ds_read_b64_tr_b16 a[32:33], v0 offset:17408
  s_add_u32 m0, s79, 114688
  v_mfma_f32_16x16x32_bf16 v[32:35], a[16:19], a[152:155], v[32:35]
  ds_read_b64_tr_b16 a[34:35], v0 offset:21504
  s_add_u32 s92, s92, 196608
  v_mfma_f32_16x16x32_bf16 v[36:39], a[16:19], a[156:159], v[36:39]
  ds_read_b64_tr_b16 a[48:49], v0 offset:25600
  buffer_load_dwordx4 v252, s[80:83], s92 offen lds
  v_mfma_f32_16x16x32_bf16 v[36:39], a[0:3], a[148:151], v[36:39]
  ds_read_b64_tr_b16 a[50:51], v0 offset:29696
  v_mfma_f32_16x16x32_bf16 v[44:47], a[4:7], a[148:151], v[44:47]
  ds_read_b64_tr_b16 a[36:37], v1 offset:17408
  v_mfma_f32_16x16x32_bf16 v[44:47], a[20:23], a[156:159], v[44:47]
  ds_read_b64_tr_b16 a[38:39], v1 offset:21504
  v_mfma_f32_16x16x32_bf16 v[40:43], a[20:23], a[152:155], v[40:43]
  ds_read_b64_tr_b16 a[52:53], v1 offset:25600
  buffer_load_dwordx4 v252, s[84:87], s92 offen offset:1024 lds
  v_mfma_f32_16x16x32_bf16 v[40:43], a[4:7], a[144:147], v[40:43]
  ds_read_b64_tr_b16 a[54:55], v1 offset:29696
  s_waitcnt lgkmcnt(8)
  v_mfma_f32_16x16x32_bf16 v[48:51], a[8:11], a[144:147], v[48:51]
  ds_read_b64_tr_b16 a[40:41], v2 offset:17408
  v_mfma_f32_16x16x32_bf16 v[48:51], a[24:27], a[152:155], v[48:51]
  ds_read_b64_tr_b16 a[42:43], v2 offset:21504
  v_mfma_f32_16x16x32_bf16 v[52:55], a[24:27], a[156:159], v[52:55]
  ds_read_b64_tr_b16 a[56:57], v2 offset:25600
  buffer_load_dwordx4 a[208:211], v8, s[4:7], s48 offen offset:2048 sc1
  v_mfma_f32_16x16x32_bf16 v[52:55], a[8:11], a[148:151], v[52:55]
  ds_read_b64_tr_b16 a[58:59], v2 offset:29696
  v_mfma_f32_16x16x32_bf16 v[60:63], a[12:15], a[148:151], v[60:63]
  ds_read_b64_tr_b16 a[44:45], v3 offset:17408
  v_mfma_f32_16x16x32_bf16 v[60:63], a[28:31], a[156:159], v[60:63]
  ds_read_b64_tr_b16 a[46:47], v3 offset:21504
  v_mfma_f32_16x16x32_bf16 v[56:59], a[28:31], a[152:155], v[56:59]
  ds_read_b64_tr_b16 a[60:61], v3 offset:25600
  buffer_load_dwordx4 a[212:215], v9, s[4:7], s48 offen offset:2048 sc1
  v_mfma_f32_16x16x32_bf16 v[56:59], a[12:15], a[144:147], v[56:59]
  ds_read_b64_tr_b16 a[62:63], v3 offset:29696
  s_waitcnt lgkmcnt(8)
  v_mfma_f32_16x16x32_bf16 v[64:67], a[32:35], a[144:147], v[64:67]
  ds_read_b64_tr_b16 a[0:1], v0 offset:32768
  s_add_u32 m0, s79, 122880
  v_mfma_f32_16x16x32_bf16 v[64:67], a[48:51], a[152:155], v[64:67]
  ds_read_b64_tr_b16 a[2:3], v0 offset:36864
  s_add_u32 s92, s92, 262144
  v_mfma_f32_16x16x32_bf16 v[68:71], a[48:51], a[156:159], v[68:71]
  ds_read_b64_tr_b16 a[16:17], v0 offset:40960
  buffer_load_dwordx4 v252, s[80:83], s92 offen lds
  v_mfma_f32_16x16x32_bf16 v[68:71], a[32:35], a[148:151], v[68:71]
  ds_read_b64_tr_b16 a[18:19], v0 offset:45056
  v_mfma_f32_16x16x32_bf16 v[76:79], a[36:39], a[148:151], v[76:79]
  ds_read_b64_tr_b16 a[4:5], v1 offset:32768
  v_mfma_f32_16x16x32_bf16 v[76:79], a[52:55], a[156:159], v[76:79]
  ds_read_b64_tr_b16 a[6:7], v1 offset:36864
  v_mfma_f32_16x16x32_bf16 v[72:75], a[52:55], a[152:155], v[72:75]
  ds_read_b64_tr_b16 a[20:21], v1 offset:40960
  buffer_load_dwordx4 v252, s[84:87], s92 offen offset:1024 lds
  v_mfma_f32_16x16x32_bf16 v[72:75], a[36:39], a[144:147], v[72:75]
  ds_read_b64_tr_b16 a[22:23], v1 offset:45056
  s_waitcnt lgkmcnt(8)
  v_mfma_f32_16x16x32_bf16 v[80:83], a[40:43], a[144:147], v[80:83]
  ds_read_b64_tr_b16 a[8:9], v2 offset:32768
  v_mfma_f32_16x16x32_bf16 v[80:83], a[56:59], a[152:155], v[80:83]
  ds_read_b64_tr_b16 a[10:11], v2 offset:36864
  v_mfma_f32_16x16x32_bf16 v[84:87], a[56:59], a[156:159], v[84:87]
  ds_read_b64_tr_b16 a[24:25], v2 offset:40960
  buffer_load_dwordx4 a[216:219], v8, s[4:7], s48 offen offset:3072 sc1
  v_mfma_f32_16x16x32_bf16 v[84:87], a[40:43], a[148:151], v[84:87]
  ds_read_b64_tr_b16 a[26:27], v2 offset:45056
  v_mfma_f32_16x16x32_bf16 v[92:95], a[44:47], a[148:151], v[92:95]
  ds_read_b64_tr_b16 a[12:13], v3 offset:32768
  v_mfma_f32_16x16x32_bf16 v[92:95], a[60:63], a[156:159], v[92:95]
  ds_read_b64_tr_b16 a[14:15], v3 offset:36864
  v_mfma_f32_16x16x32_bf16 v[88:91], a[60:63], a[152:155], v[88:91]
  ds_read_b64_tr_b16 a[28:29], v3 offset:40960
  buffer_load_dwordx4 a[220:223], v9, s[4:7], s48 offen offset:3072 sc1
  v_mfma_f32_16x16x32_bf16 v[88:91], a[44:47], a[144:147], v[88:91]
  ds_read_b64_tr_b16 a[30:31], v3 offset:45056
  s_waitcnt vmcnt(24) lgkmcnt(8)
  v_mfma_f32_16x16x32_bf16 v[32:35], a[0:3], a[160:163], v[32:35]
  s_waitcnt vmcnt(26)
  s_barrier
  ds_read_b64_tr_b16 a[32:33], v0 offset:33792
  s_add_u32 m0, s79, 0
  v_mfma_f32_16x16x32_bf16 v[32:35], a[16:19], a[168:171], v[32:35]
  s_add_u32 s92, s92, -3407872
  ds_read_b64_tr_b16 a[34:35], v0 offset:37888
  s_add_u32 s92, s92, s78
  v_mfma_f32_16x16x32_bf16 v[36:39], a[16:19], a[172:175], v[36:39]
  ds_read_b64_tr_b16 a[48:49], v0 offset:41984
  buffer_load_dwordx4 v252, s[80:83], s92 offen lds
  v_mfma_f32_16x16x32_bf16 v[36:39], a[0:3], a[164:167], v[36:39]
  ds_read_b64_tr_b16 a[50:51], v0 offset:46080
  v_mfma_f32_16x16x32_bf16 v[44:47], a[4:7], a[164:167], v[44:47]
  ds_read_b64_tr_b16 a[36:37], v1 offset:33792
  v_mfma_f32_16x16x32_bf16 v[44:47], a[20:23], a[172:175], v[44:47]
  ds_read_b64_tr_b16 a[38:39], v1 offset:37888
  v_mfma_f32_16x16x32_bf16 v[40:43], a[20:23], a[168:171], v[40:43]
  ds_read_b64_tr_b16 a[52:53], v1 offset:41984
  buffer_load_dwordx4 v252, s[84:87], s92 offen offset:1024 lds
  v_mfma_f32_16x16x32_bf16 v[40:43], a[4:7], a[160:163], v[40:43]
  ds_read_b64_tr_b16 a[54:55], v1 offset:46080
  s_waitcnt lgkmcnt(8)
  v_mfma_f32_16x16x32_bf16 v[48:51], a[8:11], a[160:163], v[48:51]
  ds_read_b64_tr_b16 a[40:41], v2 offset:33792
  v_mfma_f32_16x16x32_bf16 v[48:51], a[24:27], a[168:171], v[48:51]
  ds_read_b64_tr_b16 a[42:43], v2 offset:37888
  s_add_u32 s48, s48, 4096
  v_mfma_f32_16x16x32_bf16 v[52:55], a[24:27], a[172:175], v[52:55]
  ds_read_b64_tr_b16 a[56:57], v2 offset:41984
  buffer_load_dwordx4 a[224:227], v8, s[4:7], s48 offen offset:0 sc1
  v_mfma_f32_16x16x32_bf16 v[52:55], a[8:11], a[164:167], v[52:55]
  ds_read_b64_tr_b16 a[58:59], v2 offset:46080
  v_mfma_f32_16x16x32_bf16 v[60:63], a[12:15], a[164:167], v[60:63]
  ds_read_b64_tr_b16 a[44:45], v3 offset:33792
  v_mfma_f32_16x16x32_bf16 v[60:63], a[28:31], a[172:175], v[60:63]
  ds_read_b64_tr_b16 a[46:47], v3 offset:37888
  v_mfma_f32_16x16x32_bf16 v[56:59], a[28:31], a[168:171], v[56:59]
  ds_read_b64_tr_b16 a[60:61], v3 offset:41984
  buffer_load_dwordx4 a[228:231], v9, s[4:7], s48 offen offset:0 sc1
  v_mfma_f32_16x16x32_bf16 v[56:59], a[12:15], a[160:163], v[56:59]
  ds_read_b64_tr_b16 a[62:63], v3 offset:46080
  s_waitcnt lgkmcnt(8)
  v_mfma_f32_16x16x32_bf16 v[64:67], a[32:35], a[160:163], v[64:67]
  ds_read_b64_tr_b16 a[0:1], v0 offset:49152
  s_add_u32 m0, s79, 8192
  v_mfma_f32_16x16x32_bf16 v[64:67], a[48:51], a[168:171], v[64:67]
  ds_read_b64_tr_b16 a[2:3], v0 offset:53248
  s_add_u32 s92, s92, 458752
  v_mfma_f32_16x16x32_bf16 v[68:71], a[48:51], a[172:175], v[68:71]
  ds_read_b64_tr_b16 a[16:17], v0 offset:57344
  buffer_load_dwordx4 v252, s[80:83], s92 offen lds
  v_mfma_f32_16x16x32_bf16 v[68:71], a[32:35], a[164:167], v[68:71]
  ds_read_b64_tr_b16 a[18:19], v0 offset:61440
  v_mfma_f32_16x16x32_bf16 v[76:79], a[36:39], a[164:167], v[76:79]
  ds_read_b64_tr_b16 a[4:5], v1 offset:49152
  v_mfma_f32_16x16x32_bf16 v[76:79], a[52:55], a[172:175], v[76:79]
  ds_read_b64_tr_b16 a[6:7], v1 offset:53248
  v_mfma_f32_16x16x32_bf16 v[72:75], a[52:55], a[168:171], v[72:75]
  ds_read_b64_tr_b16 a[20:21], v1 offset:57344
  buffer_load_dwordx4 v252, s[84:87], s92 offen offset:1024 lds
  v_mfma_f32_16x16x32_bf16 v[72:75], a[36:39], a[160:163], v[72:75]
  ds_read_b64_tr_b16 a[22:23], v1 offset:61440
  s_waitcnt lgkmcnt(8)
  v_mfma_f32_16x16x32_bf16 v[80:83], a[40:43], a[160:163], v[80:83]
  ds_read_b64_tr_b16 a[8:9], v2 offset:49152
  v_mfma_f32_16x16x32_bf16 v[80:83], a[56:59], a[168:171], v[80:83]
  ds_read_b64_tr_b16 a[10:11], v2 offset:53248
  v_mfma_f32_16x16x32_bf16 v[84:87], a[56:59], a[172:175], v[84:87]
  ds_read_b64_tr_b16 a[24:25], v2 offset:57344
  buffer_load_dwordx4 a[232:235], v8, s[4:7], s48 offen offset:1024 sc1
  v_mfma_f32_16x16x32_bf16 v[84:87], a[40:43], a[164:167], v[84:87]
  ds_read_b64_tr_b16 a[26:27], v2 offset:61440
  v_mfma_f32_16x16x32_bf16 v[92:95], a[44:47], a[164:167], v[92:95]
  ds_read_b64_tr_b16 a[12:13], v3 offset:49152
  v_mfma_f32_16x16x32_bf16 v[92:95], a[60:63], a[172:175], v[92:95]
  ds_read_b64_tr_b16 a[14:15], v3 offset:53248
  v_mfma_f32_16x16x32_bf16 v[88:91], a[60:63], a[168:171], v[88:91]
  ds_read_b64_tr_b16 a[28:29], v3 offset:57344
  buffer_load_dwordx4 a[236:239], v9, s[4:7], s48 offen offset:1024 sc1
  v_mfma_f32_16x16x32_bf16 v[88:91], a[44:47], a[160:163], v[88:91]
  ds_read_b64_tr_b16 a[30:31], v3 offset:61440
  s_waitcnt vmcnt(24) lgkmcnt(8)
  v_mfma_f32_16x16x32_bf16 v[32:35], a[0:3], a[176:179], v[32:35]
  ds_read_b64_tr_b16 a[32:33], v0 offset:50176
  s_add_u32 m0, s79, 16384
  v_mfma_f32_16x16x32_bf16 v[32:35], a[16:19], a[184:187], v[32:35]
  ds_read_b64_tr_b16 a[34:35], v0 offset:54272
  s_add_u32 s92, s92, 458752
  v_mfma_f32_16x16x32_bf16 v[36:39], a[16:19], a[188:191], v[36:39]
  ds_read_b64_tr_b16 a[48:49], v0 offset:58368
  buffer_load_dwordx4 v252, s[80:83], s92 offen lds
  v_mfma_f32_16x16x32_bf16 v[36:39], a[0:3], a[180:183], v[36:39]
  ds_read_b64_tr_b16 a[50:51], v0 offset:62464
  v_mfma_f32_16x16x32_bf16 v[44:47], a[4:7], a[180:183], v[44:47]
  ds_read_b64_tr_b16 a[36:37], v1 offset:50176
  v_mfma_f32_16x16x32_bf16 v[44:47], a[20:23], a[188:191], v[44:47]
  ds_read_b64_tr_b16 a[38:39], v1 offset:54272
  v_mfma_f32_16x16x32_bf16 v[40:43], a[20:23], a[184:187], v[40:43]
  ds_read_b64_tr_b16 a[52:53], v1 offset:58368
  buffer_load_dwordx4 v252, s[84:87], s92 offen offset:1024 lds
  v_mfma_f32_16x16x32_bf16 v[40:43], a[4:7], a[176:179], v[40:43]
  ds_read_b64_tr_b16 a[54:55], v1 offset:62464
  s_waitcnt lgkmcnt(8)
  v_mfma_f32_16x16x32_bf16 v[48:51], a[8:11], a[176:179], v[48:51]
  ds_read_b64_tr_b16 a[40:41], v2 offset:50176
  v_mfma_f32_16x16x32_bf16 v[48:51], a[24:27], a[184:187], v[48:51]
  ds_read_b64_tr_b16 a[42:43], v2 offset:54272
  v_mfma_f32_16x16x32_bf16 v[52:55], a[24:27], a[188:191], v[52:55]
  ds_read_b64_tr_b16 a[56:57], v2 offset:58368
  buffer_load_dwordx4 a[240:243], v8, s[4:7], s48 offen offset:2048 sc1
  v_mfma_f32_16x16x32_bf16 v[52:55], a[8:11], a[180:183], v[52:55]
  ds_read_b64_tr_b16 a[58:59], v2 offset:62464
  v_mfma_f32_16x16x32_bf16 v[60:63], a[12:15], a[180:183], v[60:63]
  ds_read_b64_tr_b16 a[44:45], v3 offset:50176
  v_mfma_f32_16x16x32_bf16 v[60:63], a[28:31], a[188:191], v[60:63]
  ds_read_b64_tr_b16 a[46:47], v3 offset:54272
  v_mfma_f32_16x16x32_bf16 v[56:59], a[28:31], a[184:187], v[56:59]
  ds_read_b64_tr_b16 a[60:61], v3 offset:58368
  buffer_load_dwordx4 a[244:247], v9, s[4:7], s48 offen offset:2048 sc1
  v_mfma_f32_16x16x32_bf16 v[56:59], a[12:15], a[176:179], v[56:59]
  ds_read_b64_tr_b16 a[62:63], v3 offset:62464
  s_waitcnt lgkmcnt(8)
  v_mfma_f32_16x16x32_bf16 v[64:67], a[32:35], a[176:179], v[64:67]
  ds_read_b64_tr_b16 a[0:1], v4 offset:0
  s_add_u32 m0, s79, 24576
  v_mfma_f32_16x16x32_bf16 v[64:67], a[48:51], a[184:187], v[64:67]
  ds_read_b64_tr_b16 a[2:3], v4 offset:4096
  s_add_u32 s92, s92, 458752
  v_mfma_f32_16x16x32_bf16 v[68:71], a[48:51], a[188:191], v[68:71]
  ds_read_b64_tr_b16 a[16:17], v4 offset:8192
  buffer_load_dwordx4 v252, s[80:83], s92 offen lds
  v_mfma_f32_16x16x32_bf16 v[68:71], a[32:35], a[180:183], v[68:71]
  ds_read_b64_tr_b16 a[18:19], v4 offset:12288
  v_mfma_f32_16x16x32_bf16 v[76:79], a[36:39], a[180:183], v[76:79]
  ds_read_b64_tr_b16 a[4:5], v5 offset:0
  v_mfma_f32_16x16x32_bf16 v[76:79], a[52:55], a[188:191], v[76:79]
  ds_read_b64_tr_b16 a[6:7], v5 offset:4096
  v_mfma_f32_16x16x32_bf16 v[72:75], a[52:55], a[184:187], v[72:75]
  ds_read_b64_tr_b16 a[20:21], v5 offset:8192
  buffer_load_dwordx4 v252, s[84:87], s92 offen offset:1024 lds
  v_mfma_f32_16x16x32_bf16 v[72:75], a[36:39], a[176:179], v[72:75]
  ds_read_b64_tr_b16 a[22:23], v5 offset:12288
  s_waitcnt lgkmcnt(8)
  v_mfma_f32_16x16x32_bf16 v[80:83], a[40:43], a[176:179], v[80:83]
  ds_read_b64_tr_b16 a[8:9], v6 offset:0
  v_mfma_f32_16x16x32_bf16 v[80:83], a[56:59], a[184:187], v[80:83]
  ds_read_b64_tr_b16 a[10:11], v6 offset:4096
  v_mfma_f32_16x16x32_bf16 v[84:87], a[56:59], a[188:191], v[84:87]
  ds_read_b64_tr_b16 a[24:25], v6 offset:8192
  buffer_load_dwordx4 a[248:251], v8, s[4:7], s48 offen offset:3072 sc1
  v_mfma_f32_16x16x32_bf16 v[84:87], a[40:43], a[180:183], v[84:87]
  ds_read_b64_tr_b16 a[26:27], v6 offset:12288
  v_mfma_f32_16x16x32_bf16 v[92:95], a[44:47], a[180:183], v[92:95]
  ds_read_b64_tr_b16 a[12:13], v7 offset:0
  v_mfma_f32_16x16x32_bf16 v[92:95], a[60:63], a[188:191], v[92:95]
  ds_read_b64_tr_b16 a[14:15], v7 offset:4096
  v_mfma_f32_16x16x32_bf16 v[88:91], a[60:63], a[184:187], v[88:91]
  ds_read_b64_tr_b16 a[28:29], v7 offset:8192
  buffer_load_dwordx4 a[252:255], v9, s[4:7], s48 offen offset:3072 sc1
  v_mfma_f32_16x16x32_bf16 v[88:91], a[44:47], a[176:179], v[88:91]
  ds_read_b64_tr_b16 a[30:31], v7 offset:12288
  s_waitcnt vmcnt(24) lgkmcnt(8)
  v_mfma_f32_16x16x32_bf16 v[32:35], a[0:3], a[192:195], v[32:35]
  s_waitcnt vmcnt(26)
  s_barrier
  ds_read_b64_tr_b16 a[32:33], v4 offset:16384
  v_mfma_f32_16x16x32_bf16 v[32:35], a[16:19], a[200:203], v[32:35]
  s_add_u32 m0, s79, 32768
  ds_read_b64_tr_b16 a[34:35], v4 offset:20480
  s_add_u32 s92, s92, 458752
  v_mfma_f32_16x16x32_bf16 v[36:39], a[16:19], a[204:207], v[36:39]
  ds_read_b64_tr_b16 a[48:49], v4 offset:24576
  buffer_load_dwordx4 v252, s[80:83], s92 offen lds
  v_mfma_f32_16x16x32_bf16 v[36:39], a[0:3], a[196:199], v[36:39]
  ds_read_b64_tr_b16 a[50:51], v4 offset:28672
  v_mfma_f32_16x16x32_bf16 v[44:47], a[4:7], a[196:199], v[44:47]
  ds_read_b64_tr_b16 a[36:37], v5 offset:16384
  buffer_load_dwordx4 v252, s[84:87], s92 offen offset:1024 lds
  v_mfma_f32_16x16x32_bf16 v[44:47], a[20:23], a[204:207], v[44:47]
  ds_read_b64_tr_b16 a[38:39], v5 offset:20480
  s_add_u32 s48, s48, 4096
  v_mfma_f32_16x16x32_bf16 v[40:43], a[20:23], a[200:203], v[40:43]
  ds_read_b64_tr_b16 a[52:53], v5 offset:24576
  buffer_load_dwordx4 a[128:131], v8, s[4:7], s48 offen offset:0 sc1
  v_mfma_f32_16x16x32_bf16 v[40:43], a[4:7], a[192:195], v[40:43]
  ds_read_b64_tr_b16 a[54:55], v5 offset:28672
  s_waitcnt lgkmcnt(8)
  v_mfma_f32_16x16x32_bf16 v[48:51], a[8:11], a[192:195], v[48:51]
  s_add_u32 m0, s79, 40960
  ds_read_b64_tr_b16 a[40:41], v6 offset:16384
  buffer_load_dwordx4 a[132:135], v9, s[4:7], s48 offen offset:0 sc1
  v_mfma_f32_16x16x32_bf16 v[48:51], a[24:27], a[200:203], v[48:51]
  ds_read_b64_tr_b16 a[42:43], v6 offset:20480
  s_add_u32 s92, s92, 458752
  v_mfma_f32_16x16x32_bf16 v[52:55], a[24:27], a[204:207], v[52:55]
  ds_read_b64_tr_b16 a[56:57], v6 offset:24576
  buffer_load_dwordx4 v252, s[80:83], s92 offen lds
  v_mfma_f32_16x16x32_bf16 v[52:55], a[8:11], a[196:199], v[52:55]
  ds_read_b64_tr_b16 a[58:59], v6 offset:28672
  v_mfma_f32_16x16x32_bf16 v[60:63], a[12:15], a[196:199], v[60:63]
  ds_read_b64_tr_b16 a[44:45], v7 offset:16384
  buffer_load_dwordx4 v252, s[84:87], s92 offen offset:1024 lds
  v_mfma_f32_16x16x32_bf16 v[60:63], a[28:31], a[204:207], v[60:63]
  ds_read_b64_tr_b16 a[46:47], v7 offset:20480
  v_mfma_f32_16x16x32_bf16 v[56:59], a[28:31], a[200:203], v[56:59]
  ds_read_b64_tr_b16 a[60:61], v7 offset:24576
  buffer_load_dwordx4 a[136:139], v8, s[4:7], s48 offen offset:1024 sc1
  v_mfma_f32_16x16x32_bf16 v[56:59], a[12:15], a[192:195], v[56:59]
  s_waitcnt vmcnt(23) lgkmcnt(7)
  ds_read_b64_tr_b16 a[62:63], v7 offset:28672
  buffer_load_dwordx4 a[140:143], v9, s[4:7], s48 offen offset:1024 sc1
  v_mfma_f32_16x16x32_bf16 v[32:35], a[32:35], a[208:211], v[32:35]
  ds_read_b64_tr_b16 a[0:1], v4 offset:32768
  s_add_u32 m0, s79, 49152
  v_mfma_f32_16x16x32_bf16 v[32:35], a[48:51], a[216:219], v[32:35]
  ds_read_b64_tr_b16 a[2:3], v4 offset:36864
  s_add_u32 s92, s92, 458752
  v_mfma_f32_16x16x32_bf16 v[36:39], a[48:51], a[220:223], v[36:39]
  ds_read_b64_tr_b16 a[16:17], v4 offset:40960
  buffer_load_dwordx4 v252, s[80:83], s92 offen lds
  v_mfma_f32_16x16x32_bf16 v[36:39], a[32:35], a[212:215], v[36:39]
  ds_read_b64_tr_b16 a[18:19], v4 offset:45056
  v_mfma_f32_16x16x32_bf16 v[44:47], a[36:39], a[212:215], v[44:47]
  ds_read_b64_tr_b16 a[4:5], v5 offset:32768
  buffer_load_dwordx4 v252, s[84:87], s92 offen offset:1024 lds
  v_mfma_f32_16x16x32_bf16 v[44:47], a[52:55], a[220:223], v[44:47]
  ds_read_b64_tr_b16 a[6:7], v5 offset:36864
  v_mfma_f32_16x16x32_bf16 v[40:43], a[52:55], a[216:219], v[40:43]
  ds_read_b64_tr_b16 a[20:21], v5 offset:40960
  buffer_load_dwordx4 a[144:147], v8, s[4:7], s48 offen offset:2048 sc1
  v_mfma_f32_16x16x32_bf16 v[40:43], a[36:39], a[208:211], v[40:43]
  ds_read_b64_tr_b16 a[22:23], v5 offset:45056
  s_waitcnt lgkmcnt(8)
  v_mfma_f32_16x16x32_bf16 v[48:51], a[40:43], a[208:211], v[48:51]
  s_add_u32 m0, s79, 57344
  ds_read_b64_tr_b16 a[8:9], v6 offset:32768
  buffer_load_dwordx4 a[148:151], v9, s[4:7], s48 offen offset:2048 sc1
  v_mfma_f32_16x16x32_bf16 v[48:51], a[56:59], a[216:219], v[48:51]
  ds_read_b64_tr_b16 a[10:11], v6 offset:36864
  s_add_u32 s92, s92, 458752
  v_mfma_f32_16x16x32_bf16 v[52:55], a[56:59], a[220:223], v[52:55]
  ds_read_b64_tr_b16 a[24:25], v6 offset:40960
  buffer_load_dwordx4 v252, s[80:83], s92 offen lds
  v_mfma_f32_16x16x32_bf16 v[52:55], a[40:43], a[212:215], v[52:55]
  ds_read_b64_tr_b16 a[26:27], v6 offset:45056
  v_mfma_f32_16x16x32_bf16 v[60:63], a[44:47], a[212:215], v[60:63]
  ds_read_b64_tr_b16 a[12:13], v7 offset:32768
  buffer_load_dwordx4 v252, s[84:87], s92 offen offset:1024 lds
  v_mfma_f32_16x16x32_bf16 v[60:63], a[60:63], a[220:223], v[60:63]
  ds_read_b64_tr_b16 a[14:15], v7 offset:36864
  v_mfma_f32_16x16x32_bf16 v[56:59], a[60:63], a[216:219], v[56:59]
  ds_read_b64_tr_b16 a[28:29], v7 offset:40960
  buffer_load_dwordx4 a[152:155], v8, s[4:7], s48 offen offset:3072 sc1
  v_mfma_f32_16x16x32_bf16 v[56:59], a[44:47], a[208:211], v[56:59]
  s_waitcnt vmcnt(23) lgkmcnt(7)
  ds_read_b64_tr_b16 a[30:31], v7 offset:45056
  buffer_load_dwordx4 a[156:159], v9, s[4:7], s48 offen offset:3072 sc1
  v_mfma_f32_16x16x32_bf16 v[32:35], a[0:3], a[224:227], v[32:35]
  s_waitcnt vmcnt(26)
  s_barrier
  ds_read_b64_tr_b16 a[32:33], v4 offset:49152
  v_mfma_f32_16x16x32_bf16 v[32:35], a[16:19], a[232:235], v[32:35]
  ds_read_b64_tr_b16 a[34:35], v4 offset:53248
  s_add_u32 s48, s48, 4096
  v_mfma_f32_16x16x32_bf16 v[36:39], a[16:19], a[236:239], v[36:39]
  ds_read_b64_tr_b16 a[48:49], v4 offset:57344
  buffer_load_dwordx4 a[160:163], v8, s[4:7], s48 offen offset:0 sc1
  v_mfma_f32_16x16x32_bf16 v[36:39], a[0:3], a[228:231], v[36:39]
  ds_read_b64_tr_b16 a[50:51], v4 offset:61440
  v_mfma_f32_16x16x32_bf16 v[44:47], a[4:7], a[228:231], v[44:47]
  ds_read_b64_tr_b16 a[36:37], v5 offset:49152
  v_mfma_f32_16x16x32_bf16 v[44:47], a[20:23], a[236:239], v[44:47]
  ds_read_b64_tr_b16 a[38:39], v5 offset:53248
  v_mfma_f32_16x16x32_bf16 v[40:43], a[20:23], a[232:235], v[40:43]
  ds_read_b64_tr_b16 a[52:53], v5 offset:57344
  buffer_load_dwordx4 a[164:167], v9, s[4:7], s48 offen offset:0 sc1
  v_mfma_f32_16x16x32_bf16 v[40:43], a[4:7], a[224:227], v[40:43]
  ds_read_b64_tr_b16 a[54:55], v5 offset:61440
  s_waitcnt lgkmcnt(8)
  v_mfma_f32_16x16x32_bf16 v[48:51], a[8:11], a[224:227], v[48:51]
  ds_read_b64_tr_b16 a[40:41], v6 offset:49152
  v_mfma_f32_16x16x32_bf16 v[48:51], a[24:27], a[232:235], v[48:51]
  ds_read_b64_tr_b16 a[42:43], v6 offset:53248
  v_mfma_f32_16x16x32_bf16 v[52:55], a[24:27], a[236:239], v[52:55]
  ds_read_b64_tr_b16 a[56:57], v6 offset:57344
  buffer_load_dwordx4 a[168:171], v8, s[4:7], s48 offen offset:1024 sc1
  v_mfma_f32_16x16x32_bf16 v[52:55], a[8:11], a[228:231], v[52:55]
  ds_read_b64_tr_b16 a[58:59], v6 offset:61440
  v_mfma_f32_16x16x32_bf16 v[60:63], a[12:15], a[228:231], v[60:63]
  ds_read_b64_tr_b16 a[44:45], v7 offset:49152
  v_mfma_f32_16x16x32_bf16 v[60:63], a[28:31], a[236:239], v[60:63]
  ds_read_b64_tr_b16 a[46:47], v7 offset:53248
  v_mfma_f32_16x16x32_bf16 v[56:59], a[28:31], a[232:235], v[56:59]
  ds_read_b64_tr_b16 a[60:61], v7 offset:57344
  buffer_load_dwordx4 a[172:175], v9, s[4:7], s48 offen offset:1024 sc1
  v_mfma_f32_16x16x32_bf16 v[56:59], a[12:15], a[224:227], v[56:59]
  ds_read_b64_tr_b16 a[62:63], v7 offset:61440
  s_waitcnt vmcnt(20) lgkmcnt(8)
  v_mfma_f32_16x16x32_bf16 v[32:35], a[32:35], a[240:243], v[32:35]
  ds_read_b64_tr_b16 a[0:1], v0 offset:0
  v_mfma_f32_16x16x32_bf16 v[32:35], a[48:51], a[248:251], v[32:35]
  ds_read_b64_tr_b16 a[2:3], v0 offset:4096
  v_mfma_f32_16x16x32_bf16 v[36:39], a[48:51], a[252:255], v[36:39]
  ds_read_b64_tr_b16 a[16:17], v0 offset:8192
  buffer_load_dwordx4 a[176:179], v8, s[4:7], s48 offen offset:2048 sc1
  v_mfma_f32_16x16x32_bf16 v[36:39], a[32:35], a[244:247], v[36:39]
  ds_read_b64_tr_b16 a[18:19], v0 offset:12288
  v_mfma_f32_16x16x32_bf16 v[44:47], a[36:39], a[244:247], v[44:47]
  ds_read_b64_tr_b16 a[4:5], v1 offset:0
  v_mfma_f32_16x16x32_bf16 v[44:47], a[52:55], a[252:255], v[44:47]
  ds_read_b64_tr_b16 a[6:7], v1 offset:4096
  v_mfma_f32_16x16x32_bf16 v[40:43], a[52:55], a[248:251], v[40:43]
  ds_read_b64_tr_b16 a[20:21], v1 offset:8192
  buffer_load_dwordx4 a[180:183], v9, s[4:7], s48 offen offset:2048 sc1
  v_mfma_f32_16x16x32_bf16 v[40:43], a[36:39], a[240:243], v[40:43]
  ds_read_b64_tr_b16 a[22:23], v1 offset:12288
  s_waitcnt lgkmcnt(8)
  v_mfma_f32_16x16x32_bf16 v[48:51], a[40:43], a[240:243], v[48:51]
  ds_read_b64_tr_b16 a[8:9], v2 offset:0
  v_mfma_f32_16x16x32_bf16 v[48:51], a[56:59], a[248:251], v[48:51]
  ds_read_b64_tr_b16 a[10:11], v2 offset:4096
  v_mfma_f32_16x16x32_bf16 v[52:55], a[56:59], a[252:255], v[52:55]
  ds_read_b64_tr_b16 a[24:25], v2 offset:8192
  buffer_load_dwordx4 a[184:187], v8, s[4:7], s48 offen offset:3072 sc1
  v_mfma_f32_16x16x32_bf16 v[52:55], a[40:43], a[244:247], v[52:55]
  ds_read_b64_tr_b16 a[26:27], v2 offset:12288
  v_mfma_f32_16x16x32_bf16 v[60:63], a[44:47], a[244:247], v[60:63]
  ds_read_b64_tr_b16 a[12:13], v3 offset:0
  v_mfma_f32_16x16x32_bf16 v[60:63], a[60:63], a[252:255], v[60:63]
  ds_read_b64_tr_b16 a[14:15], v3 offset:4096
  v_mfma_f32_16x16x32_bf16 v[56:59], a[60:63], a[248:251], v[56:59]
  ds_read_b64_tr_b16 a[28:29], v3 offset:8192
  buffer_load_dwordx4 a[188:191], v9, s[4:7], s48 offen offset:3072 sc1
  v_mfma_f32_16x16x32_bf16 v[56:59], a[44:47], a[240:243], v[56:59]
  ds_read_b64_tr_b16 a[30:31], v3 offset:12288
  s_waitcnt vmcnt(16) lgkmcnt(8)
  v_mfma_f32_16x16x32_bf16 v[32:35], a[0:3], a[128:131], v[32:35]
  s_waitcnt vmcnt(18)
  s_barrier
  ds_read_b64_tr_b16 a[32:33], v0 offset:16384
  v_mfma_f32_16x16x32_bf16 v[32:35], a[16:19], a[136:139], v[32:35]
  ds_read_b64_tr_b16 a[34:35], v0 offset:20480
  v_mfma_f32_16x16x32_bf16 v[36:39], a[16:19], a[140:143], v[36:39]
  ds_read_b64_tr_b16 a[48:49], v0 offset:24576
  v_mfma_f32_16x16x32_bf16 v[36:39], a[0:3], a[132:135], v[36:39]
  ds_read_b64_tr_b16 a[50:51], v0 offset:28672
  v_mfma_f32_16x16x32_bf16 v[44:47], a[4:7], a[132:135], v[44:47]
  ds_read_b64_tr_b16 a[36:37], v1 offset:16384
  v_mfma_f32_16x16x32_bf16 v[44:47], a[20:23], a[140:143], v[44:47]
  ds_read_b64_tr_b16 a[38:39], v1 offset:20480
  v_mfma_f32_16x16x32_bf16 v[40:43], a[20:23], a[136:139], v[40:43]
  ds_read_b64_tr_b16 a[52:53], v1 offset:24576
  v_mfma_f32_16x16x32_bf16 v[40:43], a[4:7], a[128:131], v[40:43]
  ds_read_b64_tr_b16 a[54:55], v1 offset:28672
  s_waitcnt lgkmcnt(8)
  v_mfma_f32_16x16x32_bf16 v[48:51], a[8:11], a[128:131], v[48:51]
  ds_read_b64_tr_b16 a[40:41], v2 offset:16384
  v_mfma_f32_16x16x32_bf16 v[48:51], a[24:27], a[136:139], v[48:51]
  ds_read_b64_tr_b16 a[42:43], v2 offset:20480
  v_mfma_f32_16x16x32_bf16 v[52:55], a[24:27], a[140:143], v[52:55]
  ds_read_b64_tr_b16 a[56:57], v2 offset:24576
  v_mfma_f32_16x16x32_bf16 v[52:55], a[8:11], a[132:135], v[52:55]
  ds_read_b64_tr_b16 a[58:59], v2 offset:28672
  v_mfma_f32_16x16x32_bf16 v[60:63], a[12:15], a[132:135], v[60:63]
  ds_read_b64_tr_b16 a[44:45], v3 offset:16384
  v_mfma_f32_16x16x32_bf16 v[60:63], a[28:31], a[140:143], v[60:63]
  ds_read_b64_tr_b16 a[46:47], v3 offset:20480
  v_mfma_f32_16x16x32_bf16 v[56:59], a[28:31], a[136:139], v[56:59]
  ds_read_b64_tr_b16 a[60:61], v3 offset:24576
  v_mfma_f32_16x16x32_bf16 v[56:59], a[12:15], a[128:131], v[56:59]
  ds_read_b64_tr_b16 a[62:63], v3 offset:28672
  s_waitcnt vmcnt(8) lgkmcnt(8)
  v_mfma_f32_16x16x32_bf16 v[32:35], a[32:35], a[144:147], v[32:35]
  ds_read_b64_tr_b16 a[0:1], v0 offset:32768
  v_mfma_f32_16x16x32_bf16 v[32:35], a[48:51], a[152:155], v[32:35]
  ds_read_b64_tr_b16 a[2:3], v0 offset:36864
  v_mfma_f32_16x16x32_bf16 v[36:39], a[48:51], a[156:159], v[36:39]
  ds_read_b64_tr_b16 a[16:17], v0 offset:40960
  v_mfma_f32_16x16x32_bf16 v[36:39], a[32:35], a[148:151], v[36:39]
  ds_read_b64_tr_b16 a[18:19], v0 offset:45056
  v_mfma_f32_16x16x32_bf16 v[44:47], a[36:39], a[148:151], v[44:47]
  ds_read_b64_tr_b16 a[4:5], v1 offset:32768
  v_mfma_f32_16x16x32_bf16 v[44:47], a[52:55], a[156:159], v[44:47]
  ds_read_b64_tr_b16 a[6:7], v1 offset:36864
  v_mfma_f32_16x16x32_bf16 v[40:43], a[52:55], a[152:155], v[40:43]
  ds_read_b64_tr_b16 a[20:21], v1 offset:40960
  v_mfma_f32_16x16x32_bf16 v[40:43], a[36:39], a[144:147], v[40:43]
  ds_read_b64_tr_b16 a[22:23], v1 offset:45056
  s_waitcnt lgkmcnt(8)
  v_mfma_f32_16x16x32_bf16 v[48:51], a[40:43], a[144:147], v[48:51]
  ds_read_b64_tr_b16 a[8:9], v2 offset:32768
  v_mfma_f32_16x16x32_bf16 v[48:51], a[56:59], a[152:155], v[48:51]
  ds_read_b64_tr_b16 a[10:11], v2 offset:36864
  v_mfma_f32_16x16x32_bf16 v[52:55], a[56:59], a[156:159], v[52:55]
  ds_read_b64_tr_b16 a[24:25], v2 offset:40960
  v_mfma_f32_16x16x32_bf16 v[52:55], a[40:43], a[148:151], v[52:55]
  ds_read_b64_tr_b16 a[26:27], v2 offset:45056
  v_mfma_f32_16x16x32_bf16 v[60:63], a[44:47], a[148:151], v[60:63]
  ds_read_b64_tr_b16 a[12:13], v3 offset:32768
  v_mfma_f32_16x16x32_bf16 v[60:63], a[60:63], a[156:159], v[60:63]
  ds_read_b64_tr_b16 a[14:15], v3 offset:36864
  v_mfma_f32_16x16x32_bf16 v[56:59], a[60:63], a[152:155], v[56:59]
  ds_read_b64_tr_b16 a[28:29], v3 offset:40960
  v_mfma_f32_16x16x32_bf16 v[56:59], a[44:47], a[144:147], v[56:59]
  ds_read_b64_tr_b16 a[30:31], v3 offset:45056
  s_waitcnt vmcnt(4) lgkmcnt(8)
  v_mfma_f32_16x16x32_bf16 v[32:35], a[0:3], a[160:163], v[32:35]
  s_waitcnt vmcnt(10)
  s_barrier
  ds_read_b64_tr_b16 a[32:33], v0 offset:49152
  v_mfma_f32_16x16x32_bf16 v[32:35], a[16:19], a[168:171], v[32:35]
  ds_read_b64_tr_b16 a[34:35], v0 offset:53248
  v_mfma_f32_16x16x32_bf16 v[36:39], a[16:19], a[172:175], v[36:39]
  ds_read_b64_tr_b16 a[48:49], v0 offset:57344
  v_mfma_f32_16x16x32_bf16 v[36:39], a[0:3], a[164:167], v[36:39]
  ds_read_b64_tr_b16 a[50:51], v0 offset:61440
  v_mfma_f32_16x16x32_bf16 v[44:47], a[4:7], a[164:167], v[44:47]
  ds_read_b64_tr_b16 a[36:37], v1 offset:49152
  v_mfma_f32_16x16x32_bf16 v[44:47], a[20:23], a[172:175], v[44:47]
  ds_read_b64_tr_b16 a[38:39], v1 offset:53248
  v_mfma_f32_16x16x32_bf16 v[40:43], a[20:23], a[168:171], v[40:43]
  ds_read_b64_tr_b16 a[52:53], v1 offset:57344
  v_mfma_f32_16x16x32_bf16 v[40:43], a[4:7], a[160:163], v[40:43]
  ds_read_b64_tr_b16 a[54:55], v1 offset:61440
  s_waitcnt lgkmcnt(8)
  v_mfma_f32_16x16x32_bf16 v[48:51], a[8:11], a[160:163], v[48:51]
  ds_read_b64_tr_b16 a[40:41], v2 offset:49152
  v_mfma_f32_16x16x32_bf16 v[48:51], a[24:27], a[168:171], v[48:51]
  ds_read_b64_tr_b16 a[42:43], v2 offset:53248
  v_mfma_f32_16x16x32_bf16 v[52:55], a[24:27], a[172:175], v[52:55]
  ds_read_b64_tr_b16 a[56:57], v2 offset:57344
  v_mfma_f32_16x16x32_bf16 v[52:55], a[8:11], a[164:167], v[52:55]
  ds_read_b64_tr_b16 a[58:59], v2 offset:61440
  v_mfma_f32_16x16x32_bf16 v[60:63], a[12:15], a[164:167], v[60:63]
  ds_read_b64_tr_b16 a[44:45], v3 offset:49152
  v_mfma_f32_16x16x32_bf16 v[60:63], a[28:31], a[172:175], v[60:63]
  ds_read_b64_tr_b16 a[46:47], v3 offset:53248
  v_mfma_f32_16x16x32_bf16 v[56:59], a[28:31], a[168:171], v[56:59]
  ds_read_b64_tr_b16 a[60:61], v3 offset:57344
  v_mfma_f32_16x16x32_bf16 v[56:59], a[12:15], a[160:163], v[56:59]
  ds_read_b64_tr_b16 a[62:63], v3 offset:61440
  s_waitcnt vmcnt(0) lgkmcnt(8)
  v_mfma_f32_16x16x32_bf16 v[32:35], a[32:35], a[176:179], v[32:35]
  ds_read_b64_tr_b16 a[0:1], v4 offset:1024
  v_mfma_f32_16x16x32_bf16 v[32:35], a[48:51], a[184:187], v[32:35]
  ds_read_b64_tr_b16 a[2:3], v4 offset:5120
  v_mfma_f32_16x16x32_bf16 v[36:39], a[48:51], a[188:191], v[36:39]
  ds_read_b64_tr_b16 a[16:17], v4 offset:9216
  v_mfma_f32_16x16x32_bf16 v[36:39], a[32:35], a[180:183], v[36:39]
  ds_read_b64_tr_b16 a[18:19], v4 offset:13312
  v_mfma_f32_16x16x32_bf16 v[44:47], a[36:39], a[180:183], v[44:47]
  ds_read_b64_tr_b16 a[4:5], v5 offset:1024
  v_mfma_f32_16x16x32_bf16 v[44:47], a[52:55], a[188:191], v[44:47]
  ds_read_b64_tr_b16 a[6:7], v5 offset:5120
  v_mfma_f32_16x16x32_bf16 v[40:43], a[52:55], a[184:187], v[40:43]
  ds_read_b64_tr_b16 a[20:21], v5 offset:9216
  v_mfma_f32_16x16x32_bf16 v[40:43], a[36:39], a[176:179], v[40:43]
  ds_read_b64_tr_b16 a[22:23], v5 offset:13312
  s_waitcnt lgkmcnt(8)
  v_mfma_f32_16x16x32_bf16 v[48:51], a[40:43], a[176:179], v[48:51]
  ds_read_b64_tr_b16 a[8:9], v6 offset:1024
  v_mfma_f32_16x16x32_bf16 v[48:51], a[56:59], a[184:187], v[48:51]
  ds_read_b64_tr_b16 a[10:11], v6 offset:5120
  v_mfma_f32_16x16x32_bf16 v[52:55], a[56:59], a[188:191], v[52:55]
  ds_read_b64_tr_b16 a[24:25], v6 offset:9216
  v_mfma_f32_16x16x32_bf16 v[52:55], a[40:43], a[180:183], v[52:55]
  ds_read_b64_tr_b16 a[26:27], v6 offset:13312
  v_mfma_f32_16x16x32_bf16 v[60:63], a[44:47], a[180:183], v[60:63]
  ds_read_b64_tr_b16 a[12:13], v7 offset:1024
  v_mfma_f32_16x16x32_bf16 v[60:63], a[60:63], a[188:191], v[60:63]
  ds_read_b64_tr_b16 a[14:15], v7 offset:5120
  v_mfma_f32_16x16x32_bf16 v[56:59], a[60:63], a[184:187], v[56:59]
  ds_read_b64_tr_b16 a[28:29], v7 offset:9216
  v_mfma_f32_16x16x32_bf16 v[56:59], a[44:47], a[176:179], v[56:59]
  ds_read_b64_tr_b16 a[30:31], v7 offset:13312
  s_waitcnt lgkmcnt(8)
  v_mfma_f32_16x16x32_bf16 v[64:67], a[0:3], a[192:195], v[64:67]
  s_lshl_b32 s45, s2, 2
  ds_read_b64_tr_b16 a[32:33], v4 offset:17408
  s_add_u32 s45, s45, s40
  v_mfma_f32_16x16x32_bf16 v[64:67], a[16:19], a[200:203], v[64:67]
  s_lshl_b32 s45, s45, 12
  ds_read_b64_tr_b16 a[34:35], v4 offset:21504
  s_xor_b32 s44, s45, 32768
  v_mfma_f32_16x16x32_bf16 v[68:71], a[16:19], a[204:207], v[68:71]
  s_add_u32 s43, s42, 28311552
  ds_read_b64_tr_b16 a[48:49], v4 offset:25600
  s_add_u32 s44, s44, s43
  v_mfma_f32_16x16x32_bf16 v[68:71], a[0:3], a[196:199], v[68:71]
  s_add_u32 s45, s45, s43
  ds_read_b64_tr_b16 a[50:51], v4 offset:29696
  v_cvt_pk_bf16_f32 v16, v32, v33
  v_mfma_f32_16x16x32_bf16 v[76:79], a[4:7], a[196:199], v[76:79]
  ds_read_b64_tr_b16 a[36:37], v5 offset:17408
  v_cvt_pk_bf16_f32 v17, v34, v35
  v_cvt_pk_bf16_f32 v18, v40, v41
  v_mfma_f32_16x16x32_bf16 v[76:79], a[20:23], a[204:207], v[76:79]
  ds_read_b64_tr_b16 a[38:39], v5 offset:21504
  v_cvt_pk_bf16_f32 v19, v42, v43
  buffer_store_dwordx4 v[16:19], v8, s[4:7], s44 offen offset:0 sc1
  v_mfma_f32_16x16x32_bf16 v[72:75], a[20:23], a[200:203], v[72:75]
  ds_read_b64_tr_b16 a[52:53], v5 offset:25600
  v_cvt_pk_bf16_f32 v24, v36, v37
  v_cvt_pk_bf16_f32 v25, v38, v39
  v_mfma_f32_16x16x32_bf16 v[72:75], a[4:7], a[192:195], v[72:75]
  s_waitcnt lgkmcnt(7)
  ds_read_b64_tr_b16 a[54:55], v5 offset:29696
  v_cvt_pk_bf16_f32 v26, v44, v45
  v_cvt_pk_bf16_f32 v27, v46, v47
  v_mfma_f32_16x16x32_bf16 v[80:83], a[8:11], a[192:195], v[80:83]
  ds_read_b64_tr_b16 a[40:41], v6 offset:17408
  buffer_store_dwordx4 v[24:27], v8, s[4:7], s44 offen offset:2048 sc1
  v_cvt_pk_bf16_f32 v20, v48, v49
  v_mfma_f32_16x16x32_bf16 v[80:83], a[24:27], a[200:203], v[80:83]
  ds_read_b64_tr_b16 a[42:43], v6 offset:21504
  v_cvt_pk_bf16_f32 v21, v50, v51
  v_cvt_pk_bf16_f32 v22, v56, v57
  v_mfma_f32_16x16x32_bf16 v[84:87], a[24:27], a[204:207], v[84:87]
  ds_read_b64_tr_b16 a[56:57], v6 offset:25600
  v_cvt_pk_bf16_f32 v23, v58, v59
  buffer_store_dwordx4 v[20:23], v8, s[4:7], s44 offen offset:1024 sc1
  v_mfma_f32_16x16x32_bf16 v[84:87], a[8:11], a[196:199], v[84:87]
  ds_read_b64_tr_b16 a[58:59], v6 offset:29696
  v_cvt_pk_bf16_f32 v28, v52, v53
  v_cvt_pk_bf16_f32 v29, v54, v55
  v_mfma_f32_16x16x32_bf16 v[92:95], a[12:15], a[196:199], v[92:95]
  ds_read_b64_tr_b16 a[44:45], v7 offset:17408
  v_cvt_pk_bf16_f32 v30, v60, v61
  v_cvt_pk_bf16_f32 v31, v62, v63
  v_mfma_f32_16x16x32_bf16 v[92:95], a[28:31], a[204:207], v[92:95]
  ds_read_b64_tr_b16 a[46:47], v7 offset:21504
  buffer_store_dwordx4 v[28:31], v8, s[4:7], s44 offen offset:3072 sc1
  v_mfma_f32_16x16x32_bf16 v[88:91], a[28:31], a[200:203], v[88:91]
  ds_read_b64_tr_b16 a[60:61], v7 offset:25600
  v_mfma_f32_16x16x32_bf16 v[88:91], a[12:15], a[192:195], v[88:91]
  ds_read_b64_tr_b16 a[62:63], v7 offset:29696
  s_waitcnt lgkmcnt(8)
  v_mfma_f32_16x16x32_bf16 v[64:67], a[32:35], a[208:211], v[64:67]
  ds_read_b64_tr_b16 a[0:1], v4 offset:33792
  v_mfma_f32_16x16x32_bf16 v[64:67], a[48:51], a[216:219], v[64:67]
  ds_read_b64_tr_b16 a[2:3], v4 offset:37888
  v_mfma_f32_16x16x32_bf16 v[68:71], a[48:51], a[220:223], v[68:71]
  ds_read_b64_tr_b16 a[16:17], v4 offset:41984
  v_mfma_f32_16x16x32_bf16 v[68:71], a[32:35], a[212:215], v[68:71]
  ds_read_b64_tr_b16 a[18:19], v4 offset:46080
  v_mfma_f32_16x16x32_bf16 v[76:79], a[36:39], a[212:215], v[76:79]
  ds_read_b64_tr_b16 a[4:5], v5 offset:33792
  v_mfma_f32_16x16x32_bf16 v[76:79], a[52:55], a[220:223], v[76:79]
  ds_read_b64_tr_b16 a[6:7], v5 offset:37888
  v_mfma_f32_16x16x32_bf16 v[72:75], a[52:55], a[216:219], v[72:75]
  ds_read_b64_tr_b16 a[20:21], v5 offset:41984
  v_mfma_f32_16x16x32_bf16 v[72:75], a[36:39], a[208:211], v[72:75]
  ds_read_b64_tr_b16 a[22:23], v5 offset:46080
  s_waitcnt lgkmcnt(8)
  v_mfma_f32_16x16x32_bf16 v[80:83], a[40:43], a[208:211], v[80:83]
  ds_read_b64_tr_b16 a[8:9], v6 offset:33792
  v_mfma_f32_16x16x32_bf16 v[80:83], a[56:59], a[216:219], v[80:83]
  ds_read_b64_tr_b16 a[10:11], v6 offset:37888
  v_mfma_f32_16x16x32_bf16 v[84:87], a[56:59], a[220:223], v[84:87]
  ds_read_b64_tr_b16 a[24:25], v6 offset:41984
  v_mfma_f32_16x16x32_bf16 v[84:87], a[40:43], a[212:215], v[84:87]
  ds_read_b64_tr_b16 a[26:27], v6 offset:46080
  v_mfma_f32_16x16x32_bf16 v[92:95], a[44:47], a[212:215], v[92:95]
  ds_read_b64_tr_b16 a[12:13], v7 offset:33792
  v_mfma_f32_16x16x32_bf16 v[92:95], a[60:63], a[220:223], v[92:95]
  ds_read_b64_tr_b16 a[14:15], v7 offset:37888
  v_mfma_f32_16x16x32_bf16 v[88:91], a[60:63], a[216:219], v[88:91]
  ds_read_b64_tr_b16 a[28:29], v7 offset:41984
  v_mfma_f32_16x16x32_bf16 v[88:91], a[44:47], a[208:211], v[88:91]
  ds_read_b64_tr_b16 a[30:31], v7 offset:46080
  s_waitcnt lgkmcnt(8)
  v_mfma_f32_16x16x32_bf16 v[64:67], a[0:3], a[224:227], v[64:67]
  ds_read_b64_tr_b16 a[32:33], v4 offset:50176
  v_mfma_f32_16x16x32_bf16 v[64:67], a[16:19], a[232:235], v[64:67]
  ds_read_b64_tr_b16 a[34:35], v4 offset:54272
  v_mfma_f32_16x16x32_bf16 v[68:71], a[16:19], a[236:239], v[68:71]
  ds_read_b64_tr_b16 a[48:49], v4 offset:58368
  v_mfma_f32_16x16x32_bf16 v[68:71], a[0:3], a[228:231], v[68:71]
  ds_read_b64_tr_b16 a[50:51], v4 offset:62464
  v_mfma_f32_16x16x32_bf16 v[76:79], a[4:7], a[228:231], v[76:79]
  ds_read_b64_tr_b16 a[36:37], v5 offset:50176
  v_mfma_f32_16x16x32_bf16 v[76:79], a[20:23], a[236:239], v[76:79]
  ds_read_b64_tr_b16 a[38:39], v5 offset:54272
  v_mfma_f32_16x16x32_bf16 v[72:75], a[20:23], a[232:235], v[72:75]
  ds_read_b64_tr_b16 a[52:53], v5 offset:58368
  v_mfma_f32_16x16x32_bf16 v[72:75], a[4:7], a[224:227], v[72:75]
  ds_read_b64_tr_b16 a[54:55], v5 offset:62464
  s_waitcnt lgkmcnt(8)
  v_mfma_f32_16x16x32_bf16 v[80:83], a[8:11], a[224:227], v[80:83]
  ds_read_b64_tr_b16 a[40:41], v6 offset:50176
  v_mfma_f32_16x16x32_bf16 v[80:83], a[24:27], a[232:235], v[80:83]
  ds_read_b64_tr_b16 a[42:43], v6 offset:54272
  v_mfma_f32_16x16x32_bf16 v[84:87], a[24:27], a[236:239], v[84:87]
  ds_read_b64_tr_b16 a[56:57], v6 offset:58368
  v_mfma_f32_16x16x32_bf16 v[84:87], a[8:11], a[228:231], v[84:87]
  ds_read_b64_tr_b16 a[58:59], v6 offset:62464
  v_mfma_f32_16x16x32_bf16 v[92:95], a[12:15], a[228:231], v[92:95]
  ds_read_b64_tr_b16 a[44:45], v7 offset:50176
  v_mfma_f32_16x16x32_bf16 v[92:95], a[28:31], a[236:239], v[92:95]
  ds_read_b64_tr_b16 a[46:47], v7 offset:54272
  v_mfma_f32_16x16x32_bf16 v[88:91], a[28:31], a[232:235], v[88:91]
  ds_read_b64_tr_b16 a[60:61], v7 offset:58368
  v_mfma_f32_16x16x32_bf16 v[88:91], a[12:15], a[224:227], v[88:91]
  ds_read_b64_tr_b16 a[62:63], v7 offset:62464
  s_waitcnt lgkmcnt(8)
  v_mfma_f32_16x16x32_bf16 v[64:67], a[32:35], a[240:243], v[64:67]
  ds_read_b64_tr_b16 a[0:1], v0 offset:1024
  v_mfma_f32_16x16x32_bf16 v[64:67], a[48:51], a[248:251], v[64:67]
  ds_read_b64_tr_b16 a[2:3], v0 offset:5120
  v_mfma_f32_16x16x32_bf16 v[68:71], a[48:51], a[252:255], v[68:71]
  ds_read_b64_tr_b16 a[16:17], v0 offset:9216
  v_mfma_f32_16x16x32_bf16 v[68:71], a[32:35], a[244:247], v[68:71]
  ds_read_b64_tr_b16 a[18:19], v0 offset:13312
  v_mfma_f32_16x16x32_bf16 v[76:79], a[36:39], a[244:247], v[76:79]
  ds_read_b64_tr_b16 a[4:5], v1 offset:1024
  v_mfma_f32_16x16x32_bf16 v[76:79], a[52:55], a[252:255], v[76:79]
  ds_read_b64_tr_b16 a[6:7], v1 offset:5120
  v_mfma_f32_16x16x32_bf16 v[72:75], a[52:55], a[248:251], v[72:75]
  ds_read_b64_tr_b16 a[20:21], v1 offset:9216
  v_mfma_f32_16x16x32_bf16 v[72:75], a[36:39], a[240:243], v[72:75]
  ds_read_b64_tr_b16 a[22:23], v1 offset:13312
  s_waitcnt lgkmcnt(8)
  v_mfma_f32_16x16x32_bf16 v[80:83], a[40:43], a[240:243], v[80:83]
  ds_read_b64_tr_b16 a[8:9], v2 offset:1024
  v_mfma_f32_16x16x32_bf16 v[80:83], a[56:59], a[248:251], v[80:83]
  ds_read_b64_tr_b16 a[10:11], v2 offset:5120
  v_mfma_f32_16x16x32_bf16 v[84:87], a[56:59], a[252:255], v[84:87]
  ds_read_b64_tr_b16 a[24:25], v2 offset:9216
  v_mfma_f32_16x16x32_bf16 v[84:87], a[40:43], a[244:247], v[84:87]
  ds_read_b64_tr_b16 a[26:27], v2 offset:13312
  v_mfma_f32_16x16x32_bf16 v[92:95], a[44:47], a[244:247], v[92:95]
  ds_read_b64_tr_b16 a[12:13], v3 offset:1024
  v_mfma_f32_16x16x32_bf16 v[92:95], a[60:63], a[252:255], v[92:95]
  ds_read_b64_tr_b16 a[14:15], v3 offset:5120
  v_mfma_f32_16x16x32_bf16 v[88:91], a[60:63], a[248:251], v[88:91]
  ds_read_b64_tr_b16 a[28:29], v3 offset:9216
  v_mfma_f32_16x16x32_bf16 v[88:91], a[44:47], a[240:243], v[88:91]
  ds_read_b64_tr_b16 a[30:31], v3 offset:13312
  s_waitcnt lgkmcnt(8)
  v_mfma_f32_16x16x32_bf16 v[64:67], a[0:3], a[128:131], v[64:67]
  ds_read_b64_tr_b16 a[32:33], v0 offset:17408
  v_mfma_f32_16x16x32_bf16 v[64:67], a[16:19], a[136:139], v[64:67]
  ds_read_b64_tr_b16 a[34:35], v0 offset:21504
  v_mfma_f32_16x16x32_bf16 v[68:71], a[16:19], a[140:143], v[68:71]
  ds_read_b64_tr_b16 a[48:49], v0 offset:25600
  v_mfma_f32_16x16x32_bf16 v[68:71], a[0:3], a[132:135], v[68:71]
  ds_read_b64_tr_b16 a[50:51], v0 offset:29696
  v_mfma_f32_16x16x32_bf16 v[76:79], a[4:7], a[132:135], v[76:79]
  ds_read_b64_tr_b16 a[36:37], v1 offset:17408
  v_mfma_f32_16x16x32_bf16 v[76:79], a[20:23], a[140:143], v[76:79]
  ds_read_b64_tr_b16 a[38:39], v1 offset:21504
  v_mfma_f32_16x16x32_bf16 v[72:75], a[20:23], a[136:139], v[72:75]
  ds_read_b64_tr_b16 a[52:53], v1 offset:25600
  v_mfma_f32_16x16x32_bf16 v[72:75], a[4:7], a[128:131], v[72:75]
  ds_read_b64_tr_b16 a[54:55], v1 offset:29696
  s_waitcnt lgkmcnt(8)
  v_mfma_f32_16x16x32_bf16 v[80:83], a[8:11], a[128:131], v[80:83]
  ds_read_b64_tr_b16 a[40:41], v2 offset:17408
  v_mfma_f32_16x16x32_bf16 v[80:83], a[24:27], a[136:139], v[80:83]
  ds_read_b64_tr_b16 a[42:43], v2 offset:21504
  v_mfma_f32_16x16x32_bf16 v[84:87], a[24:27], a[140:143], v[84:87]
  ds_read_b64_tr_b16 a[56:57], v2 offset:25600
  v_mfma_f32_16x16x32_bf16 v[84:87], a[8:11], a[132:135], v[84:87]
  ds_read_b64_tr_b16 a[58:59], v2 offset:29696
  v_mfma_f32_16x16x32_bf16 v[92:95], a[12:15], a[132:135], v[92:95]
  ds_read_b64_tr_b16 a[44:45], v3 offset:17408
  v_mfma_f32_16x16x32_bf16 v[92:95], a[28:31], a[140:143], v[92:95]
  ds_read_b64_tr_b16 a[46:47], v3 offset:21504
  v_mfma_f32_16x16x32_bf16 v[88:91], a[28:31], a[136:139], v[88:91]
  ds_read_b64_tr_b16 a[60:61], v3 offset:25600
  v_mfma_f32_16x16x32_bf16 v[88:91], a[12:15], a[128:131], v[88:91]
  ds_read_b64_tr_b16 a[62:63], v3 offset:29696
  s_waitcnt lgkmcnt(8)
  v_mfma_f32_16x16x32_bf16 v[64:67], a[32:35], a[144:147], v[64:67]
  ds_read_b64_tr_b16 a[0:1], v0 offset:33792
  buffer_load_dwordx4 v[96:99], v8, s[4:7], s45 offen offset:0 sc1
  v_mfma_f32_16x16x32_bf16 v[64:67], a[48:51], a[152:155], v[64:67]
  ds_read_b64_tr_b16 a[2:3], v0 offset:37888
  v_mfma_f32_16x16x32_bf16 v[68:71], a[48:51], a[156:159], v[68:71]
  ds_read_b64_tr_b16 a[16:17], v0 offset:41984
  buffer_load_dwordx4 v[100:103], v8, s[4:7], s45 offen offset:1024 sc1
  v_mfma_f32_16x16x32_bf16 v[68:71], a[32:35], a[148:151], v[68:71]
  ds_read_b64_tr_b16 a[18:19], v0 offset:46080
  v_mfma_f32_16x16x32_bf16 v[76:79], a[36:39], a[148:151], v[76:79]
  ds_read_b64_tr_b16 a[4:5], v1 offset:33792
  buffer_load_dwordx4 v[104:107], v8, s[4:7], s45 offen offset:2048 sc1
  v_mfma_f32_16x16x32_bf16 v[76:79], a[52:55], a[156:159], v[76:79]
  ds_read_b64_tr_b16 a[6:7], v1 offset:37888
  v_mfma_f32_16x16x32_bf16 v[72:75], a[52:55], a[152:155], v[72:75]
  ds_read_b64_tr_b16 a[20:21], v1 offset:41984
  buffer_load_dwordx4 v[108:111], v8, s[4:7], s45 offen offset:3072 sc1
  v_mfma_f32_16x16x32_bf16 v[72:75], a[36:39], a[144:147], v[72:75]
  ds_read_b64_tr_b16 a[22:23], v1 offset:46080
  s_waitcnt lgkmcnt(8)
  v_mfma_f32_16x16x32_bf16 v[80:83], a[40:43], a[144:147], v[80:83]
  ds_read_b64_tr_b16 a[8:9], v2 offset:33792
  v_mfma_f32_16x16x32_bf16 v[80:83], a[56:59], a[152:155], v[80:83]
  ds_read_b64_tr_b16 a[10:11], v2 offset:37888
  v_mfma_f32_16x16x32_bf16 v[84:87], a[56:59], a[156:159], v[84:87]
  ds_read_b64_tr_b16 a[24:25], v2 offset:41984
  v_mfma_f32_16x16x32_bf16 v[84:87], a[40:43], a[148:151], v[84:87]
  ds_read_b64_tr_b16 a[26:27], v2 offset:46080
  v_mfma_f32_16x16x32_bf16 v[92:95], a[44:47], a[148:151], v[92:95]
  ds_read_b64_tr_b16 a[12:13], v3 offset:33792
  v_mfma_f32_16x16x32_bf16 v[92:95], a[60:63], a[156:159], v[92:95]
  ds_read_b64_tr_b16 a[14:15], v3 offset:37888
  v_mfma_f32_16x16x32_bf16 v[88:91], a[60:63], a[152:155], v[88:91]
  ds_read_b64_tr_b16 a[28:29], v3 offset:41984
  v_mfma_f32_16x16x32_bf16 v[88:91], a[44:47], a[144:147], v[88:91]
  ds_read_b64_tr_b16 a[30:31], v3 offset:46080
  s_waitcnt lgkmcnt(8)
  v_mfma_f32_16x16x32_bf16 v[64:67], a[0:3], a[160:163], v[64:67]
  ds_read_b64_tr_b16 a[32:33], v0 offset:50176
  v_mfma_f32_16x16x32_bf16 v[64:67], a[16:19], a[168:171], v[64:67]
  ds_read_b64_tr_b16 a[34:35], v0 offset:54272
  v_mfma_f32_16x16x32_bf16 v[68:71], a[16:19], a[172:175], v[68:71]
  ds_read_b64_tr_b16 a[48:49], v0 offset:58368
  v_mfma_f32_16x16x32_bf16 v[68:71], a[0:3], a[164:167], v[68:71]
  ds_read_b64_tr_b16 a[50:51], v0 offset:62464
  v_mfma_f32_16x16x32_bf16 v[76:79], a[4:7], a[164:167], v[76:79]
  ds_read_b64_tr_b16 a[36:37], v1 offset:50176
  v_mfma_f32_16x16x32_bf16 v[76:79], a[20:23], a[172:175], v[76:79]
  ds_read_b64_tr_b16 a[38:39], v1 offset:54272
  v_mfma_f32_16x16x32_bf16 v[72:75], a[20:23], a[168:171], v[72:75]
  ds_read_b64_tr_b16 a[52:53], v1 offset:58368
  v_mfma_f32_16x16x32_bf16 v[72:75], a[4:7], a[160:163], v[72:75]
  ds_read_b64_tr_b16 a[54:55], v1 offset:62464
  s_waitcnt lgkmcnt(8)
  v_mfma_f32_16x16x32_bf16 v[80:83], a[8:11], a[160:163], v[80:83]
  ds_read_b64_tr_b16 a[40:41], v2 offset:50176
  v_mfma_f32_16x16x32_bf16 v[80:83], a[24:27], a[168:171], v[80:83]
  ds_read_b64_tr_b16 a[42:43], v2 offset:54272
  v_mfma_f32_16x16x32_bf16 v[84:87], a[24:27], a[172:175], v[84:87]
  ds_read_b64_tr_b16 a[56:57], v2 offset:58368
  v_mfma_f32_16x16x32_bf16 v[84:87], a[8:11], a[164:167], v[84:87]
  ds_read_b64_tr_b16 a[58:59], v2 offset:62464
  v_mfma_f32_16x16x32_bf16 v[92:95], a[12:15], a[164:167], v[92:95]
  ds_read_b64_tr_b16 a[44:45], v3 offset:50176
  v_mfma_f32_16x16x32_bf16 v[92:95], a[28:31], a[172:175], v[92:95]
  ds_read_b64_tr_b16 a[46:47], v3 offset:54272
  v_mfma_f32_16x16x32_bf16 v[88:91], a[28:31], a[168:171], v[88:91]
  ds_read_b64_tr_b16 a[60:61], v3 offset:58368
  v_mfma_f32_16x16x32_bf16 v[88:91], a[12:15], a[160:163], v[88:91]
  ds_read_b64_tr_b16 a[62:63], v3 offset:62464
  s_waitcnt lgkmcnt(8)
  v_mfma_f32_16x16x32_bf16 v[64:67], a[32:35], a[176:179], v[64:67]
  v_mfma_f32_16x16x32_bf16 v[64:67], a[48:51], a[184:187], v[64:67]
  v_mfma_f32_16x16x32_bf16 v[68:71], a[48:51], a[188:191], v[68:71]
  v_mfma_f32_16x16x32_bf16 v[68:71], a[32:35], a[180:183], v[68:71]
  v_mfma_f32_16x16x32_bf16 v[76:79], a[36:39], a[180:183], v[76:79]
  v_mfma_f32_16x16x32_bf16 v[76:79], a[52:55], a[188:191], v[76:79]
  v_mfma_f32_16x16x32_bf16 v[72:75], a[52:55], a[184:187], v[72:75]
  v_mfma_f32_16x16x32_bf16 v[72:75], a[36:39], a[176:179], v[72:75]
  s_waitcnt lgkmcnt(0)
  v_mfma_f32_16x16x32_bf16 v[80:83], a[40:43], a[176:179], v[80:83]
  v_mfma_f32_16x16x32_bf16 v[80:83], a[56:59], a[184:187], v[80:83]
  s_barrier
  v_mfma_f32_16x16x32_bf16 v[84:87], a[56:59], a[188:191], v[84:87]
  v_mfma_f32_16x16x32_bf16 v[84:87], a[40:43], a[180:183], v[84:87]
  v_mfma_f32_16x16x32_bf16 v[92:95], a[44:47], a[180:183], v[92:95]
  v_mfma_f32_16x16x32_bf16 v[92:95], a[60:63], a[188:191], v[92:95]
  v_mfma_f32_16x16x32_bf16 v[88:91], a[60:63], a[184:187], v[88:91]
  v_mfma_f32_16x16x32_bf16 v[88:91], a[44:47], a[176:179], v[88:91]
  s_mov_b32 s43, 0x40000
Lp4_mb:
  s_waitcnt vmcnt(0)
  v_max3_u32 v112, v96, v97, v98
  v_max3_u32 v113, v99, v100, v101
  v_max3_u32 v112, v112, v102, v103
  v_max3_u32 v113, v113, v104, v105
  v_max3_u32 v112, v112, v106, v107
  v_max3_u32 v113, v113, v108, v109
  v_max3_u32 v112, v112, v110, v111
  v_max_u32 v112, v112, v113
  v_cmp_eq_u32 vcc, -1, v112
  s_cbranch_vccz Lp4_mbok
  buffer_load_dwordx4 v[96:99], v8, s[4:7], s45 offen offset:0 sc1
  buffer_load_dwordx4 v[100:103], v8, s[4:7], s45 offen offset:1024 sc1
  buffer_load_dwordx4 v[104:107], v8, s[4:7], s45 offen offset:2048 sc1
  buffer_load_dwordx4 v[108:111], v8, s[4:7], s45 offen offset:3072 sc1
  s_sub_u32 s43, s43, 1
  s_cmp_lg_u32 s43, 0
  s_cbranch_scc1 Lp4_mb
  s_waitcnt vmcnt(0)
Lp4_mbok:
  s_add_u32 s46, s76, 37748736
  s_add_u32 s47, s46, 32768
  s_lshl_b32 s48, s49, 11
  s_lshl_b32 s43, s53, 7
  s_add_u32 s48, s48, s43
  s_add_u32 s48, s48, 65011712
  s_cmp_lg_u32 s41, 0
  s_cbranch_scc1 Lfinal
  v_lshlrev_b32 v112, 16, v96
  v_and_b32 v113, 0xffff0000, v96
  v_lshlrev_b32 v114, 16, v97
  v_and_b32 v115, 0xffff0000, v97
  v_lshlrev_b32 v116, 16, v98
  v_and_b32 v117, 0xffff0000, v98
  v_lshlrev_b32 v118, 16, v99
  v_and_b32 v119, 0xffff0000, v99
  v_pk_add_f32 v[64:65], v[64:65], v[112:113]
  v_pk_add_f32 v[66:67], v[66:67], v[114:115]
  v_pk_add_f32 v[72:73], v[72:73], v[116:117]
  v_pk_add_f32 v[74:75], v[74:75], v[118:119]
  v_cvt_pk_bf16_f32 v16, v64, v65
  v_cvt_pk_bf16_f32 v17, v66, v67
  v_cvt_pk_bf16_f32 v18, v72, v73
  v_cvt_pk_bf16_f32 v19, v74, v75
  buffer_store_dwordx4 v[16:19], v8, s[4:7], s46 offen offset:0 sc1
  v_lshlrev_b32 v112, 16, v104
  v_and_b32 v113, 0xffff0000, v104
  v_lshlrev_b32 v114, 16, v105
  v_and_b32 v115, 0xffff0000, v105
  v_lshlrev_b32 v116, 16, v106
  v_and_b32 v117, 0xffff0000, v106
  v_lshlrev_b32 v118, 16, v107
  v_and_b32 v119, 0xffff0000, v107
  v_pk_add_f32 v[68:69], v[68:69], v[112:113]
  v_pk_add_f32 v[70:71], v[70:71], v[114:115]
  v_pk_add_f32 v[76:77], v[76:77], v[116:117]
  v_pk_add_f32 v[78:79], v[78:79], v[118:119]
  v_cvt_pk_bf16_f32 v24, v68, v69
  v_cvt_pk_bf16_f32 v25, v70, v71
  v_cvt_pk_bf16_f32 v26, v76, v77
  v_cvt_pk_bf16_f32 v27, v78, v79
  buffer_store_dwordx4 v[24:27], v8, s[4:7], s47 offen offset:0 sc1
  v_lshlrev_b32 v112, 16, v100
  v_and_b32 v113, 0xffff0000, v100
  v_lshlrev_b32 v114, 16, v101
  v_and_b32 v115, 0xffff0000, v101
  v_lshlrev_b32 v116, 16, v102
  v_and_b32 v117, 0xffff0000, v102
  v_lshlrev_b32 v118, 16, v103
  v_and_b32 v119, 0xffff0000, v103
  v_pk_add_f32 v[80:81], v[80:81], v[112:113]
  v_pk_add_f32 v[82:83], v[82:83], v[114:115]
  v_pk_add_f32 v[88:89], v[88:89], v[116:117]
  v_pk_add_f32 v[90:91], v[90:91], v[118:119]
  v_cvt_pk_bf16_f32 v20, v80, v81
  v_cvt_pk_bf16_f32 v21, v82, v83
  v_cvt_pk_bf16_f32 v22, v88, v89
  v_cvt_pk_bf16_f32 v23, v90, v91
  buffer_store_dwordx4 v[20:23], v8, s[4:7], s46 offen offset:1024 sc1
  v_lshlrev_b32 v112, 16, v108
  v_and_b32 v113, 0xffff0000, v108
  v_lshlrev_b32 v114, 16, v109
  v_and_b32 v115, 0xffff0000, v109
  v_lshlrev_b32 v116, 16, v110
  v_and_b32 v117, 0xffff0000, v110
  v_lshlrev_b32 v118, 16, v111
  v_and_b32 v119, 0xffff0000, v111
  v_pk_add_f32 v[84:85], v[84:85], v[112:113]
  v_pk_add_f32 v[86:87], v[86:87], v[114:115]
  v_pk_add_f32 v[92:93], v[92:93], v[116:117]
  v_pk_add_f32 v[94:95], v[94:95], v[118:119]
  v_cvt_pk_bf16_f32 v28, v84, v85
  v_cvt_pk_bf16_f32 v29, v86, v87
  v_cvt_pk_bf16_f32 v30, v92, v93
  v_cvt_pk_bf16_f32 v31, v94, v95
  buffer_store_dwordx4 v[28:31], v8, s[4:7], s47 offen offset:1024 sc1
  v_mov_b32 v128, 0x3f803f80
  v_mov_b32 v129, 0x3f803f80
  v_mov_b32 v130, 0x3f803f80
  v_mov_b32 v131, 0x3f803f80
  v_and_b32 v148, 15, v253
  v_lshrrev_b32 v149, 4, v253
  v_mfma_f32_16x16x32_bf16 v[132:135], v[128:131], v[16:19], 0
  v_mfma_f32_16x16x32_bf16 v[136:139], v[16:19], v[16:19], 0
  v_mfma_f32_16x16x32_bf16 v[140:143], v[128:131], v[24:27], 0
  v_mfma_f32_16x16x32_bf16 v[144:147], v[24:27], v[24:27], 0
  v_mfma_f32_16x16x32_bf16 v[132:135], v[128:131], v[20:23], v[132:135]
  v_mfma_f32_16x16x32_bf16 v[136:139], v[20:23], v[20:23], v[136:139]
  v_mfma_f32_16x16x32_bf16 v[140:143], v[128:131], v[28:31], v[140:143]
  v_mfma_f32_16x16x32_bf16 v[144:147], v[28:31], v[28:31], v[144:147]
  v_lshrrev_b32 v128, 2, v148
  v_cmp_eq_u32 s[64:65], v128, v149
  v_and_b32 v128, 3, v148
  v_cmp_eq_u32 s[66:67], 1, v128
  v_cmp_eq_u32 s[68:69], 2, v128
  v_cmp_eq_u32 s[70:71], 3, v128
  v_lshlrev_b32 v148, 3, v148
  v_mov_b32 v149, 0x7ffffff0
  s_nop 0
  v_cndmask_b32 v148, v149, v148, s[64:65]
  v_cndmask_b32 v133, v136, v137, s[66:67]
  v_cndmask_b32 v133, v133, v138, s[68:69]
  v_cndmask_b32 v133, v133, v139, s[70:71]
  buffer_store_dwordx2 v[132:133], v148, s[4:7], s48 offen offset:0 sc1
  v_cndmask_b32 v141, v144, v145, s[66:67]
  v_cndmask_b32 v141, v141, v146, s[68:69]
  v_cndmask_b32 v141, v141, v147, s[70:71]
  buffer_store_dwordx2 v[140:141], v148, s[4:7], s48 offen offset:2048 sc1
  s_lshl_b32 s77, s52, 7
  s_add_u32 s77, s77, 27792384
  s_mov_b32 s41, 1
  s_mov_b32 s42, 0x2400000
  s_mov_b32 s28, s4
  s_mov_b32 s29, s5
  s_mov_b32 s30, 0x10000000
  s_lshr_b32 s57, s40, 1
  s_and_b32 s58, s40, 1
  s_lshl_b32 s71, s50, 3
  s_mov_b32 s67, 0
  s_lshl_b32 s62, s40, 12
  s_mul_i32 s63, s40, 6144
  s_add_u32 s76, s63, 139264
  s_and_b32 s43, s50, 7
  s_cmp_lg_u32 s43, 0
  s_cselect_b32 s43, 1, 0
  s_sub_u32 s72, s71, s43
  v_lshrrev_b32 v2, 3, v253
  v_bfe_u32 v3, v253, 1, 2
  v_lshrrev_b32 v4, 4, v253
  v_xor_b32 v3, v3, v4
  v_and_b32 v5, 1, v253
  v_mov_b32 v6, v2
  s_lshl_b32 s43, s40, 4
  v_mul_u32_u24 v6, 6144, v6
  v_lshl_add_u32 v6, v3, 5, v6
  v_lshl_add_u32 v124, v5, 4, v6
  v_add_u32 v125, 48128, v124
  s_mul_i32 s43, s43, 6144
  s_lshl_b32 s60, s51, 7
  s_add_u32 s60, s60, s43
  v_and_b32 v3, 7, v253
  s_lshl_b32 s43, s40, 1
  s_add_u32 s43, s43, s71
  v_lshlrev_b32 v120, 4, v253
  v_mov_b32 v121, v120
  v_add_u32 v122, 30720, v120
  v_add_u32 v123, 30720, v120
  v_lshlrev_b32 v5, 8, v2
  v_lshl_add_u32 v5, v3, 4, v5
  v_add_u32 v126, 128, v5
  s_lshl_b32 s43, s43, 15
  s_mov_b32 s44, 37748736
  s_add_u32 s59, s43, s44
  s_lshl_b32 s43, s72, 15
  s_add_u32 s73, s43, s44
  s_movk_i32 s61, 2048
  v_and_b32 v2, 15, v253
  v_lshrrev_b32 v3, 4, v253
  v_and_b32 v4, 7, v253
  v_lshlrev_b32 v6, 4, v253
  v_add_u32 v7, 1024, v6
  v_lshlrev_b32 v5, 7, v3
  v_lshl_add_u32 v8, v4, 4, v5
  v_add_u32 v9, 512, v8
  s_lshl_b32 s43, s57, 13
  s_add_u32 s43, s43, 73728
  v_add_u32 v112, s43, v6
  v_add_u32 v113, s43, v7
  v_add_u32 v114, 122880, v8
  v_add_u32 v115, 122880, v9
  s_lshl_b32 s43, s52, 3
  s_lshl_b32 s44, s40, 1
  s_add_u32 s43, s43, s44
  v_mov_b32 v187, v6
  s_lshl_b32 s43, s43, 15
  s_lshl_b32 s44, s53, 11
  s_add_u32 s43, s43, s44
  s_add_u32 s64, s43, 37748736
  s_movk_i32 s65, 1024
  v_lshrrev_b32 v2, 2, v253
  v_bfe_u32 v3, v253, 3, 2
  v_and_b32 v4, 3, v253
  v_lshlrev_b32 v4, 3, v4
  v_lshl_add_u32 v4, v2, 7, v4
  s_lshl_b32 s43, s58, 1
  s_or_b32 s43, s43, s57
  v_xor_b32 v5, s43, v3
  v_lshl_add_u32 v116, v5, 5, v4
  v_xor_b32 v5, 1, v5
  v_lshl_add_u32 v117, v5, 5, v4
  v_add_u32 v118, 49152, v116
  v_add_u32 v119, 49152, v117
  s_mov_b32 s84, s16
  s_mov_b32 s85, s17
  s_mov_b32 s86, 7340032
  s_mov_b32 s87, 0x20000
  s_mov_b32 s3, 0
  s_mov_b32 s88, 63
  s_mov_b32 s100, 0
  v_mov_b32 v238, 0x40000000
  s_waitcnt vmcnt(0)
  s_barrier
  s_cmp_lg_u32 s40, 0
  s_cbranch_scc1 Lsig19
  v_mov_b32 v250, 1
  s_mov_b64 exec, 1
  buffer_atomic_add v250, v251, s[4:7], s77 offen sc1
  s_mov_b64 exec, -1
Lsig19:
  s_add_u32 s44, s67, 0
  s_and_b32 s44, s44, 15
  s_mul_i32 s45, s44, 393216
  s_add_u32 s69, s45, s60
  s_add_u32 s70, s69, 4096
  s_add_u32 m0, s63, 0
  s_nop 0
  buffer_load_dwordx4 v124, s[8:11], s69 offen offset:0  lds
  buffer_load_dwordx4 v125, s[8:11], s69 offen offset:1024  lds
  buffer_load_dwordx4 v124, s[8:11], s69 offen offset:2048  lds
  buffer_load_dwordx4 v125, s[8:11], s69 offen offset:3072  lds
  s_add_u32 m0, s63, 4096
  s_nop 0
  buffer_load_dwordx4 v124, s[8:11], s70 offen offset:0  lds
  buffer_load_dwordx4 v125, s[8:11], s70 offen offset:1024  lds
  s_add_u32 s44, s67, 1
  s_and_b32 s44, s44, 15
  s_mul_i32 s45, s44, 393216
  s_add_u32 s69, s45, s60
  s_add_u32 s70, s69, 4096
  s_add_u32 m0, s63, 24576
  s_nop 0
  buffer_load_dwordx4 v124, s[8:11], s69 offen offset:0  lds
  buffer_load_dwordx4 v125, s[8:11], s69 offen offset:1024  lds
  buffer_load_dwordx4 v124, s[8:11], s69 offen offset:2048  lds
  buffer_load_dwordx4 v125, s[8:11], s69 offen offset:3072  lds
  s_add_u32 m0, s63, 28672
  s_nop 0
  buffer_load_dwordx4 v124, s[8:11], s70 offen offset:0  lds
  buffer_load_dwordx4 v125, s[8:11], s70 offen offset:1024  lds
  s_add_u32 s44, s67, 2
  s_and_b32 s44, s44, 15
  s_mul_i32 s45, s44, 393216
  s_add_u32 s69, s45, s60
  s_add_u32 s70, s69, 4096
  s_add_u32 m0, s63, 49152
  s_nop 0
  buffer_load_dwordx4 v124, s[8:11], s69 offen offset:0  lds
  buffer_load_dwordx4 v125, s[8:11], s69 offen offset:1024  lds
  buffer_load_dwordx4 v124, s[8:11], s69 offen offset:2048  lds
  buffer_load_dwordx4 v125, s[8:11], s69 offen offset:3072  lds
  s_add_u32 m0, s63, 53248
  s_nop 0
  buffer_load_dwordx4 v124, s[8:11], s70 offen offset:0  lds
  buffer_load_dwordx4 v125, s[8:11], s70 offen offset:1024  lds
  v_mov_b32 v0, 0
  v_mov_b32 v1, 0
  v_mov_b32 v2, 0
  v_mov_b32 v3, 0
  v_mov_b32 v4, 0
  v_mov_b32 v5, 0
  v_mov_b32 v6, 0
  v_mov_b32 v7, 0
  v_mov_b32 v8, 0
  v_mov_b32 v9, 0
  v_mov_b32 v10, 0
  v_mov_b32 v11, 0
  v_mov_b32 v12, 0
  v_mov_b32 v13, 0
  v_mov_b32 v14, 0
  v_mov_b32 v15, 0
  v_mov_b32 v16, 0
  v_mov_b32 v17, 0
  v_mov_b32 v18, 0
  v_mov_b32 v19, 0
  v_mov_b32 v20, 0
  v_mov_b32 v21, 0
  v_mov_b32 v22, 0
  v_mov_b32 v23, 0
  v_mov_b32 v24, 0
  v_mov_b32 v25, 0
  v_mov_b32 v26, 0
  v_mov_b32 v27, 0
  v_mov_b32 v28, 0
  v_mov_b32 v29, 0
  v_mov_b32 v30, 0
  v_mov_b32 v31, 0
  v_mov_b32 v32, 0
  v_mov_b32 v33, 0
  v_mov_b32 v34, 0
  v_mov_b32 v35, 0
  v_mov_b32 v36, 0
  v_mov_b32 v37, 0
  v_mov_b32 v38, 0
  v_mov_b32 v39, 0
  v_mov_b32 v40, 0
  v_mov_b32 v41, 0
  v_mov_b32 v42, 0
  v_mov_b32 v43, 0
  v_mov_b32 v44, 0
  v_mov_b32 v45, 0
  v_mov_b32 v46, 0
  v_mov_b32 v47, 0
  v_mov_b32 v48, 0
  v_mov_b32 v49, 0
  v_mov_b32 v50, 0
  v_mov_b32 v51, 0
  v_mov_b32 v52, 0
  v_mov_b32 v53, 0
  v_mov_b32 v54, 0
  v_mov_b32 v55, 0
  v_mov_b32 v56, 0
  v_mov_b32 v57, 0
  v_mov_b32 v58, 0
  v_mov_b32 v59, 0
  v_mov_b32 v60, 0
  v_mov_b32 v61, 0
  v_mov_b32 v62, 0
  v_mov_b32 v63, 0
  v_mov_b32 v64, 0
  v_mov_b32 v65, 0
  v_mov_b32 v66, 0
  v_mov_b32 v67, 0
  v_mov_b32 v68, 0
  v_mov_b32 v69, 0
  v_mov_b32 v70, 0
  v_mov_b32 v71, 0
  v_mov_b32 v72, 0
  v_mov_b32 v73, 0
  v_mov_b32 v74, 0
  v_mov_b32 v75, 0
  v_mov_b32 v76, 0
  v_mov_b32 v77, 0
  v_mov_b32 v78, 0
  v_mov_b32 v79, 0
  v_mov_b32 v80, 0
  v_mov_b32 v81, 0
  v_mov_b32 v82, 0
  v_mov_b32 v83, 0
  v_mov_b32 v84, 0
  v_mov_b32 v85, 0
  v_mov_b32 v86, 0
  v_mov_b32 v87, 0
  v_mov_b32 v88, 0
  v_mov_b32 v89, 0
  v_mov_b32 v90, 0
  v_mov_b32 v91, 0
  v_mov_b32 v92, 0
  v_mov_b32 v93, 0
  v_mov_b32 v94, 0
  v_mov_b32 v95, 0
  v_mov_b32 v96, 0
  v_mov_b32 v97, 0
  v_mov_b32 v98, 0
  v_mov_b32 v99, 0
  v_mov_b32 v100, 0
  v_mov_b32 v101, 0
  v_mov_b32 v102, 0
  v_mov_b32 v103, 0
  s_lshl_b32 s77, s50, 7
  s_add_u32 s77, s77, 27792256
  s_and_b32 s43, s50, 7
  s_cmp_eq_u32 s43, 0
  s_cselect_b32 s43, 0x80, 0
  v_lshlrev_b32 v249, 7, v253
  v_or_b32 v249, s43, v249
  s_branch Llayer
Lfinal:
  v_and_b32 v128, 15, v253
  v_lshrrev_b32 v129, 4, v253
  v_lshrrev_b32 v130, 1, v129
  v_and_b32 v129, 1, v129
  v_lshl_add_u32 v129, v129, 1, v130
  v_and_b32 v130, 7, v253
  v_xor_b32 v129, v129, v130
  v_lshlrev_b32 v129, 4, v129
  v_lshl_add_u32 v128, v128, 7, v129
  s_lshl_b32 s43, s40, 12
  v_add_u32 v128, s43, v128
  v_xor_b32 v129, 64, v128
  v_lshlrev_b32 v112, 16, v96
  v_and_b32 v113, 0xffff0000, v96
  v_lshlrev_b32 v114, 16, v97
  v_and_b32 v115, 0xffff0000, v97
  v_lshlrev_b32 v116, 16, v98
  v_and_b32 v117, 0xffff0000, v98
  v_lshlrev_b32 v118, 16, v99
  v_and_b32 v119, 0xffff0000, v99
  v_pk_add_f32 v[64:65], v[64:65], v[112:113]
  v_pk_add_f32 v[66:67], v[66:67], v[114:115]
  v_pk_add_f32 v[72:73], v[72:73], v[116:117]
  v_pk_add_f32 v[74:75], v[74:75], v[118:119]
  v_cvt_pk_bf16_f32 v16, v64, v65
  v_cvt_pk_bf16_f32 v17, v66, v67
  v_cvt_pk_bf16_f32 v18, v72, v73
  v_cvt_pk_bf16_f32 v19, v74, v75
  s_nop 1
  v_permlane16_swap_b32 v16, v18
  v_permlane16_swap_b32 v17, v19
  ds_write_b128 v128, v[16:19] offset:0
  v_lshlrev_b32 v112, 16, v104
  v_and_b32 v113, 0xffff0000, v104
  v_lshlrev_b32 v114, 16, v105
  v_and_b32 v115, 0xffff0000, v105
  v_lshlrev_b32 v116, 16, v106
  v_and_b32 v117, 0xffff0000, v106
  v_lshlrev_b32 v118, 16, v107
  v_and_b32 v119, 0xffff0000, v107
  v_pk_add_f32 v[68:69], v[68:69], v[112:113]
  v_pk_add_f32 v[70:71], v[70:71], v[114:115]
  v_pk_add_f32 v[76:77], v[76:77], v[116:117]
  v_pk_add_f32 v[78:79], v[78:79], v[118:119]
  v_cvt_pk_bf16_f32 v24, v68, v69
  v_cvt_pk_bf16_f32 v25, v70, v71
  v_cvt_pk_bf16_f32 v26, v76, v77
  v_cvt_pk_bf16_f32 v27, v78, v79
  s_nop 1
  v_permlane16_swap_b32 v24, v26
  v_permlane16_swap_b32 v25, v27
  ds_write_b128 v128, v[24:27] offset:2048
  v_lshlrev_b32 v112, 16, v100
  v_and_b32 v113, 0xffff0000, v100
  v_lshlrev_b32 v114, 16, v101
  v_and_b32 v115, 0xffff0000, v101
  v_lshlrev_b32 v116, 16, v102
  v_and_b32 v117, 0xffff0000, v102
  v_lshlrev_b32 v118, 16, v103
  v_and_b32 v119, 0xffff0000, v103
  v_pk_add_f32 v[80:81], v[80:81], v[112:113]
  v_pk_add_f32 v[82:83], v[82:83], v[114:115]
  v_pk_add_f32 v[88:89], v[88:89], v[116:117]
  v_pk_add_f32 v[90:91], v[90:91], v[118:119]
  v_cvt_pk_bf16_f32 v20, v80, v81
  v_cvt_pk_bf16_f32 v21, v82, v83
  v_cvt_pk_bf16_f32 v22, v88, v89
  v_cvt_pk_bf16_f32 v23, v90, v91
  s_nop 1
  v_permlane16_swap_b32 v20, v22
  v_permlane16_swap_b32 v21, v23
  ds_write_b128 v129, v[20:23] offset:0
  v_lshlrev_b32 v112, 16, v108
  v_and_b32 v113, 0xffff0000, v108
  v_lshlrev_b32 v114, 16, v109
  v_and_b32 v115, 0xffff0000, v109
  v_lshlrev_b32 v116, 16, v110
  v_and_b32 v117, 0xffff0000, v110
  v_lshlrev_b32 v118, 16, v111
  v_and_b32 v119, 0xffff0000, v111
  v_pk_add_f32 v[84:85], v[84:85], v[112:113]
  v_pk_add_f32 v[86:87], v[86:87], v[114:115]
  v_pk_add_f32 v[92:93], v[92:93], v[116:117]
  v_pk_add_f32 v[94:95], v[94:95], v[118:119]
  v_cvt_pk_bf16_f32 v28, v84, v85
  v_cvt_pk_bf16_f32 v29, v86, v87
  v_cvt_pk_bf16_f32 v30, v92, v93
  v_cvt_pk_bf16_f32 v31, v94, v95
  s_nop 1
  v_permlane16_swap_b32 v28, v30
  v_permlane16_swap_b32 v29, v31
  ds_write_b128 v129, v[28:31] offset:2048
  v_lshrrev_b32 v131, 3, v253
  v_xor_b32 v132, v131, v130
  v_lshlrev_b32 v132, 4, v132
  v_lshl_add_u32 v132, v131, 7, v132
  v_add_u32 v132, s43, v132
  ds_read_b128 v[96:99], v132 offset:0
  ds_read_b128 v[100:103], v132 offset:1024
  ds_read_b128 v[104:107], v132 offset:2048
  ds_read_b128 v[108:111], v132 offset:3072
  v_lshlrev_b32 v130, 4, v130
  v_lshl_add_u32 v130, v131, 12, v130
  s_and_b32 s43, s49, 63
  s_lshl_b32 s43, s43, 16
  s_lshr_b32 s46, s49, 6
  s_lshl_b32 s46, s46, 11
  s_add_u32 s46, s46, s43
  s_lshl_b32 s43, s53, 7
  s_add_u32 s46, s46, s43
  s_waitcnt lgkmcnt(3)
  buffer_store_dwordx4 v[96:99], v130, s[32:35], s46 offen sc1
  s_add_u32 s46, s46, 32768
  s_waitcnt lgkmcnt(2)
  buffer_store_dwordx4 v[100:103], v130, s[32:35], s46 offen sc1
  s_add_u32 s46, s46, 32768
  s_waitcnt lgkmcnt(1)
  buffer_store_dwordx4 v[104:107], v130, s[32:35], s46 offen sc1
  s_add_u32 s46, s46, 32768
  s_waitcnt lgkmcnt(0)
  buffer_store_dwordx4 v[108:111], v130, s[32:35], s46 offen sc1
  s_add_u32 s46, s46, 32768
Lend:
  s_endpgm
Lside_sub:
  s_cmp_eq_u32 s90, 1
  s_cbranch_scc0 Lside_l
  s_cmp_lg_u32 s40, 0
  s_cbranch_scc1 Lside_a
  s_and_b32 s43, s2, 1
  s_lshl_b32 s43, s43, 7
  v_mov_b32 v250, 1
  s_mov_b64 exec, 1
  buffer_atomic_add v250, v251, s[36:39], s43 offen sc1
  s_mov_b64 exec, -1
Lside_a:
  s_add_u32 s88, s88, 3
  s_add_u32 s90, s90, 1
  s_setpc_b64 s[78:79]
Lside_l:
  buffer_load_dwordx4 a[240:243], v239, s[12:15], s89 offen
  s_add_u32 s89, s89, 1024
  s_cmp_eq_u32 s90, 0
  s_cbranch_scc0 Lside_b
  buffer_load_dwordx4 a[176:179], v238, s[84:87], s100 offen
  s_add_u32 s100, s100, 57344
  buffer_load_dwordx4 a[180:183], v238, s[84:87], s100 offen
  s_add_u32 s100, s100, 57344
  buffer_load_dwordx4 a[184:187], v238, s[84:87], s100 offen
  s_add_u32 s100, s100, 57344
  buffer_load_dwordx4 a[188:191], v238, s[84:87], s100 offen
  s_add_u32 s100, s100, 57344
  buffer_load_dwordx4 a[192:195], v238, s[84:87], s100 offen
  s_add_u32 s100, s100, 57344
  buffer_load_dwordx4 a[196:199], v238, s[84:87], s100 offen
  s_add_u32 s100, s100, 57344
  buffer_load_dwordx4 a[200:203], v238, s[84:87], s100 offen
  s_add_u32 s100, s100, 57344
  buffer_load_dwordx4 a[204:207], v238, s[84:87], s100 offen
  s_add_u32 s100, s100, 57344
  s_add_u32 s100, s100, 3211264
  s_add_u32 s88, s88, 3
  s_add_u32 s90, s90, 1
  s_setpc_b64 s[78:79]
Lside_b:
  buffer_load_dwordx4 a[208:211], v238, s[84:87], s100 offen
  s_add_u32 s100, s100, 57344
  buffer_load_dwordx4 a[212:215], v238, s[84:87], s100 offen
  s_add_u32 s100, s100, 57344
  buffer_load_dwordx4 a[216:219], v238, s[84:87], s100 offen
  s_add_u32 s100, s100, 57344
  buffer_load_dwordx4 a[220:223], v238, s[84:87], s100 offen
  s_add_u32 s100, s100, 57344
  buffer_load_dwordx4 a[224:227], v238, s[84:87], s100 offen
  s_add_u32 s100, s100, 57344
  buffer_load_dwordx4 a[228:231], v238, s[84:87], s100 offen
  s_add_u32 s100, s100, 57344
  buffer_load_dwordx4 a[232:235], v238, s[84:87], s100 offen
  s_add_u32 s100, s100, 57344
  buffer_load_dwordx4 a[236:239], v238, s[84:87], s100 offen
  s_add_u32 s100, s100, 57344
  s_mov_b32 s88, 63
  s_setpc_b64 s[78:79]
Lcode_end:
.fill (Lpc0 + 69632 - Lcode_end)/4, 4, 0xbf810000
.section .rodata,"a"
.p2align 6
.amdhsa_kernel interleave_layers__sliding_local_dilated__swiglu_ffn__prompt_kernel
  .amdhsa_next_free_vgpr 512
  .amdhsa_next_free_sgpr 102
  .amdhsa_accum_offset 256
  .amdhsa_group_segment_fixed_size 0
  .amdhsa_kernarg_size 80
  .amdhsa_user_sgpr_count 2
  .amdhsa_user_sgpr_kernarg_segment_ptr 1
  .amdhsa_system_sgpr_workgroup_id_x 1
  .amdhsa_float_denorm_mode_32 3
.end_amdhsa_kernel
```

```asm
; @launch grid=(256,1,1) block=(256,1,1) lds=163840
.amdgcn_target "amdgcn-amd-amdhsa--gfx950"
.text
.globl interleave_layers__sliding_local_dilated__swiglu_ffn__prompt_kernel
.p2align 8
.type interleave_layers__sliding_local_dilated__swiglu_ffn__prompt_kernel,@function
interleave_layers__sliding_local_dilated__swiglu_ffn__prompt_kernel:
  s_cmp_lt_u32 s2, 256
  s_cbranch_scc1 Lgo
  s_endpgm
Lgo:
  s_load_dwordx2 s[28:29], s[0:1], 0
  s_load_dwordx2 s[8:9], s[0:1], 8
  s_getpc_b64 s[44:45]
Lpc0:
  s_bfe_u32 s43, s2, 0x40003
  s_lshl_b32 s43, s43, 12
  v_lshl_add_u32 v2, v0, 4, s43
  s_and_b32 s44, s44, 0xffffff80
  global_load_dwordx4 a[240:243], v2, s[44:45]
  v_lshrrev_b32 v1, 6, v0
  v_and_b32 v253, 63, v0
  v_readfirstlane_b32 s40, v1
  v_mov_b32 v251, 0
  s_mov_b32 s30, 0x400000
  s_mov_b32 s31, 0x20000
  s_mov_b32 s10, 0x600000
  s_mov_b32 s11, 0x20000
  s_and_b32 s44, s2, 1
  s_bfe_u32 s45, s2, 0x20001
  s_lshr_b32 s46, s2, 3
  s_lshl_b32 s47, s44, 3
  s_and_b32 s43, s46, 7
  s_add_u32 s50, s47, s43
  s_lshl_b32 s43, s45, 2
  s_lshr_b32 s51, s46, 3
  s_add_u32 s51, s51, s43
  s_lshr_b32 s57, s40, 1
  s_and_b32 s58, s40, 1
  s_lshl_b32 s71, s50, 3
  s_add_u32 s67, s50, s51
  s_and_b32 s67, s67, 15
  s_lshl_b32 s62, s40, 12
  s_mul_i32 s63, s40, 6144
  s_add_u32 s76, s63, 139264
  s_and_b32 s43, s50, 7
  s_cmp_lg_u32 s43, 0
  s_cselect_b32 s43, 1, 0
  s_sub_u32 s72, s71, s43
  v_lshrrev_b32 v2, 3, v253
  v_bfe_u32 v3, v253, 1, 2
  v_lshrrev_b32 v4, 4, v253
  v_xor_b32 v3, v3, v4
  v_and_b32 v5, 1, v253
  v_lshrrev_b32 v6, 5, v253
  v_lshl_add_u32 v6, v6, 2, v2
  s_lshl_b32 s43, s57, 5
  s_lshl_b32 s44, s58, 2
  s_add_u32 s43, s43, s44
  v_mul_u32_u24 v6, 6144, v6
  v_lshl_add_u32 v6, v3, 5, v6
  v_lshl_add_u32 v124, v5, 4, v6
  v_add_u32 v125, 97280, v124
  s_mul_i32 s43, s43, 6144
  s_lshl_b32 s60, s51, 7
  s_add_u32 s60, s60, s43
  v_and_b32 v3, 7, v253
  s_lshl_b32 s43, s40, 1
  s_add_u32 s43, s43, s71
  v_add_u32 v5, 0, v4
  v_xor_b32 v5, v5, v3
  v_lshlrev_b32 v5, 4, v5
  v_lshl_add_u32 v5, v2, 12, v5
  v_add_u32 v120, 0, v5
  v_add_u32 v5, 4, v4
  v_xor_b32 v5, v5, v3
  v_lshlrev_b32 v5, 4, v5
  v_lshl_add_u32 v5, v2, 12, v5
  v_add_u32 v121, 31744, v5
  v_add_u32 v5, 0, v4
  v_xor_b32 v5, v5, v3
  v_lshlrev_b32 v5, 4, v5
  v_lshl_add_u32 v5, v2, 12, v5
  v_add_u32 v122, 63488, v5
  v_add_u32 v5, 4, v4
  v_xor_b32 v5, v5, v3
  v_lshlrev_b32 v5, 4, v5
  v_lshl_add_u32 v5, v2, 12, v5
  v_add_u32 v123, 95232, v5
  v_and_b32 v5, 6, v2
  v_xor_b32 v5, v5, v3
  v_lshlrev_b32 v5, 4, v5
  v_lshl_add_u32 v5, v2, 12, v5
  v_add_u32 v126, 32768, v5
  s_lshr_b32 s44, s50, 3
  s_lshl_b32 s44, s44, 11
  s_and_b32 s43, s43, 63
  s_lshl_b32 s43, s43, 16
  s_add_u32 s59, s43, s44
  s_and_b32 s43, s72, 63
  s_lshl_b32 s43, s43, 16
  s_add_u32 s73, s43, s44
  s_movk_i32 s61, 128
  s_waitcnt lgkmcnt(0)
  s_add_u32 s44, s67, 0
  s_and_b32 s44, s44, 15
  s_mul_i32 s45, s44, s61
  s_add_u32 s68, s45, s59
  s_add_u32 m0, s62, 73728
  s_nop 0
  buffer_load_dwordx4 v120, s[28:31], s68 offen offset:0 sc1  lds
  buffer_load_dwordx4 v121, s[28:31], s68 offen offset:1024 sc1  lds
  buffer_load_dwordx4 v122, s[28:31], s68 offen offset:2048 sc1  lds
  buffer_load_dwordx4 v123, s[28:31], s68 offen offset:3072 sc1  lds
  s_add_u32 s44, s67, 0
  s_and_b32 s44, s44, 15
  s_mul_i32 s45, s44, 393216
  s_add_u32 s69, s45, s60
  s_add_u32 s70, s69, 4096
  s_add_u32 m0, s63, 0
  s_nop 0
  buffer_load_dwordx4 v124, s[8:11], s69 offen offset:0  lds
  buffer_load_dwordx4 v125, s[8:11], s69 offen offset:1024  lds
  buffer_load_dwordx4 v124, s[8:11], s69 offen offset:2048  lds
  buffer_load_dwordx4 v125, s[8:11], s69 offen offset:3072  lds
  s_add_u32 m0, s63, 4096
  s_nop 0
  buffer_load_dwordx4 v124, s[8:11], s70 offen offset:0  lds
  buffer_load_dwordx4 v125, s[8:11], s70 offen offset:1024  lds
  s_add_u32 s44, s67, s40
  s_add_u32 s44, s44, 0
  s_and_b32 s44, s44, 15
  s_mul_i32 s44, s44, s61
  s_lshl_b32 s45, s40, 10
  s_add_u32 m0, s45, 122880
  s_add_u32 s44, s44, s73
  buffer_load_dwordx4 v126, s[28:31], s44 offen sc1 lds
  s_load_dwordx2 s[4:5], s[0:1], 72
  s_load_dwordx2 s[12:13], s[0:1], 16
  s_load_dwordx2 s[16:17], s[0:1], 32
  s_load_dwordx2 s[20:21], s[0:1], 40
  s_load_dwordx2 s[24:25], s[0:1], 48
  s_load_dwordx2 s[32:33], s[0:1], 56
  s_load_dwordx2 s[36:37], s[0:1], 64
  s_mov_b32 s6, 0x10000000
  s_mov_b32 s7, 0x20000
  s_mov_b32 s14, 0x200000
  s_mov_b32 s15, 0x20000
  s_mov_b32 s18, 0x700000
  s_mov_b32 s19, 0x20000
  s_mov_b32 s22, 0x700000
  s_mov_b32 s23, 0x20000
  s_mov_b32 s26, 0x700000
  s_mov_b32 s27, 0x20000
  s_mov_b32 s34, 0x400000
  s_mov_b32 s35, 0x20000
  s_mov_b32 s38, 0x100
  s_mov_b32 s39, 0x20000
  s_mov_b32 s41, 0
  s_mov_b32 s42, 0
  s_and_b32 s44, s2, 1
  s_bfe_u32 s45, s2, 0x20001
  s_lshr_b32 s46, s2, 3
  s_lshl_b32 s47, s44, 3
  s_lshr_b32 s43, s45, 1
  s_lshl_b32 s43, s43, 2
  s_add_u32 s52, s47, s43
  s_and_b32 s48, s46, 3
  s_add_u32 s52, s52, s48
  s_and_b32 s43, s45, 1
  s_lshr_b32 s49, s46, 2
  s_lshl_b32 s53, s49, 1
  s_add_u32 s53, s53, s43
  s_lshl_b32 s43, s44, 2
  s_add_u32 s54, s43, s48
  s_lshl_b32 s43, s45, 3
  s_add_u32 s55, s43, s49
  v_lshrrev_b32 v2, 3, v253
  v_bfe_u32 v3, v253, 1, 2
  v_lshrrev_b32 v4, 4, v253
  v_xor_b32 v3, v3, v4
  v_and_b32 v4, 1, v253
  v_lshlrev_b32 v2, 11, v2
  v_lshl_add_u32 v2, v3, 5, v2
  v_lshl_add_u32 v252, v4, 4, v2
  s_waitcnt lgkmcnt(0)
  s_and_b32 s43, s40, 1
  s_mul_i32 s43, s43, 41943040
  s_lshl_b32 s44, s2, 7
  s_add_u32 s43, s43, s44
  s_add_u32 s43, s43, 27787264
  buffer_store_dword v251, v251, s[4:7], s43 offen sc1
  v_and_b32 v2, 15, v253
  v_lshrrev_b32 v3, 4, v253
  v_and_b32 v4, 7, v253
  v_lshrrev_b32 v5, 1, v2
  v_xor_b32 v5, v5, v3
  v_lshlrev_b32 v5, 4, v5
  v_lshl_add_u32 v6, v2, 7, v5
  v_xor_b32 v7, 64, v6
  v_and_b32 v5, 6, v4
  v_xor_b32 v5, v5, v3
  v_lshlrev_b32 v5, 4, v5
  v_lshl_add_u32 v8, v4, 7, v5
  v_xor_b32 v9, 64, v8
  s_lshl_b32 s43, s57, 13
  s_add_u32 s43, s43, 73728
  v_add_u32 v112, s43, v6
  v_add_u32 v113, s43, v7
  v_add_u32 v114, 122880, v8
  v_add_u32 v115, 122880, v9
  s_lshl_b32 s43, s52, 3
  s_lshl_b32 s44, s40, 1
  s_add_u32 s43, s43, s44
  v_lshrrev_b32 v5, 1, v3
  v_lshrrev_b32 v187, 1, v2
  v_xor_b32 v5, v5, v187
  v_lshlrev_b32 v5, 4, v5
  v_lshl_add_u32 v187, v2, 7, v5
  v_and_b32 v5, 1, v3
  v_lshl_add_u32 v187, v5, 3, v187
  s_lshr_b32 s44, s43, 6
  s_lshl_b32 s44, s44, 11
  s_and_b32 s43, s43, 63
  s_lshl_b32 s43, s43, 16
  s_add_u32 s43, s43, s44
  s_lshl_b32 s44, s53, 7
  s_add_u32 s64, s43, s44
  v_lshrrev_b32 v2, 2, v253
  v_bfe_u32 v3, v253, 3, 2
  v_and_b32 v4, 3, v253
  v_lshlrev_b32 v4, 3, v4
  v_lshl_add_u32 v4, v2, 7, v4
  s_lshl_b32 s43, s58, 1
  s_or_b32 s43, s43, s57
  v_xor_b32 v5, s43, v3
  v_lshl_add_u32 v116, v5, 5, v4
  v_xor_b32 v5, 1, v5
  v_lshl_add_u32 v117, v5, 5, v4
  v_add_u32 v118, 49152, v116
  v_add_u32 v119, 49152, v117
  v_mov_b32 v0, 0
  v_mov_b32 v1, 0
  v_mov_b32 v2, 0
  v_mov_b32 v3, 0
  v_mov_b32 v4, 0
  v_mov_b32 v5, 0
  v_mov_b32 v6, 0
  v_mov_b32 v7, 0
  v_mov_b32 v8, 0
  v_mov_b32 v9, 0
  v_mov_b32 v10, 0
  v_mov_b32 v11, 0
  v_mov_b32 v12, 0
  v_mov_b32 v13, 0
  v_mov_b32 v14, 0
  v_mov_b32 v15, 0
  v_mov_b32 v16, 0
  v_mov_b32 v17, 0
  v_mov_b32 v18, 0
  v_mov_b32 v19, 0
  v_mov_b32 v20, 0
  v_mov_b32 v21, 0
  v_mov_b32 v22, 0
  v_mov_b32 v23, 0
  v_mov_b32 v24, 0
  v_mov_b32 v25, 0
  v_mov_b32 v26, 0
  v_mov_b32 v27, 0
  v_mov_b32 v28, 0
  v_mov_b32 v29, 0
  v_mov_b32 v30, 0
  v_mov_b32 v31, 0
  v_mov_b32 v32, 0
  v_mov_b32 v33, 0
  v_mov_b32 v34, 0
  v_mov_b32 v35, 0
  v_mov_b32 v36, 0
  v_mov_b32 v37, 0
  v_mov_b32 v38, 0
  v_mov_b32 v39, 0
  v_mov_b32 v40, 0
  v_mov_b32 v41, 0
  v_mov_b32 v42, 0
  v_mov_b32 v43, 0
  v_mov_b32 v44, 0
  v_mov_b32 v45, 0
  v_mov_b32 v46, 0
  v_mov_b32 v47, 0
  v_mov_b32 v48, 0
  v_mov_b32 v49, 0
  v_mov_b32 v50, 0
  v_mov_b32 v51, 0
  v_mov_b32 v52, 0
  v_mov_b32 v53, 0
  v_mov_b32 v54, 0
  v_mov_b32 v55, 0
  v_mov_b32 v56, 0
  v_mov_b32 v57, 0
  v_mov_b32 v58, 0
  v_mov_b32 v59, 0
  v_mov_b32 v60, 0
  v_mov_b32 v61, 0
  v_mov_b32 v62, 0
  v_mov_b32 v63, 0
  v_mov_b32 v64, 0
  v_mov_b32 v65, 0
  v_mov_b32 v66, 0
  v_mov_b32 v67, 0
  v_mov_b32 v68, 0
  v_mov_b32 v69, 0
  v_mov_b32 v70, 0
  v_mov_b32 v71, 0
  v_mov_b32 v72, 0
  v_mov_b32 v73, 0
  v_mov_b32 v74, 0
  v_mov_b32 v75, 0
  v_mov_b32 v76, 0
  v_mov_b32 v77, 0
  v_mov_b32 v78, 0
  v_mov_b32 v79, 0
  v_mov_b32 v80, 0
  v_mov_b32 v81, 0
  v_mov_b32 v82, 0
  v_mov_b32 v83, 0
  v_mov_b32 v84, 0
  v_mov_b32 v85, 0
  v_mov_b32 v86, 0
  v_mov_b32 v87, 0
  v_mov_b32 v88, 0
  v_mov_b32 v89, 0
  v_mov_b32 v90, 0
  v_mov_b32 v91, 0
  v_mov_b32 v92, 0
  v_mov_b32 v93, 0
  v_mov_b32 v94, 0
  v_mov_b32 v95, 0
  v_mov_b32 v96, 0
  v_mov_b32 v97, 0
  v_mov_b32 v98, 0
  v_mov_b32 v99, 0
  v_mov_b32 v100, 0
  v_mov_b32 v101, 0
  v_mov_b32 v102, 0
  v_mov_b32 v103, 0
  v_and_b32 v235, 15, v253
  v_lshrrev_b32 v236, 4, v253
  v_lshlrev_b32 v236, 2, v236
  v_sub_u32 v235, v235, v236
  v_mov_b32 v237, 0xf149f2ca
  v_subrev_u32 v238, 0, v235
  v_cmp_gt_u32 vcc, 8, v238
  v_add_u32 v238, 16, v238
  v_cmp_gt_u32 s[78:79], 8, v238
  v_cndmask_b32 v132, v237, 0, vcc
  s_nop 0
  v_cndmask_b32 v136, v237, 0, s[78:79]
  v_subrev_u32 v238, 1, v235
  v_cmp_gt_u32 vcc, 8, v238
  v_add_u32 v238, 16, v238
  v_cmp_gt_u32 s[78:79], 8, v238
  v_cndmask_b32 v133, v237, 0, vcc
  s_nop 0
  v_cndmask_b32 v137, v237, 0, s[78:79]
  v_subrev_u32 v238, 2, v235
  v_cmp_gt_u32 vcc, 8, v238
  v_add_u32 v238, 16, v238
  v_cmp_gt_u32 s[78:79], 8, v238
  v_cndmask_b32 v134, v237, 0, vcc
  s_nop 0
  v_cndmask_b32 v138, v237, 0, s[78:79]
  v_subrev_u32 v238, 3, v235
  v_cmp_gt_u32 vcc, 8, v238
  v_add_u32 v238, 16, v238
  v_cmp_gt_u32 s[78:79], 8, v238
  v_cndmask_b32 v135, v237, 0, vcc
  s_nop 0
  v_cndmask_b32 v139, v237, 0, s[78:79]
  v_lshlrev_b32 v232, 4, v253
  v_add_u32 v232, 149504, v232
  ds_write_b128 v232, v[132:135]
  ds_write_b128 v232, v[136:139] offset:1024
  s_lshr_b32 s46, s2, 3
  s_cmp_ge_u32 s46, 14
  s_cselect_b32 s44, 14, 0
  s_cselect_b32 s45, 1, 0
  s_cselect_b32 s84, s20, s16
  s_cselect_b32 s85, s21, s17
  s_mov_b32 s86, 7340032
  s_mov_b32 s87, 0x20000
  s_sub_u32 s44, s46, s44
  s_bfe_u32 s47, s2, 0x20001
  s_mul_i32 s47, s47, 14
  s_add_u32 s44, s44, s47
  s_and_b32 s47, s2, 1
  s_lshl_b32 s48, s47, 1
  s_add_u32 s48, s48, s45
  s_mul_i32 s48, s48, 14336
  s_lshl_b32 s49, s44, 8
  s_add_u32 s48, s48, s49
  s_add_u32 s101, s48, 27918336
  s_lshl_b32 s47, s47, 2
  s_add_u32 s47, s47, s40
  s_mul_i32 s47, s47, 458752
  s_lshl_b32 s44, s44, 7
  s_add_u32 s100, s47, s44
  s_cmp_lt_u32 s46, 28
  s_cselect_b32 s3, 1, 0
  s_cmp_eq_u32 s41, 0
  s_cselect_b32 s3, s3, 0
  v_lshrrev_b32 v238, 3, v253
  v_mul_u32_u24 v238, 7168, v238
  v_and_b32 v239, 7, v253
  v_lshl_add_u32 v238, v239, 4, v238
  s_cmp_eq_u32 s3, 0
  s_cselect_b32 s43, 0x40000000, 0
  v_or_b32 v238, s43, v238
  v_lshlrev_b32 v239, 4, v253
  s_lshl_b32 s43, s2, 2
  s_add_u32 s43, s43, s40
  s_lshl_b32 s89, s43, 11
  s_mul_i32 s43, s46, 43
  s_lshr_b32 s43, s43, 8
  s_mul_i32 s43, s43, 6
  s_sub_u32 s43, s46, s43
  s_add_u32 s43, s43, 5
  s_cmp_eq_u32 s41, 0
  s_cselect_b32 s88, s43, 63
  s_mov_b32 s90, 0
  s_lshl_b32 s43, s58, 12
  v_add_u32 v132, s43, v112
  v_add_u32 v133, s43, v113
  v_and_b32 v128, 15, v253
  v_lshrrev_b32 v129, 4, v253
  v_cmp_eq_u32 vcc, 0, v128
  v_lshlrev_b32 v129, 4, v129
  v_mov_b32 v130, 0x40000000
  v_cndmask_b32 v136, v130, v129, vcc
  v_mov_b32 v156, 0x3f803f80
  v_mov_b32 v157, 0x3f803f80
  v_mov_b32 v158, 0x3f803f80
  v_mov_b32 v159, 0x3f803f80
  s_lshl_b32 s43, s40, 1
  s_add_u32 s43, s43, s71
  s_lshl_b32 s48, s43, 11
  s_lshl_b32 s43, s67, 7
  s_add_u32 s48, s48, s43
  s_add_u32 s48, s48, 27262976
  s_lshl_b32 s43, s51, 2
  s_lshl_b32 s44, s58, 1
  s_add_u32 s43, s43, s44
  s_add_u32 s43, s43, s57
  s_lshl_b32 s43, s43, 6
  s_mul_i32 s49, s67, 12288
  s_add_u32 s49, s49, s43
  s_add_u32 s49, s49, 27983872
  s_add_u32 s44, s67, 1
  s_and_b32 s44, s44, 15
  s_mul_i32 s45, s44, s61
  s_add_u32 s68, s45, s59
  s_add_u32 m0, s62, 90112
  s_nop 0
  buffer_load_dwordx4 v120, s[28:31], s68 offen offset:0 sc1  lds
  buffer_load_dwordx4 v121, s[28:31], s68 offen offset:1024 sc1  lds
  buffer_load_dwordx4 v122, s[28:31], s68 offen offset:2048 sc1  lds
  buffer_load_dwordx4 v123, s[28:31], s68 offen offset:3072 sc1  lds
  s_waitcnt vmcnt(5)
  s_barrier
  ds_read_b128 v[140:143], v132 offset:0
  ds_read_b128 v[144:147], v133 offset:0
  ds_read_b128 v[148:151], v132 offset:2048
  ds_read_b128 v[152:155], v133 offset:2048
  ds_read_b64_tr_b16 a[40:41], v116 offset:0
  ds_read_b64_tr_b16 a[42:43], v116 offset:6144
  ds_read_b64_tr_b16 a[64:65], v116 offset:12288
  ds_read_b64_tr_b16 a[66:67], v116 offset:18432
  ds_read_b128 a[4:7], v112 offset:0
  ds_read_b128 a[24:27], v113 offset:0
  ds_read_b128 a[8:11], v112 offset:2048
  ds_read_b128 a[28:31], v113 offset:2048
  ds_read_b128 a[12:15], v112 offset:4096
  ds_read_b128 a[32:35], v113 offset:4096
  ds_read_b128 a[16:19], v112 offset:6144
  ds_read_b128 a[36:39], v113 offset:6144
  ds_read_b64_tr_b16 a[44:45], v117 offset:0
  ds_read_b64_tr_b16 a[46:47], v117 offset:6144
  ds_read_b64_tr_b16 a[68:69], v117 offset:12288
  ds_read_b64_tr_b16 a[70:71], v117 offset:18432
  ds_read_b128 a[0:3], v114 offset:0
  ds_read_b128 a[20:23], v115 offset:0
  ds_read_b64_tr_b16 a[48:49], v116 offset:2048
  ds_read_b64_tr_b16 a[50:51], v116 offset:8192
  ds_read_b64_tr_b16 a[72:73], v116 offset:14336
  ds_read_b64_tr_b16 a[74:75], v116 offset:20480
  ds_read_b64_tr_b16 a[52:53], v117 offset:2048
  ds_read_b64_tr_b16 a[54:55], v117 offset:8192
  ds_read_b64_tr_b16 a[76:77], v117 offset:14336
  ds_read_b64_tr_b16 a[78:79], v117 offset:20480
  ds_read_b64_tr_b16 a[56:57], v116 offset:4096
  ds_read_b64_tr_b16 a[58:59], v116 offset:10240
  ds_read_b64_tr_b16 a[80:81], v116 offset:16384
  ds_read_b64_tr_b16 a[82:83], v116 offset:22528
  ds_read_b64_tr_b16 a[60:61], v117 offset:4096
  ds_read_b64_tr_b16 a[62:63], v117 offset:10240
  ds_read_b64_tr_b16 a[84:85], v117 offset:16384
  ds_read_b64_tr_b16 a[86:87], v117 offset:22528
  s_add_u32 s44, s67, 1
  s_and_b32 s44, s44, 15
  s_mul_i32 s45, s44, 393216
  s_add_u32 s69, s45, s60
  s_add_u32 s70, s69, 4096
  s_add_u32 m0, s63, 24576
  s_nop 0
  buffer_load_dwordx4 v124, s[8:11], s69 offen offset:0  lds
  buffer_load_dwordx4 v125, s[8:11], s69 offen offset:1024  lds
  buffer_load_dwordx4 v124, s[8:11], s69 offen offset:2048  lds
  buffer_load_dwordx4 v125, s[8:11], s69 offen offset:3072  lds
  s_add_u32 m0, s63, 28672
  s_nop 0
  buffer_load_dwordx4 v124, s[8:11], s70 offen offset:0  lds
  buffer_load_dwordx4 v125, s[8:11], s70 offen offset:1024  lds
  s_waitcnt lgkmcnt(0)
  v_mfma_f32_16x16x32_bf16 v[160:163], a[40:43], v[156:159], 0
  v_mfma_f32_16x16x32_bf16 v[164:167], a[48:51], v[156:159], 0
  v_mfma_f32_16x16x32_bf16 v[168:171], a[56:59], v[156:159], 0
  v_mfma_f32_16x16x32_bf16 v[160:163], a[64:67], v[156:159], v[160:163]
  v_mfma_f32_16x16x32_bf16 v[164:167], a[72:75], v[156:159], v[164:167]
  v_mfma_f32_16x16x32_bf16 v[168:171], a[80:83], v[156:159], v[168:171]
  v_mov_b32 v192, 0x3f803f80
  v_mov_b32 v193, 0x3f803f80
  v_mov_b32 v194, 0x3f803f80
  v_mov_b32 v195, 0x3f803f80
  v_and_b32 v212, 15, v253
  v_lshrrev_b32 v213, 4, v253
  v_mfma_f32_16x16x32_bf16 v[196:199], v[192:195], v[140:143], 0
  v_mfma_f32_16x16x32_bf16 v[200:203], v[140:143], v[140:143], 0
  v_mfma_f32_16x16x32_bf16 v[204:207], v[192:195], v[148:151], 0
  v_mfma_f32_16x16x32_bf16 v[208:211], v[148:151], v[148:151], 0
  v_mfma_f32_16x16x32_bf16 v[196:199], v[192:195], v[144:147], v[196:199]
  v_mfma_f32_16x16x32_bf16 v[200:203], v[144:147], v[144:147], v[200:203]
  v_mfma_f32_16x16x32_bf16 v[204:207], v[192:195], v[152:155], v[204:207]
  v_mfma_f32_16x16x32_bf16 v[208:211], v[152:155], v[152:155], v[208:211]
  v_lshrrev_b32 v192, 2, v212
  v_cmp_eq_u32 s[80:81], v192, v213
  v_and_b32 v192, 3, v212
  v_cmp_eq_u32 s[82:83], 1, v192
  v_cmp_eq_u32 s[92:93], 2, v192
  v_cmp_eq_u32 s[46:47], 3, v192
  v_lshlrev_b32 v212, 3, v212
  v_mov_b32 v213, 0x7ffffff0
  s_nop 0
  v_cndmask_b32 v212, v213, v212, s[80:81]
  v_cndmask_b32 v197, v200, v201, s[82:83]
  v_cndmask_b32 v197, v197, v202, s[92:93]
  v_cndmask_b32 v197, v197, v203, s[46:47]
  buffer_store_dwordx2 v[196:197], v212, s[4:7], s48 offen offset:0 sc1
  v_cndmask_b32 v205, v208, v209, s[82:83]
  v_cndmask_b32 v205, v205, v210, s[92:93]
  v_cndmask_b32 v205, v205, v211, s[46:47]
  buffer_store_dwordx2 v[204:205], v212, s[4:7], s48 offen offset:2048 sc1
  buffer_store_dwordx4 v[160:163], v136, s[4:7], s49 offen sc1
  s_add_u32 s49, s49, 4096
  buffer_store_dwordx4 v[164:167], v136, s[4:7], s49 offen sc1
  s_add_u32 s49, s49, 4096
  buffer_store_dwordx4 v[168:171], v136, s[4:7], s49 offen sc1
  s_add_u32 s49, s49, 4096
  s_add_u32 s44, s67, s40
  s_add_u32 s44, s44, 4
  s_and_b32 s44, s44, 15
  s_mul_i32 s44, s44, s61
  s_lshl_b32 s45, s40, 10
  s_add_u32 m0, s45, 126976
  s_add_u32 s44, s44, s73
  buffer_load_dwordx4 v126, s[28:31], s44 offen sc1 lds
  s_add_u32 s44, s67, s40
  s_add_u32 s44, s44, 8
  s_and_b32 s44, s44, 15
  s_mul_i32 s44, s44, s61
  s_lshl_b32 s45, s40, 10
  s_add_u32 m0, s45, 131072
  s_add_u32 s44, s44, s73
  buffer_load_dwordx4 v126, s[28:31], s44 offen sc1 lds
  s_add_u32 s44, s67, s40
  s_add_u32 s44, s44, 12
  s_and_b32 s44, s44, 15
  s_mul_i32 s44, s44, s61
  s_lshl_b32 s45, s40, 10
  s_add_u32 m0, s45, 135168
  s_add_u32 s44, s44, s73
  buffer_load_dwordx4 v126, s[28:31], s44 offen sc1 lds
  s_add_u32 s44, s67, 2
  s_and_b32 s44, s44, 15
  s_mul_i32 s45, s44, 393216
  s_add_u32 s69, s45, s60
  s_add_u32 s70, s69, 4096
  s_add_u32 m0, s63, 49152
  s_nop 0
  buffer_load_dwordx4 v124, s[8:11], s69 offen offset:0  lds
  buffer_load_dwordx4 v125, s[8:11], s69 offen offset:1024  lds
  buffer_load_dwordx4 v124, s[8:11], s69 offen offset:2048  lds
  buffer_load_dwordx4 v125, s[8:11], s69 offen offset:3072  lds
  s_add_u32 m0, s63, 53248
  s_nop 0
  buffer_load_dwordx4 v124, s[8:11], s70 offen offset:0  lds
  buffer_load_dwordx4 v125, s[8:11], s70 offen offset:1024  lds
  s_add_u32 s44, s67, 2
  s_and_b32 s44, s44, 15
  s_mul_i32 s45, s44, s61
  s_add_u32 s68, s45, s59
  s_add_u32 m0, s62, 106496
  s_nop 0
  buffer_load_dwordx4 v120, s[28:31], s68 offen offset:0 sc1  lds
  buffer_load_dwordx4 v121, s[28:31], s68 offen offset:1024 sc1  lds
  buffer_load_dwordx4 v122, s[28:31], s68 offen offset:2048 sc1  lds
  buffer_load_dwordx4 v123, s[28:31], s68 offen offset:3072 sc1  lds
  s_branch Lp1_common
Llayer:
  s_cmp_lg_u32 s40, 0
  s_cbranch_scc1 Lpdn2
  s_mov_b32 s43, 0x40000
  s_mov_b64 exec, 3
Lpol1:
  buffer_load_dword v250, v249, s[4:7], s77 offen sc1
  s_waitcnt vmcnt(0)
  v_cmp_gt_u32 vcc, 16, v250
  s_cbranch_vccz Lpdn2
  s_sub_u32 s43, s43, 1
  s_cmp_lg_u32 s43, 0
  s_cbranch_scc1 Lpol1
Lpdn2:
  s_mov_b64 exec, -1
  s_waitcnt vmcnt(0) lgkmcnt(0)
  s_barrier
  s_add_u32 s44, s67, 0
  s_and_b32 s44, s44, 15
  s_mul_i32 s45, s44, s61
  s_add_u32 s68, s45, s59
  s_add_u32 m0, s62, 73728
  s_nop 0
  buffer_load_dwordx4 v120, s[28:31], s68 offen offset:0 sc1  lds
  buffer_load_dwordx4 v121, s[28:31], s68 offen offset:1024 sc1  lds
  buffer_load_dwordx4 v122, s[28:31], s68 offen offset:2048 sc1  lds
  buffer_load_dwordx4 v123, s[28:31], s68 offen offset:3072 sc1  lds
  s_add_u32 s44, s67, s40
  s_add_u32 s44, s44, 0
  s_and_b32 s44, s44, 15
  s_mul_i32 s44, s44, s61
  s_lshl_b32 s45, s40, 10
  s_add_u32 m0, s45, 122880
  s_add_u32 s44, s44, s73
  buffer_load_dwordx4 v126, s[28:31], s44 offen sc1 lds
  s_add_u32 s44, s67, 1
  s_and_b32 s44, s44, 15
  s_mul_i32 s45, s44, s61
  s_add_u32 s68, s45, s59
  s_add_u32 m0, s62, 90112
  s_nop 0
  buffer_load_dwordx4 v120, s[28:31], s68 offen offset:0 sc1  lds
  buffer_load_dwordx4 v121, s[28:31], s68 offen offset:1024 sc1  lds
  buffer_load_dwordx4 v122, s[28:31], s68 offen offset:2048 sc1  lds
  buffer_load_dwordx4 v123, s[28:31], s68 offen offset:3072 sc1  lds
  ds_read_b64_tr_b16 a[40:41], v116 offset:0
  ds_read_b64_tr_b16 a[42:43], v116 offset:6144
  ds_read_b64_tr_b16 a[64:65], v116 offset:12288
  ds_read_b64_tr_b16 a[66:67], v116 offset:18432
  ds_read_b64_tr_b16 a[44:45], v117 offset:0
  ds_read_b64_tr_b16 a[46:47], v117 offset:6144
  ds_read_b64_tr_b16 a[68:69], v117 offset:12288
  ds_read_b64_tr_b16 a[70:71], v117 offset:18432
  ds_read_b64_tr_b16 a[48:49], v116 offset:2048
  ds_read_b64_tr_b16 a[50:51], v116 offset:8192
  ds_read_b64_tr_b16 a[72:73], v116 offset:14336
  ds_read_b64_tr_b16 a[74:75], v116 offset:20480
  ds_read_b64_tr_b16 a[52:53], v117 offset:2048
  ds_read_b64_tr_b16 a[54:55], v117 offset:8192
  ds_read_b64_tr_b16 a[76:77], v117 offset:14336
  ds_read_b64_tr_b16 a[78:79], v117 offset:20480
  ds_read_b64_tr_b16 a[56:57], v116 offset:4096
  ds_read_b64_tr_b16 a[58:59], v116 offset:10240
  ds_read_b64_tr_b16 a[80:81], v116 offset:16384
  ds_read_b64_tr_b16 a[82:83], v116 offset:22528
  ds_read_b64_tr_b16 a[60:61], v117 offset:4096
  ds_read_b64_tr_b16 a[62:63], v117 offset:10240
  ds_read_b64_tr_b16 a[84:85], v117 offset:16384
  ds_read_b64_tr_b16 a[86:87], v117 offset:22528
  s_waitcnt vmcnt(4)
  s_barrier
  ds_read_b128 a[4:7], v112 offset:0
  ds_read_b128 a[24:27], v113 offset:0
  ds_read_b128 a[8:11], v112 offset:2048
  ds_read_b128 a[28:31], v113 offset:2048
  ds_read_b128 a[12:15], v112 offset:4096
  ds_read_b128 a[32:35], v113 offset:4096
  ds_read_b128 a[16:19], v112 offset:6144
  ds_read_b128 a[36:39], v113 offset:6144
  ds_read_b128 a[0:3], v114 offset:0
  ds_read_b128 a[20:23], v115 offset:0
  s_add_u32 s44, s67, s40
  s_add_u32 s44, s44, 4
  s_and_b32 s44, s44, 15
  s_mul_i32 s44, s44, s61
  s_lshl_b32 s45, s40, 10
  s_add_u32 m0, s45, 126976
  s_add_u32 s44, s44, s73
  buffer_load_dwordx4 v126, s[28:31], s44 offen sc1 lds
  s_add_u32 s44, s67, s40
  s_add_u32 s44, s44, 8
  s_and_b32 s44, s44, 15
  s_mul_i32 s44, s44, s61
  s_lshl_b32 s45, s40, 10
  s_add_u32 m0, s45, 131072
  s_add_u32 s44, s44, s73
  buffer_load_dwordx4 v126, s[28:31], s44 offen sc1 lds
  s_add_u32 s44, s67, s40
  s_add_u32 s44, s44, 12
  s_and_b32 s44, s44, 15
  s_mul_i32 s44, s44, s61
  s_lshl_b32 s45, s40, 10
  s_add_u32 m0, s45, 135168
  s_add_u32 s44, s44, s73
  buffer_load_dwordx4 v126, s[28:31], s44 offen sc1 lds
  s_add_u32 s44, s67, 2
  s_and_b32 s44, s44, 15
  s_mul_i32 s45, s44, s61
  s_add_u32 s68, s45, s59
  s_add_u32 m0, s62, 106496
  s_nop 0
  buffer_load_dwordx4 v120, s[28:31], s68 offen offset:0 sc1  lds
  buffer_load_dwordx4 v121, s[28:31], s68 offen offset:1024 sc1  lds
  buffer_load_dwordx4 v122, s[28:31], s68 offen offset:2048 sc1  lds
  buffer_load_dwordx4 v123, s[28:31], s68 offen offset:3072 sc1  lds
  s_waitcnt lgkmcnt(0)
Lp1_common:
  s_mov_b32 s66, 4
  s_add_u32 s44, s67, 3
  s_and_b32 s44, s44, 15
  s_mul_i32 s45, s44, s61
  s_add_u32 s68, s45, s59
  s_mov_b32 s56, 2
.p2align 3
Lp1_loop:
  s_waitcnt lgkmcnt(15)
  v_mfma_f32_16x16x32_bf16 v[0:3], a[40:43], a[4:7], v[0:3]
  s_mul_i32 s45, s44, 393216
  v_mfma_f32_16x16x32_bf16 v[0:3], a[64:67], a[24:27], v[0:3]
  s_add_u32 s69, s45, s60
  v_mfma_f32_16x16x32_bf16 v[4:7], a[64:67], a[28:31], v[4:7]
  s_add_u32 s70, s69, 4096
  v_mfma_f32_16x16x32_bf16 v[4:7], a[40:43], a[8:11], v[4:7]
  v_mfma_f32_16x16x32_bf16 v[8:11], a[40:43], a[12:15], v[8:11]
  v_mfma_f32_16x16x32_bf16 v[8:11], a[64:67], a[32:35], v[8:11]
  v_mfma_f32_16x16x32_bf16 v[12:15], a[64:67], a[36:39], v[12:15]
  v_mfma_f32_16x16x32_bf16 v[12:15], a[40:43], a[16:19], v[12:15]
  v_mfma_f32_16x16x32_bf16 v[28:31], a[44:47], a[16:19], v[28:31]
  v_mfma_f32_16x16x32_bf16 v[28:31], a[68:71], a[36:39], v[28:31]
  v_mfma_f32_16x16x32_bf16 v[24:27], a[68:71], a[32:35], v[24:27]
  s_waitcnt vmcnt(7) lgkmcnt(0)
  s_barrier
  ds_read_b64_tr_b16 a[128:129], v116 offset:24576
  v_mfma_f32_16x16x32_bf16 v[24:27], a[44:47], a[12:15], v[24:27]
  s_add_u32 m0, s62, 73728
  ds_read_b64_tr_b16 a[130:131], v116 offset:30720
  v_mfma_f32_16x16x32_bf16 v[20:23], a[44:47], a[8:11], v[20:23]
  ds_read_b64_tr_b16 a[152:153], v116 offset:36864
  buffer_load_dwordx4 v120, s[28:31], s68 offen offset:0 sc1  lds
  v_mfma_f32_16x16x32_bf16 v[20:23], a[68:71], a[28:31], v[20:23]
  ds_read_b64_tr_b16 a[154:155], v116 offset:43008
  v_mfma_f32_16x16x32_bf16 v[16:19], a[68:71], a[24:27], v[16:19]
  ds_read_b128 a[92:95], v112 offset:16384
  v_mfma_f32_16x16x32_bf16 v[16:19], a[44:47], a[4:7], v[16:19]
  ds_read_b128 a[112:115], v113 offset:16384
  v_mfma_f32_16x16x32_bf16 v[96:99], a[48:51], a[0:3], v[96:99]
  ds_read_b128 a[96:99], v112 offset:18432
  buffer_load_dwordx4 v121, s[28:31], s68 offen offset:1024 sc1  lds
  v_mfma_f32_16x16x32_bf16 v[96:99], a[72:75], a[20:23], v[96:99]
  ds_read_b128 a[116:119], v113 offset:18432
  v_mfma_f32_16x16x32_bf16 v[32:35], a[72:75], a[24:27], v[32:35]
  ds_read_b128 a[100:103], v112 offset:20480
  v_mfma_f32_16x16x32_bf16 v[32:35], a[48:51], a[4:7], v[32:35]
  ds_read_b128 a[120:123], v113 offset:20480
  v_mfma_f32_16x16x32_bf16 v[36:39], a[48:51], a[8:11], v[36:39]
  ds_read_b128 a[104:107], v112 offset:22528
  buffer_load_dwordx4 v122, s[28:31], s68 offen offset:2048 sc1  lds
  v_mfma_f32_16x16x32_bf16 v[36:39], a[72:75], a[28:31], v[36:39]
  ds_read_b128 a[124:127], v113 offset:22528
  v_mfma_f32_16x16x32_bf16 v[40:43], a[72:75], a[32:35], v[40:43]
  ds_read_b64_tr_b16 a[132:133], v117 offset:24576
  v_mfma_f32_16x16x32_bf16 v[40:43], a[48:51], a[12:15], v[40:43]
  ds_read_b64_tr_b16 a[134:135], v117 offset:30720
  v_mfma_f32_16x16x32_bf16 v[44:47], a[48:51], a[16:19], v[44:47]
  ds_read_b64_tr_b16 a[156:157], v117 offset:36864
  buffer_load_dwordx4 v123, s[28:31], s68 offen offset:3072 sc1  lds
  v_mfma_f32_16x16x32_bf16 v[44:47], a[72:75], a[36:39], v[44:47]
  ds_read_b64_tr_b16 a[158:159], v117 offset:43008
  v_mfma_f32_16x16x32_bf16 v[60:63], a[76:79], a[36:39], v[60:63]
  ds_read_b128 a[88:91], v114 offset:1024
  v_mfma_f32_16x16x32_bf16 v[60:63], a[52:55], a[16:19], v[60:63]
  s_add_u32 m0, s63, 0
  ds_read_b128 a[108:111], v115 offset:1024
  v_mfma_f32_16x16x32_bf16 v[56:59], a[52:55], a[12:15], v[56:59]
  ds_read_b64_tr_b16 a[136:137], v116 offset:26624
  buffer_load_dwordx4 v124, s[8:11], s69 offen offset:0  lds
  v_mfma_f32_16x16x32_bf16 v[56:59], a[76:79], a[32:35], v[56:59]
  ds_read_b64_tr_b16 a[138:139], v116 offset:32768
  v_mfma_f32_16x16x32_bf16 v[52:55], a[76:79], a[28:31], v[52:55]
  s_add_u32 s44, s44, 1
  ds_read_b64_tr_b16 a[160:161], v116 offset:38912
  v_mfma_f32_16x16x32_bf16 v[52:55], a[52:55], a[8:11], v[52:55]
  s_and_b32 s44, s44, 15
  ds_read_b64_tr_b16 a[162:163], v116 offset:45056
  v_mfma_f32_16x16x32_bf16 v[48:51], a[52:55], a[4:7], v[48:51]
  s_add_u32 s66, s66, 1
  ds_read_b64_tr_b16 a[140:141], v117 offset:26624
  buffer_load_dwordx4 v125, s[8:11], s69 offen offset:1024  lds
  v_mfma_f32_16x16x32_bf16 v[48:51], a[76:79], a[24:27], v[48:51]
  s_mul_i32 s45, s44, s61
  ds_read_b64_tr_b16 a[142:143], v117 offset:32768
  v_mfma_f32_16x16x32_bf16 v[100:103], a[20:23], a[80:83], v[100:103]
  s_add_u32 s68, s45, s59
  ds_read_b64_tr_b16 a[164:165], v117 offset:38912
  v_mfma_f32_16x16x32_bf16 v[100:103], a[0:3], a[56:59], v[100:103]
  ds_read_b64_tr_b16 a[166:167], v117 offset:45056
  v_mfma_f32_16x16x32_bf16 v[64:67], a[4:7], a[56:59], v[64:67]
  ds_read_b64_tr_b16 a[144:145], v116 offset:28672
  buffer_load_dwordx4 v124, s[8:11], s69 offen offset:2048  lds
  v_mfma_f32_16x16x32_bf16 v[64:67], a[24:27], a[80:83], v[64:67]
  ds_read_b64_tr_b16 a[146:147], v116 offset:34816
  v_mfma_f32_16x16x32_bf16 v[68:71], a[28:31], a[80:83], v[68:71]
  ds_read_b64_tr_b16 a[168:169], v116 offset:40960
  v_mfma_f32_16x16x32_bf16 v[68:71], a[8:11], a[56:59], v[68:71]
  ds_read_b64_tr_b16 a[170:171], v116 offset:47104
  v_mfma_f32_16x16x32_bf16 v[72:75], a[12:15], a[56:59], v[72:75]
  ds_read_b64_tr_b16 a[148:149], v117 offset:28672
  buffer_load_dwordx4 v125, s[8:11], s69 offen offset:3072  lds
  v_mfma_f32_16x16x32_bf16 v[72:75], a[32:35], a[80:83], v[72:75]
  ds_read_b64_tr_b16 a[150:151], v117 offset:34816
  v_mfma_f32_16x16x32_bf16 v[76:79], a[36:39], a[80:83], v[76:79]
  ds_read_b64_tr_b16 a[172:173], v117 offset:40960
  v_mfma_f32_16x16x32_bf16 v[76:79], a[16:19], a[56:59], v[76:79]
  s_add_u32 m0, s63, 4096
  ds_read_b64_tr_b16 a[174:175], v117 offset:47104
  v_mfma_f32_16x16x32_bf16 v[92:95], a[16:19], a[60:63], v[92:95]
  buffer_load_dwordx4 v124, s[8:11], s70 offen offset:0  lds
  v_mfma_f32_16x16x32_bf16 v[92:95], a[36:39], a[84:87], v[92:95]
  v_mfma_f32_16x16x32_bf16 v[88:91], a[32:35], a[84:87], v[88:91]
  v_mfma_f32_16x16x32_bf16 v[88:91], a[12:15], a[60:63], v[88:91]
  v_mfma_f32_16x16x32_bf16 v[84:87], a[8:11], a[60:63], v[84:87]
  buffer_load_dwordx4 v125, s[8:11], s70 offen offset:1024  lds
  v_mfma_f32_16x16x32_bf16 v[84:87], a[28:31], a[84:87], v[84:87]
  v_mfma_f32_16x16x32_bf16 v[80:83], a[24:27], a[84:87], v[80:83]
  v_mfma_f32_16x16x32_bf16 v[80:83], a[4:7], a[60:63], v[80:83]
  s_cmp_eq_u32 s66, s88
  s_cbranch_scc0 Lside_skip0
  s_call_b64 s[78:79], Lside_sub
Lside_skip0:
  s_waitcnt lgkmcnt(15)
  v_mfma_f32_16x16x32_bf16 v[0:3], a[128:131], a[92:95], v[0:3]
  s_mul_i32 s45, s44, 393216
  v_mfma_f32_16x16x32_bf16 v[0:3], a[152:155], a[112:115], v[0:3]
  s_add_u32 s69, s45, s60
  v_mfma_f32_16x16x32_bf16 v[4:7], a[152:155], a[116:119], v[4:7]
  s_add_u32 s70, s69, 4096
  v_mfma_f32_16x16x32_bf16 v[4:7], a[128:131], a[96:99], v[4:7]
  v_mfma_f32_16x16x32_bf16 v[8:11], a[128:131], a[100:103], v[8:11]
  v_mfma_f32_16x16x32_bf16 v[8:11], a[152:155], a[120:123], v[8:11]
  v_mfma_f32_16x16x32_bf16 v[12:15], a[152:155], a[124:127], v[12:15]
  v_mfma_f32_16x16x32_bf16 v[12:15], a[128:131], a[104:107], v[12:15]
  v_mfma_f32_16x16x32_bf16 v[28:31], a[132:135], a[104:107], v[28:31]
  v_mfma_f32_16x16x32_bf16 v[28:31], a[156:159], a[124:127], v[28:31]
  v_mfma_f32_16x16x32_bf16 v[24:27], a[156:159], a[120:123], v[24:27]
  s_waitcnt vmcnt(10) lgkmcnt(0)
  s_barrier
  ds_read_b64_tr_b16 a[40:41], v118 offset:0
  v_mfma_f32_16x16x32_bf16 v[24:27], a[132:135], a[100:103], v[24:27]
  s_add_u32 m0, s62, 90112
  ds_read_b64_tr_b16 a[42:43], v118 offset:6144
  v_mfma_f32_16x16x32_bf16 v[20:23], a[132:135], a[96:99], v[20:23]
  ds_read_b64_tr_b16 a[64:65], v118 offset:12288
  buffer_load_dwordx4 v120, s[28:31], s68 offen offset:0 sc1  lds
  v_mfma_f32_16x16x32_bf16 v[20:23], a[156:159], a[116:119], v[20:23]
  ds_read_b64_tr_b16 a[66:67], v118 offset:18432
  v_mfma_f32_16x16x32_bf16 v[16:19], a[156:159], a[112:115], v[16:19]
  ds_read_b128 a[4:7], v112 offset:32768
  v_mfma_f32_16x16x32_bf16 v[16:19], a[132:135], a[92:95], v[16:19]
  ds_read_b128 a[24:27], v113 offset:32768
  v_mfma_f32_16x16x32_bf16 v[96:99], a[136:139], a[88:91], v[96:99]
  ds_read_b128 a[8:11], v112 offset:34816
  buffer_load_dwordx4 v121, s[28:31], s68 offen offset:1024 sc1  lds
  v_mfma_f32_16x16x32_bf16 v[96:99], a[160:163], a[108:111], v[96:99]
  ds_read_b128 a[28:31], v113 offset:34816
  v_mfma_f32_16x16x32_bf16 v[32:35], a[160:163], a[112:115], v[32:35]
  ds_read_b128 a[12:15], v112 offset:36864
  v_mfma_f32_16x16x32_bf16 v[32:35], a[136:139], a[92:95], v[32:35]
  ds_read_b128 a[32:35], v113 offset:36864
  v_mfma_f32_16x16x32_bf16 v[36:39], a[136:139], a[96:99], v[36:39]
  ds_read_b128 a[16:19], v112 offset:38912
  buffer_load_dwordx4 v122, s[28:31], s68 offen offset:2048 sc1  lds
  v_mfma_f32_16x16x32_bf16 v[36:39], a[160:163], a[116:119], v[36:39]
  ds_read_b128 a[36:39], v113 offset:38912
  v_mfma_f32_16x16x32_bf16 v[40:43], a[160:163], a[120:123], v[40:43]
  ds_read_b64_tr_b16 a[44:45], v119 offset:0
  v_mfma_f32_16x16x32_bf16 v[40:43], a[136:139], a[100:103], v[40:43]
  ds_read_b64_tr_b16 a[46:47], v119 offset:6144
  v_mfma_f32_16x16x32_bf16 v[44:47], a[136:139], a[104:107], v[44:47]
  ds_read_b64_tr_b16 a[68:69], v119 offset:12288
  buffer_load_dwordx4 v123, s[28:31], s68 offen offset:3072 sc1  lds
  v_mfma_f32_16x16x32_bf16 v[44:47], a[160:163], a[124:127], v[44:47]
  ds_read_b64_tr_b16 a[70:71], v119 offset:18432
  v_mfma_f32_16x16x32_bf16 v[60:63], a[164:167], a[124:127], v[60:63]
  ds_read_b128 a[0:3], v114 offset:2048
  v_mfma_f32_16x16x32_bf16 v[60:63], a[140:143], a[104:107], v[60:63]
  s_add_u32 m0, s63, 24576
  ds_read_b128 a[20:23], v115 offset:2048
  v_mfma_f32_16x16x32_bf16 v[56:59], a[140:143], a[100:103], v[56:59]
  ds_read_b64_tr_b16 a[48:49], v118 offset:2048
  buffer_load_dwordx4 v124, s[8:11], s69 offen offset:0  lds
  v_mfma_f32_16x16x32_bf16 v[56:59], a[164:167], a[120:123], v[56:59]
  ds_read_b64_tr_b16 a[50:51], v118 offset:8192
  v_mfma_f32_16x16x32_bf16 v[52:55], a[164:167], a[116:119], v[52:55]
  s_add_u32 s44, s44, 1
  ds_read_b64_tr_b16 a[72:73], v118 offset:14336
  v_mfma_f32_16x16x32_bf16 v[52:55], a[140:143], a[96:99], v[52:55]
  s_and_b32 s44, s44, 15
  ds_read_b64_tr_b16 a[74:75], v118 offset:20480
  v_mfma_f32_16x16x32_bf16 v[48:51], a[140:143], a[92:95], v[48:51]
  s_add_u32 s66, s66, 1
  ds_read_b64_tr_b16 a[52:53], v119 offset:2048
  buffer_load_dwordx4 v125, s[8:11], s69 offen offset:1024  lds
  v_mfma_f32_16x16x32_bf16 v[48:51], a[164:167], a[112:115], v[48:51]
  s_mul_i32 s45, s44, s61
  ds_read_b64_tr_b16 a[54:55], v119 offset:8192
  v_mfma_f32_16x16x32_bf16 v[100:103], a[108:111], a[168:171], v[100:103]
  s_add_u32 s68, s45, s59
  ds_read_b64_tr_b16 a[76:77], v119 offset:14336
  v_mfma_f32_16x16x32_bf16 v[100:103], a[88:91], a[144:147], v[100:103]
  ds_read_b64_tr_b16 a[78:79], v119 offset:20480
  v_mfma_f32_16x16x32_bf16 v[64:67], a[92:95], a[144:147], v[64:67]
  ds_read_b64_tr_b16 a[56:57], v118 offset:4096
  buffer_load_dwordx4 v124, s[8:11], s69 offen offset:2048  lds
  v_mfma_f32_16x16x32_bf16 v[64:67], a[112:115], a[168:171], v[64:67]
  ds_read_b64_tr_b16 a[58:59], v118 offset:10240
  v_mfma_f32_16x16x32_bf16 v[68:71], a[116:119], a[168:171], v[68:71]
  ds_read_b64_tr_b16 a[80:81], v118 offset:16384
  v_mfma_f32_16x16x32_bf16 v[68:71], a[96:99], a[144:147], v[68:71]
  ds_read_b64_tr_b16 a[82:83], v118 offset:22528
  v_mfma_f32_16x16x32_bf16 v[72:75], a[100:103], a[144:147], v[72:75]
  ds_read_b64_tr_b16 a[60:61], v119 offset:4096
  buffer_load_dwordx4 v125, s[8:11], s69 offen offset:3072  lds
  v_mfma_f32_16x16x32_bf16 v[72:75], a[120:123], a[168:171], v[72:75]
  ds_read_b64_tr_b16 a[62:63], v119 offset:10240
  v_mfma_f32_16x16x32_bf16 v[76:79], a[124:127], a[168:171], v[76:79]
  ds_read_b64_tr_b16 a[84:85], v119 offset:16384
  v_mfma_f32_16x16x32_bf16 v[76:79], a[104:107], a[144:147], v[76:79]
  s_add_u32 m0, s63, 28672
  ds_read_b64_tr_b16 a[86:87], v119 offset:22528
  v_mfma_f32_16x16x32_bf16 v[92:95], a[104:107], a[148:151], v[92:95]
  buffer_load_dwordx4 v124, s[8:11], s70 offen offset:0  lds
  v_mfma_f32_16x16x32_bf16 v[92:95], a[124:127], a[172:175], v[92:95]
  v_mfma_f32_16x16x32_bf16 v[88:91], a[120:123], a[172:175], v[88:91]
  v_mfma_f32_16x16x32_bf16 v[88:91], a[100:103], a[148:151], v[88:91]
  v_mfma_f32_16x16x32_bf16 v[84:87], a[96:99], a[148:151], v[84:87]
  buffer_load_dwordx4 v125, s[8:11], s70 offen offset:1024  lds
  v_mfma_f32_16x16x32_bf16 v[84:87], a[116:119], a[172:175], v[84:87]
  v_mfma_f32_16x16x32_bf16 v[80:83], a[112:115], a[172:175], v[80:83]
  v_mfma_f32_16x16x32_bf16 v[80:83], a[92:95], a[148:151], v[80:83]
  s_cmp_eq_u32 s66, s88
  s_cbranch_scc0 Lside_skip1
  s_call_b64 s[78:79], Lside_sub
Lside_skip1:
  s_waitcnt lgkmcnt(15)
  v_mfma_f32_16x16x32_bf16 v[0:3], a[40:43], a[4:7], v[0:3]
  s_mul_i32 s45, s44, 393216
  v_mfma_f32_16x16x32_bf16 v[0:3], a[64:67], a[24:27], v[0:3]
  s_add_u32 s69, s45, s60
  v_mfma_f32_16x16x32_bf16 v[4:7], a[64:67], a[28:31], v[4:7]
  s_add_u32 s70, s69, 4096
  v_mfma_f32_16x16x32_bf16 v[4:7], a[40:43], a[8:11], v[4:7]
  v_mfma_f32_16x16x32_bf16 v[8:11], a[40:43], a[12:15], v[8:11]
  v_mfma_f32_16x16x32_bf16 v[8:11], a[64:67], a[32:35], v[8:11]
  v_mfma_f32_16x16x32_bf16 v[12:15], a[64:67], a[36:39], v[12:15]
  v_mfma_f32_16x16x32_bf16 v[12:15], a[40:43], a[16:19], v[12:15]
  v_mfma_f32_16x16x32_bf16 v[28:31], a[44:47], a[16:19], v[28:31]
  v_mfma_f32_16x16x32_bf16 v[28:31], a[68:71], a[36:39], v[28:31]
  v_mfma_f32_16x16x32_bf16 v[24:27], a[68:71], a[32:35], v[24:27]
  s_waitcnt vmcnt(10) lgkmcnt(0)
  s_barrier
  ds_read_b64_tr_b16 a[128:129], v116 offset:0
  v_mfma_f32_16x16x32_bf16 v[24:27], a[44:47], a[12:15], v[24:27]
  s_add_u32 m0, s62, 106496
  ds_read_b64_tr_b16 a[130:131], v116 offset:6144
  v_mfma_f32_16x16x32_bf16 v[20:23], a[44:47], a[8:11], v[20:23]
  ds_read_b64_tr_b16 a[152:153], v116 offset:12288
  buffer_load_dwordx4 v120, s[28:31], s68 offen offset:0 sc1  lds
  v_mfma_f32_16x16x32_bf16 v[20:23], a[68:71], a[28:31], v[20:23]
  ds_read_b64_tr_b16 a[154:155], v116 offset:18432
  v_mfma_f32_16x16x32_bf16 v[16:19], a[68:71], a[24:27], v[16:19]
  ds_read_b128 a[92:95], v112 offset:0
  v_mfma_f32_16x16x32_bf16 v[16:19], a[44:47], a[4:7], v[16:19]
  ds_read_b128 a[112:115], v113 offset:0
  v_mfma_f32_16x16x32_bf16 v[96:99], a[48:51], a[0:3], v[96:99]
  ds_read_b128 a[96:99], v112 offset:2048
  buffer_load_dwordx4 v121, s[28:31], s68 offen offset:1024 sc1  lds
  v_mfma_f32_16x16x32_bf16 v[96:99], a[72:75], a[20:23], v[96:99]
  ds_read_b128 a[116:119], v113 offset:2048
  v_mfma_f32_16x16x32_bf16 v[32:35], a[72:75], a[24:27], v[32:35]
  ds_read_b128 a[100:103], v112 offset:4096
  v_mfma_f32_16x16x32_bf16 v[32:35], a[48:51], a[4:7], v[32:35]
  ds_read_b128 a[120:123], v113 offset:4096
  v_mfma_f32_16x16x32_bf16 v[36:39], a[48:51], a[8:11], v[36:39]
  ds_read_b128 a[104:107], v112 offset:6144
  buffer_load_dwordx4 v122, s[28:31], s68 offen offset:2048 sc1  lds
  v_mfma_f32_16x16x32_bf16 v[36:39], a[72:75], a[28:31], v[36:39]
  ds_read_b128 a[124:127], v113 offset:6144
  v_mfma_f32_16x16x32_bf16 v[40:43], a[72:75], a[32:35], v[40:43]
  ds_read_b64_tr_b16 a[132:133], v117 offset:0
  v_mfma_f32_16x16x32_bf16 v[40:43], a[48:51], a[12:15], v[40:43]
  ds_read_b64_tr_b16 a[134:135], v117 offset:6144
  v_mfma_f32_16x16x32_bf16 v[44:47], a[48:51], a[16:19], v[44:47]
  ds_read_b64_tr_b16 a[156:157], v117 offset:12288
  buffer_load_dwordx4 v123, s[28:31], s68 offen offset:3072 sc1  lds
  v_mfma_f32_16x16x32_bf16 v[44:47], a[72:75], a[36:39], v[44:47]
  ds_read_b64_tr_b16 a[158:159], v117 offset:18432
  v_mfma_f32_16x16x32_bf16 v[60:63], a[76:79], a[36:39], v[60:63]
  ds_read_b128 a[88:91], v114 offset:3072
  v_mfma_f32_16x16x32_bf16 v[60:63], a[52:55], a[16:19], v[60:63]
  s_add_u32 m0, s63, 49152
  ds_read_b128 a[108:111], v115 offset:3072
  v_mfma_f32_16x16x32_bf16 v[56:59], a[52:55], a[12:15], v[56:59]
  ds_read_b64_tr_b16 a[136:137], v116 offset:2048
  buffer_load_dwordx4 v124, s[8:11], s69 offen offset:0  lds
  v_mfma_f32_16x16x32_bf16 v[56:59], a[76:79], a[32:35], v[56:59]
  ds_read_b64_tr_b16 a[138:139], v116 offset:8192
  v_mfma_f32_16x16x32_bf16 v[52:55], a[76:79], a[28:31], v[52:55]
  s_add_u32 s44, s44, 1
  ds_read_b64_tr_b16 a[160:161], v116 offset:14336
  v_mfma_f32_16x16x32_bf16 v[52:55], a[52:55], a[8:11], v[52:55]
  s_and_b32 s44, s44, 15
  ds_read_b64_tr_b16 a[162:163], v116 offset:20480
  v_mfma_f32_16x16x32_bf16 v[48:51], a[52:55], a[4:7], v[48:51]
  s_add_u32 s66, s66, 1
  ds_read_b64_tr_b16 a[140:141], v117 offset:2048
  buffer_load_dwordx4 v125, s[8:11], s69 offen offset:1024  lds
  v_mfma_f32_16x16x32_bf16 v[48:51], a[76:79], a[24:27], v[48:51]
  s_mul_i32 s45, s44, s61
  ds_read_b64_tr_b16 a[142:143], v117 offset:8192
  v_mfma_f32_16x16x32_bf16 v[100:103], a[20:23], a[80:83], v[100:103]
  s_add_u32 s68, s45, s59
  ds_read_b64_tr_b16 a[164:165], v117 offset:14336
  v_mfma_f32_16x16x32_bf16 v[100:103], a[0:3], a[56:59], v[100:103]
  ds_read_b64_tr_b16 a[166:167], v117 offset:20480
  v_mfma_f32_16x16x32_bf16 v[64:67], a[4:7], a[56:59], v[64:67]
  ds_read_b64_tr_b16 a[144:145], v116 offset:4096
  buffer_load_dwordx4 v124, s[8:11], s69 offen offset:2048  lds
  v_mfma_f32_16x16x32_bf16 v[64:67], a[24:27], a[80:83], v[64:67]
  ds_read_b64_tr_b16 a[146:147], v116 offset:10240
  v_mfma_f32_16x16x32_bf16 v[68:71], a[28:31], a[80:83], v[68:71]
  ds_read_b64_tr_b16 a[168:169], v116 offset:16384
  v_mfma_f32_16x16x32_bf16 v[68:71], a[8:11], a[56:59], v[68:71]
  ds_read_b64_tr_b16 a[170:171], v116 offset:22528
  v_mfma_f32_16x16x32_bf16 v[72:75], a[12:15], a[56:59], v[72:75]
  ds_read_b64_tr_b16 a[148:149], v117 offset:4096
  buffer_load_dwordx4 v125, s[8:11], s69 offen offset:3072  lds
  v_mfma_f32_16x16x32_bf16 v[72:75], a[32:35], a[80:83], v[72:75]
  ds_read_b64_tr_b16 a[150:151], v117 offset:10240
  v_mfma_f32_16x16x32_bf16 v[76:79], a[36:39], a[80:83], v[76:79]
  ds_read_b64_tr_b16 a[172:173], v117 offset:16384
  v_mfma_f32_16x16x32_bf16 v[76:79], a[16:19], a[56:59], v[76:79]
  s_add_u32 m0, s63, 53248
  ds_read_b64_tr_b16 a[174:175], v117 offset:22528
  v_mfma_f32_16x16x32_bf16 v[92:95], a[16:19], a[60:63], v[92:95]
  buffer_load_dwordx4 v124, s[8:11], s70 offen offset:0  lds
  v_mfma_f32_16x16x32_bf16 v[92:95], a[36:39], a[84:87], v[92:95]
  v_mfma_f32_16x16x32_bf16 v[88:91], a[32:35], a[84:87], v[88:91]
  v_mfma_f32_16x16x32_bf16 v[88:91], a[12:15], a[60:63], v[88:91]
  v_mfma_f32_16x16x32_bf16 v[84:87], a[8:11], a[60:63], v[84:87]
  buffer_load_dwordx4 v125, s[8:11], s70 offen offset:1024  lds
  v_mfma_f32_16x16x32_bf16 v[84:87], a[28:31], a[84:87], v[84:87]
  v_mfma_f32_16x16x32_bf16 v[80:83], a[24:27], a[84:87], v[80:83]
  v_mfma_f32_16x16x32_bf16 v[80:83], a[4:7], a[60:63], v[80:83]
  s_cmp_eq_u32 s66, s88
  s_cbranch_scc0 Lside_skip2
  s_call_b64 s[78:79], Lside_sub
Lside_skip2:
  s_waitcnt lgkmcnt(15)
  v_mfma_f32_16x16x32_bf16 v[0:3], a[128:131], a[92:95], v[0:3]
  s_mul_i32 s45, s44, 393216
  v_mfma_f32_16x16x32_bf16 v[0:3], a[152:155], a[112:115], v[0:3]
  s_add_u32 s69, s45, s60
  v_mfma_f32_16x16x32_bf16 v[4:7], a[152:155], a[116:119], v[4:7]
  s_add_u32 s70, s69, 4096
  v_mfma_f32_16x16x32_bf16 v[4:7], a[128:131], a[96:99], v[4:7]
  v_mfma_f32_16x16x32_bf16 v[8:11], a[128:131], a[100:103], v[8:11]
  v_mfma_f32_16x16x32_bf16 v[8:11], a[152:155], a[120:123], v[8:11]
  v_mfma_f32_16x16x32_bf16 v[12:15], a[152:155], a[124:127], v[12:15]
  v_mfma_f32_16x16x32_bf16 v[12:15], a[128:131], a[104:107], v[12:15]
  v_mfma_f32_16x16x32_bf16 v[28:31], a[132:135], a[104:107], v[28:31]
  v_mfma_f32_16x16x32_bf16 v[28:31], a[156:159], a[124:127], v[28:31]
  v_mfma_f32_16x16x32_bf16 v[24:27], a[156:159], a[120:123], v[24:27]
  s_waitcnt vmcnt(10) lgkmcnt(0)
  s_barrier
  ds_read_b64_tr_b16 a[40:41], v116 offset:24576
  v_mfma_f32_16x16x32_bf16 v[24:27], a[132:135], a[100:103], v[24:27]
  s_add_u32 m0, s62, 73728
  ds_read_b64_tr_b16 a[42:43], v116 offset:30720
  v_mfma_f32_16x16x32_bf16 v[20:23], a[132:135], a[96:99], v[20:23]
  ds_read_b64_tr_b16 a[64:65], v116 offset:36864
  buffer_load_dwordx4 v120, s[28:31], s68 offen offset:0 sc1  lds
  v_mfma_f32_16x16x32_bf16 v[20:23], a[156:159], a[116:119], v[20:23]
  ds_read_b64_tr_b16 a[66:67], v116 offset:43008
  v_mfma_f32_16x16x32_bf16 v[16:19], a[156:159], a[112:115], v[16:19]
  ds_read_b128 a[4:7], v112 offset:16384
  v_mfma_f32_16x16x32_bf16 v[16:19], a[132:135], a[92:95], v[16:19]
  ds_read_b128 a[24:27], v113 offset:16384
  v_mfma_f32_16x16x32_bf16 v[96:99], a[136:139], a[88:91], v[96:99]
  ds_read_b128 a[8:11], v112 offset:18432
  buffer_load_dwordx4 v121, s[28:31], s68 offen offset:1024 sc1  lds
  v_mfma_f32_16x16x32_bf16 v[96:99], a[160:163], a[108:111], v[96:99]
  ds_read_b128 a[28:31], v113 offset:18432
  v_mfma_f32_16x16x32_bf16 v[32:35], a[160:163], a[112:115], v[32:35]
  ds_read_b128 a[12:15], v112 offset:20480
  v_mfma_f32_16x16x32_bf16 v[32:35], a[136:139], a[92:95], v[32:35]
  ds_read_b128 a[32:35], v113 offset:20480
  v_mfma_f32_16x16x32_bf16 v[36:39], a[136:139], a[96:99], v[36:39]
  ds_read_b128 a[16:19], v112 offset:22528
  buffer_load_dwordx4 v122, s[28:31], s68 offen offset:2048 sc1  lds
  v_mfma_f32_16x16x32_bf16 v[36:39], a[160:163], a[116:119], v[36:39]
  ds_read_b128 a[36:39], v113 offset:22528
  v_mfma_f32_16x16x32_bf16 v[40:43], a[160:163], a[120:123], v[40:43]
  ds_read_b64_tr_b16 a[44:45], v117 offset:24576
  v_mfma_f32_16x16x32_bf16 v[40:43], a[136:139], a[100:103], v[40:43]
  ds_read_b64_tr_b16 a[46:47], v117 offset:30720
  v_mfma_f32_16x16x32_bf16 v[44:47], a[136:139], a[104:107], v[44:47]
  ds_read_b64_tr_b16 a[68:69], v117 offset:36864
  buffer_load_dwordx4 v123, s[28:31], s68 offen offset:3072 sc1  lds
  v_mfma_f32_16x16x32_bf16 v[44:47], a[160:163], a[124:127], v[44:47]
  ds_read_b64_tr_b16 a[70:71], v117 offset:43008
  v_mfma_f32_16x16x32_bf16 v[60:63], a[164:167], a[124:127], v[60:63]
  ds_read_b128 a[0:3], v114 offset:4096
  v_mfma_f32_16x16x32_bf16 v[60:63], a[140:143], a[104:107], v[60:63]
  s_add_u32 m0, s63, 0
  ds_read_b128 a[20:23], v115 offset:4096
  v_mfma_f32_16x16x32_bf16 v[56:59], a[140:143], a[100:103], v[56:59]
  ds_read_b64_tr_b16 a[48:49], v116 offset:26624
  buffer_load_dwordx4 v124, s[8:11], s69 offen offset:0  lds
  v_mfma_f32_16x16x32_bf16 v[56:59], a[164:167], a[120:123], v[56:59]
  ds_read_b64_tr_b16 a[50:51], v116 offset:32768
  v_mfma_f32_16x16x32_bf16 v[52:55], a[164:167], a[116:119], v[52:55]
  s_add_u32 s44, s44, 1
  ds_read_b64_tr_b16 a[72:73], v116 offset:38912
  v_mfma_f32_16x16x32_bf16 v[52:55], a[140:143], a[96:99], v[52:55]
  s_and_b32 s44, s44, 15
  ds_read_b64_tr_b16 a[74:75], v116 offset:45056
  v_mfma_f32_16x16x32_bf16 v[48:51], a[140:143], a[92:95], v[48:51]
  s_add_u32 s66, s66, 1
  ds_read_b64_tr_b16 a[52:53], v117 offset:26624
  buffer_load_dwordx4 v125, s[8:11], s69 offen offset:1024  lds
  v_mfma_f32_16x16x32_bf16 v[48:51], a[164:167], a[112:115], v[48:51]
  s_mul_i32 s45, s44, s61
  ds_read_b64_tr_b16 a[54:55], v117 offset:32768
  v_mfma_f32_16x16x32_bf16 v[100:103], a[108:111], a[168:171], v[100:103]
  s_add_u32 s68, s45, s59
  ds_read_b64_tr_b16 a[76:77], v117 offset:38912
  v_mfma_f32_16x16x32_bf16 v[100:103], a[88:91], a[144:147], v[100:103]
  ds_read_b64_tr_b16 a[78:79], v117 offset:45056
  v_mfma_f32_16x16x32_bf16 v[64:67], a[92:95], a[144:147], v[64:67]
  ds_read_b64_tr_b16 a[56:57], v116 offset:28672
  buffer_load_dwordx4 v124, s[8:11], s69 offen offset:2048  lds
  v_mfma_f32_16x16x32_bf16 v[64:67], a[112:115], a[168:171], v[64:67]
  ds_read_b64_tr_b16 a[58:59], v116 offset:34816
  v_mfma_f32_16x16x32_bf16 v[68:71], a[116:119], a[168:171], v[68:71]
  ds_read_b64_tr_b16 a[80:81], v116 offset:40960
  v_mfma_f32_16x16x32_bf16 v[68:71], a[96:99], a[144:147], v[68:71]
  ds_read_b64_tr_b16 a[82:83], v116 offset:47104
  v_mfma_f32_16x16x32_bf16 v[72:75], a[100:103], a[144:147], v[72:75]
  ds_read_b64_tr_b16 a[60:61], v117 offset:28672
  buffer_load_dwordx4 v125, s[8:11], s69 offen offset:3072  lds
  v_mfma_f32_16x16x32_bf16 v[72:75], a[120:123], a[168:171], v[72:75]
  ds_read_b64_tr_b16 a[62:63], v117 offset:34816
  v_mfma_f32_16x16x32_bf16 v[76:79], a[124:127], a[168:171], v[76:79]
  ds_read_b64_tr_b16 a[84:85], v117 offset:40960
  v_mfma_f32_16x16x32_bf16 v[76:79], a[104:107], a[144:147], v[76:79]
  s_add_u32 m0, s63, 4096
  ds_read_b64_tr_b16 a[86:87], v117 offset:47104
  v_mfma_f32_16x16x32_bf16 v[92:95], a[104:107], a[148:151], v[92:95]
  buffer_load_dwordx4 v124, s[8:11], s70 offen offset:0  lds
  v_mfma_f32_16x16x32_bf16 v[92:95], a[124:127], a[172:175], v[92:95]
  v_mfma_f32_16x16x32_bf16 v[88:91], a[120:123], a[172:175], v[88:91]
  v_mfma_f32_16x16x32_bf16 v[88:91], a[100:103], a[148:151], v[88:91]
  v_mfma_f32_16x16x32_bf16 v[84:87], a[96:99], a[148:151], v[84:87]
  buffer_load_dwordx4 v125, s[8:11], s70 offen offset:1024  lds
  v_mfma_f32_16x16x32_bf16 v[84:87], a[116:119], a[172:175], v[84:87]
  v_mfma_f32_16x16x32_bf16 v[80:83], a[112:115], a[172:175], v[80:83]
  v_mfma_f32_16x16x32_bf16 v[80:83], a[92:95], a[148:151], v[80:83]
  s_cmp_eq_u32 s66, s88
  s_cbranch_scc0 Lside_skip3
  s_call_b64 s[78:79], Lside_sub
Lside_skip3:
  s_waitcnt lgkmcnt(15)
  v_mfma_f32_16x16x32_bf16 v[0:3], a[40:43], a[4:7], v[0:3]
  s_mul_i32 s45, s44, 393216
  v_mfma_f32_16x16x32_bf16 v[0:3], a[64:67], a[24:27], v[0:3]
  s_add_u32 s69, s45, s60
  v_mfma_f32_16x16x32_bf16 v[4:7], a[64:67], a[28:31], v[4:7]
  s_add_u32 s70, s69, 4096
  v_mfma_f32_16x16x32_bf16 v[4:7], a[40:43], a[8:11], v[4:7]
  v_mfma_f32_16x16x32_bf16 v[8:11], a[40:43], a[12:15], v[8:11]
  v_mfma_f32_16x16x32_bf16 v[8:11], a[64:67], a[32:35], v[8:11]
  v_mfma_f32_16x16x32_bf16 v[12:15], a[64:67], a[36:39], v[12:15]
  v_mfma_f32_16x16x32_bf16 v[12:15], a[40:43], a[16:19], v[12:15]
  v_mfma_f32_16x16x32_bf16 v[28:31], a[44:47], a[16:19], v[28:31]
  v_mfma_f32_16x16x32_bf16 v[28:31], a[68:71], a[36:39], v[28:31]
  v_mfma_f32_16x16x32_bf16 v[24:27], a[68:71], a[32:35], v[24:27]
  s_waitcnt vmcnt(10) lgkmcnt(0)
  s_barrier
  ds_read_b64_tr_b16 a[128:129], v118 offset:0
  v_mfma_f32_16x16x32_bf16 v[24:27], a[44:47], a[12:15], v[24:27]
  s_add_u32 m0, s62, 90112
  ds_read_b64_tr_b16 a[130:131], v118 offset:6144
  v_mfma_f32_16x16x32_bf16 v[20:23], a[44:47], a[8:11], v[20:23]
  ds_read_b64_tr_b16 a[152:153], v118 offset:12288
  buffer_load_dwordx4 v120, s[28:31], s68 offen offset:0 sc1  lds
  v_mfma_f32_16x16x32_bf16 v[20:23], a[68:71], a[28:31], v[20:23]
  ds_read_b64_tr_b16 a[154:155], v118 offset:18432
  v_mfma_f32_16x16x32_bf16 v[16:19], a[68:71], a[24:27], v[16:19]
  ds_read_b128 a[92:95], v112 offset:32768
  v_mfma_f32_16x16x32_bf16 v[16:19], a[44:47], a[4:7], v[16:19]
  ds_read_b128 a[112:115], v113 offset:32768
  v_mfma_f32_16x16x32_bf16 v[96:99], a[48:51], a[0:3], v[96:99]
  ds_read_b128 a[96:99], v112 offset:34816
  buffer_load_dwordx4 v121, s[28:31], s68 offen offset:1024 sc1  lds
  v_mfma_f32_16x16x32_bf16 v[96:99], a[72:75], a[20:23], v[96:99]
  ds_read_b128 a[116:119], v113 offset:34816
  v_mfma_f32_16x16x32_bf16 v[32:35], a[72:75], a[24:27], v[32:35]
  ds_read_b128 a[100:103], v112 offset:36864
  v_mfma_f32_16x16x32_bf16 v[32:35], a[48:51], a[4:7], v[32:35]
  ds_read_b128 a[120:123], v113 offset:36864
  v_mfma_f32_16x16x32_bf16 v[36:39], a[48:51], a[8:11], v[36:39]
  ds_read_b128 a[104:107], v112 offset:38912
  buffer_load_dwordx4 v122, s[28:31], s68 offen offset:2048 sc1  lds
  v_mfma_f32_16x16x32_bf16 v[36:39], a[72:75], a[28:31], v[36:39]
  ds_read_b128 a[124:127], v113 offset:38912
  v_mfma_f32_16x16x32_bf16 v[40:43], a[72:75], a[32:35], v[40:43]
  ds_read_b64_tr_b16 a[132:133], v119 offset:0
  v_mfma_f32_16x16x32_bf16 v[40:43], a[48:51], a[12:15], v[40:43]
  ds_read_b64_tr_b16 a[134:135], v119 offset:6144
  v_mfma_f32_16x16x32_bf16 v[44:47], a[48:51], a[16:19], v[44:47]
  ds_read_b64_tr_b16 a[156:157], v119 offset:12288
  buffer_load_dwordx4 v123, s[28:31], s68 offen offset:3072 sc1  lds
  v_mfma_f32_16x16x32_bf16 v[44:47], a[72:75], a[36:39], v[44:47]
  ds_read_b64_tr_b16 a[158:159], v119 offset:18432
  v_mfma_f32_16x16x32_bf16 v[60:63], a[76:79], a[36:39], v[60:63]
  ds_read_b128 a[88:91], v114 offset:5120
  v_mfma_f32_16x16x32_bf16 v[60:63], a[52:55], a[16:19], v[60:63]
  s_add_u32 m0, s63, 24576
  ds_read_b128 a[108:111], v115 offset:5120
  v_mfma_f32_16x16x32_bf16 v[56:59], a[52:55], a[12:15], v[56:59]
  ds_read_b64_tr_b16 a[136:137], v118 offset:2048
  buffer_load_dwordx4 v124, s[8:11], s69 offen offset:0  lds
  v_mfma_f32_16x16x32_bf16 v[56:59], a[76:79], a[32:35], v[56:59]
  ds_read_b64_tr_b16 a[138:139], v118 offset:8192
  v_mfma_f32_16x16x32_bf16 v[52:55], a[76:79], a[28:31], v[52:55]
  s_add_u32 s44, s44, 1
  ds_read_b64_tr_b16 a[160:161], v118 offset:14336
  v_mfma_f32_16x16x32_bf16 v[52:55], a[52:55], a[8:11], v[52:55]
  s_and_b32 s44, s44, 15
  ds_read_b64_tr_b16 a[162:163], v118 offset:20480
  v_mfma_f32_16x16x32_bf16 v[48:51], a[52:55], a[4:7], v[48:51]
  s_add_u32 s66, s66, 1
  ds_read_b64_tr_b16 a[140:141], v119 offset:2048
  buffer_load_dwordx4 v125, s[8:11], s69 offen offset:1024  lds
  v_mfma_f32_16x16x32_bf16 v[48:51], a[76:79], a[24:27], v[48:51]
  s_mul_i32 s45, s44, s61
  ds_read_b64_tr_b16 a[142:143], v119 offset:8192
  v_mfma_f32_16x16x32_bf16 v[100:103], a[20:23], a[80:83], v[100:103]
  s_add_u32 s68, s45, s59
  ds_read_b64_tr_b16 a[164:165], v119 offset:14336
  v_mfma_f32_16x16x32_bf16 v[100:103], a[0:3], a[56:59], v[100:103]
  ds_read_b64_tr_b16 a[166:167], v119 offset:20480
  v_mfma_f32_16x16x32_bf16 v[64:67], a[4:7], a[56:59], v[64:67]
  ds_read_b64_tr_b16 a[144:145], v118 offset:4096
  buffer_load_dwordx4 v124, s[8:11], s69 offen offset:2048  lds
  v_mfma_f32_16x16x32_bf16 v[64:67], a[24:27], a[80:83], v[64:67]
  ds_read_b64_tr_b16 a[146:147], v118 offset:10240
  v_mfma_f32_16x16x32_bf16 v[68:71], a[28:31], a[80:83], v[68:71]
  ds_read_b64_tr_b16 a[168:169], v118 offset:16384
  v_mfma_f32_16x16x32_bf16 v[68:71], a[8:11], a[56:59], v[68:71]
  ds_read_b64_tr_b16 a[170:171], v118 offset:22528
  v_mfma_f32_16x16x32_bf16 v[72:75], a[12:15], a[56:59], v[72:75]
  ds_read_b64_tr_b16 a[148:149], v119 offset:4096
  buffer_load_dwordx4 v125, s[8:11], s69 offen offset:3072  lds
  v_mfma_f32_16x16x32_bf16 v[72:75], a[32:35], a[80:83], v[72:75]
  ds_read_b64_tr_b16 a[150:151], v119 offset:10240
  v_mfma_f32_16x16x32_bf16 v[76:79], a[36:39], a[80:83], v[76:79]
  ds_read_b64_tr_b16 a[172:173], v119 offset:16384
  v_mfma_f32_16x16x32_bf16 v[76:79], a[16:19], a[56:59], v[76:79]
  s_add_u32 m0, s63, 28672
  ds_read_b64_tr_b16 a[174:175], v119 offset:22528
  v_mfma_f32_16x16x32_bf16 v[92:95], a[16:19], a[60:63], v[92:95]
  buffer_load_dwordx4 v124, s[8:11], s70 offen offset:0  lds
  v_mfma_f32_16x16x32_bf16 v[92:95], a[36:39], a[84:87], v[92:95]
  v_mfma_f32_16x16x32_bf16 v[88:91], a[32:35], a[84:87], v[88:91]
  v_mfma_f32_16x16x32_bf16 v[88:91], a[12:15], a[60:63], v[88:91]
  v_mfma_f32_16x16x32_bf16 v[84:87], a[8:11], a[60:63], v[84:87]
  buffer_load_dwordx4 v125, s[8:11], s70 offen offset:1024  lds
  v_mfma_f32_16x16x32_bf16 v[84:87], a[28:31], a[84:87], v[84:87]
  v_mfma_f32_16x16x32_bf16 v[80:83], a[24:27], a[84:87], v[80:83]
  v_mfma_f32_16x16x32_bf16 v[80:83], a[4:7], a[60:63], v[80:83]
  s_cmp_eq_u32 s66, s88
  s_cbranch_scc0 Lside_skip4
  s_call_b64 s[78:79], Lside_sub
Lside_skip4:
  s_waitcnt lgkmcnt(15)
  v_mfma_f32_16x16x32_bf16 v[0:3], a[128:131], a[92:95], v[0:3]
  s_mul_i32 s45, s44, 393216
  v_mfma_f32_16x16x32_bf16 v[0:3], a[152:155], a[112:115], v[0:3]
  s_add_u32 s69, s45, s60
  v_mfma_f32_16x16x32_bf16 v[4:7], a[152:155], a[116:119], v[4:7]
  s_add_u32 s70, s69, 4096
  v_mfma_f32_16x16x32_bf16 v[4:7], a[128:131], a[96:99], v[4:7]
  v_mfma_f32_16x16x32_bf16 v[8:11], a[128:131], a[100:103], v[8:11]
  v_mfma_f32_16x16x32_bf16 v[8:11], a[152:155], a[120:123], v[8:11]
  v_mfma_f32_16x16x32_bf16 v[12:15], a[152:155], a[124:127], v[12:15]
  v_mfma_f32_16x16x32_bf16 v[12:15], a[128:131], a[104:107], v[12:15]
  v_mfma_f32_16x16x32_bf16 v[28:31], a[132:135], a[104:107], v[28:31]
  v_mfma_f32_16x16x32_bf16 v[28:31], a[156:159], a[124:127], v[28:31]
  v_mfma_f32_16x16x32_bf16 v[24:27], a[156:159], a[120:123], v[24:27]
  s_waitcnt vmcnt(10) lgkmcnt(0)
  s_barrier
  ds_read_b64_tr_b16 a[40:41], v116 offset:0
  v_mfma_f32_16x16x32_bf16 v[24:27], a[132:135], a[100:103], v[24:27]
  s_add_u32 m0, s62, 106496
  ds_read_b64_tr_b16 a[42:43], v116 offset:6144
  v_mfma_f32_16x16x32_bf16 v[20:23], a[132:135], a[96:99], v[20:23]
  ds_read_b64_tr_b16 a[64:65], v116 offset:12288
  buffer_load_dwordx4 v120, s[28:31], s68 offen offset:0 sc1  lds
  v_mfma_f32_16x16x32_bf16 v[20:23], a[156:159], a[116:119], v[20:23]
  ds_read_b64_tr_b16 a[66:67], v116 offset:18432
  v_mfma_f32_16x16x32_bf16 v[16:19], a[156:159], a[112:115], v[16:19]
  ds_read_b128 a[4:7], v112 offset:0
  v_mfma_f32_16x16x32_bf16 v[16:19], a[132:135], a[92:95], v[16:19]
  ds_read_b128 a[24:27], v113 offset:0
  v_mfma_f32_16x16x32_bf16 v[96:99], a[136:139], a[88:91], v[96:99]
  ds_read_b128 a[8:11], v112 offset:2048
  buffer_load_dwordx4 v121, s[28:31], s68 offen offset:1024 sc1  lds
  v_mfma_f32_16x16x32_bf16 v[96:99], a[160:163], a[108:111], v[96:99]
  ds_read_b128 a[28:31], v113 offset:2048
  v_mfma_f32_16x16x32_bf16 v[32:35], a[160:163], a[112:115], v[32:35]
  ds_read_b128 a[12:15], v112 offset:4096
  v_mfma_f32_16x16x32_bf16 v[32:35], a[136:139], a[92:95], v[32:35]
  ds_read_b128 a[32:35], v113 offset:4096
  v_mfma_f32_16x16x32_bf16 v[36:39], a[136:139], a[96:99], v[36:39]
  ds_read_b128 a[16:19], v112 offset:6144
  buffer_load_dwordx4 v122, s[28:31], s68 offen offset:2048 sc1  lds
  v_mfma_f32_16x16x32_bf16 v[36:39], a[160:163], a[116:119], v[36:39]
  ds_read_b128 a[36:39], v113 offset:6144
  v_mfma_f32_16x16x32_bf16 v[40:43], a[160:163], a[120:123], v[40:43]
  ds_read_b64_tr_b16 a[44:45], v117 offset:0
  v_mfma_f32_16x16x32_bf16 v[40:43], a[136:139], a[100:103], v[40:43]
  ds_read_b64_tr_b16 a[46:47], v117 offset:6144
  v_mfma_f32_16x16x32_bf16 v[44:47], a[136:139], a[104:107], v[44:47]
  ds_read_b64_tr_b16 a[68:69], v117 offset:12288
  buffer_load_dwordx4 v123, s[28:31], s68 offen offset:3072 sc1  lds
  v_mfma_f32_16x16x32_bf16 v[44:47], a[160:163], a[124:127], v[44:47]
  ds_read_b64_tr_b16 a[70:71], v117 offset:18432
  v_mfma_f32_16x16x32_bf16 v[60:63], a[164:167], a[124:127], v[60:63]
  ds_read_b128 a[0:3], v114 offset:6144
  v_add_u32 v114, 6144, v114
  v_mfma_f32_16x16x32_bf16 v[60:63], a[140:143], a[104:107], v[60:63]
  s_add_u32 m0, s63, 49152
  ds_read_b128 a[20:23], v115 offset:6144
  v_add_u32 v115, 6144, v115
  v_mfma_f32_16x16x32_bf16 v[56:59], a[140:143], a[100:103], v[56:59]
  ds_read_b64_tr_b16 a[48:49], v116 offset:2048
  buffer_load_dwordx4 v124, s[8:11], s69 offen offset:0  lds
  v_mfma_f32_16x16x32_bf16 v[56:59], a[164:167], a[120:123], v[56:59]
  ds_read_b64_tr_b16 a[50:51], v116 offset:8192
  v_mfma_f32_16x16x32_bf16 v[52:55], a[164:167], a[116:119], v[52:55]
  s_add_u32 s44, s44, 1
  ds_read_b64_tr_b16 a[72:73], v116 offset:14336
  v_mfma_f32_16x16x32_bf16 v[52:55], a[140:143], a[96:99], v[52:55]
  s_and_b32 s44, s44, 15
  ds_read_b64_tr_b16 a[74:75], v116 offset:20480
  v_mfma_f32_16x16x32_bf16 v[48:51], a[140:143], a[92:95], v[48:51]
  s_add_u32 s66, s66, 1
  ds_read_b64_tr_b16 a[52:53], v117 offset:2048
  buffer_load_dwordx4 v125, s[8:11], s69 offen offset:1024  lds
  v_mfma_f32_16x16x32_bf16 v[48:51], a[164:167], a[112:115], v[48:51]
  s_mul_i32 s45, s44, s61
  ds_read_b64_tr_b16 a[54:55], v117 offset:8192
  v_mfma_f32_16x16x32_bf16 v[100:103], a[108:111], a[168:171], v[100:103]
  s_add_u32 s68, s45, s59
  ds_read_b64_tr_b16 a[76:77], v117 offset:14336
  v_mfma_f32_16x16x32_bf16 v[100:103], a[88:91], a[144:147], v[100:103]
  ds_read_b64_tr_b16 a[78:79], v117 offset:20480
  v_mfma_f32_16x16x32_bf16 v[64:67], a[92:95], a[144:147], v[64:67]
  ds_read_b64_tr_b16 a[56:57], v116 offset:4096
  buffer_load_dwordx4 v124, s[8:11], s69 offen offset:2048  lds
  v_mfma_f32_16x16x32_bf16 v[64:67], a[112:115], a[168:171], v[64:67]
  ds_read_b64_tr_b16 a[58:59], v116 offset:10240
  v_mfma_f32_16x16x32_bf16 v[68:71], a[116:119], a[168:171], v[68:71]
  ds_read_b64_tr_b16 a[80:81], v116 offset:16384
  v_mfma_f32_16x16x32_bf16 v[68:71], a[96:99], a[144:147], v[68:71]
  ds_read_b64_tr_b16 a[82:83], v116 offset:22528
  v_mfma_f32_16x16x32_bf16 v[72:75], a[100:103], a[144:147], v[72:75]
  ds_read_b64_tr_b16 a[60:61], v117 offset:4096
  buffer_load_dwordx4 v125, s[8:11], s69 offen offset:3072  lds
  v_mfma_f32_16x16x32_bf16 v[72:75], a[120:123], a[168:171], v[72:75]
  ds_read_b64_tr_b16 a[62:63], v117 offset:10240
  v_mfma_f32_16x16x32_bf16 v[76:79], a[124:127], a[168:171], v[76:79]
  ds_read_b64_tr_b16 a[84:85], v117 offset:16384
  v_mfma_f32_16x16x32_bf16 v[76:79], a[104:107], a[144:147], v[76:79]
  s_add_u32 m0, s63, 53248
  ds_read_b64_tr_b16 a[86:87], v117 offset:22528
  v_mfma_f32_16x16x32_bf16 v[92:95], a[104:107], a[148:151], v[92:95]
  buffer_load_dwordx4 v124, s[8:11], s70 offen offset:0  lds
  v_mfma_f32_16x16x32_bf16 v[92:95], a[124:127], a[172:175], v[92:95]
  v_mfma_f32_16x16x32_bf16 v[88:91], a[120:123], a[172:175], v[88:91]
  v_mfma_f32_16x16x32_bf16 v[88:91], a[100:103], a[148:151], v[88:91]
  v_mfma_f32_16x16x32_bf16 v[84:87], a[96:99], a[148:151], v[84:87]
  buffer_load_dwordx4 v125, s[8:11], s70 offen offset:1024  lds
  v_mfma_f32_16x16x32_bf16 v[84:87], a[116:119], a[172:175], v[84:87]
  v_mfma_f32_16x16x32_bf16 v[80:83], a[112:115], a[172:175], v[80:83]
  v_mfma_f32_16x16x32_bf16 v[80:83], a[92:95], a[148:151], v[80:83]
  s_cmp_eq_u32 s66, s88
  s_cbranch_scc0 Lside_skip5
  s_call_b64 s[78:79], Lside_sub
Lside_skip5:
  s_sub_u32 s56, s56, 1
  s_cmp_lg_u32 s56, 0
  s_cbranch_scc1 Lp1_loop
Lmk_Lp1_loop_tail:
  s_waitcnt lgkmcnt(15)
  v_mfma_f32_16x16x32_bf16 v[0:3], a[40:43], a[4:7], v[0:3]
  s_mul_i32 s45, s44, 393216
  v_and_b32 v240, 1, v253
  v_lshlrev_b32 v240, 7, v240
  v_mfma_f32_16x16x32_bf16 v[0:3], a[64:67], a[24:27], v[0:3]
  s_add_u32 s69, s45, s60
  v_mfma_f32_16x16x32_bf16 v[4:7], a[64:67], a[28:31], v[4:7]
  s_add_u32 s70, s69, 4096
  buffer_load_dword v127, v240, s[36:39], 0 offen sc1
  v_mfma_f32_16x16x32_bf16 v[4:7], a[40:43], a[8:11], v[4:7]
  s_lshl_b32 s43, s57, 2
  v_mfma_f32_16x16x32_bf16 v[8:11], a[40:43], a[12:15], v[8:11]
  s_add_u32 s74, s71, s43
  v_mfma_f32_16x16x32_bf16 v[8:11], a[64:67], a[32:35], v[8:11]
  s_add_u32 s45, s42, 27262976
  v_mfma_f32_16x16x32_bf16 v[12:15], a[64:67], a[36:39], v[12:15]
  s_lshl_b32 s44, s72, 11
  v_mfma_f32_16x16x32_bf16 v[12:15], a[40:43], a[16:19], v[12:15]
  s_add_u32 s77, s44, s45
  v_mfma_f32_16x16x32_bf16 v[28:31], a[44:47], a[16:19], v[28:31]
  s_lshl_b32 s44, s40, 1
  v_mfma_f32_16x16x32_bf16 v[28:31], a[68:71], a[36:39], v[28:31]
  s_add_u32 s44, s44, s71
  v_mfma_f32_16x16x32_bf16 v[24:27], a[68:71], a[32:35], v[24:27]
  s_waitcnt vmcnt(11) lgkmcnt(0)
  s_barrier
  ds_read_b64_tr_b16 a[128:129], v116 offset:24576
  v_mfma_f32_16x16x32_bf16 v[24:27], a[44:47], a[12:15], v[24:27]
  s_add_u32 m0, s62, 73728
  ds_read_b64_tr_b16 a[130:131], v116 offset:30720
  v_mfma_f32_16x16x32_bf16 v[20:23], a[44:47], a[8:11], v[20:23]
  s_lshl_b32 s44, s44, 11
  ds_read_b64_tr_b16 a[152:153], v116 offset:36864
  buffer_load_dwordx4 v120, s[28:31], s68 offen offset:0 sc1  lds
  v_mfma_f32_16x16x32_bf16 v[20:23], a[68:71], a[28:31], v[20:23]
  s_add_u32 s78, s44, s45
  ds_read_b64_tr_b16 a[154:155], v116 offset:43008
  v_mfma_f32_16x16x32_bf16 v[16:19], a[68:71], a[24:27], v[16:19]
  s_lshl_b32 s43, s51, 1
  ds_read_b128 a[92:95], v112 offset:16384
  v_mfma_f32_16x16x32_bf16 v[16:19], a[44:47], a[4:7], v[16:19]
  s_add_u32 s75, s43, s58
  ds_read_b128 a[112:115], v113 offset:16384
  v_mfma_f32_16x16x32_bf16 v[96:99], a[48:51], a[0:3], v[96:99]
  s_lshl_b32 s43, s75, 7
  ds_read_b128 a[96:99], v112 offset:18432
  buffer_load_dwordx4 v121, s[28:31], s68 offen offset:1024 sc1  lds
  v_mfma_f32_16x16x32_bf16 v[96:99], a[72:75], a[20:23], v[96:99]
  s_add_u32 s46, s43, 27983872
  ds_read_b128 a[116:119], v113 offset:18432
  v_mfma_f32_16x16x32_bf16 v[32:35], a[72:75], a[24:27], v[32:35]
  s_lshl_b32 s43, s57, 6
  ds_read_b128 a[100:103], v112 offset:20480
  v_mfma_f32_16x16x32_bf16 v[32:35], a[48:51], a[4:7], v[32:35]
  ds_read_b128 a[120:123], v113 offset:20480
  v_mfma_f32_16x16x32_bf16 v[36:39], a[48:51], a[8:11], v[36:39]
  ds_read_b128 a[104:107], v112 offset:22528
  buffer_load_dwordx4 v122, s[28:31], s68 offen offset:2048 sc1  lds
  v_mfma_f32_16x16x32_bf16 v[36:39], a[72:75], a[28:31], v[36:39]
  ds_read_b128 a[124:127], v113 offset:22528
  v_mfma_f32_16x16x32_bf16 v[40:43], a[72:75], a[32:35], v[40:43]
  ds_read_b64_tr_b16 a[132:133], v117 offset:24576
  v_mfma_f32_16x16x32_bf16 v[40:43], a[48:51], a[12:15], v[40:43]
  ds_read_b64_tr_b16 a[134:135], v117 offset:30720
  v_mfma_f32_16x16x32_bf16 v[44:47], a[48:51], a[16:19], v[44:47]
  ds_read_b64_tr_b16 a[156:157], v117 offset:36864
  buffer_load_dwordx4 v123, s[28:31], s68 offen offset:3072 sc1  lds
  v_mfma_f32_16x16x32_bf16 v[44:47], a[72:75], a[36:39], v[44:47]
  ds_read_b64_tr_b16 a[158:159], v117 offset:43008
  v_mfma_f32_16x16x32_bf16 v[60:63], a[76:79], a[36:39], v[60:63]
  ds_read_b128 a[88:91], v114 offset:1024
  v_mfma_f32_16x16x32_bf16 v[60:63], a[52:55], a[16:19], v[60:63]
  s_add_u32 m0, s63, 0
  ds_read_b128 a[108:111], v115 offset:1024
  v_mfma_f32_16x16x32_bf16 v[56:59], a[52:55], a[12:15], v[56:59]
  ds_read_b64_tr_b16 a[136:137], v116 offset:26624
  buffer_load_dwordx4 v124, s[8:11], s69 offen offset:0  lds
  v_mfma_f32_16x16x32_bf16 v[56:59], a[76:79], a[32:35], v[56:59]
  ds_read_b64_tr_b16 a[138:139], v116 offset:32768
  v_mfma_f32_16x16x32_bf16 v[52:55], a[76:79], a[28:31], v[52:55]
  ds_read_b64_tr_b16 a[160:161], v116 offset:38912
  v_lshlrev_b32 v105, 3, v253
  v_mfma_f32_16x16x32_bf16 v[52:55], a[52:55], a[8:11], v[52:55]
  ds_read_b64_tr_b16 a[162:163], v116 offset:45056
  v_lshlrev_b32 v104, 4, v253
  v_mfma_f32_16x16x32_bf16 v[48:51], a[52:55], a[4:7], v[48:51]
  ds_read_b64_tr_b16 a[140:141], v117 offset:26624
  buffer_load_dwordx4 v125, s[8:11], s69 offen offset:1024  lds
  v_mfma_f32_16x16x32_bf16 v[48:51], a[76:79], a[24:27], v[48:51]
  ds_read_b64_tr_b16 a[142:143], v117 offset:32768
  v_xor_b32 v126, s43, v104
  v_mfma_f32_16x16x32_bf16 v[100:103], a[20:23], a[80:83], v[100:103]
  ds_read_b64_tr_b16 a[164:165], v117 offset:38912
  v_add_u32 v126, s76, v126
  v_mfma_f32_16x16x32_bf16 v[100:103], a[0:3], a[56:59], v[100:103]
  ds_read_b64_tr_b16 a[166:167], v117 offset:45056
  v_bfe_u32 v106, v253, 3, 2
  v_mfma_f32_16x16x32_bf16 v[64:67], a[4:7], a[56:59], v[64:67]
  ds_read_b64_tr_b16 a[144:145], v116 offset:28672
  buffer_load_dwordx4 v124, s[8:11], s69 offen offset:2048  lds
  v_mfma_f32_16x16x32_bf16 v[64:67], a[24:27], a[80:83], v[64:67]
  ds_read_b64_tr_b16 a[146:147], v116 offset:34816
  v_lshrrev_b32 v107, 5, v253
  v_mfma_f32_16x16x32_bf16 v[68:71], a[28:31], a[80:83], v[68:71]
  ds_read_b64_tr_b16 a[168:169], v116 offset:40960
  v_mad_u32_u24 v106, v107, 3, v106
  v_mfma_f32_16x16x32_bf16 v[68:71], a[8:11], a[56:59], v[68:71]
  ds_read_b64_tr_b16 a[170:171], v116 offset:47104
  v_and_b32 v107, 7, v253
  v_mfma_f32_16x16x32_bf16 v[72:75], a[12:15], a[56:59], v[72:75]
  ds_read_b64_tr_b16 a[148:149], v117 offset:28672
  buffer_load_dwordx4 v125, s[8:11], s69 offen offset:3072  lds
  v_mfma_f32_16x16x32_bf16 v[72:75], a[32:35], a[80:83], v[72:75]
  ds_read_b64_tr_b16 a[150:151], v117 offset:34816
  v_lshlrev_b32 v107, 4, v107
  v_mfma_f32_16x16x32_bf16 v[76:79], a[36:39], a[80:83], v[76:79]
  ds_read_b64_tr_b16 a[172:173], v117 offset:40960
  v_lshl_add_u32 v106, v106, 12, v107
  v_mfma_f32_16x16x32_bf16 v[76:79], a[16:19], a[56:59], v[76:79]
  s_add_u32 m0, s63, 4096
  ds_read_b64_tr_b16 a[174:175], v117 offset:47104
  v_mfma_f32_16x16x32_bf16 v[92:95], a[16:19], a[60:63], v[92:95]
  buffer_load_dwordx4 v124, s[8:11], s70 offen offset:0  lds
  v_mfma_f32_16x16x32_bf16 v[92:95], a[36:39], a[84:87], v[92:95]
  v_mfma_f32_16x16x32_bf16 v[88:91], a[32:35], a[84:87], v[88:91]
  v_mfma_f32_16x16x32_bf16 v[88:91], a[12:15], a[60:63], v[88:91]
  s_waitcnt vmcnt(9)
  v_cmp_gt_u32 vcc, 128, v127
  s_cbranch_vccz Lcdn4
  s_mov_b32 s43, 0x40000
Lchk3:
  s_sleep 8
  buffer_load_dword v127, v240, s[36:39], 0 offen sc1
  s_waitcnt vmcnt(0)
  v_cmp_gt_u32 vcc, 128, v127
  s_cbranch_vccz Lcdn4
  s_sub_u32 s43, s43, 1
  s_cmp_lg_u32 s43, 0
  s_cbranch_scc1 Lchk3
Lcdn4:
  v_mfma_f32_16x16x32_bf16 v[84:87], a[8:11], a[60:63], v[84:87]
  buffer_load_dwordx4 v125, s[8:11], s70 offen offset:1024  lds
  v_mfma_f32_16x16x32_bf16 v[84:87], a[28:31], a[84:87], v[84:87]
  v_mfma_f32_16x16x32_bf16 v[80:83], a[24:27], a[84:87], v[80:83]
  v_mfma_f32_16x16x32_bf16 v[80:83], a[4:7], a[60:63], v[80:83]
  s_waitcnt lgkmcnt(15)
  v_mfma_f32_16x16x32_bf16 v[0:3], a[128:131], a[92:95], v[0:3]
  s_cmp_lg_u32 s41, 0
  s_cbranch_scc1 Lp1_csl0
  buffer_load_dwordx4 v[200:203], v106, s[4:7], s46 offen sc1
  s_add_u32 s46, s46, 24576
  buffer_load_dwordx4 v[204:207], v106, s[4:7], s46 offen sc1
  s_add_u32 s46, s46, 24576
Lp1_csl0:
  v_mfma_f32_16x16x32_bf16 v[0:3], a[152:155], a[112:115], v[0:3]
  s_lshl_b32 s92, s53, 7
  s_lshl_b32 s93, s40, 14
  s_add_u32 s92, s92, s93
  v_mfma_f32_16x16x32_bf16 v[4:7], a[152:155], a[116:119], v[4:7]
  s_lshl_b32 s89, s40, 10
  v_add_u32 v186, s92, v252
  v_mfma_f32_16x16x32_bf16 v[4:7], a[128:131], a[96:99], v[4:7]
  buffer_load_dwordx2 v[128:129], v105, s[4:7], s78 offen offset:0 sc1
  v_mfma_f32_16x16x32_bf16 v[8:11], a[128:131], a[100:103], v[8:11]
  v_mfma_f32_16x16x32_bf16 v[8:11], a[152:155], a[120:123], v[8:11]
  v_mfma_f32_16x16x32_bf16 v[12:15], a[152:155], a[124:127], v[12:15]
  s_cmp_lg_u32 s41, 0
  s_cbranch_scc1 Lp1_csl1
  buffer_load_dwordx4 v[208:211], v106, s[4:7], s46 offen sc1
  s_add_u32 s46, s46, 24576
  buffer_load_dwordx4 v[212:215], v106, s[4:7], s46 offen sc1
  s_add_u32 s46, s46, 24576
Lp1_csl1:
  v_mfma_f32_16x16x32_bf16 v[12:15], a[128:131], a[104:107], v[12:15]
  buffer_load_dwordx2 v[130:131], v105, s[4:7], s78 offen offset:512 sc1
  v_mfma_f32_16x16x32_bf16 v[28:31], a[132:135], a[104:107], v[28:31]
  v_mfma_f32_16x16x32_bf16 v[28:31], a[156:159], a[124:127], v[28:31]
  v_mfma_f32_16x16x32_bf16 v[24:27], a[156:159], a[120:123], v[24:27]
  s_waitcnt lgkmcnt(0)
  s_barrier
  ds_read_b64_tr_b16 a[40:41], v118 offset:0
  v_mfma_f32_16x16x32_bf16 v[24:27], a[132:135], a[100:103], v[24:27]
  ds_read_b64_tr_b16 a[42:43], v118 offset:6144
  buffer_load_dwordx2 v[132:133], v105, s[4:7], s78 offen offset:1024 sc1
  v_mfma_f32_16x16x32_bf16 v[20:23], a[132:135], a[96:99], v[20:23]
  s_cmp_lg_u32 s41, 0
  s_cbranch_scc1 Lp1_csl2
  buffer_load_dwordx4 v[216:219], v106, s[4:7], s46 offen sc1
  s_add_u32 s46, s46, 24576
  buffer_load_dwordx4 v[220:223], v106, s[4:7], s46 offen sc1
  s_add_u32 s46, s46, 24576
Lp1_csl2:
  ds_read_b64_tr_b16 a[64:65], v118 offset:12288
  v_mfma_f32_16x16x32_bf16 v[20:23], a[156:159], a[116:119], v[20:23]
  ds_read_b64_tr_b16 a[66:67], v118 offset:18432
  v_mfma_f32_16x16x32_bf16 v[16:19], a[156:159], a[112:115], v[16:19]
  ds_read_b128 a[4:7], v112 offset:32768
  v_mfma_f32_16x16x32_bf16 v[16:19], a[132:135], a[92:95], v[16:19]
  ds_read_b128 a[24:27], v113 offset:32768
  buffer_load_dwordx2 v[134:135], v105, s[4:7], s78 offen offset:1536 sc1
  v_mfma_f32_16x16x32_bf16 v[96:99], a[136:139], a[88:91], v[96:99]
  ds_read_b128 a[8:11], v112 offset:34816
  v_mfma_f32_16x16x32_bf16 v[96:99], a[160:163], a[108:111], v[96:99]
  ds_read_b128 a[28:31], v113 offset:34816
  v_mfma_f32_16x16x32_bf16 v[32:35], a[160:163], a[112:115], v[32:35]
  s_cmp_lg_u32 s41, 0
  s_cbranch_scc1 Lp1_csl3
  buffer_load_dwordx4 v[224:227], v106, s[4:7], s46 offen sc1
  s_add_u32 s46, s46, 24576
  buffer_load_dwordx4 v[228:231], v106, s[4:7], s46 offen sc1
  s_add_u32 s46, s46, 24576
Lp1_csl3:
  ds_read_b128 a[12:15], v112 offset:36864
  v_mfma_f32_16x16x32_bf16 v[32:35], a[136:139], a[92:95], v[32:35]
  ds_read_b128 a[32:35], v113 offset:36864
  buffer_load_dwordx2 v[136:137], v105, s[4:7], s78 offen offset:2048 sc1
  v_mfma_f32_16x16x32_bf16 v[36:39], a[136:139], a[96:99], v[36:39]
  ds_read_b128 a[16:19], v112 offset:38912
  v_mfma_f32_16x16x32_bf16 v[36:39], a[160:163], a[116:119], v[36:39]
  ds_read_b128 a[36:39], v113 offset:38912
  v_mfma_f32_16x16x32_bf16 v[40:43], a[160:163], a[120:123], v[40:43]
  ds_read_b64_tr_b16 a[44:45], v119 offset:0
  v_mfma_f32_16x16x32_bf16 v[40:43], a[136:139], a[100:103], v[40:43]
  ds_read_b64_tr_b16 a[46:47], v119 offset:6144
  buffer_load_dwordx2 v[138:139], v105, s[4:7], s78 offen offset:2560 sc1
  v_mfma_f32_16x16x32_bf16 v[44:47], a[136:139], a[104:107], v[44:47]
  ds_read_b64_tr_b16 a[68:69], v119 offset:12288
  v_lshrrev_b32 v240, 4, v253
  v_mfma_f32_16x16x32_bf16 v[44:47], a[160:163], a[124:127], v[44:47]
  ds_read_b64_tr_b16 a[70:71], v119 offset:18432
  v_lshlrev_b32 v124, 4, v240
  v_mfma_f32_16x16x32_bf16 v[60:63], a[164:167], a[124:127], v[60:63]
  ds_read_b128 a[0:3], v114 offset:2048
  v_and_b32 v125, 15, v253
  v_mfma_f32_16x16x32_bf16 v[60:63], a[140:143], a[104:107], v[60:63]
  ds_read_b128 a[20:23], v115 offset:2048
  buffer_load_dwordx2 v[140:141], v105, s[4:7], s78 offen offset:3072 sc1
  v_mfma_f32_16x16x32_bf16 v[56:59], a[140:143], a[100:103], v[56:59]
  ds_read_b64_tr_b16 a[48:49], v118 offset:2048
  v_lshlrev_b32 v125, 2, v125
  v_mfma_f32_16x16x32_bf16 v[56:59], a[164:167], a[120:123], v[56:59]
  s_lshl_b32 s43, s57, 9
  ds_read_b64_tr_b16 a[50:51], v118 offset:8192
  v_add_u32 v164, 155648, v124
  v_mfma_f32_16x16x32_bf16 v[52:55], a[164:167], a[116:119], v[52:55]
  ds_read_b64_tr_b16 a[72:73], v118 offset:14336
  v_add_u32 v166, 155648, v125
  v_mfma_f32_16x16x32_bf16 v[52:55], a[140:143], a[96:99], v[52:55]
  ds_read_b64_tr_b16 a[74:75], v118 offset:20480
  buffer_load_dwordx2 v[142:143], v105, s[4:7], s78 offen offset:3584 sc1
  v_mfma_f32_16x16x32_bf16 v[48:51], a[140:143], a[92:95], v[48:51]
  ds_read_b64_tr_b16 a[52:53], v119 offset:2048
  v_add_u32 v165, s43, v164
  v_mfma_f32_16x16x32_bf16 v[48:51], a[164:167], a[112:115], v[48:51]
  ds_read_b64_tr_b16 a[54:55], v119 offset:8192
  v_add_u32 v167, s43, v166
  v_mfma_f32_16x16x32_bf16 v[100:103], a[108:111], a[168:171], v[100:103]
  s_lshl_b32 s43, s40, 1
  ds_read_b64_tr_b16 a[76:77], v119 offset:14336
  v_mfma_f32_16x16x32_bf16 v[100:103], a[88:91], a[144:147], v[100:103]
  s_add_u32 s43, s43, 1
  ds_read_b64_tr_b16 a[78:79], v119 offset:20480
  buffer_load_dwordx2 v[144:145], v105, s[4:7], s77 offen offset:0 sc1
  v_mfma_f32_16x16x32_bf16 v[64:67], a[92:95], a[144:147], v[64:67]
  ds_read_b64_tr_b16 a[56:57], v118 offset:4096
  v_add_u32 v241, s43, v240
  v_mfma_f32_16x16x32_bf16 v[64:67], a[112:115], a[168:171], v[64:67]
  ds_read_b64_tr_b16 a[58:59], v118 offset:10240
  v_cmp_gt_u32 vcc, 2, v240
  v_mfma_f32_16x16x32_bf16 v[68:71], a[116:119], a[168:171], v[68:71]
  ds_read_b64_tr_b16 a[80:81], v118 offset:16384
  v_and_b32 v240, 1, v240
  v_mfma_f32_16x16x32_bf16 v[68:71], a[96:99], a[144:147], v[68:71]
  ds_read_b64_tr_b16 a[82:83], v118 offset:22528
  buffer_load_dwordx2 v[146:147], v105, s[4:7], s77 offen offset:512 sc1
  v_mfma_f32_16x16x32_bf16 v[72:75], a[100:103], a[144:147], v[72:75]
  ds_read_b64_tr_b16 a[60:61], v119 offset:4096
  v_mul_u32_u24 v240, 9, v240
  v_mfma_f32_16x16x32_bf16 v[72:75], a[120:123], a[168:171], v[72:75]
  ds_read_b64_tr_b16 a[62:63], v119 offset:10240
  v_cndmask_b32 v240, v240, v241, vcc
  v_mfma_f32_16x16x32_bf16 v[76:79], a[124:127], a[168:171], v[76:79]
  ds_read_b64_tr_b16 a[84:85], v119 offset:16384
  v_lshl_add_u32 v106, v240, 7, v166
  v_mfma_f32_16x16x32_bf16 v[76:79], a[104:107], a[144:147], v[76:79]
  ds_read_b64_tr_b16 a[86:87], v119 offset:22528
  buffer_load_dwordx2 v[148:149], v105, s[4:7], s77 offen offset:1024 sc1
  v_mfma_f32_16x16x32_bf16 v[92:95], a[104:107], a[148:151], v[92:95]
  v_add_u32 v124, s76, v124
  v_add_u32 v125, s76, v125
  v_mfma_f32_16x16x32_bf16 v[92:95], a[124:127], a[172:175], v[92:95]
  v_add_u32 v107, 149504, v104
  v_mfma_f32_16x16x32_bf16 v[88:91], a[120:123], a[172:175], v[88:91]
  v_mfma_f32_16x16x32_bf16 v[88:91], a[100:103], a[148:151], v[88:91]
  buffer_load_dwordx2 v[150:151], v105, s[4:7], s77 offen offset:1536 sc1
  v_mfma_f32_16x16x32_bf16 v[84:87], a[96:99], a[148:151], v[84:87]
  v_mfma_f32_16x16x32_bf16 v[84:87], a[116:119], a[172:175], v[84:87]
  v_mfma_f32_16x16x32_bf16 v[80:83], a[112:115], a[172:175], v[80:83]
  v_mfma_f32_16x16x32_bf16 v[80:83], a[92:95], a[148:151], v[80:83]
  s_waitcnt lgkmcnt(15)
  v_mfma_f32_16x16x32_bf16 v[0:3], a[40:43], a[4:7], v[0:3]
  s_lshl_b32 s44, s2, 2
  s_add_u32 s44, s44, s40
  s_lshl_b32 s44, s44, 12
  v_mfma_f32_16x16x32_bf16 v[0:3], a[64:67], a[24:27], v[0:3]
  s_add_u32 s44, s44, s42
  v_mfma_f32_16x16x32_bf16 v[4:7], a[64:67], a[28:31], v[4:7]
  s_add_u32 s44, s44, 28311552
  v_mov_b32 v246, -1
  v_mov_b32 v247, -1
  v_mfma_f32_16x16x32_bf16 v[4:7], a[40:43], a[8:11], v[4:7]
  v_mov_b32 v248, -1
  v_mov_b32 v249, -1
  v_mfma_f32_16x16x32_bf16 v[8:11], a[40:43], a[12:15], v[8:11]
  v_mfma_f32_16x16x32_bf16 v[8:11], a[64:67], a[32:35], v[8:11]
  v_mfma_f32_16x16x32_bf16 v[12:15], a[64:67], a[36:39], v[12:15]
  s_waitcnt vmcnt(8)
  v_add_u32 v198, 1024, v125
  v_add_f32 v128, v128, v130
  v_mfma_f32_16x16x32_bf16 v[12:15], a[40:43], a[16:19], v[12:15]
  v_add_f32 v129, v129, v131
  v_add_f32 v132, v132, v134
  v_mfma_f32_16x16x32_bf16 v[28:31], a[44:47], a[16:19], v[28:31]
  buffer_store_dwordx4 v[246:249], v104, s[4:7], s44 offen offset:0 sc1
  v_add_f32 v133, v133, v135
  v_mfma_f32_16x16x32_bf16 v[28:31], a[68:71], a[36:39], v[28:31]
  v_add_f32 v128, v128, v132
  v_add_f32 v129, v129, v133
  v_mfma_f32_16x16x32_bf16 v[24:27], a[68:71], a[32:35], v[24:27]
  s_waitcnt lgkmcnt(0)
  s_barrier
  ds_read_b64_tr_b16 a[128:129], v116 offset:0
  s_waitcnt vmcnt(5)
  s_cmp_lg_u32 s41, 0
  s_cbranch_scc1 Lp1_css
  v_pk_add_f32 v[200:201], v[200:201], v[216:217]
  v_pk_add_f32 v[202:203], v[202:203], v[218:219]
  v_pk_add_f32 v[204:205], v[204:205], v[220:221]
  v_pk_add_f32 v[206:207], v[206:207], v[222:223]
  v_pk_add_f32 v[208:209], v[208:209], v[224:225]
  v_pk_add_f32 v[210:211], v[210:211], v[226:227]
  v_pk_add_f32 v[212:213], v[212:213], v[228:229]
  v_pk_add_f32 v[214:215], v[214:215], v[230:231]
  v_pk_add_f32 v[200:201], v[200:201], v[208:209]
  v_pk_add_f32 v[202:203], v[202:203], v[210:211]
  v_pk_add_f32 v[204:205], v[204:205], v[212:213]
  v_pk_add_f32 v[206:207], v[206:207], v[214:215]
  v_pk_add_f32 v[200:201], v[200:201], v[204:205]
  v_pk_add_f32 v[202:203], v[202:203], v[206:207]
  v_mov_b32 v204, v200
  v_mov_b32 v205, v201
  v_mov_b32 v206, v202
  v_mov_b32 v207, v203
  v_permlane32_swap_b32 v200, v204
  v_permlane32_swap_b32 v201, v205
  v_permlane32_swap_b32 v202, v206
  v_permlane32_swap_b32 v203, v207
  v_add_f32 v200, v200, v204
  v_add_f32 v201, v201, v205
  v_add_f32 v202, v202, v206
  v_add_f32 v203, v203, v207
  ds_write_b128 v126, v[200:203] offset:1024
Lp1_css:
  v_mfma_f32_16x16x32_bf16 v[24:27], a[44:47], a[12:15], v[24:27]
  ds_read_b64_tr_b16 a[130:131], v116 offset:6144
  ds_read_b128 v[168:171], v124 offset:1024
  v_mfma_f32_16x16x32_bf16 v[20:23], a[44:47], a[8:11], v[20:23]
  ds_read_b64_tr_b16 a[152:153], v116 offset:12288
  buffer_store_dwordx4 v[246:249], v104, s[4:7], s44 offen offset:1024 sc1
  v_mfma_f32_16x16x32_bf16 v[20:23], a[68:71], a[28:31], v[20:23]
  ds_read_b64_tr_b16 a[154:155], v116 offset:18432
  ds_read_b128 v[172:175], v124 offset:1088
  v_mfma_f32_16x16x32_bf16 v[16:19], a[68:71], a[24:27], v[16:19]
  ds_read_b128 a[92:95], v112 offset:0
  ds_read_b128 v[176:179], v124 offset:1152
  v_mfma_f32_16x16x32_bf16 v[16:19], a[44:47], a[4:7], v[16:19]
  ds_read_b128 a[112:115], v113 offset:0
  ds_read_b128 v[180:183], v124 offset:1216
  v_mfma_f32_16x16x32_bf16 v[96:99], a[48:51], a[0:3], v[96:99]
  ds_read_b128 a[96:99], v112 offset:2048
  buffer_store_dwordx4 v[246:249], v104, s[4:7], s44 offen offset:2048 sc1
  v_mfma_f32_16x16x32_bf16 v[96:99], a[72:75], a[20:23], v[96:99]
  ds_read_b128 a[116:119], v113 offset:2048
  ds_read2_b32 v[184:185], v198 offset0:64 offset1:80
  v_mfma_f32_16x16x32_bf16 v[32:35], a[72:75], a[24:27], v[32:35]
  s_xor_b32 s47, s40, 2
  ds_read_b128 a[100:103], v112 offset:4096
  s_mul_i32 s47, s47, 6144
  v_mfma_f32_16x16x32_bf16 v[32:35], a[48:51], a[4:7], v[32:35]
  s_add_u32 s47, s47, 139264
  ds_read_b128 a[120:123], v113 offset:4096
  s_add_u32 s49, s47, 3072
  v_mfma_f32_16x16x32_bf16 v[36:39], a[48:51], a[8:11], v[36:39]
  s_add_u32 s79, s47, 2048
  ds_read_b128 a[104:107], v112 offset:6144
  buffer_store_dwordx4 v[246:249], v104, s[4:7], s44 offen offset:3072 sc1
  v_mfma_f32_16x16x32_bf16 v[36:39], a[72:75], a[28:31], v[36:39]
  s_cmp_eq_u32 s57, 0
  s_cselect_b32 s49, s76, s49
  s_cselect_b32 s79, s47, s79
  ds_read_b128 a[124:127], v113 offset:6144
  v_add_u32 v198, s49, v105
  v_mfma_f32_16x16x32_bf16 v[40:43], a[72:75], a[32:35], v[40:43]
  ds_read_b64_tr_b16 a[132:133], v117 offset:0
  v_add_u32 v199, s79, v105
  v_mfma_f32_16x16x32_bf16 v[40:43], a[48:51], a[12:15], v[40:43]
  s_add_u32 m0, s62, 90112
  ds_read_b64_tr_b16 a[134:135], v117 offset:6144
  v_add_u32 v105, s76, v105
  v_mfma_f32_16x16x32_bf16 v[44:47], a[48:51], a[16:19], v[44:47]
  ds_read_b64_tr_b16 a[156:157], v117 offset:12288
  buffer_load_dwordx4 v120, s[28:31], s64 offen offset:0 sc1 lds
  v_mfma_f32_16x16x32_bf16 v[44:47], a[72:75], a[36:39], v[44:47]
  ds_read_b64_tr_b16 a[158:159], v117 offset:18432
  v_add_f32 v136, v136, v138
  v_mfma_f32_16x16x32_bf16 v[60:63], a[76:79], a[36:39], v[60:63]
  ds_read_b128 a[88:91], v114 offset:3072
  v_add_f32 v137, v137, v139
  v_mfma_f32_16x16x32_bf16 v[60:63], a[52:55], a[16:19], v[60:63]
  ds_read_b128 a[108:111], v115 offset:3072
  v_add_f32 v140, v140, v142
  v_mfma_f32_16x16x32_bf16 v[56:59], a[52:55], a[12:15], v[56:59]
  ds_read_b64_tr_b16 a[136:137], v116 offset:2048
  v_add_f32 v141, v141, v143
  v_mfma_f32_16x16x32_bf16 v[56:59], a[76:79], a[32:35], v[56:59]
  ds_read_b64_tr_b16 a[138:139], v116 offset:8192
  v_add_f32 v136, v136, v140
  v_mfma_f32_16x16x32_bf16 v[52:55], a[76:79], a[28:31], v[52:55]
  ds_read_b64_tr_b16 a[160:161], v116 offset:14336
  v_add_f32 v137, v137, v141
  v_mfma_f32_16x16x32_bf16 v[52:55], a[52:55], a[8:11], v[52:55]
  s_waitcnt vmcnt(5)
  ds_read_b64_tr_b16 a[162:163], v116 offset:20480
  v_add_f32 v144, v144, v146
  v_mfma_f32_16x16x32_bf16 v[48:51], a[52:55], a[4:7], v[48:51]
  ds_read_b64_tr_b16 a[140:141], v117 offset:2048
  buffer_load_dwordx4 v121, s[28:31], s64 offen offset:1024 sc1 lds
  v_mfma_f32_16x16x32_bf16 v[48:51], a[76:79], a[24:27], v[48:51]
  ds_read_b64_tr_b16 a[142:143], v117 offset:8192
  v_add_f32 v145, v145, v147
  v_mfma_f32_16x16x32_bf16 v[100:103], a[20:23], a[80:83], v[100:103]
  ds_read_b64_tr_b16 a[164:165], v117 offset:14336
  v_add_f32 v148, v148, v150
  v_mfma_f32_16x16x32_bf16 v[100:103], a[0:3], a[56:59], v[100:103]
  ds_read_b64_tr_b16 a[166:167], v117 offset:20480
  v_add_f32 v149, v149, v151
  v_mfma_f32_16x16x32_bf16 v[64:67], a[4:7], a[56:59], v[64:67]
  ds_read_b64_tr_b16 a[144:145], v116 offset:4096
  v_add_f32 v144, v144, v148
  v_mfma_f32_16x16x32_bf16 v[64:67], a[24:27], a[80:83], v[64:67]
  ds_read_b64_tr_b16 a[146:147], v116 offset:10240
  v_add_f32 v145, v145, v149
  v_mfma_f32_16x16x32_bf16 v[68:71], a[28:31], a[80:83], v[68:71]
  s_mov_b32 s48, 0x3a800000
  ds_read_b64_tr_b16 a[168:169], v116 offset:16384
  v_mov_b32 v240, 0x3727c5ac
  v_mfma_f32_16x16x32_bf16 v[68:71], a[8:11], a[56:59], v[68:71]
  ds_read_b64_tr_b16 a[170:171], v116 offset:22528
  v_permlane32_swap_b32 v136, v130
  v_mfma_f32_16x16x32_bf16 v[72:75], a[12:15], a[56:59], v[72:75]
  ds_read_b64_tr_b16 a[148:149], v117 offset:4096
  buffer_load_dwordx4 v122, s[28:31], s64 offen offset:2048 sc1 lds
  v_mfma_f32_16x16x32_bf16 v[72:75], a[32:35], a[80:83], v[72:75]
  ds_read_b64_tr_b16 a[150:151], v117 offset:10240
  v_permlane32_swap_b32 v137, v131
  v_mfma_f32_16x16x32_bf16 v[76:79], a[36:39], a[80:83], v[76:79]
  ds_read_b64_tr_b16 a[172:173], v117 offset:16384
  v_permlane32_swap_b32 v128, v144
  v_mfma_f32_16x16x32_bf16 v[76:79], a[16:19], a[56:59], v[76:79]
  ds_read_b64_tr_b16 a[174:175], v117 offset:22528
  v_permlane32_swap_b32 v129, v145
  v_mfma_f32_16x16x32_bf16 v[92:95], a[16:19], a[60:63], v[92:95]
  v_add_f32 v136, v136, v130
  v_add_f32 v128, v128, v144
  v_mfma_f32_16x16x32_bf16 v[92:95], a[36:39], a[84:87], v[92:95]
  v_add_f32 v137, v137, v131
  v_add_f32 v129, v129, v145
  v_mfma_f32_16x16x32_bf16 v[88:91], a[32:35], a[84:87], v[88:91]
  v_permlane16_swap_b32 v128, v136
  v_mfma_f32_16x16x32_bf16 v[88:91], a[12:15], a[60:63], v[88:91]
  s_nop 0
  v_permlane16_swap_b32 v129, v137
  v_add_f32 v128, v128, v136
  v_mfma_f32_16x16x32_bf16 v[84:87], a[8:11], a[60:63], v[84:87]
  buffer_load_dwordx4 v123, s[28:31], s64 offen offset:3072 sc1 lds
  v_add_f32 v129, v129, v137
  v_mfma_f32_16x16x32_bf16 v[84:87], a[28:31], a[84:87], v[84:87]
  v_mul_f32 v128, 0xba800000, v128
  v_fma_f32 v129, v129, s48, v240
  v_mfma_f32_16x16x32_bf16 v[80:83], a[24:27], a[84:87], v[80:83]
  v_fma_f32 v129, -v128, v128, v129
  v_max_f32 v129, v129, v240
  v_mfma_f32_16x16x32_bf16 v[80:83], a[4:7], a[60:63], v[80:83]
  v_rsq_f32 v129, v129
  s_nop 0
  s_waitcnt lgkmcnt(15)
  v_mfma_f32_16x16x32_bf16 v[0:3], a[128:131], a[92:95], v[0:3]
  ds_write2_b32 v106, v128, v129 offset0:0 offset1:16
  v_mfma_f32_16x16x32_bf16 v[0:3], a[152:155], a[112:115], v[0:3]
  s_add_u32 m0, s89, 40960
  v_mfma_f32_16x16x32_bf16 v[4:7], a[152:155], a[116:119], v[4:7]
  s_mov_b32 s92, 655360
  v_mfma_f32_16x16x32_bf16 v[4:7], a[128:131], a[96:99], v[4:7]
  buffer_load_dwordx4 v186, s[12:15], s92 offen lds
  v_mfma_f32_16x16x32_bf16 v[8:11], a[128:131], a[100:103], v[8:11]
  v_mfma_f32_16x16x32_bf16 v[8:11], a[152:155], a[120:123], v[8:11]
  v_mfma_f32_16x16x32_bf16 v[12:15], a[152:155], a[124:127], v[12:15]
  v_mfma_f32_16x16x32_bf16 v[12:15], a[128:131], a[104:107], v[12:15]
  s_add_u32 m0, s89, 45056
  v_mfma_f32_16x16x32_bf16 v[28:31], a[132:135], a[104:107], v[28:31]
  s_mov_b32 s92, 720896
  v_mfma_f32_16x16x32_bf16 v[28:31], a[156:159], a[124:127], v[28:31]
  buffer_load_dwordx4 v186, s[12:15], s92 offen lds
  v_mfma_f32_16x16x32_bf16 v[24:27], a[156:159], a[120:123], v[24:27]
  s_waitcnt lgkmcnt(0)
  s_barrier
  ds_read2_b32 v[190:191], v167 offset0:32 offset1:48
  ds_read2_b32 v[192:193], v167 offset0:64 offset1:80
  v_mfma_f32_16x16x32_bf16 v[24:27], a[132:135], a[100:103], v[24:27]
  ds_read2_b32 v[194:195], v167 offset0:96 offset1:112
  ds_read2_b32 v[196:197], v167 offset0:128 offset1:144
  v_mfma_f32_16x16x32_bf16 v[20:23], a[132:135], a[96:99], v[20:23]
  ds_read2_b32 v[188:189], v166 offset0:0 offset1:16
  ds_read_b128 v[128:131], v107
  v_mfma_f32_16x16x32_bf16 v[20:23], a[156:159], a[116:119], v[20:23]
  s_add_u32 m0, s89, 49152
  ds_read_b128 v[132:135], v107 offset:1024
  ds_read_b128 v[200:203], v164 offset:0
  v_mfma_f32_16x16x32_bf16 v[16:19], a[156:159], a[112:115], v[16:19]
  s_mov_b32 s92, 786432
  ds_read_b128 v[220:223], v164 offset:64
  ds_read_b128 v[216:219], v165 offset:512
  v_mfma_f32_16x16x32_bf16 v[16:19], a[132:135], a[92:95], v[16:19]
  buffer_load_dwordx4 v186, s[12:15], s92 offen lds
  ds_read_b128 v[236:239], v165 offset:576
  v_mfma_f32_16x16x32_bf16 v[96:99], a[136:139], a[88:91], v[96:99]
  ds_read_b128 v[204:207], v165 offset:128
  ds_read_b128 v[224:227], v165 offset:192
  v_mfma_f32_16x16x32_bf16 v[96:99], a[160:163], a[108:111], v[96:99]
  ds_read_b128 v[208:211], v165 offset:256
  ds_read_b128 v[228:231], v165 offset:320
  v_mfma_f32_16x16x32_bf16 v[32:35], a[160:163], a[112:115], v[32:35]
  ds_read_b128 v[212:215], v165 offset:384
  ds_read_b128 v[232:235], v165 offset:448
  v_mfma_f32_16x16x32_bf16 v[32:35], a[136:139], a[92:95], v[32:35]
  s_add_u32 m0, s89, 53248
  s_and_b32 s43, s50, 7
  s_or_b32 s43, s43, s57
  v_mfma_f32_16x16x32_bf16 v[36:39], a[136:139], a[96:99], v[36:39]
  s_cselect_b64 s[46:47], -1, 0
  s_mov_b32 s92, 851968
  v_mov_b32 v245, 0xf149f2ca
  v_mfma_f32_16x16x32_bf16 v[36:39], a[160:163], a[116:119], v[36:39]
  s_waitcnt lgkmcnt(10)
  buffer_load_dwordx4 v186, s[12:15], s92 offen lds
  v_fmac_f32 v12, v168, v196
  v_mfma_f32_16x16x32_bf16 v[40:43], a[160:163], a[120:123], v[40:43]
  v_fmac_f32 v13, v169, v196
  v_fmac_f32 v14, v170, v196
  v_mfma_f32_16x16x32_bf16 v[40:43], a[136:139], a[100:103], v[40:43]
  v_fmac_f32 v15, v171, v196
  v_fmac_f32 v28, v172, v196
  v_mfma_f32_16x16x32_bf16 v[44:47], a[136:139], a[104:107], v[44:47]
  v_fmac_f32 v29, v173, v196
  v_fmac_f32 v30, v174, v196
  v_mfma_f32_16x16x32_bf16 v[44:47], a[160:163], a[124:127], v[44:47]
  s_add_u32 m0, s89, 57344
  v_fmac_f32 v31, v175, v196
  v_cvt_pk_bf16_f32 v12, v12, v13
  v_mfma_f32_16x16x32_bf16 v[60:63], a[164:167], a[124:127], v[60:63]
  s_mov_b32 s92, 917504
  v_cvt_pk_bf16_f32 v13, v14, v15
  v_cvt_pk_bf16_f32 v14, v28, v29
  v_mfma_f32_16x16x32_bf16 v[60:63], a[140:143], a[104:107], v[60:63]
  buffer_load_dwordx4 v186, s[12:15], s92 offen lds
  v_cvt_pk_bf16_f32 v15, v30, v31
  v_mfma_f32_16x16x32_bf16 v[56:59], a[140:143], a[100:103], v[56:59]
  v_fmac_f32 v8, v168, v194
  v_fmac_f32 v9, v169, v194
  v_mfma_f32_16x16x32_bf16 v[56:59], a[164:167], a[120:123], v[56:59]
  v_fmac_f32 v10, v170, v194
  v_fmac_f32 v11, v171, v194
  v_mfma_f32_16x16x32_bf16 v[52:55], a[164:167], a[116:119], v[52:55]
  v_fmac_f32 v24, v172, v194
  v_fmac_f32 v25, v173, v194
  v_mfma_f32_16x16x32_bf16 v[52:55], a[140:143], a[96:99], v[52:55]
  s_add_u32 m0, s89, 61440
  v_fmac_f32 v26, v174, v194
  v_fmac_f32 v27, v175, v194
  v_mfma_f32_16x16x32_bf16 v[48:51], a[140:143], a[92:95], v[48:51]
  s_mov_b32 s92, 983040
  v_cvt_pk_bf16_f32 v8, v8, v9
  v_cvt_pk_bf16_f32 v9, v10, v11
  v_mfma_f32_16x16x32_bf16 v[48:51], a[164:167], a[112:115], v[48:51]
  buffer_load_dwordx4 v186, s[12:15], s92 offen lds
  v_cvt_pk_bf16_f32 v10, v24, v25
  v_mfma_f32_16x16x32_bf16 v[100:103], a[108:111], a[168:171], v[100:103]
  v_cvt_pk_bf16_f32 v11, v26, v27
  v_fmac_f32 v4, v168, v192
  v_mfma_f32_16x16x32_bf16 v[100:103], a[88:91], a[144:147], v[100:103]
  v_fmac_f32 v5, v169, v192
  v_fmac_f32 v6, v170, v192
  v_mfma_f32_16x16x32_bf16 v[64:67], a[92:95], a[144:147], v[64:67]
  v_fmac_f32 v7, v171, v192
  v_fmac_f32 v20, v172, v192
  v_mfma_f32_16x16x32_bf16 v[64:67], a[112:115], a[168:171], v[64:67]
  s_add_u32 m0, s89, 65536
  v_fmac_f32 v21, v173, v192
  v_fmac_f32 v22, v174, v192
  v_mfma_f32_16x16x32_bf16 v[68:71], a[116:119], a[168:171], v[68:71]
  s_mov_b32 s92, 1048576
  v_fmac_f32 v23, v175, v192
  v_cvt_pk_bf16_f32 v4, v4, v5
  v_mfma_f32_16x16x32_bf16 v[68:71], a[96:99], a[144:147], v[68:71]
  buffer_load_dwordx4 v186, s[12:15], s92 offen lds
  v_cvt_pk_bf16_f32 v5, v6, v7
  v_mfma_f32_16x16x32_bf16 v[72:75], a[100:103], a[144:147], v[72:75]
  v_cvt_pk_bf16_f32 v6, v20, v21
  v_cvt_pk_bf16_f32 v7, v22, v23
  v_mfma_f32_16x16x32_bf16 v[72:75], a[120:123], a[168:171], v[72:75]
  v_fmac_f32 v0, v168, v190
  v_fmac_f32 v1, v169, v190
  v_mfma_f32_16x16x32_bf16 v[76:79], a[124:127], a[168:171], v[76:79]
  v_fmac_f32 v2, v170, v190
  v_fmac_f32 v3, v171, v190
  v_mfma_f32_16x16x32_bf16 v[76:79], a[104:107], a[144:147], v[76:79]
  s_add_u32 m0, s89, 69632
  v_fmac_f32 v16, v172, v190
  v_fmac_f32 v17, v173, v190
  v_mfma_f32_16x16x32_bf16 v[92:95], a[104:107], a[148:151], v[92:95]
  s_mov_b32 s92, 1114112
  v_fmac_f32 v18, v174, v190
  v_fmac_f32 v19, v175, v190
  v_mfma_f32_16x16x32_bf16 v[92:95], a[124:127], a[172:175], v[92:95]
  buffer_load_dwordx4 v186, s[12:15], s92 offen lds
  v_cvt_pk_bf16_f32 v0, v0, v1
  v_mfma_f32_16x16x32_bf16 v[88:91], a[120:123], a[172:175], v[88:91]
  v_cvt_pk_bf16_f32 v1, v2, v3
  v_cvt_pk_bf16_f32 v2, v16, v17
  v_mfma_f32_16x16x32_bf16 v[88:91], a[100:103], a[148:151], v[88:91]
  v_cvt_pk_bf16_f32 v3, v18, v19
  v_cndmask_b32 v136, v245, v132, s[46:47]
  v_mfma_f32_16x16x32_bf16 v[84:87], a[96:99], a[148:151], v[84:87]
  v_mov_b32 v160, 0x3f803f80
  v_mul_f32 v108, 0x3e8293ee, v191
  v_mfma_f32_16x16x32_bf16 v[84:87], a[116:119], a[172:175], v[84:87]
  v_cndmask_b32 v137, v245, v133, s[46:47]
  v_mov_b32 v161, 0x3f803f80
  v_mfma_f32_16x16x32_bf16 v[80:83], a[112:115], a[172:175], v[80:83]
  v_mul_f32 v109, 0x3e8293ee, v193
  v_cndmask_b32 v138, v245, v134, s[46:47]
  v_mfma_f32_16x16x32_bf16 v[80:83], a[92:95], a[148:151], v[80:83]
  v_mov_b32 v162, 0x3f803f80
  v_mul_f32 v110, 0x3e8293ee, v195
Lmk_p1epi:
  v_cndmask_b32 v139, v245, v135, s[46:47]
  v_mov_b32 v163, 0x3f803f80
  v_mul_f32 v111, 0x3e8293ee, v197
  s_waitcnt lgkmcnt(0)
  v_pk_fma_f32 v[96:97], v[176:177], v[188:189], v[96:97] op_sel:[0,0,0] op_sel_hi:[1,0,1]
  v_pk_fma_f32 v[98:99], v[178:179], v[188:189], v[98:99] op_sel:[0,0,0] op_sel_hi:[1,0,1]
  v_pk_mul_f32 v[96:97], v[96:97], v[188:189] op_sel:[0,1] op_sel_hi:[1,1]
  v_pk_mul_f32 v[98:99], v[98:99], v[188:189] op_sel:[0,1] op_sel_hi:[1,1]
  v_cvt_pk_bf16_f32 v96, v96, v97
  v_cvt_pk_bf16_f32 v97, v98, v99
  v_pk_fma_f32 v[44:45], v[176:177], v[196:197], v[44:45] op_sel:[0,0,0] op_sel_hi:[1,0,1]
  v_pk_fma_f32 v[46:47], v[178:179], v[196:197], v[46:47] op_sel:[0,0,0] op_sel_hi:[1,0,1]
  v_pk_fma_f32 v[60:61], v[180:181], v[196:197], v[60:61] op_sel:[0,0,0] op_sel_hi:[1,0,1]
  v_pk_fma_f32 v[62:63], v[182:183], v[196:197], v[62:63] op_sel:[0,0,0] op_sel_hi:[1,0,1]
  v_pk_mul_f32 v[44:45], v[44:45], v[196:197] op_sel:[0,1] op_sel_hi:[1,1]
  v_pk_mul_f32 v[46:47], v[46:47], v[196:197] op_sel:[0,1] op_sel_hi:[1,1]
  v_pk_mul_f32 v[60:61], v[60:61], v[196:197] op_sel:[0,1] op_sel_hi:[1,1]
  v_pk_mul_f32 v[62:63], v[62:63], v[196:197] op_sel:[0,1] op_sel_hi:[1,1]
  v_cvt_pk_bf16_f32 v44, v44, v45
  v_cvt_pk_bf16_f32 v45, v46, v47
  v_cvt_pk_bf16_f32 v46, v60, v61
  v_cvt_pk_bf16_f32 v47, v62, v63
  v_pk_fma_f32 v[100:101], v[200:201], v[184:185], v[100:101] op_sel:[0,0,0] op_sel_hi:[1,0,1]
  v_pk_fma_f32 v[102:103], v[202:203], v[184:185], v[102:103] op_sel:[0,0,0] op_sel_hi:[1,0,1]
  v_pk_mul_f32 v[100:101], v[100:101], v[220:221]
  v_pk_mul_f32 v[102:103], v[102:103], v[222:223]
  v_cvt_pk_bf16_f32 v100, v100, v101
  v_cvt_pk_bf16_f32 v101, v102, v103
  v_pk_fma_f32 v[76:77], v[216:217], v[184:185], v[76:77] op_sel:[0,0,0] op_sel_hi:[1,0,1]
  v_pk_fma_f32 v[78:79], v[218:219], v[184:185], v[78:79] op_sel:[0,0,0] op_sel_hi:[1,0,1]
  v_pk_fma_f32 v[92:93], v[216:217], v[184:185], v[92:93] op_sel:[0,1,0] op_sel_hi:[1,1,1]
  v_pk_fma_f32 v[94:95], v[218:219], v[184:185], v[94:95] op_sel:[0,1,0] op_sel_hi:[1,1,1]
  v_pk_mul_f32 v[76:77], v[76:77], v[236:237]
  v_pk_mul_f32 v[78:79], v[78:79], v[238:239]
  v_pk_mul_f32 v[92:93], v[92:93], v[236:237]
  v_pk_mul_f32 v[94:95], v[94:95], v[238:239]
  v_cvt_pk_bf16_f32 v148, v76, v77
  v_cvt_pk_bf16_f32 v149, v78, v79
  v_cvt_pk_bf16_f32 v158, v92, v93
  v_cvt_pk_bf16_f32 v159, v94, v95
  ds_write2st64_b64 v105, v[96:97], v[100:101] offset0:0 offset1:1
  ds_write2st64_b64 v105, v[44:45], v[148:149] offset0:4 offset1:5
  ds_write2st64_b64 v105, v[46:47], v[158:159] offset0:6 offset1:7
  s_add_u32 m0, s89, 0
  s_mov_b32 s92, 0
  buffer_load_dwordx4 v186, s[12:15], s92 offen lds
  v_pk_fma_f32 v[40:41], v[176:177], v[194:195], v[40:41] op_sel:[0,0,0] op_sel_hi:[1,0,1]
  v_pk_fma_f32 v[42:43], v[178:179], v[194:195], v[42:43] op_sel:[0,0,0] op_sel_hi:[1,0,1]
  v_pk_fma_f32 v[56:57], v[180:181], v[194:195], v[56:57] op_sel:[0,0,0] op_sel_hi:[1,0,1]
  v_pk_fma_f32 v[58:59], v[182:183], v[194:195], v[58:59] op_sel:[0,0,0] op_sel_hi:[1,0,1]
  v_pk_mul_f32 v[40:41], v[40:41], v[194:195] op_sel:[0,1] op_sel_hi:[1,1]
  v_pk_mul_f32 v[42:43], v[42:43], v[194:195] op_sel:[0,1] op_sel_hi:[1,1]
  v_pk_mul_f32 v[56:57], v[56:57], v[194:195] op_sel:[0,1] op_sel_hi:[1,1]
  v_pk_mul_f32 v[58:59], v[58:59], v[194:195] op_sel:[0,1] op_sel_hi:[1,1]
  v_cvt_pk_bf16_f32 v40, v40, v41
  v_cvt_pk_bf16_f32 v41, v42, v43
  v_cvt_pk_bf16_f32 v42, v56, v57
  v_cvt_pk_bf16_f32 v43, v58, v59
  s_add_u32 m0, s89, 4096
  s_mov_b32 s92, 65536
  buffer_load_dwordx4 v186, s[12:15], s92 offen lds
  v_pk_fma_f32 v[36:37], v[176:177], v[192:193], v[36:37] op_sel:[0,0,0] op_sel_hi:[1,0,1]
  v_pk_fma_f32 v[38:39], v[178:179], v[192:193], v[38:39] op_sel:[0,0,0] op_sel_hi:[1,0,1]
  v_pk_fma_f32 v[52:53], v[180:181], v[192:193], v[52:53] op_sel:[0,0,0] op_sel_hi:[1,0,1]
  v_pk_fma_f32 v[54:55], v[182:183], v[192:193], v[54:55] op_sel:[0,0,0] op_sel_hi:[1,0,1]
  v_pk_mul_f32 v[36:37], v[36:37], v[192:193] op_sel:[0,1] op_sel_hi:[1,1]
  v_pk_mul_f32 v[38:39], v[38:39], v[192:193] op_sel:[0,1] op_sel_hi:[1,1]
  v_pk_mul_f32 v[52:53], v[52:53], v[192:193] op_sel:[0,1] op_sel_hi:[1,1]
  v_pk_mul_f32 v[54:55], v[54:55], v[192:193] op_sel:[0,1] op_sel_hi:[1,1]
  v_cvt_pk_bf16_f32 v36, v36, v37
  v_cvt_pk_bf16_f32 v37, v38, v39
  v_cvt_pk_bf16_f32 v38, v52, v53
  v_cvt_pk_bf16_f32 v39, v54, v55
  s_add_u32 m0, s89, 8192
  s_mov_b32 s92, 131072
  buffer_load_dwordx4 v186, s[12:15], s92 offen lds
  v_pk_fma_f32 v[32:33], v[176:177], v[190:191], v[32:33] op_sel:[0,0,0] op_sel_hi:[1,0,1]
  v_pk_fma_f32 v[34:35], v[178:179], v[190:191], v[34:35] op_sel:[0,0,0] op_sel_hi:[1,0,1]
  v_pk_fma_f32 v[48:49], v[180:181], v[190:191], v[48:49] op_sel:[0,0,0] op_sel_hi:[1,0,1]
  v_pk_fma_f32 v[50:51], v[182:183], v[190:191], v[50:51] op_sel:[0,0,0] op_sel_hi:[1,0,1]
  v_pk_mul_f32 v[32:33], v[32:33], v[190:191] op_sel:[0,1] op_sel_hi:[1,1]
  v_pk_mul_f32 v[34:35], v[34:35], v[190:191] op_sel:[0,1] op_sel_hi:[1,1]
  v_pk_mul_f32 v[48:49], v[48:49], v[190:191] op_sel:[0,1] op_sel_hi:[1,1]
  v_pk_mul_f32 v[50:51], v[50:51], v[190:191] op_sel:[0,1] op_sel_hi:[1,1]
  v_cvt_pk_bf16_f32 v32, v32, v33
  v_cvt_pk_bf16_f32 v33, v34, v35
  v_cvt_pk_bf16_f32 v34, v48, v49
  v_cvt_pk_bf16_f32 v35, v50, v51
  s_waitcnt lgkmcnt(0)
  s_barrier
  ds_read_b64 v[120:121], v198
  ds_read_b64 v[122:123], v199
  ds_read_b64 v[140:141], v198 offset:512
  ds_read_b64 v[150:151], v199 offset:512
  v_mfma_f32_16x16x32_bf16 v[60:63], v[44:47], v[12:15], v[128:131]
  v_mfma_f32_16x16x32_bf16 v[28:31], v[40:43], v[12:15], v[132:135]
  v_mfma_f32_16x16x32_bf16 v[56:59], v[40:43], v[8:11], v[128:131]
  v_mfma_f32_16x16x32_bf16 v[24:27], v[36:39], v[8:11], v[132:135]
  v_mfma_f32_16x16x32_bf16 v[52:55], v[36:39], v[4:7], v[128:131]
  v_mfma_f32_16x16x32_bf16 v[20:23], v[32:35], v[4:7], v[132:135]
  v_mfma_f32_16x16x32_bf16 v[48:51], v[32:35], v[0:3], v[128:131]
  s_waitcnt lgkmcnt(0)
  v_mfma_f32_16x16x32_bf16 v[16:19], v[120:123], v[0:3], v[136:139]
  s_add_u32 m0, s89, 12288
  s_mov_b32 s92, 196608
  buffer_load_dwordx4 v186, s[12:15], s92 offen lds
  v_pk_fma_f32 v[64:65], v[204:205], v[184:185], v[64:65] op_sel:[0,0,0] op_sel_hi:[1,0,1]
  v_pk_fma_f32 v[66:67], v[206:207], v[184:185], v[66:67] op_sel:[0,0,0] op_sel_hi:[1,0,1]
  v_pk_fma_f32 v[80:81], v[204:205], v[184:185], v[80:81] op_sel:[0,1,0] op_sel_hi:[1,1,1]
  v_pk_fma_f32 v[82:83], v[206:207], v[184:185], v[82:83] op_sel:[0,1,0] op_sel_hi:[1,1,1]
  v_pk_mul_f32 v[64:65], v[64:65], v[224:225]
  v_pk_mul_f32 v[66:67], v[66:67], v[226:227]
  v_pk_mul_f32 v[80:81], v[80:81], v[224:225]
  v_pk_mul_f32 v[82:83], v[82:83], v[226:227]
  v_cvt_pk_bf16_f32 v142, v64, v65
  v_cvt_pk_bf16_f32 v143, v66, v67
  v_cvt_pk_bf16_f32 v152, v80, v81
  v_cvt_pk_bf16_f32 v153, v82, v83
  s_add_u32 m0, s89, 16384
  s_mov_b32 s92, 262144
  buffer_load_dwordx4 v186, s[12:15], s92 offen lds
  v_pk_fma_f32 v[68:69], v[208:209], v[184:185], v[68:69] op_sel:[0,0,0] op_sel_hi:[1,0,1]
  v_pk_fma_f32 v[70:71], v[210:211], v[184:185], v[70:71] op_sel:[0,0,0] op_sel_hi:[1,0,1]
  v_pk_fma_f32 v[84:85], v[208:209], v[184:185], v[84:85] op_sel:[0,1,0] op_sel_hi:[1,1,1]
  v_pk_fma_f32 v[86:87], v[210:211], v[184:185], v[86:87] op_sel:[0,1,0] op_sel_hi:[1,1,1]
  v_pk_mul_f32 v[68:69], v[68:69], v[228:229]
  v_pk_mul_f32 v[70:71], v[70:71], v[230:231]
  v_pk_mul_f32 v[84:85], v[84:85], v[228:229]
  v_pk_mul_f32 v[86:87], v[86:87], v[230:231]
  v_cvt_pk_bf16_f32 v144, v68, v69
  v_cvt_pk_bf16_f32 v145, v70, v71
  v_cvt_pk_bf16_f32 v154, v84, v85
  v_cvt_pk_bf16_f32 v155, v86, v87
  s_add_u32 m0, s89, 20480
  s_mov_b32 s92, 327680
  buffer_load_dwordx4 v186, s[12:15], s92 offen lds
  v_pk_fma_f32 v[72:73], v[212:213], v[184:185], v[72:73] op_sel:[0,0,0] op_sel_hi:[1,0,1]
  v_pk_fma_f32 v[74:75], v[214:215], v[184:185], v[74:75] op_sel:[0,0,0] op_sel_hi:[1,0,1]
  v_pk_fma_f32 v[88:89], v[212:213], v[184:185], v[88:89] op_sel:[0,1,0] op_sel_hi:[1,1,1]
  v_pk_fma_f32 v[90:91], v[214:215], v[184:185], v[90:91] op_sel:[0,1,0] op_sel_hi:[1,1,1]
  v_pk_mul_f32 v[72:73], v[72:73], v[232:233]
  v_pk_mul_f32 v[74:75], v[74:75], v[234:235]
  v_pk_mul_f32 v[88:89], v[88:89], v[232:233]
  v_pk_mul_f32 v[90:91], v[90:91], v[234:235]
  v_cvt_pk_bf16_f32 v146, v72, v73
  v_cvt_pk_bf16_f32 v147, v74, v75
  v_cvt_pk_bf16_f32 v156, v88, v89
  v_cvt_pk_bf16_f32 v157, v90, v91
  s_add_u32 m0, s89, 24576
  s_mov_b32 s92, 393216
  buffer_load_dwordx4 v186, s[12:15], s92 offen lds
  s_cmp_eq_u32 s57, 0
  s_cbranch_scc1 Lp1_nsw
  v_swap_b32 v140, v150
  v_swap_b32 v141, v151
  v_swap_b32 v142, v152
  v_swap_b32 v143, v153
  v_swap_b32 v144, v154
  v_swap_b32 v145, v155
  v_swap_b32 v146, v156
  v_swap_b32 v147, v157
  v_swap_b32 v148, v158
  v_swap_b32 v149, v159
Lp1_nsw:
  v_max3_f32 v240, v16, v17, v18
  v_max3_f32 v241, v20, v21, v22
  v_max3_f32 v242, v24, v25, v26
  v_max3_f32 v243, v28, v29, v30
  v_max3_f32 v240, v240, v19, v48
  v_max3_f32 v241, v241, v23, v52
  v_max3_f32 v242, v242, v27, v56
  v_max3_f32 v243, v243, v31, v60
  v_max3_f32 v240, v240, v49, v50
  v_max3_f32 v241, v241, v53, v54
  v_max3_f32 v242, v242, v57, v58
  v_max3_f32 v243, v243, v61, v62
  v_max_f32 v240, v240, v51
  v_max_f32 v241, v241, v55
  v_max_f32 v242, v242, v59
  v_max_f32 v243, v243, v63
  v_mov_b32 v244, v240
  v_mov_b32 v245, v241
  v_mov_b32 v246, v242
  v_mov_b32 v247, v243
  v_permlane32_swap_b32 v240, v244
  v_permlane32_swap_b32 v241, v245
  v_permlane32_swap_b32 v242, v246
  v_permlane32_swap_b32 v243, v247
  v_max_f32 v240, v240, v244
  v_max_f32 v241, v241, v245
  v_max_f32 v242, v242, v246
  v_max_f32 v243, v243, v247
  v_mov_b32 v244, v240
  v_mov_b32 v245, v241
  v_mov_b32 v246, v242
  v_mov_b32 v247, v243
  v_permlane16_swap_b32 v240, v244
  v_permlane16_swap_b32 v241, v245
  v_permlane16_swap_b32 v242, v246
  v_permlane16_swap_b32 v243, v247
  v_max_f32 v240, v240, v244
  v_max_f32 v241, v241, v245
  v_max_f32 v242, v242, v246
  v_max_f32 v243, v243, v247
  v_pk_mul_f32 v[240:241], v[240:241], v[108:109] neg_lo:[0,1] neg_hi:[0,1]
  v_pk_mul_f32 v[242:243], v[242:243], v[110:111] neg_lo:[0,1] neg_hi:[0,1]
  v_pk_fma_f32 v[16:17], v[16:17], v[108:109], v[240:241] op_sel:[0,0,0] op_sel_hi:[1,0,0]
  v_pk_fma_f32 v[18:19], v[18:19], v[108:109], v[240:241] op_sel:[0,0,0] op_sel_hi:[1,0,0]
  v_pk_fma_f32 v[48:49], v[48:49], v[108:109], v[240:241] op_sel:[0,0,0] op_sel_hi:[1,0,0]
  v_pk_fma_f32 v[50:51], v[50:51], v[108:109], v[240:241] op_sel:[0,0,0] op_sel_hi:[1,0,0]
  v_exp_f32 v16, v16
  v_exp_f32 v17, v17
  v_exp_f32 v18, v18
  v_exp_f32 v19, v19
  v_exp_f32 v48, v48
  v_exp_f32 v49, v49
  v_exp_f32 v50, v50
  v_exp_f32 v51, v51
  v_cvt_pk_bf16_f32 v0, v16, v17
  v_cvt_pk_bf16_f32 v1, v18, v19
  v_cvt_pk_bf16_f32 v2, v48, v49
  v_cvt_pk_bf16_f32 v3, v50, v51
  s_add_u32 m0, s89, 28672
  s_mov_b32 s92, 458752
  buffer_load_dwordx4 v186, s[12:15], s92 offen lds
  v_pk_fma_f32 v[20:21], v[20:21], v[108:109], v[240:241] op_sel:[0,1,1] op_sel_hi:[1,1,1]
  v_pk_fma_f32 v[22:23], v[22:23], v[108:109], v[240:241] op_sel:[0,1,1] op_sel_hi:[1,1,1]
  v_pk_fma_f32 v[52:53], v[52:53], v[108:109], v[240:241] op_sel:[0,1,1] op_sel_hi:[1,1,1]
  v_pk_fma_f32 v[54:55], v[54:55], v[108:109], v[240:241] op_sel:[0,1,1] op_sel_hi:[1,1,1]
  v_exp_f32 v20, v20
  v_exp_f32 v21, v21
  v_exp_f32 v22, v22
  v_exp_f32 v23, v23
  v_exp_f32 v52, v52
  v_exp_f32 v53, v53
  v_exp_f32 v54, v54
  v_exp_f32 v55, v55
  v_cvt_pk_bf16_f32 v4, v20, v21
  v_cvt_pk_bf16_f32 v5, v22, v23
  v_cvt_pk_bf16_f32 v6, v52, v53
  v_cvt_pk_bf16_f32 v7, v54, v55
  s_add_u32 m0, s89, 32768
  s_mov_b32 s92, 524288
  buffer_load_dwordx4 v186, s[12:15], s92 offen lds
  v_pk_fma_f32 v[24:25], v[24:25], v[110:111], v[242:243] op_sel:[0,0,0] op_sel_hi:[1,0,0]
  v_pk_fma_f32 v[26:27], v[26:27], v[110:111], v[242:243] op_sel:[0,0,0] op_sel_hi:[1,0,0]
  v_pk_fma_f32 v[56:57], v[56:57], v[110:111], v[242:243] op_sel:[0,0,0] op_sel_hi:[1,0,0]
  v_pk_fma_f32 v[58:59], v[58:59], v[110:111], v[242:243] op_sel:[0,0,0] op_sel_hi:[1,0,0]
  v_exp_f32 v24, v24
  v_exp_f32 v25, v25
  v_exp_f32 v26, v26
  v_exp_f32 v27, v27
  v_exp_f32 v56, v56
  v_exp_f32 v57, v57
  v_exp_f32 v58, v58
  v_exp_f32 v59, v59
  v_cvt_pk_bf16_f32 v8, v24, v25
  v_cvt_pk_bf16_f32 v9, v26, v27
  v_cvt_pk_bf16_f32 v10, v56, v57
  v_cvt_pk_bf16_f32 v11, v58, v59
  v_pk_fma_f32 v[28:29], v[28:29], v[110:111], v[242:243] op_sel:[0,1,1] op_sel_hi:[1,1,1]
  v_pk_fma_f32 v[30:31], v[30:31], v[110:111], v[242:243] op_sel:[0,1,1] op_sel_hi:[1,1,1]
  v_pk_fma_f32 v[60:61], v[60:61], v[110:111], v[242:243] op_sel:[0,1,1] op_sel_hi:[1,1,1]
  v_pk_fma_f32 v[62:63], v[62:63], v[110:111], v[242:243] op_sel:[0,1,1] op_sel_hi:[1,1,1]
  v_exp_f32 v28, v28
  v_exp_f32 v29, v29
  v_exp_f32 v30, v30
  v_exp_f32 v31, v31
  v_exp_f32 v60, v60
  v_exp_f32 v61, v61
  v_exp_f32 v62, v62
  v_exp_f32 v63, v63
  v_cvt_pk_bf16_f32 v12, v28, v29
  v_cvt_pk_bf16_f32 v13, v30, v31
  v_cvt_pk_bf16_f32 v14, v60, v61
  v_cvt_pk_bf16_f32 v15, v62, v63
  s_add_u32 m0, s89, 36864
  s_mov_b32 s92, 589824
  buffer_load_dwordx4 v186, s[12:15], s92 offen lds
  v_mfma_f32_16x16x32_bf16 v[32:35], v[160:163], v[0:3], 0
  s_lshl_b32 s43, s74, 15
  s_lshl_b32 s44, s75, 10
  v_mfma_f32_16x16x32_bf16 v[36:39], v[160:163], v[4:7], 0
  s_add_u32 s43, s43, s44
  s_add_u32 s43, s43, s42
  v_mfma_f32_16x16x32_bf16 v[40:43], v[160:163], v[8:11], 0
  s_add_u32 s46, s43, 8388608
  s_add_u32 s47, s46, 32768
  v_mfma_f32_16x16x32_bf16 v[44:47], v[160:163], v[12:15], 0
  s_add_u32 s48, s47, 32768
  s_add_u32 s49, s48, 32768
  v_mfma_f32_16x16x32_bf16 v[64:67], v[140:143], v[0:3], 0
  s_lshl_b32 s77, s50, 1
  v_mfma_f32_16x16x32_bf16 v[80:83], v[150:153], v[0:3], 0
  s_lshr_b32 s43, s51, 3
  v_mfma_f32_16x16x32_bf16 v[68:71], v[142:145], v[4:7], 0
  s_add_u32 s77, s77, s43
  v_mfma_f32_16x16x32_bf16 v[84:87], v[152:155], v[4:7], 0
  s_lshl_b32 s77, s77, 7
  v_mfma_f32_16x16x32_bf16 v[72:75], v[144:147], v[8:11], 0
  s_add_u32 s77, s77, s42
  v_rcp_f32 v32, v32
  v_mfma_f32_16x16x32_bf16 v[88:91], v[154:157], v[8:11], 0
  s_add_u32 s77, s77, 27787264
  v_rcp_f32 v36, v36
  v_mfma_f32_16x16x32_bf16 v[76:79], v[146:149], v[12:15], 0
  v_rcp_f32 v40, v40
  v_mfma_f32_16x16x32_bf16 v[92:95], v[156:159], v[12:15], 0
  v_rcp_f32 v44, v44
  v_pk_mul_f32 v[64:65], v[64:65], v[32:33] op_sel:[0,0] op_sel_hi:[1,0]
  v_pk_mul_f32 v[66:67], v[66:67], v[32:33] op_sel:[0,0] op_sel_hi:[1,0]
  v_pk_mul_f32 v[80:81], v[80:81], v[32:33] op_sel:[0,0] op_sel_hi:[1,0]
  v_pk_mul_f32 v[82:83], v[82:83], v[32:33] op_sel:[0,0] op_sel_hi:[1,0]
  v_cvt_pk_bf16_f32 v16, v64, v65
  v_cvt_pk_bf16_f32 v17, v66, v67
  v_cvt_pk_bf16_f32 v18, v80, v81
  v_cvt_pk_bf16_f32 v19, v82, v83
  buffer_store_dwordx4 v[16:19], v104, s[4:7], s46 offen sc1
  v_pk_mul_f32 v[68:69], v[68:69], v[36:37] op_sel:[0,0] op_sel_hi:[1,0]
  v_pk_mul_f32 v[70:71], v[70:71], v[36:37] op_sel:[0,0] op_sel_hi:[1,0]
  v_pk_mul_f32 v[84:85], v[84:85], v[36:37] op_sel:[0,0] op_sel_hi:[1,0]
  v_pk_mul_f32 v[86:87], v[86:87], v[36:37] op_sel:[0,0] op_sel_hi:[1,0]
  v_cvt_pk_bf16_f32 v20, v68, v69
  v_cvt_pk_bf16_f32 v21, v70, v71
  v_cvt_pk_bf16_f32 v22, v84, v85
  v_cvt_pk_bf16_f32 v23, v86, v87
  buffer_store_dwordx4 v[20:23], v104, s[4:7], s47 offen sc1
  v_pk_mul_f32 v[72:73], v[72:73], v[40:41] op_sel:[0,0] op_sel_hi:[1,0]
  v_pk_mul_f32 v[74:75], v[74:75], v[40:41] op_sel:[0,0] op_sel_hi:[1,0]
  v_pk_mul_f32 v[88:89], v[88:89], v[40:41] op_sel:[0,0] op_sel_hi:[1,0]
  v_pk_mul_f32 v[90:91], v[90:91], v[40:41] op_sel:[0,0] op_sel_hi:[1,0]
  v_cvt_pk_bf16_f32 v24, v72, v73
  v_cvt_pk_bf16_f32 v25, v74, v75
  v_cvt_pk_bf16_f32 v26, v88, v89
  v_cvt_pk_bf16_f32 v27, v90, v91
  buffer_store_dwordx4 v[24:27], v104, s[4:7], s48 offen sc1
  v_pk_mul_f32 v[76:77], v[76:77], v[44:45] op_sel:[0,0] op_sel_hi:[1,0]
  v_pk_mul_f32 v[78:79], v[78:79], v[44:45] op_sel:[0,0] op_sel_hi:[1,0]
  v_pk_mul_f32 v[92:93], v[92:93], v[44:45] op_sel:[0,0] op_sel_hi:[1,0]
  v_pk_mul_f32 v[94:95], v[94:95], v[44:45] op_sel:[0,0] op_sel_hi:[1,0]
  v_cvt_pk_bf16_f32 v28, v76, v77
  v_cvt_pk_bf16_f32 v29, v78, v79
  v_cvt_pk_bf16_f32 v30, v92, v93
  v_cvt_pk_bf16_f32 v31, v94, v95
  buffer_store_dwordx4 v[28:31], v104, s[4:7], s49 offen sc1
Lmk_p1end:
  s_lshl_b32 s44, s52, 3
  s_lshl_b32 s43, s40, 1
  s_add_u32 s44, s44, s43
  s_lshl_b32 s45, s44, 15
  s_add_u32 s57, s45, s42
  s_add_u32 s57, s57, 8388608
  s_lshl_b32 s43, s53, 11
  s_add_u32 s45, s45, s43
  s_add_u32 s45, s45, s42
  s_add_u32 s58, s45, 4194304
  s_add_u32 s59, s58, 32768
  s_lshl_b32 s44, s44, 11
  s_lshl_b32 s43, s53, 7
  s_add_u32 s44, s44, s43
  s_add_u32 s44, s44, s42
  s_add_u32 s60, s44, 27525120
  v_lshlrev_b32 v48, 4, v253
  v_add_u32 v49, 32768, v48
  s_cmp_eq_u32 s41, 0
  s_cselect_b32 s44, 32, 8
  s_cselect_b32 s45, 64, 0x400
  s_lshl_b32 s43, s40, 12
  s_add_u32 s43, s43, 90112
  v_xor_b32 v3, s44, v187
  v_xor_b32 v4, s45, v187
  v_xor_b32 v5, s45, v3
  v_add_u32 v2, s43, v187
  v_add_u32 v3, s43, v3
  v_add_u32 v4, s43, v4
  v_add_u32 v5, s43, v5
  s_waitcnt vmcnt(22)
  ds_read_b64 v[52:53], v2 offset:0
  ds_read_b64 v[54:55], v3 offset:0
  ds_read_b64 v[56:57], v4 offset:0
  ds_read_b64 v[58:59], v5 offset:0
  ds_read_b64 v[60:61], v2 offset:2048
  ds_read_b64 v[62:63], v3 offset:2048
  ds_read_b64 v[64:65], v4 offset:2048
  ds_read_b64 v[66:67], v5 offset:2048
  v_lshrrev_b32 v2, 2, v253
  v_bfe_u32 v3, v253, 3, 2
  v_and_b32 v4, 3, v253
  v_lshlrev_b32 v4, 3, v4
  v_lshl_add_u32 v4, v2, 7, v4
  v_xor_b32 v5, 0, v3
  v_lshl_add_u32 v40, v5, 5, v4
  v_xor_b32 v5, 1, v3
  v_lshl_add_u32 v41, v5, 5, v4
  v_xor_b32 v5, 2, v3
  v_lshl_add_u32 v42, v5, 5, v4
  v_xor_b32 v5, 3, v3
  v_lshl_add_u32 v43, v5, 5, v4
  s_cmp_eq_u32 s3, 0
  s_cbranch_scc1 Lsd6
  v_accvgpr_read_b32 v236, a176
  v_accvgpr_read_b32 v237, a177
  v_accvgpr_read_b32 v238, a178
  v_accvgpr_read_b32 v239, a179
  v_lshlrev_b32 v224, 16, v236
  v_and_b32 v225, 0xffff0000, v236
  v_lshlrev_b32 v226, 16, v237
  v_and_b32 v227, 0xffff0000, v237
  v_lshlrev_b32 v228, 16, v238
  v_and_b32 v229, 0xffff0000, v238
  v_lshlrev_b32 v230, 16, v239
  v_and_b32 v231, 0xffff0000, v239
  v_accvgpr_read_b32 v236, a180
  v_accvgpr_read_b32 v237, a181
  v_accvgpr_read_b32 v238, a182
  v_accvgpr_read_b32 v239, a183
  v_lshlrev_b32 v232, 16, v236
  v_and_b32 v233, 0xffff0000, v236
  v_pk_add_f32 v[224:225], v[224:225], v[232:233]
  v_lshlrev_b32 v232, 16, v237
  v_and_b32 v233, 0xffff0000, v237
  v_pk_add_f32 v[226:227], v[226:227], v[232:233]
  v_lshlrev_b32 v232, 16, v238
  v_and_b32 v233, 0xffff0000, v238
  v_pk_add_f32 v[228:229], v[228:229], v[232:233]
  v_lshlrev_b32 v232, 16, v239
  v_and_b32 v233, 0xffff0000, v239
  v_pk_add_f32 v[230:231], v[230:231], v[232:233]
  v_accvgpr_read_b32 v236, a184
  v_accvgpr_read_b32 v237, a185
  v_accvgpr_read_b32 v238, a186
  v_accvgpr_read_b32 v239, a187
  v_lshlrev_b32 v232, 16, v236
  v_and_b32 v233, 0xffff0000, v236
  v_pk_add_f32 v[224:225], v[224:225], v[232:233]
  v_lshlrev_b32 v232, 16, v237
  v_and_b32 v233, 0xffff0000, v237
  v_pk_add_f32 v[226:227], v[226:227], v[232:233]
  v_lshlrev_b32 v232, 16, v238
  v_and_b32 v233, 0xffff0000, v238
  v_pk_add_f32 v[228:229], v[228:229], v[232:233]
  v_lshlrev_b32 v232, 16, v239
  v_and_b32 v233, 0xffff0000, v239
  v_pk_add_f32 v[230:231], v[230:231], v[232:233]
  v_accvgpr_read_b32 v236, a188
  v_accvgpr_read_b32 v237, a189
  v_accvgpr_read_b32 v238, a190
  v_accvgpr_read_b32 v239, a191
  v_lshlrev_b32 v232, 16, v236
  v_and_b32 v233, 0xffff0000, v236
  v_pk_add_f32 v[224:225], v[224:225], v[232:233]
  v_lshlrev_b32 v232, 16, v237
  v_and_b32 v233, 0xffff0000, v237
  v_pk_add_f32 v[226:227], v[226:227], v[232:233]
  v_lshlrev_b32 v232, 16, v238
  v_and_b32 v233, 0xffff0000, v238
  v_pk_add_f32 v[228:229], v[228:229], v[232:233]
  v_lshlrev_b32 v232, 16, v239
  v_and_b32 v233, 0xffff0000, v239
  v_pk_add_f32 v[230:231], v[230:231], v[232:233]
  v_accvgpr_read_b32 v236, a192
  v_accvgpr_read_b32 v237, a193
  v_accvgpr_read_b32 v238, a194
  v_accvgpr_read_b32 v239, a195
  v_lshlrev_b32 v232, 16, v236
  v_and_b32 v233, 0xffff0000, v236
  v_pk_add_f32 v[224:225], v[224:225], v[232:233]
  v_lshlrev_b32 v232, 16, v237
  v_and_b32 v233, 0xffff0000, v237
  v_pk_add_f32 v[226:227], v[226:227], v[232:233]
  v_lshlrev_b32 v232, 16, v238
  v_and_b32 v233, 0xffff0000, v238
  v_pk_add_f32 v[228:229], v[228:229], v[232:233]
  v_lshlrev_b32 v232, 16, v239
  v_and_b32 v233, 0xffff0000, v239
  v_pk_add_f32 v[230:231], v[230:231], v[232:233]
  v_accvgpr_read_b32 v236, a196
  v_accvgpr_read_b32 v237, a197
  v_accvgpr_read_b32 v238, a198
  v_accvgpr_read_b32 v239, a199
  v_lshlrev_b32 v232, 16, v236
  v_and_b32 v233, 0xffff0000, v236
  v_pk_add_f32 v[224:225], v[224:225], v[232:233]
  v_lshlrev_b32 v232, 16, v237
  v_and_b32 v233, 0xffff0000, v237
  v_pk_add_f32 v[226:227], v[226:227], v[232:233]
  v_lshlrev_b32 v232, 16, v238
  v_and_b32 v233, 0xffff0000, v238
  v_pk_add_f32 v[228:229], v[228:229], v[232:233]
  v_lshlrev_b32 v232, 16, v239
  v_and_b32 v233, 0xffff0000, v239
  v_pk_add_f32 v[230:231], v[230:231], v[232:233]
  v_accvgpr_read_b32 v236, a200
  v_accvgpr_read_b32 v237, a201
  v_accvgpr_read_b32 v238, a202
  v_accvgpr_read_b32 v239, a203
  v_lshlrev_b32 v232, 16, v236
  v_and_b32 v233, 0xffff0000, v236
  v_pk_add_f32 v[224:225], v[224:225], v[232:233]
  v_lshlrev_b32 v232, 16, v237
  v_and_b32 v233, 0xffff0000, v237
  v_pk_add_f32 v[226:227], v[226:227], v[232:233]
  v_lshlrev_b32 v232, 16, v238
  v_and_b32 v233, 0xffff0000, v238
  v_pk_add_f32 v[228:229], v[228:229], v[232:233]
  v_lshlrev_b32 v232, 16, v239
  v_and_b32 v233, 0xffff0000, v239
  v_pk_add_f32 v[230:231], v[230:231], v[232:233]
  v_accvgpr_read_b32 v236, a204
  v_accvgpr_read_b32 v237, a205
  v_accvgpr_read_b32 v238, a206
  v_accvgpr_read_b32 v239, a207
  v_lshlrev_b32 v232, 16, v236
  v_and_b32 v233, 0xffff0000, v236
  v_pk_add_f32 v[224:225], v[224:225], v[232:233]
  v_lshlrev_b32 v232, 16, v237
  v_and_b32 v233, 0xffff0000, v237
  v_pk_add_f32 v[226:227], v[226:227], v[232:233]
  v_lshlrev_b32 v232, 16, v238
  v_and_b32 v233, 0xffff0000, v238
  v_pk_add_f32 v[228:229], v[228:229], v[232:233]
  v_lshlrev_b32 v232, 16, v239
  v_and_b32 v233, 0xffff0000, v239
  v_pk_add_f32 v[230:231], v[230:231], v[232:233]
Lsd6:
  s_waitcnt lgkmcnt(0)
  s_waitcnt vmcnt(0)
  s_barrier
  s_cmp_lg_u32 s40, 0
  s_cbranch_scc1 Lsig5
  v_mov_b32 v250, 1
  s_mov_b64 exec, 1
  buffer_atomic_add v250, v251, s[4:7], s77 offen sc1
  s_mov_b64 exec, -1
Lsig5:
  s_add_u32 m0, s89, 73728
  s_mov_b32 s92, 1179648
  buffer_load_dwordx4 v186, s[12:15], s92 offen lds
  s_add_u32 m0, s89, 77824
  s_mov_b32 s92, 1245184
  buffer_load_dwordx4 v186, s[12:15], s92 offen lds
  s_add_u32 m0, s89, 81920
  s_mov_b32 s92, 1310720
  buffer_load_dwordx4 v186, s[12:15], s92 offen lds
  s_add_u32 m0, s89, 86016
  s_mov_b32 s92, 1376256
  buffer_load_dwordx4 v186, s[12:15], s92 offen lds
  s_add_u32 m0, s89, 90112
  s_mov_b32 s92, 1441792
  buffer_load_dwordx4 v186, s[12:15], s92 offen lds
  s_add_u32 m0, s89, 94208
  s_mov_b32 s92, 1507328
  buffer_load_dwordx4 v186, s[12:15], s92 offen lds
  s_add_u32 m0, s89, 98304
  s_mov_b32 s92, 1572864
  buffer_load_dwordx4 v186, s[12:15], s92 offen lds
  s_add_u32 m0, s89, 102400
  s_mov_b32 s92, 1638400
  buffer_load_dwordx4 v186, s[12:15], s92 offen lds
  s_add_u32 m0, s89, 106496
  s_mov_b32 s92, 1703936
  buffer_load_dwordx4 v186, s[12:15], s92 offen lds
  s_add_u32 m0, s89, 110592
  s_mov_b32 s92, 1769472
  buffer_load_dwordx4 v186, s[12:15], s92 offen lds
  s_add_u32 m0, s89, 114688
  s_mov_b32 s92, 1835008
  buffer_load_dwordx4 v186, s[12:15], s92 offen lds
  s_add_u32 m0, s89, 118784
  s_mov_b32 s92, 1900544
  buffer_load_dwordx4 v186, s[12:15], s92 offen lds
  s_add_u32 m0, s89, 122880
  s_mov_b32 s92, 1966080
  buffer_load_dwordx4 v186, s[12:15], s92 offen lds
  s_add_u32 m0, s89, 126976
  s_mov_b32 s92, 2031616
  buffer_load_dwordx4 v186, s[12:15], s92 offen lds
  v_lshlrev_b32 v0, 16, v52
  v_and_b32 v1, 0xffff0000, v52
  v_lshlrev_b32 v2, 16, v53
  v_and_b32 v3, 0xffff0000, v53
  v_lshlrev_b32 v8, 16, v54
  v_and_b32 v9, 0xffff0000, v54
  v_lshlrev_b32 v10, 16, v55
  v_and_b32 v11, 0xffff0000, v55
  v_lshlrev_b32 v16, 16, v56
  v_and_b32 v17, 0xffff0000, v56
  v_lshlrev_b32 v18, 16, v57
  v_and_b32 v19, 0xffff0000, v57
  v_lshlrev_b32 v24, 16, v58
  v_and_b32 v25, 0xffff0000, v58
  v_lshlrev_b32 v26, 16, v59
  v_and_b32 v27, 0xffff0000, v59
  v_lshlrev_b32 v4, 16, v60
  v_and_b32 v5, 0xffff0000, v60
  v_lshlrev_b32 v6, 16, v61
  v_and_b32 v7, 0xffff0000, v61
  v_lshlrev_b32 v12, 16, v62
  v_and_b32 v13, 0xffff0000, v62
  v_lshlrev_b32 v14, 16, v63
  v_and_b32 v15, 0xffff0000, v63
  v_lshlrev_b32 v20, 16, v64
  v_and_b32 v21, 0xffff0000, v64
  v_lshlrev_b32 v22, 16, v65
  v_and_b32 v23, 0xffff0000, v65
  v_lshlrev_b32 v28, 16, v66
  v_and_b32 v29, 0xffff0000, v66
  v_lshlrev_b32 v30, 16, v67
  v_and_b32 v31, 0xffff0000, v67
  v_and_b32 v92, 15, v253
  v_lshrrev_b32 v93, 4, v253
  v_lshrrev_b32 v72, 2, v92
  v_cmp_eq_u32 vcc, v72, v93
  v_and_b32 v72, 3, v92
  v_lshlrev_b32 v92, 3, v92
  v_mov_b32 v93, 0x7ffffff0
  v_cndmask_b32 v92, v93, v92, vcc
  v_cmp_eq_u32 s[64:65], 1, v72
  v_cmp_eq_u32 s[66:67], 2, v72
  v_cmp_eq_u32 s[68:69], 3, v72
  v_mov_b32 v72, 0x3f803f80
  v_mov_b32 v73, 0x3f803f80
  v_mov_b32 v74, 0x3f803f80
  v_mov_b32 v75, 0x3f803f80
  s_cmp_eq_u32 s3, 0
  s_cbranch_scc1 Lsd7
  v_accvgpr_read_b32 v236, a208
  v_accvgpr_read_b32 v237, a209
  v_accvgpr_read_b32 v238, a210
  v_accvgpr_read_b32 v239, a211
  v_lshlrev_b32 v232, 16, v236
  v_and_b32 v233, 0xffff0000, v236
  v_pk_add_f32 v[224:225], v[224:225], v[232:233]
  v_lshlrev_b32 v232, 16, v237
  v_and_b32 v233, 0xffff0000, v237
  v_pk_add_f32 v[226:227], v[226:227], v[232:233]
  v_lshlrev_b32 v232, 16, v238
  v_and_b32 v233, 0xffff0000, v238
  v_pk_add_f32 v[228:229], v[228:229], v[232:233]
  v_lshlrev_b32 v232, 16, v239
  v_and_b32 v233, 0xffff0000, v239
  v_pk_add_f32 v[230:231], v[230:231], v[232:233]
  v_accvgpr_read_b32 v236, a212
  v_accvgpr_read_b32 v237, a213
  v_accvgpr_read_b32 v238, a214
  v_accvgpr_read_b32 v239, a215
  v_lshlrev_b32 v232, 16, v236
  v_and_b32 v233, 0xffff0000, v236
  v_pk_add_f32 v[224:225], v[224:225], v[232:233]
  v_lshlrev_b32 v232, 16, v237
  v_and_b32 v233, 0xffff0000, v237
  v_pk_add_f32 v[226:227], v[226:227], v[232:233]
  v_lshlrev_b32 v232, 16, v238
  v_and_b32 v233, 0xffff0000, v238
  v_pk_add_f32 v[228:229], v[228:229], v[232:233]
  v_lshlrev_b32 v232, 16, v239
  v_and_b32 v233, 0xffff0000, v239
  v_pk_add_f32 v[230:231], v[230:231], v[232:233]
  v_accvgpr_read_b32 v236, a216
  v_accvgpr_read_b32 v237, a217
  v_accvgpr_read_b32 v238, a218
  v_accvgpr_read_b32 v239, a219
  v_lshlrev_b32 v232, 16, v236
  v_and_b32 v233, 0xffff0000, v236
  v_pk_add_f32 v[224:225], v[224:225], v[232:233]
  v_lshlrev_b32 v232, 16, v237
  v_and_b32 v233, 0xffff0000, v237
  v_pk_add_f32 v[226:227], v[226:227], v[232:233]
  v_lshlrev_b32 v232, 16, v238
  v_and_b32 v233, 0xffff0000, v238
  v_pk_add_f32 v[228:229], v[228:229], v[232:233]
  v_lshlrev_b32 v232, 16, v239
  v_and_b32 v233, 0xffff0000, v239
  v_pk_add_f32 v[230:231], v[230:231], v[232:233]
  v_accvgpr_read_b32 v236, a220
  v_accvgpr_read_b32 v237, a221
  v_accvgpr_read_b32 v238, a222
  v_accvgpr_read_b32 v239, a223
  v_lshlrev_b32 v232, 16, v236
  v_and_b32 v233, 0xffff0000, v236
  v_pk_add_f32 v[224:225], v[224:225], v[232:233]
  v_lshlrev_b32 v232, 16, v237
  v_and_b32 v233, 0xffff0000, v237
  v_pk_add_f32 v[226:227], v[226:227], v[232:233]
  v_lshlrev_b32 v232, 16, v238
  v_and_b32 v233, 0xffff0000, v238
  v_pk_add_f32 v[228:229], v[228:229], v[232:233]
  v_lshlrev_b32 v232, 16, v239
  v_and_b32 v233, 0xffff0000, v239
  v_pk_add_f32 v[230:231], v[230:231], v[232:233]
  v_accvgpr_read_b32 v236, a224
  v_accvgpr_read_b32 v237, a225
  v_accvgpr_read_b32 v238, a226
  v_accvgpr_read_b32 v239, a227
  v_lshlrev_b32 v232, 16, v236
  v_and_b32 v233, 0xffff0000, v236
  v_pk_add_f32 v[224:225], v[224:225], v[232:233]
  v_lshlrev_b32 v232, 16, v237
  v_and_b32 v233, 0xffff0000, v237
  v_pk_add_f32 v[226:227], v[226:227], v[232:233]
  v_lshlrev_b32 v232, 16, v238
  v_and_b32 v233, 0xffff0000, v238
  v_pk_add_f32 v[228:229], v[228:229], v[232:233]
  v_lshlrev_b32 v232, 16, v239
  v_and_b32 v233, 0xffff0000, v239
  v_pk_add_f32 v[230:231], v[230:231], v[232:233]
  v_accvgpr_read_b32 v236, a228
  v_accvgpr_read_b32 v237, a229
  v_accvgpr_read_b32 v238, a230
  v_accvgpr_read_b32 v239, a231
  v_lshlrev_b32 v232, 16, v236
  v_and_b32 v233, 0xffff0000, v236
  v_pk_add_f32 v[224:225], v[224:225], v[232:233]
  v_lshlrev_b32 v232, 16, v237
  v_and_b32 v233, 0xffff0000, v237
  v_pk_add_f32 v[226:227], v[226:227], v[232:233]
  v_lshlrev_b32 v232, 16, v238
  v_and_b32 v233, 0xffff0000, v238
  v_pk_add_f32 v[228:229], v[228:229], v[232:233]
  v_lshlrev_b32 v232, 16, v239
  v_and_b32 v233, 0xffff0000, v239
  v_pk_add_f32 v[230:231], v[230:231], v[232:233]
  v_accvgpr_read_b32 v236, a232
  v_accvgpr_read_b32 v237, a233
  v_accvgpr_read_b32 v238, a234
  v_accvgpr_read_b32 v239, a235
  v_lshlrev_b32 v232, 16, v236
  v_and_b32 v233, 0xffff0000, v236
  v_pk_add_f32 v[224:225], v[224:225], v[232:233]
  v_lshlrev_b32 v232, 16, v237
  v_and_b32 v233, 0xffff0000, v237
  v_pk_add_f32 v[226:227], v[226:227], v[232:233]
  v_lshlrev_b32 v232, 16, v238
  v_and_b32 v233, 0xffff0000, v238
  v_pk_add_f32 v[228:229], v[228:229], v[232:233]
  v_lshlrev_b32 v232, 16, v239
  v_and_b32 v233, 0xffff0000, v239
  v_pk_add_f32 v[230:231], v[230:231], v[232:233]
  v_accvgpr_read_b32 v236, a236
  v_accvgpr_read_b32 v237, a237
  v_accvgpr_read_b32 v238, a238
  v_accvgpr_read_b32 v239, a239
  v_lshlrev_b32 v232, 16, v236
  v_and_b32 v233, 0xffff0000, v236
  v_pk_add_f32 v[224:225], v[224:225], v[232:233]
  v_lshlrev_b32 v232, 16, v237
  v_and_b32 v233, 0xffff0000, v237
  v_pk_add_f32 v[226:227], v[226:227], v[232:233]
  v_lshlrev_b32 v232, 16, v238
  v_and_b32 v233, 0xffff0000, v238
  v_pk_add_f32 v[228:229], v[228:229], v[232:233]
  v_lshlrev_b32 v232, 16, v239
  v_and_b32 v233, 0xffff0000, v239
  v_pk_add_f32 v[230:231], v[230:231], v[232:233]
  v_mov_b32 v232, v224
  v_mov_b32 v233, v225
  v_mov_b32 v234, v226
  v_mov_b32 v235, v227
  v_mov_b32 v236, v228
  v_mov_b32 v237, v229
  v_mov_b32 v238, v230
  v_mov_b32 v239, v231
  v_permlane32_swap_b32 v224, v232
  v_permlane32_swap_b32 v225, v233
  v_permlane32_swap_b32 v226, v234
  v_permlane32_swap_b32 v227, v235
  v_permlane32_swap_b32 v228, v236
  v_permlane32_swap_b32 v229, v237
  v_permlane32_swap_b32 v230, v238
  v_permlane32_swap_b32 v231, v239
  v_add_f32 v224, v224, v232
  v_add_f32 v225, v225, v233
  v_add_f32 v226, v226, v234
  v_add_f32 v227, v227, v235
  v_add_f32 v228, v228, v236
  v_add_f32 v229, v229, v237
  v_add_f32 v230, v230, v238
  v_add_f32 v231, v231, v239
  v_mov_b32 v232, v224
  v_mov_b32 v233, v225
  v_mov_b32 v234, v226
  v_mov_b32 v235, v227
  v_mov_b32 v236, v228
  v_mov_b32 v237, v229
  v_mov_b32 v238, v230
  v_mov_b32 v239, v231
  v_permlane16_swap_b32 v224, v232
  v_permlane16_swap_b32 v225, v233
  v_permlane16_swap_b32 v226, v234
  v_permlane16_swap_b32 v227, v235
  v_permlane16_swap_b32 v228, v236
  v_permlane16_swap_b32 v229, v237
  v_permlane16_swap_b32 v230, v238
  v_permlane16_swap_b32 v231, v239
  v_add_f32 v224, v224, v232
  v_add_f32 v225, v225, v233
  v_add_f32 v226, v226, v234
  v_add_f32 v227, v227, v235
  v_add_f32 v228, v228, v236
  v_add_f32 v229, v229, v237
  v_add_f32 v230, v230, v238
  v_add_f32 v231, v231, v239
  v_and_b32 v232, 7, v253
  s_lshl_b32 s43, s40, 8
  s_add_u32 s43, s43, 143360
  v_add_f32_dpp v224, v224, v224 row_ror:8 row_mask:0xf bank_mask:0xf
  v_add_f32_dpp v225, v225, v225 row_ror:8 row_mask:0xf bank_mask:0xf
  v_add_f32_dpp v226, v226, v226 row_ror:8 row_mask:0xf bank_mask:0xf
  v_add_f32_dpp v227, v227, v227 row_ror:8 row_mask:0xf bank_mask:0xf
  v_add_f32_dpp v228, v228, v228 row_ror:8 row_mask:0xf bank_mask:0xf
  v_add_f32_dpp v229, v229, v229 row_ror:8 row_mask:0xf bank_mask:0xf
  v_add_f32_dpp v230, v230, v230 row_ror:8 row_mask:0xf bank_mask:0xf
  v_add_f32_dpp v231, v231, v231 row_ror:8 row_mask:0xf bank_mask:0xf
  v_lshl_add_u32 v232, v232, 5, s43
  ds_write_b128 v232, v[224:227]
  ds_write_b128 v232, v[228:231] offset:16
Lsd7:
  s_lshl_b32 s77, s52, 8
  s_add_u32 s77, s77, 27787264
  v_lshlrev_b32 v249, 7, v253
  s_add_u32 s77, s77, s42
  s_cmp_lg_u32 s40, 0
  s_cbranch_scc1 Lpdn9
  s_mov_b32 s43, 0x40000
  s_mov_b64 exec, 3
Lpol8:
  buffer_load_dword v250, v249, s[4:7], s77 offen sc1
  s_waitcnt vmcnt(0)
  v_cmp_gt_u32 vcc, 8, v250
  s_cbranch_vccz Lpdn9
  s_sub_u32 s43, s43, 1
  s_cmp_lg_u32 s43, 0
  s_cbranch_scc1 Lpol8
Lpdn9:
  s_mov_b64 exec, -1
  s_waitcnt vmcnt(0) lgkmcnt(0)
  s_barrier
  buffer_load_dwordx4 a[0:3], v48, s[4:7], s57 offen offset:0 sc1
  buffer_load_dwordx4 a[4:7], v49, s[4:7], s57 offen offset:0 sc1
  buffer_load_dwordx4 a[8:11], v48, s[4:7], s57 offen offset:1024 sc1
  buffer_load_dwordx4 a[12:15], v49, s[4:7], s57 offen offset:1024 sc1
  buffer_load_dwordx4 a[16:19], v48, s[4:7], s57 offen offset:2048 sc1
  buffer_load_dwordx4 a[20:23], v49, s[4:7], s57 offen offset:2048 sc1
  buffer_load_dwordx4 a[24:27], v48, s[4:7], s57 offen offset:3072 sc1
  buffer_load_dwordx4 a[28:31], v49, s[4:7], s57 offen offset:3072 sc1
  s_add_u32 s57, s57, 4096
  buffer_load_dwordx4 a[32:35], v48, s[4:7], s57 offen offset:0 sc1
  buffer_load_dwordx4 a[36:39], v49, s[4:7], s57 offen offset:0 sc1
  buffer_load_dwordx4 a[40:43], v48, s[4:7], s57 offen offset:1024 sc1
  buffer_load_dwordx4 a[44:47], v49, s[4:7], s57 offen offset:1024 sc1
  s_cmp_eq_u32 s40, 1
  s_cselect_b32 s3, s3, 0
  s_cmp_eq_u32 s3, 0
  s_cbranch_scc1 Lsd10
  v_lshlrev_b32 v232, 2, v253
  v_add_u32 v233, 143360, v232
  ds_read_b32 v234, v233 offset:0
  ds_read_b32 v235, v233 offset:256
  ds_read_b32 v236, v233 offset:512
  ds_read_b32 v237, v233 offset:768
  s_waitcnt lgkmcnt(0)
  v_add_f32 v234, v234, v235
  v_add_f32 v236, v236, v237
  v_add_f32 v234, v234, v236
  buffer_store_dword v234, v232, s[4:7], s101 offen sc1
Lsd10:
  ds_read_b64_tr_b16 a[112:113], v40 offset:0
  ds_read_b64_tr_b16 a[114:115], v40 offset:2048
  ds_read_b64_tr_b16 a[128:129], v40 offset:4096
  ds_read_b64_tr_b16 a[130:131], v40 offset:6144
  ds_read_b64_tr_b16 a[116:117], v41 offset:0
  ds_read_b64_tr_b16 a[118:119], v41 offset:2048
  ds_read_b64_tr_b16 a[132:133], v41 offset:4096
  ds_read_b64_tr_b16 a[134:135], v41 offset:6144
  ds_read_b64_tr_b16 a[120:121], v42 offset:0
  ds_read_b64_tr_b16 a[122:123], v42 offset:2048
  ds_read_b64_tr_b16 a[136:137], v42 offset:4096
  ds_read_b64_tr_b16 a[138:139], v42 offset:6144
  ds_read_b64_tr_b16 a[124:125], v43 offset:0
  ds_read_b64_tr_b16 a[126:127], v43 offset:2048
  ds_read_b64_tr_b16 a[140:141], v43 offset:4096
  ds_read_b64_tr_b16 a[142:143], v43 offset:6144
  s_lshr_b32 s77, s52, 1
  s_lshl_b32 s77, s77, 7
  s_add_u32 s77, s77, s42
  s_add_u32 s77, s77, 27791360
  s_mov_b32 s56, 3
.p2align 3
Lp2_loop:
  s_waitcnt vmcnt(8) lgkmcnt(8)
  v_mfma_f32_16x16x32_bf16 v[0:3], a[112:115], a[0:3], v[0:3]
  ds_read_b64_tr_b16 a[144:145], v40 offset:8192
  v_mfma_f32_16x16x32_bf16 v[0:3], a[128:131], a[8:11], v[0:3]
  ds_read_b64_tr_b16 a[146:147], v40 offset:10240
  buffer_load_dwordx4 a[48:51], v48, s[4:7], s57 offen offset:2048 sc1
  v_mfma_f32_16x16x32_bf16 v[4:7], a[128:131], a[12:15], v[4:7]
  ds_read_b64_tr_b16 a[160:161], v40 offset:12288
  v_mfma_f32_16x16x32_bf16 v[4:7], a[112:115], a[4:7], v[4:7]
  ds_read_b64_tr_b16 a[162:163], v40 offset:14336
  v_mfma_f32_16x16x32_bf16 v[12:15], a[116:119], a[4:7], v[12:15]
  ds_read_b64_tr_b16 a[148:149], v41 offset:8192
  v_mfma_f32_16x16x32_bf16 v[12:15], a[132:135], a[12:15], v[12:15]
  ds_read_b64_tr_b16 a[150:151], v41 offset:10240
  buffer_load_dwordx4 a[52:55], v49, s[4:7], s57 offen offset:2048 sc1
  v_mfma_f32_16x16x32_bf16 v[8:11], a[132:135], a[8:11], v[8:11]
  ds_read_b64_tr_b16 a[164:165], v41 offset:12288
  v_mfma_f32_16x16x32_bf16 v[8:11], a[116:119], a[0:3], v[8:11]
  ds_read_b64_tr_b16 a[166:167], v41 offset:14336
  s_waitcnt lgkmcnt(8)
  v_mfma_f32_16x16x32_bf16 v[16:19], a[120:123], a[0:3], v[16:19]
  ds_read_b64_tr_b16 a[152:153], v42 offset:8192
  v_mfma_f32_16x16x32_bf16 v[16:19], a[136:139], a[8:11], v[16:19]
  ds_read_b64_tr_b16 a[154:155], v42 offset:10240
  buffer_load_dwordx4 a[56:59], v48, s[4:7], s57 offen offset:3072 sc1
  v_mfma_f32_16x16x32_bf16 v[20:23], a[136:139], a[12:15], v[20:23]
  ds_read_b64_tr_b16 a[168:169], v42 offset:12288
  v_mfma_f32_16x16x32_bf16 v[20:23], a[120:123], a[4:7], v[20:23]
  ds_read_b64_tr_b16 a[170:171], v42 offset:14336
  v_mfma_f32_16x16x32_bf16 v[28:31], a[124:127], a[4:7], v[28:31]
  ds_read_b64_tr_b16 a[156:157], v43 offset:8192
  v_mfma_f32_16x16x32_bf16 v[28:31], a[140:143], a[12:15], v[28:31]
  ds_read_b64_tr_b16 a[158:159], v43 offset:10240
  buffer_load_dwordx4 a[60:63], v49, s[4:7], s57 offen offset:3072 sc1
  v_mfma_f32_16x16x32_bf16 v[24:27], a[140:143], a[8:11], v[24:27]
  ds_read_b64_tr_b16 a[172:173], v43 offset:12288
  v_mfma_f32_16x16x32_bf16 v[24:27], a[124:127], a[0:3], v[24:27]
  ds_read_b64_tr_b16 a[174:175], v43 offset:14336
  s_waitcnt vmcnt(8) lgkmcnt(8)
  v_mfma_f32_16x16x32_bf16 v[0:3], a[144:147], a[16:19], v[0:3]
  ds_read_b64_tr_b16 a[112:113], v40 offset:16384
  v_mfma_f32_16x16x32_bf16 v[0:3], a[160:163], a[24:27], v[0:3]
  s_add_u32 s57, s57, 4096
  ds_read_b64_tr_b16 a[114:115], v40 offset:18432
  buffer_load_dwordx4 a[0:3], v48, s[4:7], s57 offen offset:0 sc1
  v_mfma_f32_16x16x32_bf16 v[4:7], a[160:163], a[28:31], v[4:7]
  ds_read_b64_tr_b16 a[128:129], v40 offset:20480
  v_mfma_f32_16x16x32_bf16 v[4:7], a[144:147], a[20:23], v[4:7]
  ds_read_b64_tr_b16 a[130:131], v40 offset:22528
  v_mfma_f32_16x16x32_bf16 v[12:15], a[148:151], a[20:23], v[12:15]
  ds_read_b64_tr_b16 a[116:117], v41 offset:16384
  v_mfma_f32_16x16x32_bf16 v[12:15], a[164:167], a[28:31], v[12:15]
  ds_read_b64_tr_b16 a[118:119], v41 offset:18432
  buffer_load_dwordx4 a[4:7], v49, s[4:7], s57 offen offset:0 sc1
  v_mfma_f32_16x16x32_bf16 v[8:11], a[164:167], a[24:27], v[8:11]
  ds_read_b64_tr_b16 a[132:133], v41 offset:20480
  v_mfma_f32_16x16x32_bf16 v[8:11], a[148:151], a[16:19], v[8:11]
  ds_read_b64_tr_b16 a[134:135], v41 offset:22528
  s_waitcnt lgkmcnt(8)
  v_mfma_f32_16x16x32_bf16 v[16:19], a[152:155], a[16:19], v[16:19]
  ds_read_b64_tr_b16 a[120:121], v42 offset:16384
  v_mfma_f32_16x16x32_bf16 v[16:19], a[168:171], a[24:27], v[16:19]
  ds_read_b64_tr_b16 a[122:123], v42 offset:18432
  buffer_load_dwordx4 a[8:11], v48, s[4:7], s57 offen offset:1024 sc1
  v_mfma_f32_16x16x32_bf16 v[20:23], a[168:171], a[28:31], v[20:23]
  ds_read_b64_tr_b16 a[136:137], v42 offset:20480
  v_mfma_f32_16x16x32_bf16 v[20:23], a[152:155], a[20:23], v[20:23]
  ds_read_b64_tr_b16 a[138:139], v42 offset:22528
  v_mfma_f32_16x16x32_bf16 v[28:31], a[156:159], a[20:23], v[28:31]
  ds_read_b64_tr_b16 a[124:125], v43 offset:16384
  v_mfma_f32_16x16x32_bf16 v[28:31], a[172:175], a[28:31], v[28:31]
  ds_read_b64_tr_b16 a[126:127], v43 offset:18432
  buffer_load_dwordx4 a[12:15], v49, s[4:7], s57 offen offset:1024 sc1
  v_mfma_f32_16x16x32_bf16 v[24:27], a[172:175], a[24:27], v[24:27]
  ds_read_b64_tr_b16 a[140:141], v43 offset:20480
  v_mfma_f32_16x16x32_bf16 v[24:27], a[156:159], a[16:19], v[24:27]
  ds_read_b64_tr_b16 a[142:143], v43 offset:22528
  s_waitcnt vmcnt(8) lgkmcnt(8)
  v_mfma_f32_16x16x32_bf16 v[0:3], a[112:115], a[32:35], v[0:3]
  ds_read_b64_tr_b16 a[144:145], v40 offset:24576
  v_mfma_f32_16x16x32_bf16 v[0:3], a[128:131], a[40:43], v[0:3]
  ds_read_b64_tr_b16 a[146:147], v40 offset:26624
  buffer_load_dwordx4 a[16:19], v48, s[4:7], s57 offen offset:2048 sc1
  v_mfma_f32_16x16x32_bf16 v[4:7], a[128:131], a[44:47], v[4:7]
  ds_read_b64_tr_b16 a[160:161], v40 offset:28672
  v_mfma_f32_16x16x32_bf16 v[4:7], a[112:115], a[36:39], v[4:7]
  ds_read_b64_tr_b16 a[162:163], v40 offset:30720
  v_add_u32 v40, 32768, v40
  v_mfma_f32_16x16x32_bf16 v[12:15], a[116:119], a[36:39], v[12:15]
  ds_read_b64_tr_b16 a[148:149], v41 offset:24576
  v_mfma_f32_16x16x32_bf16 v[12:15], a[132:135], a[44:47], v[12:15]
  ds_read_b64_tr_b16 a[150:151], v41 offset:26624
  buffer_load_dwordx4 a[20:23], v49, s[4:7], s57 offen offset:2048 sc1
  v_mfma_f32_16x16x32_bf16 v[8:11], a[132:135], a[40:43], v[8:11]
  ds_read_b64_tr_b16 a[164:165], v41 offset:28672
  v_mfma_f32_16x16x32_bf16 v[8:11], a[116:119], a[32:35], v[8:11]
  s_waitcnt lgkmcnt(7)
  ds_read_b64_tr_b16 a[166:167], v41 offset:30720
  v_add_u32 v41, 32768, v41
  v_mfma_f32_16x16x32_bf16 v[16:19], a[120:123], a[32:35], v[16:19]
  ds_read_b64_tr_b16 a[152:153], v42 offset:24576
  v_mfma_f32_16x16x32_bf16 v[16:19], a[136:139], a[40:43], v[16:19]
  ds_read_b64_tr_b16 a[154:155], v42 offset:26624
  buffer_load_dwordx4 a[24:27], v48, s[4:7], s57 offen offset:3072 sc1
  v_mfma_f32_16x16x32_bf16 v[20:23], a[136:139], a[44:47], v[20:23]
  ds_read_b64_tr_b16 a[168:169], v42 offset:28672
  v_mfma_f32_16x16x32_bf16 v[20:23], a[120:123], a[36:39], v[20:23]
  ds_read_b64_tr_b16 a[170:171], v42 offset:30720
  v_add_u32 v42, 32768, v42
  v_mfma_f32_16x16x32_bf16 v[28:31], a[124:127], a[36:39], v[28:31]
  ds_read_b64_tr_b16 a[156:157], v43 offset:24576
  v_mfma_f32_16x16x32_bf16 v[28:31], a[140:143], a[44:47], v[28:31]
  ds_read_b64_tr_b16 a[158:159], v43 offset:26624
  buffer_load_dwordx4 a[28:31], v49, s[4:7], s57 offen offset:3072 sc1
  v_mfma_f32_16x16x32_bf16 v[24:27], a[140:143], a[40:43], v[24:27]
  ds_read_b64_tr_b16 a[172:173], v43 offset:28672
  v_mfma_f32_16x16x32_bf16 v[24:27], a[124:127], a[32:35], v[24:27]
  s_waitcnt vmcnt(8) lgkmcnt(7)
  ds_read_b64_tr_b16 a[174:175], v43 offset:30720
  v_add_u32 v43, 32768, v43
  v_mfma_f32_16x16x32_bf16 v[0:3], a[144:147], a[48:51], v[0:3]
  ds_read_b64_tr_b16 a[112:113], v40 offset:0
  v_mfma_f32_16x16x32_bf16 v[0:3], a[160:163], a[56:59], v[0:3]
  s_add_u32 s57, s57, 4096
  ds_read_b64_tr_b16 a[114:115], v40 offset:2048
  buffer_load_dwordx4 a[32:35], v48, s[4:7], s57 offen offset:0 sc1
  v_mfma_f32_16x16x32_bf16 v[4:7], a[160:163], a[60:63], v[4:7]
  ds_read_b64_tr_b16 a[128:129], v40 offset:4096
  v_mfma_f32_16x16x32_bf16 v[4:7], a[144:147], a[52:55], v[4:7]
  ds_read_b64_tr_b16 a[130:131], v40 offset:6144
  v_mfma_f32_16x16x32_bf16 v[12:15], a[148:151], a[52:55], v[12:15]
  ds_read_b64_tr_b16 a[116:117], v41 offset:0
  v_mfma_f32_16x16x32_bf16 v[12:15], a[164:167], a[60:63], v[12:15]
  ds_read_b64_tr_b16 a[118:119], v41 offset:2048
  buffer_load_dwordx4 a[36:39], v49, s[4:7], s57 offen offset:0 sc1
  v_mfma_f32_16x16x32_bf16 v[8:11], a[164:167], a[56:59], v[8:11]
  ds_read_b64_tr_b16 a[132:133], v41 offset:4096
  v_mfma_f32_16x16x32_bf16 v[8:11], a[148:151], a[48:51], v[8:11]
  ds_read_b64_tr_b16 a[134:135], v41 offset:6144
  s_waitcnt lgkmcnt(8)
  v_mfma_f32_16x16x32_bf16 v[16:19], a[152:155], a[48:51], v[16:19]
  ds_read_b64_tr_b16 a[120:121], v42 offset:0
  v_mfma_f32_16x16x32_bf16 v[16:19], a[168:171], a[56:59], v[16:19]
  ds_read_b64_tr_b16 a[122:123], v42 offset:2048
  buffer_load_dwordx4 a[40:43], v48, s[4:7], s57 offen offset:1024 sc1
  v_mfma_f32_16x16x32_bf16 v[20:23], a[168:171], a[60:63], v[20:23]
  ds_read_b64_tr_b16 a[136:137], v42 offset:4096
  v_mfma_f32_16x16x32_bf16 v[20:23], a[152:155], a[52:55], v[20:23]
  ds_read_b64_tr_b16 a[138:139], v42 offset:6144
  v_mfma_f32_16x16x32_bf16 v[28:31], a[156:159], a[52:55], v[28:31]
  ds_read_b64_tr_b16 a[124:125], v43 offset:0
  v_mfma_f32_16x16x32_bf16 v[28:31], a[172:175], a[60:63], v[28:31]
  ds_read_b64_tr_b16 a[126:127], v43 offset:2048
  buffer_load_dwordx4 a[44:47], v49, s[4:7], s57 offen offset:1024 sc1
  v_mfma_f32_16x16x32_bf16 v[24:27], a[172:175], a[56:59], v[24:27]
  ds_read_b64_tr_b16 a[140:141], v43 offset:4096
  v_mfma_f32_16x16x32_bf16 v[24:27], a[156:159], a[48:51], v[24:27]
  s_sub_u32 s56, s56, 1
  ds_read_b64_tr_b16 a[142:143], v43 offset:6144
  s_cmp_lg_u32 s56, 0
  s_cbranch_scc1 Lp2_loop
Lmk_Lp2_loop_tail:
  s_waitcnt vmcnt(8) lgkmcnt(8)
  v_mfma_f32_16x16x32_bf16 v[0:3], a[112:115], a[0:3], v[0:3]
  ds_read_b64_tr_b16 a[144:145], v40 offset:8192
  v_mfma_f32_16x16x32_bf16 v[0:3], a[128:131], a[8:11], v[0:3]
  ds_read_b64_tr_b16 a[146:147], v40 offset:10240
  buffer_load_dwordx4 a[48:51], v48, s[4:7], s57 offen offset:2048 sc1
  v_mfma_f32_16x16x32_bf16 v[4:7], a[128:131], a[12:15], v[4:7]
  ds_read_b64_tr_b16 a[160:161], v40 offset:12288
  v_mfma_f32_16x16x32_bf16 v[4:7], a[112:115], a[4:7], v[4:7]
  ds_read_b64_tr_b16 a[162:163], v40 offset:14336
  v_mfma_f32_16x16x32_bf16 v[12:15], a[116:119], a[4:7], v[12:15]
  ds_read_b64_tr_b16 a[148:149], v41 offset:8192
  v_mfma_f32_16x16x32_bf16 v[12:15], a[132:135], a[12:15], v[12:15]
  ds_read_b64_tr_b16 a[150:151], v41 offset:10240
  buffer_load_dwordx4 a[52:55], v49, s[4:7], s57 offen offset:2048 sc1
  v_mfma_f32_16x16x32_bf16 v[8:11], a[132:135], a[8:11], v[8:11]
  ds_read_b64_tr_b16 a[164:165], v41 offset:12288
  v_mfma_f32_16x16x32_bf16 v[8:11], a[116:119], a[0:3], v[8:11]
  ds_read_b64_tr_b16 a[166:167], v41 offset:14336
  s_waitcnt lgkmcnt(8)
  v_mfma_f32_16x16x32_bf16 v[16:19], a[120:123], a[0:3], v[16:19]
  ds_read_b64_tr_b16 a[152:153], v42 offset:8192
  v_mfma_f32_16x16x32_bf16 v[16:19], a[136:139], a[8:11], v[16:19]
  ds_read_b64_tr_b16 a[154:155], v42 offset:10240
  buffer_load_dwordx4 a[56:59], v48, s[4:7], s57 offen offset:3072 sc1
  v_mfma_f32_16x16x32_bf16 v[20:23], a[136:139], a[12:15], v[20:23]
  ds_read_b64_tr_b16 a[168:169], v42 offset:12288
  v_mfma_f32_16x16x32_bf16 v[20:23], a[120:123], a[4:7], v[20:23]
  ds_read_b64_tr_b16 a[170:171], v42 offset:14336
  v_mfma_f32_16x16x32_bf16 v[28:31], a[124:127], a[4:7], v[28:31]
  ds_read_b64_tr_b16 a[156:157], v43 offset:8192
  v_mfma_f32_16x16x32_bf16 v[28:31], a[140:143], a[12:15], v[28:31]
  ds_read_b64_tr_b16 a[158:159], v43 offset:10240
  buffer_load_dwordx4 a[60:63], v49, s[4:7], s57 offen offset:3072 sc1
  v_mfma_f32_16x16x32_bf16 v[24:27], a[140:143], a[8:11], v[24:27]
  ds_read_b64_tr_b16 a[172:173], v43 offset:12288
  v_mfma_f32_16x16x32_bf16 v[24:27], a[124:127], a[0:3], v[24:27]
  ds_read_b64_tr_b16 a[174:175], v43 offset:14336
  s_waitcnt vmcnt(8) lgkmcnt(8)
  v_mfma_f32_16x16x32_bf16 v[0:3], a[144:147], a[16:19], v[0:3]
  ds_read_b64_tr_b16 a[112:113], v40 offset:16384
  v_mfma_f32_16x16x32_bf16 v[0:3], a[160:163], a[24:27], v[0:3]
  ds_read_b64_tr_b16 a[114:115], v40 offset:18432
  v_mfma_f32_16x16x32_bf16 v[4:7], a[160:163], a[28:31], v[4:7]
  ds_read_b64_tr_b16 a[128:129], v40 offset:20480
  v_mfma_f32_16x16x32_bf16 v[4:7], a[144:147], a[20:23], v[4:7]
  ds_read_b64_tr_b16 a[130:131], v40 offset:22528
  v_mfma_f32_16x16x32_bf16 v[12:15], a[148:151], a[20:23], v[12:15]
  ds_read_b64_tr_b16 a[116:117], v41 offset:16384
  v_mfma_f32_16x16x32_bf16 v[12:15], a[164:167], a[28:31], v[12:15]
  ds_read_b64_tr_b16 a[118:119], v41 offset:18432
  v_mfma_f32_16x16x32_bf16 v[8:11], a[164:167], a[24:27], v[8:11]
  ds_read_b64_tr_b16 a[132:133], v41 offset:20480
  v_mfma_f32_16x16x32_bf16 v[8:11], a[148:151], a[16:19], v[8:11]
  ds_read_b64_tr_b16 a[134:135], v41 offset:22528
  s_waitcnt lgkmcnt(8)
  v_mfma_f32_16x16x32_bf16 v[16:19], a[152:155], a[16:19], v[16:19]
  ds_read_b64_tr_b16 a[120:121], v42 offset:16384
  v_mfma_f32_16x16x32_bf16 v[16:19], a[168:171], a[24:27], v[16:19]
  ds_read_b64_tr_b16 a[122:123], v42 offset:18432
  v_mfma_f32_16x16x32_bf16 v[20:23], a[168:171], a[28:31], v[20:23]
  ds_read_b64_tr_b16 a[136:137], v42 offset:20480
  v_mfma_f32_16x16x32_bf16 v[20:23], a[152:155], a[20:23], v[20:23]
  ds_read_b64_tr_b16 a[138:139], v42 offset:22528
  v_mfma_f32_16x16x32_bf16 v[28:31], a[156:159], a[20:23], v[28:31]
  ds_read_b64_tr_b16 a[124:125], v43 offset:16384
  v_mfma_f32_16x16x32_bf16 v[28:31], a[172:175], a[28:31], v[28:31]
  ds_read_b64_tr_b16 a[126:127], v43 offset:18432
  v_mfma_f32_16x16x32_bf16 v[24:27], a[172:175], a[24:27], v[24:27]
  ds_read_b64_tr_b16 a[140:141], v43 offset:20480
  v_mfma_f32_16x16x32_bf16 v[24:27], a[156:159], a[16:19], v[24:27]
  ds_read_b64_tr_b16 a[142:143], v43 offset:22528
  s_waitcnt vmcnt(4) lgkmcnt(8)
  v_mfma_f32_16x16x32_bf16 v[0:3], a[112:115], a[32:35], v[0:3]
  ds_read_b64_tr_b16 a[144:145], v40 offset:24576
  v_mfma_f32_16x16x32_bf16 v[0:3], a[128:131], a[40:43], v[0:3]
  ds_read_b64_tr_b16 a[146:147], v40 offset:26624
  v_mfma_f32_16x16x32_bf16 v[4:7], a[128:131], a[44:47], v[4:7]
  ds_read_b64_tr_b16 a[160:161], v40 offset:28672
  v_mfma_f32_16x16x32_bf16 v[4:7], a[112:115], a[36:39], v[4:7]
  ds_read_b64_tr_b16 a[162:163], v40 offset:30720
  v_add_u32 v40, 32768, v40
  v_mfma_f32_16x16x32_bf16 v[12:15], a[116:119], a[36:39], v[12:15]
  ds_read_b64_tr_b16 a[148:149], v41 offset:24576
  v_mfma_f32_16x16x32_bf16 v[12:15], a[132:135], a[44:47], v[12:15]
  ds_read_b64_tr_b16 a[150:151], v41 offset:26624
  v_mfma_f32_16x16x32_bf16 v[8:11], a[132:135], a[40:43], v[8:11]
  ds_read_b64_tr_b16 a[164:165], v41 offset:28672
  v_mfma_f32_16x16x32_bf16 v[8:11], a[116:119], a[32:35], v[8:11]
  s_waitcnt lgkmcnt(7)
  ds_read_b64_tr_b16 a[166:167], v41 offset:30720
  v_add_u32 v41, 32768, v41
  v_mfma_f32_16x16x32_bf16 v[16:19], a[120:123], a[32:35], v[16:19]
  ds_read_b64_tr_b16 a[152:153], v42 offset:24576
  v_mfma_f32_16x16x32_bf16 v[16:19], a[136:139], a[40:43], v[16:19]
  ds_read_b64_tr_b16 a[154:155], v42 offset:26624
  v_mfma_f32_16x16x32_bf16 v[20:23], a[136:139], a[44:47], v[20:23]
  ds_read_b64_tr_b16 a[168:169], v42 offset:28672
  v_mfma_f32_16x16x32_bf16 v[20:23], a[120:123], a[36:39], v[20:23]
  ds_read_b64_tr_b16 a[170:171], v42 offset:30720
  v_add_u32 v42, 32768, v42
  v_mfma_f32_16x16x32_bf16 v[28:31], a[124:127], a[36:39], v[28:31]
  ds_read_b64_tr_b16 a[156:157], v43 offset:24576
  v_mfma_f32_16x16x32_bf16 v[28:31], a[140:143], a[44:47], v[28:31]
  ds_read_b64_tr_b16 a[158:159], v43 offset:26624
  v_mfma_f32_16x16x32_bf16 v[24:27], a[140:143], a[40:43], v[24:27]
  ds_read_b64_tr_b16 a[172:173], v43 offset:28672
  v_mfma_f32_16x16x32_bf16 v[24:27], a[124:127], a[32:35], v[24:27]
  s_waitcnt vmcnt(0) lgkmcnt(7)
  ds_read_b64_tr_b16 a[174:175], v43 offset:30720
  v_add_u32 v43, 32768, v43
  v_mfma_f32_16x16x32_bf16 v[0:3], a[144:147], a[48:51], v[0:3]
  v_mfma_f32_16x16x32_bf16 v[0:3], a[160:163], a[56:59], v[0:3]
  v_mfma_f32_16x16x32_bf16 v[4:7], a[160:163], a[60:63], v[4:7]
  v_mfma_f32_16x16x32_bf16 v[4:7], a[144:147], a[52:55], v[4:7]
  v_mfma_f32_16x16x32_bf16 v[12:15], a[148:151], a[52:55], v[12:15]
  v_mfma_f32_16x16x32_bf16 v[12:15], a[164:167], a[60:63], v[12:15]
  v_mfma_f32_16x16x32_bf16 v[8:11], a[164:167], a[56:59], v[8:11]
  v_mfma_f32_16x16x32_bf16 v[8:11], a[148:151], a[48:51], v[8:11]
  s_waitcnt lgkmcnt(0)
  v_mfma_f32_16x16x32_bf16 v[16:19], a[152:155], a[48:51], v[16:19]
  s_nop 0
  v_mfma_f32_16x16x32_bf16 v[16:19], a[168:171], a[56:59], v[16:19]
  s_nop 0
  v_mfma_f32_16x16x32_bf16 v[20:23], a[168:171], a[60:63], v[20:23]
  s_nop 0
  v_mfma_f32_16x16x32_bf16 v[20:23], a[152:155], a[52:55], v[20:23]
  v_cvt_pk_bf16_f32 v60, v4, v5
  v_cvt_pk_bf16_f32 v61, v6, v7
  v_mfma_f32_16x16x32_bf16 v[28:31], a[156:159], a[52:55], v[28:31]
  v_cvt_pk_bf16_f32 v62, v12, v13
  v_cvt_pk_bf16_f32 v63, v14, v15
  v_mfma_f32_16x16x32_bf16 v[28:31], a[172:175], a[60:63], v[28:31]
  buffer_store_dwordx4 v[60:63], v48, s[4:7], s59 offen offset:0 sc1
  v_cvt_pk_bf16_f32 v52, v0, v1
  v_mfma_f32_16x16x32_bf16 v[24:27], a[172:175], a[56:59], v[24:27]
  v_cvt_pk_bf16_f32 v53, v2, v3
  v_cvt_pk_bf16_f32 v54, v8, v9
  v_mfma_f32_16x16x32_bf16 v[24:27], a[156:159], a[48:51], v[24:27]
  v_cvt_pk_bf16_f32 v55, v10, v11
  buffer_store_dwordx4 v[52:55], v48, s[4:7], s58 offen offset:0 sc1
  v_mfma_f32_16x16x32_bf16 v[88:91], v[60:63], v[60:63], 0
  v_mfma_f32_16x16x32_bf16 v[84:87], v[72:75], v[60:63], 0
  v_mfma_f32_16x16x32_bf16 v[80:83], v[52:55], v[52:55], 0
  v_mfma_f32_16x16x32_bf16 v[76:79], v[72:75], v[52:55], 0
  v_cvt_pk_bf16_f32 v64, v20, v21
  v_cvt_pk_bf16_f32 v65, v22, v23
  v_cvt_pk_bf16_f32 v66, v28, v29
  v_cvt_pk_bf16_f32 v67, v30, v31
  buffer_store_dwordx4 v[64:67], v48, s[4:7], s59 offen offset:1024 sc1
  v_cvt_pk_bf16_f32 v56, v16, v17
  v_cvt_pk_bf16_f32 v57, v18, v19
  v_cvt_pk_bf16_f32 v58, v24, v25
  v_cvt_pk_bf16_f32 v59, v26, v27
  buffer_store_dwordx4 v[56:59], v48, s[4:7], s58 offen offset:1024 sc1
  s_nop 0
  v_mfma_f32_16x16x32_bf16 v[88:91], v[64:67], v[64:67], v[88:91]
  v_mfma_f32_16x16x32_bf16 v[84:87], v[72:75], v[64:67], v[84:87]
  v_mfma_f32_16x16x32_bf16 v[80:83], v[56:59], v[56:59], v[80:83]
  v_mfma_f32_16x16x32_bf16 v[76:79], v[72:75], v[56:59], v[76:79]
  s_nop 5
  v_cndmask_b32 v85, v88, v89, s[64:65]
  v_cndmask_b32 v85, v85, v90, s[66:67]
  v_cndmask_b32 v85, v85, v91, s[68:69]
  buffer_store_dwordx2 v[84:85], v92, s[4:7], s60 offen offset:2048 sc1
  v_cndmask_b32 v77, v80, v81, s[64:65]
  v_cndmask_b32 v77, v77, v82, s[66:67]
  v_cndmask_b32 v77, v77, v83, s[68:69]
  buffer_store_dwordx2 v[76:77], v92, s[4:7], s60 offen offset:0 sc1
  s_and_b32 s66, s55, 1
  v_lshrrev_b32 v2, 4, v253
  v_bfe_u32 v3, v253, 1, 3
  v_and_b32 v4, 1, v253
  v_lshlrev_b32 v4, 4, v4
  v_mul_u32_u24 v5, 7168, v2
  v_add_u32 v5, v5, v4
  s_cmp_eq_u32 s66, 0
  s_cselect_b32 s44, 7, 0
  v_mov_b32 v7, 0x40000000
  v_add_u32 v6, 0, v2
  v_xor_b32 v6, v6, v3
  v_cmp_eq_u32 vcc, s44, v6
  v_lshl_add_u32 v6, v6, 5, v5
  v_add_u32 v6, 0, v6
  v_cndmask_b32 v232, v6, v7, vcc
  v_add_u32 v6, 4, v2
  v_xor_b32 v6, v6, v3
  v_cmp_eq_u32 vcc, s44, v6
  v_lshl_add_u32 v6, v6, 5, v5
  v_add_u32 v6, 27648, v6
  v_cndmask_b32 v233, v6, v7, vcc
  v_add_u32 v6, 0, v2
  v_xor_b32 v6, v6, v3
  v_cmp_eq_u32 vcc, s44, v6
  v_lshl_add_u32 v6, v6, 5, v5
  v_add_u32 v6, 55296, v6
  v_cndmask_b32 v234, v6, v7, vcc
  v_add_u32 v6, 4, v2
  v_xor_b32 v6, v6, v3
  v_cmp_eq_u32 vcc, s44, v6
  v_lshl_add_u32 v6, v6, 5, v5
  v_add_u32 v6, 82944, v6
  v_cndmask_b32 v235, v6, v7, vcc
  s_mul_i32 s67, s55, 224
  s_and_b32 s67, s67, 0xffffffc0
  s_mul_i32 s43, s40, 114688
  s_add_u32 s67, s67, s43
  s_lshl_b32 s68, s40, 12
  v_lshlrev_b32 v231, 4, v253
  s_lshl_b32 s43, s41, 30
  v_or_b32 v236, s43, v231
  s_lshl_b32 s43, s2, 2
  s_add_u32 s43, s43, s40
  s_mul_i32 s70, s43, 7168
  s_lshl_b32 s69, s54, 2
  s_add_u32 s69, s69, s40
  s_lshl_b32 s72, s69, 17
  s_add_u32 s72, s72, s42
  s_add_u32 s72, s72, 4194304
  s_add_u32 s73, s72, 32768
  s_add_u32 s74, s73, 32768
  s_add_u32 s75, s74, 32768
  s_lshl_b32 s71, s40, 11
  s_add_u32 s71, s71, 131072
  v_lshrrev_b32 v2, 2, v253
  v_and_b32 v3, 7, v2
  v_and_b32 v4, 3, v253
  v_lshlrev_b32 v5, 3, v4
  v_lshl_add_u32 v5, v2, 8, v5
  s_lshl_b32 s43, s66, 1
  s_cmp_eq_u32 s66, 0
  s_cselect_b32 s45, 6, 1
  s_add_u32 s46, s43, 0
  v_xor_b32 v6, s46, v3
  v_lshl_add_u32 v224, v6, 5, v5
  s_add_u32 s46, s43, 1
  v_xor_b32 v6, s46, v3
  v_lshl_add_u32 v225, v6, 5, v5
  s_add_u32 s46, s43, 2
  v_xor_b32 v6, s46, v3
  v_lshl_add_u32 v226, v6, 5, v5
  s_add_u32 s46, s43, 3
  v_xor_b32 v6, s46, v3
  v_lshl_add_u32 v227, v6, 5, v5
  s_add_u32 s46, s43, 4
  v_xor_b32 v6, s46, v3
  v_lshl_add_u32 v228, v6, 5, v5
  s_add_u32 s46, s43, 5
  v_xor_b32 v6, s46, v3
  v_lshl_add_u32 v229, v6, 5, v5
  v_xor_b32 v6, s45, v3
  v_lshl_add_u32 v230, v6, 5, v5
  s_mul_i32 s46, s55, 448
  s_add_u32 s46, s46, 27918336
  s_add_u32 s47, s46, 28672
  s_lshr_b32 s48, s55, 3
  s_lshl_b32 s48, s48, 7
  s_add_u32 s48, s48, 27794432
  s_lshl_b32 s44, s69, 13
  s_add_u32 s44, s44, s42
  s_add_u32 s44, s44, 27525120
  s_add_u32 s45, s44, 4096
  s_waitcnt vmcnt(0)
  s_barrier
  s_cmp_lg_u32 s40, 0
  s_cbranch_scc1 Lsig11
  v_mov_b32 v250, 1
  s_mov_b64 exec, 1
  buffer_atomic_add v250, v251, s[4:7], s77 offen sc1
  s_mov_b64 exec, -1
Lsig11:
  s_cmp_eq_u32 s3, 0
  s_cbranch_scc1 Lsd12
  s_bfe_u32 s43, s2, 0x20001
  s_lshl_b32 s43, s43, 7
  s_add_u32 s43, s43, 27794432
  v_mov_b32 v250, 1
  s_mov_b64 exec, 1
  buffer_atomic_add v250, v251, s[4:7], s43 offen sc1
  s_mov_b64 exec, -1
Lsd12:
  s_add_u32 m0, s68, 0
  s_nop 0
  buffer_load_dwordx4 v232, s[16:19], s67 offen offset:0  lds
  buffer_load_dwordx4 v233, s[16:19], s67 offen offset:1024  lds
  buffer_load_dwordx4 v234, s[16:19], s67 offen offset:2048  lds
  buffer_load_dwordx4 v235, s[16:19], s67 offen offset:3072  lds
  s_add_u32 m0, s68, 16384
  s_nop 0
  buffer_load_dwordx4 v232, s[20:23], s67 offen offset:0  lds
  buffer_load_dwordx4 v233, s[20:23], s67 offen offset:1024  lds
  buffer_load_dwordx4 v234, s[20:23], s67 offen offset:2048  lds
  buffer_load_dwordx4 v235, s[20:23], s67 offen offset:3072  lds
  s_add_u32 s67, s67, 458752
  s_add_u32 m0, s68, 32768
  s_nop 0
  buffer_load_dwordx4 v232, s[16:19], s67 offen offset:0  lds
  buffer_load_dwordx4 v233, s[16:19], s67 offen offset:1024  lds
  buffer_load_dwordx4 v234, s[16:19], s67 offen offset:2048  lds
  buffer_load_dwordx4 v235, s[16:19], s67 offen offset:3072  lds
  s_add_u32 m0, s68, 49152
  s_nop 0
  buffer_load_dwordx4 v232, s[20:23], s67 offen offset:0  lds
  buffer_load_dwordx4 v233, s[20:23], s67 offen offset:1024  lds
  buffer_load_dwordx4 v234, s[20:23], s67 offen offset:2048  lds
  buffer_load_dwordx4 v235, s[20:23], s67 offen offset:3072  lds
  s_add_u32 s67, s67, 458752
  s_xor_b32 s68, s68, 0x10000
  s_lshl_b32 s77, s54, 7
  s_add_u32 s77, s77, s42
  s_add_u32 s77, s77, 27791360
  s_cmp_lg_u32 s40, 0
  s_cbranch_scc1 Lpdn14
  s_mov_b32 s43, 0x40000
  s_mov_b64 exec, 1
Lpol13:
  buffer_load_dword v250, v251, s[4:7], s77 offen sc1
  s_waitcnt vmcnt(0)
  v_cmp_gt_u32 vcc, 32, v250
  s_cbranch_vccz Lpdn14
  s_sub_u32 s43, s43, 1
  s_cmp_lg_u32 s43, 0
  s_cbranch_scc1 Lpol13
Lpdn14:
  s_mov_b64 exec, -1
  s_waitcnt vmcnt(0) lgkmcnt(0)
  s_barrier
  buffer_load_dwordx4 a[0:3], v231, s[4:7], s72 offen offset:0 sc1
  buffer_load_dwordx4 a[16:19], v231, s[4:7], s72 offen offset:1024 sc1
  buffer_load_dwordx4 a[4:7], v231, s[4:7], s73 offen offset:0 sc1
  buffer_load_dwordx4 a[20:23], v231, s[4:7], s73 offen offset:1024 sc1
  buffer_load_dwordx4 a[8:11], v231, s[4:7], s74 offen offset:0 sc1
  buffer_load_dwordx4 a[24:27], v231, s[4:7], s74 offen offset:1024 sc1
  buffer_load_dwordx4 a[12:15], v231, s[4:7], s75 offen offset:0 sc1
  buffer_load_dwordx4 a[28:31], v231, s[4:7], s75 offen offset:1024 sc1
  ds_read_b64_tr_b16 a[64:65], v224 offset:0
  ds_read_b64_tr_b16 a[66:67], v224 offset:4096
  ds_read_b64_tr_b16 a[68:69], v224 offset:8192
  ds_read_b64_tr_b16 a[70:71], v224 offset:12288
  ds_read_b64_tr_b16 a[72:73], v224 offset:16384
  ds_read_b64_tr_b16 a[74:75], v224 offset:20480
  ds_read_b64_tr_b16 a[76:77], v224 offset:24576
  ds_read_b64_tr_b16 a[78:79], v224 offset:28672
Lmk_p3s0:
  s_waitcnt vmcnt(6) lgkmcnt(4)
  v_mfma_f32_16x16x32_bf16 v[0:3], a[64:67], a[0:3], 0
  ds_read_b64_tr_b16 a[80:81], v225 offset:0
  v_mfma_f32_16x16x32_bf16 v[0:3], a[68:71], a[16:19], v[0:3]
  s_waitcnt vmcnt(4)
  v_mfma_f32_16x16x32_bf16 v[4:7], a[68:71], a[20:23], 0
  ds_read_b64_tr_b16 a[82:83], v225 offset:4096
  v_mfma_f32_16x16x32_bf16 v[4:7], a[64:67], a[4:7], v[4:7]
  s_waitcnt vmcnt(2)
  v_mfma_f32_16x16x32_bf16 v[8:11], a[64:67], a[8:11], 0
  ds_read_b64_tr_b16 a[84:85], v225 offset:8192
  v_mfma_f32_16x16x32_bf16 v[8:11], a[68:71], a[24:27], v[8:11]
  s_waitcnt vmcnt(0)
  v_mfma_f32_16x16x32_bf16 v[12:15], a[68:71], a[28:31], 0
  ds_read_b64_tr_b16 a[86:87], v225 offset:12288
  v_mfma_f32_16x16x32_bf16 v[12:15], a[64:67], a[12:15], v[12:15]
  s_waitcnt lgkmcnt(4)
  v_mfma_f32_16x16x32_bf16 v[28:31], a[72:75], a[12:15], 0
  ds_read_b64_tr_b16 a[88:89], v225 offset:16384
  v_mfma_f32_16x16x32_bf16 v[28:31], a[76:79], a[28:31], v[28:31]
  buffer_load_dwordx4 a[32:35], v231, s[4:7], s72 offen offset:2048 sc1
  v_mfma_f32_16x16x32_bf16 v[24:27], a[76:79], a[24:27], 0
  ds_read_b64_tr_b16 a[90:91], v225 offset:20480
  v_mfma_f32_16x16x32_bf16 v[24:27], a[72:75], a[8:11], v[24:27]
  v_mfma_f32_16x16x32_bf16 v[20:23], a[72:75], a[4:7], 0
  ds_read_b64_tr_b16 a[92:93], v225 offset:24576
  v_mfma_f32_16x16x32_bf16 v[20:23], a[76:79], a[20:23], v[20:23]
  buffer_load_dwordx4 a[48:51], v231, s[4:7], s72 offen offset:3072 sc1
  v_mfma_f32_16x16x32_bf16 v[16:19], a[76:79], a[16:19], 0
  ds_read_b64_tr_b16 a[94:95], v225 offset:28672
  s_add_u32 s72, s72, 4096
  v_mfma_f32_16x16x32_bf16 v[16:19], a[72:75], a[0:3], v[16:19]
  s_waitcnt lgkmcnt(4)
  v_mfma_f32_16x16x32_bf16 v[32:35], a[80:83], a[0:3], 0
  ds_read_b64_tr_b16 a[64:65], v226 offset:0
  v_mfma_f32_16x16x32_bf16 v[32:35], a[84:87], a[16:19], v[32:35]
  buffer_load_dwordx4 a[36:39], v231, s[4:7], s73 offen offset:2048 sc1
  v_mfma_f32_16x16x32_bf16 v[36:39], a[84:87], a[20:23], 0
  ds_read_b64_tr_b16 a[66:67], v226 offset:4096
  v_mfma_f32_16x16x32_bf16 v[36:39], a[80:83], a[4:7], v[36:39]
  v_mfma_f32_16x16x32_bf16 v[40:43], a[80:83], a[8:11], 0
  ds_read_b64_tr_b16 a[68:69], v226 offset:8192
  v_mfma_f32_16x16x32_bf16 v[40:43], a[84:87], a[24:27], v[40:43]
  buffer_load_dwordx4 a[52:55], v231, s[4:7], s73 offen offset:3072 sc1
  v_mfma_f32_16x16x32_bf16 v[44:47], a[84:87], a[28:31], 0
  ds_read_b64_tr_b16 a[70:71], v226 offset:12288
  s_add_u32 s73, s73, 4096
  v_mfma_f32_16x16x32_bf16 v[44:47], a[80:83], a[12:15], v[44:47]
  s_waitcnt lgkmcnt(4)
  v_mfma_f32_16x16x32_bf16 v[60:63], a[88:91], a[12:15], 0
  ds_read_b64_tr_b16 a[72:73], v226 offset:16384
  v_mfma_f32_16x16x32_bf16 v[60:63], a[92:95], a[28:31], v[60:63]
  buffer_load_dwordx4 a[40:43], v231, s[4:7], s74 offen offset:2048 sc1
  v_mfma_f32_16x16x32_bf16 v[56:59], a[92:95], a[24:27], 0
  ds_read_b64_tr_b16 a[74:75], v226 offset:20480
  v_mfma_f32_16x16x32_bf16 v[56:59], a[88:91], a[8:11], v[56:59]
  v_mfma_f32_16x16x32_bf16 v[52:55], a[88:91], a[4:7], 0
  ds_read_b64_tr_b16 a[76:77], v226 offset:24576
  v_mfma_f32_16x16x32_bf16 v[52:55], a[92:95], a[20:23], v[52:55]
  buffer_load_dwordx4 a[56:59], v231, s[4:7], s74 offen offset:3072 sc1
  v_mfma_f32_16x16x32_bf16 v[48:51], a[92:95], a[16:19], 0
  ds_read_b64_tr_b16 a[78:79], v226 offset:28672
  s_add_u32 s74, s74, 4096
  v_mfma_f32_16x16x32_bf16 v[48:51], a[88:91], a[0:3], v[48:51]
  s_waitcnt lgkmcnt(4)
  v_mfma_f32_16x16x32_bf16 v[64:67], a[64:67], a[0:3], 0
  ds_read_b64_tr_b16 a[80:81], v227 offset:0
  v_mfma_f32_16x16x32_bf16 v[64:67], a[68:71], a[16:19], v[64:67]
  buffer_load_dwordx4 a[44:47], v231, s[4:7], s75 offen offset:2048 sc1
  v_mfma_f32_16x16x32_bf16 v[68:71], a[68:71], a[20:23], 0
  ds_read_b64_tr_b16 a[82:83], v227 offset:4096
  v_mfma_f32_16x16x32_bf16 v[68:71], a[64:67], a[4:7], v[68:71]
  v_mfma_f32_16x16x32_bf16 v[72:75], a[64:67], a[8:11], 0
  ds_read_b64_tr_b16 a[84:85], v227 offset:8192
  v_mfma_f32_16x16x32_bf16 v[72:75], a[68:71], a[24:27], v[72:75]
  buffer_load_dwordx4 a[60:63], v231, s[4:7], s75 offen offset:3072 sc1
  v_mfma_f32_16x16x32_bf16 v[76:79], a[68:71], a[28:31], 0
  ds_read_b64_tr_b16 a[86:87], v227 offset:12288
  s_add_u32 s75, s75, 4096
  v_mfma_f32_16x16x32_bf16 v[76:79], a[64:67], a[12:15], v[76:79]
  s_waitcnt lgkmcnt(4)
  v_mfma_f32_16x16x32_bf16 v[92:95], a[72:75], a[12:15], 0
  ds_read_b64_tr_b16 a[88:89], v227 offset:16384
  s_add_u32 m0, s68, 32768
  v_mfma_f32_16x16x32_bf16 v[92:95], a[76:79], a[28:31], v[92:95]
  buffer_load_dwordx4 v231, s[4:7], s44 offen offset:0 sc1 lds
  v_mfma_f32_16x16x32_bf16 v[88:91], a[76:79], a[24:27], 0
  ds_read_b64_tr_b16 a[90:91], v227 offset:20480
  v_mfma_f32_16x16x32_bf16 v[88:91], a[72:75], a[8:11], v[88:91]
  v_mfma_f32_16x16x32_bf16 v[84:87], a[72:75], a[4:7], 0
  ds_read_b64_tr_b16 a[92:93], v227 offset:24576
  v_mfma_f32_16x16x32_bf16 v[84:87], a[76:79], a[20:23], v[84:87]
  buffer_load_dwordx4 v231, s[4:7], s44 offen offset:1024 sc1 lds
  v_mfma_f32_16x16x32_bf16 v[80:83], a[76:79], a[16:19], 0
  ds_read_b64_tr_b16 a[94:95], v227 offset:28672
  v_mfma_f32_16x16x32_bf16 v[80:83], a[72:75], a[0:3], v[80:83]
  s_waitcnt lgkmcnt(4)
  v_mfma_f32_16x16x32_bf16 v[96:99], a[80:83], a[0:3], 0
  ds_read_b64_tr_b16 a[64:65], v228 offset:0
  v_mfma_f32_16x16x32_bf16 v[96:99], a[84:87], a[16:19], v[96:99]
  buffer_load_dwordx4 v231, s[4:7], s44 offen offset:2048 sc1 lds
  v_mfma_f32_16x16x32_bf16 v[100:103], a[84:87], a[20:23], 0
  ds_read_b64_tr_b16 a[66:67], v228 offset:4096
  v_mfma_f32_16x16x32_bf16 v[100:103], a[80:83], a[4:7], v[100:103]
  v_mfma_f32_16x16x32_bf16 v[104:107], a[80:83], a[8:11], 0
  ds_read_b64_tr_b16 a[68:69], v228 offset:8192
  v_mfma_f32_16x16x32_bf16 v[104:107], a[84:87], a[24:27], v[104:107]
  buffer_load_dwordx4 v231, s[4:7], s44 offen offset:3072 sc1 lds
  v_mfma_f32_16x16x32_bf16 v[108:111], a[84:87], a[28:31], 0
  ds_read_b64_tr_b16 a[70:71], v228 offset:12288
  v_mfma_f32_16x16x32_bf16 v[108:111], a[80:83], a[12:15], v[108:111]
  s_waitcnt lgkmcnt(4)
  v_mfma_f32_16x16x32_bf16 v[124:127], a[88:91], a[12:15], 0
  ds_read_b64_tr_b16 a[72:73], v228 offset:16384
  s_add_u32 m0, s68, 49152
  v_mfma_f32_16x16x32_bf16 v[124:127], a[92:95], a[28:31], v[124:127]
  buffer_load_dwordx4 v231, s[4:7], s45 offen offset:0 sc1 lds
  v_mfma_f32_16x16x32_bf16 v[120:123], a[92:95], a[24:27], 0
  ds_read_b64_tr_b16 a[74:75], v228 offset:20480
  v_mfma_f32_16x16x32_bf16 v[120:123], a[88:91], a[8:11], v[120:123]
  v_mfma_f32_16x16x32_bf16 v[116:119], a[88:91], a[4:7], 0
  ds_read_b64_tr_b16 a[76:77], v228 offset:24576
  v_mfma_f32_16x16x32_bf16 v[116:119], a[92:95], a[20:23], v[116:119]
  buffer_load_dwordx4 v231, s[4:7], s45 offen offset:1024 sc1 lds
  v_mfma_f32_16x16x32_bf16 v[112:115], a[92:95], a[16:19], 0
  ds_read_b64_tr_b16 a[78:79], v228 offset:28672
  v_mfma_f32_16x16x32_bf16 v[112:115], a[88:91], a[0:3], v[112:115]
  s_waitcnt lgkmcnt(4)
  v_mfma_f32_16x16x32_bf16 v[128:131], a[64:67], a[0:3], 0
  ds_read_b64_tr_b16 a[80:81], v229 offset:0
  v_mfma_f32_16x16x32_bf16 v[128:131], a[68:71], a[16:19], v[128:131]
  buffer_load_dwordx4 v231, s[4:7], s45 offen offset:2048 sc1 lds
  v_mfma_f32_16x16x32_bf16 v[132:135], a[68:71], a[20:23], 0
  ds_read_b64_tr_b16 a[82:83], v229 offset:4096
  v_mfma_f32_16x16x32_bf16 v[132:135], a[64:67], a[4:7], v[132:135]
  v_mfma_f32_16x16x32_bf16 v[136:139], a[64:67], a[8:11], 0
  ds_read_b64_tr_b16 a[84:85], v229 offset:8192
  v_mfma_f32_16x16x32_bf16 v[136:139], a[68:71], a[24:27], v[136:139]
  buffer_load_dwordx4 v231, s[4:7], s45 offen offset:3072 sc1 lds
  v_mfma_f32_16x16x32_bf16 v[140:143], a[68:71], a[28:31], 0
  ds_read_b64_tr_b16 a[86:87], v229 offset:12288
  v_mfma_f32_16x16x32_bf16 v[140:143], a[64:67], a[12:15], v[140:143]
  s_waitcnt lgkmcnt(4)
  v_mfma_f32_16x16x32_bf16 v[156:159], a[72:75], a[12:15], 0
  ds_read_b64_tr_b16 a[88:89], v229 offset:16384
  v_mfma_f32_16x16x32_bf16 v[156:159], a[76:79], a[28:31], v[156:159]
  v_mfma_f32_16x16x32_bf16 v[152:155], a[76:79], a[24:27], 0
  ds_read_b64_tr_b16 a[90:91], v229 offset:20480
  s_add_u32 m0, s68, 0
  v_mfma_f32_16x16x32_bf16 v[152:155], a[72:75], a[8:11], v[152:155]
  buffer_load_dwordx4 v232, s[16:19], s67 offen offset:0  lds
  v_mfma_f32_16x16x32_bf16 v[148:151], a[72:75], a[4:7], 0
  ds_read_b64_tr_b16 a[92:93], v229 offset:24576
  v_mfma_f32_16x16x32_bf16 v[148:151], a[76:79], a[20:23], v[148:151]
  v_mfma_f32_16x16x32_bf16 v[144:147], a[76:79], a[16:19], 0
  ds_read_b64_tr_b16 a[94:95], v229 offset:28672
  v_mfma_f32_16x16x32_bf16 v[144:147], a[72:75], a[0:3], v[144:147]
  buffer_load_dwordx4 v233, s[16:19], s67 offen offset:1024  lds
  s_waitcnt lgkmcnt(4)
  v_mfma_f32_16x16x32_bf16 v[160:163], a[80:83], a[0:3], 0
  ds_read_b64_tr_b16 a[64:65], v230 offset:0
  v_mfma_f32_16x16x32_bf16 v[160:163], a[84:87], a[16:19], v[160:163]
  v_mfma_f32_16x16x32_bf16 v[164:167], a[84:87], a[20:23], 0
  ds_read_b64_tr_b16 a[66:67], v230 offset:4096
  v_mfma_f32_16x16x32_bf16 v[164:167], a[80:83], a[4:7], v[164:167]
  buffer_load_dwordx4 v234, s[16:19], s67 offen offset:2048  lds
  v_mfma_f32_16x16x32_bf16 v[168:171], a[80:83], a[8:11], 0
  ds_read_b64_tr_b16 a[68:69], v230 offset:8192
  v_mfma_f32_16x16x32_bf16 v[168:171], a[84:87], a[24:27], v[168:171]
  v_mfma_f32_16x16x32_bf16 v[172:175], a[84:87], a[28:31], 0
  ds_read_b64_tr_b16 a[70:71], v230 offset:12288
  v_mfma_f32_16x16x32_bf16 v[172:175], a[80:83], a[12:15], v[172:175]
  buffer_load_dwordx4 v235, s[16:19], s67 offen offset:3072  lds
  s_waitcnt lgkmcnt(4)
  v_mfma_f32_16x16x32_bf16 v[188:191], a[88:91], a[12:15], 0
  ds_read_b64_tr_b16 a[72:73], v230 offset:16384
  v_mfma_f32_16x16x32_bf16 v[188:191], a[92:95], a[28:31], v[188:191]
  v_mfma_f32_16x16x32_bf16 v[184:187], a[92:95], a[24:27], 0
  ds_read_b64_tr_b16 a[74:75], v230 offset:20480
  s_add_u32 m0, s68, 16384
  v_mfma_f32_16x16x32_bf16 v[184:187], a[88:91], a[8:11], v[184:187]
  buffer_load_dwordx4 v232, s[20:23], s67 offen offset:0  lds
  v_mfma_f32_16x16x32_bf16 v[180:183], a[88:91], a[4:7], 0
  ds_read_b64_tr_b16 a[76:77], v230 offset:24576
  v_mfma_f32_16x16x32_bf16 v[180:183], a[92:95], a[20:23], v[180:183]
  v_mfma_f32_16x16x32_bf16 v[176:179], a[92:95], a[16:19], 0
  ds_read_b64_tr_b16 a[78:79], v230 offset:28672
  v_mfma_f32_16x16x32_bf16 v[176:179], a[88:91], a[0:3], v[176:179]
  buffer_load_dwordx4 v233, s[20:23], s67 offen offset:1024  lds
  s_waitcnt lgkmcnt(4)
  v_mfma_f32_16x16x32_bf16 v[192:195], a[64:67], a[0:3], 0
  s_barrier
  ds_read_b64_tr_b16 a[80:81], v224 offset:32768
  v_mfma_f32_16x16x32_bf16 v[192:195], a[68:71], a[16:19], v[192:195]
  v_mfma_f32_16x16x32_bf16 v[196:199], a[68:71], a[20:23], 0
  ds_read_b64_tr_b16 a[82:83], v224 offset:36864
  v_mfma_f32_16x16x32_bf16 v[196:199], a[64:67], a[4:7], v[196:199]
  buffer_load_dwordx4 v234, s[20:23], s67 offen offset:2048  lds
  v_mfma_f32_16x16x32_bf16 v[200:203], a[64:67], a[8:11], 0
  ds_read_b64_tr_b16 a[84:85], v224 offset:40960
  v_mfma_f32_16x16x32_bf16 v[200:203], a[68:71], a[24:27], v[200:203]
  v_mfma_f32_16x16x32_bf16 v[204:207], a[68:71], a[28:31], 0
  ds_read_b64_tr_b16 a[86:87], v224 offset:45056
  v_mfma_f32_16x16x32_bf16 v[204:207], a[64:67], a[12:15], v[204:207]
  buffer_load_dwordx4 v235, s[20:23], s67 offen offset:3072  lds
  s_waitcnt lgkmcnt(4)
  v_mfma_f32_16x16x32_bf16 v[220:223], a[72:75], a[12:15], 0
  ds_read_b64_tr_b16 a[88:89], v224 offset:49152
  s_add_u32 s67, s67, 458752
  v_mfma_f32_16x16x32_bf16 v[220:223], a[76:79], a[28:31], v[220:223]
  v_mfma_f32_16x16x32_bf16 v[216:219], a[76:79], a[24:27], 0
  ds_read_b64_tr_b16 a[90:91], v224 offset:53248
  v_mfma_f32_16x16x32_bf16 v[216:219], a[72:75], a[8:11], v[216:219]
  v_mfma_f32_16x16x32_bf16 v[212:215], a[72:75], a[4:7], 0
  ds_read_b64_tr_b16 a[92:93], v224 offset:57344
  buffer_load_dwordx4 a[96:99], v236, s[24:27], s70 offen
  v_mfma_f32_16x16x32_bf16 v[212:215], a[76:79], a[20:23], v[212:215]
  s_add_u32 s70, s70, 1024
  v_mfma_f32_16x16x32_bf16 v[208:211], a[76:79], a[16:19], 0
  ds_read_b64_tr_b16 a[94:95], v224 offset:61440
  v_xor_b32 v224, 0x10000, v224
  v_mfma_f32_16x16x32_bf16 v[208:211], a[72:75], a[0:3], v[208:211]
Lmk_p3s1:
  s_waitcnt vmcnt(17) lgkmcnt(4)
  v_mfma_f32_16x16x32_bf16 v[0:3], a[80:83], a[32:35], v[0:3]
  ds_read_b64_tr_b16 a[64:65], v225 offset:32768
  v_mfma_f32_16x16x32_bf16 v[0:3], a[84:87], a[48:51], v[0:3]
  v_mfma_f32_16x16x32_bf16 v[4:7], a[84:87], a[52:55], v[4:7]
  ds_read_b64_tr_b16 a[66:67], v225 offset:36864
  v_mfma_f32_16x16x32_bf16 v[4:7], a[80:83], a[36:39], v[4:7]
  buffer_load_dwordx4 a[0:3], v231, s[4:7], s72 offen offset:0 sc1
  v_mfma_f32_16x16x32_bf16 v[8:11], a[80:83], a[40:43], v[8:11]
  ds_read_b64_tr_b16 a[68:69], v225 offset:40960
  v_mfma_f32_16x16x32_bf16 v[8:11], a[84:87], a[56:59], v[8:11]
  s_add_u32 s43, s68, 32768
  v_lshlrev_b32 v250, 3, v253
  v_mfma_f32_16x16x32_bf16 v[12:15], a[84:87], a[60:63], v[12:15]
  ds_read_b64_tr_b16 a[70:71], v225 offset:45056
  v_add_u32 v250, s43, v250
  v_mfma_f32_16x16x32_bf16 v[12:15], a[80:83], a[44:47], v[12:15]
  s_waitcnt lgkmcnt(4)
  v_mfma_f32_16x16x32_bf16 v[28:31], a[88:91], a[44:47], v[28:31]
  ds_read_b64_tr_b16 a[72:73], v225 offset:49152
  v_mfma_f32_16x16x32_bf16 v[28:31], a[92:95], a[60:63], v[28:31]
  v_mfma_f32_16x16x32_bf16 v[24:27], a[92:95], a[56:59], v[24:27]
  ds_read_b64_tr_b16 a[74:75], v225 offset:53248
  buffer_load_dwordx4 a[16:19], v231, s[4:7], s72 offen offset:1024 sc1
  v_mfma_f32_16x16x32_bf16 v[24:27], a[88:91], a[40:43], v[24:27]
  v_mfma_f32_16x16x32_bf16 v[20:23], a[88:91], a[36:39], v[20:23]
  ds_read_b64_tr_b16 a[76:77], v225 offset:57344
  v_mfma_f32_16x16x32_bf16 v[20:23], a[92:95], a[52:55], v[20:23]
  s_waitcnt vmcnt(11)
  ds_read_b64 v[238:239], v250 offset:0
  v_mfma_f32_16x16x32_bf16 v[16:19], a[92:95], a[48:51], v[16:19]
  ds_read_b64_tr_b16 a[78:79], v225 offset:61440
  ds_read_b64 v[240:241], v250 offset:2048
  v_xor_b32 v225, 0x10000, v225
  v_mfma_f32_16x16x32_bf16 v[16:19], a[88:91], a[32:35], v[16:19]
  ds_read_b64 v[242:243], v250 offset:16384
  s_waitcnt lgkmcnt(7)
  v_mfma_f32_16x16x32_bf16 v[32:35], a[64:67], a[32:35], v[32:35]
  ds_read_b64_tr_b16 a[80:81], v226 offset:32768
  ds_read_b64 v[244:245], v250 offset:18432
  v_mfma_f32_16x16x32_bf16 v[32:35], a[68:71], a[48:51], v[32:35]
  buffer_load_dwordx4 a[4:7], v231, s[4:7], s73 offen offset:0 sc1
  ds_read_b64 v[246:247], v250 offset:512
  v_mfma_f32_16x16x32_bf16 v[36:39], a[68:71], a[52:55], v[36:39]
  ds_read_b64_tr_b16 a[82:83], v226 offset:36864
  v_mfma_f32_16x16x32_bf16 v[36:39], a[64:67], a[36:39], v[36:39]
  v_mfma_f32_16x16x32_bf16 v[40:43], a[64:67], a[40:43], v[40:43]
  ds_read_b64_tr_b16 a[84:85], v226 offset:40960
  ds_read_b64 v[248:249], v250 offset:2560
  v_mfma_f32_16x16x32_bf16 v[40:43], a[68:71], a[56:59], v[40:43]
  v_mfma_f32_16x16x32_bf16 v[44:47], a[68:71], a[60:63], v[44:47]
  s_waitcnt lgkmcnt(3)
  ds_read_b64_tr_b16 a[86:87], v226 offset:45056
  v_add_f32 v238, v238, v246
  v_add_f32 v239, v239, v247
  v_mfma_f32_16x16x32_bf16 v[44:47], a[64:67], a[44:47], v[44:47]
  ds_read_b64 v[246:247], v250 offset:16896
  v_mfma_f32_16x16x32_bf16 v[60:63], a[72:75], a[44:47], v[60:63]
  ds_read_b64_tr_b16 a[88:89], v226 offset:49152
  buffer_load_dwordx4 a[20:23], v231, s[4:7], s73 offen offset:1024 sc1
  v_mfma_f32_16x16x32_bf16 v[60:63], a[76:79], a[60:63], v[60:63]
  s_waitcnt lgkmcnt(3)
  v_add_f32 v240, v240, v248
  v_add_f32 v241, v241, v249
  v_mfma_f32_16x16x32_bf16 v[56:59], a[76:79], a[56:59], v[56:59]
  ds_read_b64_tr_b16 a[90:91], v226 offset:53248
  ds_read_b64 v[248:249], v250 offset:18944
  v_mfma_f32_16x16x32_bf16 v[56:59], a[72:75], a[40:43], v[56:59]
  v_mfma_f32_16x16x32_bf16 v[52:55], a[72:75], a[36:39], v[52:55]
  s_waitcnt lgkmcnt(3)
  ds_read_b64_tr_b16 a[92:93], v226 offset:57344
  v_add_f32 v242, v242, v246
  v_add_f32 v243, v243, v247
  v_mfma_f32_16x16x32_bf16 v[52:55], a[76:79], a[52:55], v[52:55]
  ds_read_b64 v[246:247], v250 offset:1024
  v_mfma_f32_16x16x32_bf16 v[48:51], a[76:79], a[48:51], v[48:51]
  ds_read_b64_tr_b16 a[94:95], v226 offset:61440
  v_xor_b32 v226, 0x10000, v226
  v_mfma_f32_16x16x32_bf16 v[48:51], a[72:75], a[32:35], v[48:51]
  s_waitcnt lgkmcnt(3)
  buffer_load_dwordx4 a[8:11], v231, s[4:7], s74 offen offset:0 sc1
  v_add_f32 v244, v244, v248
  v_add_f32 v245, v245, v249
  v_mfma_f32_16x16x32_bf16 v[64:67], a[80:83], a[32:35], v[64:67]
  ds_read_b64_tr_b16 a[64:65], v227 offset:32768
  ds_read_b64 v[248:249], v250 offset:3072
  v_mfma_f32_16x16x32_bf16 v[64:67], a[84:87], a[48:51], v[64:67]
  v_mfma_f32_16x16x32_bf16 v[68:71], a[84:87], a[52:55], v[68:71]
  s_waitcnt lgkmcnt(3)
  ds_read_b64_tr_b16 a[66:67], v227 offset:36864
  v_add_f32 v238, v238, v246
  v_add_f32 v239, v239, v247
  v_mfma_f32_16x16x32_bf16 v[68:71], a[80:83], a[36:39], v[68:71]
  ds_read_b64 v[246:247], v250 offset:17408
  v_mfma_f32_16x16x32_bf16 v[72:75], a[80:83], a[40:43], v[72:75]
  ds_read_b64_tr_b16 a[68:69], v227 offset:40960
  v_mfma_f32_16x16x32_bf16 v[72:75], a[84:87], a[56:59], v[72:75]
  s_waitcnt lgkmcnt(3)
  v_add_f32 v240, v240, v248
  v_add_f32 v241, v241, v249
  v_mfma_f32_16x16x32_bf16 v[76:79], a[84:87], a[60:63], v[76:79]
  ds_read_b64_tr_b16 a[70:71], v227 offset:45056
  buffer_load_dwordx4 a[24:27], v231, s[4:7], s74 offen offset:1024 sc1
  ds_read_b64 v[248:249], v250 offset:19456
  v_mfma_f32_16x16x32_bf16 v[76:79], a[80:83], a[44:47], v[76:79]
  v_mfma_f32_16x16x32_bf16 v[92:95], a[88:91], a[44:47], v[92:95]
  s_waitcnt lgkmcnt(3)
  ds_read_b64_tr_b16 a[72:73], v227 offset:49152
  v_add_f32 v242, v242, v246
  v_add_f32 v243, v243, v247
  v_mfma_f32_16x16x32_bf16 v[92:95], a[92:95], a[60:63], v[92:95]
  ds_read_b64 v[246:247], v250 offset:1536
  v_mfma_f32_16x16x32_bf16 v[88:91], a[92:95], a[56:59], v[88:91]
  ds_read_b64_tr_b16 a[74:75], v227 offset:53248
  v_mfma_f32_16x16x32_bf16 v[88:91], a[88:91], a[40:43], v[88:91]
  s_waitcnt lgkmcnt(3)
  v_add_f32 v244, v244, v248
  v_add_f32 v245, v245, v249
  v_mfma_f32_16x16x32_bf16 v[84:87], a[88:91], a[36:39], v[84:87]
  ds_read_b64_tr_b16 a[76:77], v227 offset:57344
  ds_read_b64 v[248:249], v250 offset:3584
  v_mfma_f32_16x16x32_bf16 v[84:87], a[92:95], a[52:55], v[84:87]
  buffer_load_dwordx4 a[12:15], v231, s[4:7], s75 offen offset:0 sc1
  v_mfma_f32_16x16x32_bf16 v[80:83], a[92:95], a[48:51], v[80:83]
  s_waitcnt lgkmcnt(3)
  ds_read_b64_tr_b16 a[78:79], v227 offset:61440
  v_xor_b32 v227, 0x10000, v227
  v_add_f32 v238, v238, v246
  v_add_f32 v239, v239, v247
  v_mfma_f32_16x16x32_bf16 v[80:83], a[88:91], a[32:35], v[80:83]
  ds_read_b64 v[246:247], v250 offset:17920
  buffer_load_dword v237, v251, s[4:7], s48 offen sc1
  v_mfma_f32_16x16x32_bf16 v[96:99], a[64:67], a[32:35], v[96:99]
  ds_read_b64_tr_b16 a[80:81], v228 offset:32768
  v_mfma_f32_16x16x32_bf16 v[96:99], a[68:71], a[48:51], v[96:99]
  s_waitcnt lgkmcnt(3)
  v_add_f32 v240, v240, v248
  v_add_f32 v241, v241, v249
  v_mfma_f32_16x16x32_bf16 v[100:103], a[68:71], a[52:55], v[100:103]
  ds_read_b64_tr_b16 a[82:83], v228 offset:36864
  ds_read_b64 v[248:249], v250 offset:19968
  v_mfma_f32_16x16x32_bf16 v[100:103], a[64:67], a[36:39], v[100:103]
  v_mfma_f32_16x16x32_bf16 v[104:107], a[64:67], a[40:43], v[104:107]
  s_waitcnt lgkmcnt(3)
  ds_read_b64_tr_b16 a[84:85], v228 offset:40960
  buffer_load_dwordx4 a[28:31], v231, s[4:7], s75 offen offset:1024 sc1
  v_add_f32 v242, v242, v246
  v_add_f32 v243, v243, v247
  v_mfma_f32_16x16x32_bf16 v[104:107], a[68:71], a[56:59], v[104:107]
  buffer_load_dwordx4 a[96:99], v236, s[24:27], s70 offen
  v_mfma_f32_16x16x32_bf16 v[108:111], a[68:71], a[60:63], v[108:111]
  ds_read_b64_tr_b16 a[86:87], v228 offset:45056
  s_add_u32 s70, s70, 1024
  v_mfma_f32_16x16x32_bf16 v[108:111], a[64:67], a[44:47], v[108:111]
  s_waitcnt lgkmcnt(2)
  v_add_f32 v244, v244, v248
  v_add_f32 v245, v245, v249
  v_mfma_f32_16x16x32_bf16 v[124:127], a[72:75], a[44:47], v[124:127]
  ds_read_b64_tr_b16 a[88:89], v228 offset:49152
  s_mov_b32 s43, 0x3a800000
  v_mfma_f32_16x16x32_bf16 v[124:127], a[76:79], a[60:63], v[124:127]
  v_mov_b32 v250, 0x3727c5ac
  v_lshlrev_b32 v246, 2, v253
  v_mfma_f32_16x16x32_bf16 v[120:123], a[76:79], a[56:59], v[120:123]
  ds_read_b64_tr_b16 a[90:91], v228 offset:53248
  s_add_u32 m0, s68, 32768
  v_mfma_f32_16x16x32_bf16 v[120:123], a[72:75], a[40:43], v[120:123]
  buffer_load_dwordx4 v232, s[16:19], s67 offen offset:0  lds
  v_add_u32 v246, s71, v246
  v_mfma_f32_16x16x32_bf16 v[116:119], a[72:75], a[36:39], v[116:119]
  ds_read_b64_tr_b16 a[92:93], v228 offset:57344
  v_permlane32_swap_b32 v238, v242
  v_mfma_f32_16x16x32_bf16 v[116:119], a[76:79], a[52:55], v[116:119]
  v_permlane32_swap_b32 v239, v243
  v_permlane32_swap_b32 v240, v244
  v_mfma_f32_16x16x32_bf16 v[112:115], a[76:79], a[48:51], v[112:115]
  ds_read_b64_tr_b16 a[94:95], v228 offset:61440
  v_xor_b32 v228, 0x10000, v228
  v_permlane32_swap_b32 v241, v245
  v_mfma_f32_16x16x32_bf16 v[112:115], a[72:75], a[32:35], v[112:115]
  s_waitcnt lgkmcnt(4)
  v_add_f32 v238, v238, v242
  v_add_f32 v240, v240, v244
  v_mfma_f32_16x16x32_bf16 v[128:131], a[80:83], a[32:35], v[128:131]
  ds_read_b64_tr_b16 a[64:65], v229 offset:32768
  v_add_f32 v239, v239, v243
  v_mfma_f32_16x16x32_bf16 v[128:131], a[84:87], a[48:51], v[128:131]
  v_add_f32 v241, v241, v245
  v_and_b32 v247, 0xffffff3f, v246
  v_mfma_f32_16x16x32_bf16 v[132:135], a[84:87], a[52:55], v[132:135]
  ds_read_b64_tr_b16 a[66:67], v229 offset:36864
  buffer_load_dwordx4 v233, s[16:19], s67 offen offset:1024  lds
  v_mfma_f32_16x16x32_bf16 v[132:135], a[80:83], a[36:39], v[132:135]
  v_permlane16_swap_b32 v238, v240
  v_permlane16_swap_b32 v239, v241
  v_mfma_f32_16x16x32_bf16 v[136:139], a[80:83], a[40:43], v[136:139]
  ds_read_b64_tr_b16 a[68:69], v229 offset:40960
  v_add_f32 v238, v238, v240
  v_mfma_f32_16x16x32_bf16 v[136:139], a[84:87], a[56:59], v[136:139]
  v_add_f32 v239, v239, v241
  v_add_u32 v247, 1024, v247
  v_mfma_f32_16x16x32_bf16 v[140:143], a[84:87], a[60:63], v[140:143]
  ds_read_b64_tr_b16 a[70:71], v229 offset:45056
  v_mul_f32 v238, 0xba800000, v238
  v_mfma_f32_16x16x32_bf16 v[140:143], a[80:83], a[44:47], v[140:143]
  s_waitcnt lgkmcnt(4)
  v_fma_f32 v239, v239, s43, v250
  v_fma_f32 v239, -v238, v238, v239
  v_mfma_f32_16x16x32_bf16 v[156:159], a[88:91], a[44:47], v[156:159]
  ds_read_b64_tr_b16 a[72:73], v229 offset:49152
  v_max_f32 v239, v239, v250
  v_mfma_f32_16x16x32_bf16 v[156:159], a[92:95], a[60:63], v[156:159]
  buffer_load_dwordx4 v234, s[16:19], s67 offen offset:2048  lds
  v_rsq_f32 v240, v239
  v_mfma_f32_16x16x32_bf16 v[152:155], a[92:95], a[56:59], v[152:155]
  ds_read_b64_tr_b16 a[74:75], v229 offset:53248
  ds_write_b32 v246, v238 offset:1024
  v_mfma_f32_16x16x32_bf16 v[152:155], a[88:91], a[40:43], v[152:155]
  ds_write_b32 v246, v239 offset:1536
  v_mul_f32 v240, 0xbfb8aa3b, v240
  v_mfma_f32_16x16x32_bf16 v[148:151], a[88:91], a[36:39], v[148:151]
  ds_read_b64_tr_b16 a[76:77], v229 offset:57344
  ds_write_b32 v246, v240 offset:1280
  v_mfma_f32_16x16x32_bf16 v[148:151], a[92:95], a[52:55], v[148:151]
  ds_read2_b32 v[238:239], v247 offset0:0 offset1:16
  ds_read2_b32 v[240:241], v247 offset0:32 offset1:48
  v_mfma_f32_16x16x32_bf16 v[144:147], a[92:95], a[48:51], v[144:147]
  ds_read_b64_tr_b16 a[78:79], v229 offset:61440
  v_xor_b32 v229, 0x10000, v229
  v_lshrrev_b32 v250, 3, v253
  v_mfma_f32_16x16x32_bf16 v[144:147], a[88:91], a[32:35], v[144:147]
  s_waitcnt lgkmcnt(9)
  v_add_u32 v250, s66, v250
  v_cmp_ne_u32 vcc, 7, v250
  v_mfma_f32_16x16x32_bf16 v[160:163], a[64:67], a[32:35], v[160:163]
  ds_read_b64_tr_b16 a[80:81], v230 offset:32768
  buffer_load_dwordx4 v235, s[16:19], s67 offen offset:3072  lds
  v_mfma_f32_16x16x32_bf16 v[160:163], a[68:71], a[48:51], v[160:163]
  v_bfe_u32 v242, v253, 2, 1
  v_mul_u32_u24 v242, 14336, v242
  v_mfma_f32_16x16x32_bf16 v[164:167], a[68:71], a[52:55], v[164:167]
  ds_read_b64_tr_b16 a[82:83], v230 offset:36864
  v_cndmask_b32 v250, 0, v250, vcc
  v_mfma_f32_16x16x32_bf16 v[164:167], a[64:67], a[36:39], v[164:167]
  v_lshl_add_u32 v250, v250, 6, v242
  v_and_b32 v242, 3, v253
  v_mfma_f32_16x16x32_bf16 v[168:171], a[64:67], a[40:43], v[168:171]
  ds_read_b64_tr_b16 a[84:85], v230 offset:40960
  v_lshl_add_u32 v250, v242, 4, v250
  v_mfma_f32_16x16x32_bf16 v[168:171], a[68:71], a[56:59], v[168:171]
  s_waitcnt vmcnt(6)
  v_cmp_gt_u32 vcc, 56, v237
  s_cbranch_vccz Lcdn16
  s_mov_b32 s43, 0x40000
Lchk15:
  s_sleep 8
  buffer_load_dword v237, v251, s[4:7], s48 offen sc1
  s_waitcnt vmcnt(0)
  v_cmp_gt_u32 vcc, 56, v237
  s_cbranch_vccz Lcdn16
  s_sub_u32 s43, s43, 1
  s_cmp_lg_u32 s43, 0
  s_cbranch_scc1 Lchk15
Lcdn16:
  buffer_load_dwordx4 v[242:245], v250, s[4:7], s46 offen sc1
  v_mfma_f32_16x16x32_bf16 v[172:175], a[68:71], a[60:63], v[172:175]
  ds_read_b64_tr_b16 a[86:87], v230 offset:45056
  s_add_u32 m0, s68, 49152
  v_mfma_f32_16x16x32_bf16 v[172:175], a[64:67], a[44:47], v[172:175]
  s_waitcnt lgkmcnt(4)
  buffer_load_dwordx4 v232, s[20:23], s67 offen offset:0  lds
  buffer_load_dwordx4 v[246:249], v250, s[4:7], s47 offen sc1
  v_mfma_f32_16x16x32_bf16 v[188:191], a[72:75], a[44:47], v[188:191]
  ds_read_b64_tr_b16 a[88:89], v230 offset:49152
  v_lshrrev_b32 v237, 4, v253
  v_mfma_f32_16x16x32_bf16 v[188:191], a[76:79], a[60:63], v[188:191]
  v_lshlrev_b32 v237, 4, v237
  v_add_u32 v237, s71, v237
  v_mfma_f32_16x16x32_bf16 v[184:187], a[76:79], a[56:59], v[184:187]
  ds_read_b64_tr_b16 a[90:91], v230 offset:53248
  v_add_u32 v250, s71, v231
  v_mfma_f32_16x16x32_bf16 v[184:187], a[72:75], a[40:43], v[184:187]
  v_mfma_f32_16x16x32_bf16 v[180:183], a[72:75], a[36:39], v[180:183]
  ds_read_b64_tr_b16 a[92:93], v230 offset:57344
  v_mfma_f32_16x16x32_bf16 v[180:183], a[76:79], a[52:55], v[180:183]
  v_mfma_f32_16x16x32_bf16 v[176:179], a[76:79], a[48:51], v[176:179]
  ds_read_b64_tr_b16 a[94:95], v230 offset:61440
  buffer_load_dwordx4 v233, s[20:23], s67 offen offset:1024  lds
  v_xor_b32 v230, 0x10000, v230
  v_mfma_f32_16x16x32_bf16 v[176:179], a[72:75], a[32:35], v[176:179]
  s_waitcnt lgkmcnt(4)
  v_mfma_f32_16x16x32_bf16 v[192:195], a[80:83], a[32:35], v[192:195]
  s_barrier
  ds_read_b64_tr_b16 a[64:65], v224 offset:0
  v_mfma_f32_16x16x32_bf16 v[192:195], a[84:87], a[48:51], v[192:195]
  v_mfma_f32_16x16x32_bf16 v[196:199], a[84:87], a[52:55], v[196:199]
  ds_read_b64_tr_b16 a[66:67], v224 offset:4096
  v_mfma_f32_16x16x32_bf16 v[196:199], a[80:83], a[36:39], v[196:199]
  v_mfma_f32_16x16x32_bf16 v[200:203], a[80:83], a[40:43], v[200:203]
  ds_read_b64_tr_b16 a[68:69], v224 offset:8192
  v_mfma_f32_16x16x32_bf16 v[200:203], a[84:87], a[56:59], v[200:203]
  buffer_load_dwordx4 v234, s[20:23], s67 offen offset:2048  lds
  v_mfma_f32_16x16x32_bf16 v[204:207], a[84:87], a[60:63], v[204:207]
  ds_read_b64_tr_b16 a[70:71], v224 offset:12288
  v_mfma_f32_16x16x32_bf16 v[204:207], a[80:83], a[44:47], v[204:207]
  s_waitcnt lgkmcnt(4)
  v_mfma_f32_16x16x32_bf16 v[220:223], a[88:91], a[44:47], v[220:223]
  ds_read_b64_tr_b16 a[72:73], v224 offset:16384
  v_mfma_f32_16x16x32_bf16 v[220:223], a[92:95], a[60:63], v[220:223]
  v_mfma_f32_16x16x32_bf16 v[216:219], a[92:95], a[56:59], v[216:219]
  ds_read_b64_tr_b16 a[74:75], v224 offset:20480
  v_mfma_f32_16x16x32_bf16 v[216:219], a[88:91], a[40:43], v[216:219]
  v_mfma_f32_16x16x32_bf16 v[212:215], a[88:91], a[36:39], v[212:215]
  ds_read_b64_tr_b16 a[76:77], v224 offset:24576
  buffer_load_dwordx4 v235, s[20:23], s67 offen offset:3072  lds
  v_mfma_f32_16x16x32_bf16 v[212:215], a[92:95], a[52:55], v[212:215]
  s_add_u32 s67, s67, 458752
  s_xor_b32 s68, s68, 0x10000
  v_mfma_f32_16x16x32_bf16 v[208:211], a[92:95], a[48:51], v[208:211]
  ds_read_b64_tr_b16 a[78:79], v224 offset:28672
  v_mfma_f32_16x16x32_bf16 v[208:211], a[88:91], a[32:35], v[208:211]
  s_mov_b32 s56, 5
.p2align 3
Lp3_loop:
  s_waitcnt vmcnt(8) lgkmcnt(4)
  v_mfma_f32_16x16x32_bf16 v[0:3], a[64:67], a[0:3], v[0:3]
  ds_read_b64_tr_b16 a[80:81], v225 offset:0
  v_mfma_f32_16x16x32_bf16 v[0:3], a[68:71], a[16:19], v[0:3]
  v_mfma_f32_16x16x32_bf16 v[4:7], a[68:71], a[20:23], v[4:7]
  ds_read_b64_tr_b16 a[82:83], v225 offset:4096
  v_mfma_f32_16x16x32_bf16 v[4:7], a[64:67], a[4:7], v[4:7]
  buffer_load_dwordx4 a[32:35], v231, s[4:7], s72 offen offset:2048 sc1
  v_mfma_f32_16x16x32_bf16 v[8:11], a[64:67], a[8:11], v[8:11]
  ds_read_b64_tr_b16 a[84:85], v225 offset:8192
  v_mfma_f32_16x16x32_bf16 v[8:11], a[68:71], a[24:27], v[8:11]
  v_mfma_f32_16x16x32_bf16 v[12:15], a[68:71], a[28:31], v[12:15]
  ds_read_b64_tr_b16 a[86:87], v225 offset:12288
  v_mfma_f32_16x16x32_bf16 v[12:15], a[64:67], a[12:15], v[12:15]
  s_waitcnt lgkmcnt(4)
  v_mfma_f32_16x16x32_bf16 v[28:31], a[72:75], a[12:15], v[28:31]
  ds_read_b64_tr_b16 a[88:89], v225 offset:16384
  v_mfma_f32_16x16x32_bf16 v[28:31], a[76:79], a[28:31], v[28:31]
  v_mfma_f32_16x16x32_bf16 v[24:27], a[76:79], a[24:27], v[24:27]
  ds_read_b64_tr_b16 a[90:91], v225 offset:20480
  buffer_load_dwordx4 a[48:51], v231, s[4:7], s72 offen offset:3072 sc1
  v_mfma_f32_16x16x32_bf16 v[24:27], a[72:75], a[8:11], v[24:27]
  s_add_u32 s72, s72, 4096
  v_mfma_f32_16x16x32_bf16 v[20:23], a[72:75], a[4:7], v[20:23]
  ds_read_b64_tr_b16 a[92:93], v225 offset:24576
  v_mfma_f32_16x16x32_bf16 v[20:23], a[76:79], a[20:23], v[20:23]
  v_mfma_f32_16x16x32_bf16 v[16:19], a[76:79], a[16:19], v[16:19]
  ds_read_b64_tr_b16 a[94:95], v225 offset:28672
  v_mfma_f32_16x16x32_bf16 v[16:19], a[72:75], a[0:3], v[16:19]
  s_waitcnt lgkmcnt(4)
  v_mfma_f32_16x16x32_bf16 v[32:35], a[80:83], a[0:3], v[32:35]
  ds_read_b64_tr_b16 a[64:65], v226 offset:0
  v_mfma_f32_16x16x32_bf16 v[32:35], a[84:87], a[16:19], v[32:35]
  buffer_load_dwordx4 a[36:39], v231, s[4:7], s73 offen offset:2048 sc1
  v_mfma_f32_16x16x32_bf16 v[36:39], a[84:87], a[20:23], v[36:39]
  ds_read_b64_tr_b16 a[66:67], v226 offset:4096
  v_mfma_f32_16x16x32_bf16 v[36:39], a[80:83], a[4:7], v[36:39]
  v_mfma_f32_16x16x32_bf16 v[40:43], a[80:83], a[8:11], v[40:43]
  ds_read_b64_tr_b16 a[68:69], v226 offset:8192
  v_mfma_f32_16x16x32_bf16 v[40:43], a[84:87], a[24:27], v[40:43]
  v_mfma_f32_16x16x32_bf16 v[44:47], a[84:87], a[28:31], v[44:47]
  ds_read_b64_tr_b16 a[70:71], v226 offset:12288
  v_mfma_f32_16x16x32_bf16 v[44:47], a[80:83], a[12:15], v[44:47]
  s_waitcnt lgkmcnt(4)
  v_mfma_f32_16x16x32_bf16 v[60:63], a[88:91], a[12:15], v[60:63]
  ds_read_b64_tr_b16 a[72:73], v226 offset:16384
  buffer_load_dwordx4 a[52:55], v231, s[4:7], s73 offen offset:3072 sc1
  v_mfma_f32_16x16x32_bf16 v[60:63], a[92:95], a[28:31], v[60:63]
  s_add_u32 s73, s73, 4096
  v_mfma_f32_16x16x32_bf16 v[56:59], a[92:95], a[24:27], v[56:59]
  ds_read_b64_tr_b16 a[74:75], v226 offset:20480
  v_mfma_f32_16x16x32_bf16 v[56:59], a[88:91], a[8:11], v[56:59]
  v_mfma_f32_16x16x32_bf16 v[52:55], a[88:91], a[4:7], v[52:55]
  ds_read_b64_tr_b16 a[76:77], v226 offset:24576
  v_mfma_f32_16x16x32_bf16 v[52:55], a[92:95], a[20:23], v[52:55]
  v_mfma_f32_16x16x32_bf16 v[48:51], a[92:95], a[16:19], v[48:51]
  ds_read_b64_tr_b16 a[78:79], v226 offset:28672
  v_mfma_f32_16x16x32_bf16 v[48:51], a[88:91], a[0:3], v[48:51]
  buffer_load_dwordx4 a[40:43], v231, s[4:7], s74 offen offset:2048 sc1
  s_waitcnt lgkmcnt(4)
  v_mfma_f32_16x16x32_bf16 v[64:67], a[64:67], a[0:3], v[64:67]
  ds_read_b64_tr_b16 a[80:81], v227 offset:0
  v_mfma_f32_16x16x32_bf16 v[64:67], a[68:71], a[16:19], v[64:67]
  v_mfma_f32_16x16x32_bf16 v[68:71], a[68:71], a[20:23], v[68:71]
  ds_read_b64_tr_b16 a[82:83], v227 offset:4096
  v_mfma_f32_16x16x32_bf16 v[68:71], a[64:67], a[4:7], v[68:71]
  v_mfma_f32_16x16x32_bf16 v[72:75], a[64:67], a[8:11], v[72:75]
  ds_read_b64_tr_b16 a[84:85], v227 offset:8192
  v_mfma_f32_16x16x32_bf16 v[72:75], a[68:71], a[24:27], v[72:75]
  v_mfma_f32_16x16x32_bf16 v[76:79], a[68:71], a[28:31], v[76:79]
  ds_read_b64_tr_b16 a[86:87], v227 offset:12288
  buffer_load_dwordx4 a[56:59], v231, s[4:7], s74 offen offset:3072 sc1
  v_mfma_f32_16x16x32_bf16 v[76:79], a[64:67], a[12:15], v[76:79]
  s_add_u32 s74, s74, 4096
  s_waitcnt lgkmcnt(4)
  v_mfma_f32_16x16x32_bf16 v[92:95], a[72:75], a[12:15], v[92:95]
  ds_read_b64_tr_b16 a[88:89], v227 offset:16384
  v_mfma_f32_16x16x32_bf16 v[92:95], a[76:79], a[28:31], v[92:95]
  v_mfma_f32_16x16x32_bf16 v[88:91], a[76:79], a[24:27], v[88:91]
  ds_read_b64_tr_b16 a[90:91], v227 offset:20480
  v_mfma_f32_16x16x32_bf16 v[88:91], a[72:75], a[8:11], v[88:91]
  v_mfma_f32_16x16x32_bf16 v[84:87], a[72:75], a[4:7], v[84:87]
  ds_read_b64_tr_b16 a[92:93], v227 offset:24576
  v_mfma_f32_16x16x32_bf16 v[84:87], a[76:79], a[20:23], v[84:87]
  buffer_load_dwordx4 a[44:47], v231, s[4:7], s75 offen offset:2048 sc1
  v_mfma_f32_16x16x32_bf16 v[80:83], a[76:79], a[16:19], v[80:83]
  ds_read_b64_tr_b16 a[94:95], v227 offset:28672
  v_mfma_f32_16x16x32_bf16 v[80:83], a[72:75], a[0:3], v[80:83]
  s_waitcnt lgkmcnt(4)
  v_mfma_f32_16x16x32_bf16 v[96:99], a[80:83], a[0:3], v[96:99]
  ds_read_b64_tr_b16 a[64:65], v228 offset:0
  v_mfma_f32_16x16x32_bf16 v[96:99], a[84:87], a[16:19], v[96:99]
  v_mfma_f32_16x16x32_bf16 v[100:103], a[84:87], a[20:23], v[100:103]
  ds_read_b64_tr_b16 a[66:67], v228 offset:4096
  v_mfma_f32_16x16x32_bf16 v[100:103], a[80:83], a[4:7], v[100:103]
  v_mfma_f32_16x16x32_bf16 v[104:107], a[80:83], a[8:11], v[104:107]
  ds_read_b64_tr_b16 a[68:69], v228 offset:8192
  buffer_load_dwordx4 a[60:63], v231, s[4:7], s75 offen offset:3072 sc1
  v_mfma_f32_16x16x32_bf16 v[104:107], a[84:87], a[24:27], v[104:107]
  s_add_u32 s75, s75, 4096
  buffer_load_dwordx4 a[96:99], v236, s[24:27], s70 offen
  v_mfma_f32_16x16x32_bf16 v[108:111], a[84:87], a[28:31], v[108:111]
  ds_read_b64_tr_b16 a[70:71], v228 offset:12288
  s_add_u32 s70, s70, 1024
  v_mfma_f32_16x16x32_bf16 v[108:111], a[80:83], a[12:15], v[108:111]
  s_waitcnt lgkmcnt(4)
  v_mfma_f32_16x16x32_bf16 v[124:127], a[88:91], a[12:15], v[124:127]
  ds_read_b64_tr_b16 a[72:73], v228 offset:16384
  v_mfma_f32_16x16x32_bf16 v[124:127], a[92:95], a[28:31], v[124:127]
  v_mfma_f32_16x16x32_bf16 v[120:123], a[92:95], a[24:27], v[120:123]
  ds_read_b64_tr_b16 a[74:75], v228 offset:20480
  s_add_u32 m0, s68, 0
  v_mfma_f32_16x16x32_bf16 v[120:123], a[88:91], a[8:11], v[120:123]
  buffer_load_dwordx4 v232, s[16:19], s67 offen offset:0  lds
  v_mfma_f32_16x16x32_bf16 v[116:119], a[88:91], a[4:7], v[116:119]
  ds_read_b64_tr_b16 a[76:77], v228 offset:24576
  v_mfma_f32_16x16x32_bf16 v[116:119], a[92:95], a[20:23], v[116:119]
  v_mfma_f32_16x16x32_bf16 v[112:115], a[92:95], a[16:19], v[112:115]
  ds_read_b64_tr_b16 a[78:79], v228 offset:28672
  v_mfma_f32_16x16x32_bf16 v[112:115], a[88:91], a[0:3], v[112:115]
  s_waitcnt lgkmcnt(4)
  v_mfma_f32_16x16x32_bf16 v[128:131], a[64:67], a[0:3], v[128:131]
  ds_read_b64_tr_b16 a[80:81], v229 offset:0
  v_mfma_f32_16x16x32_bf16 v[128:131], a[68:71], a[16:19], v[128:131]
  v_mfma_f32_16x16x32_bf16 v[132:135], a[68:71], a[20:23], v[132:135]
  ds_read_b64_tr_b16 a[82:83], v229 offset:4096
  buffer_load_dwordx4 v233, s[16:19], s67 offen offset:1024  lds
  v_mfma_f32_16x16x32_bf16 v[132:135], a[64:67], a[4:7], v[132:135]
  v_mfma_f32_16x16x32_bf16 v[136:139], a[64:67], a[8:11], v[136:139]
  ds_read_b64_tr_b16 a[84:85], v229 offset:8192
  v_mfma_f32_16x16x32_bf16 v[136:139], a[68:71], a[24:27], v[136:139]
  v_mfma_f32_16x16x32_bf16 v[140:143], a[68:71], a[28:31], v[140:143]
  ds_read_b64_tr_b16 a[86:87], v229 offset:12288
  v_mfma_f32_16x16x32_bf16 v[140:143], a[64:67], a[12:15], v[140:143]
  s_waitcnt lgkmcnt(4)
  v_mfma_f32_16x16x32_bf16 v[156:159], a[72:75], a[12:15], v[156:159]
  ds_read_b64_tr_b16 a[88:89], v229 offset:16384
  v_mfma_f32_16x16x32_bf16 v[156:159], a[76:79], a[28:31], v[156:159]
  buffer_load_dwordx4 v234, s[16:19], s67 offen offset:2048  lds
  v_mfma_f32_16x16x32_bf16 v[152:155], a[76:79], a[24:27], v[152:155]
  ds_read_b64_tr_b16 a[90:91], v229 offset:20480
  v_mfma_f32_16x16x32_bf16 v[152:155], a[72:75], a[8:11], v[152:155]
  v_mfma_f32_16x16x32_bf16 v[148:151], a[72:75], a[4:7], v[148:151]
  ds_read_b64_tr_b16 a[92:93], v229 offset:24576
  v_mfma_f32_16x16x32_bf16 v[148:151], a[76:79], a[20:23], v[148:151]
  v_mfma_f32_16x16x32_bf16 v[144:147], a[76:79], a[16:19], v[144:147]
  ds_read_b64_tr_b16 a[94:95], v229 offset:28672
  v_mfma_f32_16x16x32_bf16 v[144:147], a[72:75], a[0:3], v[144:147]
  s_waitcnt lgkmcnt(4)
  v_mfma_f32_16x16x32_bf16 v[160:163], a[80:83], a[0:3], v[160:163]
  ds_read_b64_tr_b16 a[64:65], v230 offset:0
  buffer_load_dwordx4 v235, s[16:19], s67 offen offset:3072  lds
  v_mfma_f32_16x16x32_bf16 v[160:163], a[84:87], a[16:19], v[160:163]
  v_mfma_f32_16x16x32_bf16 v[164:167], a[84:87], a[20:23], v[164:167]
  ds_read_b64_tr_b16 a[66:67], v230 offset:4096
  v_mfma_f32_16x16x32_bf16 v[164:167], a[80:83], a[4:7], v[164:167]
  v_mfma_f32_16x16x32_bf16 v[168:171], a[80:83], a[8:11], v[168:171]
  ds_read_b64_tr_b16 a[68:69], v230 offset:8192
  v_mfma_f32_16x16x32_bf16 v[168:171], a[84:87], a[24:27], v[168:171]
  v_mfma_f32_16x16x32_bf16 v[172:175], a[84:87], a[28:31], v[172:175]
  ds_read_b64_tr_b16 a[70:71], v230 offset:12288
  s_add_u32 m0, s68, 16384
  v_mfma_f32_16x16x32_bf16 v[172:175], a[80:83], a[12:15], v[172:175]
  buffer_load_dwordx4 v232, s[20:23], s67 offen offset:0  lds
  s_waitcnt lgkmcnt(4)
  v_mfma_f32_16x16x32_bf16 v[188:191], a[88:91], a[12:15], v[188:191]
  ds_read_b64_tr_b16 a[72:73], v230 offset:16384
  v_mfma_f32_16x16x32_bf16 v[188:191], a[92:95], a[28:31], v[188:191]
  v_mfma_f32_16x16x32_bf16 v[184:187], a[92:95], a[24:27], v[184:187]
  ds_read_b64_tr_b16 a[74:75], v230 offset:20480
  v_mfma_f32_16x16x32_bf16 v[184:187], a[88:91], a[8:11], v[184:187]
  v_mfma_f32_16x16x32_bf16 v[180:183], a[88:91], a[4:7], v[180:183]
  ds_read_b64_tr_b16 a[76:77], v230 offset:24576
  v_mfma_f32_16x16x32_bf16 v[180:183], a[92:95], a[20:23], v[180:183]
  v_mfma_f32_16x16x32_bf16 v[176:179], a[92:95], a[16:19], v[176:179]
  ds_read_b64_tr_b16 a[78:79], v230 offset:28672
  buffer_load_dwordx4 v233, s[20:23], s67 offen offset:1024  lds
  v_mfma_f32_16x16x32_bf16 v[176:179], a[88:91], a[0:3], v[176:179]
  s_waitcnt lgkmcnt(4)
  v_mfma_f32_16x16x32_bf16 v[192:195], a[64:67], a[0:3], v[192:195]
  s_waitcnt vmcnt(15)
  s_barrier
  ds_read_b64_tr_b16 a[80:81], v224 offset:32768
  v_mfma_f32_16x16x32_bf16 v[192:195], a[68:71], a[16:19], v[192:195]
  v_mfma_f32_16x16x32_bf16 v[196:199], a[68:71], a[20:23], v[196:199]
  ds_read_b64_tr_b16 a[82:83], v224 offset:36864
  v_mfma_f32_16x16x32_bf16 v[196:199], a[64:67], a[4:7], v[196:199]
  v_mfma_f32_16x16x32_bf16 v[200:203], a[64:67], a[8:11], v[200:203]
  ds_read_b64_tr_b16 a[84:85], v224 offset:40960
  v_mfma_f32_16x16x32_bf16 v[200:203], a[68:71], a[24:27], v[200:203]
  buffer_load_dwordx4 v234, s[20:23], s67 offen offset:2048  lds
  v_mfma_f32_16x16x32_bf16 v[204:207], a[68:71], a[28:31], v[204:207]
  ds_read_b64_tr_b16 a[86:87], v224 offset:45056
  v_mfma_f32_16x16x32_bf16 v[204:207], a[64:67], a[12:15], v[204:207]
  s_waitcnt lgkmcnt(4)
  v_mfma_f32_16x16x32_bf16 v[220:223], a[72:75], a[12:15], v[220:223]
  ds_read_b64_tr_b16 a[88:89], v224 offset:49152
  v_mfma_f32_16x16x32_bf16 v[220:223], a[76:79], a[28:31], v[220:223]
  v_mfma_f32_16x16x32_bf16 v[216:219], a[76:79], a[24:27], v[216:219]
  ds_read_b64_tr_b16 a[90:91], v224 offset:53248
  v_mfma_f32_16x16x32_bf16 v[216:219], a[72:75], a[8:11], v[216:219]
  v_mfma_f32_16x16x32_bf16 v[212:215], a[72:75], a[4:7], v[212:215]
  ds_read_b64_tr_b16 a[92:93], v224 offset:57344
  buffer_load_dwordx4 v235, s[20:23], s67 offen offset:3072  lds
  v_mfma_f32_16x16x32_bf16 v[212:215], a[76:79], a[20:23], v[212:215]
  s_add_u32 s67, s67, 458752
  v_mfma_f32_16x16x32_bf16 v[208:211], a[76:79], a[16:19], v[208:211]
  ds_read_b64_tr_b16 a[94:95], v224 offset:61440
  v_xor_b32 v224, 0x10000, v224
  v_mfma_f32_16x16x32_bf16 v[208:211], a[72:75], a[0:3], v[208:211]
  s_waitcnt vmcnt(9) lgkmcnt(4)
  v_mfma_f32_16x16x32_bf16 v[0:3], a[80:83], a[32:35], v[0:3]
  ds_read_b64_tr_b16 a[64:65], v225 offset:32768
  v_mfma_f32_16x16x32_bf16 v[0:3], a[84:87], a[48:51], v[0:3]
  v_mfma_f32_16x16x32_bf16 v[4:7], a[84:87], a[52:55], v[4:7]
  ds_read_b64_tr_b16 a[66:67], v225 offset:36864
  v_mfma_f32_16x16x32_bf16 v[4:7], a[80:83], a[36:39], v[4:7]
  buffer_load_dwordx4 a[0:3], v231, s[4:7], s72 offen offset:0 sc1
  v_mfma_f32_16x16x32_bf16 v[8:11], a[80:83], a[40:43], v[8:11]
  ds_read_b64_tr_b16 a[68:69], v225 offset:40960
  v_mfma_f32_16x16x32_bf16 v[8:11], a[84:87], a[56:59], v[8:11]
  v_mfma_f32_16x16x32_bf16 v[12:15], a[84:87], a[60:63], v[12:15]
  ds_read_b64_tr_b16 a[70:71], v225 offset:45056
  v_mfma_f32_16x16x32_bf16 v[12:15], a[80:83], a[44:47], v[12:15]
  s_waitcnt lgkmcnt(4)
  v_mfma_f32_16x16x32_bf16 v[28:31], a[88:91], a[44:47], v[28:31]
  ds_read_b64_tr_b16 a[72:73], v225 offset:49152
  v_mfma_f32_16x16x32_bf16 v[28:31], a[92:95], a[60:63], v[28:31]
  v_mfma_f32_16x16x32_bf16 v[24:27], a[92:95], a[56:59], v[24:27]
  ds_read_b64_tr_b16 a[74:75], v225 offset:53248
  buffer_load_dwordx4 a[16:19], v231, s[4:7], s72 offen offset:1024 sc1
  v_mfma_f32_16x16x32_bf16 v[24:27], a[88:91], a[40:43], v[24:27]
  v_mfma_f32_16x16x32_bf16 v[20:23], a[88:91], a[36:39], v[20:23]
  ds_read_b64_tr_b16 a[76:77], v225 offset:57344
  v_mfma_f32_16x16x32_bf16 v[20:23], a[92:95], a[52:55], v[20:23]
  v_mfma_f32_16x16x32_bf16 v[16:19], a[92:95], a[48:51], v[16:19]
  ds_read_b64_tr_b16 a[78:79], v225 offset:61440
  v_xor_b32 v225, 0x10000, v225
  v_mfma_f32_16x16x32_bf16 v[16:19], a[88:91], a[32:35], v[16:19]
  s_waitcnt lgkmcnt(4)
  v_mfma_f32_16x16x32_bf16 v[32:35], a[64:67], a[32:35], v[32:35]
  ds_read_b64_tr_b16 a[80:81], v226 offset:32768
  v_mfma_f32_16x16x32_bf16 v[32:35], a[68:71], a[48:51], v[32:35]
  buffer_load_dwordx4 a[4:7], v231, s[4:7], s73 offen offset:0 sc1
  v_mfma_f32_16x16x32_bf16 v[36:39], a[68:71], a[52:55], v[36:39]
  ds_read_b64_tr_b16 a[82:83], v226 offset:36864
  v_mfma_f32_16x16x32_bf16 v[36:39], a[64:67], a[36:39], v[36:39]
  v_mfma_f32_16x16x32_bf16 v[40:43], a[64:67], a[40:43], v[40:43]
  ds_read_b64_tr_b16 a[84:85], v226 offset:40960
  v_mfma_f32_16x16x32_bf16 v[40:43], a[68:71], a[56:59], v[40:43]
  v_mfma_f32_16x16x32_bf16 v[44:47], a[68:71], a[60:63], v[44:47]
  ds_read_b64_tr_b16 a[86:87], v226 offset:45056
  v_mfma_f32_16x16x32_bf16 v[44:47], a[64:67], a[44:47], v[44:47]
  s_waitcnt lgkmcnt(4)
  v_mfma_f32_16x16x32_bf16 v[60:63], a[72:75], a[44:47], v[60:63]
  ds_read_b64_tr_b16 a[88:89], v226 offset:49152
  buffer_load_dwordx4 a[20:23], v231, s[4:7], s73 offen offset:1024 sc1
  v_mfma_f32_16x16x32_bf16 v[60:63], a[76:79], a[60:63], v[60:63]
  v_mfma_f32_16x16x32_bf16 v[56:59], a[76:79], a[56:59], v[56:59]
  ds_read_b64_tr_b16 a[90:91], v226 offset:53248
  v_mfma_f32_16x16x32_bf16 v[56:59], a[72:75], a[40:43], v[56:59]
  v_mfma_f32_16x16x32_bf16 v[52:55], a[72:75], a[36:39], v[52:55]
  ds_read_b64_tr_b16 a[92:93], v226 offset:57344
  v_mfma_f32_16x16x32_bf16 v[52:55], a[76:79], a[52:55], v[52:55]
  v_mfma_f32_16x16x32_bf16 v[48:51], a[76:79], a[48:51], v[48:51]
  ds_read_b64_tr_b16 a[94:95], v226 offset:61440
  v_xor_b32 v226, 0x10000, v226
  v_mfma_f32_16x16x32_bf16 v[48:51], a[72:75], a[32:35], v[48:51]
  buffer_load_dwordx4 a[8:11], v231, s[4:7], s74 offen offset:0 sc1
  s_waitcnt lgkmcnt(4)
  v_mfma_f32_16x16x32_bf16 v[64:67], a[80:83], a[32:35], v[64:67]
  ds_read_b64_tr_b16 a[64:65], v227 offset:32768
  v_mfma_f32_16x16x32_bf16 v[64:67], a[84:87], a[48:51], v[64:67]
  v_mfma_f32_16x16x32_bf16 v[68:71], a[84:87], a[52:55], v[68:71]
  ds_read_b64_tr_b16 a[66:67], v227 offset:36864
  v_mfma_f32_16x16x32_bf16 v[68:71], a[80:83], a[36:39], v[68:71]
  v_mfma_f32_16x16x32_bf16 v[72:75], a[80:83], a[40:43], v[72:75]
  ds_read_b64_tr_b16 a[68:69], v227 offset:40960
  v_mfma_f32_16x16x32_bf16 v[72:75], a[84:87], a[56:59], v[72:75]
  v_mfma_f32_16x16x32_bf16 v[76:79], a[84:87], a[60:63], v[76:79]
  ds_read_b64_tr_b16 a[70:71], v227 offset:45056
  buffer_load_dwordx4 a[24:27], v231, s[4:7], s74 offen offset:1024 sc1
  v_mfma_f32_16x16x32_bf16 v[76:79], a[80:83], a[44:47], v[76:79]
  s_waitcnt lgkmcnt(4)
  v_mfma_f32_16x16x32_bf16 v[92:95], a[88:91], a[44:47], v[92:95]
  ds_read_b64_tr_b16 a[72:73], v227 offset:49152
  v_mfma_f32_16x16x32_bf16 v[92:95], a[92:95], a[60:63], v[92:95]
  v_mfma_f32_16x16x32_bf16 v[88:91], a[92:95], a[56:59], v[88:91]
  ds_read_b64_tr_b16 a[74:75], v227 offset:53248
  v_mfma_f32_16x16x32_bf16 v[88:91], a[88:91], a[40:43], v[88:91]
  v_mfma_f32_16x16x32_bf16 v[84:87], a[88:91], a[36:39], v[84:87]
  ds_read_b64_tr_b16 a[76:77], v227 offset:57344
  v_mfma_f32_16x16x32_bf16 v[84:87], a[92:95], a[52:55], v[84:87]
  buffer_load_dwordx4 a[12:15], v231, s[4:7], s75 offen offset:0 sc1
  v_mfma_f32_16x16x32_bf16 v[80:83], a[92:95], a[48:51], v[80:83]
  ds_read_b64_tr_b16 a[78:79], v227 offset:61440
  v_xor_b32 v227, 0x10000, v227
  v_mfma_f32_16x16x32_bf16 v[80:83], a[88:91], a[32:35], v[80:83]
  s_waitcnt lgkmcnt(4)
  v_mfma_f32_16x16x32_bf16 v[96:99], a[64:67], a[32:35], v[96:99]
  ds_read_b64_tr_b16 a[80:81], v228 offset:32768
  v_mfma_f32_16x16x32_bf16 v[96:99], a[68:71], a[48:51], v[96:99]
  v_mfma_f32_16x16x32_bf16 v[100:103], a[68:71], a[52:55], v[100:103]
  ds_read_b64_tr_b16 a[82:83], v228 offset:36864
  v_mfma_f32_16x16x32_bf16 v[100:103], a[64:67], a[36:39], v[100:103]
  v_mfma_f32_16x16x32_bf16 v[104:107], a[64:67], a[40:43], v[104:107]
  ds_read_b64_tr_b16 a[84:85], v228 offset:40960
  buffer_load_dwordx4 a[28:31], v231, s[4:7], s75 offen offset:1024 sc1
  v_mfma_f32_16x16x32_bf16 v[104:107], a[68:71], a[56:59], v[104:107]
  v_mfma_f32_16x16x32_bf16 v[108:111], a[68:71], a[60:63], v[108:111]
  ds_read_b64_tr_b16 a[86:87], v228 offset:45056
  v_mfma_f32_16x16x32_bf16 v[108:111], a[64:67], a[44:47], v[108:111]
  s_waitcnt lgkmcnt(4)
  v_mfma_f32_16x16x32_bf16 v[124:127], a[72:75], a[44:47], v[124:127]
  ds_read_b64_tr_b16 a[88:89], v228 offset:49152
  v_mfma_f32_16x16x32_bf16 v[124:127], a[76:79], a[60:63], v[124:127]
  v_mfma_f32_16x16x32_bf16 v[120:123], a[76:79], a[56:59], v[120:123]
  ds_read_b64_tr_b16 a[90:91], v228 offset:53248
  s_add_u32 m0, s68, 32768
  v_mfma_f32_16x16x32_bf16 v[120:123], a[72:75], a[40:43], v[120:123]
  buffer_load_dwordx4 v232, s[16:19], s67 offen offset:0  lds
  v_mfma_f32_16x16x32_bf16 v[116:119], a[72:75], a[36:39], v[116:119]
  ds_read_b64_tr_b16 a[92:93], v228 offset:57344
  v_mfma_f32_16x16x32_bf16 v[116:119], a[76:79], a[52:55], v[116:119]
  v_mfma_f32_16x16x32_bf16 v[112:115], a[76:79], a[48:51], v[112:115]
  ds_read_b64_tr_b16 a[94:95], v228 offset:61440
  v_xor_b32 v228, 0x10000, v228
  v_mfma_f32_16x16x32_bf16 v[112:115], a[72:75], a[32:35], v[112:115]
  s_waitcnt lgkmcnt(4)
  v_mfma_f32_16x16x32_bf16 v[128:131], a[80:83], a[32:35], v[128:131]
  ds_read_b64_tr_b16 a[64:65], v229 offset:32768
  v_mfma_f32_16x16x32_bf16 v[128:131], a[84:87], a[48:51], v[128:131]
  v_mfma_f32_16x16x32_bf16 v[132:135], a[84:87], a[52:55], v[132:135]
  ds_read_b64_tr_b16 a[66:67], v229 offset:36864
  buffer_load_dwordx4 v233, s[16:19], s67 offen offset:1024  lds
  v_mfma_f32_16x16x32_bf16 v[132:135], a[80:83], a[36:39], v[132:135]
  v_mfma_f32_16x16x32_bf16 v[136:139], a[80:83], a[40:43], v[136:139]
  ds_read_b64_tr_b16 a[68:69], v229 offset:40960
  v_mfma_f32_16x16x32_bf16 v[136:139], a[84:87], a[56:59], v[136:139]
  v_mfma_f32_16x16x32_bf16 v[140:143], a[84:87], a[60:63], v[140:143]
  ds_read_b64_tr_b16 a[70:71], v229 offset:45056
  v_mfma_f32_16x16x32_bf16 v[140:143], a[80:83], a[44:47], v[140:143]
  s_waitcnt lgkmcnt(4)
  v_mfma_f32_16x16x32_bf16 v[156:159], a[88:91], a[44:47], v[156:159]
  ds_read_b64_tr_b16 a[72:73], v229 offset:49152
  v_mfma_f32_16x16x32_bf16 v[156:159], a[92:95], a[60:63], v[156:159]
  buffer_load_dwordx4 v234, s[16:19], s67 offen offset:2048  lds
  v_mfma_f32_16x16x32_bf16 v[152:155], a[92:95], a[56:59], v[152:155]
  ds_read_b64_tr_b16 a[74:75], v229 offset:53248
  v_mfma_f32_16x16x32_bf16 v[152:155], a[88:91], a[40:43], v[152:155]
  v_mfma_f32_16x16x32_bf16 v[148:151], a[88:91], a[36:39], v[148:151]
  ds_read_b64_tr_b16 a[76:77], v229 offset:57344
  v_mfma_f32_16x16x32_bf16 v[148:151], a[92:95], a[52:55], v[148:151]
  v_mfma_f32_16x16x32_bf16 v[144:147], a[92:95], a[48:51], v[144:147]
  ds_read_b64_tr_b16 a[78:79], v229 offset:61440
  v_xor_b32 v229, 0x10000, v229
  v_mfma_f32_16x16x32_bf16 v[144:147], a[88:91], a[32:35], v[144:147]
  s_waitcnt lgkmcnt(4)
  v_mfma_f32_16x16x32_bf16 v[160:163], a[64:67], a[32:35], v[160:163]
  ds_read_b64_tr_b16 a[80:81], v230 offset:32768
  buffer_load_dwordx4 v235, s[16:19], s67 offen offset:3072  lds
  v_mfma_f32_16x16x32_bf16 v[160:163], a[68:71], a[48:51], v[160:163]
  v_mfma_f32_16x16x32_bf16 v[164:167], a[68:71], a[52:55], v[164:167]
  ds_read_b64_tr_b16 a[82:83], v230 offset:36864
  v_mfma_f32_16x16x32_bf16 v[164:167], a[64:67], a[36:39], v[164:167]
  v_mfma_f32_16x16x32_bf16 v[168:171], a[64:67], a[40:43], v[168:171]
  ds_read_b64_tr_b16 a[84:85], v230 offset:40960
  v_mfma_f32_16x16x32_bf16 v[168:171], a[68:71], a[56:59], v[168:171]
  v_mfma_f32_16x16x32_bf16 v[172:175], a[68:71], a[60:63], v[172:175]
  ds_read_b64_tr_b16 a[86:87], v230 offset:45056
  s_add_u32 m0, s68, 49152
  v_mfma_f32_16x16x32_bf16 v[172:175], a[64:67], a[44:47], v[172:175]
  buffer_load_dwordx4 v232, s[20:23], s67 offen offset:0  lds
  s_waitcnt lgkmcnt(4)
  v_mfma_f32_16x16x32_bf16 v[188:191], a[72:75], a[44:47], v[188:191]
  ds_read_b64_tr_b16 a[88:89], v230 offset:49152
  v_mfma_f32_16x16x32_bf16 v[188:191], a[76:79], a[60:63], v[188:191]
  v_mfma_f32_16x16x32_bf16 v[184:187], a[76:79], a[56:59], v[184:187]
  ds_read_b64_tr_b16 a[90:91], v230 offset:53248
  v_mfma_f32_16x16x32_bf16 v[184:187], a[72:75], a[40:43], v[184:187]
  v_mfma_f32_16x16x32_bf16 v[180:183], a[72:75], a[36:39], v[180:183]
  ds_read_b64_tr_b16 a[92:93], v230 offset:57344
  v_mfma_f32_16x16x32_bf16 v[180:183], a[76:79], a[52:55], v[180:183]
  v_mfma_f32_16x16x32_bf16 v[176:179], a[76:79], a[48:51], v[176:179]
  ds_read_b64_tr_b16 a[94:95], v230 offset:61440
  buffer_load_dwordx4 v233, s[20:23], s67 offen offset:1024  lds
  v_xor_b32 v230, 0x10000, v230
  v_mfma_f32_16x16x32_bf16 v[176:179], a[72:75], a[32:35], v[176:179]
  s_waitcnt lgkmcnt(4)
  v_mfma_f32_16x16x32_bf16 v[192:195], a[80:83], a[32:35], v[192:195]
  s_waitcnt vmcnt(14)
  s_barrier
  ds_read_b64_tr_b16 a[64:65], v224 offset:0
  v_mfma_f32_16x16x32_bf16 v[192:195], a[84:87], a[48:51], v[192:195]
  v_mfma_f32_16x16x32_bf16 v[196:199], a[84:87], a[52:55], v[196:199]
  ds_read_b64_tr_b16 a[66:67], v224 offset:4096
  v_mfma_f32_16x16x32_bf16 v[196:199], a[80:83], a[36:39], v[196:199]
  v_mfma_f32_16x16x32_bf16 v[200:203], a[80:83], a[40:43], v[200:203]
  ds_read_b64_tr_b16 a[68:69], v224 offset:8192
  v_mfma_f32_16x16x32_bf16 v[200:203], a[84:87], a[56:59], v[200:203]
  buffer_load_dwordx4 v234, s[20:23], s67 offen offset:2048  lds
  v_mfma_f32_16x16x32_bf16 v[204:207], a[84:87], a[60:63], v[204:207]
  ds_read_b64_tr_b16 a[70:71], v224 offset:12288
  v_mfma_f32_16x16x32_bf16 v[204:207], a[80:83], a[44:47], v[204:207]
  s_waitcnt lgkmcnt(4)
  v_mfma_f32_16x16x32_bf16 v[220:223], a[88:91], a[44:47], v[220:223]
  ds_read_b64_tr_b16 a[72:73], v224 offset:16384
  v_mfma_f32_16x16x32_bf16 v[220:223], a[92:95], a[60:63], v[220:223]
  v_mfma_f32_16x16x32_bf16 v[216:219], a[92:95], a[56:59], v[216:219]
  ds_read_b64_tr_b16 a[74:75], v224 offset:20480
  v_mfma_f32_16x16x32_bf16 v[216:219], a[88:91], a[40:43], v[216:219]
  v_mfma_f32_16x16x32_bf16 v[212:215], a[88:91], a[36:39], v[212:215]
  ds_read_b64_tr_b16 a[76:77], v224 offset:24576
  buffer_load_dwordx4 v235, s[20:23], s67 offen offset:3072  lds
  v_mfma_f32_16x16x32_bf16 v[212:215], a[92:95], a[52:55], v[212:215]
  s_add_u32 s67, s67, 458752
  s_xor_b32 s68, s68, 0x10000
  v_mfma_f32_16x16x32_bf16 v[208:211], a[92:95], a[48:51], v[208:211]
  ds_read_b64_tr_b16 a[78:79], v224 offset:28672
  v_mfma_f32_16x16x32_bf16 v[208:211], a[88:91], a[32:35], v[208:211]
  s_sub_u32 s56, s56, 1
  s_cmp_lg_u32 s56, 0
  s_cbranch_scc1 Lp3_loop
Lmk_Lp3_loop_tail:
  s_waitcnt vmcnt(8) lgkmcnt(4)
  v_mfma_f32_16x16x32_bf16 v[0:3], a[64:67], a[0:3], v[0:3]
  ds_read_b64_tr_b16 a[80:81], v225 offset:0
  v_add_f32 v242, v242, v246
  v_mfma_f32_16x16x32_bf16 v[0:3], a[68:71], a[16:19], v[0:3]
  v_add_f32 v243, v243, v247
  v_add_f32 v244, v244, v248
  v_mfma_f32_16x16x32_bf16 v[4:7], a[68:71], a[20:23], v[4:7]
  ds_read_b64_tr_b16 a[82:83], v225 offset:4096
  v_add_f32 v245, v245, v249
  v_mfma_f32_16x16x32_bf16 v[4:7], a[64:67], a[4:7], v[4:7]
  buffer_load_dwordx4 a[32:35], v231, s[4:7], s72 offen offset:2048 sc1
  ds_write_b128 v250, v[242:245]
  v_mfma_f32_16x16x32_bf16 v[8:11], a[64:67], a[8:11], v[8:11]
  ds_read_b64_tr_b16 a[84:85], v225 offset:8192
  v_mfma_f32_16x16x32_bf16 v[8:11], a[68:71], a[24:27], v[8:11]
  v_mfma_f32_16x16x32_bf16 v[12:15], a[68:71], a[28:31], v[12:15]
  ds_read_b64_tr_b16 a[86:87], v225 offset:12288
  v_mfma_f32_16x16x32_bf16 v[12:15], a[64:67], a[12:15], v[12:15]
  buffer_load_dwordx4 a[48:51], v231, s[4:7], s72 offen offset:3072 sc1
  s_waitcnt lgkmcnt(5)
  v_mfma_f32_16x16x32_bf16 v[28:31], a[72:75], a[12:15], v[28:31]
  s_add_u32 s72, s72, 4096
  ds_read_b64_tr_b16 a[88:89], v225 offset:16384
  v_mfma_f32_16x16x32_bf16 v[28:31], a[76:79], a[28:31], v[28:31]
  ds_read_b128 v[246:249], v237 offset:384
  v_mfma_f32_16x16x32_bf16 v[24:27], a[76:79], a[24:27], v[24:27]
  ds_read_b64_tr_b16 a[90:91], v225 offset:20480
  v_mfma_f32_16x16x32_bf16 v[24:27], a[72:75], a[8:11], v[24:27]
  v_mfma_f32_16x16x32_bf16 v[20:23], a[72:75], a[4:7], v[20:23]
  ds_read_b64_tr_b16 a[92:93], v225 offset:24576
  v_mfma_f32_16x16x32_bf16 v[20:23], a[76:79], a[20:23], v[20:23]
  buffer_load_dwordx4 a[36:39], v231, s[4:7], s73 offen offset:2048 sc1
  v_mfma_f32_16x16x32_bf16 v[16:19], a[76:79], a[16:19], v[16:19]
  ds_read_b64_tr_b16 a[94:95], v225 offset:28672
  v_mfma_f32_16x16x32_bf16 v[16:19], a[72:75], a[0:3], v[16:19]
  s_waitcnt lgkmcnt(5)
  v_mfma_f32_16x16x32_bf16 v[32:35], a[80:83], a[0:3], v[32:35]
  s_waitcnt lgkmcnt(3)
  ds_read_b64_tr_b16 a[64:65], v226 offset:0
  v_fmac_f32 v96, v246, v238
  v_mfma_f32_16x16x32_bf16 v[32:35], a[84:87], a[16:19], v[32:35]
  buffer_load_dwordx4 a[52:55], v231, s[4:7], s73 offen offset:3072 sc1
  ds_read_b128 v[242:245], v237 offset:0
  v_mfma_f32_16x16x32_bf16 v[36:39], a[84:87], a[20:23], v[36:39]
  s_add_u32 s73, s73, 4096
  ds_read_b64_tr_b16 a[66:67], v226 offset:4096
  v_fmac_f32 v97, v247, v238
  v_mfma_f32_16x16x32_bf16 v[36:39], a[80:83], a[4:7], v[36:39]
  v_fmac_f32 v98, v248, v238
  v_fmac_f32 v99, v249, v238
  v_mfma_f32_16x16x32_bf16 v[40:43], a[80:83], a[8:11], v[40:43]
  s_xor_b32 s93, s53, 1
  ds_read_b64_tr_b16 a[68:69], v226 offset:8192
  v_fmac_f32 v100, v246, v239
  v_mfma_f32_16x16x32_bf16 v[40:43], a[84:87], a[24:27], v[40:43]
  s_lshl_b32 s93, s93, 7
  v_fmac_f32 v101, v247, v239
  v_fmac_f32 v102, v248, v239
  v_mfma_f32_16x16x32_bf16 v[44:47], a[84:87], a[28:31], v[44:47]
  s_add_u32 s80, s24, s93
  s_addc_u32 s81, s25, 0
  ds_read_b64_tr_b16 a[70:71], v226 offset:12288
  v_fmac_f32 v103, v249, v239
  v_mfma_f32_16x16x32_bf16 v[44:47], a[80:83], a[12:15], v[44:47]
  s_sub_u32 s82, 7340032, s93
  buffer_load_dwordx4 a[40:43], v231, s[4:7], s74 offen offset:2048 sc1
  v_fmac_f32 v104, v246, v240
  s_waitcnt lgkmcnt(5)
  v_mfma_f32_16x16x32_bf16 v[60:63], a[88:91], a[12:15], v[60:63]
  s_mov_b32 s83, 0x20000
  ds_read_b64_tr_b16 a[72:73], v226 offset:16384
  v_fmac_f32 v105, v247, v240
  v_mfma_f32_16x16x32_bf16 v[60:63], a[92:95], a[28:31], v[60:63]
  s_lshl_b32 s93, s53, 7
  v_fmac_f32 v106, v248, v240
  v_fmac_f32 v107, v249, v240
  v_mfma_f32_16x16x32_bf16 v[56:59], a[92:95], a[24:27], v[56:59]
  s_add_u32 s84, s24, s93
  s_addc_u32 s85, s25, 0
  ds_read_b64_tr_b16 a[74:75], v226 offset:20480
  v_fmac_f32 v108, v246, v241
  v_mfma_f32_16x16x32_bf16 v[56:59], a[88:91], a[8:11], v[56:59]
  s_sub_u32 s84, s84, 1024
  s_subb_u32 s85, s85, 0
  buffer_load_dwordx4 a[56:59], v231, s[4:7], s74 offen offset:3072 sc1
  v_fmac_f32 v109, v247, v241
  v_mfma_f32_16x16x32_bf16 v[52:55], a[88:91], a[4:7], v[52:55]
  s_add_u32 s74, s74, 4096
  ds_read_b64_tr_b16 a[76:77], v226 offset:24576
  v_fmac_f32 v110, v248, v241
  v_mfma_f32_16x16x32_bf16 v[52:55], a[92:95], a[20:23], v[52:55]
  s_sub_u32 s86, 7341056, s93
  v_fmac_f32 v111, v249, v241
  v_mfma_f32_16x16x32_bf16 v[48:51], a[92:95], a[16:19], v[48:51]
  s_mov_b32 s87, 0x20000
  ds_read_b64_tr_b16 a[78:79], v226 offset:28672
  v_mfma_f32_16x16x32_bf16 v[48:51], a[88:91], a[0:3], v[48:51]
  s_and_b32 s93, s53, 1
  s_waitcnt lgkmcnt(4)
  v_mfma_f32_16x16x32_bf16 v[64:67], a[64:67], a[0:3], v[64:67]
  ds_read_b64_tr_b16 a[80:81], v227 offset:0
  v_fmac_f32 v0, v242, v238
  v_mfma_f32_16x16x32_bf16 v[64:67], a[68:71], a[16:19], v[64:67]
  s_mul_i32 s92, s93, 3670016
  buffer_load_dwordx4 a[44:47], v231, s[4:7], s75 offen offset:2048 sc1
  ds_read_b128 v[246:249], v237 offset:64
  v_mfma_f32_16x16x32_bf16 v[68:71], a[68:71], a[20:23], v[68:71]
  s_lshl_b32 s93, s40, 14
  ds_read_b64_tr_b16 a[82:83], v227 offset:4096
  v_fmac_f32 v1, v243, v238
  v_mfma_f32_16x16x32_bf16 v[68:71], a[64:67], a[4:7], v[68:71]
  s_add_u32 s92, s92, s93
  v_fmac_f32 v2, v244, v238
  v_fmac_f32 v3, v245, v238
  v_mfma_f32_16x16x32_bf16 v[72:75], a[64:67], a[8:11], v[72:75]
  s_lshl_b32 s79, s40, 11
  ds_read_b64_tr_b16 a[84:85], v227 offset:8192
  v_fmac_f32 v4, v242, v239
  v_mfma_f32_16x16x32_bf16 v[72:75], a[68:71], a[24:27], v[72:75]
  s_lshr_b32 s93, s53, 1
  buffer_load_dwordx4 a[60:63], v231, s[4:7], s75 offen offset:3072 sc1
  v_fmac_f32 v5, v243, v239
  v_mfma_f32_16x16x32_bf16 v[76:79], a[68:71], a[28:31], v[76:79]
  s_add_u32 s75, s75, 4096
  ds_read_b64_tr_b16 a[86:87], v227 offset:12288
  v_fmac_f32 v6, v244, v239
  v_mfma_f32_16x16x32_bf16 v[76:79], a[64:67], a[12:15], v[76:79]
  s_add_u32 s93, s93, s52
  v_fmac_f32 v7, v245, v239
  v_fmac_f32 v8, v242, v240
  s_waitcnt lgkmcnt(5)
  v_mfma_f32_16x16x32_bf16 v[92:95], a[72:75], a[12:15], v[92:95]
  s_and_b32 s93, s93, 3
  ds_read_b64_tr_b16 a[88:89], v227 offset:16384
  v_fmac_f32 v9, v243, v240
  v_mfma_f32_16x16x32_bf16 v[92:95], a[76:79], a[28:31], v[92:95]
  s_cmp_eq_u32 s93, 0
  s_cselect_b32 s88, 917504, 0
  v_fmac_f32 v10, v244, v240
  v_fmac_f32 v11, v245, v240
  v_mfma_f32_16x16x32_bf16 v[88:91], a[76:79], a[24:27], v[88:91]
  s_add_u32 m0, s68, 0
  ds_read_b64_tr_b16 a[90:91], v227 offset:20480
  v_fmac_f32 v12, v242, v241
  v_mfma_f32_16x16x32_bf16 v[88:91], a[72:75], a[8:11], v[88:91]
  s_cmp_eq_u32 s93, 1
  s_cselect_b32 s89, 917504, 0
  buffer_load_dwordx4 v232, s[16:19], s67 offen offset:0  lds
  v_fmac_f32 v13, v243, v241
  v_mfma_f32_16x16x32_bf16 v[84:87], a[72:75], a[4:7], v[84:87]
  s_cmp_eq_u32 s93, 2
  s_cselect_b32 s90, 917504, 0
  ds_read_b64_tr_b16 a[92:93], v227 offset:24576
  v_fmac_f32 v14, v244, v241
  v_mfma_f32_16x16x32_bf16 v[84:87], a[76:79], a[20:23], v[84:87]
  s_cmp_eq_u32 s93, 3
  s_cselect_b32 s91, 917504, 0
  v_fmac_f32 v15, v245, v241
  v_mfma_f32_16x16x32_bf16 v[80:83], a[76:79], a[16:19], v[80:83]
  s_cmp_eq_u32 s40, 1
  s_cselect_b32 s78, 16384, 0
  ds_read_b64_tr_b16 a[94:95], v227 offset:28672
  v_mfma_f32_16x16x32_bf16 v[80:83], a[72:75], a[0:3], v[80:83]
  s_cmp_eq_u32 s40, 2
  s_cselect_b32 s78, -16384, s78
  buffer_load_dwordx4 v233, s[16:19], s67 offen offset:1024  lds
  s_waitcnt lgkmcnt(4)
  v_mfma_f32_16x16x32_bf16 v[96:99], a[80:83], a[0:3], v[96:99]
  ds_read_b64_tr_b16 a[64:65], v228 offset:0
  v_fmac_f32 v16, v246, v238
  v_mfma_f32_16x16x32_bf16 v[96:99], a[84:87], a[16:19], v[96:99]
  s_mul_i32 s43, s69, 458752
  ds_read_b128 v[242:245], v237 offset:128
  v_fmac_f32 v17, v247, v238
  v_mfma_f32_16x16x32_bf16 v[100:103], a[84:87], a[20:23], v[100:103]
  s_lshr_b32 s45, s55, 4
  ds_read_b64_tr_b16 a[66:67], v228 offset:4096
  v_fmac_f32 v18, v248, v238
  v_mfma_f32_16x16x32_bf16 v[100:103], a[80:83], a[4:7], v[100:103]
  s_mul_i32 s45, s45, 57344
  v_fmac_f32 v19, v249, v238
  v_fmac_f32 v20, v246, v239
  v_mfma_f32_16x16x32_bf16 v[104:107], a[80:83], a[8:11], v[104:107]
  s_add_u32 s43, s43, s45
  ds_read_b64_tr_b16 a[68:69], v228 offset:8192
  v_fmac_f32 v21, v247, v239
  v_mfma_f32_16x16x32_bf16 v[104:107], a[84:87], a[24:27], v[104:107]
  s_add_u32 s43, s43, s42
  buffer_load_dwordx4 v234, s[16:19], s67 offen offset:2048  lds
  v_fmac_f32 v22, v248, v239
  v_mfma_f32_16x16x32_bf16 v[108:111], a[84:87], a[28:31], v[108:111]
  s_add_u32 s43, s43, 12582912
  ds_read_b64_tr_b16 a[70:71], v228 offset:12288
  v_fmac_f32 v23, v249, v239
  v_mfma_f32_16x16x32_bf16 v[108:111], a[80:83], a[12:15], v[108:111]
  s_and_b32 s44, s55, 15
  v_fmac_f32 v24, v246, v240
  v_fmac_f32 v25, v247, v240
  s_waitcnt lgkmcnt(5)
  v_mfma_f32_16x16x32_bf16 v[124:127], a[88:91], a[12:15], v[124:127]
  s_lshl_b32 s45, s44, 10
  ds_read_b64_tr_b16 a[72:73], v228 offset:16384
  v_fmac_f32 v26, v248, v240
  v_mfma_f32_16x16x32_bf16 v[124:127], a[92:95], a[28:31], v[124:127]
  s_add_u32 s57, s43, s45
  buffer_load_dwordx4 v235, s[16:19], s67 offen offset:3072  lds
  v_fmac_f32 v27, v249, v240
  v_mfma_f32_16x16x32_bf16 v[120:123], a[92:95], a[24:27], v[120:123]
  s_lshl_b32 s45, s44, 9
  ds_read_b64_tr_b16 a[74:75], v228 offset:20480
  v_fmac_f32 v28, v246, v241
  v_mfma_f32_16x16x32_bf16 v[120:123], a[88:91], a[8:11], v[120:123]
  s_add_u32 s61, s43, s45
  v_fmac_f32 v29, v247, v241
  v_fmac_f32 v30, v248, v241
  v_mfma_f32_16x16x32_bf16 v[116:119], a[88:91], a[4:7], v[116:119]
  s_add_u32 s61, s61, 49152
  ds_read_b64_tr_b16 a[76:77], v228 offset:24576
  v_fmac_f32 v31, v249, v241
  v_mfma_f32_16x16x32_bf16 v[116:119], a[92:95], a[20:23], v[116:119]
  s_add_u32 s62, s61, 229376
  v_mfma_f32_16x16x32_bf16 v[112:115], a[92:95], a[16:19], v[112:115]
  s_add_u32 m0, s68, 16384
  ds_read_b64_tr_b16 a[78:79], v228 offset:28672
  v_mfma_f32_16x16x32_bf16 v[112:115], a[88:91], a[0:3], v[112:115]
  s_add_u32 s58, s57, 114688
  buffer_load_dwordx4 v232, s[20:23], s67 offen offset:0  lds
  s_waitcnt lgkmcnt(4)
  v_mfma_f32_16x16x32_bf16 v[128:131], a[64:67], a[0:3], v[128:131]
  ds_read_b64_tr_b16 a[80:81], v229 offset:0
  v_fmac_f32 v32, v242, v238
  v_mfma_f32_16x16x32_bf16 v[128:131], a[68:71], a[16:19], v[128:131]
  s_add_u32 s59, s58, 114688
  ds_read_b128 v[246:249], v237 offset:192
  v_fmac_f32 v33, v243, v238
  v_mfma_f32_16x16x32_bf16 v[132:135], a[68:71], a[20:23], v[132:135]
  s_add_u32 s60, s59, 114688
  ds_read_b64_tr_b16 a[82:83], v229 offset:4096
  v_fmac_f32 v34, v244, v238
  v_mfma_f32_16x16x32_bf16 v[132:135], a[64:67], a[4:7], v[132:135]
  s_lshl_b32 s77, s54, 1
  buffer_load_dwordx4 v233, s[20:23], s67 offen offset:1024  lds
  v_fmac_f32 v35, v245, v238
  v_mfma_f32_16x16x32_bf16 v[136:139], a[64:67], a[8:11], v[136:139]
  s_lshr_b32 s43, s55, 4
  ds_read_b64_tr_b16 a[84:85], v229 offset:8192
  v_fmac_f32 v36, v242, v239
  v_mfma_f32_16x16x32_bf16 v[136:139], a[68:71], a[24:27], v[136:139]
  s_add_u32 s77, s77, s43
  v_fmac_f32 v37, v243, v239
  v_fmac_f32 v38, v244, v239
  v_mfma_f32_16x16x32_bf16 v[140:143], a[68:71], a[28:31], v[140:143]
  s_lshl_b32 s77, s77, 7
  ds_read_b64_tr_b16 a[86:87], v229 offset:12288
  v_fmac_f32 v39, v245, v239
  v_mfma_f32_16x16x32_bf16 v[140:143], a[64:67], a[12:15], v[140:143]
  s_add_u32 s77, s77, s42
  v_fmac_f32 v40, v242, v240
  v_fmac_f32 v41, v243, v240
  s_waitcnt lgkmcnt(5)
  v_mfma_f32_16x16x32_bf16 v[156:159], a[72:75], a[12:15], v[156:159]
  s_add_u32 s77, s77, 27795456
  ds_read_b64_tr_b16 a[88:89], v229 offset:16384
  v_fmac_f32 v42, v244, v240
  v_mfma_f32_16x16x32_bf16 v[156:159], a[76:79], a[28:31], v[156:159]
  s_and_b32 s43, s53, 1
  buffer_load_dwordx4 v234, s[20:23], s67 offen offset:2048  lds
  v_fmac_f32 v43, v245, v240
  v_mfma_f32_16x16x32_bf16 v[152:155], a[76:79], a[24:27], v[152:155]
  s_and_b32 s64, s52, 14
  ds_read_b64_tr_b16 a[90:91], v229 offset:20480
  v_fmac_f32 v44, v242, v241
  v_mfma_f32_16x16x32_bf16 v[152:155], a[72:75], a[8:11], v[152:155]
  s_add_u32 s64, s64, s43
  v_fmac_f32 v45, v243, v241
  v_fmac_f32 v46, v244, v241
  v_mfma_f32_16x16x32_bf16 v[148:151], a[72:75], a[4:7], v[148:151]
  s_lshl_b32 s64, s64, 7
  ds_read_b64_tr_b16 a[92:93], v229 offset:24576
  v_fmac_f32 v47, v245, v241
  v_mfma_f32_16x16x32_bf16 v[148:151], a[76:79], a[20:23], v[148:151]
  s_add_u32 s64, s64, s42
  buffer_load_dwordx4 v235, s[20:23], s67 offen offset:3072  lds
  v_mfma_f32_16x16x32_bf16 v[144:147], a[76:79], a[16:19], v[144:147]
  s_add_u32 s67, s67, 458752
  ds_read_b64_tr_b16 a[94:95], v229 offset:28672
  v_mfma_f32_16x16x32_bf16 v[144:147], a[72:75], a[0:3], v[144:147]
  s_add_u32 s64, s64, 27795456
  s_waitcnt lgkmcnt(4)
  v_mfma_f32_16x16x32_bf16 v[160:163], a[80:83], a[0:3], v[160:163]
  ds_read_b64_tr_b16 a[64:65], v230 offset:0
  v_fmac_f32 v48, v246, v238
  v_mfma_f32_16x16x32_bf16 v[160:163], a[84:87], a[16:19], v[160:163]
  s_lshl_b32 s49, s52, 3
  ds_read_b128 v[242:245], v237 offset:256
  v_fmac_f32 v49, v247, v238
  v_mfma_f32_16x16x32_bf16 v[164:167], a[84:87], a[20:23], v[164:167]
  s_lshl_b32 s43, s40, 1
  ds_read_b64_tr_b16 a[66:67], v230 offset:4096
  v_fmac_f32 v50, v248, v238
  v_mfma_f32_16x16x32_bf16 v[164:167], a[80:83], a[4:7], v[164:167]
  s_add_u32 s49, s49, s43
  buffer_load_dwordx4 a[192:195], v231, s[4:7], s72 offen offset:0 sc1
  v_fmac_f32 v51, v249, v238
  v_mfma_f32_16x16x32_bf16 v[168:171], a[80:83], a[8:11], v[168:171]
  s_lshl_b32 s76, s49, 15
  ds_read_b64_tr_b16 a[68:69], v230 offset:8192
  v_fmac_f32 v52, v246, v239
  v_mfma_f32_16x16x32_bf16 v[168:171], a[84:87], a[24:27], v[168:171]
  s_lshl_b32 s43, s53, 11
  v_fmac_f32 v53, v247, v239
  v_fmac_f32 v54, v248, v239
  v_mfma_f32_16x16x32_bf16 v[172:175], a[84:87], a[28:31], v[172:175]
  s_add_u32 s76, s76, s43
  ds_read_b64_tr_b16 a[70:71], v230 offset:12288
  v_fmac_f32 v55, v249, v239
  v_mfma_f32_16x16x32_bf16 v[172:175], a[80:83], a[12:15], v[172:175]
  s_add_u32 s76, s76, s42
  buffer_load_dwordx4 a[208:211], v231, s[4:7], s72 offen offset:1024 sc1
  v_fmac_f32 v56, v246, v240
  s_waitcnt lgkmcnt(5)
  v_mfma_f32_16x16x32_bf16 v[188:191], a[88:91], a[12:15], v[188:191]
  s_add_u32 s46, s76, 4194304
  ds_read_b64_tr_b16 a[72:73], v230 offset:16384
  v_fmac_f32 v57, v247, v240
  v_mfma_f32_16x16x32_bf16 v[188:191], a[92:95], a[28:31], v[188:191]
  s_add_u32 s47, s46, 32768
  v_fmac_f32 v58, v248, v240
  v_fmac_f32 v59, v249, v240
  v_mfma_f32_16x16x32_bf16 v[184:187], a[92:95], a[24:27], v[184:187]
  s_mul_i32 s48, s49, 114688
  ds_read_b64_tr_b16 a[74:75], v230 offset:20480
  v_fmac_f32 v60, v246, v241
  v_mfma_f32_16x16x32_bf16 v[184:187], a[88:91], a[8:11], v[184:187]
  s_and_b32 s43, s53, 1
  v_fmac_f32 v61, v247, v241
  v_fmac_f32 v62, v248, v241
  v_mfma_f32_16x16x32_bf16 v[180:183], a[88:91], a[4:7], v[180:183]
  s_mul_i32 s44, s43, 57344
  ds_read_b64_tr_b16 a[76:77], v230 offset:24576
  v_fmac_f32 v63, v249, v241
  v_mfma_f32_16x16x32_bf16 v[180:183], a[92:95], a[20:23], v[180:183]
  s_add_u32 s48, s48, s44
  buffer_load_dwordx4 a[196:199], v231, s[4:7], s73 offen offset:0 sc1
  v_mfma_f32_16x16x32_bf16 v[176:179], a[92:95], a[16:19], v[176:179]
  s_add_u32 s48, s48, s42
  ds_read_b64_tr_b16 a[78:79], v230 offset:28672
  v_mfma_f32_16x16x32_bf16 v[176:179], a[88:91], a[0:3], v[176:179]
  s_add_u32 s48, s48, 12582912
  s_waitcnt lgkmcnt(4)
  v_mfma_f32_16x16x32_bf16 v[192:195], a[64:67], a[0:3], v[192:195]
  s_waitcnt vmcnt(19)
  s_barrier
  ds_read_b64_tr_b16 a[80:81], v224 offset:32768
  v_mfma_f32_16x16x32_bf16 v[192:195], a[68:71], a[16:19], v[192:195]
  buffer_load_dwordx4 a[212:215], v231, s[4:7], s73 offen offset:1024 sc1
  ds_read_b128 v[246:249], v237 offset:320
  v_mfma_f32_16x16x32_bf16 v[196:199], a[68:71], a[20:23], v[196:199]
  ds_read_b64_tr_b16 a[82:83], v224 offset:36864
  v_fmac_f32 v64, v242, v238
  v_mfma_f32_16x16x32_bf16 v[196:199], a[64:67], a[4:7], v[196:199]
  v_fmac_f32 v65, v243, v238
  v_fmac_f32 v66, v244, v238
  v_mfma_f32_16x16x32_bf16 v[200:203], a[64:67], a[8:11], v[200:203]
  ds_read_b64_tr_b16 a[84:85], v224 offset:40960
  v_fmac_f32 v67, v245, v238
  v_mfma_f32_16x16x32_bf16 v[200:203], a[68:71], a[24:27], v[200:203]
  v_fmac_f32 v68, v242, v239
  v_fmac_f32 v69, v243, v239
  v_mfma_f32_16x16x32_bf16 v[204:207], a[68:71], a[28:31], v[204:207]
  ds_read_b64_tr_b16 a[86:87], v224 offset:45056
  v_fmac_f32 v70, v244, v239
  v_mfma_f32_16x16x32_bf16 v[204:207], a[64:67], a[12:15], v[204:207]
  s_waitcnt lgkmcnt(5)
  buffer_load_dwordx4 a[200:203], v231, s[4:7], s74 offen offset:0 sc1
  v_fmac_f32 v71, v245, v239
  v_mfma_f32_16x16x32_bf16 v[220:223], a[72:75], a[12:15], v[220:223]
  ds_read_b64_tr_b16 a[88:89], v224 offset:49152
  v_fmac_f32 v72, v242, v240
  v_mfma_f32_16x16x32_bf16 v[220:223], a[76:79], a[28:31], v[220:223]
  v_fmac_f32 v73, v243, v240
  v_fmac_f32 v74, v244, v240
  v_mfma_f32_16x16x32_bf16 v[216:219], a[76:79], a[24:27], v[216:219]
  ds_read_b64_tr_b16 a[90:91], v224 offset:53248
  v_fmac_f32 v75, v245, v240
  v_mfma_f32_16x16x32_bf16 v[216:219], a[72:75], a[8:11], v[216:219]
  buffer_load_dwordx4 a[216:219], v231, s[4:7], s74 offen offset:1024 sc1
  v_fmac_f32 v76, v242, v241
  v_mfma_f32_16x16x32_bf16 v[212:215], a[72:75], a[4:7], v[212:215]
  ds_read_b64_tr_b16 a[92:93], v224 offset:57344
  v_fmac_f32 v77, v243, v241
  v_mfma_f32_16x16x32_bf16 v[212:215], a[76:79], a[20:23], v[212:215]
  v_fmac_f32 v78, v244, v241
  v_fmac_f32 v79, v245, v241
  v_mfma_f32_16x16x32_bf16 v[208:211], a[76:79], a[16:19], v[208:211]
  ds_read_b64_tr_b16 a[94:95], v224 offset:61440
  v_xor_b32 v224, 0x10000, v224
  v_mfma_f32_16x16x32_bf16 v[208:211], a[72:75], a[0:3], v[208:211]
  s_waitcnt vmcnt(20) lgkmcnt(4)
  v_mfma_f32_16x16x32_bf16 v[0:3], a[80:83], a[32:35], v[0:3]
  ds_read_b64_tr_b16 a[64:65], v225 offset:32768
  v_fmac_f32 v80, v246, v238
  v_mfma_f32_16x16x32_bf16 v[0:3], a[84:87], a[48:51], v[0:3]
  s_waitcnt vmcnt(18)
  buffer_load_dwordx4 a[204:207], v231, s[4:7], s75 offen offset:0 sc1
  ds_read_b128 v[242:245], v237 offset:448
  v_mfma_f32_16x16x32_bf16 v[4:7], a[84:87], a[52:55], v[4:7]
  ds_read_b64_tr_b16 a[66:67], v225 offset:36864
  v_fmac_f32 v81, v247, v238
  v_mfma_f32_16x16x32_bf16 v[4:7], a[80:83], a[36:39], v[4:7]
  s_waitcnt vmcnt(17)
  v_fmac_f32 v82, v248, v238
  v_fmac_f32 v83, v249, v238
  v_mfma_f32_16x16x32_bf16 v[8:11], a[80:83], a[40:43], v[8:11]
  ds_read_b64_tr_b16 a[68:69], v225 offset:40960
  v_fmac_f32 v84, v246, v239
  v_mfma_f32_16x16x32_bf16 v[8:11], a[84:87], a[56:59], v[8:11]
  s_waitcnt vmcnt(15)
  buffer_load_dwordx4 a[220:223], v231, s[4:7], s75 offen offset:1024 sc1
  v_fmac_f32 v85, v247, v239
  v_mfma_f32_16x16x32_bf16 v[12:15], a[84:87], a[60:63], v[12:15]
  ds_read_b64_tr_b16 a[70:71], v225 offset:45056
  v_fmac_f32 v86, v248, v239
  v_mfma_f32_16x16x32_bf16 v[12:15], a[80:83], a[44:47], v[12:15]
  s_waitcnt lgkmcnt(5)
  v_fmac_f32 v87, v249, v239
  v_fmac_f32 v88, v246, v240
  v_mfma_f32_16x16x32_bf16 v[28:31], a[88:91], a[44:47], v[28:31]
  ds_read_b64_tr_b16 a[72:73], v225 offset:49152
  v_fmac_f32 v89, v247, v240
  v_mfma_f32_16x16x32_bf16 v[28:31], a[92:95], a[60:63], v[28:31]
  v_fmac_f32 v90, v248, v240
  v_fmac_f32 v91, v249, v240
  v_mfma_f32_16x16x32_bf16 v[24:27], a[92:95], a[56:59], v[24:27]
  s_add_u32 m0, s68, 32768
  ds_read_b64_tr_b16 a[74:75], v225 offset:53248
  v_fmac_f32 v92, v246, v241
  v_mfma_f32_16x16x32_bf16 v[24:27], a[88:91], a[40:43], v[24:27]
  buffer_load_dwordx4 v232, s[16:19], s67 offen offset:0  lds
  v_fmac_f32 v93, v247, v241
  v_mfma_f32_16x16x32_bf16 v[20:23], a[88:91], a[36:39], v[20:23]
  ds_read_b64_tr_b16 a[76:77], v225 offset:57344
  v_fmac_f32 v94, v248, v241
  v_mfma_f32_16x16x32_bf16 v[20:23], a[92:95], a[52:55], v[20:23]
  v_fmac_f32 v95, v249, v241
  v_mfma_f32_16x16x32_bf16 v[16:19], a[92:95], a[48:51], v[16:19]
  ds_read_b64_tr_b16 a[78:79], v225 offset:61440
  v_xor_b32 v225, 0x10000, v225
  v_mfma_f32_16x16x32_bf16 v[16:19], a[88:91], a[32:35], v[16:19]
  buffer_load_dwordx4 v233, s[16:19], s67 offen offset:1024  lds
  s_waitcnt lgkmcnt(4)
  v_mfma_f32_16x16x32_bf16 v[32:35], a[64:67], a[32:35], v[32:35]
  ds_read_b64_tr_b16 a[80:81], v226 offset:32768
  v_fmac_f32 v112, v242, v238
  v_mfma_f32_16x16x32_bf16 v[32:35], a[68:71], a[48:51], v[32:35]
  ds_read_b128 v[246:249], v237 offset:512
  v_fmac_f32 v113, v243, v238
  v_mfma_f32_16x16x32_bf16 v[36:39], a[68:71], a[52:55], v[36:39]
  ds_read_b64_tr_b16 a[82:83], v226 offset:36864
  v_fmac_f32 v114, v244, v238
  v_mfma_f32_16x16x32_bf16 v[36:39], a[64:67], a[36:39], v[36:39]
  v_fmac_f32 v115, v245, v238
  v_fmac_f32 v116, v242, v239
  v_mfma_f32_16x16x32_bf16 v[40:43], a[64:67], a[40:43], v[40:43]
  ds_read_b64_tr_b16 a[84:85], v226 offset:40960
  v_fmac_f32 v117, v243, v239
  v_mfma_f32_16x16x32_bf16 v[40:43], a[68:71], a[56:59], v[40:43]
  buffer_load_dwordx4 v234, s[16:19], s67 offen offset:2048  lds
  v_fmac_f32 v118, v244, v239
  v_mfma_f32_16x16x32_bf16 v[44:47], a[68:71], a[60:63], v[44:47]
  ds_read_b64_tr_b16 a[86:87], v226 offset:45056
  v_fmac_f32 v119, v245, v239
  v_mfma_f32_16x16x32_bf16 v[44:47], a[64:67], a[44:47], v[44:47]
  s_waitcnt lgkmcnt(5)
  v_fmac_f32 v120, v242, v240
  v_fmac_f32 v121, v243, v240
  v_mfma_f32_16x16x32_bf16 v[60:63], a[72:75], a[44:47], v[60:63]
  ds_read_b64_tr_b16 a[88:89], v226 offset:49152
  v_fmac_f32 v122, v244, v240
  v_mfma_f32_16x16x32_bf16 v[60:63], a[76:79], a[60:63], v[60:63]
  buffer_load_dwordx4 v235, s[16:19], s67 offen offset:3072  lds
  v_fmac_f32 v123, v245, v240
  v_mfma_f32_16x16x32_bf16 v[56:59], a[76:79], a[56:59], v[56:59]
  ds_read_b64_tr_b16 a[90:91], v226 offset:53248
  v_fmac_f32 v124, v242, v241
  v_mfma_f32_16x16x32_bf16 v[56:59], a[72:75], a[40:43], v[56:59]
  v_fmac_f32 v125, v243, v241
  v_fmac_f32 v126, v244, v241
  v_mfma_f32_16x16x32_bf16 v[52:55], a[72:75], a[36:39], v[52:55]
  ds_read_b64_tr_b16 a[92:93], v226 offset:57344
  v_fmac_f32 v127, v245, v241
  v_mfma_f32_16x16x32_bf16 v[52:55], a[76:79], a[52:55], v[52:55]
  v_mfma_f32_16x16x32_bf16 v[48:51], a[76:79], a[48:51], v[48:51]
  s_add_u32 m0, s68, 49152
  ds_read_b64_tr_b16 a[94:95], v226 offset:61440
  v_xor_b32 v226, 0x10000, v226
  v_mfma_f32_16x16x32_bf16 v[48:51], a[72:75], a[32:35], v[48:51]
  buffer_load_dwordx4 v232, s[20:23], s67 offen offset:0  lds
  s_waitcnt lgkmcnt(4)
  v_mfma_f32_16x16x32_bf16 v[64:67], a[80:83], a[32:35], v[64:67]
  ds_read_b64_tr_b16 a[64:65], v227 offset:32768
  v_fmac_f32 v128, v246, v238
  v_mfma_f32_16x16x32_bf16 v[64:67], a[84:87], a[48:51], v[64:67]
  ds_read_b128 v[242:245], v237 offset:576
  v_fmac_f32 v129, v247, v238
  v_mfma_f32_16x16x32_bf16 v[68:71], a[84:87], a[52:55], v[68:71]
  ds_read_b64_tr_b16 a[66:67], v227 offset:36864
  v_fmac_f32 v130, v248, v238
  v_mfma_f32_16x16x32_bf16 v[68:71], a[80:83], a[36:39], v[68:71]
  buffer_load_dwordx4 v233, s[20:23], s67 offen offset:1024  lds
  v_fmac_f32 v131, v249, v238
  v_mfma_f32_16x16x32_bf16 v[72:75], a[80:83], a[40:43], v[72:75]
  ds_read_b64_tr_b16 a[68:69], v227 offset:40960
  v_fmac_f32 v132, v246, v239
  v_mfma_f32_16x16x32_bf16 v[72:75], a[84:87], a[56:59], v[72:75]
  v_fmac_f32 v133, v247, v239
  v_fmac_f32 v134, v248, v239
  v_mfma_f32_16x16x32_bf16 v[76:79], a[84:87], a[60:63], v[76:79]
  ds_read_b64_tr_b16 a[70:71], v227 offset:45056
  v_fmac_f32 v135, v249, v239
  v_mfma_f32_16x16x32_bf16 v[76:79], a[80:83], a[44:47], v[76:79]
  s_waitcnt lgkmcnt(5)
  v_fmac_f32 v136, v246, v240
  v_fmac_f32 v137, v247, v240
  v_mfma_f32_16x16x32_bf16 v[92:95], a[88:91], a[44:47], v[92:95]
  ds_read_b64_tr_b16 a[72:73], v227 offset:49152
  v_fmac_f32 v138, v248, v240
  v_mfma_f32_16x16x32_bf16 v[92:95], a[92:95], a[60:63], v[92:95]
  buffer_load_dwordx4 v234, s[20:23], s67 offen offset:2048  lds
  v_fmac_f32 v139, v249, v240
  v_mfma_f32_16x16x32_bf16 v[88:91], a[92:95], a[56:59], v[88:91]
  ds_read_b64_tr_b16 a[74:75], v227 offset:53248
  v_fmac_f32 v140, v246, v241
  v_mfma_f32_16x16x32_bf16 v[88:91], a[88:91], a[40:43], v[88:91]
  v_fmac_f32 v141, v247, v241
  v_fmac_f32 v142, v248, v241
  v_mfma_f32_16x16x32_bf16 v[84:87], a[88:91], a[36:39], v[84:87]
  ds_read_b64_tr_b16 a[76:77], v227 offset:57344
  v_fmac_f32 v143, v249, v241
  v_mfma_f32_16x16x32_bf16 v[84:87], a[92:95], a[52:55], v[84:87]
  buffer_load_dwordx4 v235, s[20:23], s67 offen offset:3072  lds
  v_mfma_f32_16x16x32_bf16 v[80:83], a[92:95], a[48:51], v[80:83]
  s_add_u32 s67, s67, 458752
  s_xor_b32 s68, s68, 0x10000
  ds_read_b64_tr_b16 a[78:79], v227 offset:61440
  v_xor_b32 v227, 0x10000, v227
  v_mfma_f32_16x16x32_bf16 v[80:83], a[88:91], a[32:35], v[80:83]
  s_waitcnt lgkmcnt(4)
  v_mfma_f32_16x16x32_bf16 v[96:99], a[64:67], a[32:35], v[96:99]
  s_waitcnt vmcnt(16)
  s_barrier
  ds_read_b64_tr_b16 a[80:81], v224 offset:0
  v_mfma_f32_16x16x32_bf16 v[96:99], a[68:71], a[48:51], v[96:99]
  ds_read_b128 v[246:249], v237 offset:640
  v_fmac_f32 v144, v242, v238
  v_mfma_f32_16x16x32_bf16 v[100:103], a[68:71], a[52:55], v[100:103]
  ds_read_b64_tr_b16 a[82:83], v224 offset:4096
  v_fmac_f32 v145, v243, v238
  v_mfma_f32_16x16x32_bf16 v[100:103], a[64:67], a[36:39], v[100:103]
  buffer_load_dwordx4 a[224:227], v231, s[4:7], s72 offen offset:2048 sc1
  v_fmac_f32 v146, v244, v238
  v_mfma_f32_16x16x32_bf16 v[104:107], a[64:67], a[40:43], v[104:107]
  ds_read_b64_tr_b16 a[84:85], v224 offset:8192
  v_fmac_f32 v147, v245, v238
  v_mfma_f32_16x16x32_bf16 v[104:107], a[68:71], a[56:59], v[104:107]
  v_fmac_f32 v148, v242, v239
  v_fmac_f32 v149, v243, v239
  v_mfma_f32_16x16x32_bf16 v[108:111], a[68:71], a[60:63], v[108:111]
  ds_read_b64_tr_b16 a[86:87], v224 offset:12288
  v_fmac_f32 v150, v244, v239
  v_mfma_f32_16x16x32_bf16 v[108:111], a[64:67], a[44:47], v[108:111]
  s_waitcnt lgkmcnt(5)
  buffer_load_dwordx4 a[240:243], v231, s[4:7], s72 offen offset:3072 sc1
  v_fmac_f32 v151, v245, v239
  v_mfma_f32_16x16x32_bf16 v[124:127], a[72:75], a[44:47], v[124:127]
  s_add_u32 s72, s72, 4096
  ds_read_b64_tr_b16 a[88:89], v224 offset:16384
  v_fmac_f32 v152, v242, v240
  v_mfma_f32_16x16x32_bf16 v[124:127], a[76:79], a[60:63], v[124:127]
  v_fmac_f32 v153, v243, v240
  v_fmac_f32 v154, v244, v240
  v_mfma_f32_16x16x32_bf16 v[120:123], a[76:79], a[56:59], v[120:123]
  ds_read_b64_tr_b16 a[90:91], v224 offset:20480
  v_fmac_f32 v155, v245, v240
  v_mfma_f32_16x16x32_bf16 v[120:123], a[72:75], a[40:43], v[120:123]
  v_fmac_f32 v156, v242, v241
  v_fmac_f32 v157, v243, v241
  v_mfma_f32_16x16x32_bf16 v[116:119], a[72:75], a[36:39], v[116:119]
  ds_read_b64_tr_b16 a[92:93], v224 offset:24576
  v_fmac_f32 v158, v244, v241
  v_mfma_f32_16x16x32_bf16 v[116:119], a[76:79], a[52:55], v[116:119]
  buffer_load_dwordx4 a[228:231], v231, s[4:7], s73 offen offset:2048 sc1
  v_fmac_f32 v159, v245, v241
  v_mfma_f32_16x16x32_bf16 v[112:115], a[76:79], a[48:51], v[112:115]
  ds_read_b64_tr_b16 a[94:95], v224 offset:28672
  v_mfma_f32_16x16x32_bf16 v[112:115], a[72:75], a[32:35], v[112:115]
  s_waitcnt vmcnt(17) lgkmcnt(4)
  v_mfma_f32_16x16x32_bf16 v[0:3], a[80:83], a[192:195], v[0:3]
  ds_read_b64_tr_b16 a[64:65], v225 offset:0
  v_fmac_f32 v160, v246, v238
  v_mfma_f32_16x16x32_bf16 v[0:3], a[84:87], a[208:211], v[0:3]
  s_waitcnt vmcnt(15)
  buffer_load_dwordx4 a[244:247], v231, s[4:7], s73 offen offset:3072 sc1
  ds_read_b128 v[242:245], v237 offset:704
  v_mfma_f32_16x16x32_bf16 v[4:7], a[84:87], a[212:215], v[4:7]
  s_add_u32 s73, s73, 4096
  ds_read_b64_tr_b16 a[66:67], v225 offset:4096
  v_fmac_f32 v161, v247, v238
  v_mfma_f32_16x16x32_bf16 v[4:7], a[80:83], a[196:199], v[4:7]
  s_waitcnt vmcnt(14)
  v_fmac_f32 v162, v248, v238
  v_fmac_f32 v163, v249, v238
  v_mfma_f32_16x16x32_bf16 v[8:11], a[80:83], a[200:203], v[8:11]
  ds_read_b64_tr_b16 a[68:69], v225 offset:8192
  v_fmac_f32 v164, v246, v239
  v_mfma_f32_16x16x32_bf16 v[8:11], a[84:87], a[216:219], v[8:11]
  s_waitcnt vmcnt(12)
  v_fmac_f32 v165, v247, v239
  v_fmac_f32 v166, v248, v239
  v_mfma_f32_16x16x32_bf16 v[12:15], a[84:87], a[220:223], v[12:15]
  ds_read_b64_tr_b16 a[70:71], v225 offset:12288
  v_fmac_f32 v167, v249, v239
  v_mfma_f32_16x16x32_bf16 v[12:15], a[80:83], a[204:207], v[12:15]
  s_waitcnt lgkmcnt(5)
  buffer_load_dwordx4 a[232:235], v231, s[4:7], s74 offen offset:2048 sc1
  v_fmac_f32 v168, v246, v240
  v_mfma_f32_16x16x32_bf16 v[28:31], a[88:91], a[204:207], v[28:31]
  ds_read_b64_tr_b16 a[72:73], v225 offset:16384
  v_fmac_f32 v169, v247, v240
  v_mfma_f32_16x16x32_bf16 v[28:31], a[92:95], a[220:223], v[28:31]
  v_fmac_f32 v170, v248, v240
  v_fmac_f32 v171, v249, v240
  v_mfma_f32_16x16x32_bf16 v[24:27], a[92:95], a[216:219], v[24:27]
  ds_read_b64_tr_b16 a[74:75], v225 offset:20480
  v_fmac_f32 v172, v246, v241
  v_mfma_f32_16x16x32_bf16 v[24:27], a[88:91], a[200:203], v[24:27]
  buffer_load_dwordx4 a[248:251], v231, s[4:7], s74 offen offset:3072 sc1
  v_fmac_f32 v173, v247, v241
  v_mfma_f32_16x16x32_bf16 v[20:23], a[88:91], a[196:199], v[20:23]
  s_add_u32 s74, s74, 4096
  ds_read_b64_tr_b16 a[76:77], v225 offset:24576
  v_fmac_f32 v174, v248, v241
  v_mfma_f32_16x16x32_bf16 v[20:23], a[92:95], a[212:215], v[20:23]
  v_fmac_f32 v175, v249, v241
  v_mfma_f32_16x16x32_bf16 v[16:19], a[92:95], a[208:211], v[16:19]
  ds_read_b64_tr_b16 a[78:79], v225 offset:28672
  v_mfma_f32_16x16x32_bf16 v[16:19], a[88:91], a[192:195], v[16:19]
  s_waitcnt lgkmcnt(4)
  v_mfma_f32_16x16x32_bf16 v[32:35], a[64:67], a[192:195], v[32:35]
  ds_read_b64_tr_b16 a[80:81], v226 offset:0
  v_fmac_f32 v176, v242, v238
  v_mfma_f32_16x16x32_bf16 v[32:35], a[68:71], a[208:211], v[32:35]
  buffer_load_dwordx4 a[236:239], v231, s[4:7], s75 offen offset:2048 sc1
  ds_read_b128 v[246:249], v237 offset:768
  v_mfma_f32_16x16x32_bf16 v[36:39], a[68:71], a[212:215], v[36:39]
  ds_read_b64_tr_b16 a[82:83], v226 offset:4096
  v_fmac_f32 v177, v243, v238
  v_mfma_f32_16x16x32_bf16 v[36:39], a[64:67], a[196:199], v[36:39]
  v_fmac_f32 v178, v244, v238
  v_fmac_f32 v179, v245, v238
  v_mfma_f32_16x16x32_bf16 v[40:43], a[64:67], a[200:203], v[40:43]
  ds_read_b64_tr_b16 a[84:85], v226 offset:8192
  v_fmac_f32 v180, v242, v239
  v_mfma_f32_16x16x32_bf16 v[40:43], a[68:71], a[216:219], v[40:43]
  buffer_load_dwordx4 a[252:255], v231, s[4:7], s75 offen offset:3072 sc1
  v_fmac_f32 v181, v243, v239
  v_mfma_f32_16x16x32_bf16 v[44:47], a[68:71], a[220:223], v[44:47]
  s_add_u32 s75, s75, 4096
  ds_read_b64_tr_b16 a[86:87], v226 offset:12288
  v_fmac_f32 v182, v244, v239
  v_mfma_f32_16x16x32_bf16 v[44:47], a[64:67], a[204:207], v[44:47]
  s_waitcnt lgkmcnt(5)
  v_fmac_f32 v183, v245, v239
  v_fmac_f32 v184, v242, v240
  v_mfma_f32_16x16x32_bf16 v[60:63], a[72:75], a[204:207], v[60:63]
  ds_read_b64_tr_b16 a[88:89], v226 offset:16384
  v_fmac_f32 v185, v243, v240
  v_mfma_f32_16x16x32_bf16 v[60:63], a[76:79], a[220:223], v[60:63]
  v_fmac_f32 v186, v244, v240
  v_fmac_f32 v187, v245, v240
  v_mfma_f32_16x16x32_bf16 v[56:59], a[76:79], a[216:219], v[56:59]
  ds_read_b64_tr_b16 a[90:91], v226 offset:20480
  v_fmac_f32 v188, v242, v241
  v_mfma_f32_16x16x32_bf16 v[56:59], a[72:75], a[200:203], v[56:59]
  s_add_u32 m0, s79, 0
  v_fmac_f32 v189, v243, v241
  v_fmac_f32 v190, v244, v241
  v_mfma_f32_16x16x32_bf16 v[52:55], a[72:75], a[196:199], v[52:55]
  s_add_u32 s92, s92, 0
  s_add_u32 s93, s92, s88
  ds_read_b64_tr_b16 a[92:93], v226 offset:24576
  v_fmac_f32 v191, v245, v241
  v_mfma_f32_16x16x32_bf16 v[52:55], a[76:79], a[212:215], v[52:55]
  buffer_load_dwordx4 v252, s[80:83], s93 offen lds
  v_mfma_f32_16x16x32_bf16 v[48:51], a[76:79], a[208:211], v[48:51]
  ds_read_b64_tr_b16 a[94:95], v226 offset:28672
  v_mfma_f32_16x16x32_bf16 v[48:51], a[72:75], a[192:195], v[48:51]
  s_waitcnt lgkmcnt(4)
  v_mfma_f32_16x16x32_bf16 v[64:67], a[80:83], a[192:195], v[64:67]
  ds_read_b64_tr_b16 a[64:65], v228 offset:32768
  v_fmac_f32 v192, v246, v238
  v_mfma_f32_16x16x32_bf16 v[64:67], a[84:87], a[208:211], v[64:67]
  ds_read_b128 v[242:245], v237 offset:832
  v_fmac_f32 v193, v247, v238
  v_mfma_f32_16x16x32_bf16 v[68:71], a[84:87], a[212:215], v[68:71]
  ds_read_b64_tr_b16 a[66:67], v228 offset:36864
  v_fmac_f32 v194, v248, v238
  v_mfma_f32_16x16x32_bf16 v[68:71], a[80:83], a[196:199], v[68:71]
  buffer_load_dwordx4 v252, s[84:87], s93 offen offset:1024 lds
  v_fmac_f32 v195, v249, v238
  v_fmac_f32 v196, v246, v239
  v_mfma_f32_16x16x32_bf16 v[72:75], a[80:83], a[200:203], v[72:75]
  ds_read_b64_tr_b16 a[68:69], v228 offset:40960
  v_fmac_f32 v197, v247, v239
  v_mfma_f32_16x16x32_bf16 v[72:75], a[84:87], a[216:219], v[72:75]
  v_fmac_f32 v198, v248, v239
  v_fmac_f32 v199, v249, v239
  v_mfma_f32_16x16x32_bf16 v[76:79], a[84:87], a[220:223], v[76:79]
  ds_read_b64_tr_b16 a[70:71], v228 offset:45056
  v_fmac_f32 v200, v246, v240
  v_mfma_f32_16x16x32_bf16 v[76:79], a[80:83], a[204:207], v[76:79]
  s_add_u32 m0, s79, 8192
  v_fmac_f32 v201, v247, v240
  v_fmac_f32 v202, v248, v240
  s_waitcnt lgkmcnt(5)
  v_mfma_f32_16x16x32_bf16 v[92:95], a[88:91], a[204:207], v[92:95]
  s_add_u32 s92, s92, 262144
  s_add_u32 s93, s92, s89
  ds_read_b64_tr_b16 a[72:73], v228 offset:49152
  v_fmac_f32 v203, v249, v240
  v_mfma_f32_16x16x32_bf16 v[92:95], a[92:95], a[220:223], v[92:95]
  buffer_load_dwordx4 v252, s[80:83], s93 offen lds
  v_fmac_f32 v204, v246, v241
  v_fmac_f32 v205, v247, v241
  v_mfma_f32_16x16x32_bf16 v[88:91], a[92:95], a[216:219], v[88:91]
  ds_read_b64_tr_b16 a[74:75], v228 offset:53248
  v_fmac_f32 v206, v248, v241
  v_mfma_f32_16x16x32_bf16 v[88:91], a[88:91], a[200:203], v[88:91]
  v_fmac_f32 v207, v249, v241
  v_mfma_f32_16x16x32_bf16 v[84:87], a[88:91], a[196:199], v[84:87]
  ds_read_b64_tr_b16 a[76:77], v228 offset:57344
  v_mfma_f32_16x16x32_bf16 v[84:87], a[92:95], a[212:215], v[84:87]
  v_mfma_f32_16x16x32_bf16 v[80:83], a[92:95], a[208:211], v[80:83]
  ds_read_b64_tr_b16 a[78:79], v228 offset:61440
  v_xor_b32 v228, 0x10000, v228
  v_mfma_f32_16x16x32_bf16 v[80:83], a[88:91], a[192:195], v[80:83]
  buffer_load_dwordx4 v252, s[84:87], s93 offen offset:1024 lds
  s_waitcnt lgkmcnt(4)
  v_mfma_f32_16x16x32_bf16 v[128:131], a[64:67], a[32:35], v[128:131]
  s_waitcnt vmcnt(12)
  s_barrier
  ds_read_b64_tr_b16 a[80:81], v224 offset:32768
  v_mfma_f32_16x16x32_bf16 v[128:131], a[68:71], a[48:51], v[128:131]
  v_fmac_f32 v208, v242, v238
  v_fmac_f32 v209, v243, v238
  v_mfma_f32_16x16x32_bf16 v[132:135], a[68:71], a[52:55], v[132:135]
  ds_read_b64_tr_b16 a[82:83], v224 offset:36864
  v_fmac_f32 v210, v244, v238
  v_mfma_f32_16x16x32_bf16 v[132:135], a[64:67], a[36:39], v[132:135]
  s_add_u32 m0, s79, 16384
  v_fmac_f32 v211, v245, v238
  v_fmac_f32 v212, v242, v239
  v_mfma_f32_16x16x32_bf16 v[136:139], a[64:67], a[40:43], v[136:139]
  s_add_u32 s92, s92, 196608
  s_add_u32 s93, s92, s90
  ds_read_b64_tr_b16 a[84:85], v224 offset:40960
  v_fmac_f32 v213, v243, v239
  v_mfma_f32_16x16x32_bf16 v[136:139], a[68:71], a[56:59], v[136:139]
  buffer_load_dwordx4 v252, s[80:83], s93 offen lds
  v_fmac_f32 v214, v244, v239
  v_fmac_f32 v215, v245, v239
  v_mfma_f32_16x16x32_bf16 v[140:143], a[68:71], a[60:63], v[140:143]
  ds_read_b64_tr_b16 a[86:87], v224 offset:45056
  v_fmac_f32 v216, v242, v240
  v_mfma_f32_16x16x32_bf16 v[140:143], a[64:67], a[44:47], v[140:143]
  s_waitcnt lgkmcnt(4)
  v_fmac_f32 v217, v243, v240
  v_fmac_f32 v218, v244, v240
  v_mfma_f32_16x16x32_bf16 v[156:159], a[72:75], a[44:47], v[156:159]
  ds_read_b64_tr_b16 a[88:89], v224 offset:49152
  v_fmac_f32 v219, v245, v240
  v_mfma_f32_16x16x32_bf16 v[156:159], a[76:79], a[60:63], v[156:159]
  v_fmac_f32 v220, v242, v241
  v_fmac_f32 v221, v243, v241
  v_mfma_f32_16x16x32_bf16 v[152:155], a[76:79], a[56:59], v[152:155]
  ds_read_b64_tr_b16 a[90:91], v224 offset:53248
  v_fmac_f32 v222, v244, v241
  v_mfma_f32_16x16x32_bf16 v[152:155], a[72:75], a[40:43], v[152:155]
  buffer_load_dwordx4 v252, s[84:87], s93 offen offset:1024 lds
  v_fmac_f32 v223, v245, v241
  v_mfma_f32_16x16x32_bf16 v[148:151], a[72:75], a[36:39], v[148:151]
  ds_read_b64_tr_b16 a[92:93], v224 offset:57344
  v_mfma_f32_16x16x32_bf16 v[148:151], a[76:79], a[52:55], v[148:151]
  v_mfma_f32_16x16x32_bf16 v[144:147], a[76:79], a[48:51], v[144:147]
  ds_read_b64_tr_b16 a[94:95], v224 offset:61440
  v_mfma_f32_16x16x32_bf16 v[144:147], a[72:75], a[32:35], v[144:147]
  s_add_u32 m0, s79, 24576
  s_waitcnt vmcnt(12) lgkmcnt(4)
  v_mfma_f32_16x16x32_bf16 v[0:3], a[80:83], a[224:227], v[0:3]
  s_add_u32 s92, s92, 262144
  s_add_u32 s93, s92, s91
  ds_read_b64_tr_b16 a[64:65], v229 offset:32768
  v_and_b32 v236, 31, v253
  v_mfma_f32_16x16x32_bf16 v[0:3], a[84:87], a[240:243], v[0:3]
  s_waitcnt vmcnt(10)
  buffer_load_dwordx4 v252, s[80:83], s93 offen lds
  v_lshlrev_b32 v236, 4, v236
  v_mfma_f32_16x16x32_bf16 v[4:7], a[84:87], a[244:247], v[4:7]
  ds_read_b64_tr_b16 a[66:67], v229 offset:36864
  v_lshrrev_b32 v250, 5, v253
  v_mfma_f32_16x16x32_bf16 v[4:7], a[80:83], a[228:231], v[4:7]
  s_mov_b32 s43, 114688
  v_mad_u32_u24 v236, v250, s43, v236
  v_and_b32 v250, 15, v253
  s_waitcnt vmcnt(9)
  v_mfma_f32_16x16x32_bf16 v[8:11], a[80:83], a[232:235], v[8:11]
  s_add_u32 s43, s71, 1024
  ds_read_b64_tr_b16 a[68:69], v229 offset:40960
  v_lshl_add_u32 v250, v250, 2, s43
  v_mfma_f32_16x16x32_bf16 v[8:11], a[84:87], a[248:251], v[8:11]
  s_waitcnt vmcnt(7)
  ds_read2_b32 v[238:239], v250 offset0:64 offset1:80
  ds_read2_b32 v[240:241], v250 offset0:96 offset1:112
  v_mfma_f32_16x16x32_bf16 v[12:15], a[84:87], a[252:255], v[12:15]
  ds_read_b64_tr_b16 a[70:71], v229 offset:45056
  ds_read2_b32 v[232:233], v250 offset0:128 offset1:144
  v_mfma_f32_16x16x32_bf16 v[12:15], a[80:83], a[236:239], v[12:15]
  s_waitcnt lgkmcnt(7)
  buffer_load_dwordx4 v252, s[84:87], s93 offen offset:1024 lds
  ds_read2_b32 v[234:235], v250 offset0:160 offset1:176
  v_mfma_f32_16x16x32_bf16 v[28:31], a[88:91], a[236:239], v[28:31]
  ds_read_b64_tr_b16 a[72:73], v229 offset:49152
  v_mfma_f32_16x16x32_bf16 v[28:31], a[92:95], a[252:255], v[28:31]
  v_mfma_f32_16x16x32_bf16 v[24:27], a[92:95], a[248:251], v[24:27]
  ds_read_b64_tr_b16 a[74:75], v229 offset:53248
  v_mfma_f32_16x16x32_bf16 v[24:27], a[88:91], a[232:235], v[24:27]
  v_mfma_f32_16x16x32_bf16 v[20:23], a[88:91], a[228:231], v[20:23]
  ds_read_b64_tr_b16 a[76:77], v229 offset:57344
  v_mfma_f32_16x16x32_bf16 v[20:23], a[92:95], a[244:247], v[20:23]
  v_mfma_f32_16x16x32_bf16 v[16:19], a[92:95], a[240:243], v[16:19]
  ds_read_b64_tr_b16 a[78:79], v229 offset:61440
  v_xor_b32 v229, 0x10000, v229
  v_mfma_f32_16x16x32_bf16 v[16:19], a[88:91], a[224:227], v[16:19]
  s_waitcnt lgkmcnt(6)
  v_mfma_f32_16x16x32_bf16 v[160:163], a[64:67], a[32:35], v[160:163]
  ds_read_b64_tr_b16 a[80:81], v225 offset:32768
  v_mfma_f32_16x16x32_bf16 v[160:163], a[68:71], a[48:51], v[160:163]
  v_mfma_f32_16x16x32_bf16 v[164:167], a[68:71], a[52:55], v[164:167]
  s_waitcnt lgkmcnt(5)
  ds_read_b64_tr_b16 a[82:83], v225 offset:36864
  v_mfma_f32_16x16x32_bf16 v[164:167], a[64:67], a[36:39], v[164:167]
  v_pk_mul_f32 v[242:243], v[0:1], v[238:239] op_sel:[0,0] op_sel_hi:[1,0]
  v_pk_mul_f32 v[244:245], v[2:3], v[238:239] op_sel:[0,0] op_sel_hi:[1,0]
  v_pk_mul_f32 v[0:1], v[0:1], v[16:17]
  v_pk_mul_f32 v[2:3], v[2:3], v[18:19]
  v_mfma_f32_16x16x32_bf16 v[168:171], a[64:67], a[40:43], v[168:171]
  ds_read_b64_tr_b16 a[84:85], v225 offset:40960
  v_mfma_f32_16x16x32_bf16 v[168:171], a[68:71], a[56:59], v[168:171]
  v_mfma_f32_16x16x32_bf16 v[172:175], a[68:71], a[60:63], v[172:175]
  ds_read_b64_tr_b16 a[86:87], v225 offset:45056
  v_mfma_f32_16x16x32_bf16 v[172:175], a[64:67], a[44:47], v[172:175]
  s_waitcnt lgkmcnt(4)
  v_mfma_f32_16x16x32_bf16 v[188:191], a[72:75], a[44:47], v[188:191]
  v_exp_f32 v242, v242
  v_mfma_f32_16x16x32_bf16 v[188:191], a[76:79], a[60:63], v[188:191]
  v_exp_f32 v243, v243
  v_mfma_f32_16x16x32_bf16 v[184:187], a[76:79], a[56:59], v[184:187]
  ds_read_b64_tr_b16 a[88:89], v225 offset:49152
  ds_read_b64_tr_b16 a[90:91], v225 offset:53248
  v_mfma_f32_16x16x32_bf16 v[184:187], a[72:75], a[40:43], v[184:187]
  v_exp_f32 v244, v244
  v_exp_f32 v245, v245
  s_nop 0
  v_pk_fma_f32 v[242:243], v[242:243], v[232:233], v[232:233] op_sel:[0,0,0] op_sel_hi:[1,0,0]
  v_pk_fma_f32 v[244:245], v[244:245], v[232:233], v[232:233] op_sel:[0,0,0] op_sel_hi:[1,0,0]
  v_pk_mul_f32 v[246:247], v[4:5], v[238:239] op_sel:[0,1] op_sel_hi:[1,1]
  v_pk_mul_f32 v[248:249], v[6:7], v[238:239] op_sel:[0,1] op_sel_hi:[1,1]
  v_pk_mul_f32 v[4:5], v[4:5], v[20:21]
  v_pk_mul_f32 v[6:7], v[6:7], v[22:23]
  v_rcp_f32 v242, v242
  v_mfma_f32_16x16x32_bf16 v[180:183], a[72:75], a[36:39], v[180:183]
  v_rcp_f32 v243, v243
  v_mfma_f32_16x16x32_bf16 v[180:183], a[76:79], a[52:55], v[180:183]
  v_rcp_f32 v244, v244
  v_mfma_f32_16x16x32_bf16 v[176:179], a[76:79], a[48:51], v[176:179]
  ds_read_b64_tr_b16 a[92:93], v225 offset:57344
  v_mfma_f32_16x16x32_bf16 v[176:179], a[72:75], a[32:35], v[176:179]
  ds_read_b64_tr_b16 a[94:95], v225 offset:61440
  s_waitcnt lgkmcnt(4)
  v_mfma_f32_16x16x32_bf16 v[32:35], a[80:83], a[224:227], v[32:35]
  v_exp_f32 v246, v246
  v_mfma_f32_16x16x32_bf16 v[32:35], a[84:87], a[240:243], v[32:35]
  v_exp_f32 v247, v247
  v_mfma_f32_16x16x32_bf16 v[36:39], a[84:87], a[244:247], v[36:39]
  ds_read_b64_tr_b16 a[64:65], v230 offset:32768
  ds_read_b64_tr_b16 a[66:67], v230 offset:36864
  v_mfma_f32_16x16x32_bf16 v[36:39], a[80:83], a[228:231], v[36:39]
  v_exp_f32 v248, v248
  v_exp_f32 v249, v249
  v_rcp_f32 v245, v245
  v_pk_fma_f32 v[246:247], v[246:247], v[232:233], v[232:233] op_sel:[0,1,1] op_sel_hi:[1,1,1]
  v_pk_fma_f32 v[248:249], v[248:249], v[232:233], v[232:233] op_sel:[0,1,1] op_sel_hi:[1,1,1]
  v_pk_mul_f32 v[0:1], v[0:1], v[242:243]
  v_pk_mul_f32 v[2:3], v[2:3], v[244:245]
  v_pk_mul_f32 v[242:243], v[8:9], v[240:241] op_sel:[0,0] op_sel_hi:[1,0]
  v_pk_mul_f32 v[244:245], v[10:11], v[240:241] op_sel:[0,0] op_sel_hi:[1,0]
  v_pk_mul_f32 v[8:9], v[8:9], v[24:25]
  v_pk_mul_f32 v[10:11], v[10:11], v[26:27]
  v_rcp_f32 v246, v246
  v_mfma_f32_16x16x32_bf16 v[40:43], a[80:83], a[232:235], v[40:43]
  v_rcp_f32 v247, v247
  v_mfma_f32_16x16x32_bf16 v[40:43], a[84:87], a[248:251], v[40:43]
  v_rcp_f32 v248, v248
  v_mfma_f32_16x16x32_bf16 v[44:47], a[84:87], a[252:255], v[44:47]
  ds_read_b64_tr_b16 a[68:69], v230 offset:40960
  v_cvt_pk_bf16_f32 v16, v0, v1
  v_mfma_f32_16x16x32_bf16 v[44:47], a[80:83], a[236:239], v[44:47]
  s_waitcnt lgkmcnt(3)
  ds_read_b64_tr_b16 a[70:71], v230 offset:45056
  v_cvt_pk_bf16_f32 v17, v2, v3
  v_mfma_f32_16x16x32_bf16 v[60:63], a[88:91], a[236:239], v[60:63]
  v_exp_f32 v242, v242
  v_mfma_f32_16x16x32_bf16 v[60:63], a[92:95], a[252:255], v[60:63]
  v_exp_f32 v243, v243
  v_mfma_f32_16x16x32_bf16 v[56:59], a[92:95], a[248:251], v[56:59]
  ds_read_b64_tr_b16 a[72:73], v230 offset:49152
  ds_read_b64_tr_b16 a[74:75], v230 offset:53248
  v_mfma_f32_16x16x32_bf16 v[56:59], a[88:91], a[232:235], v[56:59]
  v_exp_f32 v244, v244
  v_exp_f32 v245, v245
  v_rcp_f32 v249, v249
  v_pk_fma_f32 v[242:243], v[242:243], v[234:235], v[234:235] op_sel:[0,0,0] op_sel_hi:[1,0,0]
  v_pk_fma_f32 v[244:245], v[244:245], v[234:235], v[234:235] op_sel:[0,0,0] op_sel_hi:[1,0,0]
  v_pk_mul_f32 v[4:5], v[4:5], v[246:247]
  v_pk_mul_f32 v[6:7], v[6:7], v[248:249]
  v_pk_mul_f32 v[246:247], v[12:13], v[240:241] op_sel:[0,1] op_sel_hi:[1,1]
  v_pk_mul_f32 v[248:249], v[14:15], v[240:241] op_sel:[0,1] op_sel_hi:[1,1]
  v_pk_mul_f32 v[12:13], v[12:13], v[28:29]
  v_pk_mul_f32 v[14:15], v[14:15], v[30:31]
  v_rcp_f32 v242, v242
  v_mfma_f32_16x16x32_bf16 v[52:55], a[88:91], a[228:231], v[52:55]
  v_rcp_f32 v243, v243
  v_mfma_f32_16x16x32_bf16 v[52:55], a[92:95], a[244:247], v[52:55]
  v_rcp_f32 v244, v244
  v_mfma_f32_16x16x32_bf16 v[48:51], a[92:95], a[240:243], v[48:51]
  ds_read_b64_tr_b16 a[76:77], v230 offset:57344
  v_cvt_pk_bf16_f32 v20, v4, v5
  v_mfma_f32_16x16x32_bf16 v[48:51], a[88:91], a[224:227], v[48:51]
  s_waitcnt lgkmcnt(3)
  ds_read_b64_tr_b16 a[78:79], v230 offset:61440
  v_xor_b32 v230, 0x10000, v230
  v_cvt_pk_bf16_f32 v21, v6, v7
  v_mfma_f32_16x16x32_bf16 v[192:195], a[64:67], a[32:35], v[192:195]
  v_exp_f32 v246, v246
  v_mfma_f32_16x16x32_bf16 v[192:195], a[68:71], a[48:51], v[192:195]
  v_exp_f32 v247, v247
  v_mfma_f32_16x16x32_bf16 v[196:199], a[68:71], a[52:55], v[196:199]
  ds_read_b64_tr_b16 a[80:81], v226 offset:32768
  ds_read_b64_tr_b16 a[82:83], v226 offset:36864
  v_mfma_f32_16x16x32_bf16 v[196:199], a[64:67], a[36:39], v[196:199]
  v_exp_f32 v248, v248
  v_exp_f32 v249, v249
  v_rcp_f32 v245, v245
  v_pk_fma_f32 v[246:247], v[246:247], v[234:235], v[234:235] op_sel:[0,1,1] op_sel_hi:[1,1,1]
  v_pk_fma_f32 v[248:249], v[248:249], v[234:235], v[234:235] op_sel:[0,1,1] op_sel_hi:[1,1,1]
  v_pk_mul_f32 v[8:9], v[8:9], v[242:243]
  v_pk_mul_f32 v[10:11], v[10:11], v[244:245]
  v_pk_mul_f32 v[242:243], v[32:33], v[238:239] op_sel:[0,0] op_sel_hi:[1,0]
  v_pk_mul_f32 v[244:245], v[34:35], v[238:239] op_sel:[0,0] op_sel_hi:[1,0]
  v_pk_mul_f32 v[32:33], v[32:33], v[48:49]
  v_pk_mul_f32 v[34:35], v[34:35], v[50:51]
  v_rcp_f32 v246, v246
  v_mfma_f32_16x16x32_bf16 v[200:203], a[64:67], a[40:43], v[200:203]
  v_rcp_f32 v247, v247
  v_mfma_f32_16x16x32_bf16 v[200:203], a[68:71], a[56:59], v[200:203]
  v_rcp_f32 v248, v248
  v_mfma_f32_16x16x32_bf16 v[204:207], a[68:71], a[60:63], v[204:207]
  ds_read_b64_tr_b16 a[84:85], v226 offset:40960
  v_cvt_pk_bf16_f32 v24, v8, v9
  v_mfma_f32_16x16x32_bf16 v[204:207], a[64:67], a[44:47], v[204:207]
  s_waitcnt lgkmcnt(3)
  ds_read_b64_tr_b16 a[86:87], v226 offset:45056
  v_cvt_pk_bf16_f32 v25, v10, v11
  v_mfma_f32_16x16x32_bf16 v[220:223], a[72:75], a[44:47], v[220:223]
  v_exp_f32 v242, v242
  v_mfma_f32_16x16x32_bf16 v[220:223], a[76:79], a[60:63], v[220:223]
  v_exp_f32 v243, v243
  v_mfma_f32_16x16x32_bf16 v[216:219], a[76:79], a[56:59], v[216:219]
  ds_read_b64_tr_b16 a[88:89], v226 offset:49152
  ds_read_b64_tr_b16 a[90:91], v226 offset:53248
  v_mfma_f32_16x16x32_bf16 v[216:219], a[72:75], a[40:43], v[216:219]
  v_exp_f32 v244, v244
  v_exp_f32 v245, v245
  v_rcp_f32 v249, v249
  v_pk_fma_f32 v[242:243], v[242:243], v[232:233], v[232:233] op_sel:[0,0,0] op_sel_hi:[1,0,0]
  v_pk_fma_f32 v[244:245], v[244:245], v[232:233], v[232:233] op_sel:[0,0,0] op_sel_hi:[1,0,0]
  v_pk_mul_f32 v[12:13], v[12:13], v[246:247]
  v_pk_mul_f32 v[14:15], v[14:15], v[248:249]
  v_pk_mul_f32 v[246:247], v[36:37], v[238:239] op_sel:[0,1] op_sel_hi:[1,1]
  v_pk_mul_f32 v[248:249], v[38:39], v[238:239] op_sel:[0,1] op_sel_hi:[1,1]
  v_pk_mul_f32 v[36:37], v[36:37], v[52:53]
  v_pk_mul_f32 v[38:39], v[38:39], v[54:55]
  v_rcp_f32 v242, v242
  v_mfma_f32_16x16x32_bf16 v[212:215], a[72:75], a[36:39], v[212:215]
  v_rcp_f32 v243, v243
  v_mfma_f32_16x16x32_bf16 v[212:215], a[76:79], a[52:55], v[212:215]
  v_rcp_f32 v244, v244
  v_mfma_f32_16x16x32_bf16 v[208:211], a[76:79], a[48:51], v[208:211]
  ds_read_b64_tr_b16 a[92:93], v226 offset:57344
  v_cvt_pk_bf16_f32 v28, v12, v13
  v_mfma_f32_16x16x32_bf16 v[208:211], a[72:75], a[32:35], v[208:211]
  s_waitcnt lgkmcnt(3)
  ds_read_b64_tr_b16 a[94:95], v226 offset:61440
  v_cvt_pk_bf16_f32 v29, v14, v15
  v_mfma_f32_16x16x32_bf16 v[64:67], a[80:83], a[224:227], v[64:67]
  v_exp_f32 v246, v246
  v_mfma_f32_16x16x32_bf16 v[64:67], a[84:87], a[240:243], v[64:67]
  v_exp_f32 v247, v247
  v_mfma_f32_16x16x32_bf16 v[68:71], a[84:87], a[244:247], v[68:71]
  ds_read_b64_tr_b16 a[64:65], v227 offset:0
  ds_read_b64_tr_b16 a[66:67], v227 offset:4096
  v_mfma_f32_16x16x32_bf16 v[68:71], a[80:83], a[228:231], v[68:71]
  v_exp_f32 v248, v248
  v_exp_f32 v249, v249
  v_rcp_f32 v245, v245
  v_pk_fma_f32 v[246:247], v[246:247], v[232:233], v[232:233] op_sel:[0,1,1] op_sel_hi:[1,1,1]
  v_pk_fma_f32 v[248:249], v[248:249], v[232:233], v[232:233] op_sel:[0,1,1] op_sel_hi:[1,1,1]
  v_pk_mul_f32 v[32:33], v[32:33], v[242:243]
  v_pk_mul_f32 v[34:35], v[34:35], v[244:245]
  v_pk_mul_f32 v[242:243], v[40:41], v[240:241] op_sel:[0,0] op_sel_hi:[1,0]
  v_pk_mul_f32 v[244:245], v[42:43], v[240:241] op_sel:[0,0] op_sel_hi:[1,0]
  v_pk_mul_f32 v[40:41], v[40:41], v[56:57]
  v_pk_mul_f32 v[42:43], v[42:43], v[58:59]
  v_rcp_f32 v246, v246
  v_mfma_f32_16x16x32_bf16 v[72:75], a[80:83], a[232:235], v[72:75]
  v_rcp_f32 v247, v247
  v_mfma_f32_16x16x32_bf16 v[72:75], a[84:87], a[248:251], v[72:75]
  v_rcp_f32 v248, v248
  v_mfma_f32_16x16x32_bf16 v[76:79], a[84:87], a[252:255], v[76:79]
  ds_read_b64_tr_b16 a[68:69], v227 offset:8192
  v_cvt_pk_bf16_f32 v18, v32, v33
  v_mfma_f32_16x16x32_bf16 v[76:79], a[80:83], a[236:239], v[76:79]
  s_waitcnt lgkmcnt(3)
  ds_read_b64_tr_b16 a[70:71], v227 offset:12288
  v_cvt_pk_bf16_f32 v19, v34, v35
  v_mfma_f32_16x16x32_bf16 v[92:95], a[88:91], a[236:239], v[92:95]
  buffer_store_dwordx4 v[16:19], v231, s[4:7], s57 offen sc1
  s_add_u32 s57, s57, 16384
  v_exp_f32 v242, v242
  v_mfma_f32_16x16x32_bf16 v[92:95], a[92:95], a[252:255], v[92:95]
  v_exp_f32 v243, v243
  v_mfma_f32_16x16x32_bf16 v[88:91], a[92:95], a[248:251], v[88:91]
  ds_read_b64_tr_b16 a[72:73], v227 offset:16384
  ds_read_b64_tr_b16 a[74:75], v227 offset:20480
  v_mfma_f32_16x16x32_bf16 v[88:91], a[88:91], a[232:235], v[88:91]
  v_exp_f32 v244, v244
  v_exp_f32 v245, v245
  v_rcp_f32 v249, v249
  v_pk_fma_f32 v[242:243], v[242:243], v[234:235], v[234:235] op_sel:[0,0,0] op_sel_hi:[1,0,0]
  v_pk_fma_f32 v[244:245], v[244:245], v[234:235], v[234:235] op_sel:[0,0,0] op_sel_hi:[1,0,0]
  v_pk_mul_f32 v[36:37], v[36:37], v[246:247]
  v_pk_mul_f32 v[38:39], v[38:39], v[248:249]
  v_pk_mul_f32 v[246:247], v[44:45], v[240:241] op_sel:[0,1] op_sel_hi:[1,1]
  v_pk_mul_f32 v[248:249], v[46:47], v[240:241] op_sel:[0,1] op_sel_hi:[1,1]
  v_pk_mul_f32 v[44:45], v[44:45], v[60:61]
  v_pk_mul_f32 v[46:47], v[46:47], v[62:63]
  v_rcp_f32 v242, v242
  v_mfma_f32_16x16x32_bf16 v[84:87], a[88:91], a[228:231], v[84:87]
  v_rcp_f32 v243, v243
  v_mfma_f32_16x16x32_bf16 v[84:87], a[92:95], a[244:247], v[84:87]
  v_rcp_f32 v244, v244
  v_mfma_f32_16x16x32_bf16 v[80:83], a[92:95], a[240:243], v[80:83]
  ds_read_b64_tr_b16 a[76:77], v227 offset:24576
  v_cvt_pk_bf16_f32 v22, v36, v37
  v_mfma_f32_16x16x32_bf16 v[80:83], a[88:91], a[224:227], v[80:83]
  s_waitcnt lgkmcnt(3)
  ds_read_b64_tr_b16 a[78:79], v227 offset:28672
  v_cvt_pk_bf16_f32 v23, v38, v39
  v_mfma_f32_16x16x32_bf16 v[96:99], a[64:67], a[192:195], v[96:99]
  buffer_store_dwordx4 v[20:23], v231, s[4:7], s58 offen sc1
  s_add_u32 s58, s58, 16384
  v_exp_f32 v246, v246
  v_mfma_f32_16x16x32_bf16 v[96:99], a[68:71], a[208:211], v[96:99]
  v_exp_f32 v247, v247
  v_mfma_f32_16x16x32_bf16 v[100:103], a[68:71], a[212:215], v[100:103]
  ds_read_b64_tr_b16 a[80:81], v227 offset:32768
  ds_read_b64_tr_b16 a[82:83], v227 offset:36864
  v_mfma_f32_16x16x32_bf16 v[100:103], a[64:67], a[196:199], v[100:103]
  v_exp_f32 v248, v248
  v_exp_f32 v249, v249
  v_rcp_f32 v245, v245
  v_pk_fma_f32 v[246:247], v[246:247], v[234:235], v[234:235] op_sel:[0,1,1] op_sel_hi:[1,1,1]
  v_pk_fma_f32 v[248:249], v[248:249], v[234:235], v[234:235] op_sel:[0,1,1] op_sel_hi:[1,1,1]
  v_pk_mul_f32 v[40:41], v[40:41], v[242:243]
  v_pk_mul_f32 v[42:43], v[42:43], v[244:245]
  v_pk_mul_f32 v[242:243], v[64:65], v[238:239] op_sel:[0,0] op_sel_hi:[1,0]
  v_pk_mul_f32 v[244:245], v[66:67], v[238:239] op_sel:[0,0] op_sel_hi:[1,0]
  v_pk_mul_f32 v[64:65], v[64:65], v[80:81]
  v_pk_mul_f32 v[66:67], v[66:67], v[82:83]
  v_rcp_f32 v246, v246
  v_mfma_f32_16x16x32_bf16 v[104:107], a[64:67], a[200:203], v[104:107]
  v_rcp_f32 v247, v247
  v_mfma_f32_16x16x32_bf16 v[104:107], a[68:71], a[216:219], v[104:107]
  v_rcp_f32 v248, v248
  v_mfma_f32_16x16x32_bf16 v[108:111], a[68:71], a[220:223], v[108:111]
  ds_read_b64_tr_b16 a[84:85], v227 offset:40960
  v_cvt_pk_bf16_f32 v26, v40, v41
  v_mfma_f32_16x16x32_bf16 v[108:111], a[64:67], a[204:207], v[108:111]
  s_waitcnt lgkmcnt(3)
  ds_read_b64_tr_b16 a[86:87], v227 offset:45056
  v_cvt_pk_bf16_f32 v27, v42, v43
  v_mfma_f32_16x16x32_bf16 v[124:127], a[72:75], a[204:207], v[124:127]
  buffer_store_dwordx4 v[24:27], v231, s[4:7], s59 offen sc1
  s_add_u32 s59, s59, 16384
  v_exp_f32 v242, v242
  v_mfma_f32_16x16x32_bf16 v[124:127], a[76:79], a[220:223], v[124:127]
  v_exp_f32 v243, v243
  v_mfma_f32_16x16x32_bf16 v[120:123], a[76:79], a[216:219], v[120:123]
  ds_read_b64_tr_b16 a[88:89], v227 offset:49152
  ds_read_b64_tr_b16 a[90:91], v227 offset:53248
  v_mfma_f32_16x16x32_bf16 v[120:123], a[72:75], a[200:203], v[120:123]
  v_exp_f32 v244, v244
  v_exp_f32 v245, v245
  v_rcp_f32 v249, v249
  v_pk_fma_f32 v[242:243], v[242:243], v[232:233], v[232:233] op_sel:[0,0,0] op_sel_hi:[1,0,0]
  v_pk_fma_f32 v[244:245], v[244:245], v[232:233], v[232:233] op_sel:[0,0,0] op_sel_hi:[1,0,0]
  v_pk_mul_f32 v[44:45], v[44:45], v[246:247]
  v_pk_mul_f32 v[46:47], v[46:47], v[248:249]
  v_pk_mul_f32 v[246:247], v[68:69], v[238:239] op_sel:[0,1] op_sel_hi:[1,1]
  v_pk_mul_f32 v[248:249], v[70:71], v[238:239] op_sel:[0,1] op_sel_hi:[1,1]
  v_pk_mul_f32 v[68:69], v[68:69], v[84:85]
  v_pk_mul_f32 v[70:71], v[70:71], v[86:87]
  v_rcp_f32 v242, v242
  v_mfma_f32_16x16x32_bf16 v[116:119], a[72:75], a[196:199], v[116:119]
  v_rcp_f32 v243, v243
  v_mfma_f32_16x16x32_bf16 v[116:119], a[76:79], a[212:215], v[116:119]
  v_rcp_f32 v244, v244
  v_mfma_f32_16x16x32_bf16 v[112:115], a[76:79], a[208:211], v[112:115]
  ds_read_b64_tr_b16 a[92:93], v227 offset:57344
  v_cvt_pk_bf16_f32 v30, v44, v45
  v_mfma_f32_16x16x32_bf16 v[112:115], a[72:75], a[192:195], v[112:115]
  s_waitcnt lgkmcnt(3)
  ds_read_b64_tr_b16 a[94:95], v227 offset:61440
  v_cvt_pk_bf16_f32 v31, v46, v47
  v_mfma_f32_16x16x32_bf16 v[96:99], a[80:83], a[224:227], v[96:99]
  buffer_store_dwordx4 v[28:31], v231, s[4:7], s60 offen sc1
  s_add_u32 s60, s60, 16384
  v_exp_f32 v246, v246
  v_mfma_f32_16x16x32_bf16 v[96:99], a[84:87], a[240:243], v[96:99]
  v_exp_f32 v247, v247
  v_mfma_f32_16x16x32_bf16 v[100:103], a[84:87], a[244:247], v[100:103]
  ds_read_b64_tr_b16 a[64:65], v228 offset:0
  ds_read_b64_tr_b16 a[66:67], v228 offset:4096
  v_mfma_f32_16x16x32_bf16 v[100:103], a[80:83], a[228:231], v[100:103]
  v_exp_f32 v248, v248
  v_exp_f32 v249, v249
  v_rcp_f32 v245, v245
  v_pk_fma_f32 v[246:247], v[246:247], v[232:233], v[232:233] op_sel:[0,1,1] op_sel_hi:[1,1,1]
  v_pk_fma_f32 v[248:249], v[248:249], v[232:233], v[232:233] op_sel:[0,1,1] op_sel_hi:[1,1,1]
  v_pk_mul_f32 v[64:65], v[64:65], v[242:243]
  v_pk_mul_f32 v[66:67], v[66:67], v[244:245]
  v_pk_mul_f32 v[242:243], v[72:73], v[240:241] op_sel:[0,0] op_sel_hi:[1,0]
  v_pk_mul_f32 v[244:245], v[74:75], v[240:241] op_sel:[0,0] op_sel_hi:[1,0]
  v_pk_mul_f32 v[72:73], v[72:73], v[88:89]
  v_pk_mul_f32 v[74:75], v[74:75], v[90:91]
  v_rcp_f32 v246, v246
  v_mfma_f32_16x16x32_bf16 v[104:107], a[80:83], a[232:235], v[104:107]
  v_rcp_f32 v247, v247
  v_lshlrev_b32 v8, 4, v253
  v_mfma_f32_16x16x32_bf16 v[104:107], a[84:87], a[248:251], v[104:107]
  v_rcp_f32 v248, v248
  v_add_u32 v9, 114688, v8
  v_mfma_f32_16x16x32_bf16 v[108:111], a[84:87], a[252:255], v[108:111]
  ds_read_b64_tr_b16 a[68:69], v228 offset:8192
  v_cvt_pk_bf16_f32 v80, v64, v65
  v_mfma_f32_16x16x32_bf16 v[108:111], a[80:83], a[236:239], v[108:111]
  s_waitcnt lgkmcnt(3)
  ds_read_b64_tr_b16 a[70:71], v228 offset:12288
  v_cvt_pk_bf16_f32 v81, v66, v67
  v_mfma_f32_16x16x32_bf16 v[124:127], a[88:91], a[236:239], v[124:127]
  buffer_load_dwordx4 v[16:19], v8, s[4:7], s46 offen offset:0 sc1
  v_exp_f32 v242, v242
  v_mfma_f32_16x16x32_bf16 v[124:127], a[92:95], a[252:255], v[124:127]
  buffer_load_dwordx4 v[20:23], v8, s[4:7], s46 offen offset:1024 sc1
  v_exp_f32 v243, v243
  v_mfma_f32_16x16x32_bf16 v[120:123], a[92:95], a[248:251], v[120:123]
  ds_read_b64_tr_b16 a[72:73], v228 offset:16384
  ds_read_b64_tr_b16 a[74:75], v228 offset:20480
  v_mfma_f32_16x16x32_bf16 v[120:123], a[88:91], a[232:235], v[120:123]
  v_exp_f32 v244, v244
  v_exp_f32 v245, v245
  v_rcp_f32 v249, v249
  v_pk_fma_f32 v[242:243], v[242:243], v[234:235], v[234:235] op_sel:[0,0,0] op_sel_hi:[1,0,0]
  v_pk_fma_f32 v[244:245], v[244:245], v[234:235], v[234:235] op_sel:[0,0,0] op_sel_hi:[1,0,0]
  v_pk_mul_f32 v[68:69], v[68:69], v[246:247]
  v_pk_mul_f32 v[70:71], v[70:71], v[248:249]
  v_pk_mul_f32 v[246:247], v[76:77], v[240:241] op_sel:[0,1] op_sel_hi:[1,1]
  v_pk_mul_f32 v[248:249], v[78:79], v[240:241] op_sel:[0,1] op_sel_hi:[1,1]
  v_pk_mul_f32 v[76:77], v[76:77], v[92:93]
  v_pk_mul_f32 v[78:79], v[78:79], v[94:95]
  v_rcp_f32 v242, v242
  v_mfma_f32_16x16x32_bf16 v[116:119], a[88:91], a[228:231], v[116:119]
  buffer_load_dwordx4 v[24:27], v8, s[4:7], s47 offen offset:0 sc1
  v_rcp_f32 v243, v243
  v_mfma_f32_16x16x32_bf16 v[116:119], a[92:95], a[244:247], v[116:119]
  buffer_load_dwordx4 v[28:31], v8, s[4:7], s47 offen offset:1024 sc1
  v_rcp_f32 v244, v244
  v_mfma_f32_16x16x32_bf16 v[112:115], a[92:95], a[240:243], v[112:115]
  ds_read_b64_tr_b16 a[76:77], v228 offset:24576
  v_cvt_pk_bf16_f32 v84, v68, v69
  v_mfma_f32_16x16x32_bf16 v[112:115], a[88:91], a[224:227], v[112:115]
  s_waitcnt lgkmcnt(3)
  ds_read_b64_tr_b16 a[78:79], v228 offset:28672
  v_cvt_pk_bf16_f32 v85, v70, v71
  v_mfma_f32_16x16x32_bf16 v[128:131], a[64:67], a[192:195], v[128:131]
  v_exp_f32 v246, v246
  v_bfe_u32 v11, v253, 2, 3
  v_mfma_f32_16x16x32_bf16 v[128:131], a[68:71], a[208:211], v[128:131]
  v_exp_f32 v247, v247
  v_bfe_u32 v12, v253, 3, 2
  v_mfma_f32_16x16x32_bf16 v[132:135], a[68:71], a[212:215], v[132:135]
  ds_read_b64_tr_b16 a[80:81], v228 offset:32768
  ds_read_b64_tr_b16 a[82:83], v228 offset:36864
  v_mfma_f32_16x16x32_bf16 v[132:135], a[64:67], a[196:199], v[132:135]
  v_exp_f32 v248, v248
  v_exp_f32 v249, v249
  v_rcp_f32 v245, v245
  v_pk_fma_f32 v[246:247], v[246:247], v[234:235], v[234:235] op_sel:[0,1,1] op_sel_hi:[1,1,1]
  v_pk_fma_f32 v[248:249], v[248:249], v[234:235], v[234:235] op_sel:[0,1,1] op_sel_hi:[1,1,1]
  v_pk_mul_f32 v[72:73], v[72:73], v[242:243]
  v_pk_mul_f32 v[74:75], v[74:75], v[244:245]
  v_pk_mul_f32 v[242:243], v[96:97], v[238:239] op_sel:[0,0] op_sel_hi:[1,0]
  v_pk_mul_f32 v[244:245], v[98:99], v[238:239] op_sel:[0,0] op_sel_hi:[1,0]
  v_pk_mul_f32 v[96:97], v[96:97], v[112:113]
  v_pk_mul_f32 v[98:99], v[98:99], v[114:115]
  v_rcp_f32 v246, v246
  v_mfma_f32_16x16x32_bf16 v[136:139], a[64:67], a[200:203], v[136:139]
  v_rcp_f32 v247, v247
  v_and_b32 v13, 3, v253
  v_mfma_f32_16x16x32_bf16 v[136:139], a[68:71], a[216:219], v[136:139]
  v_rcp_f32 v248, v248
  v_lshlrev_b32 v13, 3, v13
  v_mfma_f32_16x16x32_bf16 v[140:143], a[68:71], a[220:223], v[140:143]
  ds_read_b64_tr_b16 a[84:85], v228 offset:40960
  v_cvt_pk_bf16_f32 v88, v72, v73
  v_mfma_f32_16x16x32_bf16 v[140:143], a[64:67], a[204:207], v[140:143]
  s_waitcnt lgkmcnt(3)
  ds_read_b64_tr_b16 a[86:87], v228 offset:45056
  v_cvt_pk_bf16_f32 v89, v74, v75
  v_mfma_f32_16x16x32_bf16 v[156:159], a[72:75], a[204:207], v[156:159]
  v_exp_f32 v242, v242
  v_lshl_add_u32 v13, v11, 7, v13
  v_mfma_f32_16x16x32_bf16 v[156:159], a[76:79], a[220:223], v[156:159]
  v_exp_f32 v243, v243
  v_lshrrev_b32 v11, 5, v253
  v_mfma_f32_16x16x32_bf16 v[152:155], a[76:79], a[216:219], v[152:155]
  ds_read_b64_tr_b16 a[88:89], v228 offset:49152
  ds_read_b64_tr_b16 a[90:91], v228 offset:53248
  v_mfma_f32_16x16x32_bf16 v[152:155], a[72:75], a[200:203], v[152:155]
  v_exp_f32 v244, v244
  v_exp_f32 v245, v245
  v_rcp_f32 v249, v249
  v_pk_fma_f32 v[242:243], v[242:243], v[232:233], v[232:233] op_sel:[0,0,0] op_sel_hi:[1,0,0]
  v_pk_fma_f32 v[244:245], v[244:245], v[232:233], v[232:233] op_sel:[0,0,0] op_sel_hi:[1,0,0]
  v_pk_mul_f32 v[76:77], v[76:77], v[246:247]
  v_pk_mul_f32 v[78:79], v[78:79], v[248:249]
  v_pk_mul_f32 v[246:247], v[100:101], v[238:239] op_sel:[0,1] op_sel_hi:[1,1]
  v_pk_mul_f32 v[248:249], v[102:103], v[238:239] op_sel:[0,1] op_sel_hi:[1,1]
  v_pk_mul_f32 v[100:101], v[100:101], v[116:117]
  v_pk_mul_f32 v[102:103], v[102:103], v[118:119]
  v_rcp_f32 v242, v242
  v_mfma_f32_16x16x32_bf16 v[148:151], a[72:75], a[196:199], v[148:151]
  s_waitcnt vmcnt(4)
  s_barrier
  s_cmp_lg_u32 s40, 0
  s_cbranch_scc1 Lsgf17
  v_mov_b32 v250, 1
  s_mov_b64 exec, 1
  buffer_atomic_add v250, v251, s[4:7], s77 offen sc1
  s_mov_b64 exec, -1
Lsgf17:
  s_add_u32 s77, s77, 4096
  v_rcp_f32 v243, v243
  v_lshl_add_u32 v13, v11, 11, v13
  v_mfma_f32_16x16x32_bf16 v[148:151], a[76:79], a[212:215], v[148:151]
  s_add_u32 m0, s79, 32768
  v_rcp_f32 v244, v244
  v_xor_b32 v11, 0, v12
  v_mfma_f32_16x16x32_bf16 v[144:147], a[76:79], a[208:211], v[144:147]
  s_add_u32 s92, s92, 196608
  s_add_u32 s93, s92, s88
  ds_read_b64_tr_b16 a[92:93], v228 offset:57344
  v_cvt_pk_bf16_f32 v92, v76, v77
  v_mfma_f32_16x16x32_bf16 v[144:147], a[72:75], a[192:195], v[144:147]
  s_waitcnt lgkmcnt(3)
  ds_read_b64_tr_b16 a[94:95], v228 offset:61440
  v_cvt_pk_bf16_f32 v93, v78, v79
  v_mfma_f32_16x16x32_bf16 v[128:131], a[80:83], a[224:227], v[128:131]
  buffer_load_dwordx4 v252, s[80:83], s93 offen lds
  v_exp_f32 v246, v246
  v_mfma_f32_16x16x32_bf16 v[128:131], a[84:87], a[240:243], v[128:131]
  buffer_load_dwordx4 v252, s[84:87], s93 offen offset:1024 lds
  v_exp_f32 v247, v247
  v_mfma_f32_16x16x32_bf16 v[132:135], a[84:87], a[244:247], v[132:135]
  ds_read_b64_tr_b16 a[64:65], v229 offset:0
  ds_read_b64_tr_b16 a[66:67], v229 offset:4096
  v_mfma_f32_16x16x32_bf16 v[132:135], a[80:83], a[228:231], v[132:135]
  v_exp_f32 v248, v248
  v_exp_f32 v249, v249
  v_rcp_f32 v245, v245
  v_pk_fma_f32 v[246:247], v[246:247], v[232:233], v[232:233] op_sel:[0,1,1] op_sel_hi:[1,1,1]
  v_pk_fma_f32 v[248:249], v[248:249], v[232:233], v[232:233] op_sel:[0,1,1] op_sel_hi:[1,1,1]
  v_pk_mul_f32 v[96:97], v[96:97], v[242:243]
  v_pk_mul_f32 v[98:99], v[98:99], v[244:245]
  v_pk_mul_f32 v[242:243], v[104:105], v[240:241] op_sel:[0,0] op_sel_hi:[1,0]
  v_pk_mul_f32 v[244:245], v[106:107], v[240:241] op_sel:[0,0] op_sel_hi:[1,0]
  v_pk_mul_f32 v[104:105], v[104:105], v[120:121]
  v_pk_mul_f32 v[106:107], v[106:107], v[122:123]
  v_rcp_f32 v246, v246
  v_mfma_f32_16x16x32_bf16 v[136:139], a[80:83], a[232:235], v[136:139]
  s_add_u32 m0, s79, 40960
  v_rcp_f32 v247, v247
  v_lshl_add_u32 v0, v11, 5, v13
  v_mfma_f32_16x16x32_bf16 v[136:139], a[84:87], a[248:251], v[136:139]
  s_add_u32 s92, s92, 262144
  s_add_u32 s93, s92, s89
  buffer_load_dwordx4 v252, s[80:83], s93 offen lds
  v_rcp_f32 v248, v248
  v_mfma_f32_16x16x32_bf16 v[140:143], a[84:87], a[252:255], v[140:143]
  ds_read_b64_tr_b16 a[68:69], v229 offset:8192
  v_cvt_pk_bf16_f32 v82, v96, v97
  v_mfma_f32_16x16x32_bf16 v[140:143], a[80:83], a[236:239], v[140:143]
  s_waitcnt lgkmcnt(3)
  ds_read_b64_tr_b16 a[70:71], v229 offset:12288
  v_cvt_pk_bf16_f32 v83, v98, v99
  v_mfma_f32_16x16x32_bf16 v[156:159], a[88:91], a[236:239], v[156:159]
  buffer_load_dwordx4 v252, s[84:87], s93 offen offset:1024 lds
  buffer_store_dwordx4 v[80:83], v231, s[4:7], s57 offen sc1
  s_add_u32 s57, s57, 16384
  v_exp_f32 v242, v242
  v_mfma_f32_16x16x32_bf16 v[156:159], a[92:95], a[252:255], v[156:159]
  v_exp_f32 v243, v243
  v_add_u32 v4, 0x10000, v0
  v_mfma_f32_16x16x32_bf16 v[152:155], a[92:95], a[248:251], v[152:155]
  ds_read_b64_tr_b16 a[72:73], v229 offset:16384
  ds_read_b64_tr_b16 a[74:75], v229 offset:20480
  v_mfma_f32_16x16x32_bf16 v[152:155], a[88:91], a[232:235], v[152:155]
  v_exp_f32 v244, v244
  v_exp_f32 v245, v245
  v_rcp_f32 v249, v249
  v_pk_fma_f32 v[242:243], v[242:243], v[234:235], v[234:235] op_sel:[0,0,0] op_sel_hi:[1,0,0]
  v_pk_fma_f32 v[244:245], v[244:245], v[234:235], v[234:235] op_sel:[0,0,0] op_sel_hi:[1,0,0]
  v_pk_mul_f32 v[100:101], v[100:101], v[246:247]
  v_pk_mul_f32 v[102:103], v[102:103], v[248:249]
  v_pk_mul_f32 v[246:247], v[108:109], v[240:241] op_sel:[0,1] op_sel_hi:[1,1]
  v_pk_mul_f32 v[248:249], v[110:111], v[240:241] op_sel:[0,1] op_sel_hi:[1,1]
  v_pk_mul_f32 v[108:109], v[108:109], v[124:125]
  v_pk_mul_f32 v[110:111], v[110:111], v[126:127]
  v_rcp_f32 v242, v242
  v_mfma_f32_16x16x32_bf16 v[148:151], a[88:91], a[228:231], v[148:151]
  s_add_u32 m0, s79, 49152
  v_rcp_f32 v243, v243
  v_xor_b32 v11, 1, v12
  v_mfma_f32_16x16x32_bf16 v[148:151], a[92:95], a[244:247], v[148:151]
  s_add_u32 s92, s92, 196608
  s_add_u32 s93, s92, s90
  buffer_load_dwordx4 v252, s[80:83], s93 offen lds
  v_rcp_f32 v244, v244
  v_mfma_f32_16x16x32_bf16 v[144:147], a[92:95], a[240:243], v[144:147]
  ds_read_b64_tr_b16 a[76:77], v229 offset:24576
  v_cvt_pk_bf16_f32 v86, v100, v101
  v_mfma_f32_16x16x32_bf16 v[144:147], a[88:91], a[224:227], v[144:147]
  s_waitcnt lgkmcnt(3)
  ds_read_b64_tr_b16 a[78:79], v229 offset:28672
  v_cvt_pk_bf16_f32 v87, v102, v103
  v_mfma_f32_16x16x32_bf16 v[160:163], a[64:67], a[192:195], v[160:163]
  buffer_load_dwordx4 v252, s[84:87], s93 offen offset:1024 lds
  buffer_store_dwordx4 v[84:87], v231, s[4:7], s58 offen sc1
  s_add_u32 s58, s58, 16384
  v_exp_f32 v246, v246
  v_mfma_f32_16x16x32_bf16 v[160:163], a[68:71], a[208:211], v[160:163]
  v_exp_f32 v247, v247
  v_lshl_add_u32 v1, v11, 5, v13
  v_mfma_f32_16x16x32_bf16 v[164:167], a[68:71], a[212:215], v[164:167]
  ds_read_b64_tr_b16 a[80:81], v229 offset:32768
  ds_read_b64_tr_b16 a[82:83], v229 offset:36864
  v_mfma_f32_16x16x32_bf16 v[164:167], a[64:67], a[196:199], v[164:167]
  v_exp_f32 v248, v248
  v_exp_f32 v249, v249
  v_rcp_f32 v245, v245
  v_pk_fma_f32 v[246:247], v[246:247], v[234:235], v[234:235] op_sel:[0,1,1] op_sel_hi:[1,1,1]
  v_pk_fma_f32 v[248:249], v[248:249], v[234:235], v[234:235] op_sel:[0,1,1] op_sel_hi:[1,1,1]
  v_pk_mul_f32 v[104:105], v[104:105], v[242:243]
  v_pk_mul_f32 v[106:107], v[106:107], v[244:245]
  v_pk_mul_f32 v[242:243], v[128:129], v[238:239] op_sel:[0,0] op_sel_hi:[1,0]
  v_pk_mul_f32 v[244:245], v[130:131], v[238:239] op_sel:[0,0] op_sel_hi:[1,0]
  v_pk_mul_f32 v[128:129], v[128:129], v[144:145]
  v_pk_mul_f32 v[130:131], v[130:131], v[146:147]
  v_rcp_f32 v246, v246
  v_mfma_f32_16x16x32_bf16 v[168:171], a[64:67], a[200:203], v[168:171]
  s_add_u32 m0, s79, 57344
  v_rcp_f32 v247, v247
  v_add_u32 v5, 0x10000, v1
  v_mfma_f32_16x16x32_bf16 v[168:171], a[68:71], a[216:219], v[168:171]
  s_add_u32 s92, s92, 262144
  s_add_u32 s93, s92, s91
  buffer_load_dwordx4 v252, s[80:83], s93 offen lds
  v_rcp_f32 v248, v248
  v_mfma_f32_16x16x32_bf16 v[172:175], a[68:71], a[220:223], v[172:175]
  ds_read_b64_tr_b16 a[84:85], v229 offset:40960
  v_cvt_pk_bf16_f32 v90, v104, v105
  v_mfma_f32_16x16x32_bf16 v[172:175], a[64:67], a[204:207], v[172:175]
  s_waitcnt lgkmcnt(3)
  ds_read_b64_tr_b16 a[86:87], v229 offset:45056
  v_cvt_pk_bf16_f32 v91, v106, v107
  v_mfma_f32_16x16x32_bf16 v[188:191], a[72:75], a[204:207], v[188:191]
  buffer_load_dwordx4 v252, s[84:87], s93 offen offset:1024 lds
  buffer_store_dwordx4 v[88:91], v231, s[4:7], s59 offen sc1
  s_add_u32 s59, s59, 16384
  v_exp_f32 v242, v242
  v_mfma_f32_16x16x32_bf16 v[188:191], a[76:79], a[220:223], v[188:191]
  v_exp_f32 v243, v243
  v_xor_b32 v11, 2, v12
  v_mfma_f32_16x16x32_bf16 v[184:187], a[76:79], a[216:219], v[184:187]
  ds_read_b64_tr_b16 a[88:89], v229 offset:49152
  ds_read_b64_tr_b16 a[90:91], v229 offset:53248
  v_mfma_f32_16x16x32_bf16 v[184:187], a[72:75], a[200:203], v[184:187]
  v_exp_f32 v244, v244
  v_exp_f32 v245, v245
  v_rcp_f32 v249, v249
  v_pk_fma_f32 v[242:243], v[242:243], v[232:233], v[232:233] op_sel:[0,0,0] op_sel_hi:[1,0,0]
  v_pk_fma_f32 v[244:245], v[244:245], v[232:233], v[232:233] op_sel:[0,0,0] op_sel_hi:[1,0,0]
  v_pk_mul_f32 v[108:109], v[108:109], v[246:247]
  v_pk_mul_f32 v[110:111], v[110:111], v[248:249]
  v_pk_mul_f32 v[246:247], v[132:133], v[238:239] op_sel:[0,1] op_sel_hi:[1,1]
  v_pk_mul_f32 v[248:249], v[134:135], v[238:239] op_sel:[0,1] op_sel_hi:[1,1]
  v_pk_mul_f32 v[132:133], v[132:133], v[148:149]
  v_pk_mul_f32 v[134:135], v[134:135], v[150:151]
  v_rcp_f32 v242, v242
  v_mfma_f32_16x16x32_bf16 v[180:183], a[72:75], a[196:199], v[180:183]
  buffer_load_dword v10, v251, s[4:7], s64 offen sc1
  v_rcp_f32 v243, v243
  v_mfma_f32_16x16x32_bf16 v[180:183], a[76:79], a[212:215], v[180:183]
  v_rcp_f32 v244, v244
  v_lshl_add_u32 v2, v11, 5, v13
  v_mfma_f32_16x16x32_bf16 v[176:179], a[76:79], a[208:211], v[176:179]
  ds_read_b64_tr_b16 a[92:93], v229 offset:57344
  v_cvt_pk_bf16_f32 v94, v108, v109
  v_mfma_f32_16x16x32_bf16 v[176:179], a[72:75], a[192:195], v[176:179]
  s_waitcnt lgkmcnt(3)
  ds_read_b64_tr_b16 a[94:95], v229 offset:61440
  v_cvt_pk_bf16_f32 v95, v110, v111
  v_mfma_f32_16x16x32_bf16 v[160:163], a[80:83], a[224:227], v[160:163]
  buffer_store_dwordx4 v[92:95], v231, s[4:7], s60 offen sc1
  s_add_u32 s60, s60, 16384
  v_exp_f32 v246, v246
  v_mfma_f32_16x16x32_bf16 v[160:163], a[84:87], a[240:243], v[160:163]
  v_exp_f32 v247, v247
  v_add_u32 v6, 0x10000, v2
  v_mfma_f32_16x16x32_bf16 v[164:167], a[84:87], a[244:247], v[164:167]
  ds_read_b64_tr_b16 a[64:65], v230 offset:0
  ds_read_b64_tr_b16 a[66:67], v230 offset:4096
  v_mfma_f32_16x16x32_bf16 v[164:167], a[80:83], a[228:231], v[164:167]
  v_exp_f32 v248, v248
  v_exp_f32 v249, v249
  v_rcp_f32 v245, v245
  v_pk_fma_f32 v[246:247], v[246:247], v[232:233], v[232:233] op_sel:[0,1,1] op_sel_hi:[1,1,1]
  v_pk_fma_f32 v[248:249], v[248:249], v[232:233], v[232:233] op_sel:[0,1,1] op_sel_hi:[1,1,1]
  v_pk_mul_f32 v[128:129], v[128:129], v[242:243]
  v_pk_mul_f32 v[130:131], v[130:131], v[244:245]
  v_pk_mul_f32 v[242:243], v[136:137], v[240:241] op_sel:[0,0] op_sel_hi:[1,0]
  v_pk_mul_f32 v[244:245], v[138:139], v[240:241] op_sel:[0,0] op_sel_hi:[1,0]
  v_pk_mul_f32 v[136:137], v[136:137], v[152:153]
  v_pk_mul_f32 v[138:139], v[138:139], v[154:155]
  v_rcp_f32 v246, v246
  v_mfma_f32_16x16x32_bf16 v[168:171], a[80:83], a[232:235], v[168:171]
  v_rcp_f32 v247, v247
  v_xor_b32 v11, 3, v12
  v_mfma_f32_16x16x32_bf16 v[168:171], a[84:87], a[248:251], v[168:171]
  v_rcp_f32 v248, v248
  v_lshl_add_u32 v3, v11, 5, v13
  v_mfma_f32_16x16x32_bf16 v[172:175], a[84:87], a[252:255], v[172:175]
  ds_read_b64_tr_b16 a[68:69], v230 offset:8192
  v_cvt_pk_bf16_f32 v144, v128, v129
  v_mfma_f32_16x16x32_bf16 v[172:175], a[80:83], a[236:239], v[172:175]
  s_waitcnt lgkmcnt(3)
  ds_read_b64_tr_b16 a[70:71], v230 offset:12288
  v_cvt_pk_bf16_f32 v145, v130, v131
  v_mfma_f32_16x16x32_bf16 v[188:191], a[88:91], a[236:239], v[188:191]
  v_exp_f32 v242, v242
  v_add_u32 v7, 0x10000, v3
  v_mfma_f32_16x16x32_bf16 v[188:191], a[92:95], a[252:255], v[188:191]
  v_exp_f32 v243, v243
  v_mfma_f32_16x16x32_bf16 v[184:187], a[92:95], a[248:251], v[184:187]
  ds_read_b64_tr_b16 a[72:73], v230 offset:16384
  ds_read_b64_tr_b16 a[74:75], v230 offset:20480
  v_mfma_f32_16x16x32_bf16 v[184:187], a[88:91], a[232:235], v[184:187]
  v_exp_f32 v244, v244
  v_exp_f32 v245, v245
  v_rcp_f32 v249, v249
  v_pk_fma_f32 v[242:243], v[242:243], v[234:235], v[234:235] op_sel:[0,0,0] op_sel_hi:[1,0,0]
  v_pk_fma_f32 v[244:245], v[244:245], v[234:235], v[234:235] op_sel:[0,0,0] op_sel_hi:[1,0,0]
  v_pk_mul_f32 v[132:133], v[132:133], v[246:247]
  v_pk_mul_f32 v[134:135], v[134:135], v[248:249]
  v_pk_mul_f32 v[246:247], v[140:141], v[240:241] op_sel:[0,1] op_sel_hi:[1,1]
  v_pk_mul_f32 v[248:249], v[142:143], v[240:241] op_sel:[0,1] op_sel_hi:[1,1]
  v_pk_mul_f32 v[140:141], v[140:141], v[156:157]
  v_pk_mul_f32 v[142:143], v[142:143], v[158:159]
  v_rcp_f32 v242, v242
  v_mfma_f32_16x16x32_bf16 v[180:183], a[88:91], a[228:231], v[180:183]
  v_rcp_f32 v243, v243
  v_mfma_f32_16x16x32_bf16 v[180:183], a[92:95], a[244:247], v[180:183]
  v_rcp_f32 v244, v244
  v_mfma_f32_16x16x32_bf16 v[176:179], a[92:95], a[240:243], v[176:179]
  ds_read_b64_tr_b16 a[76:77], v230 offset:24576
  v_cvt_pk_bf16_f32 v148, v132, v133
  v_mfma_f32_16x16x32_bf16 v[176:179], a[88:91], a[224:227], v[176:179]
  s_waitcnt lgkmcnt(3)
  ds_read_b64_tr_b16 a[78:79], v230 offset:28672
  v_cvt_pk_bf16_f32 v149, v134, v135
  v_mfma_f32_16x16x32_bf16 v[192:195], a[64:67], a[192:195], v[192:195]
  v_exp_f32 v246, v246
  v_mfma_f32_16x16x32_bf16 v[192:195], a[68:71], a[208:211], v[192:195]
  v_exp_f32 v247, v247
  v_mfma_f32_16x16x32_bf16 v[196:199], a[68:71], a[212:215], v[196:199]
  ds_read_b64_tr_b16 a[80:81], v230 offset:32768
  ds_read_b64_tr_b16 a[82:83], v230 offset:36864
  v_mfma_f32_16x16x32_bf16 v[196:199], a[64:67], a[196:199], v[196:199]
  v_exp_f32 v248, v248
  v_exp_f32 v249, v249
  v_rcp_f32 v245, v245
  v_pk_fma_f32 v[246:247], v[246:247], v[234:235], v[234:235] op_sel:[0,1,1] op_sel_hi:[1,1,1]
  v_pk_fma_f32 v[248:249], v[248:249], v[234:235], v[234:235] op_sel:[0,1,1] op_sel_hi:[1,1,1]
  v_pk_mul_f32 v[136:137], v[136:137], v[242:243]
  v_pk_mul_f32 v[138:139], v[138:139], v[244:245]
  v_pk_mul_f32 v[242:243], v[160:161], v[238:239] op_sel:[0,0] op_sel_hi:[1,0]
  v_pk_mul_f32 v[244:245], v[162:163], v[238:239] op_sel:[0,0] op_sel_hi:[1,0]
  v_pk_mul_f32 v[160:161], v[160:161], v[176:177]
  v_pk_mul_f32 v[162:163], v[162:163], v[178:179]
  v_rcp_f32 v246, v246
  v_mfma_f32_16x16x32_bf16 v[200:203], a[64:67], a[200:203], v[200:203]
  s_waitcnt vmcnt(1)
  v_cmp_gt_u32 vcc, 16, v10
  s_cbranch_vccz Lp4a_ok
  s_mov_b32 s43, 0x40000
Lp4a_sp:
  s_sleep 10
  buffer_load_dword v10, v251, s[4:7], s64 offen sc1
  s_waitcnt vmcnt(0)
  v_cmp_gt_u32 vcc, 16, v10
  s_cbranch_vccz Lp4a_ok
  s_sub_u32 s43, s43, 1
  s_cmp_lg_u32 s43, 0
  s_cbranch_scc1 Lp4a_sp
Lp4a_ok:
  s_add_u32 s64, s64, 4096
  v_rcp_f32 v247, v247
  v_mfma_f32_16x16x32_bf16 v[200:203], a[68:71], a[216:219], v[200:203]
  s_min_u32 s63, s88, 4096
  s_add_u32 s63, s63, s48
  buffer_load_dwordx4 a[128:131], v8, s[4:7], s63 offen offset:0 sc1
  v_rcp_f32 v248, v248
  v_mfma_f32_16x16x32_bf16 v[204:207], a[68:71], a[220:223], v[204:207]
  ds_read_b64_tr_b16 a[84:85], v230 offset:40960
  v_cvt_pk_bf16_f32 v152, v136, v137
  v_mfma_f32_16x16x32_bf16 v[204:207], a[64:67], a[204:207], v[204:207]
  s_waitcnt lgkmcnt(3)
  ds_read_b64_tr_b16 a[86:87], v230 offset:45056
  v_cvt_pk_bf16_f32 v153, v138, v139
  v_mfma_f32_16x16x32_bf16 v[220:223], a[72:75], a[204:207], v[220:223]
  buffer_load_dwordx4 a[132:135], v9, s[4:7], s63 offen offset:0 sc1
  v_exp_f32 v242, v242
  v_mfma_f32_16x16x32_bf16 v[220:223], a[76:79], a[220:223], v[220:223]
  s_min_u32 s63, s89, 4096
  s_add_u32 s63, s63, s48
  buffer_load_dwordx4 a[136:139], v8, s[4:7], s63 offen offset:1024 sc1
  v_exp_f32 v243, v243
  v_mfma_f32_16x16x32_bf16 v[216:219], a[76:79], a[216:219], v[216:219]
  ds_read_b64_tr_b16 a[88:89], v230 offset:49152
  ds_read_b64_tr_b16 a[90:91], v230 offset:53248
  v_mfma_f32_16x16x32_bf16 v[216:219], a[72:75], a[200:203], v[216:219]
  buffer_load_dwordx4 a[140:143], v9, s[4:7], s63 offen offset:1024 sc1
  v_exp_f32 v244, v244
  v_exp_f32 v245, v245
  v_rcp_f32 v249, v249
  v_pk_fma_f32 v[242:243], v[242:243], v[232:233], v[232:233] op_sel:[0,0,0] op_sel_hi:[1,0,0]
  v_pk_fma_f32 v[244:245], v[244:245], v[232:233], v[232:233] op_sel:[0,0,0] op_sel_hi:[1,0,0]
  v_pk_mul_f32 v[140:141], v[140:141], v[246:247]
  v_pk_mul_f32 v[142:143], v[142:143], v[248:249]
  v_pk_mul_f32 v[246:247], v[164:165], v[238:239] op_sel:[0,1] op_sel_hi:[1,1]
  v_pk_mul_f32 v[248:249], v[166:167], v[238:239] op_sel:[0,1] op_sel_hi:[1,1]
  v_pk_mul_f32 v[164:165], v[164:165], v[180:181]
  v_pk_mul_f32 v[166:167], v[166:167], v[182:183]
  v_rcp_f32 v242, v242
  v_mfma_f32_16x16x32_bf16 v[212:215], a[72:75], a[196:199], v[212:215]
  s_min_u32 s63, s90, 4096
  s_add_u32 s63, s63, s48
  buffer_load_dwordx4 a[144:147], v8, s[4:7], s63 offen offset:2048 sc1
  v_rcp_f32 v243, v243
  v_mfma_f32_16x16x32_bf16 v[212:215], a[76:79], a[212:215], v[212:215]
  buffer_load_dwordx4 a[148:151], v9, s[4:7], s63 offen offset:2048 sc1
  v_rcp_f32 v244, v244
  v_mfma_f32_16x16x32_bf16 v[208:211], a[76:79], a[208:211], v[208:211]
  s_min_u32 s63, s91, 4096
  s_add_u32 s63, s63, s48
  ds_read_b64_tr_b16 a[92:93], v230 offset:57344
  v_cvt_pk_bf16_f32 v156, v140, v141
  v_mfma_f32_16x16x32_bf16 v[208:211], a[72:75], a[192:195], v[208:211]
  s_waitcnt lgkmcnt(3)
  ds_read_b64_tr_b16 a[94:95], v230 offset:61440
  v_cvt_pk_bf16_f32 v157, v142, v143
  v_mfma_f32_16x16x32_bf16 v[192:195], a[80:83], a[224:227], v[192:195]
  buffer_load_dwordx4 a[152:155], v8, s[4:7], s63 offen offset:3072 sc1
  v_exp_f32 v246, v246
  v_mfma_f32_16x16x32_bf16 v[192:195], a[84:87], a[240:243], v[192:195]
  buffer_load_dwordx4 a[156:159], v9, s[4:7], s63 offen offset:3072 sc1
  v_exp_f32 v247, v247
  v_mfma_f32_16x16x32_bf16 v[196:199], a[84:87], a[244:247], v[196:199]
  v_mfma_f32_16x16x32_bf16 v[196:199], a[80:83], a[228:231], v[196:199]
  v_exp_f32 v248, v248
  v_exp_f32 v249, v249
  v_rcp_f32 v245, v245
  v_pk_fma_f32 v[246:247], v[246:247], v[232:233], v[232:233] op_sel:[0,1,1] op_sel_hi:[1,1,1]
  v_pk_fma_f32 v[248:249], v[248:249], v[232:233], v[232:233] op_sel:[0,1,1] op_sel_hi:[1,1,1]
  v_pk_mul_f32 v[160:161], v[160:161], v[242:243]
  v_pk_mul_f32 v[162:163], v[162:163], v[244:245]
  v_pk_mul_f32 v[242:243], v[168:169], v[240:241] op_sel:[0,0] op_sel_hi:[1,0]
  v_pk_mul_f32 v[244:245], v[170:171], v[240:241] op_sel:[0,0] op_sel_hi:[1,0]
  v_pk_mul_f32 v[168:169], v[168:169], v[184:185]
  v_pk_mul_f32 v[170:171], v[170:171], v[186:187]
  v_rcp_f32 v246, v246
  v_mfma_f32_16x16x32_bf16 v[200:203], a[80:83], a[232:235], v[200:203]
  s_waitcnt vmcnt(8)
  s_barrier
  s_cmp_lg_u32 s40, 0
  s_cbranch_scc1 Lsgf18
  v_mov_b32 v250, 1
  s_mov_b64 exec, 1
  buffer_atomic_add v250, v251, s[4:7], s77 offen sc1
  s_mov_b64 exec, -1
Lsgf18:
  s_add_u32 s77, s77, 4096
  v_rcp_f32 v247, v247
  v_mfma_f32_16x16x32_bf16 v[200:203], a[84:87], a[248:251], v[200:203]
  s_add_u32 s48, s48, 4096
  s_min_u32 s63, s88, 4096
  s_add_u32 s63, s63, s48
  buffer_load_dwordx4 a[160:163], v8, s[4:7], s63 offen offset:0 sc1
  v_rcp_f32 v248, v248
  v_mfma_f32_16x16x32_bf16 v[204:207], a[84:87], a[252:255], v[204:207]
  v_cvt_pk_bf16_f32 v146, v160, v161
  v_mfma_f32_16x16x32_bf16 v[204:207], a[80:83], a[236:239], v[204:207]
  v_cvt_pk_bf16_f32 v147, v162, v163
  s_waitcnt lgkmcnt(0)
  v_mfma_f32_16x16x32_bf16 v[220:223], a[88:91], a[236:239], v[220:223]
  buffer_load_dwordx4 a[164:167], v9, s[4:7], s63 offen offset:0 sc1
  buffer_store_dwordx4 v[144:147], v231, s[4:7], s57 offen sc1
  s_add_u32 s57, s57, 16384
  v_exp_f32 v242, v242
  v_mfma_f32_16x16x32_bf16 v[220:223], a[92:95], a[252:255], v[220:223]
  s_min_u32 s63, s89, 4096
  s_add_u32 s63, s63, s48
  buffer_load_dwordx4 a[168:171], v8, s[4:7], s63 offen offset:1024 sc1
  v_exp_f32 v243, v243
  v_mfma_f32_16x16x32_bf16 v[216:219], a[92:95], a[248:251], v[216:219]
  v_mfma_f32_16x16x32_bf16 v[216:219], a[88:91], a[232:235], v[216:219]
  buffer_load_dwordx4 a[172:175], v9, s[4:7], s63 offen offset:1024 sc1
  v_exp_f32 v244, v244
  v_exp_f32 v245, v245
  v_rcp_f32 v249, v249
  v_pk_fma_f32 v[242:243], v[242:243], v[234:235], v[234:235] op_sel:[0,0,0] op_sel_hi:[1,0,0]
  v_pk_fma_f32 v[244:245], v[244:245], v[234:235], v[234:235] op_sel:[0,0,0] op_sel_hi:[1,0,0]
  v_pk_mul_f32 v[164:165], v[164:165], v[246:247]
  v_pk_mul_f32 v[166:167], v[166:167], v[248:249]
  v_pk_mul_f32 v[246:247], v[172:173], v[240:241] op_sel:[0,1] op_sel_hi:[1,1]
  v_pk_mul_f32 v[248:249], v[174:175], v[240:241] op_sel:[0,1] op_sel_hi:[1,1]
  v_pk_mul_f32 v[172:173], v[172:173], v[188:189]
  v_pk_mul_f32 v[174:175], v[174:175], v[190:191]
  v_rcp_f32 v242, v242
  v_mfma_f32_16x16x32_bf16 v[212:215], a[88:91], a[228:231], v[212:215]
  v_mfma_f32_16x16x32_bf16 v[212:215], a[92:95], a[244:247], v[212:215]
  v_mfma_f32_16x16x32_bf16 v[208:211], a[92:95], a[240:243], v[208:211]
  v_mfma_f32_16x16x32_bf16 v[208:211], a[88:91], a[224:227], v[208:211]
  ds_read_b64_tr_b16 a[0:1], v0 offset:0
  ds_read_b64_tr_b16 a[2:3], v0 offset:4096
  ds_read_b64_tr_b16 a[16:17], v0 offset:8192
  ds_read_b64_tr_b16 a[18:19], v0 offset:12288
  ds_read_b64_tr_b16 a[4:5], v1 offset:0
  ds_read_b64_tr_b16 a[6:7], v1 offset:4096
  ds_read_b64_tr_b16 a[20:21], v1 offset:8192
  ds_read_b64_tr_b16 a[22:23], v1 offset:12288
  ds_read_b64_tr_b16 a[8:9], v2 offset:0
  ds_read_b64_tr_b16 a[10:11], v2 offset:4096
  ds_read_b64_tr_b16 a[24:25], v2 offset:8192
  ds_read_b64_tr_b16 a[26:27], v2 offset:12288
  ds_read_b64_tr_b16 a[12:13], v3 offset:0
  ds_read_b64_tr_b16 a[14:15], v3 offset:4096
  ds_read_b64_tr_b16 a[28:29], v3 offset:8192
  ds_read_b64_tr_b16 a[30:31], v3 offset:12288
  s_min_u32 s63, s90, 4096
  s_add_u32 s63, s63, s48
  buffer_load_dwordx4 a[176:179], v8, s[4:7], s63 offen offset:2048 sc1
  buffer_load_dwordx4 a[180:183], v9, s[4:7], s63 offen offset:2048 sc1
  v_rcp_f32 v243, v243
  v_rcp_f32 v244, v244
  v_cvt_pk_bf16_f32 v150, v164, v165
  v_cvt_pk_bf16_f32 v151, v166, v167
  s_min_u32 s63, s91, 4096
  s_add_u32 s63, s63, s48
  buffer_load_dwordx4 a[184:187], v8, s[4:7], s63 offen offset:3072 sc1
  buffer_load_dwordx4 a[188:191], v9, s[4:7], s63 offen offset:3072 sc1
  buffer_store_dwordx4 v[148:151], v231, s[4:7], s58 offen sc1
  s_add_u32 s58, s58, 16384
  v_exp_f32 v246, v246
  v_exp_f32 v247, v247
  v_exp_f32 v248, v248
  v_exp_f32 v249, v249
  v_rcp_f32 v245, v245
  v_pk_fma_f32 v[246:247], v[246:247], v[234:235], v[234:235] op_sel:[0,1,1] op_sel_hi:[1,1,1]
  v_pk_fma_f32 v[248:249], v[248:249], v[234:235], v[234:235] op_sel:[0,1,1] op_sel_hi:[1,1,1]
  v_pk_mul_f32 v[168:169], v[168:169], v[242:243]
  v_pk_mul_f32 v[170:171], v[170:171], v[244:245]
  v_pk_mul_f32 v[242:243], v[192:193], v[238:239] op_sel:[0,0] op_sel_hi:[1,0]
  v_pk_mul_f32 v[244:245], v[194:195], v[238:239] op_sel:[0,0] op_sel_hi:[1,0]
  v_pk_mul_f32 v[192:193], v[192:193], v[208:209]
  v_pk_mul_f32 v[194:195], v[194:195], v[210:211]
  v_rcp_f32 v246, v246
  s_add_u32 m0, s79, 65536
  s_add_u32 s92, s92, 196608
  s_add_u32 s93, s92, s88
  v_rcp_f32 v247, v247
  v_rcp_f32 v248, v248
  v_cvt_pk_bf16_f32 v154, v168, v169
  v_cvt_pk_bf16_f32 v155, v170, v171
  buffer_load_dwordx4 v252, s[80:83], s93 offen lds
  buffer_load_dwordx4 v252, s[84:87], s93 offen offset:1024 lds
  buffer_store_dwordx4 v[152:155], v231, s[4:7], s59 offen sc1
  s_add_u32 s59, s59, 16384
  v_exp_f32 v242, v242
  v_exp_f32 v243, v243
  v_exp_f32 v244, v244
  v_exp_f32 v245, v245
  v_rcp_f32 v249, v249
  v_pk_fma_f32 v[242:243], v[242:243], v[232:233], v[232:233] op_sel:[0,0,0] op_sel_hi:[1,0,0]
  v_pk_fma_f32 v[244:245], v[244:245], v[232:233], v[232:233] op_sel:[0,0,0] op_sel_hi:[1,0,0]
  v_pk_mul_f32 v[172:173], v[172:173], v[246:247]
  v_pk_mul_f32 v[174:175], v[174:175], v[248:249]
  v_pk_mul_f32 v[246:247], v[196:197], v[238:239] op_sel:[0,1] op_sel_hi:[1,1]
  v_pk_mul_f32 v[248:249], v[198:199], v[238:239] op_sel:[0,1] op_sel_hi:[1,1]
  v_pk_mul_f32 v[196:197], v[196:197], v[212:213]
  v_pk_mul_f32 v[198:199], v[198:199], v[214:215]
  v_rcp_f32 v242, v242
  s_add_u32 m0, s79, 73728
  s_add_u32 s92, s92, 262144
  s_add_u32 s93, s92, s89
  v_rcp_f32 v243, v243
  v_rcp_f32 v244, v244
  v_cvt_pk_bf16_f32 v158, v172, v173
  v_cvt_pk_bf16_f32 v159, v174, v175
  buffer_load_dwordx4 v252, s[80:83], s93 offen lds
  buffer_load_dwordx4 v252, s[84:87], s93 offen offset:1024 lds
  buffer_store_dwordx4 v[156:159], v231, s[4:7], s60 offen sc1
  s_add_u32 s60, s60, 16384
  v_exp_f32 v246, v246
  v_exp_f32 v247, v247
  v_exp_f32 v248, v248
  v_exp_f32 v249, v249
  v_rcp_f32 v245, v245
  v_pk_fma_f32 v[246:247], v[246:247], v[232:233], v[232:233] op_sel:[0,1,1] op_sel_hi:[1,1,1]
  v_pk_fma_f32 v[248:249], v[248:249], v[232:233], v[232:233] op_sel:[0,1,1] op_sel_hi:[1,1,1]
  v_pk_mul_f32 v[192:193], v[192:193], v[242:243]
  v_pk_mul_f32 v[194:195], v[194:195], v[244:245]
  v_pk_mul_f32 v[242:243], v[200:201], v[240:241] op_sel:[0,0] op_sel_hi:[1,0]
  v_pk_mul_f32 v[244:245], v[202:203], v[240:241] op_sel:[0,0] op_sel_hi:[1,0]
  v_pk_mul_f32 v[200:201], v[200:201], v[216:217]
  v_pk_mul_f32 v[202:203], v[202:203], v[218:219]
  v_rcp_f32 v246, v246
  s_add_u32 m0, s79, 81920
  s_add_u32 s92, s92, 196608
  s_add_u32 s93, s92, s90
  v_rcp_f32 v247, v247
  v_rcp_f32 v248, v248
  v_cvt_pk_bf16_f32 v208, v192, v193
  v_cvt_pk_bf16_f32 v209, v194, v195
  buffer_load_dwordx4 v252, s[80:83], s93 offen lds
  buffer_load_dwordx4 v252, s[84:87], s93 offen offset:1024 lds
  v_exp_f32 v242, v242
  v_exp_f32 v243, v243
  v_exp_f32 v244, v244
  v_exp_f32 v245, v245
  v_rcp_f32 v249, v249
  v_pk_fma_f32 v[242:243], v[242:243], v[234:235], v[234:235] op_sel:[0,0,0] op_sel_hi:[1,0,0]
  v_pk_fma_f32 v[244:245], v[244:245], v[234:235], v[234:235] op_sel:[0,0,0] op_sel_hi:[1,0,0]
  v_pk_mul_f32 v[196:197], v[196:197], v[246:247]
  v_pk_mul_f32 v[198:199], v[198:199], v[248:249]
  v_pk_mul_f32 v[246:247], v[204:205], v[240:241] op_sel:[0,1] op_sel_hi:[1,1]
  v_pk_mul_f32 v[248:249], v[206:207], v[240:241] op_sel:[0,1] op_sel_hi:[1,1]
  v_pk_mul_f32 v[204:205], v[204:205], v[220:221]
  v_pk_mul_f32 v[206:207], v[206:207], v[222:223]
  v_rcp_f32 v242, v242
  s_add_u32 m0, s79, 90112
  s_add_u32 s92, s92, 262144
  s_add_u32 s93, s92, s91
  v_rcp_f32 v243, v243
  v_rcp_f32 v244, v244
  v_cvt_pk_bf16_f32 v210, v196, v197
  v_cvt_pk_bf16_f32 v211, v198, v199
  buffer_load_dwordx4 v252, s[80:83], s93 offen lds
  buffer_load_dwordx4 v252, s[84:87], s93 offen offset:1024 lds
  s_nop 1
  v_permlane32_swap_b32 v208, v210
  v_permlane32_swap_b32 v209, v211
  buffer_store_dwordx4 v[208:211], v236, s[4:7], s61 offen sc1
  v_exp_f32 v246, v246
  v_exp_f32 v247, v247
  v_exp_f32 v248, v248
  v_exp_f32 v249, v249
  v_rcp_f32 v245, v245
  v_pk_fma_f32 v[246:247], v[246:247], v[234:235], v[234:235] op_sel:[0,1,1] op_sel_hi:[1,1,1]
  v_pk_fma_f32 v[248:249], v[248:249], v[234:235], v[234:235] op_sel:[0,1,1] op_sel_hi:[1,1,1]
  v_pk_mul_f32 v[200:201], v[200:201], v[242:243]
  v_pk_mul_f32 v[202:203], v[202:203], v[244:245]
  v_rcp_f32 v246, v246
  v_rcp_f32 v247, v247
  v_rcp_f32 v248, v248
  v_cvt_pk_bf16_f32 v216, v200, v201
  v_cvt_pk_bf16_f32 v217, v202, v203
  v_rcp_f32 v249, v249
  s_nop 0
  v_pk_mul_f32 v[204:205], v[204:205], v[246:247]
  v_pk_mul_f32 v[206:207], v[206:207], v[248:249]
  v_cvt_pk_bf16_f32 v218, v204, v205
  v_cvt_pk_bf16_f32 v219, v206, v207
  s_nop 1
  v_permlane32_swap_b32 v216, v218
  v_permlane32_swap_b32 v217, v219
  buffer_store_dwordx4 v[216:219], v236, s[4:7], s62 offen sc1
  v_pk_mul_f32 v[32:33], v[250:251], 0 op_sel:[1,0] op_sel_hi:[1,0]
  v_pk_mul_f32 v[34:35], v[250:251], 0 op_sel:[1,0] op_sel_hi:[1,0]
  v_pk_mul_f32 v[36:37], v[250:251], 0 op_sel:[1,0] op_sel_hi:[1,0]
  v_pk_mul_f32 v[38:39], v[250:251], 0 op_sel:[1,0] op_sel_hi:[1,0]
  v_pk_mul_f32 v[40:41], v[250:251], 0 op_sel:[1,0] op_sel_hi:[1,0]
  v_pk_mul_f32 v[42:43], v[250:251], 0 op_sel:[1,0] op_sel_hi:[1,0]
  v_pk_mul_f32 v[44:45], v[250:251], 0 op_sel:[1,0] op_sel_hi:[1,0]
  v_pk_mul_f32 v[46:47], v[250:251], 0 op_sel:[1,0] op_sel_hi:[1,0]
  v_pk_mul_f32 v[48:49], v[250:251], 0 op_sel:[1,0] op_sel_hi:[1,0]
  v_pk_mul_f32 v[50:51], v[250:251], 0 op_sel:[1,0] op_sel_hi:[1,0]
  v_pk_mul_f32 v[52:53], v[250:251], 0 op_sel:[1,0] op_sel_hi:[1,0]
  v_pk_mul_f32 v[54:55], v[250:251], 0 op_sel:[1,0] op_sel_hi:[1,0]
  v_pk_mul_f32 v[56:57], v[250:251], 0 op_sel:[1,0] op_sel_hi:[1,0]
  v_pk_mul_f32 v[58:59], v[250:251], 0 op_sel:[1,0] op_sel_hi:[1,0]
  v_pk_mul_f32 v[60:61], v[250:251], 0 op_sel:[1,0] op_sel_hi:[1,0]
  v_pk_mul_f32 v[62:63], v[250:251], 0 op_sel:[1,0] op_sel_hi:[1,0]
  v_lshlrev_b32 v64, 16, v16
  v_and_b32 v65, 0xffff0000, v16
  v_lshlrev_b32 v66, 16, v17
  v_and_b32 v67, 0xffff0000, v17
  v_lshlrev_b32 v72, 16, v18
  v_and_b32 v73, 0xffff0000, v18
  v_lshlrev_b32 v74, 16, v19
  v_and_b32 v75, 0xffff0000, v19
  v_lshlrev_b32 v80, 16, v20
  v_and_b32 v81, 0xffff0000, v20
  v_lshlrev_b32 v82, 16, v21
  v_and_b32 v83, 0xffff0000, v21
  v_lshlrev_b32 v88, 16, v22
  v_and_b32 v89, 0xffff0000, v22
  v_lshlrev_b32 v90, 16, v23
  v_and_b32 v91, 0xffff0000, v23
  v_lshlrev_b32 v68, 16, v24
  v_and_b32 v69, 0xffff0000, v24
  v_lshlrev_b32 v70, 16, v25
  v_and_b32 v71, 0xffff0000, v25
  v_lshlrev_b32 v76, 16, v26
  v_and_b32 v77, 0xffff0000, v26
  v_lshlrev_b32 v78, 16, v27
  v_and_b32 v79, 0xffff0000, v27
  v_lshlrev_b32 v84, 16, v28
  v_and_b32 v85, 0xffff0000, v28
  v_lshlrev_b32 v86, 16, v29
  v_and_b32 v87, 0xffff0000, v29
  v_lshlrev_b32 v92, 16, v30
  v_and_b32 v93, 0xffff0000, v30
  v_lshlrev_b32 v94, 16, v31
  v_and_b32 v95, 0xffff0000, v31
  s_mov_b32 s56, 2
.p2align 3
Lp4_loop:
  s_waitcnt vmcnt(24) lgkmcnt(8)
  v_mfma_f32_16x16x32_bf16 v[32:35], a[0:3], a[128:131], v[32:35]
  s_waitcnt vmcnt(26)
  s_barrier
  ds_read_b64_tr_b16 a[32:33], v0 offset:1024
  s_add_u32 m0, s79, 98304
  s_add_u32 s92, s92, 196608
  s_cmp_lg_u32 s88, 0
  v_mfma_f32_16x16x32_bf16 v[32:35], a[16:19], a[136:139], v[32:35]
  s_cselect_b32 s93, -2686976, 0
  ds_read_b64_tr_b16 a[34:35], v0 offset:5120
  s_add_u32 s93, s93, s92
  v_mfma_f32_16x16x32_bf16 v[36:39], a[16:19], a[140:143], v[36:39]
  ds_read_b64_tr_b16 a[48:49], v0 offset:9216
  buffer_load_dwordx4 v252, s[80:83], s93 offen lds
  v_mfma_f32_16x16x32_bf16 v[36:39], a[0:3], a[132:135], v[36:39]
  ds_read_b64_tr_b16 a[50:51], v0 offset:13312
  v_mfma_f32_16x16x32_bf16 v[44:47], a[4:7], a[132:135], v[44:47]
  ds_read_b64_tr_b16 a[36:37], v1 offset:1024
  v_mfma_f32_16x16x32_bf16 v[44:47], a[20:23], a[140:143], v[44:47]
  ds_read_b64_tr_b16 a[38:39], v1 offset:5120
  v_mfma_f32_16x16x32_bf16 v[40:43], a[20:23], a[136:139], v[40:43]
  ds_read_b64_tr_b16 a[52:53], v1 offset:9216
  buffer_load_dwordx4 v252, s[84:87], s93 offen offset:1024 lds
  v_mfma_f32_16x16x32_bf16 v[40:43], a[4:7], a[128:131], v[40:43]
  ds_read_b64_tr_b16 a[54:55], v1 offset:13312
  s_waitcnt lgkmcnt(8)
  v_mfma_f32_16x16x32_bf16 v[48:51], a[8:11], a[128:131], v[48:51]
  ds_read_b64_tr_b16 a[40:41], v2 offset:1024
  v_mfma_f32_16x16x32_bf16 v[48:51], a[24:27], a[136:139], v[48:51]
  s_add_u32 s48, s48, 4096
  ds_read_b64_tr_b16 a[42:43], v2 offset:5120
  s_min_u32 s63, s88, 4096
  v_mfma_f32_16x16x32_bf16 v[52:55], a[24:27], a[140:143], v[52:55]
  s_add_u32 s63, s63, s48
  ds_read_b64_tr_b16 a[56:57], v2 offset:9216
  buffer_load_dwordx4 a[192:195], v8, s[4:7], s63 offen offset:0 sc1
  v_mfma_f32_16x16x32_bf16 v[52:55], a[8:11], a[132:135], v[52:55]
  ds_read_b64_tr_b16 a[58:59], v2 offset:13312
  v_mfma_f32_16x16x32_bf16 v[60:63], a[12:15], a[132:135], v[60:63]
  ds_read_b64_tr_b16 a[44:45], v3 offset:1024
  v_mfma_f32_16x16x32_bf16 v[60:63], a[28:31], a[140:143], v[60:63]
  ds_read_b64_tr_b16 a[46:47], v3 offset:5120
  v_mfma_f32_16x16x32_bf16 v[56:59], a[28:31], a[136:139], v[56:59]
  ds_read_b64_tr_b16 a[60:61], v3 offset:9216
  buffer_load_dwordx4 a[196:199], v9, s[4:7], s63 offen offset:0 sc1
  v_mfma_f32_16x16x32_bf16 v[56:59], a[12:15], a[128:131], v[56:59]
  ds_read_b64_tr_b16 a[62:63], v3 offset:13312
  s_waitcnt lgkmcnt(8)
  v_mfma_f32_16x16x32_bf16 v[64:67], a[32:35], a[128:131], v[64:67]
  s_add_u32 m0, s79, 106496
  ds_read_b64_tr_b16 a[0:1], v0 offset:16384
  buffer_load_dword v10, v251, s[4:7], s64 offen sc1
  s_add_u32 s92, s92, 262144
  s_cmp_lg_u32 s89, 0
  v_mfma_f32_16x16x32_bf16 v[64:67], a[48:51], a[136:139], v[64:67]
  s_cselect_b32 s93, -2686976, 0
  ds_read_b64_tr_b16 a[2:3], v0 offset:20480
  s_add_u32 s93, s93, s92
  v_mfma_f32_16x16x32_bf16 v[68:71], a[48:51], a[140:143], v[68:71]
  ds_read_b64_tr_b16 a[16:17], v0 offset:24576
  buffer_load_dwordx4 v252, s[80:83], s93 offen lds
  v_mfma_f32_16x16x32_bf16 v[68:71], a[32:35], a[132:135], v[68:71]
  ds_read_b64_tr_b16 a[18:19], v0 offset:28672
  v_mfma_f32_16x16x32_bf16 v[76:79], a[36:39], a[132:135], v[76:79]
  ds_read_b64_tr_b16 a[4:5], v1 offset:16384
  v_mfma_f32_16x16x32_bf16 v[76:79], a[52:55], a[140:143], v[76:79]
  ds_read_b64_tr_b16 a[6:7], v1 offset:20480
  v_mfma_f32_16x16x32_bf16 v[72:75], a[52:55], a[136:139], v[72:75]
  ds_read_b64_tr_b16 a[20:21], v1 offset:24576
  buffer_load_dwordx4 v252, s[84:87], s93 offen offset:1024 lds
  v_mfma_f32_16x16x32_bf16 v[72:75], a[36:39], a[128:131], v[72:75]
  ds_read_b64_tr_b16 a[22:23], v1 offset:28672
  s_waitcnt lgkmcnt(8)
  v_mfma_f32_16x16x32_bf16 v[80:83], a[40:43], a[128:131], v[80:83]
  ds_read_b64_tr_b16 a[8:9], v2 offset:16384
  v_mfma_f32_16x16x32_bf16 v[80:83], a[56:59], a[136:139], v[80:83]
  s_min_u32 s63, s89, 4096
  ds_read_b64_tr_b16 a[10:11], v2 offset:20480
  s_add_u32 s63, s63, s48
  v_mfma_f32_16x16x32_bf16 v[84:87], a[56:59], a[140:143], v[84:87]
  ds_read_b64_tr_b16 a[24:25], v2 offset:24576
  buffer_load_dwordx4 a[200:203], v8, s[4:7], s63 offen offset:1024 sc1
  v_mfma_f32_16x16x32_bf16 v[84:87], a[40:43], a[132:135], v[84:87]
  ds_read_b64_tr_b16 a[26:27], v2 offset:28672
  v_mfma_f32_16x16x32_bf16 v[92:95], a[44:47], a[132:135], v[92:95]
  ds_read_b64_tr_b16 a[12:13], v3 offset:16384
  v_mfma_f32_16x16x32_bf16 v[92:95], a[60:63], a[140:143], v[92:95]
  ds_read_b64_tr_b16 a[14:15], v3 offset:20480
  v_mfma_f32_16x16x32_bf16 v[88:91], a[60:63], a[136:139], v[88:91]
  ds_read_b64_tr_b16 a[28:29], v3 offset:24576
  buffer_load_dwordx4 a[204:207], v9, s[4:7], s63 offen offset:1024 sc1
  v_mfma_f32_16x16x32_bf16 v[88:91], a[44:47], a[128:131], v[88:91]
  ds_read_b64_tr_b16 a[30:31], v3 offset:28672
  s_waitcnt vmcnt(25) lgkmcnt(8)
  v_mfma_f32_16x16x32_bf16 v[32:35], a[0:3], a[144:147], v[32:35]
  s_add_u32 m0, s79, 114688
  ds_read_b64_tr_b16 a[32:33], v0 offset:17408
  s_add_u32 s92, s92, 196608
  s_cmp_lg_u32 s90, 0
  v_mfma_f32_16x16x32_bf16 v[32:35], a[16:19], a[152:155], v[32:35]
  s_cselect_b32 s93, -2686976, 0
  ds_read_b64_tr_b16 a[34:35], v0 offset:21504
  s_add_u32 s93, s93, s92
  v_mfma_f32_16x16x32_bf16 v[36:39], a[16:19], a[156:159], v[36:39]
  ds_read_b64_tr_b16 a[48:49], v0 offset:25600
  buffer_load_dwordx4 v252, s[80:83], s93 offen lds
  v_mfma_f32_16x16x32_bf16 v[36:39], a[0:3], a[148:151], v[36:39]
  ds_read_b64_tr_b16 a[50:51], v0 offset:29696
  v_mfma_f32_16x16x32_bf16 v[44:47], a[4:7], a[148:151], v[44:47]
  ds_read_b64_tr_b16 a[36:37], v1 offset:17408
  v_mfma_f32_16x16x32_bf16 v[44:47], a[20:23], a[156:159], v[44:47]
  ds_read_b64_tr_b16 a[38:39], v1 offset:21504
  v_mfma_f32_16x16x32_bf16 v[40:43], a[20:23], a[152:155], v[40:43]
  ds_read_b64_tr_b16 a[52:53], v1 offset:25600
  buffer_load_dwordx4 v252, s[84:87], s93 offen offset:1024 lds
  v_mfma_f32_16x16x32_bf16 v[40:43], a[4:7], a[144:147], v[40:43]
  ds_read_b64_tr_b16 a[54:55], v1 offset:29696
  s_waitcnt lgkmcnt(8)
  v_mfma_f32_16x16x32_bf16 v[48:51], a[8:11], a[144:147], v[48:51]
  ds_read_b64_tr_b16 a[40:41], v2 offset:17408
  v_mfma_f32_16x16x32_bf16 v[48:51], a[24:27], a[152:155], v[48:51]
  s_min_u32 s63, s90, 4096
  ds_read_b64_tr_b16 a[42:43], v2 offset:21504
  s_add_u32 s63, s63, s48
  v_mfma_f32_16x16x32_bf16 v[52:55], a[24:27], a[156:159], v[52:55]
  ds_read_b64_tr_b16 a[56:57], v2 offset:25600
  buffer_load_dwordx4 a[208:211], v8, s[4:7], s63 offen offset:2048 sc1
  v_mfma_f32_16x16x32_bf16 v[52:55], a[8:11], a[148:151], v[52:55]
  ds_read_b64_tr_b16 a[58:59], v2 offset:29696
  v_mfma_f32_16x16x32_bf16 v[60:63], a[12:15], a[148:151], v[60:63]
  ds_read_b64_tr_b16 a[44:45], v3 offset:17408
  v_mfma_f32_16x16x32_bf16 v[60:63], a[28:31], a[156:159], v[60:63]
  ds_read_b64_tr_b16 a[46:47], v3 offset:21504
  v_mfma_f32_16x16x32_bf16 v[56:59], a[28:31], a[152:155], v[56:59]
  ds_read_b64_tr_b16 a[60:61], v3 offset:25600
  buffer_load_dwordx4 a[212:215], v9, s[4:7], s63 offen offset:2048 sc1
  v_mfma_f32_16x16x32_bf16 v[56:59], a[12:15], a[144:147], v[56:59]
  ds_read_b64_tr_b16 a[62:63], v3 offset:29696
  s_waitcnt lgkmcnt(8)
  v_mfma_f32_16x16x32_bf16 v[64:67], a[32:35], a[144:147], v[64:67]
  s_add_u32 m0, s79, 122880
  ds_read_b64_tr_b16 a[0:1], v0 offset:32768
  s_add_u32 s92, s92, 262144
  s_cmp_lg_u32 s91, 0
  v_mfma_f32_16x16x32_bf16 v[64:67], a[48:51], a[152:155], v[64:67]
  s_cselect_b32 s93, -2686976, 0
  ds_read_b64_tr_b16 a[2:3], v0 offset:36864
  s_add_u32 s93, s93, s92
  v_mfma_f32_16x16x32_bf16 v[68:71], a[48:51], a[156:159], v[68:71]
  ds_read_b64_tr_b16 a[16:17], v0 offset:40960
  buffer_load_dwordx4 v252, s[80:83], s93 offen lds
  v_mfma_f32_16x16x32_bf16 v[68:71], a[32:35], a[148:151], v[68:71]
  ds_read_b64_tr_b16 a[18:19], v0 offset:45056
  v_mfma_f32_16x16x32_bf16 v[76:79], a[36:39], a[148:151], v[76:79]
  ds_read_b64_tr_b16 a[4:5], v1 offset:32768
  v_mfma_f32_16x16x32_bf16 v[76:79], a[52:55], a[156:159], v[76:79]
  ds_read_b64_tr_b16 a[6:7], v1 offset:36864
  v_mfma_f32_16x16x32_bf16 v[72:75], a[52:55], a[152:155], v[72:75]
  ds_read_b64_tr_b16 a[20:21], v1 offset:40960
  buffer_load_dwordx4 v252, s[84:87], s93 offen offset:1024 lds
  v_mfma_f32_16x16x32_bf16 v[72:75], a[36:39], a[144:147], v[72:75]
  ds_read_b64_tr_b16 a[22:23], v1 offset:45056
  s_waitcnt lgkmcnt(8)
  v_mfma_f32_16x16x32_bf16 v[80:83], a[40:43], a[144:147], v[80:83]
  ds_read_b64_tr_b16 a[8:9], v2 offset:32768
  v_mfma_f32_16x16x32_bf16 v[80:83], a[56:59], a[152:155], v[80:83]
  s_min_u32 s63, s91, 4096
  ds_read_b64_tr_b16 a[10:11], v2 offset:36864
  s_add_u32 s63, s63, s48
  v_mfma_f32_16x16x32_bf16 v[84:87], a[56:59], a[156:159], v[84:87]
  ds_read_b64_tr_b16 a[24:25], v2 offset:40960
  buffer_load_dwordx4 a[216:219], v8, s[4:7], s63 offen offset:3072 sc1
  v_mfma_f32_16x16x32_bf16 v[84:87], a[40:43], a[148:151], v[84:87]
  ds_read_b64_tr_b16 a[26:27], v2 offset:45056
  v_mfma_f32_16x16x32_bf16 v[92:95], a[44:47], a[148:151], v[92:95]
  ds_read_b64_tr_b16 a[12:13], v3 offset:32768
  v_mfma_f32_16x16x32_bf16 v[92:95], a[60:63], a[156:159], v[92:95]
  ds_read_b64_tr_b16 a[14:15], v3 offset:36864
  v_mfma_f32_16x16x32_bf16 v[88:91], a[60:63], a[152:155], v[88:91]
  ds_read_b64_tr_b16 a[28:29], v3 offset:40960
  buffer_load_dwordx4 a[220:223], v9, s[4:7], s63 offen offset:3072 sc1
  v_mfma_f32_16x16x32_bf16 v[88:91], a[44:47], a[144:147], v[88:91]
  ds_read_b64_tr_b16 a[30:31], v3 offset:45056
  s_waitcnt vmcnt(25) lgkmcnt(8)
  v_mfma_f32_16x16x32_bf16 v[32:35], a[0:3], a[160:163], v[32:35]
  s_waitcnt vmcnt(24)
  s_barrier
  ds_read_b64_tr_b16 a[32:33], v0 offset:33792
  s_waitcnt vmcnt(12)
  v_cmp_gt_u32 vcc, 16, v10
  s_cbranch_vccz Lp4b_ok
  s_mov_b32 s43, 0x40000
Lp4b_sp:
  s_sleep 10
  buffer_load_dword v10, v251, s[4:7], s64 offen sc1
  s_waitcnt vmcnt(0)
  v_cmp_gt_u32 vcc, 16, v10
  s_cbranch_vccz Lp4b_ok
  s_sub_u32 s43, s43, 1
  s_cmp_lg_u32 s43, 0
  s_cbranch_scc1 Lp4b_sp
Lp4b_ok:
  s_add_u32 s64, s64, 4096
  v_mfma_f32_16x16x32_bf16 v[32:35], a[16:19], a[168:171], v[32:35]
  s_add_u32 m0, s79, 0
  ds_read_b64_tr_b16 a[34:35], v0 offset:37888
  s_add_u32 s92, s92, -3407872
  v_mfma_f32_16x16x32_bf16 v[36:39], a[16:19], a[172:175], v[36:39]
  s_add_u32 s93, s92, s88
  ds_read_b64_tr_b16 a[48:49], v0 offset:41984
  buffer_load_dwordx4 v252, s[80:83], s93 offen lds
  v_mfma_f32_16x16x32_bf16 v[36:39], a[0:3], a[164:167], v[36:39]
  ds_read_b64_tr_b16 a[50:51], v0 offset:46080
  v_mfma_f32_16x16x32_bf16 v[44:47], a[4:7], a[164:167], v[44:47]
  ds_read_b64_tr_b16 a[36:37], v1 offset:33792
  v_mfma_f32_16x16x32_bf16 v[44:47], a[20:23], a[172:175], v[44:47]
  ds_read_b64_tr_b16 a[38:39], v1 offset:37888
  v_mfma_f32_16x16x32_bf16 v[40:43], a[20:23], a[168:171], v[40:43]
  ds_read_b64_tr_b16 a[52:53], v1 offset:41984
  buffer_load_dwordx4 v252, s[84:87], s93 offen offset:1024 lds
  v_mfma_f32_16x16x32_bf16 v[40:43], a[4:7], a[160:163], v[40:43]
  ds_read_b64_tr_b16 a[54:55], v1 offset:46080
  s_waitcnt lgkmcnt(8)
  v_mfma_f32_16x16x32_bf16 v[48:51], a[8:11], a[160:163], v[48:51]
  ds_read_b64_tr_b16 a[40:41], v2 offset:33792
  v_mfma_f32_16x16x32_bf16 v[48:51], a[24:27], a[168:171], v[48:51]
  s_add_u32 s48, s48, 4096
  ds_read_b64_tr_b16 a[42:43], v2 offset:37888
  s_min_u32 s63, s88, 4096
  v_mfma_f32_16x16x32_bf16 v[52:55], a[24:27], a[172:175], v[52:55]
  s_add_u32 s63, s63, s48
  ds_read_b64_tr_b16 a[56:57], v2 offset:41984
  buffer_load_dwordx4 a[224:227], v8, s[4:7], s63 offen offset:0 sc1
  v_mfma_f32_16x16x32_bf16 v[52:55], a[8:11], a[164:167], v[52:55]
  ds_read_b64_tr_b16 a[58:59], v2 offset:46080
  v_mfma_f32_16x16x32_bf16 v[60:63], a[12:15], a[164:167], v[60:63]
  ds_read_b64_tr_b16 a[44:45], v3 offset:33792
  v_mfma_f32_16x16x32_bf16 v[60:63], a[28:31], a[172:175], v[60:63]
  ds_read_b64_tr_b16 a[46:47], v3 offset:37888
  v_mfma_f32_16x16x32_bf16 v[56:59], a[28:31], a[168:171], v[56:59]
  ds_read_b64_tr_b16 a[60:61], v3 offset:41984
  buffer_load_dwordx4 a[228:231], v9, s[4:7], s63 offen offset:0 sc1
  v_mfma_f32_16x16x32_bf16 v[56:59], a[12:15], a[160:163], v[56:59]
  ds_read_b64_tr_b16 a[62:63], v3 offset:46080
  s_waitcnt lgkmcnt(8)
  v_mfma_f32_16x16x32_bf16 v[64:67], a[32:35], a[160:163], v[64:67]
  ds_read_b64_tr_b16 a[0:1], v0 offset:49152
  s_add_u32 m0, s79, 8192
  v_mfma_f32_16x16x32_bf16 v[64:67], a[48:51], a[168:171], v[64:67]
  s_add_u32 s92, s92, 262144
  ds_read_b64_tr_b16 a[2:3], v0 offset:53248
  s_add_u32 s93, s92, s89
  v_mfma_f32_16x16x32_bf16 v[68:71], a[48:51], a[172:175], v[68:71]
  ds_read_b64_tr_b16 a[16:17], v0 offset:57344
  buffer_load_dwordx4 v252, s[80:83], s93 offen lds
  v_mfma_f32_16x16x32_bf16 v[68:71], a[32:35], a[164:167], v[68:71]
  ds_read_b64_tr_b16 a[18:19], v0 offset:61440
  v_mfma_f32_16x16x32_bf16 v[76:79], a[36:39], a[164:167], v[76:79]
  ds_read_b64_tr_b16 a[4:5], v1 offset:49152
  v_mfma_f32_16x16x32_bf16 v[76:79], a[52:55], a[172:175], v[76:79]
  ds_read_b64_tr_b16 a[6:7], v1 offset:53248
  v_mfma_f32_16x16x32_bf16 v[72:75], a[52:55], a[168:171], v[72:75]
  ds_read_b64_tr_b16 a[20:21], v1 offset:57344
  buffer_load_dwordx4 v252, s[84:87], s93 offen offset:1024 lds
  v_mfma_f32_16x16x32_bf16 v[72:75], a[36:39], a[160:163], v[72:75]
  ds_read_b64_tr_b16 a[22:23], v1 offset:61440
  s_waitcnt lgkmcnt(8)
  v_mfma_f32_16x16x32_bf16 v[80:83], a[40:43], a[160:163], v[80:83]
  ds_read_b64_tr_b16 a[8:9], v2 offset:49152
  v_mfma_f32_16x16x32_bf16 v[80:83], a[56:59], a[168:171], v[80:83]
  s_min_u32 s63, s89, 4096
  ds_read_b64_tr_b16 a[10:11], v2 offset:53248
  s_add_u32 s63, s63, s48
  v_mfma_f32_16x16x32_bf16 v[84:87], a[56:59], a[172:175], v[84:87]
  ds_read_b64_tr_b16 a[24:25], v2 offset:57344
  buffer_load_dwordx4 a[232:235], v8, s[4:7], s63 offen offset:1024 sc1
  v_mfma_f32_16x16x32_bf16 v[84:87], a[40:43], a[164:167], v[84:87]
  ds_read_b64_tr_b16 a[26:27], v2 offset:61440
  v_mfma_f32_16x16x32_bf16 v[92:95], a[44:47], a[164:167], v[92:95]
  ds_read_b64_tr_b16 a[12:13], v3 offset:49152
  v_mfma_f32_16x16x32_bf16 v[92:95], a[60:63], a[172:175], v[92:95]
  ds_read_b64_tr_b16 a[14:15], v3 offset:53248
  v_mfma_f32_16x16x32_bf16 v[88:91], a[60:63], a[168:171], v[88:91]
  ds_read_b64_tr_b16 a[28:29], v3 offset:57344
  buffer_load_dwordx4 a[236:239], v9, s[4:7], s63 offen offset:1024 sc1
  v_mfma_f32_16x16x32_bf16 v[88:91], a[44:47], a[160:163], v[88:91]
  ds_read_b64_tr_b16 a[30:31], v3 offset:61440
  s_waitcnt vmcnt(25) lgkmcnt(8)
  v_mfma_f32_16x16x32_bf16 v[32:35], a[0:3], a[176:179], v[32:35]
  ds_read_b64_tr_b16 a[32:33], v0 offset:50176
  s_add_u32 m0, s79, 16384
  v_mfma_f32_16x16x32_bf16 v[32:35], a[16:19], a[184:187], v[32:35]
  s_add_u32 s92, s92, 196608
  ds_read_b64_tr_b16 a[34:35], v0 offset:54272
  s_add_u32 s93, s92, s90
  v_mfma_f32_16x16x32_bf16 v[36:39], a[16:19], a[188:191], v[36:39]
  ds_read_b64_tr_b16 a[48:49], v0 offset:58368
  buffer_load_dwordx4 v252, s[80:83], s93 offen lds
  v_mfma_f32_16x16x32_bf16 v[36:39], a[0:3], a[180:183], v[36:39]
  ds_read_b64_tr_b16 a[50:51], v0 offset:62464
  v_mfma_f32_16x16x32_bf16 v[44:47], a[4:7], a[180:183], v[44:47]
  ds_read_b64_tr_b16 a[36:37], v1 offset:50176
  v_mfma_f32_16x16x32_bf16 v[44:47], a[20:23], a[188:191], v[44:47]
  ds_read_b64_tr_b16 a[38:39], v1 offset:54272
  v_mfma_f32_16x16x32_bf16 v[40:43], a[20:23], a[184:187], v[40:43]
  ds_read_b64_tr_b16 a[52:53], v1 offset:58368
  buffer_load_dwordx4 v252, s[84:87], s93 offen offset:1024 lds
  v_mfma_f32_16x16x32_bf16 v[40:43], a[4:7], a[176:179], v[40:43]
  ds_read_b64_tr_b16 a[54:55], v1 offset:62464
  s_waitcnt lgkmcnt(8)
  v_mfma_f32_16x16x32_bf16 v[48:51], a[8:11], a[176:179], v[48:51]
  ds_read_b64_tr_b16 a[40:41], v2 offset:50176
  v_mfma_f32_16x16x32_bf16 v[48:51], a[24:27], a[184:187], v[48:51]
  s_min_u32 s63, s90, 4096
  ds_read_b64_tr_b16 a[42:43], v2 offset:54272
  s_add_u32 s63, s63, s48
  v_mfma_f32_16x16x32_bf16 v[52:55], a[24:27], a[188:191], v[52:55]
  ds_read_b64_tr_b16 a[56:57], v2 offset:58368
  buffer_load_dwordx4 a[240:243], v8, s[4:7], s63 offen offset:2048 sc1
  v_mfma_f32_16x16x32_bf16 v[52:55], a[8:11], a[180:183], v[52:55]
  ds_read_b64_tr_b16 a[58:59], v2 offset:62464
  v_mfma_f32_16x16x32_bf16 v[60:63], a[12:15], a[180:183], v[60:63]
  ds_read_b64_tr_b16 a[44:45], v3 offset:50176
  v_mfma_f32_16x16x32_bf16 v[60:63], a[28:31], a[188:191], v[60:63]
  ds_read_b64_tr_b16 a[46:47], v3 offset:54272
  v_mfma_f32_16x16x32_bf16 v[56:59], a[28:31], a[184:187], v[56:59]
  ds_read_b64_tr_b16 a[60:61], v3 offset:58368
  buffer_load_dwordx4 a[244:247], v9, s[4:7], s63 offen offset:2048 sc1
  v_mfma_f32_16x16x32_bf16 v[56:59], a[12:15], a[176:179], v[56:59]
  ds_read_b64_tr_b16 a[62:63], v3 offset:62464
  s_waitcnt lgkmcnt(8)
  v_mfma_f32_16x16x32_bf16 v[64:67], a[32:35], a[176:179], v[64:67]
  ds_read_b64_tr_b16 a[0:1], v4 offset:0
  s_add_u32 m0, s79, 24576
  v_mfma_f32_16x16x32_bf16 v[64:67], a[48:51], a[184:187], v[64:67]
  s_add_u32 s92, s92, 262144
  ds_read_b64_tr_b16 a[2:3], v4 offset:4096
  s_add_u32 s93, s92, s91
  v_mfma_f32_16x16x32_bf16 v[68:71], a[48:51], a[188:191], v[68:71]
  ds_read_b64_tr_b16 a[16:17], v4 offset:8192
  buffer_load_dwordx4 v252, s[80:83], s93 offen lds
  v_mfma_f32_16x16x32_bf16 v[68:71], a[32:35], a[180:183], v[68:71]
  ds_read_b64_tr_b16 a[18:19], v4 offset:12288
  v_mfma_f32_16x16x32_bf16 v[76:79], a[36:39], a[180:183], v[76:79]
  ds_read_b64_tr_b16 a[4:5], v5 offset:0
  v_mfma_f32_16x16x32_bf16 v[76:79], a[52:55], a[188:191], v[76:79]
  ds_read_b64_tr_b16 a[6:7], v5 offset:4096
  v_mfma_f32_16x16x32_bf16 v[72:75], a[52:55], a[184:187], v[72:75]
  ds_read_b64_tr_b16 a[20:21], v5 offset:8192
  buffer_load_dwordx4 v252, s[84:87], s93 offen offset:1024 lds
  v_mfma_f32_16x16x32_bf16 v[72:75], a[36:39], a[176:179], v[72:75]
  ds_read_b64_tr_b16 a[22:23], v5 offset:12288
  s_waitcnt lgkmcnt(8)
  v_mfma_f32_16x16x32_bf16 v[80:83], a[40:43], a[176:179], v[80:83]
  ds_read_b64_tr_b16 a[8:9], v6 offset:0
  v_mfma_f32_16x16x32_bf16 v[80:83], a[56:59], a[184:187], v[80:83]
  s_min_u32 s63, s91, 4096
  ds_read_b64_tr_b16 a[10:11], v6 offset:4096
  s_add_u32 s63, s63, s48
  v_mfma_f32_16x16x32_bf16 v[84:87], a[56:59], a[188:191], v[84:87]
  ds_read_b64_tr_b16 a[24:25], v6 offset:8192
  buffer_load_dwordx4 a[248:251], v8, s[4:7], s63 offen offset:3072 sc1
  v_mfma_f32_16x16x32_bf16 v[84:87], a[40:43], a[180:183], v[84:87]
  ds_read_b64_tr_b16 a[26:27], v6 offset:12288
  v_mfma_f32_16x16x32_bf16 v[92:95], a[44:47], a[180:183], v[92:95]
  ds_read_b64_tr_b16 a[12:13], v7 offset:0
  v_mfma_f32_16x16x32_bf16 v[92:95], a[60:63], a[188:191], v[92:95]
  ds_read_b64_tr_b16 a[14:15], v7 offset:4096
  v_mfma_f32_16x16x32_bf16 v[88:91], a[60:63], a[184:187], v[88:91]
  ds_read_b64_tr_b16 a[28:29], v7 offset:8192
  buffer_load_dwordx4 a[252:255], v9, s[4:7], s63 offen offset:3072 sc1
  v_mfma_f32_16x16x32_bf16 v[88:91], a[44:47], a[176:179], v[88:91]
  ds_read_b64_tr_b16 a[30:31], v7 offset:12288
  s_waitcnt vmcnt(24) lgkmcnt(8)
  v_mfma_f32_16x16x32_bf16 v[32:35], a[0:3], a[192:195], v[32:35]
  s_waitcnt vmcnt(26)
  s_barrier
  s_xor_b32 s43, s56, 2
  s_or_b32 s43, s43, s40
  s_cbranch_scc1 Lp3_sgl
  v_mov_b32 v250, 1
  s_mov_b64 exec, 1
  buffer_atomic_add v250, v251, s[4:7], s77 offen sc1
  s_mov_b64 exec, -1
Lp3_sgl:
  ds_read_b64_tr_b16 a[32:33], v4 offset:1024
  v_mfma_f32_16x16x32_bf16 v[32:35], a[16:19], a[200:203], v[32:35]
  s_add_u32 m0, s79, 32768
  ds_read_b64_tr_b16 a[34:35], v4 offset:5120
  s_add_u32 s92, s92, 196608
  v_mfma_f32_16x16x32_bf16 v[36:39], a[16:19], a[204:207], v[36:39]
  s_add_u32 s93, s92, s88
  ds_read_b64_tr_b16 a[48:49], v4 offset:9216
  buffer_load_dwordx4 v252, s[80:83], s93 offen lds
  v_mfma_f32_16x16x32_bf16 v[36:39], a[0:3], a[196:199], v[36:39]
  ds_read_b64_tr_b16 a[50:51], v4 offset:13312
  v_mfma_f32_16x16x32_bf16 v[44:47], a[4:7], a[196:199], v[44:47]
  ds_read_b64_tr_b16 a[36:37], v5 offset:1024
  v_mfma_f32_16x16x32_bf16 v[44:47], a[20:23], a[204:207], v[44:47]
  ds_read_b64_tr_b16 a[38:39], v5 offset:5120
  v_mfma_f32_16x16x32_bf16 v[40:43], a[20:23], a[200:203], v[40:43]
  ds_read_b64_tr_b16 a[52:53], v5 offset:9216
  buffer_load_dwordx4 v252, s[84:87], s93 offen offset:1024 lds
  v_mfma_f32_16x16x32_bf16 v[40:43], a[4:7], a[192:195], v[40:43]
  ds_read_b64_tr_b16 a[54:55], v5 offset:13312
  s_waitcnt lgkmcnt(8)
  v_mfma_f32_16x16x32_bf16 v[48:51], a[8:11], a[192:195], v[48:51]
  ds_read_b64_tr_b16 a[40:41], v6 offset:1024
  v_mfma_f32_16x16x32_bf16 v[48:51], a[24:27], a[200:203], v[48:51]
  s_add_u32 s48, s48, 4096
  ds_read_b64_tr_b16 a[42:43], v6 offset:5120
  s_min_u32 s63, s88, 4096
  v_mfma_f32_16x16x32_bf16 v[52:55], a[24:27], a[204:207], v[52:55]
  s_add_u32 s63, s63, s48
  ds_read_b64_tr_b16 a[56:57], v6 offset:9216
  buffer_load_dwordx4 a[128:131], v8, s[4:7], s63 offen offset:0 sc1
  v_mfma_f32_16x16x32_bf16 v[52:55], a[8:11], a[196:199], v[52:55]
  ds_read_b64_tr_b16 a[58:59], v6 offset:13312
  v_mfma_f32_16x16x32_bf16 v[60:63], a[12:15], a[196:199], v[60:63]
  ds_read_b64_tr_b16 a[44:45], v7 offset:1024
  v_mfma_f32_16x16x32_bf16 v[60:63], a[28:31], a[204:207], v[60:63]
  ds_read_b64_tr_b16 a[46:47], v7 offset:5120
  v_mfma_f32_16x16x32_bf16 v[56:59], a[28:31], a[200:203], v[56:59]
  ds_read_b64_tr_b16 a[60:61], v7 offset:9216
  buffer_load_dwordx4 a[132:135], v9, s[4:7], s63 offen offset:0 sc1
  v_mfma_f32_16x16x32_bf16 v[56:59], a[12:15], a[192:195], v[56:59]
  ds_read_b64_tr_b16 a[62:63], v7 offset:13312
  s_waitcnt lgkmcnt(8)
  v_mfma_f32_16x16x32_bf16 v[64:67], a[32:35], a[192:195], v[64:67]
  ds_read_b64_tr_b16 a[0:1], v4 offset:16384
  s_add_u32 m0, s79, 40960
  v_mfma_f32_16x16x32_bf16 v[64:67], a[48:51], a[200:203], v[64:67]
  s_add_u32 s92, s92, 262144
  ds_read_b64_tr_b16 a[2:3], v4 offset:20480
  s_add_u32 s93, s92, s89
  v_mfma_f32_16x16x32_bf16 v[68:71], a[48:51], a[204:207], v[68:71]
  ds_read_b64_tr_b16 a[16:17], v4 offset:24576
  buffer_load_dwordx4 v252, s[80:83], s93 offen lds
  v_mfma_f32_16x16x32_bf16 v[68:71], a[32:35], a[196:199], v[68:71]
  ds_read_b64_tr_b16 a[18:19], v4 offset:28672
  v_mfma_f32_16x16x32_bf16 v[76:79], a[36:39], a[196:199], v[76:79]
  ds_read_b64_tr_b16 a[4:5], v5 offset:16384
  v_mfma_f32_16x16x32_bf16 v[76:79], a[52:55], a[204:207], v[76:79]
  ds_read_b64_tr_b16 a[6:7], v5 offset:20480
  v_mfma_f32_16x16x32_bf16 v[72:75], a[52:55], a[200:203], v[72:75]
  ds_read_b64_tr_b16 a[20:21], v5 offset:24576
  buffer_load_dwordx4 v252, s[84:87], s93 offen offset:1024 lds
  v_mfma_f32_16x16x32_bf16 v[72:75], a[36:39], a[192:195], v[72:75]
  ds_read_b64_tr_b16 a[22:23], v5 offset:28672
  s_waitcnt lgkmcnt(8)
  v_mfma_f32_16x16x32_bf16 v[80:83], a[40:43], a[192:195], v[80:83]
  ds_read_b64_tr_b16 a[8:9], v6 offset:16384
  v_mfma_f32_16x16x32_bf16 v[80:83], a[56:59], a[200:203], v[80:83]
  s_min_u32 s63, s89, 4096
  ds_read_b64_tr_b16 a[10:11], v6 offset:20480
  s_add_u32 s63, s63, s48
  v_mfma_f32_16x16x32_bf16 v[84:87], a[56:59], a[204:207], v[84:87]
  ds_read_b64_tr_b16 a[24:25], v6 offset:24576
  buffer_load_dwordx4 a[136:139], v8, s[4:7], s63 offen offset:1024 sc1
  v_mfma_f32_16x16x32_bf16 v[84:87], a[40:43], a[196:199], v[84:87]
  ds_read_b64_tr_b16 a[26:27], v6 offset:28672
  v_mfma_f32_16x16x32_bf16 v[92:95], a[44:47], a[196:199], v[92:95]
  ds_read_b64_tr_b16 a[12:13], v7 offset:16384
  v_mfma_f32_16x16x32_bf16 v[92:95], a[60:63], a[204:207], v[92:95]
  ds_read_b64_tr_b16 a[14:15], v7 offset:20480
  v_mfma_f32_16x16x32_bf16 v[88:91], a[60:63], a[200:203], v[88:91]
  ds_read_b64_tr_b16 a[28:29], v7 offset:24576
  buffer_load_dwordx4 a[140:143], v9, s[4:7], s63 offen offset:1024 sc1
  v_mfma_f32_16x16x32_bf16 v[88:91], a[44:47], a[192:195], v[88:91]
  ds_read_b64_tr_b16 a[30:31], v7 offset:28672
  s_waitcnt vmcnt(24) lgkmcnt(8)
  v_mfma_f32_16x16x32_bf16 v[32:35], a[0:3], a[208:211], v[32:35]
  ds_read_b64_tr_b16 a[32:33], v4 offset:17408
  s_add_u32 m0, s79, 49152
  v_mfma_f32_16x16x32_bf16 v[32:35], a[16:19], a[216:219], v[32:35]
  s_add_u32 s92, s92, 196608
  ds_read_b64_tr_b16 a[34:35], v4 offset:21504
  s_add_u32 s93, s92, s90
  v_mfma_f32_16x16x32_bf16 v[36:39], a[16:19], a[220:223], v[36:39]
  ds_read_b64_tr_b16 a[48:49], v4 offset:25600
  buffer_load_dwordx4 v252, s[80:83], s93 offen lds
  v_mfma_f32_16x16x32_bf16 v[36:39], a[0:3], a[212:215], v[36:39]
  ds_read_b64_tr_b16 a[50:51], v4 offset:29696
  v_mfma_f32_16x16x32_bf16 v[44:47], a[4:7], a[212:215], v[44:47]
  ds_read_b64_tr_b16 a[36:37], v5 offset:17408
  v_mfma_f32_16x16x32_bf16 v[44:47], a[20:23], a[220:223], v[44:47]
  ds_read_b64_tr_b16 a[38:39], v5 offset:21504
  v_mfma_f32_16x16x32_bf16 v[40:43], a[20:23], a[216:219], v[40:43]
  ds_read_b64_tr_b16 a[52:53], v5 offset:25600
  buffer_load_dwordx4 v252, s[84:87], s93 offen offset:1024 lds
  v_mfma_f32_16x16x32_bf16 v[40:43], a[4:7], a[208:211], v[40:43]
  ds_read_b64_tr_b16 a[54:55], v5 offset:29696
  s_waitcnt lgkmcnt(8)
  v_mfma_f32_16x16x32_bf16 v[48:51], a[8:11], a[208:211], v[48:51]
  ds_read_b64_tr_b16 a[40:41], v6 offset:17408
  v_mfma_f32_16x16x32_bf16 v[48:51], a[24:27], a[216:219], v[48:51]
  s_min_u32 s63, s90, 4096
  ds_read_b64_tr_b16 a[42:43], v6 offset:21504
  s_add_u32 s63, s63, s48
  v_mfma_f32_16x16x32_bf16 v[52:55], a[24:27], a[220:223], v[52:55]
  ds_read_b64_tr_b16 a[56:57], v6 offset:25600
  buffer_load_dwordx4 a[144:147], v8, s[4:7], s63 offen offset:2048 sc1
  v_mfma_f32_16x16x32_bf16 v[52:55], a[8:11], a[212:215], v[52:55]
  ds_read_b64_tr_b16 a[58:59], v6 offset:29696
  v_mfma_f32_16x16x32_bf16 v[60:63], a[12:15], a[212:215], v[60:63]
  ds_read_b64_tr_b16 a[44:45], v7 offset:17408
  v_mfma_f32_16x16x32_bf16 v[60:63], a[28:31], a[220:223], v[60:63]
  ds_read_b64_tr_b16 a[46:47], v7 offset:21504
  v_mfma_f32_16x16x32_bf16 v[56:59], a[28:31], a[216:219], v[56:59]
  ds_read_b64_tr_b16 a[60:61], v7 offset:25600
  buffer_load_dwordx4 a[148:151], v9, s[4:7], s63 offen offset:2048 sc1
  v_mfma_f32_16x16x32_bf16 v[56:59], a[12:15], a[208:211], v[56:59]
  ds_read_b64_tr_b16 a[62:63], v7 offset:29696
  s_waitcnt lgkmcnt(8)
  v_mfma_f32_16x16x32_bf16 v[64:67], a[32:35], a[208:211], v[64:67]
  ds_read_b64_tr_b16 a[0:1], v4 offset:32768
  s_add_u32 m0, s79, 57344
  v_mfma_f32_16x16x32_bf16 v[64:67], a[48:51], a[216:219], v[64:67]
  s_add_u32 s92, s92, 262144
  ds_read_b64_tr_b16 a[2:3], v4 offset:36864
  s_add_u32 s93, s92, s91
  v_mfma_f32_16x16x32_bf16 v[68:71], a[48:51], a[220:223], v[68:71]
  ds_read_b64_tr_b16 a[16:17], v4 offset:40960
  buffer_load_dwordx4 v252, s[80:83], s93 offen lds
  v_mfma_f32_16x16x32_bf16 v[68:71], a[32:35], a[212:215], v[68:71]
  ds_read_b64_tr_b16 a[18:19], v4 offset:45056
  v_mfma_f32_16x16x32_bf16 v[76:79], a[36:39], a[212:215], v[76:79]
  ds_read_b64_tr_b16 a[4:5], v5 offset:32768
  v_mfma_f32_16x16x32_bf16 v[76:79], a[52:55], a[220:223], v[76:79]
  ds_read_b64_tr_b16 a[6:7], v5 offset:36864
  v_mfma_f32_16x16x32_bf16 v[72:75], a[52:55], a[216:219], v[72:75]
  ds_read_b64_tr_b16 a[20:21], v5 offset:40960
  buffer_load_dwordx4 v252, s[84:87], s93 offen offset:1024 lds
  v_mfma_f32_16x16x32_bf16 v[72:75], a[36:39], a[208:211], v[72:75]
  ds_read_b64_tr_b16 a[22:23], v5 offset:45056
  s_waitcnt lgkmcnt(8)
  v_mfma_f32_16x16x32_bf16 v[80:83], a[40:43], a[208:211], v[80:83]
  ds_read_b64_tr_b16 a[8:9], v6 offset:32768
  v_mfma_f32_16x16x32_bf16 v[80:83], a[56:59], a[216:219], v[80:83]
  s_min_u32 s63, s91, 4096
  ds_read_b64_tr_b16 a[10:11], v6 offset:36864
  s_add_u32 s63, s63, s48
  v_mfma_f32_16x16x32_bf16 v[84:87], a[56:59], a[220:223], v[84:87]
  ds_read_b64_tr_b16 a[24:25], v6 offset:40960
  buffer_load_dwordx4 a[152:155], v8, s[4:7], s63 offen offset:3072 sc1
  v_mfma_f32_16x16x32_bf16 v[84:87], a[40:43], a[212:215], v[84:87]
  ds_read_b64_tr_b16 a[26:27], v6 offset:45056
  v_mfma_f32_16x16x32_bf16 v[92:95], a[44:47], a[212:215], v[92:95]
  ds_read_b64_tr_b16 a[12:13], v7 offset:32768
  v_mfma_f32_16x16x32_bf16 v[92:95], a[60:63], a[220:223], v[92:95]
  ds_read_b64_tr_b16 a[14:15], v7 offset:36864
  v_mfma_f32_16x16x32_bf16 v[88:91], a[60:63], a[216:219], v[88:91]
  ds_read_b64_tr_b16 a[28:29], v7 offset:40960
  buffer_load_dwordx4 a[156:159], v9, s[4:7], s63 offen offset:3072 sc1
  v_mfma_f32_16x16x32_bf16 v[88:91], a[44:47], a[208:211], v[88:91]
  ds_read_b64_tr_b16 a[30:31], v7 offset:45056
  s_waitcnt vmcnt(24) lgkmcnt(8)
  v_mfma_f32_16x16x32_bf16 v[32:35], a[0:3], a[224:227], v[32:35]
  s_waitcnt vmcnt(26)
  s_barrier
  ds_read_b64_tr_b16 a[32:33], v4 offset:33792
  v_mfma_f32_16x16x32_bf16 v[32:35], a[16:19], a[232:235], v[32:35]
  s_add_u32 m0, s79, 65536
  ds_read_b64_tr_b16 a[34:35], v4 offset:37888
  s_add_u32 s92, s92, 196608
  v_mfma_f32_16x16x32_bf16 v[36:39], a[16:19], a[236:239], v[36:39]
  s_add_u32 s93, s92, s88
  ds_read_b64_tr_b16 a[48:49], v4 offset:41984
  buffer_load_dwordx4 v252, s[80:83], s93 offen lds
  v_mfma_f32_16x16x32_bf16 v[36:39], a[0:3], a[228:231], v[36:39]
  ds_read_b64_tr_b16 a[50:51], v4 offset:46080
  v_mfma_f32_16x16x32_bf16 v[44:47], a[4:7], a[228:231], v[44:47]
  ds_read_b64_tr_b16 a[36:37], v5 offset:33792
  v_mfma_f32_16x16x32_bf16 v[44:47], a[20:23], a[236:239], v[44:47]
  ds_read_b64_tr_b16 a[38:39], v5 offset:37888
  v_mfma_f32_16x16x32_bf16 v[40:43], a[20:23], a[232:235], v[40:43]
  ds_read_b64_tr_b16 a[52:53], v5 offset:41984
  buffer_load_dwordx4 v252, s[84:87], s93 offen offset:1024 lds
  v_mfma_f32_16x16x32_bf16 v[40:43], a[4:7], a[224:227], v[40:43]
  ds_read_b64_tr_b16 a[54:55], v5 offset:46080
  s_waitcnt lgkmcnt(8)
  v_mfma_f32_16x16x32_bf16 v[48:51], a[8:11], a[224:227], v[48:51]
  ds_read_b64_tr_b16 a[40:41], v6 offset:33792
  v_mfma_f32_16x16x32_bf16 v[48:51], a[24:27], a[232:235], v[48:51]
  s_add_u32 s48, s48, 4096
  ds_read_b64_tr_b16 a[42:43], v6 offset:37888
  s_min_u32 s63, s88, 4096
  v_mfma_f32_16x16x32_bf16 v[52:55], a[24:27], a[236:239], v[52:55]
  s_add_u32 s63, s63, s48
  ds_read_b64_tr_b16 a[56:57], v6 offset:41984
  buffer_load_dwordx4 a[160:163], v8, s[4:7], s63 offen offset:0 sc1
  v_mfma_f32_16x16x32_bf16 v[52:55], a[8:11], a[228:231], v[52:55]
  ds_read_b64_tr_b16 a[58:59], v6 offset:46080
  v_mfma_f32_16x16x32_bf16 v[60:63], a[12:15], a[228:231], v[60:63]
  ds_read_b64_tr_b16 a[44:45], v7 offset:33792
  v_mfma_f32_16x16x32_bf16 v[60:63], a[28:31], a[236:239], v[60:63]
  ds_read_b64_tr_b16 a[46:47], v7 offset:37888
  v_mfma_f32_16x16x32_bf16 v[56:59], a[28:31], a[232:235], v[56:59]
  ds_read_b64_tr_b16 a[60:61], v7 offset:41984
  buffer_load_dwordx4 a[164:167], v9, s[4:7], s63 offen offset:0 sc1
  v_mfma_f32_16x16x32_bf16 v[56:59], a[12:15], a[224:227], v[56:59]
  ds_read_b64_tr_b16 a[62:63], v7 offset:46080
  s_waitcnt lgkmcnt(8)
  v_mfma_f32_16x16x32_bf16 v[64:67], a[32:35], a[224:227], v[64:67]
  ds_read_b64_tr_b16 a[0:1], v4 offset:49152
  s_add_u32 m0, s79, 73728
  v_mfma_f32_16x16x32_bf16 v[64:67], a[48:51], a[232:235], v[64:67]
  s_add_u32 s92, s92, 262144
  ds_read_b64_tr_b16 a[2:3], v4 offset:53248
  s_add_u32 s93, s92, s89
  v_mfma_f32_16x16x32_bf16 v[68:71], a[48:51], a[236:239], v[68:71]
  ds_read_b64_tr_b16 a[16:17], v4 offset:57344
  buffer_load_dwordx4 v252, s[80:83], s93 offen lds
  v_mfma_f32_16x16x32_bf16 v[68:71], a[32:35], a[228:231], v[68:71]
  ds_read_b64_tr_b16 a[18:19], v4 offset:61440
  v_mfma_f32_16x16x32_bf16 v[76:79], a[36:39], a[228:231], v[76:79]
  ds_read_b64_tr_b16 a[4:5], v5 offset:49152
  v_mfma_f32_16x16x32_bf16 v[76:79], a[52:55], a[236:239], v[76:79]
  ds_read_b64_tr_b16 a[6:7], v5 offset:53248
  v_mfma_f32_16x16x32_bf16 v[72:75], a[52:55], a[232:235], v[72:75]
  ds_read_b64_tr_b16 a[20:21], v5 offset:57344
  buffer_load_dwordx4 v252, s[84:87], s93 offen offset:1024 lds
  v_mfma_f32_16x16x32_bf16 v[72:75], a[36:39], a[224:227], v[72:75]
  ds_read_b64_tr_b16 a[22:23], v5 offset:61440
  s_waitcnt lgkmcnt(8)
  v_mfma_f32_16x16x32_bf16 v[80:83], a[40:43], a[224:227], v[80:83]
  ds_read_b64_tr_b16 a[8:9], v6 offset:49152
  v_mfma_f32_16x16x32_bf16 v[80:83], a[56:59], a[232:235], v[80:83]
  s_min_u32 s63, s89, 4096
  ds_read_b64_tr_b16 a[10:11], v6 offset:53248
  s_add_u32 s63, s63, s48
  v_mfma_f32_16x16x32_bf16 v[84:87], a[56:59], a[236:239], v[84:87]
  ds_read_b64_tr_b16 a[24:25], v6 offset:57344
  buffer_load_dwordx4 a[168:171], v8, s[4:7], s63 offen offset:1024 sc1
  v_mfma_f32_16x16x32_bf16 v[84:87], a[40:43], a[228:231], v[84:87]
  ds_read_b64_tr_b16 a[26:27], v6 offset:61440
  v_mfma_f32_16x16x32_bf16 v[92:95], a[44:47], a[228:231], v[92:95]
  ds_read_b64_tr_b16 a[12:13], v7 offset:49152
  v_mfma_f32_16x16x32_bf16 v[92:95], a[60:63], a[236:239], v[92:95]
  ds_read_b64_tr_b16 a[14:15], v7 offset:53248
  v_mfma_f32_16x16x32_bf16 v[88:91], a[60:63], a[232:235], v[88:91]
  ds_read_b64_tr_b16 a[28:29], v7 offset:57344
  buffer_load_dwordx4 a[172:175], v9, s[4:7], s63 offen offset:1024 sc1
  v_mfma_f32_16x16x32_bf16 v[88:91], a[44:47], a[224:227], v[88:91]
  ds_read_b64_tr_b16 a[30:31], v7 offset:61440
  s_waitcnt vmcnt(24) lgkmcnt(8)
  v_mfma_f32_16x16x32_bf16 v[32:35], a[0:3], a[240:243], v[32:35]
  ds_read_b64_tr_b16 a[32:33], v4 offset:50176
  s_add_u32 m0, s79, 81920
  v_mfma_f32_16x16x32_bf16 v[32:35], a[16:19], a[248:251], v[32:35]
  s_add_u32 s92, s92, 196608
  ds_read_b64_tr_b16 a[34:35], v4 offset:54272
  s_add_u32 s93, s92, s90
  v_mfma_f32_16x16x32_bf16 v[36:39], a[16:19], a[252:255], v[36:39]
  ds_read_b64_tr_b16 a[48:49], v4 offset:58368
  buffer_load_dwordx4 v252, s[80:83], s93 offen lds
  v_mfma_f32_16x16x32_bf16 v[36:39], a[0:3], a[244:247], v[36:39]
  ds_read_b64_tr_b16 a[50:51], v4 offset:62464
  v_mfma_f32_16x16x32_bf16 v[44:47], a[4:7], a[244:247], v[44:47]
  ds_read_b64_tr_b16 a[36:37], v5 offset:50176
  v_mfma_f32_16x16x32_bf16 v[44:47], a[20:23], a[252:255], v[44:47]
  ds_read_b64_tr_b16 a[38:39], v5 offset:54272
  v_mfma_f32_16x16x32_bf16 v[40:43], a[20:23], a[248:251], v[40:43]
  ds_read_b64_tr_b16 a[52:53], v5 offset:58368
  buffer_load_dwordx4 v252, s[84:87], s93 offen offset:1024 lds
  v_mfma_f32_16x16x32_bf16 v[40:43], a[4:7], a[240:243], v[40:43]
  ds_read_b64_tr_b16 a[54:55], v5 offset:62464
  s_waitcnt lgkmcnt(8)
  v_mfma_f32_16x16x32_bf16 v[48:51], a[8:11], a[240:243], v[48:51]
  ds_read_b64_tr_b16 a[40:41], v6 offset:50176
  v_mfma_f32_16x16x32_bf16 v[48:51], a[24:27], a[248:251], v[48:51]
  s_min_u32 s63, s90, 4096
  ds_read_b64_tr_b16 a[42:43], v6 offset:54272
  s_add_u32 s63, s63, s48
  v_mfma_f32_16x16x32_bf16 v[52:55], a[24:27], a[252:255], v[52:55]
  ds_read_b64_tr_b16 a[56:57], v6 offset:58368
  buffer_load_dwordx4 a[176:179], v8, s[4:7], s63 offen offset:2048 sc1
  v_mfma_f32_16x16x32_bf16 v[52:55], a[8:11], a[244:247], v[52:55]
  ds_read_b64_tr_b16 a[58:59], v6 offset:62464
  v_mfma_f32_16x16x32_bf16 v[60:63], a[12:15], a[244:247], v[60:63]
  ds_read_b64_tr_b16 a[44:45], v7 offset:50176
  v_mfma_f32_16x16x32_bf16 v[60:63], a[28:31], a[252:255], v[60:63]
  ds_read_b64_tr_b16 a[46:47], v7 offset:54272
  v_mfma_f32_16x16x32_bf16 v[56:59], a[28:31], a[248:251], v[56:59]
  ds_read_b64_tr_b16 a[60:61], v7 offset:58368
  buffer_load_dwordx4 a[180:183], v9, s[4:7], s63 offen offset:2048 sc1
  v_mfma_f32_16x16x32_bf16 v[56:59], a[12:15], a[240:243], v[56:59]
  ds_read_b64_tr_b16 a[62:63], v7 offset:62464
  s_waitcnt lgkmcnt(8)
  v_mfma_f32_16x16x32_bf16 v[64:67], a[32:35], a[240:243], v[64:67]
  ds_read_b64_tr_b16 a[0:1], v0 offset:0
  s_add_u32 m0, s79, 90112
  v_mfma_f32_16x16x32_bf16 v[64:67], a[48:51], a[248:251], v[64:67]
  s_add_u32 s92, s92, 262144
  ds_read_b64_tr_b16 a[2:3], v0 offset:4096
  s_add_u32 s93, s92, s91
  v_mfma_f32_16x16x32_bf16 v[68:71], a[48:51], a[252:255], v[68:71]
  ds_read_b64_tr_b16 a[16:17], v0 offset:8192
  buffer_load_dwordx4 v252, s[80:83], s93 offen lds
  v_mfma_f32_16x16x32_bf16 v[68:71], a[32:35], a[244:247], v[68:71]
  ds_read_b64_tr_b16 a[18:19], v0 offset:12288
  v_mfma_f32_16x16x32_bf16 v[76:79], a[36:39], a[244:247], v[76:79]
  ds_read_b64_tr_b16 a[4:5], v1 offset:0
  v_mfma_f32_16x16x32_bf16 v[76:79], a[52:55], a[252:255], v[76:79]
  ds_read_b64_tr_b16 a[6:7], v1 offset:4096
  v_mfma_f32_16x16x32_bf16 v[72:75], a[52:55], a[248:251], v[72:75]
  ds_read_b64_tr_b16 a[20:21], v1 offset:8192
  buffer_load_dwordx4 v252, s[84:87], s93 offen offset:1024 lds
  v_mfma_f32_16x16x32_bf16 v[72:75], a[36:39], a[240:243], v[72:75]
  ds_read_b64_tr_b16 a[22:23], v1 offset:12288
  s_waitcnt lgkmcnt(8)
  v_mfma_f32_16x16x32_bf16 v[80:83], a[40:43], a[240:243], v[80:83]
  ds_read_b64_tr_b16 a[8:9], v2 offset:0
  v_mfma_f32_16x16x32_bf16 v[80:83], a[56:59], a[248:251], v[80:83]
  s_min_u32 s63, s91, 4096
  ds_read_b64_tr_b16 a[10:11], v2 offset:4096
  s_add_u32 s63, s63, s48
  v_mfma_f32_16x16x32_bf16 v[84:87], a[56:59], a[252:255], v[84:87]
  ds_read_b64_tr_b16 a[24:25], v2 offset:8192
  buffer_load_dwordx4 a[184:187], v8, s[4:7], s63 offen offset:3072 sc1
  v_mfma_f32_16x16x32_bf16 v[84:87], a[40:43], a[244:247], v[84:87]
  ds_read_b64_tr_b16 a[26:27], v2 offset:12288
  v_mfma_f32_16x16x32_bf16 v[92:95], a[44:47], a[244:247], v[92:95]
  ds_read_b64_tr_b16 a[12:13], v3 offset:0
  v_mfma_f32_16x16x32_bf16 v[92:95], a[60:63], a[252:255], v[92:95]
  ds_read_b64_tr_b16 a[14:15], v3 offset:4096
  v_mfma_f32_16x16x32_bf16 v[88:91], a[60:63], a[248:251], v[88:91]
  ds_read_b64_tr_b16 a[28:29], v3 offset:8192
  buffer_load_dwordx4 a[188:191], v9, s[4:7], s63 offen offset:3072 sc1
  v_mfma_f32_16x16x32_bf16 v[88:91], a[44:47], a[240:243], v[88:91]
  s_sub_u32 s56, s56, 1
  ds_read_b64_tr_b16 a[30:31], v3 offset:12288
  s_cmp_lg_u32 s56, 0
  s_cbranch_scc1 Lp4_loop
Lmk_Lp4_loop_tail:
  s_waitcnt vmcnt(24) lgkmcnt(8)
  v_mfma_f32_16x16x32_bf16 v[32:35], a[0:3], a[128:131], v[32:35]
  s_waitcnt vmcnt(26)
  s_barrier
  ds_read_b64_tr_b16 a[32:33], v0 offset:1024
  s_add_u32 m0, s79, 98304
  s_add_u32 s92, s92, 196608
  s_cmp_lg_u32 s88, 0
  s_cselect_b32 s93, -2686976, 0
  s_cselect_b32 s43, s78, 0
  v_mfma_f32_16x16x32_bf16 v[32:35], a[16:19], a[136:139], v[32:35]
  s_add_u32 s93, s93, s43
  ds_read_b64_tr_b16 a[34:35], v0 offset:5120
  s_add_u32 s93, s93, s92
  v_mfma_f32_16x16x32_bf16 v[36:39], a[16:19], a[140:143], v[36:39]
  ds_read_b64_tr_b16 a[48:49], v0 offset:9216
  buffer_load_dwordx4 v252, s[80:83], s93 offen lds
  v_mfma_f32_16x16x32_bf16 v[36:39], a[0:3], a[132:135], v[36:39]
  ds_read_b64_tr_b16 a[50:51], v0 offset:13312
  v_mfma_f32_16x16x32_bf16 v[44:47], a[4:7], a[132:135], v[44:47]
  ds_read_b64_tr_b16 a[36:37], v1 offset:1024
  v_mfma_f32_16x16x32_bf16 v[44:47], a[20:23], a[140:143], v[44:47]
  ds_read_b64_tr_b16 a[38:39], v1 offset:5120
  v_mfma_f32_16x16x32_bf16 v[40:43], a[20:23], a[136:139], v[40:43]
  ds_read_b64_tr_b16 a[52:53], v1 offset:9216
  buffer_load_dwordx4 v252, s[84:87], s93 offen offset:1024 lds
  v_mfma_f32_16x16x32_bf16 v[40:43], a[4:7], a[128:131], v[40:43]
  ds_read_b64_tr_b16 a[54:55], v1 offset:13312
  s_waitcnt lgkmcnt(8)
  v_mfma_f32_16x16x32_bf16 v[48:51], a[8:11], a[128:131], v[48:51]
  ds_read_b64_tr_b16 a[40:41], v2 offset:1024
  v_mfma_f32_16x16x32_bf16 v[48:51], a[24:27], a[136:139], v[48:51]
  s_add_u32 s48, s48, 4096
  ds_read_b64_tr_b16 a[42:43], v2 offset:5120
  s_min_u32 s63, s88, 4096
  v_mfma_f32_16x16x32_bf16 v[52:55], a[24:27], a[140:143], v[52:55]
  s_add_u32 s63, s63, s48
  ds_read_b64_tr_b16 a[56:57], v2 offset:9216
  buffer_load_dwordx4 a[192:195], v8, s[4:7], s63 offen offset:0 sc1
  v_mfma_f32_16x16x32_bf16 v[52:55], a[8:11], a[132:135], v[52:55]
  ds_read_b64_tr_b16 a[58:59], v2 offset:13312
  v_mfma_f32_16x16x32_bf16 v[60:63], a[12:15], a[132:135], v[60:63]
  ds_read_b64_tr_b16 a[44:45], v3 offset:1024
  v_mfma_f32_16x16x32_bf16 v[60:63], a[28:31], a[140:143], v[60:63]
  ds_read_b64_tr_b16 a[46:47], v3 offset:5120
  v_mfma_f32_16x16x32_bf16 v[56:59], a[28:31], a[136:139], v[56:59]
  ds_read_b64_tr_b16 a[60:61], v3 offset:9216
  buffer_load_dwordx4 a[196:199], v9, s[4:7], s63 offen offset:0 sc1
  v_mfma_f32_16x16x32_bf16 v[56:59], a[12:15], a[128:131], v[56:59]
  ds_read_b64_tr_b16 a[62:63], v3 offset:13312
  s_waitcnt lgkmcnt(8)
  v_mfma_f32_16x16x32_bf16 v[64:67], a[32:35], a[128:131], v[64:67]
  s_add_u32 m0, s79, 106496
  ds_read_b64_tr_b16 a[0:1], v0 offset:16384
  s_add_u32 s92, s92, 262144
  s_cmp_lg_u32 s89, 0
  s_cselect_b32 s93, -2490368, 0
  s_cselect_b32 s43, s78, 0
  v_mfma_f32_16x16x32_bf16 v[64:67], a[48:51], a[136:139], v[64:67]
  s_add_u32 s93, s93, s43
  ds_read_b64_tr_b16 a[2:3], v0 offset:20480
  s_add_u32 s93, s93, s92
  v_mfma_f32_16x16x32_bf16 v[68:71], a[48:51], a[140:143], v[68:71]
  ds_read_b64_tr_b16 a[16:17], v0 offset:24576
  buffer_load_dwordx4 v252, s[80:83], s93 offen lds
  v_mfma_f32_16x16x32_bf16 v[68:71], a[32:35], a[132:135], v[68:71]
  ds_read_b64_tr_b16 a[18:19], v0 offset:28672
  v_mfma_f32_16x16x32_bf16 v[76:79], a[36:39], a[132:135], v[76:79]
  ds_read_b64_tr_b16 a[4:5], v1 offset:16384
  v_mfma_f32_16x16x32_bf16 v[76:79], a[52:55], a[140:143], v[76:79]
  ds_read_b64_tr_b16 a[6:7], v1 offset:20480
  v_mfma_f32_16x16x32_bf16 v[72:75], a[52:55], a[136:139], v[72:75]
  ds_read_b64_tr_b16 a[20:21], v1 offset:24576
  buffer_load_dwordx4 v252, s[84:87], s93 offen offset:1024 lds
  v_mfma_f32_16x16x32_bf16 v[72:75], a[36:39], a[128:131], v[72:75]
  ds_read_b64_tr_b16 a[22:23], v1 offset:28672
  s_waitcnt lgkmcnt(8)
  v_mfma_f32_16x16x32_bf16 v[80:83], a[40:43], a[128:131], v[80:83]
  ds_read_b64_tr_b16 a[8:9], v2 offset:16384
  v_mfma_f32_16x16x32_bf16 v[80:83], a[56:59], a[136:139], v[80:83]
  s_min_u32 s63, s89, 4096
  ds_read_b64_tr_b16 a[10:11], v2 offset:20480
  s_add_u32 s63, s63, s48
  v_mfma_f32_16x16x32_bf16 v[84:87], a[56:59], a[140:143], v[84:87]
  ds_read_b64_tr_b16 a[24:25], v2 offset:24576
  buffer_load_dwordx4 a[200:203], v8, s[4:7], s63 offen offset:1024 sc1
  v_mfma_f32_16x16x32_bf16 v[84:87], a[40:43], a[132:135], v[84:87]
  ds_read_b64_tr_b16 a[26:27], v2 offset:28672
  v_mfma_f32_16x16x32_bf16 v[92:95], a[44:47], a[132:135], v[92:95]
  ds_read_b64_tr_b16 a[12:13], v3 offset:16384
  v_mfma_f32_16x16x32_bf16 v[92:95], a[60:63], a[140:143], v[92:95]
  ds_read_b64_tr_b16 a[14:15], v3 offset:20480
  v_mfma_f32_16x16x32_bf16 v[88:91], a[60:63], a[136:139], v[88:91]
  ds_read_b64_tr_b16 a[28:29], v3 offset:24576
  buffer_load_dwordx4 a[204:207], v9, s[4:7], s63 offen offset:1024 sc1
  v_mfma_f32_16x16x32_bf16 v[88:91], a[44:47], a[128:131], v[88:91]
  ds_read_b64_tr_b16 a[30:31], v3 offset:28672
  s_waitcnt vmcnt(24) lgkmcnt(8)
  v_mfma_f32_16x16x32_bf16 v[32:35], a[0:3], a[144:147], v[32:35]
  s_add_u32 m0, s79, 114688
  ds_read_b64_tr_b16 a[32:33], v0 offset:17408
  s_add_u32 s92, s92, 196608
  s_cmp_lg_u32 s90, 0
  s_cselect_b32 s93, -2228224, 0
  s_cselect_b32 s43, s78, 0
  v_mfma_f32_16x16x32_bf16 v[32:35], a[16:19], a[152:155], v[32:35]
  s_add_u32 s93, s93, s43
  ds_read_b64_tr_b16 a[34:35], v0 offset:21504
  s_add_u32 s93, s93, s92
  v_mfma_f32_16x16x32_bf16 v[36:39], a[16:19], a[156:159], v[36:39]
  ds_read_b64_tr_b16 a[48:49], v0 offset:25600
  buffer_load_dwordx4 v252, s[80:83], s93 offen lds
  v_mfma_f32_16x16x32_bf16 v[36:39], a[0:3], a[148:151], v[36:39]
  ds_read_b64_tr_b16 a[50:51], v0 offset:29696
  v_mfma_f32_16x16x32_bf16 v[44:47], a[4:7], a[148:151], v[44:47]
  ds_read_b64_tr_b16 a[36:37], v1 offset:17408
  v_mfma_f32_16x16x32_bf16 v[44:47], a[20:23], a[156:159], v[44:47]
  ds_read_b64_tr_b16 a[38:39], v1 offset:21504
  v_mfma_f32_16x16x32_bf16 v[40:43], a[20:23], a[152:155], v[40:43]
  ds_read_b64_tr_b16 a[52:53], v1 offset:25600
  buffer_load_dwordx4 v252, s[84:87], s93 offen offset:1024 lds
  v_mfma_f32_16x16x32_bf16 v[40:43], a[4:7], a[144:147], v[40:43]
  ds_read_b64_tr_b16 a[54:55], v1 offset:29696
  s_waitcnt lgkmcnt(8)
  v_mfma_f32_16x16x32_bf16 v[48:51], a[8:11], a[144:147], v[48:51]
  ds_read_b64_tr_b16 a[40:41], v2 offset:17408
  v_mfma_f32_16x16x32_bf16 v[48:51], a[24:27], a[152:155], v[48:51]
  s_min_u32 s63, s90, 4096
  ds_read_b64_tr_b16 a[42:43], v2 offset:21504
  s_add_u32 s63, s63, s48
  v_mfma_f32_16x16x32_bf16 v[52:55], a[24:27], a[156:159], v[52:55]
  ds_read_b64_tr_b16 a[56:57], v2 offset:25600
  buffer_load_dwordx4 a[208:211], v8, s[4:7], s63 offen offset:2048 sc1
  v_mfma_f32_16x16x32_bf16 v[52:55], a[8:11], a[148:151], v[52:55]
  ds_read_b64_tr_b16 a[58:59], v2 offset:29696
  v_mfma_f32_16x16x32_bf16 v[60:63], a[12:15], a[148:151], v[60:63]
  ds_read_b64_tr_b16 a[44:45], v3 offset:17408
  v_mfma_f32_16x16x32_bf16 v[60:63], a[28:31], a[156:159], v[60:63]
  ds_read_b64_tr_b16 a[46:47], v3 offset:21504
  v_mfma_f32_16x16x32_bf16 v[56:59], a[28:31], a[152:155], v[56:59]
  ds_read_b64_tr_b16 a[60:61], v3 offset:25600
  buffer_load_dwordx4 a[212:215], v9, s[4:7], s63 offen offset:2048 sc1
  v_mfma_f32_16x16x32_bf16 v[56:59], a[12:15], a[144:147], v[56:59]
  ds_read_b64_tr_b16 a[62:63], v3 offset:29696
  s_waitcnt lgkmcnt(8)
  v_mfma_f32_16x16x32_bf16 v[64:67], a[32:35], a[144:147], v[64:67]
  s_add_u32 m0, s79, 122880
  ds_read_b64_tr_b16 a[0:1], v0 offset:32768
  s_add_u32 s92, s92, 262144
  s_cmp_lg_u32 s91, 0
  s_cselect_b32 s93, -2031616, 0
  s_cselect_b32 s43, s78, 0
  v_mfma_f32_16x16x32_bf16 v[64:67], a[48:51], a[152:155], v[64:67]
  s_add_u32 s93, s93, s43
  ds_read_b64_tr_b16 a[2:3], v0 offset:36864
  s_add_u32 s93, s93, s92
  v_mfma_f32_16x16x32_bf16 v[68:71], a[48:51], a[156:159], v[68:71]
  ds_read_b64_tr_b16 a[16:17], v0 offset:40960
  buffer_load_dwordx4 v252, s[80:83], s93 offen lds
  v_mfma_f32_16x16x32_bf16 v[68:71], a[32:35], a[148:151], v[68:71]
  ds_read_b64_tr_b16 a[18:19], v0 offset:45056
  v_mfma_f32_16x16x32_bf16 v[76:79], a[36:39], a[148:151], v[76:79]
  ds_read_b64_tr_b16 a[4:5], v1 offset:32768
  v_mfma_f32_16x16x32_bf16 v[76:79], a[52:55], a[156:159], v[76:79]
  ds_read_b64_tr_b16 a[6:7], v1 offset:36864
  v_mfma_f32_16x16x32_bf16 v[72:75], a[52:55], a[152:155], v[72:75]
  ds_read_b64_tr_b16 a[20:21], v1 offset:40960
  buffer_load_dwordx4 v252, s[84:87], s93 offen offset:1024 lds
  v_mfma_f32_16x16x32_bf16 v[72:75], a[36:39], a[144:147], v[72:75]
  ds_read_b64_tr_b16 a[22:23], v1 offset:45056
  s_waitcnt lgkmcnt(8)
  v_mfma_f32_16x16x32_bf16 v[80:83], a[40:43], a[144:147], v[80:83]
  ds_read_b64_tr_b16 a[8:9], v2 offset:32768
  v_mfma_f32_16x16x32_bf16 v[80:83], a[56:59], a[152:155], v[80:83]
  s_min_u32 s63, s91, 4096
  ds_read_b64_tr_b16 a[10:11], v2 offset:36864
  s_add_u32 s63, s63, s48
  v_mfma_f32_16x16x32_bf16 v[84:87], a[56:59], a[156:159], v[84:87]
  ds_read_b64_tr_b16 a[24:25], v2 offset:40960
  buffer_load_dwordx4 a[216:219], v8, s[4:7], s63 offen offset:3072 sc1
  v_mfma_f32_16x16x32_bf16 v[84:87], a[40:43], a[148:151], v[84:87]
  ds_read_b64_tr_b16 a[26:27], v2 offset:45056
  v_mfma_f32_16x16x32_bf16 v[92:95], a[44:47], a[148:151], v[92:95]
  ds_read_b64_tr_b16 a[12:13], v3 offset:32768
  v_mfma_f32_16x16x32_bf16 v[92:95], a[60:63], a[156:159], v[92:95]
  ds_read_b64_tr_b16 a[14:15], v3 offset:36864
  v_mfma_f32_16x16x32_bf16 v[88:91], a[60:63], a[152:155], v[88:91]
  ds_read_b64_tr_b16 a[28:29], v3 offset:40960
  buffer_load_dwordx4 a[220:223], v9, s[4:7], s63 offen offset:3072 sc1
  v_mfma_f32_16x16x32_bf16 v[88:91], a[44:47], a[144:147], v[88:91]
  ds_read_b64_tr_b16 a[30:31], v3 offset:45056
  s_waitcnt vmcnt(24) lgkmcnt(8)
  v_mfma_f32_16x16x32_bf16 v[32:35], a[0:3], a[160:163], v[32:35]
  s_waitcnt vmcnt(26)
  s_barrier
  ds_read_b64_tr_b16 a[32:33], v0 offset:33792
  s_add_u32 m0, s79, 0
  s_add_u32 s92, s92, -3407872
  s_add_u32 s92, s92, s78
  s_cmp_lg_u32 s88, 0
  v_mfma_f32_16x16x32_bf16 v[32:35], a[16:19], a[168:171], v[32:35]
  s_cselect_b32 s93, 1835008, 0
  ds_read_b64_tr_b16 a[34:35], v0 offset:37888
  s_add_u32 s93, s93, s92
  v_mfma_f32_16x16x32_bf16 v[36:39], a[16:19], a[172:175], v[36:39]
  ds_read_b64_tr_b16 a[48:49], v0 offset:41984
  buffer_load_dwordx4 v252, s[80:83], s93 offen lds
  v_mfma_f32_16x16x32_bf16 v[36:39], a[0:3], a[164:167], v[36:39]
  ds_read_b64_tr_b16 a[50:51], v0 offset:46080
  v_mfma_f32_16x16x32_bf16 v[44:47], a[4:7], a[164:167], v[44:47]
  ds_read_b64_tr_b16 a[36:37], v1 offset:33792
  v_mfma_f32_16x16x32_bf16 v[44:47], a[20:23], a[172:175], v[44:47]
  ds_read_b64_tr_b16 a[38:39], v1 offset:37888
  v_mfma_f32_16x16x32_bf16 v[40:43], a[20:23], a[168:171], v[40:43]
  ds_read_b64_tr_b16 a[52:53], v1 offset:41984
  buffer_load_dwordx4 v252, s[84:87], s93 offen offset:1024 lds
  v_mfma_f32_16x16x32_bf16 v[40:43], a[4:7], a[160:163], v[40:43]
  ds_read_b64_tr_b16 a[54:55], v1 offset:46080
  s_waitcnt lgkmcnt(8)
  v_mfma_f32_16x16x32_bf16 v[48:51], a[8:11], a[160:163], v[48:51]
  ds_read_b64_tr_b16 a[40:41], v2 offset:33792
  v_mfma_f32_16x16x32_bf16 v[48:51], a[24:27], a[168:171], v[48:51]
  s_add_u32 s48, s48, 4096
  ds_read_b64_tr_b16 a[42:43], v2 offset:37888
  s_min_u32 s63, s88, 4096
  v_mfma_f32_16x16x32_bf16 v[52:55], a[24:27], a[172:175], v[52:55]
  s_add_u32 s63, s63, s48
  ds_read_b64_tr_b16 a[56:57], v2 offset:41984
  buffer_load_dwordx4 a[224:227], v8, s[4:7], s63 offen offset:0 sc1
  v_mfma_f32_16x16x32_bf16 v[52:55], a[8:11], a[164:167], v[52:55]
  ds_read_b64_tr_b16 a[58:59], v2 offset:46080
  v_mfma_f32_16x16x32_bf16 v[60:63], a[12:15], a[164:167], v[60:63]
  ds_read_b64_tr_b16 a[44:45], v3 offset:33792
  v_mfma_f32_16x16x32_bf16 v[60:63], a[28:31], a[172:175], v[60:63]
  ds_read_b64_tr_b16 a[46:47], v3 offset:37888
  v_mfma_f32_16x16x32_bf16 v[56:59], a[28:31], a[168:171], v[56:59]
  ds_read_b64_tr_b16 a[60:61], v3 offset:41984
  buffer_load_dwordx4 a[228:231], v9, s[4:7], s63 offen offset:0 sc1
  v_mfma_f32_16x16x32_bf16 v[56:59], a[12:15], a[160:163], v[56:59]
  ds_read_b64_tr_b16 a[62:63], v3 offset:46080
  s_waitcnt lgkmcnt(8)
  v_mfma_f32_16x16x32_bf16 v[64:67], a[32:35], a[160:163], v[64:67]
  s_add_u32 m0, s79, 8192
  ds_read_b64_tr_b16 a[0:1], v0 offset:49152
  s_add_u32 s92, s92, 458752
  s_cmp_lg_u32 s89, 0
  v_mfma_f32_16x16x32_bf16 v[64:67], a[48:51], a[168:171], v[64:67]
  s_cselect_b32 s93, 1835008, 0
  ds_read_b64_tr_b16 a[2:3], v0 offset:53248
  s_add_u32 s93, s93, s92
  v_mfma_f32_16x16x32_bf16 v[68:71], a[48:51], a[172:175], v[68:71]
  ds_read_b64_tr_b16 a[16:17], v0 offset:57344
  buffer_load_dwordx4 v252, s[80:83], s93 offen lds
  v_mfma_f32_16x16x32_bf16 v[68:71], a[32:35], a[164:167], v[68:71]
  ds_read_b64_tr_b16 a[18:19], v0 offset:61440
  v_mfma_f32_16x16x32_bf16 v[76:79], a[36:39], a[164:167], v[76:79]
  ds_read_b64_tr_b16 a[4:5], v1 offset:49152
  v_mfma_f32_16x16x32_bf16 v[76:79], a[52:55], a[172:175], v[76:79]
  ds_read_b64_tr_b16 a[6:7], v1 offset:53248
  v_mfma_f32_16x16x32_bf16 v[72:75], a[52:55], a[168:171], v[72:75]
  ds_read_b64_tr_b16 a[20:21], v1 offset:57344
  buffer_load_dwordx4 v252, s[84:87], s93 offen offset:1024 lds
  v_mfma_f32_16x16x32_bf16 v[72:75], a[36:39], a[160:163], v[72:75]
  ds_read_b64_tr_b16 a[22:23], v1 offset:61440
  s_waitcnt lgkmcnt(8)
  v_mfma_f32_16x16x32_bf16 v[80:83], a[40:43], a[160:163], v[80:83]
  ds_read_b64_tr_b16 a[8:9], v2 offset:49152
  v_mfma_f32_16x16x32_bf16 v[80:83], a[56:59], a[168:171], v[80:83]
  s_min_u32 s63, s89, 4096
  ds_read_b64_tr_b16 a[10:11], v2 offset:53248
  s_add_u32 s63, s63, s48
  v_mfma_f32_16x16x32_bf16 v[84:87], a[56:59], a[172:175], v[84:87]
  ds_read_b64_tr_b16 a[24:25], v2 offset:57344
  buffer_load_dwordx4 a[232:235], v8, s[4:7], s63 offen offset:1024 sc1
  v_mfma_f32_16x16x32_bf16 v[84:87], a[40:43], a[164:167], v[84:87]
  ds_read_b64_tr_b16 a[26:27], v2 offset:61440
  v_mfma_f32_16x16x32_bf16 v[92:95], a[44:47], a[164:167], v[92:95]
  ds_read_b64_tr_b16 a[12:13], v3 offset:49152
  v_mfma_f32_16x16x32_bf16 v[92:95], a[60:63], a[172:175], v[92:95]
  ds_read_b64_tr_b16 a[14:15], v3 offset:53248
  v_mfma_f32_16x16x32_bf16 v[88:91], a[60:63], a[168:171], v[88:91]
  ds_read_b64_tr_b16 a[28:29], v3 offset:57344
  buffer_load_dwordx4 a[236:239], v9, s[4:7], s63 offen offset:1024 sc1
  v_mfma_f32_16x16x32_bf16 v[88:91], a[44:47], a[160:163], v[88:91]
  ds_read_b64_tr_b16 a[30:31], v3 offset:61440
  s_waitcnt vmcnt(24) lgkmcnt(8)
  v_mfma_f32_16x16x32_bf16 v[32:35], a[0:3], a[176:179], v[32:35]
  s_add_u32 m0, s79, 16384
  ds_read_b64_tr_b16 a[32:33], v0 offset:50176
  s_add_u32 s92, s92, 458752
  s_cmp_lg_u32 s90, 0
  v_mfma_f32_16x16x32_bf16 v[32:35], a[16:19], a[184:187], v[32:35]
  s_cselect_b32 s93, 1835008, 0
  ds_read_b64_tr_b16 a[34:35], v0 offset:54272
  s_add_u32 s93, s93, s92
  v_mfma_f32_16x16x32_bf16 v[36:39], a[16:19], a[188:191], v[36:39]
  ds_read_b64_tr_b16 a[48:49], v0 offset:58368
  buffer_load_dwordx4 v252, s[80:83], s93 offen lds
  v_mfma_f32_16x16x32_bf16 v[36:39], a[0:3], a[180:183], v[36:39]
  ds_read_b64_tr_b16 a[50:51], v0 offset:62464
  v_mfma_f32_16x16x32_bf16 v[44:47], a[4:7], a[180:183], v[44:47]
  ds_read_b64_tr_b16 a[36:37], v1 offset:50176
  v_mfma_f32_16x16x32_bf16 v[44:47], a[20:23], a[188:191], v[44:47]
  ds_read_b64_tr_b16 a[38:39], v1 offset:54272
  v_mfma_f32_16x16x32_bf16 v[40:43], a[20:23], a[184:187], v[40:43]
  ds_read_b64_tr_b16 a[52:53], v1 offset:58368
  buffer_load_dwordx4 v252, s[84:87], s93 offen offset:1024 lds
  v_mfma_f32_16x16x32_bf16 v[40:43], a[4:7], a[176:179], v[40:43]
  ds_read_b64_tr_b16 a[54:55], v1 offset:62464
  s_waitcnt lgkmcnt(8)
  v_mfma_f32_16x16x32_bf16 v[48:51], a[8:11], a[176:179], v[48:51]
  ds_read_b64_tr_b16 a[40:41], v2 offset:50176
  v_mfma_f32_16x16x32_bf16 v[48:51], a[24:27], a[184:187], v[48:51]
  s_min_u32 s63, s90, 4096
  ds_read_b64_tr_b16 a[42:43], v2 offset:54272
  s_add_u32 s63, s63, s48
  v_mfma_f32_16x16x32_bf16 v[52:55], a[24:27], a[188:191], v[52:55]
  ds_read_b64_tr_b16 a[56:57], v2 offset:58368
  buffer_load_dwordx4 a[240:243], v8, s[4:7], s63 offen offset:2048 sc1
  v_mfma_f32_16x16x32_bf16 v[52:55], a[8:11], a[180:183], v[52:55]
  ds_read_b64_tr_b16 a[58:59], v2 offset:62464
  v_mfma_f32_16x16x32_bf16 v[60:63], a[12:15], a[180:183], v[60:63]
  ds_read_b64_tr_b16 a[44:45], v3 offset:50176
  v_mfma_f32_16x16x32_bf16 v[60:63], a[28:31], a[188:191], v[60:63]
  ds_read_b64_tr_b16 a[46:47], v3 offset:54272
  v_mfma_f32_16x16x32_bf16 v[56:59], a[28:31], a[184:187], v[56:59]
  ds_read_b64_tr_b16 a[60:61], v3 offset:58368
  buffer_load_dwordx4 a[244:247], v9, s[4:7], s63 offen offset:2048 sc1
  v_mfma_f32_16x16x32_bf16 v[56:59], a[12:15], a[176:179], v[56:59]
  ds_read_b64_tr_b16 a[62:63], v3 offset:62464
  s_waitcnt lgkmcnt(8)
  v_mfma_f32_16x16x32_bf16 v[64:67], a[32:35], a[176:179], v[64:67]
  s_add_u32 m0, s79, 24576
  ds_read_b64_tr_b16 a[0:1], v4 offset:0
  s_add_u32 s92, s92, 458752
  s_cmp_lg_u32 s91, 0
  v_mfma_f32_16x16x32_bf16 v[64:67], a[48:51], a[184:187], v[64:67]
  s_cselect_b32 s93, 1835008, 0
  ds_read_b64_tr_b16 a[2:3], v4 offset:4096
  s_add_u32 s93, s93, s92
  v_mfma_f32_16x16x32_bf16 v[68:71], a[48:51], a[188:191], v[68:71]
  ds_read_b64_tr_b16 a[16:17], v4 offset:8192
  buffer_load_dwordx4 v252, s[80:83], s93 offen lds
  v_mfma_f32_16x16x32_bf16 v[68:71], a[32:35], a[180:183], v[68:71]
  ds_read_b64_tr_b16 a[18:19], v4 offset:12288
  v_mfma_f32_16x16x32_bf16 v[76:79], a[36:39], a[180:183], v[76:79]
  ds_read_b64_tr_b16 a[4:5], v5 offset:0
  v_mfma_f32_16x16x32_bf16 v[76:79], a[52:55], a[188:191], v[76:79]
  ds_read_b64_tr_b16 a[6:7], v5 offset:4096
  v_mfma_f32_16x16x32_bf16 v[72:75], a[52:55], a[184:187], v[72:75]
  ds_read_b64_tr_b16 a[20:21], v5 offset:8192
  buffer_load_dwordx4 v252, s[84:87], s93 offen offset:1024 lds
  v_mfma_f32_16x16x32_bf16 v[72:75], a[36:39], a[176:179], v[72:75]
  ds_read_b64_tr_b16 a[22:23], v5 offset:12288
  s_waitcnt lgkmcnt(8)
  v_mfma_f32_16x16x32_bf16 v[80:83], a[40:43], a[176:179], v[80:83]
  ds_read_b64_tr_b16 a[8:9], v6 offset:0
  v_mfma_f32_16x16x32_bf16 v[80:83], a[56:59], a[184:187], v[80:83]
  s_min_u32 s63, s91, 4096
  ds_read_b64_tr_b16 a[10:11], v6 offset:4096
  s_add_u32 s63, s63, s48
  v_mfma_f32_16x16x32_bf16 v[84:87], a[56:59], a[188:191], v[84:87]
  ds_read_b64_tr_b16 a[24:25], v6 offset:8192
  buffer_load_dwordx4 a[248:251], v8, s[4:7], s63 offen offset:3072 sc1
  v_mfma_f32_16x16x32_bf16 v[84:87], a[40:43], a[180:183], v[84:87]
  ds_read_b64_tr_b16 a[26:27], v6 offset:12288
  v_mfma_f32_16x16x32_bf16 v[92:95], a[44:47], a[180:183], v[92:95]
  ds_read_b64_tr_b16 a[12:13], v7 offset:0
  v_mfma_f32_16x16x32_bf16 v[92:95], a[60:63], a[188:191], v[92:95]
  ds_read_b64_tr_b16 a[14:15], v7 offset:4096
  v_mfma_f32_16x16x32_bf16 v[88:91], a[60:63], a[184:187], v[88:91]
  ds_read_b64_tr_b16 a[28:29], v7 offset:8192
  buffer_load_dwordx4 a[252:255], v9, s[4:7], s63 offen offset:3072 sc1
  v_mfma_f32_16x16x32_bf16 v[88:91], a[44:47], a[176:179], v[88:91]
  ds_read_b64_tr_b16 a[30:31], v7 offset:12288
  s_waitcnt vmcnt(24) lgkmcnt(8)
  v_mfma_f32_16x16x32_bf16 v[32:35], a[0:3], a[192:195], v[32:35]
  s_waitcnt vmcnt(26)
  s_barrier
  ds_read_b64_tr_b16 a[32:33], v4 offset:16384
  s_add_u32 m0, s79, 32768
  s_add_u32 s92, s92, 458752
  s_cmp_lg_u32 s88, 0
  s_cselect_b32 s93, -2031616, 0
  s_cselect_b32 s43, s78, 0
  v_mfma_f32_16x16x32_bf16 v[32:35], a[16:19], a[200:203], v[32:35]
  s_sub_u32 s93, s93, s43
  ds_read_b64_tr_b16 a[34:35], v4 offset:20480
  s_add_u32 s93, s93, s92
  v_mfma_f32_16x16x32_bf16 v[36:39], a[16:19], a[204:207], v[36:39]
  ds_read_b64_tr_b16 a[48:49], v4 offset:24576
  buffer_load_dwordx4 v252, s[80:83], s93 offen lds
  v_mfma_f32_16x16x32_bf16 v[36:39], a[0:3], a[196:199], v[36:39]
  ds_read_b64_tr_b16 a[50:51], v4 offset:28672
  v_mfma_f32_16x16x32_bf16 v[44:47], a[4:7], a[196:199], v[44:47]
  ds_read_b64_tr_b16 a[36:37], v5 offset:16384
  buffer_load_dwordx4 v252, s[84:87], s93 offen offset:1024 lds
  v_mfma_f32_16x16x32_bf16 v[44:47], a[20:23], a[204:207], v[44:47]
  s_add_u32 s48, s48, 4096
  ds_read_b64_tr_b16 a[38:39], v5 offset:20480
  s_min_u32 s63, s88, 4096
  v_mfma_f32_16x16x32_bf16 v[40:43], a[20:23], a[200:203], v[40:43]
  s_add_u32 s63, s63, s48
  ds_read_b64_tr_b16 a[52:53], v5 offset:24576
  buffer_load_dwordx4 a[128:131], v8, s[4:7], s63 offen offset:0 sc1
  v_mfma_f32_16x16x32_bf16 v[40:43], a[4:7], a[192:195], v[40:43]
  ds_read_b64_tr_b16 a[54:55], v5 offset:28672
  s_waitcnt lgkmcnt(8)
  v_mfma_f32_16x16x32_bf16 v[48:51], a[8:11], a[192:195], v[48:51]
  s_add_u32 m0, s79, 40960
  ds_read_b64_tr_b16 a[40:41], v6 offset:16384
  buffer_load_dwordx4 a[132:135], v9, s[4:7], s63 offen offset:0 sc1
  s_add_u32 s92, s92, 458752
  s_cmp_lg_u32 s89, 0
  s_cselect_b32 s93, -2228224, 0
  s_cselect_b32 s43, s78, 0
  v_mfma_f32_16x16x32_bf16 v[48:51], a[24:27], a[200:203], v[48:51]
  s_sub_u32 s93, s93, s43
  ds_read_b64_tr_b16 a[42:43], v6 offset:20480
  s_add_u32 s93, s93, s92
  v_mfma_f32_16x16x32_bf16 v[52:55], a[24:27], a[204:207], v[52:55]
  ds_read_b64_tr_b16 a[56:57], v6 offset:24576
  buffer_load_dwordx4 v252, s[80:83], s93 offen lds
  v_mfma_f32_16x16x32_bf16 v[52:55], a[8:11], a[196:199], v[52:55]
  ds_read_b64_tr_b16 a[58:59], v6 offset:28672
  v_mfma_f32_16x16x32_bf16 v[60:63], a[12:15], a[196:199], v[60:63]
  ds_read_b64_tr_b16 a[44:45], v7 offset:16384
  buffer_load_dwordx4 v252, s[84:87], s93 offen offset:1024 lds
  v_mfma_f32_16x16x32_bf16 v[60:63], a[28:31], a[204:207], v[60:63]
  s_min_u32 s63, s89, 4096
  ds_read_b64_tr_b16 a[46:47], v7 offset:20480
  s_add_u32 s63, s63, s48
  v_mfma_f32_16x16x32_bf16 v[56:59], a[28:31], a[200:203], v[56:59]
  ds_read_b64_tr_b16 a[60:61], v7 offset:24576
  buffer_load_dwordx4 a[136:139], v8, s[4:7], s63 offen offset:1024 sc1
  v_mfma_f32_16x16x32_bf16 v[56:59], a[12:15], a[192:195], v[56:59]
  s_waitcnt vmcnt(23) lgkmcnt(7)
  ds_read_b64_tr_b16 a[62:63], v7 offset:28672
  buffer_load_dwordx4 a[140:143], v9, s[4:7], s63 offen offset:1024 sc1
  v_mfma_f32_16x16x32_bf16 v[32:35], a[32:35], a[208:211], v[32:35]
  s_add_u32 m0, s79, 49152
  ds_read_b64_tr_b16 a[0:1], v4 offset:32768
  s_add_u32 s92, s92, 458752
  s_cmp_lg_u32 s90, 0
  s_cselect_b32 s93, -2490368, 0
  s_cselect_b32 s43, s78, 0
  v_mfma_f32_16x16x32_bf16 v[32:35], a[48:51], a[216:219], v[32:35]
  s_sub_u32 s93, s93, s43
  ds_read_b64_tr_b16 a[2:3], v4 offset:36864
  s_add_u32 s93, s93, s92
  v_mfma_f32_16x16x32_bf16 v[36:39], a[48:51], a[220:223], v[36:39]
  ds_read_b64_tr_b16 a[16:17], v4 offset:40960
  buffer_load_dwordx4 v252, s[80:83], s93 offen lds
  v_mfma_f32_16x16x32_bf16 v[36:39], a[32:35], a[212:215], v[36:39]
  ds_read_b64_tr_b16 a[18:19], v4 offset:45056
  v_mfma_f32_16x16x32_bf16 v[44:47], a[36:39], a[212:215], v[44:47]
  ds_read_b64_tr_b16 a[4:5], v5 offset:32768
  buffer_load_dwordx4 v252, s[84:87], s93 offen offset:1024 lds
  v_mfma_f32_16x16x32_bf16 v[44:47], a[52:55], a[220:223], v[44:47]
  s_min_u32 s63, s90, 4096
  ds_read_b64_tr_b16 a[6:7], v5 offset:36864
  s_add_u32 s63, s63, s48
  v_mfma_f32_16x16x32_bf16 v[40:43], a[52:55], a[216:219], v[40:43]
  ds_read_b64_tr_b16 a[20:21], v5 offset:40960
  buffer_load_dwordx4 a[144:147], v8, s[4:7], s63 offen offset:2048 sc1
  v_mfma_f32_16x16x32_bf16 v[40:43], a[36:39], a[208:211], v[40:43]
  ds_read_b64_tr_b16 a[22:23], v5 offset:45056
  s_waitcnt lgkmcnt(8)
  v_mfma_f32_16x16x32_bf16 v[48:51], a[40:43], a[208:211], v[48:51]
  s_add_u32 m0, s79, 57344
  ds_read_b64_tr_b16 a[8:9], v6 offset:32768
  buffer_load_dwordx4 a[148:151], v9, s[4:7], s63 offen offset:2048 sc1
  s_add_u32 s92, s92, 458752
  s_cmp_lg_u32 s91, 0
  s_cselect_b32 s93, -2686976, 0
  s_cselect_b32 s43, s78, 0
  v_mfma_f32_16x16x32_bf16 v[48:51], a[56:59], a[216:219], v[48:51]
  s_sub_u32 s93, s93, s43
  ds_read_b64_tr_b16 a[10:11], v6 offset:36864
  s_add_u32 s93, s93, s92
  v_mfma_f32_16x16x32_bf16 v[52:55], a[56:59], a[220:223], v[52:55]
  ds_read_b64_tr_b16 a[24:25], v6 offset:40960
  buffer_load_dwordx4 v252, s[80:83], s93 offen lds
  v_mfma_f32_16x16x32_bf16 v[52:55], a[40:43], a[212:215], v[52:55]
  ds_read_b64_tr_b16 a[26:27], v6 offset:45056
  v_mfma_f32_16x16x32_bf16 v[60:63], a[44:47], a[212:215], v[60:63]
  ds_read_b64_tr_b16 a[12:13], v7 offset:32768
  buffer_load_dwordx4 v252, s[84:87], s93 offen offset:1024 lds
  v_mfma_f32_16x16x32_bf16 v[60:63], a[60:63], a[220:223], v[60:63]
  s_min_u32 s63, s91, 4096
  ds_read_b64_tr_b16 a[14:15], v7 offset:36864
  s_add_u32 s63, s63, s48
  v_mfma_f32_16x16x32_bf16 v[56:59], a[60:63], a[216:219], v[56:59]
  ds_read_b64_tr_b16 a[28:29], v7 offset:40960
  buffer_load_dwordx4 a[152:155], v8, s[4:7], s63 offen offset:3072 sc1
  v_mfma_f32_16x16x32_bf16 v[56:59], a[44:47], a[208:211], v[56:59]
  s_waitcnt vmcnt(23) lgkmcnt(7)
  ds_read_b64_tr_b16 a[30:31], v7 offset:45056
  buffer_load_dwordx4 a[156:159], v9, s[4:7], s63 offen offset:3072 sc1
  v_mfma_f32_16x16x32_bf16 v[32:35], a[0:3], a[224:227], v[32:35]
  s_waitcnt vmcnt(26)
  s_barrier
  ds_read_b64_tr_b16 a[32:33], v4 offset:49152
  v_mfma_f32_16x16x32_bf16 v[32:35], a[16:19], a[232:235], v[32:35]
  s_add_u32 s48, s48, 4096
  ds_read_b64_tr_b16 a[34:35], v4 offset:53248
  s_min_u32 s63, s88, 4096
  s_mul_i32 s63, s63, -13
  v_mfma_f32_16x16x32_bf16 v[36:39], a[16:19], a[236:239], v[36:39]
  s_add_u32 s63, s63, s48
  ds_read_b64_tr_b16 a[48:49], v4 offset:57344
  buffer_load_dwordx4 a[160:163], v8, s[4:7], s63 offen offset:0 sc1
  v_mfma_f32_16x16x32_bf16 v[36:39], a[0:3], a[228:231], v[36:39]
  ds_read_b64_tr_b16 a[50:51], v4 offset:61440
  v_mfma_f32_16x16x32_bf16 v[44:47], a[4:7], a[228:231], v[44:47]
  ds_read_b64_tr_b16 a[36:37], v5 offset:49152
  v_mfma_f32_16x16x32_bf16 v[44:47], a[20:23], a[236:239], v[44:47]
  ds_read_b64_tr_b16 a[38:39], v5 offset:53248
  v_mfma_f32_16x16x32_bf16 v[40:43], a[20:23], a[232:235], v[40:43]
  ds_read_b64_tr_b16 a[52:53], v5 offset:57344
  buffer_load_dwordx4 a[164:167], v9, s[4:7], s63 offen offset:0 sc1
  v_mfma_f32_16x16x32_bf16 v[40:43], a[4:7], a[224:227], v[40:43]
  ds_read_b64_tr_b16 a[54:55], v5 offset:61440
  s_waitcnt lgkmcnt(8)
  v_mfma_f32_16x16x32_bf16 v[48:51], a[8:11], a[224:227], v[48:51]
  ds_read_b64_tr_b16 a[40:41], v6 offset:49152
  v_mfma_f32_16x16x32_bf16 v[48:51], a[24:27], a[232:235], v[48:51]
  s_min_u32 s63, s89, 4096
  ds_read_b64_tr_b16 a[42:43], v6 offset:53248
  s_mul_i32 s63, s63, -13
  v_mfma_f32_16x16x32_bf16 v[52:55], a[24:27], a[236:239], v[52:55]
  s_add_u32 s63, s63, s48
  ds_read_b64_tr_b16 a[56:57], v6 offset:57344
  buffer_load_dwordx4 a[168:171], v8, s[4:7], s63 offen offset:1024 sc1
  v_mfma_f32_16x16x32_bf16 v[52:55], a[8:11], a[228:231], v[52:55]
  ds_read_b64_tr_b16 a[58:59], v6 offset:61440
  v_mfma_f32_16x16x32_bf16 v[60:63], a[12:15], a[228:231], v[60:63]
  ds_read_b64_tr_b16 a[44:45], v7 offset:49152
  v_mfma_f32_16x16x32_bf16 v[60:63], a[28:31], a[236:239], v[60:63]
  ds_read_b64_tr_b16 a[46:47], v7 offset:53248
  v_mfma_f32_16x16x32_bf16 v[56:59], a[28:31], a[232:235], v[56:59]
  ds_read_b64_tr_b16 a[60:61], v7 offset:57344
  buffer_load_dwordx4 a[172:175], v9, s[4:7], s63 offen offset:1024 sc1
  v_mfma_f32_16x16x32_bf16 v[56:59], a[12:15], a[224:227], v[56:59]
  ds_read_b64_tr_b16 a[62:63], v7 offset:61440
  s_waitcnt vmcnt(20) lgkmcnt(8)
  v_mfma_f32_16x16x32_bf16 v[32:35], a[32:35], a[240:243], v[32:35]
  ds_read_b64_tr_b16 a[0:1], v0 offset:0
  v_mfma_f32_16x16x32_bf16 v[32:35], a[48:51], a[248:251], v[32:35]
  s_min_u32 s63, s90, 4096
  ds_read_b64_tr_b16 a[2:3], v0 offset:4096
  s_mul_i32 s63, s63, -13
  v_mfma_f32_16x16x32_bf16 v[36:39], a[48:51], a[252:255], v[36:39]
  s_add_u32 s63, s63, s48
  ds_read_b64_tr_b16 a[16:17], v0 offset:8192
  buffer_load_dwordx4 a[176:179], v8, s[4:7], s63 offen offset:2048 sc1
  v_mfma_f32_16x16x32_bf16 v[36:39], a[32:35], a[244:247], v[36:39]
  ds_read_b64_tr_b16 a[18:19], v0 offset:12288
  v_mfma_f32_16x16x32_bf16 v[44:47], a[36:39], a[244:247], v[44:47]
  ds_read_b64_tr_b16 a[4:5], v1 offset:0
  v_mfma_f32_16x16x32_bf16 v[44:47], a[52:55], a[252:255], v[44:47]
  ds_read_b64_tr_b16 a[6:7], v1 offset:4096
  v_mfma_f32_16x16x32_bf16 v[40:43], a[52:55], a[248:251], v[40:43]
  ds_read_b64_tr_b16 a[20:21], v1 offset:8192
  buffer_load_dwordx4 a[180:183], v9, s[4:7], s63 offen offset:2048 sc1
  v_mfma_f32_16x16x32_bf16 v[40:43], a[36:39], a[240:243], v[40:43]
  ds_read_b64_tr_b16 a[22:23], v1 offset:12288
  s_waitcnt lgkmcnt(8)
  v_mfma_f32_16x16x32_bf16 v[48:51], a[40:43], a[240:243], v[48:51]
  ds_read_b64_tr_b16 a[8:9], v2 offset:0
  v_mfma_f32_16x16x32_bf16 v[48:51], a[56:59], a[248:251], v[48:51]
  s_min_u32 s63, s91, 4096
  ds_read_b64_tr_b16 a[10:11], v2 offset:4096
  s_mul_i32 s63, s63, -13
  v_mfma_f32_16x16x32_bf16 v[52:55], a[56:59], a[252:255], v[52:55]
  s_add_u32 s63, s63, s48
  ds_read_b64_tr_b16 a[24:25], v2 offset:8192
  buffer_load_dwordx4 a[184:187], v8, s[4:7], s63 offen offset:3072 sc1
  v_mfma_f32_16x16x32_bf16 v[52:55], a[40:43], a[244:247], v[52:55]
  ds_read_b64_tr_b16 a[26:27], v2 offset:12288
  v_mfma_f32_16x16x32_bf16 v[60:63], a[44:47], a[244:247], v[60:63]
  ds_read_b64_tr_b16 a[12:13], v3 offset:0
  v_mfma_f32_16x16x32_bf16 v[60:63], a[60:63], a[252:255], v[60:63]
  ds_read_b64_tr_b16 a[14:15], v3 offset:4096
  v_mfma_f32_16x16x32_bf16 v[56:59], a[60:63], a[248:251], v[56:59]
  ds_read_b64_tr_b16 a[28:29], v3 offset:8192
  buffer_load_dwordx4 a[188:191], v9, s[4:7], s63 offen offset:3072 sc1
  v_mfma_f32_16x16x32_bf16 v[56:59], a[44:47], a[240:243], v[56:59]
  ds_read_b64_tr_b16 a[30:31], v3 offset:12288
  s_waitcnt vmcnt(16) lgkmcnt(8)
  v_mfma_f32_16x16x32_bf16 v[32:35], a[0:3], a[128:131], v[32:35]
  s_waitcnt vmcnt(18)
  s_barrier
  ds_read_b64_tr_b16 a[32:33], v0 offset:16384
  v_mfma_f32_16x16x32_bf16 v[32:35], a[16:19], a[136:139], v[32:35]
  ds_read_b64_tr_b16 a[34:35], v0 offset:20480
  v_mfma_f32_16x16x32_bf16 v[36:39], a[16:19], a[140:143], v[36:39]
  ds_read_b64_tr_b16 a[48:49], v0 offset:24576
  v_mfma_f32_16x16x32_bf16 v[36:39], a[0:3], a[132:135], v[36:39]
  ds_read_b64_tr_b16 a[50:51], v0 offset:28672
  v_mfma_f32_16x16x32_bf16 v[44:47], a[4:7], a[132:135], v[44:47]
  ds_read_b64_tr_b16 a[36:37], v1 offset:16384
  v_mfma_f32_16x16x32_bf16 v[44:47], a[20:23], a[140:143], v[44:47]
  ds_read_b64_tr_b16 a[38:39], v1 offset:20480
  v_mfma_f32_16x16x32_bf16 v[40:43], a[20:23], a[136:139], v[40:43]
  ds_read_b64_tr_b16 a[52:53], v1 offset:24576
  v_mfma_f32_16x16x32_bf16 v[40:43], a[4:7], a[128:131], v[40:43]
  ds_read_b64_tr_b16 a[54:55], v1 offset:28672
  s_waitcnt lgkmcnt(8)
  v_mfma_f32_16x16x32_bf16 v[48:51], a[8:11], a[128:131], v[48:51]
  ds_read_b64_tr_b16 a[40:41], v2 offset:16384
  v_mfma_f32_16x16x32_bf16 v[48:51], a[24:27], a[136:139], v[48:51]
  ds_read_b64_tr_b16 a[42:43], v2 offset:20480
  v_mfma_f32_16x16x32_bf16 v[52:55], a[24:27], a[140:143], v[52:55]
  ds_read_b64_tr_b16 a[56:57], v2 offset:24576
  v_mfma_f32_16x16x32_bf16 v[52:55], a[8:11], a[132:135], v[52:55]
  ds_read_b64_tr_b16 a[58:59], v2 offset:28672
  v_mfma_f32_16x16x32_bf16 v[60:63], a[12:15], a[132:135], v[60:63]
  ds_read_b64_tr_b16 a[44:45], v3 offset:16384
  v_mfma_f32_16x16x32_bf16 v[60:63], a[28:31], a[140:143], v[60:63]
  ds_read_b64_tr_b16 a[46:47], v3 offset:20480
  v_mfma_f32_16x16x32_bf16 v[56:59], a[28:31], a[136:139], v[56:59]
  ds_read_b64_tr_b16 a[60:61], v3 offset:24576
  v_mfma_f32_16x16x32_bf16 v[56:59], a[12:15], a[128:131], v[56:59]
  ds_read_b64_tr_b16 a[62:63], v3 offset:28672
  s_waitcnt vmcnt(8) lgkmcnt(8)
  v_mfma_f32_16x16x32_bf16 v[32:35], a[32:35], a[144:147], v[32:35]
  ds_read_b64_tr_b16 a[0:1], v0 offset:32768
  v_mfma_f32_16x16x32_bf16 v[32:35], a[48:51], a[152:155], v[32:35]
  ds_read_b64_tr_b16 a[2:3], v0 offset:36864
  v_mfma_f32_16x16x32_bf16 v[36:39], a[48:51], a[156:159], v[36:39]
  ds_read_b64_tr_b16 a[16:17], v0 offset:40960
  v_mfma_f32_16x16x32_bf16 v[36:39], a[32:35], a[148:151], v[36:39]
  ds_read_b64_tr_b16 a[18:19], v0 offset:45056
  v_mfma_f32_16x16x32_bf16 v[44:47], a[36:39], a[148:151], v[44:47]
  ds_read_b64_tr_b16 a[4:5], v1 offset:32768
  v_mfma_f32_16x16x32_bf16 v[44:47], a[52:55], a[156:159], v[44:47]
  ds_read_b64_tr_b16 a[6:7], v1 offset:36864
  v_mfma_f32_16x16x32_bf16 v[40:43], a[52:55], a[152:155], v[40:43]
  ds_read_b64_tr_b16 a[20:21], v1 offset:40960
  v_mfma_f32_16x16x32_bf16 v[40:43], a[36:39], a[144:147], v[40:43]
  ds_read_b64_tr_b16 a[22:23], v1 offset:45056
  s_waitcnt lgkmcnt(8)
  v_mfma_f32_16x16x32_bf16 v[48:51], a[40:43], a[144:147], v[48:51]
  ds_read_b64_tr_b16 a[8:9], v2 offset:32768
  v_mfma_f32_16x16x32_bf16 v[48:51], a[56:59], a[152:155], v[48:51]
  ds_read_b64_tr_b16 a[10:11], v2 offset:36864
  v_mfma_f32_16x16x32_bf16 v[52:55], a[56:59], a[156:159], v[52:55]
  ds_read_b64_tr_b16 a[24:25], v2 offset:40960
  v_mfma_f32_16x16x32_bf16 v[52:55], a[40:43], a[148:151], v[52:55]
  ds_read_b64_tr_b16 a[26:27], v2 offset:45056
  v_mfma_f32_16x16x32_bf16 v[60:63], a[44:47], a[148:151], v[60:63]
  ds_read_b64_tr_b16 a[12:13], v3 offset:32768
  v_mfma_f32_16x16x32_bf16 v[60:63], a[60:63], a[156:159], v[60:63]
  ds_read_b64_tr_b16 a[14:15], v3 offset:36864
  v_mfma_f32_16x16x32_bf16 v[56:59], a[60:63], a[152:155], v[56:59]
  ds_read_b64_tr_b16 a[28:29], v3 offset:40960
  v_mfma_f32_16x16x32_bf16 v[56:59], a[44:47], a[144:147], v[56:59]
  ds_read_b64_tr_b16 a[30:31], v3 offset:45056
  s_waitcnt vmcnt(4) lgkmcnt(8)
  v_mfma_f32_16x16x32_bf16 v[32:35], a[0:3], a[160:163], v[32:35]
  s_waitcnt vmcnt(10)
  s_barrier
  ds_read_b64_tr_b16 a[32:33], v0 offset:49152
  v_mfma_f32_16x16x32_bf16 v[32:35], a[16:19], a[168:171], v[32:35]
  ds_read_b64_tr_b16 a[34:35], v0 offset:53248
  v_mfma_f32_16x16x32_bf16 v[36:39], a[16:19], a[172:175], v[36:39]
  ds_read_b64_tr_b16 a[48:49], v0 offset:57344
  v_mfma_f32_16x16x32_bf16 v[36:39], a[0:3], a[164:167], v[36:39]
  ds_read_b64_tr_b16 a[50:51], v0 offset:61440
  v_mfma_f32_16x16x32_bf16 v[44:47], a[4:7], a[164:167], v[44:47]
  ds_read_b64_tr_b16 a[36:37], v1 offset:49152
  v_mfma_f32_16x16x32_bf16 v[44:47], a[20:23], a[172:175], v[44:47]
  ds_read_b64_tr_b16 a[38:39], v1 offset:53248
  v_mfma_f32_16x16x32_bf16 v[40:43], a[20:23], a[168:171], v[40:43]
  ds_read_b64_tr_b16 a[52:53], v1 offset:57344
  v_mfma_f32_16x16x32_bf16 v[40:43], a[4:7], a[160:163], v[40:43]
  ds_read_b64_tr_b16 a[54:55], v1 offset:61440
  s_waitcnt lgkmcnt(8)
  v_mfma_f32_16x16x32_bf16 v[48:51], a[8:11], a[160:163], v[48:51]
  ds_read_b64_tr_b16 a[40:41], v2 offset:49152
  v_mfma_f32_16x16x32_bf16 v[48:51], a[24:27], a[168:171], v[48:51]
  ds_read_b64_tr_b16 a[42:43], v2 offset:53248
  v_mfma_f32_16x16x32_bf16 v[52:55], a[24:27], a[172:175], v[52:55]
  ds_read_b64_tr_b16 a[56:57], v2 offset:57344
  v_mfma_f32_16x16x32_bf16 v[52:55], a[8:11], a[164:167], v[52:55]
  ds_read_b64_tr_b16 a[58:59], v2 offset:61440
  v_mfma_f32_16x16x32_bf16 v[60:63], a[12:15], a[164:167], v[60:63]
  ds_read_b64_tr_b16 a[44:45], v3 offset:49152
  v_mfma_f32_16x16x32_bf16 v[60:63], a[28:31], a[172:175], v[60:63]
  ds_read_b64_tr_b16 a[46:47], v3 offset:53248
  v_mfma_f32_16x16x32_bf16 v[56:59], a[28:31], a[168:171], v[56:59]
  ds_read_b64_tr_b16 a[60:61], v3 offset:57344
  v_mfma_f32_16x16x32_bf16 v[56:59], a[12:15], a[160:163], v[56:59]
  ds_read_b64_tr_b16 a[62:63], v3 offset:61440
  s_waitcnt vmcnt(0) lgkmcnt(8)
  v_mfma_f32_16x16x32_bf16 v[32:35], a[32:35], a[176:179], v[32:35]
  ds_read_b64_tr_b16 a[0:1], v4 offset:1024
  v_mfma_f32_16x16x32_bf16 v[32:35], a[48:51], a[184:187], v[32:35]
  ds_read_b64_tr_b16 a[2:3], v4 offset:5120
  v_mfma_f32_16x16x32_bf16 v[36:39], a[48:51], a[188:191], v[36:39]
  ds_read_b64_tr_b16 a[16:17], v4 offset:9216
  v_mfma_f32_16x16x32_bf16 v[36:39], a[32:35], a[180:183], v[36:39]
  ds_read_b64_tr_b16 a[18:19], v4 offset:13312
  v_mfma_f32_16x16x32_bf16 v[44:47], a[36:39], a[180:183], v[44:47]
  ds_read_b64_tr_b16 a[4:5], v5 offset:1024
  v_mfma_f32_16x16x32_bf16 v[44:47], a[52:55], a[188:191], v[44:47]
  ds_read_b64_tr_b16 a[6:7], v5 offset:5120
  v_mfma_f32_16x16x32_bf16 v[40:43], a[52:55], a[184:187], v[40:43]
  ds_read_b64_tr_b16 a[20:21], v5 offset:9216
  v_mfma_f32_16x16x32_bf16 v[40:43], a[36:39], a[176:179], v[40:43]
  ds_read_b64_tr_b16 a[22:23], v5 offset:13312
  s_waitcnt lgkmcnt(8)
  v_mfma_f32_16x16x32_bf16 v[48:51], a[40:43], a[176:179], v[48:51]
  ds_read_b64_tr_b16 a[8:9], v6 offset:1024
  v_mfma_f32_16x16x32_bf16 v[48:51], a[56:59], a[184:187], v[48:51]
  ds_read_b64_tr_b16 a[10:11], v6 offset:5120
  v_mfma_f32_16x16x32_bf16 v[52:55], a[56:59], a[188:191], v[52:55]
  ds_read_b64_tr_b16 a[24:25], v6 offset:9216
  v_mfma_f32_16x16x32_bf16 v[52:55], a[40:43], a[180:183], v[52:55]
  ds_read_b64_tr_b16 a[26:27], v6 offset:13312
  v_mfma_f32_16x16x32_bf16 v[60:63], a[44:47], a[180:183], v[60:63]
  ds_read_b64_tr_b16 a[12:13], v7 offset:1024
  v_mfma_f32_16x16x32_bf16 v[60:63], a[60:63], a[188:191], v[60:63]
  ds_read_b64_tr_b16 a[14:15], v7 offset:5120
  v_mfma_f32_16x16x32_bf16 v[56:59], a[60:63], a[184:187], v[56:59]
  ds_read_b64_tr_b16 a[28:29], v7 offset:9216
  v_mfma_f32_16x16x32_bf16 v[56:59], a[44:47], a[176:179], v[56:59]
  ds_read_b64_tr_b16 a[30:31], v7 offset:13312
  s_waitcnt lgkmcnt(8)
  v_mfma_f32_16x16x32_bf16 v[64:67], a[0:3], a[192:195], v[64:67]
  s_lshl_b32 s45, s2, 2
  ds_read_b64_tr_b16 a[32:33], v4 offset:17408
  s_add_u32 s45, s45, s40
  v_mfma_f32_16x16x32_bf16 v[64:67], a[16:19], a[200:203], v[64:67]
  s_lshl_b32 s45, s45, 12
  ds_read_b64_tr_b16 a[34:35], v4 offset:21504
  s_xor_b32 s44, s45, 32768
  v_mfma_f32_16x16x32_bf16 v[68:71], a[16:19], a[204:207], v[68:71]
  s_add_u32 s43, s42, 28311552
  ds_read_b64_tr_b16 a[48:49], v4 offset:25600
  s_add_u32 s44, s44, s43
  v_mfma_f32_16x16x32_bf16 v[68:71], a[0:3], a[196:199], v[68:71]
  s_add_u32 s45, s45, s43
  ds_read_b64_tr_b16 a[50:51], v4 offset:29696
  v_cvt_pk_bf16_f32 v16, v32, v33
  v_mfma_f32_16x16x32_bf16 v[76:79], a[4:7], a[196:199], v[76:79]
  ds_read_b64_tr_b16 a[36:37], v5 offset:17408
  v_cvt_pk_bf16_f32 v17, v34, v35
  v_cvt_pk_bf16_f32 v18, v40, v41
  v_mfma_f32_16x16x32_bf16 v[76:79], a[20:23], a[204:207], v[76:79]
  ds_read_b64_tr_b16 a[38:39], v5 offset:21504
  v_cvt_pk_bf16_f32 v19, v42, v43
  buffer_store_dwordx4 v[16:19], v8, s[4:7], s44 offen offset:0 sc1
  v_mfma_f32_16x16x32_bf16 v[72:75], a[20:23], a[200:203], v[72:75]
  ds_read_b64_tr_b16 a[52:53], v5 offset:25600
  v_cvt_pk_bf16_f32 v24, v36, v37
  v_cvt_pk_bf16_f32 v25, v38, v39
  v_mfma_f32_16x16x32_bf16 v[72:75], a[4:7], a[192:195], v[72:75]
  s_waitcnt lgkmcnt(7)
  ds_read_b64_tr_b16 a[54:55], v5 offset:29696
  v_cvt_pk_bf16_f32 v26, v44, v45
  v_cvt_pk_bf16_f32 v27, v46, v47
  v_mfma_f32_16x16x32_bf16 v[80:83], a[8:11], a[192:195], v[80:83]
  ds_read_b64_tr_b16 a[40:41], v6 offset:17408
  buffer_store_dwordx4 v[24:27], v8, s[4:7], s44 offen offset:2048 sc1
  v_cvt_pk_bf16_f32 v20, v48, v49
  v_mfma_f32_16x16x32_bf16 v[80:83], a[24:27], a[200:203], v[80:83]
  ds_read_b64_tr_b16 a[42:43], v6 offset:21504
  v_cvt_pk_bf16_f32 v21, v50, v51
  v_cvt_pk_bf16_f32 v22, v56, v57
  v_mfma_f32_16x16x32_bf16 v[84:87], a[24:27], a[204:207], v[84:87]
  ds_read_b64_tr_b16 a[56:57], v6 offset:25600
  v_cvt_pk_bf16_f32 v23, v58, v59
  buffer_store_dwordx4 v[20:23], v8, s[4:7], s44 offen offset:1024 sc1
  v_mfma_f32_16x16x32_bf16 v[84:87], a[8:11], a[196:199], v[84:87]
  ds_read_b64_tr_b16 a[58:59], v6 offset:29696
  v_cvt_pk_bf16_f32 v28, v52, v53
  v_cvt_pk_bf16_f32 v29, v54, v55
  v_mfma_f32_16x16x32_bf16 v[92:95], a[12:15], a[196:199], v[92:95]
  ds_read_b64_tr_b16 a[44:45], v7 offset:17408
  v_cvt_pk_bf16_f32 v30, v60, v61
  v_cvt_pk_bf16_f32 v31, v62, v63
  v_mfma_f32_16x16x32_bf16 v[92:95], a[28:31], a[204:207], v[92:95]
  ds_read_b64_tr_b16 a[46:47], v7 offset:21504
  buffer_store_dwordx4 v[28:31], v8, s[4:7], s44 offen offset:3072 sc1
  v_mfma_f32_16x16x32_bf16 v[88:91], a[28:31], a[200:203], v[88:91]
  ds_read_b64_tr_b16 a[60:61], v7 offset:25600
  v_mfma_f32_16x16x32_bf16 v[88:91], a[12:15], a[192:195], v[88:91]
  ds_read_b64_tr_b16 a[62:63], v7 offset:29696
  s_waitcnt lgkmcnt(8)
  v_mfma_f32_16x16x32_bf16 v[64:67], a[32:35], a[208:211], v[64:67]
  ds_read_b64_tr_b16 a[0:1], v4 offset:33792
  v_and_b32 v148, 15, v253
  v_mfma_f32_16x16x32_bf16 v[64:67], a[48:51], a[216:219], v[64:67]
  ds_read_b64_tr_b16 a[2:3], v4 offset:37888
  v_lshrrev_b32 v149, 4, v253
  v_mfma_f32_16x16x32_bf16 v[68:71], a[48:51], a[220:223], v[68:71]
  ds_read_b64_tr_b16 a[16:17], v4 offset:41984
  v_lshrrev_b32 v128, 2, v148
  v_mfma_f32_16x16x32_bf16 v[68:71], a[32:35], a[212:215], v[68:71]
  ds_read_b64_tr_b16 a[18:19], v4 offset:46080
  v_cmp_eq_u32 vcc, v128, v149
  v_mfma_f32_16x16x32_bf16 v[76:79], a[36:39], a[212:215], v[76:79]
  ds_read_b64_tr_b16 a[4:5], v5 offset:33792
  v_and_b32 v128, 3, v148
  v_mfma_f32_16x16x32_bf16 v[76:79], a[52:55], a[220:223], v[76:79]
  ds_read_b64_tr_b16 a[6:7], v5 offset:37888
  v_lshlrev_b32 v148, 3, v148
  v_mfma_f32_16x16x32_bf16 v[72:75], a[52:55], a[216:219], v[72:75]
  ds_read_b64_tr_b16 a[20:21], v5 offset:41984
  v_mov_b32 v149, 0x7ffffff0
  v_mfma_f32_16x16x32_bf16 v[72:75], a[36:39], a[208:211], v[72:75]
  s_waitcnt lgkmcnt(7)
  ds_read_b64_tr_b16 a[22:23], v5 offset:46080
  v_cndmask_b32 v148, v149, v148, vcc
  v_mfma_f32_16x16x32_bf16 v[80:83], a[40:43], a[208:211], v[80:83]
  ds_read_b64_tr_b16 a[8:9], v6 offset:33792
  v_cmp_eq_u32 s[66:67], 1, v128
  v_mfma_f32_16x16x32_bf16 v[80:83], a[56:59], a[216:219], v[80:83]
  ds_read_b64_tr_b16 a[10:11], v6 offset:37888
  v_cmp_eq_u32 s[68:69], 2, v128
  v_mfma_f32_16x16x32_bf16 v[84:87], a[56:59], a[220:223], v[84:87]
  ds_read_b64_tr_b16 a[24:25], v6 offset:41984
  v_cmp_eq_u32 s[70:71], 3, v128
  v_mfma_f32_16x16x32_bf16 v[84:87], a[40:43], a[212:215], v[84:87]
  ds_read_b64_tr_b16 a[26:27], v6 offset:46080
  v_mov_b32 v128, 0x3f803f80
  v_mfma_f32_16x16x32_bf16 v[92:95], a[44:47], a[212:215], v[92:95]
  ds_read_b64_tr_b16 a[12:13], v7 offset:33792
  v_mov_b32 v129, 0x3f803f80
  v_mfma_f32_16x16x32_bf16 v[92:95], a[60:63], a[220:223], v[92:95]
  ds_read_b64_tr_b16 a[14:15], v7 offset:37888
  v_mov_b32 v130, 0x3f803f80
  v_mfma_f32_16x16x32_bf16 v[88:91], a[60:63], a[216:219], v[88:91]
  ds_read_b64_tr_b16 a[28:29], v7 offset:41984
  v_mov_b32 v131, 0x3f803f80
  v_mfma_f32_16x16x32_bf16 v[88:91], a[44:47], a[208:211], v[88:91]
  ds_read_b64_tr_b16 a[30:31], v7 offset:46080
  s_waitcnt lgkmcnt(8)
  v_mfma_f32_16x16x32_bf16 v[64:67], a[0:3], a[224:227], v[64:67]
  ds_read_b64_tr_b16 a[32:33], v4 offset:50176
  v_and_b32 v152, 15, v253
  v_lshrrev_b32 v153, 4, v253
  v_mfma_f32_16x16x32_bf16 v[64:67], a[16:19], a[232:235], v[64:67]
  ds_read_b64_tr_b16 a[34:35], v4 offset:54272
  v_lshrrev_b32 v155, 1, v153
  v_and_b32 v153, 1, v153
  v_mfma_f32_16x16x32_bf16 v[68:71], a[16:19], a[236:239], v[68:71]
  ds_read_b64_tr_b16 a[48:49], v4 offset:58368
  v_lshl_add_u32 v153, v153, 1, v155
  v_and_b32 v155, 7, v253
  v_mfma_f32_16x16x32_bf16 v[68:71], a[0:3], a[228:231], v[68:71]
  ds_read_b64_tr_b16 a[50:51], v4 offset:62464
  v_xor_b32 v153, v153, v155
  v_lshlrev_b32 v153, 4, v153
  v_mfma_f32_16x16x32_bf16 v[76:79], a[4:7], a[228:231], v[76:79]
  s_lshl_b32 s43, s40, 12
  ds_read_b64_tr_b16 a[36:37], v5 offset:50176
  v_lshl_add_u32 v152, v152, 7, v153
  v_mfma_f32_16x16x32_bf16 v[76:79], a[20:23], a[236:239], v[76:79]
  ds_read_b64_tr_b16 a[38:39], v5 offset:54272
  v_add_u32 v152, s43, v152
  v_xor_b32 v153, 64, v152
  v_mfma_f32_16x16x32_bf16 v[72:75], a[20:23], a[232:235], v[72:75]
  ds_read_b64_tr_b16 a[52:53], v5 offset:58368
  v_lshrrev_b32 v156, 3, v253
  v_xor_b32 v154, v156, v155
  v_mfma_f32_16x16x32_bf16 v[72:75], a[4:7], a[224:227], v[72:75]
  s_waitcnt lgkmcnt(7)
  ds_read_b64_tr_b16 a[54:55], v5 offset:62464
  v_lshlrev_b32 v154, 4, v154
  v_lshl_add_u32 v154, v156, 7, v154
  v_mfma_f32_16x16x32_bf16 v[80:83], a[8:11], a[224:227], v[80:83]
  ds_read_b64_tr_b16 a[40:41], v6 offset:50176
  v_add_u32 v154, s43, v154
  v_lshlrev_b32 v155, 4, v155
  v_mfma_f32_16x16x32_bf16 v[80:83], a[24:27], a[232:235], v[80:83]
  ds_read_b64_tr_b16 a[42:43], v6 offset:54272
  v_lshl_add_u32 v155, v156, 12, v155
  v_mfma_f32_16x16x32_bf16 v[84:87], a[24:27], a[236:239], v[84:87]
  ds_read_b64_tr_b16 a[56:57], v6 offset:58368
  v_mfma_f32_16x16x32_bf16 v[84:87], a[8:11], a[228:231], v[84:87]
  ds_read_b64_tr_b16 a[58:59], v6 offset:62464
  v_mfma_f32_16x16x32_bf16 v[92:95], a[12:15], a[228:231], v[92:95]
  ds_read_b64_tr_b16 a[44:45], v7 offset:50176
  v_mfma_f32_16x16x32_bf16 v[92:95], a[28:31], a[236:239], v[92:95]
  ds_read_b64_tr_b16 a[46:47], v7 offset:54272
  v_mfma_f32_16x16x32_bf16 v[88:91], a[28:31], a[232:235], v[88:91]
  ds_read_b64_tr_b16 a[60:61], v7 offset:58368
  v_mfma_f32_16x16x32_bf16 v[88:91], a[12:15], a[224:227], v[88:91]
  ds_read_b64_tr_b16 a[62:63], v7 offset:62464
  s_waitcnt lgkmcnt(8)
  v_mfma_f32_16x16x32_bf16 v[64:67], a[32:35], a[240:243], v[64:67]
  s_add_u32 s46, s76, 41943040
  ds_read_b64_tr_b16 a[0:1], v0 offset:1024
  s_add_u32 s47, s46, 32768
  v_mfma_f32_16x16x32_bf16 v[64:67], a[48:51], a[248:251], v[64:67]
  s_lshl_b32 s48, s49, 11
  ds_read_b64_tr_b16 a[2:3], v0 offset:5120
  s_lshl_b32 s43, s53, 7
  v_mfma_f32_16x16x32_bf16 v[68:71], a[48:51], a[252:255], v[68:71]
  s_add_u32 s48, s48, s43
  ds_read_b64_tr_b16 a[16:17], v0 offset:9216
  s_add_u32 s48, s48, 69206016
  v_mfma_f32_16x16x32_bf16 v[68:71], a[32:35], a[244:247], v[68:71]
  s_and_b32 s57, s49, 63
  ds_read_b64_tr_b16 a[18:19], v0 offset:13312
  s_lshl_b32 s57, s57, 16
  v_mfma_f32_16x16x32_bf16 v[76:79], a[36:39], a[244:247], v[76:79]
  s_add_u32 s57, s57, s43
  ds_read_b64_tr_b16 a[4:5], v1 offset:1024
  s_lshr_b32 s43, s49, 6
  v_mfma_f32_16x16x32_bf16 v[76:79], a[52:55], a[252:255], v[76:79]
  s_lshl_b32 s43, s43, 11
  ds_read_b64_tr_b16 a[6:7], v1 offset:5120
  s_add_u32 s57, s57, s43
  v_mfma_f32_16x16x32_bf16 v[72:75], a[52:55], a[248:251], v[72:75]
  s_lshl_b32 s77, s52, 7
  ds_read_b64_tr_b16 a[20:21], v1 offset:9216
  s_add_u32 s77, s77, 27792384
  v_mfma_f32_16x16x32_bf16 v[72:75], a[36:39], a[240:243], v[72:75]
  ds_read_b64_tr_b16 a[22:23], v1 offset:13312
  s_waitcnt lgkmcnt(8)
  v_mfma_f32_16x16x32_bf16 v[80:83], a[40:43], a[240:243], v[80:83]
  ds_read_b64_tr_b16 a[8:9], v2 offset:1024
  v_mfma_f32_16x16x32_bf16 v[80:83], a[56:59], a[248:251], v[80:83]
  ds_read_b64_tr_b16 a[10:11], v2 offset:5120
  v_mfma_f32_16x16x32_bf16 v[84:87], a[56:59], a[252:255], v[84:87]
  ds_read_b64_tr_b16 a[24:25], v2 offset:9216
  v_mfma_f32_16x16x32_bf16 v[84:87], a[40:43], a[244:247], v[84:87]
  ds_read_b64_tr_b16 a[26:27], v2 offset:13312
  v_mfma_f32_16x16x32_bf16 v[92:95], a[44:47], a[244:247], v[92:95]
  ds_read_b64_tr_b16 a[12:13], v3 offset:1024
  v_mfma_f32_16x16x32_bf16 v[92:95], a[60:63], a[252:255], v[92:95]
  ds_read_b64_tr_b16 a[14:15], v3 offset:5120
  v_mfma_f32_16x16x32_bf16 v[88:91], a[60:63], a[248:251], v[88:91]
  ds_read_b64_tr_b16 a[28:29], v3 offset:9216
  v_mfma_f32_16x16x32_bf16 v[88:91], a[44:47], a[240:243], v[88:91]
  ds_read_b64_tr_b16 a[30:31], v3 offset:13312
  s_waitcnt lgkmcnt(8)
  v_mfma_f32_16x16x32_bf16 v[64:67], a[0:3], a[128:131], v[64:67]
  ds_read_b64_tr_b16 a[32:33], v0 offset:17408
  v_mfma_f32_16x16x32_bf16 v[64:67], a[16:19], a[136:139], v[64:67]
  ds_read_b64_tr_b16 a[34:35], v0 offset:21504
  v_mfma_f32_16x16x32_bf16 v[68:71], a[16:19], a[140:143], v[68:71]
  ds_read_b64_tr_b16 a[48:49], v0 offset:25600
  v_mfma_f32_16x16x32_bf16 v[68:71], a[0:3], a[132:135], v[68:71]
  ds_read_b64_tr_b16 a[50:51], v0 offset:29696
  v_mfma_f32_16x16x32_bf16 v[76:79], a[4:7], a[132:135], v[76:79]
  ds_read_b64_tr_b16 a[36:37], v1 offset:17408
  v_mfma_f32_16x16x32_bf16 v[76:79], a[20:23], a[140:143], v[76:79]
  ds_read_b64_tr_b16 a[38:39], v1 offset:21504
  v_mfma_f32_16x16x32_bf16 v[72:75], a[20:23], a[136:139], v[72:75]
  ds_read_b64_tr_b16 a[52:53], v1 offset:25600
  v_mfma_f32_16x16x32_bf16 v[72:75], a[4:7], a[128:131], v[72:75]
  ds_read_b64_tr_b16 a[54:55], v1 offset:29696
  s_waitcnt lgkmcnt(8)
  v_mfma_f32_16x16x32_bf16 v[80:83], a[8:11], a[128:131], v[80:83]
  ds_read_b64_tr_b16 a[40:41], v2 offset:17408
  v_mfma_f32_16x16x32_bf16 v[80:83], a[24:27], a[136:139], v[80:83]
  ds_read_b64_tr_b16 a[42:43], v2 offset:21504
  v_mfma_f32_16x16x32_bf16 v[84:87], a[24:27], a[140:143], v[84:87]
  ds_read_b64_tr_b16 a[56:57], v2 offset:25600
  v_mfma_f32_16x16x32_bf16 v[84:87], a[8:11], a[132:135], v[84:87]
  ds_read_b64_tr_b16 a[58:59], v2 offset:29696
  v_mfma_f32_16x16x32_bf16 v[92:95], a[12:15], a[132:135], v[92:95]
  ds_read_b64_tr_b16 a[44:45], v3 offset:17408
  v_mfma_f32_16x16x32_bf16 v[92:95], a[28:31], a[140:143], v[92:95]
  ds_read_b64_tr_b16 a[46:47], v3 offset:21504
  v_mfma_f32_16x16x32_bf16 v[88:91], a[28:31], a[136:139], v[88:91]
  ds_read_b64_tr_b16 a[60:61], v3 offset:25600
  v_mfma_f32_16x16x32_bf16 v[88:91], a[12:15], a[128:131], v[88:91]
  ds_read_b64_tr_b16 a[62:63], v3 offset:29696
  s_waitcnt lgkmcnt(8)
  v_mfma_f32_16x16x32_bf16 v[64:67], a[32:35], a[144:147], v[64:67]
  ds_read_b64_tr_b16 a[0:1], v0 offset:33792
  v_mfma_f32_16x16x32_bf16 v[64:67], a[48:51], a[152:155], v[64:67]
  ds_read_b64_tr_b16 a[2:3], v0 offset:37888
  v_mfma_f32_16x16x32_bf16 v[68:71], a[48:51], a[156:159], v[68:71]
  ds_read_b64_tr_b16 a[16:17], v0 offset:41984
  v_mfma_f32_16x16x32_bf16 v[68:71], a[32:35], a[148:151], v[68:71]
  ds_read_b64_tr_b16 a[18:19], v0 offset:46080
  v_mfma_f32_16x16x32_bf16 v[76:79], a[36:39], a[148:151], v[76:79]
  ds_read_b64_tr_b16 a[4:5], v1 offset:33792
  buffer_load_dwordx4 v[96:99], v8, s[4:7], s45 offen offset:0 sc1
  buffer_load_dwordx4 v[100:103], v8, s[4:7], s45 offen offset:1024 sc1
  v_mfma_f32_16x16x32_bf16 v[76:79], a[52:55], a[156:159], v[76:79]
  ds_read_b64_tr_b16 a[6:7], v1 offset:37888
  v_mfma_f32_16x16x32_bf16 v[72:75], a[52:55], a[152:155], v[72:75]
  ds_read_b64_tr_b16 a[20:21], v1 offset:41984
  buffer_load_dwordx4 v[104:107], v8, s[4:7], s45 offen offset:2048 sc1
  buffer_load_dwordx4 v[108:111], v8, s[4:7], s45 offen offset:3072 sc1
  v_mfma_f32_16x16x32_bf16 v[72:75], a[36:39], a[144:147], v[72:75]
  ds_read_b64_tr_b16 a[22:23], v1 offset:46080
  s_waitcnt lgkmcnt(8)
  v_mfma_f32_16x16x32_bf16 v[80:83], a[40:43], a[144:147], v[80:83]
  ds_read_b64_tr_b16 a[8:9], v2 offset:33792
  v_mfma_f32_16x16x32_bf16 v[80:83], a[56:59], a[152:155], v[80:83]
  ds_read_b64_tr_b16 a[10:11], v2 offset:37888
  v_mfma_f32_16x16x32_bf16 v[84:87], a[56:59], a[156:159], v[84:87]
  ds_read_b64_tr_b16 a[24:25], v2 offset:41984
  v_mfma_f32_16x16x32_bf16 v[84:87], a[40:43], a[148:151], v[84:87]
  ds_read_b64_tr_b16 a[26:27], v2 offset:46080
  v_mfma_f32_16x16x32_bf16 v[92:95], a[44:47], a[148:151], v[92:95]
  ds_read_b64_tr_b16 a[12:13], v3 offset:33792
  v_mfma_f32_16x16x32_bf16 v[92:95], a[60:63], a[156:159], v[92:95]
  ds_read_b64_tr_b16 a[14:15], v3 offset:37888
  v_mfma_f32_16x16x32_bf16 v[88:91], a[60:63], a[152:155], v[88:91]
  ds_read_b64_tr_b16 a[28:29], v3 offset:41984
  v_mfma_f32_16x16x32_bf16 v[88:91], a[44:47], a[144:147], v[88:91]
  ds_read_b64_tr_b16 a[30:31], v3 offset:46080
  s_waitcnt lgkmcnt(8)
  v_mfma_f32_16x16x32_bf16 v[64:67], a[0:3], a[160:163], v[64:67]
  ds_read_b64_tr_b16 a[32:33], v0 offset:50176
  v_mfma_f32_16x16x32_bf16 v[64:67], a[16:19], a[168:171], v[64:67]
  ds_read_b64_tr_b16 a[34:35], v0 offset:54272
  v_mfma_f32_16x16x32_bf16 v[68:71], a[16:19], a[172:175], v[68:71]
  ds_read_b64_tr_b16 a[48:49], v0 offset:58368
  v_mfma_f32_16x16x32_bf16 v[68:71], a[0:3], a[164:167], v[68:71]
  ds_read_b64_tr_b16 a[50:51], v0 offset:62464
  v_mfma_f32_16x16x32_bf16 v[76:79], a[4:7], a[164:167], v[76:79]
  ds_read_b64_tr_b16 a[36:37], v1 offset:50176
  v_mfma_f32_16x16x32_bf16 v[76:79], a[20:23], a[172:175], v[76:79]
  ds_read_b64_tr_b16 a[38:39], v1 offset:54272
  v_mfma_f32_16x16x32_bf16 v[72:75], a[20:23], a[168:171], v[72:75]
  ds_read_b64_tr_b16 a[52:53], v1 offset:58368
  v_mfma_f32_16x16x32_bf16 v[72:75], a[4:7], a[160:163], v[72:75]
  ds_read_b64_tr_b16 a[54:55], v1 offset:62464
  s_waitcnt lgkmcnt(8)
  v_mfma_f32_16x16x32_bf16 v[80:83], a[8:11], a[160:163], v[80:83]
  ds_read_b64_tr_b16 a[40:41], v2 offset:50176
  v_mfma_f32_16x16x32_bf16 v[80:83], a[24:27], a[168:171], v[80:83]
  ds_read_b64_tr_b16 a[42:43], v2 offset:54272
  v_mfma_f32_16x16x32_bf16 v[84:87], a[24:27], a[172:175], v[84:87]
  ds_read_b64_tr_b16 a[56:57], v2 offset:58368
  v_mfma_f32_16x16x32_bf16 v[84:87], a[8:11], a[164:167], v[84:87]
  ds_read_b64_tr_b16 a[58:59], v2 offset:62464
  v_mfma_f32_16x16x32_bf16 v[92:95], a[12:15], a[164:167], v[92:95]
  ds_read_b64_tr_b16 a[44:45], v3 offset:50176
  v_mfma_f32_16x16x32_bf16 v[92:95], a[28:31], a[172:175], v[92:95]
  ds_read_b64_tr_b16 a[46:47], v3 offset:54272
  v_mfma_f32_16x16x32_bf16 v[88:91], a[28:31], a[168:171], v[88:91]
  ds_read_b64_tr_b16 a[60:61], v3 offset:58368
  v_mfma_f32_16x16x32_bf16 v[88:91], a[12:15], a[160:163], v[88:91]
  ds_read_b64_tr_b16 a[62:63], v3 offset:62464
  s_mov_b32 s43, 0x40000
Lp4_mb:
  s_waitcnt vmcnt(0)
  v_max3_u32 v112, v96, v97, v98
  v_max3_u32 v113, v99, v100, v101
  v_max3_u32 v112, v112, v102, v103
  v_max3_u32 v113, v113, v104, v105
  v_max3_u32 v112, v112, v106, v107
  v_max3_u32 v113, v113, v108, v109
  v_max3_u32 v112, v112, v110, v111
  v_max_u32 v112, v112, v113
  v_cmp_eq_u32 vcc, -1, v112
  s_cbranch_vccz Lp4_mbok
  buffer_load_dwordx4 v[96:99], v8, s[4:7], s45 offen offset:0 sc1
  buffer_load_dwordx4 v[100:103], v8, s[4:7], s45 offen offset:1024 sc1
  buffer_load_dwordx4 v[104:107], v8, s[4:7], s45 offen offset:2048 sc1
  buffer_load_dwordx4 v[108:111], v8, s[4:7], s45 offen offset:3072 sc1
  s_sub_u32 s43, s43, 1
  s_cmp_lg_u32 s43, 0
  s_cbranch_scc1 Lp4_mb
  s_waitcnt vmcnt(0)
Lp4_mbok:
  s_waitcnt lgkmcnt(8)
  v_mfma_f32_16x16x32_bf16 v[64:67], a[32:35], a[176:179], v[64:67]
  v_lshlrev_b32 v32, 16, v96
  v_and_b32 v33, 0xffff0000, v96
  v_mfma_f32_16x16x32_bf16 v[64:67], a[48:51], a[184:187], v[64:67]
  v_lshlrev_b32 v34, 16, v97
  v_and_b32 v35, 0xffff0000, v97
  v_mfma_f32_16x16x32_bf16 v[68:71], a[48:51], a[188:191], v[68:71]
  v_lshlrev_b32 v40, 16, v98
  v_and_b32 v41, 0xffff0000, v98
  v_mfma_f32_16x16x32_bf16 v[68:71], a[32:35], a[180:183], v[68:71]
  v_lshlrev_b32 v42, 16, v99
  v_and_b32 v43, 0xffff0000, v99
  v_mfma_f32_16x16x32_bf16 v[76:79], a[36:39], a[180:183], v[76:79]
  v_lshlrev_b32 v36, 16, v104
  v_and_b32 v37, 0xffff0000, v104
  v_mfma_f32_16x16x32_bf16 v[76:79], a[52:55], a[188:191], v[76:79]
  v_lshlrev_b32 v38, 16, v105
  v_and_b32 v39, 0xffff0000, v105
  v_mfma_f32_16x16x32_bf16 v[72:75], a[52:55], a[184:187], v[72:75]
  v_lshlrev_b32 v44, 16, v106
  v_and_b32 v45, 0xffff0000, v106
  v_mfma_f32_16x16x32_bf16 v[72:75], a[36:39], a[176:179], v[72:75]
  s_waitcnt lgkmcnt(0)
  v_lshlrev_b32 v46, 16, v107
  v_and_b32 v47, 0xffff0000, v107
  v_mfma_f32_16x16x32_bf16 v[80:83], a[40:43], a[176:179], v[80:83]
  v_lshlrev_b32 v48, 16, v100
  v_and_b32 v49, 0xffff0000, v100
  v_mfma_f32_16x16x32_bf16 v[80:83], a[56:59], a[184:187], v[80:83]
  s_barrier
  v_lshlrev_b32 v50, 16, v101
  v_mfma_f32_16x16x32_bf16 v[84:87], a[56:59], a[188:191], v[84:87]
  v_and_b32 v51, 0xffff0000, v101
  v_lshlrev_b32 v56, 16, v102
  v_mfma_f32_16x16x32_bf16 v[84:87], a[40:43], a[180:183], v[84:87]
  v_and_b32 v57, 0xffff0000, v102
  v_lshlrev_b32 v58, 16, v103
  v_mfma_f32_16x16x32_bf16 v[92:95], a[44:47], a[180:183], v[92:95]
  v_and_b32 v59, 0xffff0000, v103
  v_lshlrev_b32 v52, 16, v108
  v_mfma_f32_16x16x32_bf16 v[92:95], a[60:63], a[188:191], v[92:95]
  v_and_b32 v53, 0xffff0000, v108
  v_lshlrev_b32 v54, 16, v109
  v_mfma_f32_16x16x32_bf16 v[88:91], a[60:63], a[184:187], v[88:91]
  v_and_b32 v55, 0xffff0000, v109
  v_lshlrev_b32 v60, 16, v110
  v_mfma_f32_16x16x32_bf16 v[88:91], a[44:47], a[176:179], v[88:91]
  v_and_b32 v61, 0xffff0000, v110
  v_lshlrev_b32 v62, 16, v111
  v_and_b32 v63, 0xffff0000, v111
  v_pk_add_f32 v[68:69], v[68:69], v[36:37]
  v_pk_add_f32 v[70:71], v[70:71], v[38:39]
  v_pk_add_f32 v[76:77], v[76:77], v[44:45]
  v_pk_add_f32 v[78:79], v[78:79], v[46:47]
  v_cvt_pk_bf16_f32 v24, v68, v69
  v_cvt_pk_bf16_f32 v25, v70, v71
  v_cvt_pk_bf16_f32 v26, v76, v77
  v_cvt_pk_bf16_f32 v27, v78, v79
  v_pk_add_f32 v[64:65], v[64:65], v[32:33]
  v_pk_add_f32 v[66:67], v[66:67], v[34:35]
  v_pk_add_f32 v[72:73], v[72:73], v[40:41]
  v_pk_add_f32 v[74:75], v[74:75], v[42:43]
  v_cvt_pk_bf16_f32 v16, v64, v65
  v_cvt_pk_bf16_f32 v17, v66, v67
  v_cvt_pk_bf16_f32 v18, v72, v73
  v_cvt_pk_bf16_f32 v19, v74, v75
  v_pk_add_f32 v[84:85], v[84:85], v[52:53]
  v_pk_add_f32 v[86:87], v[86:87], v[54:55]
  v_pk_add_f32 v[92:93], v[92:93], v[60:61]
  v_pk_add_f32 v[94:95], v[94:95], v[62:63]
  v_cvt_pk_bf16_f32 v28, v84, v85
  v_cvt_pk_bf16_f32 v29, v86, v87
  v_cvt_pk_bf16_f32 v30, v92, v93
  v_cvt_pk_bf16_f32 v31, v94, v95
  v_pk_add_f32 v[80:81], v[80:81], v[48:49]
  v_pk_add_f32 v[82:83], v[82:83], v[50:51]
  v_pk_add_f32 v[88:89], v[88:89], v[56:57]
  v_pk_add_f32 v[90:91], v[90:91], v[58:59]
  v_cvt_pk_bf16_f32 v20, v80, v81
  v_cvt_pk_bf16_f32 v21, v82, v83
  v_cvt_pk_bf16_f32 v22, v88, v89
  v_cvt_pk_bf16_f32 v23, v90, v91
  s_cmp_eq_u32 s41, 0
  s_cbranch_scc1 Lp4_mid
  v_permlane16_swap_b32 v16, v18
  v_permlane16_swap_b32 v17, v19
  v_permlane16_swap_b32 v20, v22
  v_permlane16_swap_b32 v21, v23
  ds_write_b128 v152, v[16:19] offset:0
  ds_write_b128 v153, v[20:23] offset:0
  ds_read_b128 v[96:99], v154 offset:0
  ds_read_b128 v[100:103], v154 offset:1024
  v_permlane16_swap_b32 v24, v26
  v_permlane16_swap_b32 v25, v27
  v_permlane16_swap_b32 v28, v30
  v_permlane16_swap_b32 v29, v31
  ds_write_b128 v152, v[24:27] offset:2048
  ds_write_b128 v153, v[28:31] offset:2048
  ds_read_b128 v[104:107], v154 offset:2048
  ds_read_b128 v[108:111], v154 offset:3072
  s_waitcnt lgkmcnt(5)
  buffer_store_dwordx4 v[96:99], v155, s[32:35], s57 offen sc1
  s_add_u32 s57, s57, 32768
  s_waitcnt lgkmcnt(4)
  buffer_store_dwordx4 v[100:103], v155, s[32:35], s57 offen sc1
  s_add_u32 s57, s57, 32768
  s_waitcnt lgkmcnt(1)
  buffer_store_dwordx4 v[104:107], v155, s[32:35], s57 offen sc1
  s_add_u32 s57, s57, 32768
  s_waitcnt lgkmcnt(0)
  buffer_store_dwordx4 v[108:111], v155, s[32:35], s57 offen sc1
  s_add_u32 s57, s57, 32768
  s_endpgm
Lp4_mid:
  buffer_store_dwordx4 v[16:19], v8, s[4:7], s46 offen offset:0 sc1
  buffer_store_dwordx4 v[24:27], v8, s[4:7], s47 offen offset:0 sc1
  v_mfma_f32_16x16x32_bf16 v[144:147], v[24:27], v[24:27], 0
  v_mfma_f32_16x16x32_bf16 v[140:143], v[128:131], v[24:27], 0
  v_mfma_f32_16x16x32_bf16 v[136:139], v[16:19], v[16:19], 0
  v_mfma_f32_16x16x32_bf16 v[132:135], v[128:131], v[16:19], 0
  buffer_store_dwordx4 v[20:23], v8, s[4:7], s46 offen offset:1024 sc1
  buffer_store_dwordx4 v[28:31], v8, s[4:7], s47 offen offset:1024 sc1
  v_mfma_f32_16x16x32_bf16 v[144:147], v[28:31], v[28:31], v[144:147]
  v_mfma_f32_16x16x32_bf16 v[140:143], v[128:131], v[28:31], v[140:143]
  v_mfma_f32_16x16x32_bf16 v[136:139], v[20:23], v[20:23], v[136:139]
  v_mfma_f32_16x16x32_bf16 v[132:135], v[128:131], v[20:23], v[132:135]
  s_nop 5
  v_cndmask_b32 v141, v144, v145, s[66:67]
  v_cndmask_b32 v141, v141, v146, s[68:69]
  v_cndmask_b32 v141, v141, v147, s[70:71]
  buffer_store_dwordx2 v[140:141], v148, s[4:7], s48 offen offset:2048 sc1
  v_cndmask_b32 v133, v136, v137, s[66:67]
  v_cndmask_b32 v133, v133, v138, s[68:69]
  v_cndmask_b32 v133, v133, v139, s[70:71]
  buffer_store_dwordx2 v[132:133], v148, s[4:7], s48 offen offset:0 sc1
  s_mov_b32 s41, 1
  s_mov_b32 s42, 0x2800000
  s_mov_b32 s28, s4
  s_mov_b32 s29, s5
  s_mov_b32 s30, 0x10000000
  s_lshr_b32 s57, s40, 1
  s_and_b32 s58, s40, 1
  s_lshl_b32 s71, s50, 3
  s_mov_b32 s67, 0
  s_lshl_b32 s62, s40, 12
  s_mul_i32 s63, s40, 6144
  s_add_u32 s76, s63, 139264
  s_and_b32 s43, s50, 7
  s_cmp_lg_u32 s43, 0
  s_cselect_b32 s43, 1, 0
  s_sub_u32 s72, s71, s43
  v_lshrrev_b32 v2, 3, v253
  v_bfe_u32 v3, v253, 1, 2
  v_lshrrev_b32 v4, 4, v253
  v_xor_b32 v3, v3, v4
  v_and_b32 v5, 1, v253
  v_mov_b32 v6, v2
  s_lshl_b32 s43, s40, 4
  v_mul_u32_u24 v6, 6144, v6
  v_lshl_add_u32 v6, v3, 5, v6
  v_lshl_add_u32 v124, v5, 4, v6
  v_add_u32 v125, 48128, v124
  s_mul_i32 s43, s43, 6144
  s_lshl_b32 s60, s51, 7
  s_add_u32 s60, s60, s43
  v_and_b32 v3, 7, v253
  s_lshl_b32 s43, s40, 1
  s_add_u32 s43, s43, s71
  v_lshlrev_b32 v120, 4, v253
  v_mov_b32 v121, v120
  v_add_u32 v122, 30720, v120
  v_add_u32 v123, 30720, v120
  v_lshlrev_b32 v5, 8, v2
  v_lshl_add_u32 v5, v3, 4, v5
  v_add_u32 v126, 128, v5
  s_lshl_b32 s43, s43, 15
  s_mov_b32 s44, 41943040
  s_add_u32 s59, s43, s44
  s_lshl_b32 s43, s72, 15
  s_add_u32 s73, s43, s44
  s_movk_i32 s61, 2048
  v_and_b32 v2, 15, v253
  v_lshrrev_b32 v3, 4, v253
  v_and_b32 v4, 7, v253
  v_lshlrev_b32 v6, 4, v253
  v_add_u32 v7, 1024, v6
  v_lshlrev_b32 v5, 7, v3
  v_lshl_add_u32 v8, v4, 4, v5
  v_add_u32 v9, 512, v8
  s_lshl_b32 s43, s57, 13
  s_add_u32 s43, s43, 73728
  v_add_u32 v112, s43, v6
  v_add_u32 v113, s43, v7
  v_add_u32 v114, 122880, v8
  v_add_u32 v115, 122880, v9
  s_lshl_b32 s43, s52, 3
  s_lshl_b32 s44, s40, 1
  s_add_u32 s43, s43, s44
  v_mov_b32 v187, v6
  s_lshl_b32 s43, s43, 15
  s_lshl_b32 s44, s53, 11
  s_add_u32 s43, s43, s44
  s_add_u32 s64, s43, 41943040
  v_lshrrev_b32 v2, 2, v253
  v_bfe_u32 v3, v253, 3, 2
  v_and_b32 v4, 3, v253
  v_lshlrev_b32 v4, 3, v4
  v_lshl_add_u32 v4, v2, 7, v4
  s_lshl_b32 s43, s58, 1
  s_or_b32 s43, s43, s57
  v_xor_b32 v5, s43, v3
  v_lshl_add_u32 v116, v5, 5, v4
  v_xor_b32 v5, 1, v5
  v_lshl_add_u32 v117, v5, 5, v4
  v_add_u32 v118, 49152, v116
  v_add_u32 v119, 49152, v117
  s_mov_b32 s84, s16
  s_mov_b32 s85, s17
  s_mov_b32 s86, 7340032
  s_mov_b32 s87, 0x20000
  s_mov_b32 s3, 0
  s_mov_b32 s88, 63
  s_mov_b32 s100, 0
  v_mov_b32 v238, 0x40000000
  s_waitcnt vmcnt(0)
  s_barrier
  s_cmp_lg_u32 s40, 0
  s_cbranch_scc1 Lsig19
  v_mov_b32 v250, 1
  s_mov_b64 exec, 1
  buffer_atomic_add v250, v251, s[4:7], s77 offen sc1
  s_mov_b64 exec, -1
Lsig19:
  s_add_u32 s44, s67, 0
  s_and_b32 s44, s44, 15
  s_mul_i32 s45, s44, 393216
  s_add_u32 s69, s45, s60
  s_add_u32 s70, s69, 4096
  s_add_u32 m0, s63, 0
  s_nop 0
  buffer_load_dwordx4 v124, s[8:11], s69 offen offset:0  lds
  buffer_load_dwordx4 v125, s[8:11], s69 offen offset:1024  lds
  buffer_load_dwordx4 v124, s[8:11], s69 offen offset:2048  lds
  buffer_load_dwordx4 v125, s[8:11], s69 offen offset:3072  lds
  s_add_u32 m0, s63, 4096
  s_nop 0
  buffer_load_dwordx4 v124, s[8:11], s70 offen offset:0  lds
  buffer_load_dwordx4 v125, s[8:11], s70 offen offset:1024  lds
  s_add_u32 s44, s67, 1
  s_and_b32 s44, s44, 15
  s_mul_i32 s45, s44, 393216
  s_add_u32 s69, s45, s60
  s_add_u32 s70, s69, 4096
  s_add_u32 m0, s63, 24576
  s_nop 0
  buffer_load_dwordx4 v124, s[8:11], s69 offen offset:0  lds
  buffer_load_dwordx4 v125, s[8:11], s69 offen offset:1024  lds
  buffer_load_dwordx4 v124, s[8:11], s69 offen offset:2048  lds
  buffer_load_dwordx4 v125, s[8:11], s69 offen offset:3072  lds
  s_add_u32 m0, s63, 28672
  s_nop 0
  buffer_load_dwordx4 v124, s[8:11], s70 offen offset:0  lds
  buffer_load_dwordx4 v125, s[8:11], s70 offen offset:1024  lds
  s_add_u32 s44, s67, 2
  s_and_b32 s44, s44, 15
  s_mul_i32 s45, s44, 393216
  s_add_u32 s69, s45, s60
  s_add_u32 s70, s69, 4096
  s_add_u32 m0, s63, 49152
  s_nop 0
  buffer_load_dwordx4 v124, s[8:11], s69 offen offset:0  lds
  buffer_load_dwordx4 v125, s[8:11], s69 offen offset:1024  lds
  buffer_load_dwordx4 v124, s[8:11], s69 offen offset:2048  lds
  buffer_load_dwordx4 v125, s[8:11], s69 offen offset:3072  lds
  s_add_u32 m0, s63, 53248
  s_nop 0
  buffer_load_dwordx4 v124, s[8:11], s70 offen offset:0  lds
  buffer_load_dwordx4 v125, s[8:11], s70 offen offset:1024  lds
  v_mov_b32 v0, 0
  v_mov_b32 v1, 0
  v_mov_b32 v2, 0
  v_mov_b32 v3, 0
  v_mov_b32 v4, 0
  v_mov_b32 v5, 0
  v_mov_b32 v6, 0
  v_mov_b32 v7, 0
  v_mov_b32 v8, 0
  v_mov_b32 v9, 0
  v_mov_b32 v10, 0
  v_mov_b32 v11, 0
  v_mov_b32 v12, 0
  v_mov_b32 v13, 0
  v_mov_b32 v14, 0
  v_mov_b32 v15, 0
  v_mov_b32 v16, 0
  v_mov_b32 v17, 0
  v_mov_b32 v18, 0
  v_mov_b32 v19, 0
  v_mov_b32 v20, 0
  v_mov_b32 v21, 0
  v_mov_b32 v22, 0
  v_mov_b32 v23, 0
  v_mov_b32 v24, 0
  v_mov_b32 v25, 0
  v_mov_b32 v26, 0
  v_mov_b32 v27, 0
  v_mov_b32 v28, 0
  v_mov_b32 v29, 0
  v_mov_b32 v30, 0
  v_mov_b32 v31, 0
  v_mov_b32 v32, 0
  v_mov_b32 v33, 0
  v_mov_b32 v34, 0
  v_mov_b32 v35, 0
  v_mov_b32 v36, 0
  v_mov_b32 v37, 0
  v_mov_b32 v38, 0
  v_mov_b32 v39, 0
  v_mov_b32 v40, 0
  v_mov_b32 v41, 0
  v_mov_b32 v42, 0
  v_mov_b32 v43, 0
  v_mov_b32 v44, 0
  v_mov_b32 v45, 0
  v_mov_b32 v46, 0
  v_mov_b32 v47, 0
  v_mov_b32 v48, 0
  v_mov_b32 v49, 0
  v_mov_b32 v50, 0
  v_mov_b32 v51, 0
  v_mov_b32 v52, 0
  v_mov_b32 v53, 0
  v_mov_b32 v54, 0
  v_mov_b32 v55, 0
  v_mov_b32 v56, 0
  v_mov_b32 v57, 0
  v_mov_b32 v58, 0
  v_mov_b32 v59, 0
  v_mov_b32 v60, 0
  v_mov_b32 v61, 0
  v_mov_b32 v62, 0
  v_mov_b32 v63, 0
  v_mov_b32 v64, 0
  v_mov_b32 v65, 0
  v_mov_b32 v66, 0
  v_mov_b32 v67, 0
  v_mov_b32 v68, 0
  v_mov_b32 v69, 0
  v_mov_b32 v70, 0
  v_mov_b32 v71, 0
  v_mov_b32 v72, 0
  v_mov_b32 v73, 0
  v_mov_b32 v74, 0
  v_mov_b32 v75, 0
  v_mov_b32 v76, 0
  v_mov_b32 v77, 0
  v_mov_b32 v78, 0
  v_mov_b32 v79, 0
  v_mov_b32 v80, 0
  v_mov_b32 v81, 0
  v_mov_b32 v82, 0
  v_mov_b32 v83, 0
  v_mov_b32 v84, 0
  v_mov_b32 v85, 0
  v_mov_b32 v86, 0
  v_mov_b32 v87, 0
  v_mov_b32 v88, 0
  v_mov_b32 v89, 0
  v_mov_b32 v90, 0
  v_mov_b32 v91, 0
  v_mov_b32 v92, 0
  v_mov_b32 v93, 0
  v_mov_b32 v94, 0
  v_mov_b32 v95, 0
  v_mov_b32 v96, 0
  v_mov_b32 v97, 0
  v_mov_b32 v98, 0
  v_mov_b32 v99, 0
  v_mov_b32 v100, 0
  v_mov_b32 v101, 0
  v_mov_b32 v102, 0
  v_mov_b32 v103, 0
  s_lshl_b32 s77, s50, 7
  s_add_u32 s77, s77, 27792256
  s_and_b32 s43, s50, 7
  s_cmp_eq_u32 s43, 0
  s_cselect_b32 s43, 0x80, 0
  v_lshlrev_b32 v249, 7, v253
  v_or_b32 v249, s43, v249
  s_branch Llayer
Lend:
  s_endpgm
Lside_sub:
  s_cmp_eq_u32 s90, 1
  s_cbranch_scc0 Lside_l
  s_cmp_lg_u32 s40, 0
  s_cbranch_scc1 Lside_a
  s_and_b32 s43, s2, 1
  s_lshl_b32 s43, s43, 7
  v_mov_b32 v250, 1
  s_mov_b64 exec, 1
  buffer_atomic_add v250, v251, s[36:39], s43 offen sc1
  s_mov_b64 exec, -1
Lside_a:
  s_add_u32 s88, s88, 3
  s_add_u32 s90, s90, 1
  s_setpc_b64 s[78:79]
Lside_l:
  buffer_load_dwordx4 a[240:243], v239, s[12:15], s89 offen
  s_add_u32 s89, s89, 1024
  s_cmp_eq_u32 s90, 0
  s_cbranch_scc0 Lside_b
  buffer_load_dwordx4 a[176:179], v238, s[84:87], s100 offen
  s_add_u32 s100, s100, 57344
  buffer_load_dwordx4 a[180:183], v238, s[84:87], s100 offen
  s_add_u32 s100, s100, 57344
  buffer_load_dwordx4 a[184:187], v238, s[84:87], s100 offen
  s_add_u32 s100, s100, 57344
  buffer_load_dwordx4 a[188:191], v238, s[84:87], s100 offen
  s_add_u32 s100, s100, 57344
  buffer_load_dwordx4 a[192:195], v238, s[84:87], s100 offen
  s_add_u32 s100, s100, 57344
  buffer_load_dwordx4 a[196:199], v238, s[84:87], s100 offen
  s_add_u32 s100, s100, 57344
  buffer_load_dwordx4 a[200:203], v238, s[84:87], s100 offen
  s_add_u32 s100, s100, 57344
  buffer_load_dwordx4 a[204:207], v238, s[84:87], s100 offen
  s_add_u32 s100, s100, 57344
  s_add_u32 s100, s100, 3211264
  s_add_u32 s88, s88, 3
  s_add_u32 s90, s90, 1
  s_setpc_b64 s[78:79]
Lside_b:
  buffer_load_dwordx4 a[208:211], v238, s[84:87], s100 offen
  s_add_u32 s100, s100, 57344
  buffer_load_dwordx4 a[212:215], v238, s[84:87], s100 offen
  s_add_u32 s100, s100, 57344
  buffer_load_dwordx4 a[216:219], v238, s[84:87], s100 offen
  s_add_u32 s100, s100, 57344
  buffer_load_dwordx4 a[220:223], v238, s[84:87], s100 offen
  s_add_u32 s100, s100, 57344
  buffer_load_dwordx4 a[224:227], v238, s[84:87], s100 offen
  s_add_u32 s100, s100, 57344
  buffer_load_dwordx4 a[228:231], v238, s[84:87], s100 offen
  s_add_u32 s100, s100, 57344
  buffer_load_dwordx4 a[232:235], v238, s[84:87], s100 offen
  s_add_u32 s100, s100, 57344
  buffer_load_dwordx4 a[236:239], v238, s[84:87], s100 offen
  s_add_u32 s100, s100, 57344
  s_mov_b32 s88, 63
  s_setpc_b64 s[78:79]
Lcode_end:
.fill (Lpc0 + 69632 - Lcode_end)/4, 4, 0xbf810000
.section .rodata,"a"
.p2align 6
.amdhsa_kernel interleave_layers__sliding_local_dilated__swiglu_ffn__prompt_kernel
  .amdhsa_next_free_vgpr 512
  .amdhsa_next_free_sgpr 102
  .amdhsa_accum_offset 256
  .amdhsa_group_segment_fixed_size 0
  .amdhsa_kernarg_size 80
  .amdhsa_user_sgpr_count 2
  .amdhsa_user_sgpr_kernarg_segment_ptr 1
  .amdhsa_system_sgpr_workgroup_id_x 1
  .amdhsa_float_denorm_mode_32 3
.end_amdhsa_kernel
```

```asm
; @launch grid=(256,1,1) block=(256,1,1) lds=163840
.amdgcn_target "amdgcn-amd-amdhsa--gfx950"
.text
.globl interleave_layers__sliding_local_dilated__swiglu_ffn__prompt_kernel
.p2align 8
.type interleave_layers__sliding_local_dilated__swiglu_ffn__prompt_kernel,@function
interleave_layers__sliding_local_dilated__swiglu_ffn__prompt_kernel:
  s_cmp_lt_u32 s2, 256
  s_cbranch_scc1 Lgo
  s_endpgm
Lgo:
  s_load_dwordx2 s[28:29], s[0:1], 0
  s_load_dwordx2 s[8:9], s[0:1], 8
  s_getpc_b64 s[44:45]
Lpc0:
  s_bfe_u32 s43, s2, 0x40003
  s_lshl_b32 s43, s43, 12
  v_lshl_add_u32 v2, v0, 4, s43
  s_and_b32 s44, s44, 0xffffff80
  global_load_dwordx4 a[240:243], v2, s[44:45]
  v_lshrrev_b32 v1, 6, v0
  v_and_b32 v253, 63, v0
  v_readfirstlane_b32 s40, v1
  v_mov_b32 v251, 0
  s_mov_b32 s30, 0x400000
  s_mov_b32 s31, 0x20000
  s_mov_b32 s10, 0x600000
  s_mov_b32 s11, 0x20000
  s_and_b32 s44, s2, 1
  s_bfe_u32 s45, s2, 0x20001
  s_lshr_b32 s46, s2, 3
  s_lshl_b32 s47, s44, 3
  s_and_b32 s43, s46, 7
  s_add_u32 s50, s47, s43
  s_lshl_b32 s43, s45, 2
  s_lshr_b32 s51, s46, 3
  s_add_u32 s51, s51, s43
  s_lshr_b32 s57, s40, 1
  s_and_b32 s58, s40, 1
  s_lshl_b32 s71, s50, 3
  s_add_u32 s67, s50, s51
  s_and_b32 s67, s67, 15
  s_lshl_b32 s62, s40, 12
  s_mul_i32 s63, s40, 6144
  s_add_u32 s76, s63, 139264
  s_and_b32 s43, s50, 7
  s_cmp_lg_u32 s43, 0
  s_cselect_b32 s43, 1, 0
  s_sub_u32 s72, s71, s43
  v_lshrrev_b32 v2, 3, v253
  v_bfe_u32 v3, v253, 1, 2
  v_lshrrev_b32 v4, 4, v253
  v_xor_b32 v3, v3, v4
  v_and_b32 v5, 1, v253
  v_lshrrev_b32 v6, 5, v253
  v_lshl_add_u32 v6, v6, 2, v2
  s_lshl_b32 s43, s57, 5
  s_lshl_b32 s44, s58, 2
  s_add_u32 s43, s43, s44
  v_mul_u32_u24 v6, 6144, v6
  v_lshl_add_u32 v6, v3, 5, v6
  v_lshl_add_u32 v124, v5, 4, v6
  v_add_u32 v125, 97280, v124
  s_mul_i32 s43, s43, 6144
  s_lshl_b32 s60, s51, 7
  s_add_u32 s60, s60, s43
  v_and_b32 v3, 7, v253
  s_lshl_b32 s43, s40, 1
  s_add_u32 s43, s43, s71
  v_add_u32 v5, 0, v4
  v_xor_b32 v5, v5, v3
  v_lshlrev_b32 v5, 4, v5
  v_lshl_add_u32 v5, v2, 12, v5
  v_add_u32 v120, 0, v5
  v_add_u32 v5, 4, v4
  v_xor_b32 v5, v5, v3
  v_lshlrev_b32 v5, 4, v5
  v_lshl_add_u32 v5, v2, 12, v5
  v_add_u32 v121, 31744, v5
  v_add_u32 v5, 0, v4
  v_xor_b32 v5, v5, v3
  v_lshlrev_b32 v5, 4, v5
  v_lshl_add_u32 v5, v2, 12, v5
  v_add_u32 v122, 63488, v5
  v_add_u32 v5, 4, v4
  v_xor_b32 v5, v5, v3
  v_lshlrev_b32 v5, 4, v5
  v_lshl_add_u32 v5, v2, 12, v5
  v_add_u32 v123, 95232, v5
  v_and_b32 v5, 6, v2
  v_xor_b32 v5, v5, v3
  v_lshlrev_b32 v5, 4, v5
  v_lshl_add_u32 v5, v2, 12, v5
  v_add_u32 v126, 32768, v5
  s_lshr_b32 s44, s50, 3
  s_lshl_b32 s44, s44, 11
  s_and_b32 s43, s43, 63
  s_lshl_b32 s43, s43, 16
  s_add_u32 s59, s43, s44
  s_and_b32 s43, s72, 63
  s_lshl_b32 s43, s43, 16
  s_add_u32 s73, s43, s44
  s_movk_i32 s61, 128
  s_waitcnt lgkmcnt(0)
  s_add_u32 s44, s67, 0
  s_and_b32 s44, s44, 15
  s_mul_i32 s45, s44, s61
  s_add_u32 s68, s45, s59
  s_add_u32 m0, s62, 73728
  s_nop 0
  buffer_load_dwordx4 v120, s[28:31], s68 offen offset:0 sc1  lds
  buffer_load_dwordx4 v121, s[28:31], s68 offen offset:1024 sc1  lds
  buffer_load_dwordx4 v122, s[28:31], s68 offen offset:2048 sc1  lds
  buffer_load_dwordx4 v123, s[28:31], s68 offen offset:3072 sc1  lds
  s_add_u32 s44, s67, 0
  s_and_b32 s44, s44, 15
  s_mul_i32 s45, s44, 393216
  s_add_u32 s69, s45, s60
  s_add_u32 s70, s69, 4096
  s_add_u32 m0, s63, 0
  s_nop 0
  buffer_load_dwordx4 v124, s[8:11], s69 offen offset:0  lds
  buffer_load_dwordx4 v125, s[8:11], s69 offen offset:1024  lds
  buffer_load_dwordx4 v124, s[8:11], s69 offen offset:2048  lds
  buffer_load_dwordx4 v125, s[8:11], s69 offen offset:3072  lds
  s_add_u32 m0, s63, 4096
  s_nop 0
  buffer_load_dwordx4 v124, s[8:11], s70 offen offset:0  lds
  buffer_load_dwordx4 v125, s[8:11], s70 offen offset:1024  lds
  s_add_u32 s44, s67, s40
  s_add_u32 s44, s44, 0
  s_and_b32 s44, s44, 15
  s_mul_i32 s44, s44, s61
  s_lshl_b32 s45, s40, 10
  s_add_u32 m0, s45, 122880
  s_add_u32 s44, s44, s73
  buffer_load_dwordx4 v126, s[28:31], s44 offen sc1 lds
  s_load_dwordx2 s[4:5], s[0:1], 72
  s_load_dwordx2 s[12:13], s[0:1], 16
  s_load_dwordx2 s[16:17], s[0:1], 32
  s_load_dwordx2 s[20:21], s[0:1], 40
  s_load_dwordx2 s[24:25], s[0:1], 48
  s_load_dwordx2 s[32:33], s[0:1], 56
  s_load_dwordx2 s[36:37], s[0:1], 64
  s_mov_b32 s6, 0x10000000
  s_mov_b32 s7, 0x20000
  s_mov_b32 s14, 0x200000
  s_mov_b32 s15, 0x20000
  s_mov_b32 s18, 0x700000
  s_mov_b32 s19, 0x20000
  s_mov_b32 s22, 0x700000
  s_mov_b32 s23, 0x20000
  s_mov_b32 s26, 0x700000
  s_mov_b32 s27, 0x20000
  s_mov_b32 s34, 0x400000
  s_mov_b32 s35, 0x20000
  s_mov_b32 s38, 0x100
  s_mov_b32 s39, 0x20000
  s_mov_b32 s41, 0
  s_mov_b32 s42, 0
  s_and_b32 s44, s2, 1
  s_bfe_u32 s45, s2, 0x20001
  s_lshr_b32 s46, s2, 3
  s_lshl_b32 s47, s44, 3
  s_lshr_b32 s43, s45, 1
  s_lshl_b32 s43, s43, 2
  s_add_u32 s52, s47, s43
  s_and_b32 s48, s46, 3
  s_add_u32 s52, s52, s48
  s_and_b32 s43, s45, 1
  s_lshr_b32 s49, s46, 2
  s_lshl_b32 s53, s49, 1
  s_add_u32 s53, s53, s43
  s_lshl_b32 s43, s44, 2
  s_add_u32 s54, s43, s48
  s_lshl_b32 s43, s45, 3
  s_add_u32 s55, s43, s49
  v_lshrrev_b32 v2, 3, v253
  v_bfe_u32 v3, v253, 1, 2
  v_lshrrev_b32 v4, 4, v253
  v_xor_b32 v3, v3, v4
  v_and_b32 v4, 1, v253
  v_lshlrev_b32 v2, 11, v2
  v_lshl_add_u32 v2, v3, 5, v2
  v_lshl_add_u32 v252, v4, 4, v2
  s_waitcnt lgkmcnt(0)
  s_and_b32 s43, s40, 1
  s_mul_i32 s43, s43, 41943040
  s_lshl_b32 s44, s2, 7
  s_add_u32 s43, s43, s44
  s_add_u32 s43, s43, 27787264
  buffer_store_dword v251, v251, s[4:7], s43 offen sc1
  v_and_b32 v2, 15, v253
  v_lshrrev_b32 v3, 4, v253
  v_and_b32 v4, 7, v253
  v_lshrrev_b32 v5, 1, v2
  v_xor_b32 v5, v5, v3
  v_lshlrev_b32 v5, 4, v5
  v_lshl_add_u32 v6, v2, 7, v5
  v_xor_b32 v7, 64, v6
  v_and_b32 v5, 6, v4
  v_xor_b32 v5, v5, v3
  v_lshlrev_b32 v5, 4, v5
  v_lshl_add_u32 v8, v4, 7, v5
  v_xor_b32 v9, 64, v8
  s_lshl_b32 s43, s57, 13
  s_add_u32 s43, s43, 73728
  v_add_u32 v112, s43, v6
  v_add_u32 v113, s43, v7
  v_add_u32 v114, 122880, v8
  v_add_u32 v115, 122880, v9
  s_lshl_b32 s43, s52, 3
  s_lshl_b32 s44, s40, 1
  s_add_u32 s43, s43, s44
  v_lshrrev_b32 v5, 1, v3
  v_lshrrev_b32 v187, 1, v2
  v_xor_b32 v5, v5, v187
  v_lshlrev_b32 v5, 4, v5
  v_lshl_add_u32 v187, v2, 7, v5
  v_and_b32 v5, 1, v3
  v_lshl_add_u32 v187, v5, 3, v187
  s_lshr_b32 s44, s43, 6
  s_lshl_b32 s44, s44, 11
  s_and_b32 s43, s43, 63
  s_lshl_b32 s43, s43, 16
  s_add_u32 s43, s43, s44
  s_lshl_b32 s44, s53, 7
  s_add_u32 s64, s43, s44
  v_lshrrev_b32 v2, 2, v253
  v_bfe_u32 v3, v253, 3, 2
  v_and_b32 v4, 3, v253
  v_lshlrev_b32 v4, 3, v4
  v_lshl_add_u32 v4, v2, 7, v4
  s_lshl_b32 s43, s58, 1
  s_or_b32 s43, s43, s57
  v_xor_b32 v5, s43, v3
  v_lshl_add_u32 v116, v5, 5, v4
  v_xor_b32 v5, 1, v5
  v_lshl_add_u32 v117, v5, 5, v4
  v_add_u32 v118, 49152, v116
  v_add_u32 v119, 49152, v117
  v_and_b32 v235, 15, v253
  v_lshrrev_b32 v236, 4, v253
  v_lshlrev_b32 v236, 2, v236
  v_sub_u32 v235, v235, v236
  v_mov_b32 v237, 0xf149f2ca
  v_subrev_u32 v238, 0, v235
  v_cmp_gt_u32 vcc, 8, v238
  v_add_u32 v238, 16, v238
  v_cmp_gt_u32 s[78:79], 8, v238
  v_cndmask_b32 v132, v237, 0, vcc
  s_nop 0
  v_cndmask_b32 v136, v237, 0, s[78:79]
  v_subrev_u32 v238, 1, v235
  v_cmp_gt_u32 vcc, 8, v238
  v_add_u32 v238, 16, v238
  v_cmp_gt_u32 s[78:79], 8, v238
  v_cndmask_b32 v133, v237, 0, vcc
  s_nop 0
  v_cndmask_b32 v137, v237, 0, s[78:79]
  v_subrev_u32 v238, 2, v235
  v_cmp_gt_u32 vcc, 8, v238
  v_add_u32 v238, 16, v238
  v_cmp_gt_u32 s[78:79], 8, v238
  v_cndmask_b32 v134, v237, 0, vcc
  s_nop 0
  v_cndmask_b32 v138, v237, 0, s[78:79]
  v_subrev_u32 v238, 3, v235
  v_cmp_gt_u32 vcc, 8, v238
  v_add_u32 v238, 16, v238
  v_cmp_gt_u32 s[78:79], 8, v238
  v_cndmask_b32 v135, v237, 0, vcc
  s_nop 0
  v_cndmask_b32 v139, v237, 0, s[78:79]
  v_lshlrev_b32 v232, 4, v253
  v_add_u32 v232, 149504, v232
  ds_write_b128 v232, v[132:135]
  ds_write_b128 v232, v[136:139] offset:1024
  s_lshr_b32 s46, s2, 3
  s_cmp_ge_u32 s46, 14
  s_cselect_b32 s44, 14, 0
  s_cselect_b32 s45, 1, 0
  s_cselect_b32 s84, s20, s16
  s_cselect_b32 s85, s21, s17
  s_mov_b32 s86, 7340032
  s_mov_b32 s87, 0x20000
  s_sub_u32 s44, s46, s44
  s_bfe_u32 s47, s2, 0x20001
  s_mul_i32 s47, s47, 14
  s_add_u32 s44, s44, s47
  s_and_b32 s47, s2, 1
  s_lshl_b32 s48, s47, 1
  s_add_u32 s48, s48, s45
  s_mul_i32 s48, s48, 14336
  s_lshl_b32 s49, s44, 8
  s_add_u32 s48, s48, s49
  s_add_u32 s101, s48, 27918336
  s_lshl_b32 s47, s47, 2
  s_add_u32 s47, s47, s40
  s_mul_i32 s47, s47, 458752
  s_lshl_b32 s44, s44, 7
  s_add_u32 s100, s47, s44
  s_cmp_lt_u32 s46, 28
  s_cselect_b32 s3, 1, 0
  s_cmp_eq_u32 s41, 0
  s_cselect_b32 s3, s3, 0
  v_lshrrev_b32 v238, 3, v253
  v_mul_u32_u24 v238, 7168, v238
  v_and_b32 v239, 7, v253
  v_lshl_add_u32 v238, v239, 4, v238
  s_cmp_eq_u32 s3, 0
  s_cselect_b32 s43, 0x40000000, 0
  v_or_b32 v238, s43, v238
  v_lshlrev_b32 v239, 4, v253
  s_lshl_b32 s43, s2, 2
  s_add_u32 s43, s43, s40
  s_lshl_b32 s89, s43, 11
  s_mul_i32 s43, s46, 43
  s_lshr_b32 s43, s43, 8
  s_mul_i32 s43, s43, 6
  s_sub_u32 s43, s46, s43
  s_add_u32 s43, s43, 5
  s_cmp_eq_u32 s41, 0
  s_cselect_b32 s88, s43, 63
  s_mov_b32 s90, 0
  s_lshl_b32 s43, s58, 12
  v_add_u32 v132, s43, v112
  v_add_u32 v133, s43, v113
  v_and_b32 v128, 15, v253
  v_lshrrev_b32 v129, 4, v253
  v_cmp_eq_u32 vcc, 0, v128
  v_lshlrev_b32 v129, 4, v129
  v_mov_b32 v130, 0x40000000
  v_cndmask_b32 v136, v130, v129, vcc
  v_mov_b32 v156, 0x3f803f80
  v_mov_b32 v157, 0x3f803f80
  v_mov_b32 v158, 0x3f803f80
  v_mov_b32 v159, 0x3f803f80
  s_lshl_b32 s43, s40, 1
  s_add_u32 s43, s43, s71
  s_lshl_b32 s48, s43, 11
  s_lshl_b32 s43, s67, 7
  s_add_u32 s48, s48, s43
  s_add_u32 s48, s48, 27262976
  s_lshl_b32 s43, s51, 2
  s_lshl_b32 s44, s58, 1
  s_add_u32 s43, s43, s44
  s_add_u32 s43, s43, s57
  s_lshl_b32 s43, s43, 6
  s_mul_i32 s49, s67, 12288
  s_add_u32 s49, s49, s43
  s_add_u32 s49, s49, 27983872
  v_and_b32 v212, 15, v253
  v_lshrrev_b32 v213, 4, v253
  v_lshrrev_b32 v192, 2, v212
  v_cmp_eq_u32 vcc, v192, v213
  v_and_b32 v192, 3, v212
  v_lshlrev_b32 v212, 3, v212
  v_mov_b32 v213, 0x7ffffff0
  v_cndmask_b32 v212, v213, v212, vcc
  v_cmp_eq_u32 s[78:79], 1, v192
  v_cmp_eq_u32 s[80:81], 2, v192
  v_cmp_eq_u32 s[82:83], 3, v192
  v_mov_b32 v192, 0x3f803f80
  v_mov_b32 v193, 0x3f803f80
  v_mov_b32 v194, 0x3f803f80
  v_mov_b32 v195, 0x3f803f80
  s_add_u32 s44, s67, 1
  s_and_b32 s44, s44, 15
  s_mul_i32 s45, s44, s61
  s_add_u32 s68, s45, s59
  s_add_u32 m0, s62, 90112
  s_nop 0
  buffer_load_dwordx4 v120, s[28:31], s68 offen offset:0 sc1  lds
  buffer_load_dwordx4 v121, s[28:31], s68 offen offset:1024 sc1  lds
  buffer_load_dwordx4 v122, s[28:31], s68 offen offset:2048 sc1  lds
  buffer_load_dwordx4 v123, s[28:31], s68 offen offset:3072 sc1  lds
  s_waitcnt vmcnt(5)
  s_barrier
  ds_read_b64_tr_b16 a[40:41], v116 offset:0
  ds_read_b64_tr_b16 a[42:43], v116 offset:6144
  ds_read_b64_tr_b16 a[64:65], v116 offset:12288
  ds_read_b64_tr_b16 a[66:67], v116 offset:18432
  ds_read_b128 a[4:7], v112 offset:0
  ds_read_b128 a[24:27], v113 offset:0
  ds_read_b128 a[8:11], v112 offset:2048
  ds_read_b128 a[28:31], v113 offset:2048
  ds_read_b128 a[12:15], v112 offset:4096
  ds_read_b128 a[32:35], v113 offset:4096
  ds_read_b128 a[16:19], v112 offset:6144
  ds_read_b128 a[36:39], v113 offset:6144
  ds_read_b64_tr_b16 a[44:45], v117 offset:0
  ds_read_b64_tr_b16 a[46:47], v117 offset:6144
  ds_read_b64_tr_b16 a[68:69], v117 offset:12288
  ds_read_b64_tr_b16 a[70:71], v117 offset:18432
  ds_read_b128 a[0:3], v114 offset:0
  ds_read_b128 a[20:23], v115 offset:0
  ds_read_b64_tr_b16 a[48:49], v116 offset:2048
  ds_read_b64_tr_b16 a[50:51], v116 offset:8192
  ds_read_b64_tr_b16 a[72:73], v116 offset:14336
  ds_read_b64_tr_b16 a[74:75], v116 offset:20480
  ds_read_b64_tr_b16 a[52:53], v117 offset:2048
  ds_read_b64_tr_b16 a[54:55], v117 offset:8192
  ds_read_b64_tr_b16 a[76:77], v117 offset:14336
  ds_read_b64_tr_b16 a[78:79], v117 offset:20480
  ds_read_b64_tr_b16 a[56:57], v116 offset:4096
  ds_read_b64_tr_b16 a[58:59], v116 offset:10240
  ds_read_b64_tr_b16 a[80:81], v116 offset:16384
  ds_read_b64_tr_b16 a[82:83], v116 offset:22528
  ds_read_b64_tr_b16 a[60:61], v117 offset:4096
  ds_read_b64_tr_b16 a[62:63], v117 offset:10240
  ds_read_b64_tr_b16 a[84:85], v117 offset:16384
  ds_read_b64_tr_b16 a[86:87], v117 offset:22528
  ds_read_b128 v[140:143], v132 offset:0
  ds_read_b128 v[144:147], v133 offset:0
  ds_read_b128 v[148:151], v132 offset:2048
  ds_read_b128 v[152:155], v133 offset:2048
  s_add_u32 s44, s67, 1
  s_and_b32 s44, s44, 15
  s_mul_i32 s45, s44, 393216
  s_add_u32 s69, s45, s60
  s_add_u32 s70, s69, 4096
  s_add_u32 m0, s63, 24576
  s_nop 0
  buffer_load_dwordx4 v124, s[8:11], s69 offen offset:0  lds
  buffer_load_dwordx4 v125, s[8:11], s69 offen offset:1024  lds
  buffer_load_dwordx4 v124, s[8:11], s69 offen offset:2048  lds
  buffer_load_dwordx4 v125, s[8:11], s69 offen offset:3072  lds
  s_add_u32 m0, s63, 28672
  s_nop 0
  buffer_load_dwordx4 v124, s[8:11], s70 offen offset:0  lds
  buffer_load_dwordx4 v125, s[8:11], s70 offen offset:1024  lds
  s_waitcnt lgkmcnt(15)
  v_mfma_f32_16x16x32_bf16 v[0:3], a[40:43], a[4:7], 0
  s_add_u32 s44, s67, 2
  s_and_b32 s44, s44, 15
  s_mul_i32 s45, s44, 393216
  s_add_u32 s69, s45, s60
  s_add_u32 s70, s69, 4096
  s_add_u32 m0, s63, 49152
  s_nop 0
  v_mfma_f32_16x16x32_bf16 v[0:3], a[64:67], a[24:27], v[0:3]
  buffer_load_dwordx4 v124, s[8:11], s69 offen offset:0  lds
  v_mfma_f32_16x16x32_bf16 v[4:7], a[64:67], a[28:31], 0
  v_mfma_f32_16x16x32_bf16 v[4:7], a[40:43], a[8:11], v[4:7]
  buffer_load_dwordx4 v125, s[8:11], s69 offen offset:1024  lds
  v_mfma_f32_16x16x32_bf16 v[8:11], a[40:43], a[12:15], 0
  v_mfma_f32_16x16x32_bf16 v[8:11], a[64:67], a[32:35], v[8:11]
  v_mfma_f32_16x16x32_bf16 v[12:15], a[64:67], a[36:39], 0
  buffer_load_dwordx4 v124, s[8:11], s69 offen offset:2048  lds
  v_mfma_f32_16x16x32_bf16 v[12:15], a[40:43], a[16:19], v[12:15]
  v_mfma_f32_16x16x32_bf16 v[28:31], a[44:47], a[16:19], 0
  v_mfma_f32_16x16x32_bf16 v[28:31], a[68:71], a[36:39], v[28:31]
  buffer_load_dwordx4 v125, s[8:11], s69 offen offset:3072  lds
  s_add_u32 m0, s63, 53248
  s_nop 0
  v_mfma_f32_16x16x32_bf16 v[24:27], a[68:71], a[32:35], 0
  v_mfma_f32_16x16x32_bf16 v[24:27], a[44:47], a[12:15], v[24:27]
  buffer_load_dwordx4 v124, s[8:11], s70 offen offset:0  lds
  v_mfma_f32_16x16x32_bf16 v[20:23], a[44:47], a[8:11], 0
  v_mfma_f32_16x16x32_bf16 v[20:23], a[68:71], a[28:31], v[20:23]
  v_mfma_f32_16x16x32_bf16 v[16:19], a[68:71], a[24:27], 0
  s_add_u32 s44, s67, 2
  buffer_load_dwordx4 v125, s[8:11], s70 offen offset:1024  lds
  s_and_b32 s44, s44, 15
  s_mul_i32 s45, s44, s61
  s_add_u32 s68, s45, s59
  s_add_u32 m0, s62, 106496
  s_nop 0
  v_mfma_f32_16x16x32_bf16 v[16:19], a[44:47], a[4:7], v[16:19]
  v_mfma_f32_16x16x32_bf16 v[96:99], a[48:51], a[0:3], 0
  s_waitcnt vmcnt(6) lgkmcnt(0)
  s_barrier
  ds_read_b64_tr_b16 a[128:129], v116 offset:24576
  v_mfma_f32_16x16x32_bf16 v[96:99], a[72:75], a[20:23], v[96:99]
  ds_read_b64_tr_b16 a[130:131], v116 offset:30720
  buffer_load_dwordx4 v120, s[28:31], s68 offen offset:0 sc1  lds
  v_mfma_f32_16x16x32_bf16 v[32:35], a[72:75], a[24:27], 0
  ds_read_b64_tr_b16 a[152:153], v116 offset:36864
  v_mfma_f32_16x16x32_bf16 v[32:35], a[48:51], a[4:7], v[32:35]
  ds_read_b64_tr_b16 a[154:155], v116 offset:43008
  v_mfma_f32_16x16x32_bf16 v[36:39], a[48:51], a[8:11], 0
  ds_read_b128 a[92:95], v112 offset:16384
  buffer_load_dwordx4 v121, s[28:31], s68 offen offset:1024 sc1  lds
  v_mfma_f32_16x16x32_bf16 v[36:39], a[72:75], a[28:31], v[36:39]
  ds_read_b128 a[112:115], v113 offset:16384
  v_mfma_f32_16x16x32_bf16 v[40:43], a[72:75], a[32:35], 0
  ds_read_b128 a[96:99], v112 offset:18432
  buffer_load_dwordx4 v122, s[28:31], s68 offen offset:2048 sc1  lds
  v_mfma_f32_16x16x32_bf16 v[40:43], a[48:51], a[12:15], v[40:43]
  ds_read_b128 a[116:119], v113 offset:18432
  v_mfma_f32_16x16x32_bf16 v[44:47], a[48:51], a[16:19], 0
  ds_read_b128 a[100:103], v112 offset:20480
  v_mfma_f32_16x16x32_bf16 v[44:47], a[72:75], a[36:39], v[44:47]
  s_add_u32 s44, s67, s40
  ds_read_b128 a[120:123], v113 offset:20480
  buffer_load_dwordx4 v123, s[28:31], s68 offen offset:3072 sc1  lds
  s_add_u32 s44, s44, 4
  s_and_b32 s44, s44, 15
  s_mul_i32 s44, s44, s61
  s_lshl_b32 s45, s40, 10
  v_mfma_f32_16x16x32_bf16 v[60:63], a[76:79], a[36:39], 0
  s_add_u32 m0, s45, 126976
  s_add_u32 s44, s44, s73
  ds_read_b128 a[104:107], v112 offset:22528
  v_mfma_f32_16x16x32_bf16 v[60:63], a[52:55], a[16:19], v[60:63]
  ds_read_b128 a[124:127], v113 offset:22528
  v_mfma_f32_16x16x32_bf16 v[56:59], a[52:55], a[12:15], 0
  ds_read_b64_tr_b16 a[132:133], v117 offset:24576
  buffer_load_dwordx4 v126, s[28:31], s44 offen sc1 lds
  s_add_u32 s44, s67, s40
  s_add_u32 s44, s44, 8
  s_and_b32 s44, s44, 15
  s_mul_i32 s44, s44, s61
  s_lshl_b32 s45, s40, 10
  v_mfma_f32_16x16x32_bf16 v[56:59], a[76:79], a[32:35], v[56:59]
  s_add_u32 m0, s45, 131072
  s_add_u32 s44, s44, s73
  ds_read_b64_tr_b16 a[134:135], v117 offset:30720
  v_mfma_f32_16x16x32_bf16 v[160:163], a[40:43], v[156:159], 0
  ds_read_b64_tr_b16 a[156:157], v117 offset:36864
  v_mfma_f32_16x16x32_bf16 v[164:167], a[48:51], v[156:159], 0
  ds_read_b64_tr_b16 a[158:159], v117 offset:43008
  buffer_load_dwordx4 v126, s[28:31], s44 offen sc1 lds
  s_add_u32 s44, s67, s40
  s_add_u32 s44, s44, 12
  s_and_b32 s44, s44, 15
  s_mul_i32 s44, s44, s61
  s_lshl_b32 s45, s40, 10
  v_mfma_f32_16x16x32_bf16 v[168:171], a[56:59], v[156:159], 0
  s_add_u32 m0, s45, 135168
  s_add_u32 s44, s44, s73
  ds_read_b128 a[88:91], v114 offset:1024
  v_mfma_f32_16x16x32_bf16 v[160:163], a[64:67], v[156:159], v[160:163]
  ds_read_b128 a[108:111], v115 offset:1024
  buffer_load_dwordx4 v126, s[28:31], s44 offen sc1 lds
  s_add_u32 s44, s67, 3
  s_and_b32 s44, s44, 15
  s_mul_i32 s45, s44, s61
  s_add_u32 s68, s45, s59
  s_add_u32 m0, s62, 73728
  s_nop 0
  v_mfma_f32_16x16x32_bf16 v[164:167], a[72:75], v[156:159], v[164:167]
  ds_read_b64_tr_b16 a[136:137], v116 offset:26624
  v_mfma_f32_16x16x32_bf16 v[168:171], a[80:83], v[156:159], v[168:171]
  ds_read_b64_tr_b16 a[138:139], v116 offset:32768
  v_mfma_f32_16x16x32_bf16 v[208:211], v[148:151], v[148:151], 0
  ds_read_b64_tr_b16 a[160:161], v116 offset:38912
  buffer_load_dwordx4 v120, s[28:31], s68 offen offset:0 sc1  lds
  v_mfma_f32_16x16x32_bf16 v[204:207], v[192:195], v[148:151], 0
  ds_read_b64_tr_b16 a[162:163], v116 offset:45056
  v_mfma_f32_16x16x32_bf16 v[200:203], v[140:143], v[140:143], 0
  ds_read_b64_tr_b16 a[140:141], v117 offset:26624
  v_mfma_f32_16x16x32_bf16 v[196:199], v[192:195], v[140:143], 0
  ds_read_b64_tr_b16 a[142:143], v117 offset:32768
  buffer_load_dwordx4 v121, s[28:31], s68 offen offset:1024 sc1  lds
  v_mfma_f32_16x16x32_bf16 v[208:211], v[152:155], v[152:155], v[208:211]
  ds_read_b64_tr_b16 a[164:165], v117 offset:38912
  v_mfma_f32_16x16x32_bf16 v[204:207], v[192:195], v[152:155], v[204:207]
  ds_read_b64_tr_b16 a[166:167], v117 offset:45056
  v_mfma_f32_16x16x32_bf16 v[200:203], v[144:147], v[144:147], v[200:203]
  ds_read_b64_tr_b16 a[144:145], v116 offset:28672
  buffer_load_dwordx4 v122, s[28:31], s68 offen offset:2048 sc1  lds
  v_mfma_f32_16x16x32_bf16 v[196:199], v[192:195], v[144:147], v[196:199]
  ds_read_b64_tr_b16 a[146:147], v116 offset:34816
  v_mfma_f32_16x16x32_bf16 v[52:55], a[76:79], a[28:31], 0
  s_add_u32 s44, s67, 3
  ds_read_b64_tr_b16 a[168:169], v116 offset:40960
  buffer_load_dwordx4 v123, s[28:31], s68 offen offset:3072 sc1  lds
  s_and_b32 s44, s44, 15
  s_mul_i32 s45, s44, 393216
  s_add_u32 s69, s45, s60
  s_add_u32 s70, s69, 4096
  s_add_u32 m0, s63, 0
  s_nop 0
  v_mfma_f32_16x16x32_bf16 v[52:55], a[52:55], a[8:11], v[52:55]
  ds_read_b64_tr_b16 a[170:171], v116 offset:47104
  v_mfma_f32_16x16x32_bf16 v[48:51], a[52:55], a[4:7], 0
  ds_read_b64_tr_b16 a[148:149], v117 offset:28672
  v_mfma_f32_16x16x32_bf16 v[48:51], a[76:79], a[24:27], v[48:51]
  ds_read_b64_tr_b16 a[150:151], v117 offset:34816
  buffer_load_dwordx4 v124, s[8:11], s69 offen offset:0  lds
  v_mfma_f32_16x16x32_bf16 v[100:103], a[20:23], a[80:83], 0
  ds_read_b64_tr_b16 a[172:173], v117 offset:40960
  v_mfma_f32_16x16x32_bf16 v[100:103], a[0:3], a[56:59], v[100:103]
  ds_read_b64_tr_b16 a[174:175], v117 offset:47104
  v_mfma_f32_16x16x32_bf16 v[64:67], a[4:7], a[56:59], 0
  buffer_load_dwordx4 v125, s[8:11], s69 offen offset:1024  lds
  v_mfma_f32_16x16x32_bf16 v[64:67], a[24:27], a[80:83], v[64:67]
  v_cndmask_b32 v205, v208, v209, s[78:79]
  v_cndmask_b32 v205, v205, v210, s[80:81]
  v_cndmask_b32 v205, v205, v211, s[82:83]
  v_mfma_f32_16x16x32_bf16 v[68:71], a[28:31], a[80:83], 0
  buffer_store_dwordx2 v[204:205], v212, s[4:7], s48 offen offset:2048 sc1
  v_cndmask_b32 v197, v200, v201, s[78:79]
  v_cndmask_b32 v197, v197, v202, s[80:81]
  v_mfma_f32_16x16x32_bf16 v[68:71], a[8:11], a[56:59], v[68:71]
  buffer_load_dwordx4 v124, s[8:11], s69 offen offset:2048  lds
  v_cndmask_b32 v197, v197, v203, s[82:83]
  buffer_store_dwordx2 v[196:197], v212, s[4:7], s48 offen offset:0 sc1
  v_mfma_f32_16x16x32_bf16 v[72:75], a[12:15], a[56:59], 0
  buffer_store_dwordx4 v[160:163], v136, s[4:7], s49 offen sc1
  v_mfma_f32_16x16x32_bf16 v[72:75], a[32:35], a[80:83], v[72:75]
  s_add_u32 s49, s49, 4096
  buffer_load_dwordx4 v125, s[8:11], s69 offen offset:3072  lds
  s_add_u32 m0, s63, 4096
  s_nop 0
  v_mfma_f32_16x16x32_bf16 v[76:79], a[36:39], a[80:83], 0
  buffer_store_dwordx4 v[164:167], v136, s[4:7], s49 offen sc1
  v_mfma_f32_16x16x32_bf16 v[76:79], a[16:19], a[56:59], v[76:79]
  s_add_u32 s49, s49, 4096
  buffer_store_dwordx4 v[168:171], v136, s[4:7], s49 offen sc1
  v_mfma_f32_16x16x32_bf16 v[92:95], a[16:19], a[60:63], 0
  s_add_u32 s49, s49, 4096
  buffer_load_dwordx4 v124, s[8:11], s70 offen offset:0  lds
  v_mfma_f32_16x16x32_bf16 v[92:95], a[36:39], a[84:87], v[92:95]
  v_mfma_f32_16x16x32_bf16 v[88:91], a[32:35], a[84:87], 0
  v_mfma_f32_16x16x32_bf16 v[88:91], a[12:15], a[60:63], v[88:91]
  buffer_load_dwordx4 v125, s[8:11], s70 offen offset:1024  lds
  v_mfma_f32_16x16x32_bf16 v[84:87], a[8:11], a[60:63], 0
  v_mfma_f32_16x16x32_bf16 v[84:87], a[28:31], a[84:87], v[84:87]
  v_mfma_f32_16x16x32_bf16 v[80:83], a[24:27], a[84:87], 0
  v_mfma_f32_16x16x32_bf16 v[80:83], a[4:7], a[60:63], v[80:83]
  s_add_u32 s44, s67, 4
  s_and_b32 s44, s44, 15
  s_mul_i32 s45, s44, s61
  s_add_u32 s68, s45, s59
  s_mov_b32 s66, 5
  s_mov_b32 s56, 2
  s_cmp_eq_u32 s66, s88
  s_cbranch_scc0 Lside_skip9
  s_call_b64 s[78:79], Lside_sub
Lside_skip9:
  s_branch Lp1_u1
  s_branch Lp1_common
Llayer:
  s_cmp_lg_u32 s40, 0
  s_cbranch_scc1 Lpdn2
  s_mov_b32 s43, 0x40000
  s_mov_b64 exec, 15
Lpol1:
  buffer_load_dword v250, v249, s[4:7], s77 offen sc1
  s_waitcnt vmcnt(0)
  v_cmp_gt_u32 vcc, 8, v250
  s_cbranch_vccz Lpdn2x
  s_sub_u32 s43, s43, 1
  s_cmp_lg_u32 s43, 0
  s_cbranch_scc1 Lpol1
Lpdn2x:
  s_mov_b64 exec, -1
Lpdn2:
  s_waitcnt vmcnt(0) lgkmcnt(0)
  s_barrier
  s_add_u32 s44, s67, 0
  s_and_b32 s44, s44, 15
  s_mul_i32 s45, s44, s61
  s_add_u32 s68, s45, s59
  s_add_u32 m0, s62, 73728
  s_nop 0
  buffer_load_dwordx4 v120, s[28:31], s68 offen offset:0 sc1  lds
  buffer_load_dwordx4 v121, s[28:31], s68 offen offset:1024 sc1  lds
  buffer_load_dwordx4 v122, s[28:31], s68 offen offset:2048 sc1  lds
  buffer_load_dwordx4 v123, s[28:31], s68 offen offset:3072 sc1  lds
  s_add_u32 s44, s67, s40
  s_add_u32 s44, s44, 0
  s_and_b32 s44, s44, 15
  s_mul_i32 s44, s44, s61
  s_lshl_b32 s45, s40, 10
  s_add_u32 m0, s45, 122880
  s_add_u32 s44, s44, s73
  buffer_load_dwordx4 v126, s[28:31], s44 offen sc1 lds
  s_add_u32 s44, s67, 1
  s_and_b32 s44, s44, 15
  s_mul_i32 s45, s44, s61
  s_add_u32 s68, s45, s59
  s_add_u32 m0, s62, 90112
  s_nop 0
  buffer_load_dwordx4 v120, s[28:31], s68 offen offset:0 sc1  lds
  buffer_load_dwordx4 v121, s[28:31], s68 offen offset:1024 sc1  lds
  buffer_load_dwordx4 v122, s[28:31], s68 offen offset:2048 sc1  lds
  buffer_load_dwordx4 v123, s[28:31], s68 offen offset:3072 sc1  lds
  ds_read_b64_tr_b16 a[40:41], v116 offset:0
  ds_read_b64_tr_b16 a[42:43], v116 offset:6144
  ds_read_b64_tr_b16 a[64:65], v116 offset:12288
  ds_read_b64_tr_b16 a[66:67], v116 offset:18432
  ds_read_b64_tr_b16 a[44:45], v117 offset:0
  ds_read_b64_tr_b16 a[46:47], v117 offset:6144
  ds_read_b64_tr_b16 a[68:69], v117 offset:12288
  ds_read_b64_tr_b16 a[70:71], v117 offset:18432
  ds_read_b64_tr_b16 a[48:49], v116 offset:2048
  ds_read_b64_tr_b16 a[50:51], v116 offset:8192
  ds_read_b64_tr_b16 a[72:73], v116 offset:14336
  ds_read_b64_tr_b16 a[74:75], v116 offset:20480
  ds_read_b64_tr_b16 a[52:53], v117 offset:2048
  ds_read_b64_tr_b16 a[54:55], v117 offset:8192
  ds_read_b64_tr_b16 a[76:77], v117 offset:14336
  ds_read_b64_tr_b16 a[78:79], v117 offset:20480
  ds_read_b64_tr_b16 a[56:57], v116 offset:4096
  ds_read_b64_tr_b16 a[58:59], v116 offset:10240
  ds_read_b64_tr_b16 a[80:81], v116 offset:16384
  ds_read_b64_tr_b16 a[82:83], v116 offset:22528
  ds_read_b64_tr_b16 a[60:61], v117 offset:4096
  ds_read_b64_tr_b16 a[62:63], v117 offset:10240
  ds_read_b64_tr_b16 a[84:85], v117 offset:16384
  ds_read_b64_tr_b16 a[86:87], v117 offset:22528
  s_waitcnt vmcnt(4)
  s_barrier
  ds_read_b128 a[4:7], v112 offset:0
  ds_read_b128 a[24:27], v113 offset:0
  ds_read_b128 a[8:11], v112 offset:2048
  ds_read_b128 a[28:31], v113 offset:2048
  ds_read_b128 a[12:15], v112 offset:4096
  ds_read_b128 a[32:35], v113 offset:4096
  ds_read_b128 a[16:19], v112 offset:6144
  ds_read_b128 a[36:39], v113 offset:6144
  ds_read_b128 a[0:3], v114 offset:0
  ds_read_b128 a[20:23], v115 offset:0
  s_add_u32 s44, s67, s40
  s_add_u32 s44, s44, 4
  s_and_b32 s44, s44, 15
  s_mul_i32 s44, s44, s61
  s_lshl_b32 s45, s40, 10
  s_add_u32 m0, s45, 126976
  s_add_u32 s44, s44, s73
  buffer_load_dwordx4 v126, s[28:31], s44 offen sc1 lds
  s_add_u32 s44, s67, s40
  s_add_u32 s44, s44, 8
  s_and_b32 s44, s44, 15
  s_mul_i32 s44, s44, s61
  s_lshl_b32 s45, s40, 10
  s_add_u32 m0, s45, 131072
  s_add_u32 s44, s44, s73
  buffer_load_dwordx4 v126, s[28:31], s44 offen sc1 lds
  s_add_u32 s44, s67, s40
  s_add_u32 s44, s44, 12
  s_and_b32 s44, s44, 15
  s_mul_i32 s44, s44, s61
  s_lshl_b32 s45, s40, 10
  s_add_u32 m0, s45, 135168
  s_add_u32 s44, s44, s73
  buffer_load_dwordx4 v126, s[28:31], s44 offen sc1 lds
  s_add_u32 s44, s67, 2
  s_and_b32 s44, s44, 15
  s_mul_i32 s45, s44, s61
  s_add_u32 s68, s45, s59
  s_add_u32 m0, s62, 106496
  s_nop 0
  buffer_load_dwordx4 v120, s[28:31], s68 offen offset:0 sc1  lds
  buffer_load_dwordx4 v121, s[28:31], s68 offen offset:1024 sc1  lds
  buffer_load_dwordx4 v122, s[28:31], s68 offen offset:2048 sc1  lds
  buffer_load_dwordx4 v123, s[28:31], s68 offen offset:3072 sc1  lds
  s_waitcnt lgkmcnt(0)
Lp1_common:
  s_mov_b32 s66, 4
  s_add_u32 s44, s67, 3
  s_and_b32 s44, s44, 15
  s_mul_i32 s45, s44, s61
  s_add_u32 s68, s45, s59
  s_mov_b32 s56, 2
.p2align 3
Lp1_loop:
  s_waitcnt lgkmcnt(15)
  v_mfma_f32_16x16x32_bf16 v[0:3], a[40:43], a[4:7], v[0:3]
  s_mul_i32 s45, s44, 393216
  v_mfma_f32_16x16x32_bf16 v[0:3], a[64:67], a[24:27], v[0:3]
  s_add_u32 s69, s45, s60
  v_mfma_f32_16x16x32_bf16 v[4:7], a[64:67], a[28:31], v[4:7]
  s_add_u32 s70, s69, 4096
  v_mfma_f32_16x16x32_bf16 v[4:7], a[40:43], a[8:11], v[4:7]
  v_mfma_f32_16x16x32_bf16 v[8:11], a[40:43], a[12:15], v[8:11]
  v_mfma_f32_16x16x32_bf16 v[8:11], a[64:67], a[32:35], v[8:11]
  v_mfma_f32_16x16x32_bf16 v[12:15], a[64:67], a[36:39], v[12:15]
  v_mfma_f32_16x16x32_bf16 v[12:15], a[40:43], a[16:19], v[12:15]
  v_mfma_f32_16x16x32_bf16 v[28:31], a[44:47], a[16:19], v[28:31]
  v_mfma_f32_16x16x32_bf16 v[28:31], a[68:71], a[36:39], v[28:31]
  v_mfma_f32_16x16x32_bf16 v[24:27], a[68:71], a[32:35], v[24:27]
  s_waitcnt vmcnt(7) lgkmcnt(0)
  s_barrier
  ds_read_b64_tr_b16 a[128:129], v116 offset:24576
  v_mfma_f32_16x16x32_bf16 v[24:27], a[44:47], a[12:15], v[24:27]
  s_add_u32 m0, s62, 73728
  ds_read_b64_tr_b16 a[130:131], v116 offset:30720
  v_mfma_f32_16x16x32_bf16 v[20:23], a[44:47], a[8:11], v[20:23]
  ds_read_b64_tr_b16 a[152:153], v116 offset:36864
  buffer_load_dwordx4 v120, s[28:31], s68 offen offset:0 sc1  lds
  v_mfma_f32_16x16x32_bf16 v[20:23], a[68:71], a[28:31], v[20:23]
  ds_read_b64_tr_b16 a[154:155], v116 offset:43008
  v_mfma_f32_16x16x32_bf16 v[16:19], a[68:71], a[24:27], v[16:19]
  ds_read_b128 a[92:95], v112 offset:16384
  v_mfma_f32_16x16x32_bf16 v[16:19], a[44:47], a[4:7], v[16:19]
  ds_read_b128 a[112:115], v113 offset:16384
  v_mfma_f32_16x16x32_bf16 v[96:99], a[48:51], a[0:3], v[96:99]
  ds_read_b128 a[96:99], v112 offset:18432
  buffer_load_dwordx4 v121, s[28:31], s68 offen offset:1024 sc1  lds
  v_mfma_f32_16x16x32_bf16 v[96:99], a[72:75], a[20:23], v[96:99]
  ds_read_b128 a[116:119], v113 offset:18432
  v_mfma_f32_16x16x32_bf16 v[32:35], a[72:75], a[24:27], v[32:35]
  ds_read_b128 a[100:103], v112 offset:20480
  v_mfma_f32_16x16x32_bf16 v[32:35], a[48:51], a[4:7], v[32:35]
  ds_read_b128 a[120:123], v113 offset:20480
  v_mfma_f32_16x16x32_bf16 v[36:39], a[48:51], a[8:11], v[36:39]
  ds_read_b128 a[104:107], v112 offset:22528
  buffer_load_dwordx4 v122, s[28:31], s68 offen offset:2048 sc1  lds
  v_mfma_f32_16x16x32_bf16 v[36:39], a[72:75], a[28:31], v[36:39]
  ds_read_b128 a[124:127], v113 offset:22528
  v_mfma_f32_16x16x32_bf16 v[40:43], a[72:75], a[32:35], v[40:43]
  ds_read_b64_tr_b16 a[132:133], v117 offset:24576
  v_mfma_f32_16x16x32_bf16 v[40:43], a[48:51], a[12:15], v[40:43]
  ds_read_b64_tr_b16 a[134:135], v117 offset:30720
  v_mfma_f32_16x16x32_bf16 v[44:47], a[48:51], a[16:19], v[44:47]
  ds_read_b64_tr_b16 a[156:157], v117 offset:36864
  buffer_load_dwordx4 v123, s[28:31], s68 offen offset:3072 sc1  lds
  v_mfma_f32_16x16x32_bf16 v[44:47], a[72:75], a[36:39], v[44:47]
  ds_read_b64_tr_b16 a[158:159], v117 offset:43008
  v_mfma_f32_16x16x32_bf16 v[60:63], a[76:79], a[36:39], v[60:63]
  ds_read_b128 a[88:91], v114 offset:1024
  v_mfma_f32_16x16x32_bf16 v[60:63], a[52:55], a[16:19], v[60:63]
  s_add_u32 m0, s63, 0
  ds_read_b128 a[108:111], v115 offset:1024
  v_mfma_f32_16x16x32_bf16 v[56:59], a[52:55], a[12:15], v[56:59]
  ds_read_b64_tr_b16 a[136:137], v116 offset:26624
  buffer_load_dwordx4 v124, s[8:11], s69 offen offset:0  lds
  v_mfma_f32_16x16x32_bf16 v[56:59], a[76:79], a[32:35], v[56:59]
  ds_read_b64_tr_b16 a[138:139], v116 offset:32768
  v_mfma_f32_16x16x32_bf16 v[52:55], a[76:79], a[28:31], v[52:55]
  s_add_u32 s44, s44, 1
  ds_read_b64_tr_b16 a[160:161], v116 offset:38912
  v_mfma_f32_16x16x32_bf16 v[52:55], a[52:55], a[8:11], v[52:55]
  s_and_b32 s44, s44, 15
  ds_read_b64_tr_b16 a[162:163], v116 offset:45056
  v_mfma_f32_16x16x32_bf16 v[48:51], a[52:55], a[4:7], v[48:51]
  s_add_u32 s66, s66, 1
  ds_read_b64_tr_b16 a[140:141], v117 offset:26624
  buffer_load_dwordx4 v125, s[8:11], s69 offen offset:1024  lds
  v_mfma_f32_16x16x32_bf16 v[48:51], a[76:79], a[24:27], v[48:51]
  s_mul_i32 s45, s44, s61
  ds_read_b64_tr_b16 a[142:143], v117 offset:32768
  v_mfma_f32_16x16x32_bf16 v[100:103], a[20:23], a[80:83], v[100:103]
  s_add_u32 s68, s45, s59
  ds_read_b64_tr_b16 a[164:165], v117 offset:38912
  v_mfma_f32_16x16x32_bf16 v[100:103], a[0:3], a[56:59], v[100:103]
  ds_read_b64_tr_b16 a[166:167], v117 offset:45056
  v_mfma_f32_16x16x32_bf16 v[64:67], a[4:7], a[56:59], v[64:67]
  ds_read_b64_tr_b16 a[144:145], v116 offset:28672
  buffer_load_dwordx4 v124, s[8:11], s69 offen offset:2048  lds
  v_mfma_f32_16x16x32_bf16 v[64:67], a[24:27], a[80:83], v[64:67]
  ds_read_b64_tr_b16 a[146:147], v116 offset:34816
  v_mfma_f32_16x16x32_bf16 v[68:71], a[28:31], a[80:83], v[68:71]
  ds_read_b64_tr_b16 a[168:169], v116 offset:40960
  v_mfma_f32_16x16x32_bf16 v[68:71], a[8:11], a[56:59], v[68:71]
  ds_read_b64_tr_b16 a[170:171], v116 offset:47104
  v_mfma_f32_16x16x32_bf16 v[72:75], a[12:15], a[56:59], v[72:75]
  ds_read_b64_tr_b16 a[148:149], v117 offset:28672
  buffer_load_dwordx4 v125, s[8:11], s69 offen offset:3072  lds
  v_mfma_f32_16x16x32_bf16 v[72:75], a[32:35], a[80:83], v[72:75]
  ds_read_b64_tr_b16 a[150:151], v117 offset:34816
  v_mfma_f32_16x16x32_bf16 v[76:79], a[36:39], a[80:83], v[76:79]
  ds_read_b64_tr_b16 a[172:173], v117 offset:40960
  v_mfma_f32_16x16x32_bf16 v[76:79], a[16:19], a[56:59], v[76:79]
  s_add_u32 m0, s63, 4096
  ds_read_b64_tr_b16 a[174:175], v117 offset:47104
  v_mfma_f32_16x16x32_bf16 v[92:95], a[16:19], a[60:63], v[92:95]
  buffer_load_dwordx4 v124, s[8:11], s70 offen offset:0  lds
  v_mfma_f32_16x16x32_bf16 v[92:95], a[36:39], a[84:87], v[92:95]
  v_mfma_f32_16x16x32_bf16 v[88:91], a[32:35], a[84:87], v[88:91]
  v_mfma_f32_16x16x32_bf16 v[88:91], a[12:15], a[60:63], v[88:91]
  v_mfma_f32_16x16x32_bf16 v[84:87], a[8:11], a[60:63], v[84:87]
  buffer_load_dwordx4 v125, s[8:11], s70 offen offset:1024  lds
  v_mfma_f32_16x16x32_bf16 v[84:87], a[28:31], a[84:87], v[84:87]
  v_mfma_f32_16x16x32_bf16 v[80:83], a[24:27], a[84:87], v[80:83]
  v_mfma_f32_16x16x32_bf16 v[80:83], a[4:7], a[60:63], v[80:83]
  s_cmp_eq_u32 s66, s88
  s_cbranch_scc0 Lside_skip0
  s_call_b64 s[78:79], Lside_sub
Lside_skip0:
Lp1_u1:
  s_waitcnt lgkmcnt(15)
  v_mfma_f32_16x16x32_bf16 v[0:3], a[128:131], a[92:95], v[0:3]
  s_mul_i32 s45, s44, 393216
  v_mfma_f32_16x16x32_bf16 v[0:3], a[152:155], a[112:115], v[0:3]
  s_add_u32 s69, s45, s60
  v_mfma_f32_16x16x32_bf16 v[4:7], a[152:155], a[116:119], v[4:7]
  s_add_u32 s70, s69, 4096
  v_mfma_f32_16x16x32_bf16 v[4:7], a[128:131], a[96:99], v[4:7]
  v_mfma_f32_16x16x32_bf16 v[8:11], a[128:131], a[100:103], v[8:11]
  v_mfma_f32_16x16x32_bf16 v[8:11], a[152:155], a[120:123], v[8:11]
  v_mfma_f32_16x16x32_bf16 v[12:15], a[152:155], a[124:127], v[12:15]
  v_mfma_f32_16x16x32_bf16 v[12:15], a[128:131], a[104:107], v[12:15]
  v_mfma_f32_16x16x32_bf16 v[28:31], a[132:135], a[104:107], v[28:31]
  v_mfma_f32_16x16x32_bf16 v[28:31], a[156:159], a[124:127], v[28:31]
  v_mfma_f32_16x16x32_bf16 v[24:27], a[156:159], a[120:123], v[24:27]
  s_waitcnt vmcnt(10) lgkmcnt(0)
  s_barrier
  ds_read_b64_tr_b16 a[40:41], v118 offset:0
  v_mfma_f32_16x16x32_bf16 v[24:27], a[132:135], a[100:103], v[24:27]
  s_add_u32 m0, s62, 90112
  ds_read_b64_tr_b16 a[42:43], v118 offset:6144
  v_mfma_f32_16x16x32_bf16 v[20:23], a[132:135], a[96:99], v[20:23]
  ds_read_b64_tr_b16 a[64:65], v118 offset:12288
  buffer_load_dwordx4 v120, s[28:31], s68 offen offset:0 sc1  lds
  v_mfma_f32_16x16x32_bf16 v[20:23], a[156:159], a[116:119], v[20:23]
  ds_read_b64_tr_b16 a[66:67], v118 offset:18432
  v_mfma_f32_16x16x32_bf16 v[16:19], a[156:159], a[112:115], v[16:19]
  ds_read_b128 a[4:7], v112 offset:32768
  v_mfma_f32_16x16x32_bf16 v[16:19], a[132:135], a[92:95], v[16:19]
  ds_read_b128 a[24:27], v113 offset:32768
  v_mfma_f32_16x16x32_bf16 v[96:99], a[136:139], a[88:91], v[96:99]
  ds_read_b128 a[8:11], v112 offset:34816
  buffer_load_dwordx4 v121, s[28:31], s68 offen offset:1024 sc1  lds
  v_mfma_f32_16x16x32_bf16 v[96:99], a[160:163], a[108:111], v[96:99]
  ds_read_b128 a[28:31], v113 offset:34816
  v_mfma_f32_16x16x32_bf16 v[32:35], a[160:163], a[112:115], v[32:35]
  ds_read_b128 a[12:15], v112 offset:36864
  v_mfma_f32_16x16x32_bf16 v[32:35], a[136:139], a[92:95], v[32:35]
  ds_read_b128 a[32:35], v113 offset:36864
  v_mfma_f32_16x16x32_bf16 v[36:39], a[136:139], a[96:99], v[36:39]
  ds_read_b128 a[16:19], v112 offset:38912
  buffer_load_dwordx4 v122, s[28:31], s68 offen offset:2048 sc1  lds
  v_mfma_f32_16x16x32_bf16 v[36:39], a[160:163], a[116:119], v[36:39]
  ds_read_b128 a[36:39], v113 offset:38912
  v_mfma_f32_16x16x32_bf16 v[40:43], a[160:163], a[120:123], v[40:43]
  ds_read_b64_tr_b16 a[44:45], v119 offset:0
  v_mfma_f32_16x16x32_bf16 v[40:43], a[136:139], a[100:103], v[40:43]
  ds_read_b64_tr_b16 a[46:47], v119 offset:6144
  v_mfma_f32_16x16x32_bf16 v[44:47], a[136:139], a[104:107], v[44:47]
  ds_read_b64_tr_b16 a[68:69], v119 offset:12288
  buffer_load_dwordx4 v123, s[28:31], s68 offen offset:3072 sc1  lds
  v_mfma_f32_16x16x32_bf16 v[44:47], a[160:163], a[124:127], v[44:47]
  ds_read_b64_tr_b16 a[70:71], v119 offset:18432
  v_mfma_f32_16x16x32_bf16 v[60:63], a[164:167], a[124:127], v[60:63]
  ds_read_b128 a[0:3], v114 offset:2048
  v_mfma_f32_16x16x32_bf16 v[60:63], a[140:143], a[104:107], v[60:63]
  s_add_u32 m0, s63, 24576
  ds_read_b128 a[20:23], v115 offset:2048
  v_mfma_f32_16x16x32_bf16 v[56:59], a[140:143], a[100:103], v[56:59]
  ds_read_b64_tr_b16 a[48:49], v118 offset:2048
  buffer_load_dwordx4 v124, s[8:11], s69 offen offset:0  lds
  v_mfma_f32_16x16x32_bf16 v[56:59], a[164:167], a[120:123], v[56:59]
  ds_read_b64_tr_b16 a[50:51], v118 offset:8192
  v_mfma_f32_16x16x32_bf16 v[52:55], a[164:167], a[116:119], v[52:55]
  s_add_u32 s44, s44, 1
  ds_read_b64_tr_b16 a[72:73], v118 offset:14336
  v_mfma_f32_16x16x32_bf16 v[52:55], a[140:143], a[96:99], v[52:55]
  s_and_b32 s44, s44, 15
  ds_read_b64_tr_b16 a[74:75], v118 offset:20480
  v_mfma_f32_16x16x32_bf16 v[48:51], a[140:143], a[92:95], v[48:51]
  s_add_u32 s66, s66, 1
  ds_read_b64_tr_b16 a[52:53], v119 offset:2048
  buffer_load_dwordx4 v125, s[8:11], s69 offen offset:1024  lds
  v_mfma_f32_16x16x32_bf16 v[48:51], a[164:167], a[112:115], v[48:51]
  s_mul_i32 s45, s44, s61
  ds_read_b64_tr_b16 a[54:55], v119 offset:8192
  v_mfma_f32_16x16x32_bf16 v[100:103], a[108:111], a[168:171], v[100:103]
  s_add_u32 s68, s45, s59
  ds_read_b64_tr_b16 a[76:77], v119 offset:14336
  v_mfma_f32_16x16x32_bf16 v[100:103], a[88:91], a[144:147], v[100:103]
  ds_read_b64_tr_b16 a[78:79], v119 offset:20480
  v_mfma_f32_16x16x32_bf16 v[64:67], a[92:95], a[144:147], v[64:67]
  ds_read_b64_tr_b16 a[56:57], v118 offset:4096
  buffer_load_dwordx4 v124, s[8:11], s69 offen offset:2048  lds
  v_mfma_f32_16x16x32_bf16 v[64:67], a[112:115], a[168:171], v[64:67]
  ds_read_b64_tr_b16 a[58:59], v118 offset:10240
  v_mfma_f32_16x16x32_bf16 v[68:71], a[116:119], a[168:171], v[68:71]
  ds_read_b64_tr_b16 a[80:81], v118 offset:16384
  v_mfma_f32_16x16x32_bf16 v[68:71], a[96:99], a[144:147], v[68:71]
  ds_read_b64_tr_b16 a[82:83], v118 offset:22528
  v_mfma_f32_16x16x32_bf16 v[72:75], a[100:103], a[144:147], v[72:75]
  ds_read_b64_tr_b16 a[60:61], v119 offset:4096
  buffer_load_dwordx4 v125, s[8:11], s69 offen offset:3072  lds
  v_mfma_f32_16x16x32_bf16 v[72:75], a[120:123], a[168:171], v[72:75]
  ds_read_b64_tr_b16 a[62:63], v119 offset:10240
  v_mfma_f32_16x16x32_bf16 v[76:79], a[124:127], a[168:171], v[76:79]
  ds_read_b64_tr_b16 a[84:85], v119 offset:16384
  v_mfma_f32_16x16x32_bf16 v[76:79], a[104:107], a[144:147], v[76:79]
  s_add_u32 m0, s63, 28672
  ds_read_b64_tr_b16 a[86:87], v119 offset:22528
  v_mfma_f32_16x16x32_bf16 v[92:95], a[104:107], a[148:151], v[92:95]
  buffer_load_dwordx4 v124, s[8:11], s70 offen offset:0  lds
  v_mfma_f32_16x16x32_bf16 v[92:95], a[124:127], a[172:175], v[92:95]
  v_mfma_f32_16x16x32_bf16 v[88:91], a[120:123], a[172:175], v[88:91]
  v_mfma_f32_16x16x32_bf16 v[88:91], a[100:103], a[148:151], v[88:91]
  v_mfma_f32_16x16x32_bf16 v[84:87], a[96:99], a[148:151], v[84:87]
  buffer_load_dwordx4 v125, s[8:11], s70 offen offset:1024  lds
  v_mfma_f32_16x16x32_bf16 v[84:87], a[116:119], a[172:175], v[84:87]
  v_mfma_f32_16x16x32_bf16 v[80:83], a[112:115], a[172:175], v[80:83]
  v_mfma_f32_16x16x32_bf16 v[80:83], a[92:95], a[148:151], v[80:83]
  s_cmp_eq_u32 s66, s88
  s_cbranch_scc0 Lside_skip1
  s_call_b64 s[78:79], Lside_sub
Lside_skip1:
  s_waitcnt lgkmcnt(15)
  v_mfma_f32_16x16x32_bf16 v[0:3], a[40:43], a[4:7], v[0:3]
  s_mul_i32 s45, s44, 393216
  v_mfma_f32_16x16x32_bf16 v[0:3], a[64:67], a[24:27], v[0:3]
  s_add_u32 s69, s45, s60
  v_mfma_f32_16x16x32_bf16 v[4:7], a[64:67], a[28:31], v[4:7]
  s_add_u32 s70, s69, 4096
  v_mfma_f32_16x16x32_bf16 v[4:7], a[40:43], a[8:11], v[4:7]
  v_mfma_f32_16x16x32_bf16 v[8:11], a[40:43], a[12:15], v[8:11]
  v_mfma_f32_16x16x32_bf16 v[8:11], a[64:67], a[32:35], v[8:11]
  v_mfma_f32_16x16x32_bf16 v[12:15], a[64:67], a[36:39], v[12:15]
  v_mfma_f32_16x16x32_bf16 v[12:15], a[40:43], a[16:19], v[12:15]
  v_mfma_f32_16x16x32_bf16 v[28:31], a[44:47], a[16:19], v[28:31]
  v_mfma_f32_16x16x32_bf16 v[28:31], a[68:71], a[36:39], v[28:31]
  v_mfma_f32_16x16x32_bf16 v[24:27], a[68:71], a[32:35], v[24:27]
  s_waitcnt vmcnt(10) lgkmcnt(0)
  s_barrier
  ds_read_b64_tr_b16 a[128:129], v116 offset:0
  v_mfma_f32_16x16x32_bf16 v[24:27], a[44:47], a[12:15], v[24:27]
  s_add_u32 m0, s62, 106496
  ds_read_b64_tr_b16 a[130:131], v116 offset:6144
  v_mfma_f32_16x16x32_bf16 v[20:23], a[44:47], a[8:11], v[20:23]
  ds_read_b64_tr_b16 a[152:153], v116 offset:12288
  buffer_load_dwordx4 v120, s[28:31], s68 offen offset:0 sc1  lds
  v_mfma_f32_16x16x32_bf16 v[20:23], a[68:71], a[28:31], v[20:23]
  ds_read_b64_tr_b16 a[154:155], v116 offset:18432
  v_mfma_f32_16x16x32_bf16 v[16:19], a[68:71], a[24:27], v[16:19]
  ds_read_b128 a[92:95], v112 offset:0
  v_mfma_f32_16x16x32_bf16 v[16:19], a[44:47], a[4:7], v[16:19]
  ds_read_b128 a[112:115], v113 offset:0
  v_mfma_f32_16x16x32_bf16 v[96:99], a[48:51], a[0:3], v[96:99]
  ds_read_b128 a[96:99], v112 offset:2048
  buffer_load_dwordx4 v121, s[28:31], s68 offen offset:1024 sc1  lds
  v_mfma_f32_16x16x32_bf16 v[96:99], a[72:75], a[20:23], v[96:99]
  ds_read_b128 a[116:119], v113 offset:2048
  v_mfma_f32_16x16x32_bf16 v[32:35], a[72:75], a[24:27], v[32:35]
  ds_read_b128 a[100:103], v112 offset:4096
  v_mfma_f32_16x16x32_bf16 v[32:35], a[48:51], a[4:7], v[32:35]
  ds_read_b128 a[120:123], v113 offset:4096
  v_mfma_f32_16x16x32_bf16 v[36:39], a[48:51], a[8:11], v[36:39]
  ds_read_b128 a[104:107], v112 offset:6144
  buffer_load_dwordx4 v122, s[28:31], s68 offen offset:2048 sc1  lds
  v_mfma_f32_16x16x32_bf16 v[36:39], a[72:75], a[28:31], v[36:39]
  ds_read_b128 a[124:127], v113 offset:6144
  v_mfma_f32_16x16x32_bf16 v[40:43], a[72:75], a[32:35], v[40:43]
  ds_read_b64_tr_b16 a[132:133], v117 offset:0
  v_mfma_f32_16x16x32_bf16 v[40:43], a[48:51], a[12:15], v[40:43]
  ds_read_b64_tr_b16 a[134:135], v117 offset:6144
  v_mfma_f32_16x16x32_bf16 v[44:47], a[48:51], a[16:19], v[44:47]
  ds_read_b64_tr_b16 a[156:157], v117 offset:12288
  buffer_load_dwordx4 v123, s[28:31], s68 offen offset:3072 sc1  lds
  v_mfma_f32_16x16x32_bf16 v[44:47], a[72:75], a[36:39], v[44:47]
  ds_read_b64_tr_b16 a[158:159], v117 offset:18432
  v_mfma_f32_16x16x32_bf16 v[60:63], a[76:79], a[36:39], v[60:63]
  ds_read_b128 a[88:91], v114 offset:3072
  v_mfma_f32_16x16x32_bf16 v[60:63], a[52:55], a[16:19], v[60:63]
  s_add_u32 m0, s63, 49152
  ds_read_b128 a[108:111], v115 offset:3072
  v_mfma_f32_16x16x32_bf16 v[56:59], a[52:55], a[12:15], v[56:59]
  ds_read_b64_tr_b16 a[136:137], v116 offset:2048
  buffer_load_dwordx4 v124, s[8:11], s69 offen offset:0  lds
  v_mfma_f32_16x16x32_bf16 v[56:59], a[76:79], a[32:35], v[56:59]
  ds_read_b64_tr_b16 a[138:139], v116 offset:8192
  v_mfma_f32_16x16x32_bf16 v[52:55], a[76:79], a[28:31], v[52:55]
  s_add_u32 s44, s44, 1
  ds_read_b64_tr_b16 a[160:161], v116 offset:14336
  v_mfma_f32_16x16x32_bf16 v[52:55], a[52:55], a[8:11], v[52:55]
  s_and_b32 s44, s44, 15
  ds_read_b64_tr_b16 a[162:163], v116 offset:20480
  v_mfma_f32_16x16x32_bf16 v[48:51], a[52:55], a[4:7], v[48:51]
  s_add_u32 s66, s66, 1
  ds_read_b64_tr_b16 a[140:141], v117 offset:2048
  buffer_load_dwordx4 v125, s[8:11], s69 offen offset:1024  lds
  v_mfma_f32_16x16x32_bf16 v[48:51], a[76:79], a[24:27], v[48:51]
  s_mul_i32 s45, s44, s61
  ds_read_b64_tr_b16 a[142:143], v117 offset:8192
  v_mfma_f32_16x16x32_bf16 v[100:103], a[20:23], a[80:83], v[100:103]
  s_add_u32 s68, s45, s59
  ds_read_b64_tr_b16 a[164:165], v117 offset:14336
  v_mfma_f32_16x16x32_bf16 v[100:103], a[0:3], a[56:59], v[100:103]
  ds_read_b64_tr_b16 a[166:167], v117 offset:20480
  v_mfma_f32_16x16x32_bf16 v[64:67], a[4:7], a[56:59], v[64:67]
  ds_read_b64_tr_b16 a[144:145], v116 offset:4096
  buffer_load_dwordx4 v124, s[8:11], s69 offen offset:2048  lds
  v_mfma_f32_16x16x32_bf16 v[64:67], a[24:27], a[80:83], v[64:67]
  ds_read_b64_tr_b16 a[146:147], v116 offset:10240
  v_mfma_f32_16x16x32_bf16 v[68:71], a[28:31], a[80:83], v[68:71]
  ds_read_b64_tr_b16 a[168:169], v116 offset:16384
  v_mfma_f32_16x16x32_bf16 v[68:71], a[8:11], a[56:59], v[68:71]
  ds_read_b64_tr_b16 a[170:171], v116 offset:22528
  v_mfma_f32_16x16x32_bf16 v[72:75], a[12:15], a[56:59], v[72:75]
  ds_read_b64_tr_b16 a[148:149], v117 offset:4096
  buffer_load_dwordx4 v125, s[8:11], s69 offen offset:3072  lds
  v_mfma_f32_16x16x32_bf16 v[72:75], a[32:35], a[80:83], v[72:75]
  ds_read_b64_tr_b16 a[150:151], v117 offset:10240
  v_mfma_f32_16x16x32_bf16 v[76:79], a[36:39], a[80:83], v[76:79]
  ds_read_b64_tr_b16 a[172:173], v117 offset:16384
  v_mfma_f32_16x16x32_bf16 v[76:79], a[16:19], a[56:59], v[76:79]
  s_add_u32 m0, s63, 53248
  ds_read_b64_tr_b16 a[174:175], v117 offset:22528
  v_mfma_f32_16x16x32_bf16 v[92:95], a[16:19], a[60:63], v[92:95]
  buffer_load_dwordx4 v124, s[8:11], s70 offen offset:0  lds
  v_mfma_f32_16x16x32_bf16 v[92:95], a[36:39], a[84:87], v[92:95]
  v_mfma_f32_16x16x32_bf16 v[88:91], a[32:35], a[84:87], v[88:91]
  v_mfma_f32_16x16x32_bf16 v[88:91], a[12:15], a[60:63], v[88:91]
  v_mfma_f32_16x16x32_bf16 v[84:87], a[8:11], a[60:63], v[84:87]
  buffer_load_dwordx4 v125, s[8:11], s70 offen offset:1024  lds
  v_mfma_f32_16x16x32_bf16 v[84:87], a[28:31], a[84:87], v[84:87]
  v_mfma_f32_16x16x32_bf16 v[80:83], a[24:27], a[84:87], v[80:83]
  v_mfma_f32_16x16x32_bf16 v[80:83], a[4:7], a[60:63], v[80:83]
  s_cmp_eq_u32 s66, s88
  s_cbranch_scc0 Lside_skip2
  s_call_b64 s[78:79], Lside_sub
Lside_skip2:
  s_waitcnt lgkmcnt(15)
  v_mfma_f32_16x16x32_bf16 v[0:3], a[128:131], a[92:95], v[0:3]
  s_mul_i32 s45, s44, 393216
  v_mfma_f32_16x16x32_bf16 v[0:3], a[152:155], a[112:115], v[0:3]
  s_add_u32 s69, s45, s60
  v_mfma_f32_16x16x32_bf16 v[4:7], a[152:155], a[116:119], v[4:7]
  s_add_u32 s70, s69, 4096
  v_mfma_f32_16x16x32_bf16 v[4:7], a[128:131], a[96:99], v[4:7]
  v_mfma_f32_16x16x32_bf16 v[8:11], a[128:131], a[100:103], v[8:11]
  v_mfma_f32_16x16x32_bf16 v[8:11], a[152:155], a[120:123], v[8:11]
  v_mfma_f32_16x16x32_bf16 v[12:15], a[152:155], a[124:127], v[12:15]
  v_mfma_f32_16x16x32_bf16 v[12:15], a[128:131], a[104:107], v[12:15]
  v_mfma_f32_16x16x32_bf16 v[28:31], a[132:135], a[104:107], v[28:31]
  v_mfma_f32_16x16x32_bf16 v[28:31], a[156:159], a[124:127], v[28:31]
  v_mfma_f32_16x16x32_bf16 v[24:27], a[156:159], a[120:123], v[24:27]
  s_waitcnt vmcnt(10) lgkmcnt(0)
  s_barrier
  ds_read_b64_tr_b16 a[40:41], v116 offset:24576
  v_mfma_f32_16x16x32_bf16 v[24:27], a[132:135], a[100:103], v[24:27]
  s_add_u32 m0, s62, 73728
  ds_read_b64_tr_b16 a[42:43], v116 offset:30720
  v_mfma_f32_16x16x32_bf16 v[20:23], a[132:135], a[96:99], v[20:23]
  ds_read_b64_tr_b16 a[64:65], v116 offset:36864
  buffer_load_dwordx4 v120, s[28:31], s68 offen offset:0 sc1  lds
  v_mfma_f32_16x16x32_bf16 v[20:23], a[156:159], a[116:119], v[20:23]
  ds_read_b64_tr_b16 a[66:67], v116 offset:43008
  v_mfma_f32_16x16x32_bf16 v[16:19], a[156:159], a[112:115], v[16:19]
  ds_read_b128 a[4:7], v112 offset:16384
  v_mfma_f32_16x16x32_bf16 v[16:19], a[132:135], a[92:95], v[16:19]
  ds_read_b128 a[24:27], v113 offset:16384
  v_mfma_f32_16x16x32_bf16 v[96:99], a[136:139], a[88:91], v[96:99]
  ds_read_b128 a[8:11], v112 offset:18432
  buffer_load_dwordx4 v121, s[28:31], s68 offen offset:1024 sc1  lds
  v_mfma_f32_16x16x32_bf16 v[96:99], a[160:163], a[108:111], v[96:99]
  ds_read_b128 a[28:31], v113 offset:18432
  v_mfma_f32_16x16x32_bf16 v[32:35], a[160:163], a[112:115], v[32:35]
  ds_read_b128 a[12:15], v112 offset:20480
  v_mfma_f32_16x16x32_bf16 v[32:35], a[136:139], a[92:95], v[32:35]
  ds_read_b128 a[32:35], v113 offset:20480
  v_mfma_f32_16x16x32_bf16 v[36:39], a[136:139], a[96:99], v[36:39]
  ds_read_b128 a[16:19], v112 offset:22528
  buffer_load_dwordx4 v122, s[28:31], s68 offen offset:2048 sc1  lds
  v_mfma_f32_16x16x32_bf16 v[36:39], a[160:163], a[116:119], v[36:39]
  ds_read_b128 a[36:39], v113 offset:22528
  v_mfma_f32_16x16x32_bf16 v[40:43], a[160:163], a[120:123], v[40:43]
  ds_read_b64_tr_b16 a[44:45], v117 offset:24576
  v_mfma_f32_16x16x32_bf16 v[40:43], a[136:139], a[100:103], v[40:43]
  ds_read_b64_tr_b16 a[46:47], v117 offset:30720
  v_mfma_f32_16x16x32_bf16 v[44:47], a[136:139], a[104:107], v[44:47]
  ds_read_b64_tr_b16 a[68:69], v117 offset:36864
  buffer_load_dwordx4 v123, s[28:31], s68 offen offset:3072 sc1  lds
  v_mfma_f32_16x16x32_bf16 v[44:47], a[160:163], a[124:127], v[44:47]
  ds_read_b64_tr_b16 a[70:71], v117 offset:43008
  v_mfma_f32_16x16x32_bf16 v[60:63], a[164:167], a[124:127], v[60:63]
  ds_read_b128 a[0:3], v114 offset:4096
  v_mfma_f32_16x16x32_bf16 v[60:63], a[140:143], a[104:107], v[60:63]
  s_add_u32 m0, s63, 0
  ds_read_b128 a[20:23], v115 offset:4096
  v_mfma_f32_16x16x32_bf16 v[56:59], a[140:143], a[100:103], v[56:59]
  ds_read_b64_tr_b16 a[48:49], v116 offset:26624
  buffer_load_dwordx4 v124, s[8:11], s69 offen offset:0  lds
  v_mfma_f32_16x16x32_bf16 v[56:59], a[164:167], a[120:123], v[56:59]
  ds_read_b64_tr_b16 a[50:51], v116 offset:32768
  v_mfma_f32_16x16x32_bf16 v[52:55], a[164:167], a[116:119], v[52:55]
  s_add_u32 s44, s44, 1
  ds_read_b64_tr_b16 a[72:73], v116 offset:38912
  v_mfma_f32_16x16x32_bf16 v[52:55], a[140:143], a[96:99], v[52:55]
  s_and_b32 s44, s44, 15
  ds_read_b64_tr_b16 a[74:75], v116 offset:45056
  v_mfma_f32_16x16x32_bf16 v[48:51], a[140:143], a[92:95], v[48:51]
  s_add_u32 s66, s66, 1
  ds_read_b64_tr_b16 a[52:53], v117 offset:26624
  buffer_load_dwordx4 v125, s[8:11], s69 offen offset:1024  lds
  v_mfma_f32_16x16x32_bf16 v[48:51], a[164:167], a[112:115], v[48:51]
  s_mul_i32 s45, s44, s61
  ds_read_b64_tr_b16 a[54:55], v117 offset:32768
  v_mfma_f32_16x16x32_bf16 v[100:103], a[108:111], a[168:171], v[100:103]
  s_add_u32 s68, s45, s59
  ds_read_b64_tr_b16 a[76:77], v117 offset:38912
  v_mfma_f32_16x16x32_bf16 v[100:103], a[88:91], a[144:147], v[100:103]
  ds_read_b64_tr_b16 a[78:79], v117 offset:45056
  v_mfma_f32_16x16x32_bf16 v[64:67], a[92:95], a[144:147], v[64:67]
  ds_read_b64_tr_b16 a[56:57], v116 offset:28672
  buffer_load_dwordx4 v124, s[8:11], s69 offen offset:2048  lds
  v_mfma_f32_16x16x32_bf16 v[64:67], a[112:115], a[168:171], v[64:67]
  ds_read_b64_tr_b16 a[58:59], v116 offset:34816
  v_mfma_f32_16x16x32_bf16 v[68:71], a[116:119], a[168:171], v[68:71]
  ds_read_b64_tr_b16 a[80:81], v116 offset:40960
  v_mfma_f32_16x16x32_bf16 v[68:71], a[96:99], a[144:147], v[68:71]
  ds_read_b64_tr_b16 a[82:83], v116 offset:47104
  v_mfma_f32_16x16x32_bf16 v[72:75], a[100:103], a[144:147], v[72:75]
  ds_read_b64_tr_b16 a[60:61], v117 offset:28672
  buffer_load_dwordx4 v125, s[8:11], s69 offen offset:3072  lds
  v_mfma_f32_16x16x32_bf16 v[72:75], a[120:123], a[168:171], v[72:75]
  ds_read_b64_tr_b16 a[62:63], v117 offset:34816
  v_mfma_f32_16x16x32_bf16 v[76:79], a[124:127], a[168:171], v[76:79]
  ds_read_b64_tr_b16 a[84:85], v117 offset:40960
  v_mfma_f32_16x16x32_bf16 v[76:79], a[104:107], a[144:147], v[76:79]
  s_add_u32 m0, s63, 4096
  ds_read_b64_tr_b16 a[86:87], v117 offset:47104
  v_mfma_f32_16x16x32_bf16 v[92:95], a[104:107], a[148:151], v[92:95]
  buffer_load_dwordx4 v124, s[8:11], s70 offen offset:0  lds
  v_mfma_f32_16x16x32_bf16 v[92:95], a[124:127], a[172:175], v[92:95]
  v_mfma_f32_16x16x32_bf16 v[88:91], a[120:123], a[172:175], v[88:91]
  v_mfma_f32_16x16x32_bf16 v[88:91], a[100:103], a[148:151], v[88:91]
  v_mfma_f32_16x16x32_bf16 v[84:87], a[96:99], a[148:151], v[84:87]
  buffer_load_dwordx4 v125, s[8:11], s70 offen offset:1024  lds
  v_mfma_f32_16x16x32_bf16 v[84:87], a[116:119], a[172:175], v[84:87]
  v_mfma_f32_16x16x32_bf16 v[80:83], a[112:115], a[172:175], v[80:83]
  v_mfma_f32_16x16x32_bf16 v[80:83], a[92:95], a[148:151], v[80:83]
  s_cmp_eq_u32 s66, s88
  s_cbranch_scc0 Lside_skip3
  s_call_b64 s[78:79], Lside_sub
Lside_skip3:
  s_waitcnt lgkmcnt(15)
  v_mfma_f32_16x16x32_bf16 v[0:3], a[40:43], a[4:7], v[0:3]
  s_mul_i32 s45, s44, 393216
  v_mfma_f32_16x16x32_bf16 v[0:3], a[64:67], a[24:27], v[0:3]
  s_add_u32 s69, s45, s60
  v_mfma_f32_16x16x32_bf16 v[4:7], a[64:67], a[28:31], v[4:7]
  s_add_u32 s70, s69, 4096
  v_mfma_f32_16x16x32_bf16 v[4:7], a[40:43], a[8:11], v[4:7]
  v_mfma_f32_16x16x32_bf16 v[8:11], a[40:43], a[12:15], v[8:11]
  v_mfma_f32_16x16x32_bf16 v[8:11], a[64:67], a[32:35], v[8:11]
  v_mfma_f32_16x16x32_bf16 v[12:15], a[64:67], a[36:39], v[12:15]
  v_mfma_f32_16x16x32_bf16 v[12:15], a[40:43], a[16:19], v[12:15]
  v_mfma_f32_16x16x32_bf16 v[28:31], a[44:47], a[16:19], v[28:31]
  v_mfma_f32_16x16x32_bf16 v[28:31], a[68:71], a[36:39], v[28:31]
  v_mfma_f32_16x16x32_bf16 v[24:27], a[68:71], a[32:35], v[24:27]
  s_waitcnt vmcnt(10) lgkmcnt(0)
  s_barrier
  ds_read_b64_tr_b16 a[128:129], v118 offset:0
  v_mfma_f32_16x16x32_bf16 v[24:27], a[44:47], a[12:15], v[24:27]
  s_add_u32 m0, s62, 90112
  ds_read_b64_tr_b16 a[130:131], v118 offset:6144
  v_mfma_f32_16x16x32_bf16 v[20:23], a[44:47], a[8:11], v[20:23]
  ds_read_b64_tr_b16 a[152:153], v118 offset:12288
  buffer_load_dwordx4 v120, s[28:31], s68 offen offset:0 sc1  lds
  v_mfma_f32_16x16x32_bf16 v[20:23], a[68:71], a[28:31], v[20:23]
  ds_read_b64_tr_b16 a[154:155], v118 offset:18432
  v_mfma_f32_16x16x32_bf16 v[16:19], a[68:71], a[24:27], v[16:19]
  ds_read_b128 a[92:95], v112 offset:32768
  v_mfma_f32_16x16x32_bf16 v[16:19], a[44:47], a[4:7], v[16:19]
  ds_read_b128 a[112:115], v113 offset:32768
  v_mfma_f32_16x16x32_bf16 v[96:99], a[48:51], a[0:3], v[96:99]
  ds_read_b128 a[96:99], v112 offset:34816
  buffer_load_dwordx4 v121, s[28:31], s68 offen offset:1024 sc1  lds
  v_mfma_f32_16x16x32_bf16 v[96:99], a[72:75], a[20:23], v[96:99]
  ds_read_b128 a[116:119], v113 offset:34816
  v_mfma_f32_16x16x32_bf16 v[32:35], a[72:75], a[24:27], v[32:35]
  ds_read_b128 a[100:103], v112 offset:36864
  v_mfma_f32_16x16x32_bf16 v[32:35], a[48:51], a[4:7], v[32:35]
  ds_read_b128 a[120:123], v113 offset:36864
  v_mfma_f32_16x16x32_bf16 v[36:39], a[48:51], a[8:11], v[36:39]
  ds_read_b128 a[104:107], v112 offset:38912
  buffer_load_dwordx4 v122, s[28:31], s68 offen offset:2048 sc1  lds
  v_mfma_f32_16x16x32_bf16 v[36:39], a[72:75], a[28:31], v[36:39]
  ds_read_b128 a[124:127], v113 offset:38912
  v_mfma_f32_16x16x32_bf16 v[40:43], a[72:75], a[32:35], v[40:43]
  ds_read_b64_tr_b16 a[132:133], v119 offset:0
  v_mfma_f32_16x16x32_bf16 v[40:43], a[48:51], a[12:15], v[40:43]
  ds_read_b64_tr_b16 a[134:135], v119 offset:6144
  v_mfma_f32_16x16x32_bf16 v[44:47], a[48:51], a[16:19], v[44:47]
  ds_read_b64_tr_b16 a[156:157], v119 offset:12288
  buffer_load_dwordx4 v123, s[28:31], s68 offen offset:3072 sc1  lds
  v_mfma_f32_16x16x32_bf16 v[44:47], a[72:75], a[36:39], v[44:47]
  ds_read_b64_tr_b16 a[158:159], v119 offset:18432
  v_mfma_f32_16x16x32_bf16 v[60:63], a[76:79], a[36:39], v[60:63]
  ds_read_b128 a[88:91], v114 offset:5120
  v_mfma_f32_16x16x32_bf16 v[60:63], a[52:55], a[16:19], v[60:63]
  s_add_u32 m0, s63, 24576
  ds_read_b128 a[108:111], v115 offset:5120
  v_mfma_f32_16x16x32_bf16 v[56:59], a[52:55], a[12:15], v[56:59]
  ds_read_b64_tr_b16 a[136:137], v118 offset:2048
  buffer_load_dwordx4 v124, s[8:11], s69 offen offset:0  lds
  v_mfma_f32_16x16x32_bf16 v[56:59], a[76:79], a[32:35], v[56:59]
  ds_read_b64_tr_b16 a[138:139], v118 offset:8192
  v_mfma_f32_16x16x32_bf16 v[52:55], a[76:79], a[28:31], v[52:55]
  s_add_u32 s44, s44, 1
  ds_read_b64_tr_b16 a[160:161], v118 offset:14336
  v_mfma_f32_16x16x32_bf16 v[52:55], a[52:55], a[8:11], v[52:55]
  s_and_b32 s44, s44, 15
  ds_read_b64_tr_b16 a[162:163], v118 offset:20480
  v_mfma_f32_16x16x32_bf16 v[48:51], a[52:55], a[4:7], v[48:51]
  s_add_u32 s66, s66, 1
  ds_read_b64_tr_b16 a[140:141], v119 offset:2048
  buffer_load_dwordx4 v125, s[8:11], s69 offen offset:1024  lds
  v_mfma_f32_16x16x32_bf16 v[48:51], a[76:79], a[24:27], v[48:51]
  s_mul_i32 s45, s44, s61
  ds_read_b64_tr_b16 a[142:143], v119 offset:8192
  v_mfma_f32_16x16x32_bf16 v[100:103], a[20:23], a[80:83], v[100:103]
  s_add_u32 s68, s45, s59
  ds_read_b64_tr_b16 a[164:165], v119 offset:14336
  v_mfma_f32_16x16x32_bf16 v[100:103], a[0:3], a[56:59], v[100:103]
  ds_read_b64_tr_b16 a[166:167], v119 offset:20480
  v_mfma_f32_16x16x32_bf16 v[64:67], a[4:7], a[56:59], v[64:67]
  ds_read_b64_tr_b16 a[144:145], v118 offset:4096
  buffer_load_dwordx4 v124, s[8:11], s69 offen offset:2048  lds
  v_mfma_f32_16x16x32_bf16 v[64:67], a[24:27], a[80:83], v[64:67]
  ds_read_b64_tr_b16 a[146:147], v118 offset:10240
  v_mfma_f32_16x16x32_bf16 v[68:71], a[28:31], a[80:83], v[68:71]
  ds_read_b64_tr_b16 a[168:169], v118 offset:16384
  v_mfma_f32_16x16x32_bf16 v[68:71], a[8:11], a[56:59], v[68:71]
  ds_read_b64_tr_b16 a[170:171], v118 offset:22528
  v_mfma_f32_16x16x32_bf16 v[72:75], a[12:15], a[56:59], v[72:75]
  ds_read_b64_tr_b16 a[148:149], v119 offset:4096
  buffer_load_dwordx4 v125, s[8:11], s69 offen offset:3072  lds
  v_mfma_f32_16x16x32_bf16 v[72:75], a[32:35], a[80:83], v[72:75]
  ds_read_b64_tr_b16 a[150:151], v119 offset:10240
  v_mfma_f32_16x16x32_bf16 v[76:79], a[36:39], a[80:83], v[76:79]
  ds_read_b64_tr_b16 a[172:173], v119 offset:16384
  v_mfma_f32_16x16x32_bf16 v[76:79], a[16:19], a[56:59], v[76:79]
  s_add_u32 m0, s63, 28672
  ds_read_b64_tr_b16 a[174:175], v119 offset:22528
  v_mfma_f32_16x16x32_bf16 v[92:95], a[16:19], a[60:63], v[92:95]
  buffer_load_dwordx4 v124, s[8:11], s70 offen offset:0  lds
  v_mfma_f32_16x16x32_bf16 v[92:95], a[36:39], a[84:87], v[92:95]
  v_mfma_f32_16x16x32_bf16 v[88:91], a[32:35], a[84:87], v[88:91]
  v_mfma_f32_16x16x32_bf16 v[88:91], a[12:15], a[60:63], v[88:91]
  v_mfma_f32_16x16x32_bf16 v[84:87], a[8:11], a[60:63], v[84:87]
  buffer_load_dwordx4 v125, s[8:11], s70 offen offset:1024  lds
  v_mfma_f32_16x16x32_bf16 v[84:87], a[28:31], a[84:87], v[84:87]
  v_mfma_f32_16x16x32_bf16 v[80:83], a[24:27], a[84:87], v[80:83]
  v_mfma_f32_16x16x32_bf16 v[80:83], a[4:7], a[60:63], v[80:83]
  s_cmp_eq_u32 s66, s88
  s_cbranch_scc0 Lside_skip4
  s_call_b64 s[78:79], Lside_sub
Lside_skip4:
  s_waitcnt lgkmcnt(15)
  v_mfma_f32_16x16x32_bf16 v[0:3], a[128:131], a[92:95], v[0:3]
  s_mul_i32 s45, s44, 393216
  v_mfma_f32_16x16x32_bf16 v[0:3], a[152:155], a[112:115], v[0:3]
  s_add_u32 s69, s45, s60
  v_mfma_f32_16x16x32_bf16 v[4:7], a[152:155], a[116:119], v[4:7]
  s_add_u32 s70, s69, 4096
  v_mfma_f32_16x16x32_bf16 v[4:7], a[128:131], a[96:99], v[4:7]
  v_mfma_f32_16x16x32_bf16 v[8:11], a[128:131], a[100:103], v[8:11]
  v_mfma_f32_16x16x32_bf16 v[8:11], a[152:155], a[120:123], v[8:11]
  v_mfma_f32_16x16x32_bf16 v[12:15], a[152:155], a[124:127], v[12:15]
  v_mfma_f32_16x16x32_bf16 v[12:15], a[128:131], a[104:107], v[12:15]
  v_mfma_f32_16x16x32_bf16 v[28:31], a[132:135], a[104:107], v[28:31]
  v_mfma_f32_16x16x32_bf16 v[28:31], a[156:159], a[124:127], v[28:31]
  v_mfma_f32_16x16x32_bf16 v[24:27], a[156:159], a[120:123], v[24:27]
  s_waitcnt vmcnt(10) lgkmcnt(0)
  s_barrier
  ds_read_b64_tr_b16 a[40:41], v116 offset:0
  v_mfma_f32_16x16x32_bf16 v[24:27], a[132:135], a[100:103], v[24:27]
  s_add_u32 m0, s62, 106496
  ds_read_b64_tr_b16 a[42:43], v116 offset:6144
  v_mfma_f32_16x16x32_bf16 v[20:23], a[132:135], a[96:99], v[20:23]
  ds_read_b64_tr_b16 a[64:65], v116 offset:12288
  buffer_load_dwordx4 v120, s[28:31], s68 offen offset:0 sc1  lds
  v_mfma_f32_16x16x32_bf16 v[20:23], a[156:159], a[116:119], v[20:23]
  ds_read_b64_tr_b16 a[66:67], v116 offset:18432
  v_mfma_f32_16x16x32_bf16 v[16:19], a[156:159], a[112:115], v[16:19]
  ds_read_b128 a[4:7], v112 offset:0
  v_mfma_f32_16x16x32_bf16 v[16:19], a[132:135], a[92:95], v[16:19]
  ds_read_b128 a[24:27], v113 offset:0
  v_mfma_f32_16x16x32_bf16 v[96:99], a[136:139], a[88:91], v[96:99]
  ds_read_b128 a[8:11], v112 offset:2048
  buffer_load_dwordx4 v121, s[28:31], s68 offen offset:1024 sc1  lds
  v_mfma_f32_16x16x32_bf16 v[96:99], a[160:163], a[108:111], v[96:99]
  ds_read_b128 a[28:31], v113 offset:2048
  v_mfma_f32_16x16x32_bf16 v[32:35], a[160:163], a[112:115], v[32:35]
  ds_read_b128 a[12:15], v112 offset:4096
  v_mfma_f32_16x16x32_bf16 v[32:35], a[136:139], a[92:95], v[32:35]
  ds_read_b128 a[32:35], v113 offset:4096
  v_mfma_f32_16x16x32_bf16 v[36:39], a[136:139], a[96:99], v[36:39]
  ds_read_b128 a[16:19], v112 offset:6144
  buffer_load_dwordx4 v122, s[28:31], s68 offen offset:2048 sc1  lds
  v_mfma_f32_16x16x32_bf16 v[36:39], a[160:163], a[116:119], v[36:39]
  ds_read_b128 a[36:39], v113 offset:6144
  v_mfma_f32_16x16x32_bf16 v[40:43], a[160:163], a[120:123], v[40:43]
  ds_read_b64_tr_b16 a[44:45], v117 offset:0
  v_mfma_f32_16x16x32_bf16 v[40:43], a[136:139], a[100:103], v[40:43]
  ds_read_b64_tr_b16 a[46:47], v117 offset:6144
  v_mfma_f32_16x16x32_bf16 v[44:47], a[136:139], a[104:107], v[44:47]
  ds_read_b64_tr_b16 a[68:69], v117 offset:12288
  buffer_load_dwordx4 v123, s[28:31], s68 offen offset:3072 sc1  lds
  v_mfma_f32_16x16x32_bf16 v[44:47], a[160:163], a[124:127], v[44:47]
  ds_read_b64_tr_b16 a[70:71], v117 offset:18432
  v_mfma_f32_16x16x32_bf16 v[60:63], a[164:167], a[124:127], v[60:63]
  ds_read_b128 a[0:3], v114 offset:6144
  v_add_u32 v114, 6144, v114
  v_mfma_f32_16x16x32_bf16 v[60:63], a[140:143], a[104:107], v[60:63]
  s_add_u32 m0, s63, 49152
  ds_read_b128 a[20:23], v115 offset:6144
  v_add_u32 v115, 6144, v115
  v_mfma_f32_16x16x32_bf16 v[56:59], a[140:143], a[100:103], v[56:59]
  ds_read_b64_tr_b16 a[48:49], v116 offset:2048
  buffer_load_dwordx4 v124, s[8:11], s69 offen offset:0  lds
  v_mfma_f32_16x16x32_bf16 v[56:59], a[164:167], a[120:123], v[56:59]
  ds_read_b64_tr_b16 a[50:51], v116 offset:8192
  v_mfma_f32_16x16x32_bf16 v[52:55], a[164:167], a[116:119], v[52:55]
  s_add_u32 s44, s44, 1
  ds_read_b64_tr_b16 a[72:73], v116 offset:14336
  v_mfma_f32_16x16x32_bf16 v[52:55], a[140:143], a[96:99], v[52:55]
  s_and_b32 s44, s44, 15
  ds_read_b64_tr_b16 a[74:75], v116 offset:20480
  v_mfma_f32_16x16x32_bf16 v[48:51], a[140:143], a[92:95], v[48:51]
  s_add_u32 s66, s66, 1
  ds_read_b64_tr_b16 a[52:53], v117 offset:2048
  buffer_load_dwordx4 v125, s[8:11], s69 offen offset:1024  lds
  v_mfma_f32_16x16x32_bf16 v[48:51], a[164:167], a[112:115], v[48:51]
  s_mul_i32 s45, s44, s61
  ds_read_b64_tr_b16 a[54:55], v117 offset:8192
  v_mfma_f32_16x16x32_bf16 v[100:103], a[108:111], a[168:171], v[100:103]
  s_add_u32 s68, s45, s59
  ds_read_b64_tr_b16 a[76:77], v117 offset:14336
  v_mfma_f32_16x16x32_bf16 v[100:103], a[88:91], a[144:147], v[100:103]
  ds_read_b64_tr_b16 a[78:79], v117 offset:20480
  v_mfma_f32_16x16x32_bf16 v[64:67], a[92:95], a[144:147], v[64:67]
  ds_read_b64_tr_b16 a[56:57], v116 offset:4096
  buffer_load_dwordx4 v124, s[8:11], s69 offen offset:2048  lds
  v_mfma_f32_16x16x32_bf16 v[64:67], a[112:115], a[168:171], v[64:67]
  ds_read_b64_tr_b16 a[58:59], v116 offset:10240
  v_mfma_f32_16x16x32_bf16 v[68:71], a[116:119], a[168:171], v[68:71]
  ds_read_b64_tr_b16 a[80:81], v116 offset:16384
  v_mfma_f32_16x16x32_bf16 v[68:71], a[96:99], a[144:147], v[68:71]
  ds_read_b64_tr_b16 a[82:83], v116 offset:22528
  v_mfma_f32_16x16x32_bf16 v[72:75], a[100:103], a[144:147], v[72:75]
  ds_read_b64_tr_b16 a[60:61], v117 offset:4096
  buffer_load_dwordx4 v125, s[8:11], s69 offen offset:3072  lds
  v_mfma_f32_16x16x32_bf16 v[72:75], a[120:123], a[168:171], v[72:75]
  ds_read_b64_tr_b16 a[62:63], v117 offset:10240
  v_mfma_f32_16x16x32_bf16 v[76:79], a[124:127], a[168:171], v[76:79]
  ds_read_b64_tr_b16 a[84:85], v117 offset:16384
  v_mfma_f32_16x16x32_bf16 v[76:79], a[104:107], a[144:147], v[76:79]
  s_add_u32 m0, s63, 53248
  ds_read_b64_tr_b16 a[86:87], v117 offset:22528
  v_mfma_f32_16x16x32_bf16 v[92:95], a[104:107], a[148:151], v[92:95]
  buffer_load_dwordx4 v124, s[8:11], s70 offen offset:0  lds
  v_mfma_f32_16x16x32_bf16 v[92:95], a[124:127], a[172:175], v[92:95]
  v_mfma_f32_16x16x32_bf16 v[88:91], a[120:123], a[172:175], v[88:91]
  v_mfma_f32_16x16x32_bf16 v[88:91], a[100:103], a[148:151], v[88:91]
  v_mfma_f32_16x16x32_bf16 v[84:87], a[96:99], a[148:151], v[84:87]
  buffer_load_dwordx4 v125, s[8:11], s70 offen offset:1024  lds
  v_mfma_f32_16x16x32_bf16 v[84:87], a[116:119], a[172:175], v[84:87]
  v_mfma_f32_16x16x32_bf16 v[80:83], a[112:115], a[172:175], v[80:83]
  v_mfma_f32_16x16x32_bf16 v[80:83], a[92:95], a[148:151], v[80:83]
  s_cmp_eq_u32 s66, s88
  s_cbranch_scc0 Lside_skip5
  s_call_b64 s[78:79], Lside_sub
Lside_skip5:
  s_sub_u32 s56, s56, 1
  s_cmp_lg_u32 s56, 0
  s_cbranch_scc1 Lp1_loop
Lmk_Lp1_loop_tail:
  s_waitcnt lgkmcnt(15)
  v_mfma_f32_16x16x32_bf16 v[0:3], a[40:43], a[4:7], v[0:3]
  s_mul_i32 s45, s44, 393216
  v_and_b32 v240, 1, v253
  v_lshlrev_b32 v240, 7, v240
  v_mfma_f32_16x16x32_bf16 v[0:3], a[64:67], a[24:27], v[0:3]
  s_add_u32 s69, s45, s60
  v_mfma_f32_16x16x32_bf16 v[4:7], a[64:67], a[28:31], v[4:7]
  s_add_u32 s70, s69, 4096
  buffer_load_dword v127, v240, s[36:39], 0 offen sc1
  v_mfma_f32_16x16x32_bf16 v[4:7], a[40:43], a[8:11], v[4:7]
  s_lshl_b32 s43, s57, 2
  v_mfma_f32_16x16x32_bf16 v[8:11], a[40:43], a[12:15], v[8:11]
  s_add_u32 s74, s71, s43
  v_mfma_f32_16x16x32_bf16 v[8:11], a[64:67], a[32:35], v[8:11]
  s_add_u32 s45, s42, 27262976
  v_mfma_f32_16x16x32_bf16 v[12:15], a[64:67], a[36:39], v[12:15]
  s_lshl_b32 s44, s72, 11
  v_mfma_f32_16x16x32_bf16 v[12:15], a[40:43], a[16:19], v[12:15]
  s_add_u32 s77, s44, s45
  v_mfma_f32_16x16x32_bf16 v[28:31], a[44:47], a[16:19], v[28:31]
  s_lshl_b32 s44, s40, 1
  v_mfma_f32_16x16x32_bf16 v[28:31], a[68:71], a[36:39], v[28:31]
  s_add_u32 s44, s44, s71
  v_mfma_f32_16x16x32_bf16 v[24:27], a[68:71], a[32:35], v[24:27]
  s_waitcnt vmcnt(11) lgkmcnt(0)
  s_barrier
  ds_read_b64_tr_b16 a[128:129], v116 offset:24576
  v_mfma_f32_16x16x32_bf16 v[24:27], a[44:47], a[12:15], v[24:27]
  s_add_u32 m0, s62, 73728
  ds_read_b64_tr_b16 a[130:131], v116 offset:30720
  v_mfma_f32_16x16x32_bf16 v[20:23], a[44:47], a[8:11], v[20:23]
  s_lshl_b32 s44, s44, 11
  ds_read_b64_tr_b16 a[152:153], v116 offset:36864
  buffer_load_dwordx4 v120, s[28:31], s68 offen offset:0 sc1  lds
  v_mfma_f32_16x16x32_bf16 v[20:23], a[68:71], a[28:31], v[20:23]
  s_add_u32 s78, s44, s45
  ds_read_b64_tr_b16 a[154:155], v116 offset:43008
  v_mfma_f32_16x16x32_bf16 v[16:19], a[68:71], a[24:27], v[16:19]
  s_lshl_b32 s43, s51, 1
  ds_read_b128 a[92:95], v112 offset:16384
  v_mfma_f32_16x16x32_bf16 v[16:19], a[44:47], a[4:7], v[16:19]
  s_add_u32 s75, s43, s58
  ds_read_b128 a[112:115], v113 offset:16384
  v_mfma_f32_16x16x32_bf16 v[96:99], a[48:51], a[0:3], v[96:99]
  s_lshl_b32 s43, s75, 7
  ds_read_b128 a[96:99], v112 offset:18432
  buffer_load_dwordx4 v121, s[28:31], s68 offen offset:1024 sc1  lds
  v_mfma_f32_16x16x32_bf16 v[96:99], a[72:75], a[20:23], v[96:99]
  s_add_u32 s46, s43, 27983872
  ds_read_b128 a[116:119], v113 offset:18432
  v_mfma_f32_16x16x32_bf16 v[32:35], a[72:75], a[24:27], v[32:35]
  s_lshl_b32 s43, s57, 6
  ds_read_b128 a[100:103], v112 offset:20480
  v_mfma_f32_16x16x32_bf16 v[32:35], a[48:51], a[4:7], v[32:35]
  ds_read_b128 a[120:123], v113 offset:20480
  v_mfma_f32_16x16x32_bf16 v[36:39], a[48:51], a[8:11], v[36:39]
  ds_read_b128 a[104:107], v112 offset:22528
  buffer_load_dwordx4 v122, s[28:31], s68 offen offset:2048 sc1  lds
  v_mfma_f32_16x16x32_bf16 v[36:39], a[72:75], a[28:31], v[36:39]
  ds_read_b128 a[124:127], v113 offset:22528
  v_mfma_f32_16x16x32_bf16 v[40:43], a[72:75], a[32:35], v[40:43]
  ds_read_b64_tr_b16 a[132:133], v117 offset:24576
  v_mfma_f32_16x16x32_bf16 v[40:43], a[48:51], a[12:15], v[40:43]
  ds_read_b64_tr_b16 a[134:135], v117 offset:30720
  v_mfma_f32_16x16x32_bf16 v[44:47], a[48:51], a[16:19], v[44:47]
  ds_read_b64_tr_b16 a[156:157], v117 offset:36864
  buffer_load_dwordx4 v123, s[28:31], s68 offen offset:3072 sc1  lds
  v_mfma_f32_16x16x32_bf16 v[44:47], a[72:75], a[36:39], v[44:47]
  ds_read_b64_tr_b16 a[158:159], v117 offset:43008
  v_mfma_f32_16x16x32_bf16 v[60:63], a[76:79], a[36:39], v[60:63]
  ds_read_b128 a[88:91], v114 offset:1024
  v_mfma_f32_16x16x32_bf16 v[60:63], a[52:55], a[16:19], v[60:63]
  s_add_u32 m0, s63, 0
  ds_read_b128 a[108:111], v115 offset:1024
  v_mfma_f32_16x16x32_bf16 v[56:59], a[52:55], a[12:15], v[56:59]
  ds_read_b64_tr_b16 a[136:137], v116 offset:26624
  buffer_load_dwordx4 v124, s[8:11], s69 offen offset:0  lds
  v_mfma_f32_16x16x32_bf16 v[56:59], a[76:79], a[32:35], v[56:59]
  ds_read_b64_tr_b16 a[138:139], v116 offset:32768
  v_mfma_f32_16x16x32_bf16 v[52:55], a[76:79], a[28:31], v[52:55]
  ds_read_b64_tr_b16 a[160:161], v116 offset:38912
  v_lshlrev_b32 v105, 3, v253
  v_mfma_f32_16x16x32_bf16 v[52:55], a[52:55], a[8:11], v[52:55]
  ds_read_b64_tr_b16 a[162:163], v116 offset:45056
  v_lshlrev_b32 v104, 4, v253
  v_mfma_f32_16x16x32_bf16 v[48:51], a[52:55], a[4:7], v[48:51]
  ds_read_b64_tr_b16 a[140:141], v117 offset:26624
  buffer_load_dwordx4 v125, s[8:11], s69 offen offset:1024  lds
  v_mfma_f32_16x16x32_bf16 v[48:51], a[76:79], a[24:27], v[48:51]
  ds_read_b64_tr_b16 a[142:143], v117 offset:32768
  v_xor_b32 v126, s43, v104
  v_mfma_f32_16x16x32_bf16 v[100:103], a[20:23], a[80:83], v[100:103]
  ds_read_b64_tr_b16 a[164:165], v117 offset:38912
  v_add_u32 v126, s76, v126
  v_mfma_f32_16x16x32_bf16 v[100:103], a[0:3], a[56:59], v[100:103]
  ds_read_b64_tr_b16 a[166:167], v117 offset:45056
  v_bfe_u32 v106, v253, 3, 2
  v_mfma_f32_16x16x32_bf16 v[64:67], a[4:7], a[56:59], v[64:67]
  ds_read_b64_tr_b16 a[144:145], v116 offset:28672
  buffer_load_dwordx4 v124, s[8:11], s69 offen offset:2048  lds
  v_mfma_f32_16x16x32_bf16 v[64:67], a[24:27], a[80:83], v[64:67]
  ds_read_b64_tr_b16 a[146:147], v116 offset:34816
  v_lshrrev_b32 v107, 5, v253
  v_mfma_f32_16x16x32_bf16 v[68:71], a[28:31], a[80:83], v[68:71]
  ds_read_b64_tr_b16 a[168:169], v116 offset:40960
  v_mad_u32_u24 v106, v107, 3, v106
  v_mfma_f32_16x16x32_bf16 v[68:71], a[8:11], a[56:59], v[68:71]
  ds_read_b64_tr_b16 a[170:171], v116 offset:47104
  v_and_b32 v107, 7, v253
  v_mfma_f32_16x16x32_bf16 v[72:75], a[12:15], a[56:59], v[72:75]
  ds_read_b64_tr_b16 a[148:149], v117 offset:28672
  buffer_load_dwordx4 v125, s[8:11], s69 offen offset:3072  lds
  v_mfma_f32_16x16x32_bf16 v[72:75], a[32:35], a[80:83], v[72:75]
  ds_read_b64_tr_b16 a[150:151], v117 offset:34816
  v_lshlrev_b32 v107, 4, v107
  v_mfma_f32_16x16x32_bf16 v[76:79], a[36:39], a[80:83], v[76:79]
  ds_read_b64_tr_b16 a[172:173], v117 offset:40960
  v_lshl_add_u32 v106, v106, 12, v107
  v_mfma_f32_16x16x32_bf16 v[76:79], a[16:19], a[56:59], v[76:79]
  s_add_u32 m0, s63, 4096
  ds_read_b64_tr_b16 a[174:175], v117 offset:47104
  v_mfma_f32_16x16x32_bf16 v[92:95], a[16:19], a[60:63], v[92:95]
  buffer_load_dwordx4 v124, s[8:11], s70 offen offset:0  lds
  v_mfma_f32_16x16x32_bf16 v[92:95], a[36:39], a[84:87], v[92:95]
  v_mfma_f32_16x16x32_bf16 v[88:91], a[32:35], a[84:87], v[88:91]
  v_mfma_f32_16x16x32_bf16 v[88:91], a[12:15], a[60:63], v[88:91]
  s_waitcnt vmcnt(9)
  v_cmp_gt_u32 vcc, 128, v127
  s_cbranch_vccz Lcdn4
  s_mov_b32 s43, 0x40000
Lchk3:
  s_sleep 8
  buffer_load_dword v127, v240, s[36:39], 0 offen sc1
  s_waitcnt vmcnt(0)
  v_cmp_gt_u32 vcc, 128, v127
  s_cbranch_vccz Lcdn4
  s_sub_u32 s43, s43, 1
  s_cmp_lg_u32 s43, 0
  s_cbranch_scc1 Lchk3
Lcdn4:
  v_mfma_f32_16x16x32_bf16 v[84:87], a[8:11], a[60:63], v[84:87]
  buffer_load_dwordx4 v125, s[8:11], s70 offen offset:1024  lds
  v_mfma_f32_16x16x32_bf16 v[84:87], a[28:31], a[84:87], v[84:87]
  v_mfma_f32_16x16x32_bf16 v[80:83], a[24:27], a[84:87], v[80:83]
  v_mfma_f32_16x16x32_bf16 v[80:83], a[4:7], a[60:63], v[80:83]
  s_waitcnt lgkmcnt(15)
  v_mfma_f32_16x16x32_bf16 v[0:3], a[128:131], a[92:95], v[0:3]
  s_cmp_lg_u32 s41, 0
  s_cbranch_scc1 Lp1_csl0
  buffer_load_dwordx4 v[200:203], v106, s[4:7], s46 offen sc1
  s_add_u32 s46, s46, 24576
  buffer_load_dwordx4 v[204:207], v106, s[4:7], s46 offen sc1
  s_add_u32 s46, s46, 24576
Lp1_csl0:
  v_mfma_f32_16x16x32_bf16 v[0:3], a[152:155], a[112:115], v[0:3]
  s_lshl_b32 s92, s53, 7
  s_lshl_b32 s93, s40, 14
  s_add_u32 s92, s92, s93
  v_mfma_f32_16x16x32_bf16 v[4:7], a[152:155], a[116:119], v[4:7]
  s_lshl_b32 s89, s40, 10
  v_add_u32 v186, s92, v252
  v_mfma_f32_16x16x32_bf16 v[4:7], a[128:131], a[96:99], v[4:7]
  buffer_load_dwordx2 v[128:129], v105, s[4:7], s78 offen offset:0 sc1
  v_mfma_f32_16x16x32_bf16 v[8:11], a[128:131], a[100:103], v[8:11]
  v_mfma_f32_16x16x32_bf16 v[8:11], a[152:155], a[120:123], v[8:11]
  v_mfma_f32_16x16x32_bf16 v[12:15], a[152:155], a[124:127], v[12:15]
  s_cmp_lg_u32 s41, 0
  s_cbranch_scc1 Lp1_csl1
  buffer_load_dwordx4 v[208:211], v106, s[4:7], s46 offen sc1
  s_add_u32 s46, s46, 24576
  buffer_load_dwordx4 v[212:215], v106, s[4:7], s46 offen sc1
  s_add_u32 s46, s46, 24576
Lp1_csl1:
  v_mfma_f32_16x16x32_bf16 v[12:15], a[128:131], a[104:107], v[12:15]
  buffer_load_dwordx2 v[130:131], v105, s[4:7], s78 offen offset:512 sc1
  v_mfma_f32_16x16x32_bf16 v[28:31], a[132:135], a[104:107], v[28:31]
  v_mfma_f32_16x16x32_bf16 v[28:31], a[156:159], a[124:127], v[28:31]
  v_mfma_f32_16x16x32_bf16 v[24:27], a[156:159], a[120:123], v[24:27]
  s_waitcnt lgkmcnt(0)
  s_barrier
  ds_read_b64_tr_b16 a[40:41], v118 offset:0
  v_mfma_f32_16x16x32_bf16 v[24:27], a[132:135], a[100:103], v[24:27]
  ds_read_b64_tr_b16 a[42:43], v118 offset:6144
  buffer_load_dwordx2 v[132:133], v105, s[4:7], s78 offen offset:1024 sc1
  v_mfma_f32_16x16x32_bf16 v[20:23], a[132:135], a[96:99], v[20:23]
  s_cmp_lg_u32 s41, 0
  s_cbranch_scc1 Lp1_csl2
  buffer_load_dwordx4 v[216:219], v106, s[4:7], s46 offen sc1
  s_add_u32 s46, s46, 24576
  buffer_load_dwordx4 v[220:223], v106, s[4:7], s46 offen sc1
  s_add_u32 s46, s46, 24576
Lp1_csl2:
  ds_read_b64_tr_b16 a[64:65], v118 offset:12288
  v_mfma_f32_16x16x32_bf16 v[20:23], a[156:159], a[116:119], v[20:23]
  ds_read_b64_tr_b16 a[66:67], v118 offset:18432
  v_mfma_f32_16x16x32_bf16 v[16:19], a[156:159], a[112:115], v[16:19]
  ds_read_b128 a[4:7], v112 offset:32768
  v_mfma_f32_16x16x32_bf16 v[16:19], a[132:135], a[92:95], v[16:19]
  ds_read_b128 a[24:27], v113 offset:32768
  buffer_load_dwordx2 v[134:135], v105, s[4:7], s78 offen offset:1536 sc1
  v_mfma_f32_16x16x32_bf16 v[96:99], a[136:139], a[88:91], v[96:99]
  ds_read_b128 a[8:11], v112 offset:34816
  v_mfma_f32_16x16x32_bf16 v[96:99], a[160:163], a[108:111], v[96:99]
  ds_read_b128 a[28:31], v113 offset:34816
  v_mfma_f32_16x16x32_bf16 v[32:35], a[160:163], a[112:115], v[32:35]
  s_cmp_lg_u32 s41, 0
  s_cbranch_scc1 Lp1_csl3
  buffer_load_dwordx4 v[224:227], v106, s[4:7], s46 offen sc1
  s_add_u32 s46, s46, 24576
  buffer_load_dwordx4 v[228:231], v106, s[4:7], s46 offen sc1
  s_add_u32 s46, s46, 24576
Lp1_csl3:
  ds_read_b128 a[12:15], v112 offset:36864
  v_mfma_f32_16x16x32_bf16 v[32:35], a[136:139], a[92:95], v[32:35]
  ds_read_b128 a[32:35], v113 offset:36864
  buffer_load_dwordx2 v[136:137], v105, s[4:7], s78 offen offset:2048 sc1
  v_mfma_f32_16x16x32_bf16 v[36:39], a[136:139], a[96:99], v[36:39]
  ds_read_b128 a[16:19], v112 offset:38912
  v_mfma_f32_16x16x32_bf16 v[36:39], a[160:163], a[116:119], v[36:39]
  ds_read_b128 a[36:39], v113 offset:38912
  v_mfma_f32_16x16x32_bf16 v[40:43], a[160:163], a[120:123], v[40:43]
  ds_read_b64_tr_b16 a[44:45], v119 offset:0
  v_mfma_f32_16x16x32_bf16 v[40:43], a[136:139], a[100:103], v[40:43]
  ds_read_b64_tr_b16 a[46:47], v119 offset:6144
  buffer_load_dwordx2 v[138:139], v105, s[4:7], s78 offen offset:2560 sc1
  v_mfma_f32_16x16x32_bf16 v[44:47], a[136:139], a[104:107], v[44:47]
  ds_read_b64_tr_b16 a[68:69], v119 offset:12288
  v_lshrrev_b32 v240, 4, v253
  v_mfma_f32_16x16x32_bf16 v[44:47], a[160:163], a[124:127], v[44:47]
  ds_read_b64_tr_b16 a[70:71], v119 offset:18432
  v_lshlrev_b32 v124, 4, v240
  v_mfma_f32_16x16x32_bf16 v[60:63], a[164:167], a[124:127], v[60:63]
  ds_read_b128 a[0:3], v114 offset:2048
  v_and_b32 v125, 15, v253
  v_mfma_f32_16x16x32_bf16 v[60:63], a[140:143], a[104:107], v[60:63]
  ds_read_b128 a[20:23], v115 offset:2048
  buffer_load_dwordx2 v[140:141], v105, s[4:7], s78 offen offset:3072 sc1
  v_mfma_f32_16x16x32_bf16 v[56:59], a[140:143], a[100:103], v[56:59]
  ds_read_b64_tr_b16 a[48:49], v118 offset:2048
  v_lshlrev_b32 v125, 2, v125
  v_mfma_f32_16x16x32_bf16 v[56:59], a[164:167], a[120:123], v[56:59]
  s_lshl_b32 s43, s57, 9
  ds_read_b64_tr_b16 a[50:51], v118 offset:8192
  v_add_u32 v164, 155648, v124
  v_mfma_f32_16x16x32_bf16 v[52:55], a[164:167], a[116:119], v[52:55]
  ds_read_b64_tr_b16 a[72:73], v118 offset:14336
  v_add_u32 v166, 155648, v125
  v_mfma_f32_16x16x32_bf16 v[52:55], a[140:143], a[96:99], v[52:55]
  ds_read_b64_tr_b16 a[74:75], v118 offset:20480
  buffer_load_dwordx2 v[142:143], v105, s[4:7], s78 offen offset:3584 sc1
  v_mfma_f32_16x16x32_bf16 v[48:51], a[140:143], a[92:95], v[48:51]
  ds_read_b64_tr_b16 a[52:53], v119 offset:2048
  v_add_u32 v165, s43, v164
  v_mfma_f32_16x16x32_bf16 v[48:51], a[164:167], a[112:115], v[48:51]
  ds_read_b64_tr_b16 a[54:55], v119 offset:8192
  v_add_u32 v167, s43, v166
  v_mfma_f32_16x16x32_bf16 v[100:103], a[108:111], a[168:171], v[100:103]
  s_lshl_b32 s43, s40, 1
  ds_read_b64_tr_b16 a[76:77], v119 offset:14336
  v_mfma_f32_16x16x32_bf16 v[100:103], a[88:91], a[144:147], v[100:103]
  s_add_u32 s43, s43, 1
  ds_read_b64_tr_b16 a[78:79], v119 offset:20480
  buffer_load_dwordx2 v[144:145], v105, s[4:7], s77 offen offset:0 sc1
  v_mfma_f32_16x16x32_bf16 v[64:67], a[92:95], a[144:147], v[64:67]
  ds_read_b64_tr_b16 a[56:57], v118 offset:4096
  v_add_u32 v241, s43, v240
  v_mfma_f32_16x16x32_bf16 v[64:67], a[112:115], a[168:171], v[64:67]
  ds_read_b64_tr_b16 a[58:59], v118 offset:10240
  v_cmp_gt_u32 vcc, 2, v240
  v_mfma_f32_16x16x32_bf16 v[68:71], a[116:119], a[168:171], v[68:71]
  ds_read_b64_tr_b16 a[80:81], v118 offset:16384
  v_and_b32 v240, 1, v240
  v_mfma_f32_16x16x32_bf16 v[68:71], a[96:99], a[144:147], v[68:71]
  ds_read_b64_tr_b16 a[82:83], v118 offset:22528
  buffer_load_dwordx2 v[146:147], v105, s[4:7], s77 offen offset:512 sc1
  v_mfma_f32_16x16x32_bf16 v[72:75], a[100:103], a[144:147], v[72:75]
  ds_read_b64_tr_b16 a[60:61], v119 offset:4096
  v_mul_u32_u24 v240, 9, v240
  v_mfma_f32_16x16x32_bf16 v[72:75], a[120:123], a[168:171], v[72:75]
  ds_read_b64_tr_b16 a[62:63], v119 offset:10240
  v_cndmask_b32 v240, v240, v241, vcc
  v_mfma_f32_16x16x32_bf16 v[76:79], a[124:127], a[168:171], v[76:79]
  ds_read_b64_tr_b16 a[84:85], v119 offset:16384
  v_lshl_add_u32 v106, v240, 7, v166
  v_mfma_f32_16x16x32_bf16 v[76:79], a[104:107], a[144:147], v[76:79]
  ds_read_b64_tr_b16 a[86:87], v119 offset:22528
  buffer_load_dwordx2 v[148:149], v105, s[4:7], s77 offen offset:1024 sc1
  v_mfma_f32_16x16x32_bf16 v[92:95], a[104:107], a[148:151], v[92:95]
  v_add_u32 v124, s76, v124
  v_add_u32 v125, s76, v125
  v_mfma_f32_16x16x32_bf16 v[92:95], a[124:127], a[172:175], v[92:95]
  v_add_u32 v107, 149504, v104
  v_mfma_f32_16x16x32_bf16 v[88:91], a[120:123], a[172:175], v[88:91]
  v_mfma_f32_16x16x32_bf16 v[88:91], a[100:103], a[148:151], v[88:91]
  buffer_load_dwordx2 v[150:151], v105, s[4:7], s77 offen offset:1536 sc1
  v_mfma_f32_16x16x32_bf16 v[84:87], a[96:99], a[148:151], v[84:87]
  v_mfma_f32_16x16x32_bf16 v[84:87], a[116:119], a[172:175], v[84:87]
  v_mfma_f32_16x16x32_bf16 v[80:83], a[112:115], a[172:175], v[80:83]
  v_mfma_f32_16x16x32_bf16 v[80:83], a[92:95], a[148:151], v[80:83]
  s_waitcnt lgkmcnt(15)
  v_mfma_f32_16x16x32_bf16 v[0:3], a[40:43], a[4:7], v[0:3]
  s_lshl_b32 s44, s2, 2
  s_add_u32 s44, s44, s40
  s_lshl_b32 s44, s44, 12
  v_mfma_f32_16x16x32_bf16 v[0:3], a[64:67], a[24:27], v[0:3]
  s_add_u32 s44, s44, s42
  v_mfma_f32_16x16x32_bf16 v[4:7], a[64:67], a[28:31], v[4:7]
  s_add_u32 s44, s44, 28311552
  v_mov_b32 v246, -1
  v_mov_b32 v247, -1
  v_mfma_f32_16x16x32_bf16 v[4:7], a[40:43], a[8:11], v[4:7]
  v_mov_b32 v248, -1
  v_mov_b32 v249, -1
  v_mfma_f32_16x16x32_bf16 v[8:11], a[40:43], a[12:15], v[8:11]
  v_mfma_f32_16x16x32_bf16 v[8:11], a[64:67], a[32:35], v[8:11]
  v_mfma_f32_16x16x32_bf16 v[12:15], a[64:67], a[36:39], v[12:15]
  s_waitcnt vmcnt(8)
  v_add_u32 v198, 1024, v125
  v_add_f32 v128, v128, v130
  v_mfma_f32_16x16x32_bf16 v[12:15], a[40:43], a[16:19], v[12:15]
  v_add_f32 v129, v129, v131
  v_add_f32 v132, v132, v134
  v_mfma_f32_16x16x32_bf16 v[28:31], a[44:47], a[16:19], v[28:31]
  buffer_store_dwordx4 v[246:249], v104, s[4:7], s44 offen offset:0 sc1
  v_add_f32 v133, v133, v135
  v_mfma_f32_16x16x32_bf16 v[28:31], a[68:71], a[36:39], v[28:31]
  v_add_f32 v128, v128, v132
  v_add_f32 v129, v129, v133
  v_mfma_f32_16x16x32_bf16 v[24:27], a[68:71], a[32:35], v[24:27]
  s_waitcnt lgkmcnt(0)
  s_barrier
  ds_read_b64_tr_b16 a[128:129], v116 offset:0
  s_waitcnt vmcnt(5)
  s_cmp_lg_u32 s41, 0
  s_cbranch_scc1 Lp1_css
  v_pk_add_f32 v[200:201], v[200:201], v[216:217]
  v_pk_add_f32 v[202:203], v[202:203], v[218:219]
  v_pk_add_f32 v[204:205], v[204:205], v[220:221]
  v_pk_add_f32 v[206:207], v[206:207], v[222:223]
  v_pk_add_f32 v[208:209], v[208:209], v[224:225]
  v_pk_add_f32 v[210:211], v[210:211], v[226:227]
  v_pk_add_f32 v[212:213], v[212:213], v[228:229]
  v_pk_add_f32 v[214:215], v[214:215], v[230:231]
  v_pk_add_f32 v[200:201], v[200:201], v[208:209]
  v_pk_add_f32 v[202:203], v[202:203], v[210:211]
  v_pk_add_f32 v[204:205], v[204:205], v[212:213]
  v_pk_add_f32 v[206:207], v[206:207], v[214:215]
  v_pk_add_f32 v[200:201], v[200:201], v[204:205]
  v_pk_add_f32 v[202:203], v[202:203], v[206:207]
  v_mov_b32 v204, v200
  v_mov_b32 v205, v201
  v_mov_b32 v206, v202
  v_mov_b32 v207, v203
  v_permlane32_swap_b32 v200, v204
  v_permlane32_swap_b32 v201, v205
  v_permlane32_swap_b32 v202, v206
  v_permlane32_swap_b32 v203, v207
  v_add_f32 v200, v200, v204
  v_add_f32 v201, v201, v205
  v_add_f32 v202, v202, v206
  v_add_f32 v203, v203, v207
  ds_write_b128 v126, v[200:203] offset:1024
Lp1_css:
  v_mfma_f32_16x16x32_bf16 v[24:27], a[44:47], a[12:15], v[24:27]
  ds_read_b64_tr_b16 a[130:131], v116 offset:6144
  ds_read_b128 v[168:171], v124 offset:1024
  v_mfma_f32_16x16x32_bf16 v[20:23], a[44:47], a[8:11], v[20:23]
  ds_read_b64_tr_b16 a[152:153], v116 offset:12288
  buffer_store_dwordx4 v[246:249], v104, s[4:7], s44 offen offset:1024 sc1
  v_mfma_f32_16x16x32_bf16 v[20:23], a[68:71], a[28:31], v[20:23]
  ds_read_b64_tr_b16 a[154:155], v116 offset:18432
  ds_read_b128 v[172:175], v124 offset:1088
  v_mfma_f32_16x16x32_bf16 v[16:19], a[68:71], a[24:27], v[16:19]
  ds_read_b128 a[92:95], v112 offset:0
  ds_read_b128 v[176:179], v124 offset:1152
  v_mfma_f32_16x16x32_bf16 v[16:19], a[44:47], a[4:7], v[16:19]
  ds_read_b128 a[112:115], v113 offset:0
  ds_read_b128 v[180:183], v124 offset:1216
  v_mfma_f32_16x16x32_bf16 v[96:99], a[48:51], a[0:3], v[96:99]
  ds_read_b128 a[96:99], v112 offset:2048
  buffer_store_dwordx4 v[246:249], v104, s[4:7], s44 offen offset:2048 sc1
  v_mfma_f32_16x16x32_bf16 v[96:99], a[72:75], a[20:23], v[96:99]
  ds_read_b128 a[116:119], v113 offset:2048
  ds_read2_b32 v[184:185], v198 offset0:64 offset1:80
  v_mfma_f32_16x16x32_bf16 v[32:35], a[72:75], a[24:27], v[32:35]
  s_xor_b32 s47, s40, 2
  ds_read_b128 a[100:103], v112 offset:4096
  s_mul_i32 s47, s47, 6144
  v_mfma_f32_16x16x32_bf16 v[32:35], a[48:51], a[4:7], v[32:35]
  s_add_u32 s47, s47, 139264
  ds_read_b128 a[120:123], v113 offset:4096
  s_add_u32 s49, s47, 3072
  v_mfma_f32_16x16x32_bf16 v[36:39], a[48:51], a[8:11], v[36:39]
  s_add_u32 s79, s47, 2048
  ds_read_b128 a[104:107], v112 offset:6144
  buffer_store_dwordx4 v[246:249], v104, s[4:7], s44 offen offset:3072 sc1
  v_mfma_f32_16x16x32_bf16 v[36:39], a[72:75], a[28:31], v[36:39]
  s_cmp_eq_u32 s57, 0
  s_cselect_b32 s49, s76, s49
  s_cselect_b32 s79, s47, s79
  ds_read_b128 a[124:127], v113 offset:6144
  v_add_u32 v198, s49, v105
  v_mfma_f32_16x16x32_bf16 v[40:43], a[72:75], a[32:35], v[40:43]
  ds_read_b64_tr_b16 a[132:133], v117 offset:0
  v_add_u32 v199, s79, v105
  v_mfma_f32_16x16x32_bf16 v[40:43], a[48:51], a[12:15], v[40:43]
  s_add_u32 m0, s62, 90112
  ds_read_b64_tr_b16 a[134:135], v117 offset:6144
  v_add_u32 v105, s76, v105
  v_mfma_f32_16x16x32_bf16 v[44:47], a[48:51], a[16:19], v[44:47]
  ds_read_b64_tr_b16 a[156:157], v117 offset:12288
  buffer_load_dwordx4 v120, s[28:31], s64 offen offset:0 sc1 lds
  v_mfma_f32_16x16x32_bf16 v[44:47], a[72:75], a[36:39], v[44:47]
  ds_read_b64_tr_b16 a[158:159], v117 offset:18432
  v_add_f32 v136, v136, v138
  v_mfma_f32_16x16x32_bf16 v[60:63], a[76:79], a[36:39], v[60:63]
  ds_read_b128 a[88:91], v114 offset:3072
  v_add_f32 v137, v137, v139
  v_mfma_f32_16x16x32_bf16 v[60:63], a[52:55], a[16:19], v[60:63]
  ds_read_b128 a[108:111], v115 offset:3072
  v_add_f32 v140, v140, v142
  v_mfma_f32_16x16x32_bf16 v[56:59], a[52:55], a[12:15], v[56:59]
  ds_read_b64_tr_b16 a[136:137], v116 offset:2048
  v_add_f32 v141, v141, v143
  v_mfma_f32_16x16x32_bf16 v[56:59], a[76:79], a[32:35], v[56:59]
  ds_read_b64_tr_b16 a[138:139], v116 offset:8192
  v_add_f32 v136, v136, v140
  v_mfma_f32_16x16x32_bf16 v[52:55], a[76:79], a[28:31], v[52:55]
  ds_read_b64_tr_b16 a[160:161], v116 offset:14336
  v_add_f32 v137, v137, v141
  v_mfma_f32_16x16x32_bf16 v[52:55], a[52:55], a[8:11], v[52:55]
  s_waitcnt vmcnt(5)
  ds_read_b64_tr_b16 a[162:163], v116 offset:20480
  v_add_f32 v144, v144, v146
  v_mfma_f32_16x16x32_bf16 v[48:51], a[52:55], a[4:7], v[48:51]
  ds_read_b64_tr_b16 a[140:141], v117 offset:2048
  buffer_load_dwordx4 v121, s[28:31], s64 offen offset:1024 sc1 lds
  v_mfma_f32_16x16x32_bf16 v[48:51], a[76:79], a[24:27], v[48:51]
  ds_read_b64_tr_b16 a[142:143], v117 offset:8192
  v_add_f32 v145, v145, v147
  v_mfma_f32_16x16x32_bf16 v[100:103], a[20:23], a[80:83], v[100:103]
  ds_read_b64_tr_b16 a[164:165], v117 offset:14336
  v_add_f32 v148, v148, v150
  v_mfma_f32_16x16x32_bf16 v[100:103], a[0:3], a[56:59], v[100:103]
  ds_read_b64_tr_b16 a[166:167], v117 offset:20480
  v_add_f32 v149, v149, v151
  v_mfma_f32_16x16x32_bf16 v[64:67], a[4:7], a[56:59], v[64:67]
  ds_read_b64_tr_b16 a[144:145], v116 offset:4096
  v_add_f32 v144, v144, v148
  v_mfma_f32_16x16x32_bf16 v[64:67], a[24:27], a[80:83], v[64:67]
  ds_read_b64_tr_b16 a[146:147], v116 offset:10240
  v_add_f32 v145, v145, v149
  v_mfma_f32_16x16x32_bf16 v[68:71], a[28:31], a[80:83], v[68:71]
  s_mov_b32 s48, 0x3a800000
  ds_read_b64_tr_b16 a[168:169], v116 offset:16384
  v_mov_b32 v240, 0x3727c5ac
  v_mfma_f32_16x16x32_bf16 v[68:71], a[8:11], a[56:59], v[68:71]
  ds_read_b64_tr_b16 a[170:171], v116 offset:22528
  v_permlane32_swap_b32 v136, v130
  v_mfma_f32_16x16x32_bf16 v[72:75], a[12:15], a[56:59], v[72:75]
  ds_read_b64_tr_b16 a[148:149], v117 offset:4096
  buffer_load_dwordx4 v122, s[28:31], s64 offen offset:2048 sc1 lds
  v_mfma_f32_16x16x32_bf16 v[72:75], a[32:35], a[80:83], v[72:75]
  ds_read_b64_tr_b16 a[150:151], v117 offset:10240
  v_permlane32_swap_b32 v137, v131
  v_mfma_f32_16x16x32_bf16 v[76:79], a[36:39], a[80:83], v[76:79]
  ds_read_b64_tr_b16 a[172:173], v117 offset:16384
  v_permlane32_swap_b32 v128, v144
  v_mfma_f32_16x16x32_bf16 v[76:79], a[16:19], a[56:59], v[76:79]
  ds_read_b64_tr_b16 a[174:175], v117 offset:22528
  v_permlane32_swap_b32 v129, v145
  v_mfma_f32_16x16x32_bf16 v[92:95], a[16:19], a[60:63], v[92:95]
  v_add_f32 v136, v136, v130
  v_add_f32 v128, v128, v144
  v_mfma_f32_16x16x32_bf16 v[92:95], a[36:39], a[84:87], v[92:95]
  v_add_f32 v137, v137, v131
  v_add_f32 v129, v129, v145
  v_mfma_f32_16x16x32_bf16 v[88:91], a[32:35], a[84:87], v[88:91]
  v_permlane16_swap_b32 v128, v136
  v_mfma_f32_16x16x32_bf16 v[88:91], a[12:15], a[60:63], v[88:91]
  s_nop 0
  v_permlane16_swap_b32 v129, v137
  v_add_f32 v128, v128, v136
  v_mfma_f32_16x16x32_bf16 v[84:87], a[8:11], a[60:63], v[84:87]
  buffer_load_dwordx4 v123, s[28:31], s64 offen offset:3072 sc1 lds
  v_add_f32 v129, v129, v137
  v_mfma_f32_16x16x32_bf16 v[84:87], a[28:31], a[84:87], v[84:87]
  v_mul_f32 v128, 0xba800000, v128
  v_fma_f32 v129, v129, s48, v240
  v_mfma_f32_16x16x32_bf16 v[80:83], a[24:27], a[84:87], v[80:83]
  v_fma_f32 v129, -v128, v128, v129
  v_max_f32 v129, v129, v240
  v_mfma_f32_16x16x32_bf16 v[80:83], a[4:7], a[60:63], v[80:83]
  v_rsq_f32 v129, v129
  s_nop 0
  s_waitcnt lgkmcnt(15)
  v_mfma_f32_16x16x32_bf16 v[0:3], a[128:131], a[92:95], v[0:3]
  ds_write2_b32 v106, v128, v129 offset0:0 offset1:16
  v_mfma_f32_16x16x32_bf16 v[0:3], a[152:155], a[112:115], v[0:3]
  s_add_u32 m0, s89, 40960
  v_mfma_f32_16x16x32_bf16 v[4:7], a[152:155], a[116:119], v[4:7]
  s_mov_b32 s92, 655360
  v_mfma_f32_16x16x32_bf16 v[4:7], a[128:131], a[96:99], v[4:7]
  buffer_load_dwordx4 v186, s[12:15], s92 offen lds
  v_mfma_f32_16x16x32_bf16 v[8:11], a[128:131], a[100:103], v[8:11]
  v_mfma_f32_16x16x32_bf16 v[8:11], a[152:155], a[120:123], v[8:11]
  v_mfma_f32_16x16x32_bf16 v[12:15], a[152:155], a[124:127], v[12:15]
  v_mfma_f32_16x16x32_bf16 v[12:15], a[128:131], a[104:107], v[12:15]
  s_add_u32 m0, s89, 45056
  v_mfma_f32_16x16x32_bf16 v[28:31], a[132:135], a[104:107], v[28:31]
  s_mov_b32 s92, 720896
  v_mfma_f32_16x16x32_bf16 v[28:31], a[156:159], a[124:127], v[28:31]
  buffer_load_dwordx4 v186, s[12:15], s92 offen lds
  v_mfma_f32_16x16x32_bf16 v[24:27], a[156:159], a[120:123], v[24:27]
  s_waitcnt lgkmcnt(0)
  s_barrier
  ds_read2_b32 v[190:191], v167 offset0:32 offset1:48
  ds_read2_b32 v[192:193], v167 offset0:64 offset1:80
  v_mfma_f32_16x16x32_bf16 v[24:27], a[132:135], a[100:103], v[24:27]
  ds_read2_b32 v[194:195], v167 offset0:96 offset1:112
  ds_read2_b32 v[196:197], v167 offset0:128 offset1:144
  v_mfma_f32_16x16x32_bf16 v[20:23], a[132:135], a[96:99], v[20:23]
  ds_read2_b32 v[188:189], v166 offset0:0 offset1:16
  ds_read_b128 v[128:131], v107
  v_mfma_f32_16x16x32_bf16 v[20:23], a[156:159], a[116:119], v[20:23]
  s_add_u32 m0, s89, 49152
  ds_read_b128 v[132:135], v107 offset:1024
  ds_read_b128 v[200:203], v164 offset:0
  v_mfma_f32_16x16x32_bf16 v[16:19], a[156:159], a[112:115], v[16:19]
  s_mov_b32 s92, 786432
  ds_read_b128 v[220:223], v164 offset:64
  ds_read_b128 v[216:219], v165 offset:512
  v_mfma_f32_16x16x32_bf16 v[16:19], a[132:135], a[92:95], v[16:19]
  buffer_load_dwordx4 v186, s[12:15], s92 offen lds
  ds_read_b128 v[236:239], v165 offset:576
  v_mfma_f32_16x16x32_bf16 v[96:99], a[136:139], a[88:91], v[96:99]
  ds_read_b128 v[204:207], v165 offset:128
  ds_read_b128 v[224:227], v165 offset:192
  v_mfma_f32_16x16x32_bf16 v[96:99], a[160:163], a[108:111], v[96:99]
  ds_read_b128 v[208:211], v165 offset:256
  ds_read_b128 v[228:231], v165 offset:320
  v_mfma_f32_16x16x32_bf16 v[32:35], a[160:163], a[112:115], v[32:35]
  ds_read_b128 v[212:215], v165 offset:384
  ds_read_b128 v[232:235], v165 offset:448
  v_mfma_f32_16x16x32_bf16 v[32:35], a[136:139], a[92:95], v[32:35]
  s_add_u32 m0, s89, 53248
  s_and_b32 s43, s50, 7
  s_or_b32 s43, s43, s57
  v_mfma_f32_16x16x32_bf16 v[36:39], a[136:139], a[96:99], v[36:39]
  s_cselect_b64 s[46:47], -1, 0
  s_mov_b32 s92, 851968
  v_mov_b32 v245, 0xf149f2ca
  v_mfma_f32_16x16x32_bf16 v[36:39], a[160:163], a[116:119], v[36:39]
  s_waitcnt lgkmcnt(10)
  buffer_load_dwordx4 v186, s[12:15], s92 offen lds
  v_fmac_f32 v12, v168, v196
  v_mfma_f32_16x16x32_bf16 v[40:43], a[160:163], a[120:123], v[40:43]
  v_fmac_f32 v13, v169, v196
  v_fmac_f32 v14, v170, v196
  v_mfma_f32_16x16x32_bf16 v[40:43], a[136:139], a[100:103], v[40:43]
  v_fmac_f32 v15, v171, v196
  v_fmac_f32 v28, v172, v196
  v_mfma_f32_16x16x32_bf16 v[44:47], a[136:139], a[104:107], v[44:47]
  v_fmac_f32 v29, v173, v196
  v_fmac_f32 v30, v174, v196
  v_mfma_f32_16x16x32_bf16 v[44:47], a[160:163], a[124:127], v[44:47]
  s_add_u32 m0, s89, 57344
  v_fmac_f32 v31, v175, v196
  v_cvt_pk_bf16_f32 v12, v12, v13
  v_mfma_f32_16x16x32_bf16 v[60:63], a[164:167], a[124:127], v[60:63]
  s_mov_b32 s92, 917504
  v_cvt_pk_bf16_f32 v13, v14, v15
  v_cvt_pk_bf16_f32 v14, v28, v29
  v_mfma_f32_16x16x32_bf16 v[60:63], a[140:143], a[104:107], v[60:63]
  buffer_load_dwordx4 v186, s[12:15], s92 offen lds
  v_cvt_pk_bf16_f32 v15, v30, v31
  v_mfma_f32_16x16x32_bf16 v[56:59], a[140:143], a[100:103], v[56:59]
  v_fmac_f32 v8, v168, v194
  v_fmac_f32 v9, v169, v194
  v_mfma_f32_16x16x32_bf16 v[56:59], a[164:167], a[120:123], v[56:59]
  v_fmac_f32 v10, v170, v194
  v_fmac_f32 v11, v171, v194
  v_mfma_f32_16x16x32_bf16 v[52:55], a[164:167], a[116:119], v[52:55]
  v_fmac_f32 v24, v172, v194
  v_fmac_f32 v25, v173, v194
  v_mfma_f32_16x16x32_bf16 v[52:55], a[140:143], a[96:99], v[52:55]
  s_add_u32 m0, s89, 61440
  v_fmac_f32 v26, v174, v194
  v_fmac_f32 v27, v175, v194
  v_mfma_f32_16x16x32_bf16 v[48:51], a[140:143], a[92:95], v[48:51]
  s_mov_b32 s92, 983040
  v_cvt_pk_bf16_f32 v8, v8, v9
  v_cvt_pk_bf16_f32 v9, v10, v11
  v_mfma_f32_16x16x32_bf16 v[48:51], a[164:167], a[112:115], v[48:51]
  buffer_load_dwordx4 v186, s[12:15], s92 offen lds
  v_cvt_pk_bf16_f32 v10, v24, v25
  v_mfma_f32_16x16x32_bf16 v[100:103], a[108:111], a[168:171], v[100:103]
  v_cvt_pk_bf16_f32 v11, v26, v27
  v_fmac_f32 v4, v168, v192
  v_mfma_f32_16x16x32_bf16 v[100:103], a[88:91], a[144:147], v[100:103]
  v_fmac_f32 v5, v169, v192
  v_fmac_f32 v6, v170, v192
  v_mfma_f32_16x16x32_bf16 v[64:67], a[92:95], a[144:147], v[64:67]
  v_fmac_f32 v7, v171, v192
  v_fmac_f32 v20, v172, v192
  v_mfma_f32_16x16x32_bf16 v[64:67], a[112:115], a[168:171], v[64:67]
  s_add_u32 m0, s89, 65536
  v_fmac_f32 v21, v173, v192
  v_fmac_f32 v22, v174, v192
  v_mfma_f32_16x16x32_bf16 v[68:71], a[116:119], a[168:171], v[68:71]
  s_mov_b32 s92, 1048576
  v_fmac_f32 v23, v175, v192
  v_cvt_pk_bf16_f32 v4, v4, v5
  v_mfma_f32_16x16x32_bf16 v[68:71], a[96:99], a[144:147], v[68:71]
  buffer_load_dwordx4 v186, s[12:15], s92 offen lds
  v_cvt_pk_bf16_f32 v5, v6, v7
  v_mfma_f32_16x16x32_bf16 v[72:75], a[100:103], a[144:147], v[72:75]
  v_cvt_pk_bf16_f32 v6, v20, v21
  v_cvt_pk_bf16_f32 v7, v22, v23
  v_mfma_f32_16x16x32_bf16 v[72:75], a[120:123], a[168:171], v[72:75]
  v_fmac_f32 v0, v168, v190
  v_fmac_f32 v1, v169, v190
  v_mfma_f32_16x16x32_bf16 v[76:79], a[124:127], a[168:171], v[76:79]
  v_fmac_f32 v2, v170, v190
  v_fmac_f32 v3, v171, v190
  v_mfma_f32_16x16x32_bf16 v[76:79], a[104:107], a[144:147], v[76:79]
  s_add_u32 m0, s89, 69632
  v_fmac_f32 v16, v172, v190
  v_fmac_f32 v17, v173, v190
  v_mfma_f32_16x16x32_bf16 v[92:95], a[104:107], a[148:151], v[92:95]
  s_mov_b32 s92, 1114112
  v_fmac_f32 v18, v174, v190
  v_fmac_f32 v19, v175, v190
  v_mfma_f32_16x16x32_bf16 v[92:95], a[124:127], a[172:175], v[92:95]
  buffer_load_dwordx4 v186, s[12:15], s92 offen lds
  v_cvt_pk_bf16_f32 v0, v0, v1
  v_mfma_f32_16x16x32_bf16 v[88:91], a[120:123], a[172:175], v[88:91]
  v_cvt_pk_bf16_f32 v1, v2, v3
  v_cvt_pk_bf16_f32 v2, v16, v17
  v_mfma_f32_16x16x32_bf16 v[88:91], a[100:103], a[148:151], v[88:91]
  v_cvt_pk_bf16_f32 v3, v18, v19
  v_cndmask_b32 v136, v245, v132, s[46:47]
  v_mfma_f32_16x16x32_bf16 v[84:87], a[96:99], a[148:151], v[84:87]
  v_mov_b32 v160, 0x3f803f80
  v_mul_f32 v108, 0x3e8293ee, v191
  v_mfma_f32_16x16x32_bf16 v[84:87], a[116:119], a[172:175], v[84:87]
  v_cndmask_b32 v137, v245, v133, s[46:47]
  v_mov_b32 v161, 0x3f803f80
  v_mfma_f32_16x16x32_bf16 v[80:83], a[112:115], a[172:175], v[80:83]
  v_mul_f32 v109, 0x3e8293ee, v193
  v_cndmask_b32 v138, v245, v134, s[46:47]
  v_mfma_f32_16x16x32_bf16 v[80:83], a[92:95], a[148:151], v[80:83]
  v_mov_b32 v162, 0x3f803f80
  v_mul_f32 v110, 0x3e8293ee, v195
Lmk_p1epi:
  v_cndmask_b32 v139, v245, v135, s[46:47]
  v_mov_b32 v163, 0x3f803f80
  v_mul_f32 v111, 0x3e8293ee, v197
  s_waitcnt lgkmcnt(0)
  v_pk_fma_f32 v[96:97], v[176:177], v[188:189], v[96:97] op_sel:[0,0,0] op_sel_hi:[1,0,1]
  v_pk_fma_f32 v[98:99], v[178:179], v[188:189], v[98:99] op_sel:[0,0,0] op_sel_hi:[1,0,1]
  v_pk_mul_f32 v[96:97], v[96:97], v[188:189] op_sel:[0,1] op_sel_hi:[1,1]
  v_pk_mul_f32 v[98:99], v[98:99], v[188:189] op_sel:[0,1] op_sel_hi:[1,1]
  v_cvt_pk_bf16_f32 v96, v96, v97
  v_cvt_pk_bf16_f32 v97, v98, v99
  v_pk_fma_f32 v[44:45], v[176:177], v[196:197], v[44:45] op_sel:[0,0,0] op_sel_hi:[1,0,1]
  v_pk_fma_f32 v[46:47], v[178:179], v[196:197], v[46:47] op_sel:[0,0,0] op_sel_hi:[1,0,1]
  v_pk_fma_f32 v[60:61], v[180:181], v[196:197], v[60:61] op_sel:[0,0,0] op_sel_hi:[1,0,1]
  v_pk_fma_f32 v[62:63], v[182:183], v[196:197], v[62:63] op_sel:[0,0,0] op_sel_hi:[1,0,1]
  v_pk_mul_f32 v[44:45], v[44:45], v[196:197] op_sel:[0,1] op_sel_hi:[1,1]
  v_pk_mul_f32 v[46:47], v[46:47], v[196:197] op_sel:[0,1] op_sel_hi:[1,1]
  v_pk_mul_f32 v[60:61], v[60:61], v[196:197] op_sel:[0,1] op_sel_hi:[1,1]
  v_pk_mul_f32 v[62:63], v[62:63], v[196:197] op_sel:[0,1] op_sel_hi:[1,1]
  v_cvt_pk_bf16_f32 v44, v44, v45
  v_cvt_pk_bf16_f32 v45, v46, v47
  v_cvt_pk_bf16_f32 v46, v60, v61
  v_cvt_pk_bf16_f32 v47, v62, v63
  v_pk_fma_f32 v[100:101], v[200:201], v[184:185], v[100:101] op_sel:[0,0,0] op_sel_hi:[1,0,1]
  v_pk_fma_f32 v[102:103], v[202:203], v[184:185], v[102:103] op_sel:[0,0,0] op_sel_hi:[1,0,1]
  v_pk_mul_f32 v[100:101], v[100:101], v[220:221]
  v_pk_mul_f32 v[102:103], v[102:103], v[222:223]
  v_cvt_pk_bf16_f32 v100, v100, v101
  v_cvt_pk_bf16_f32 v101, v102, v103
  v_pk_fma_f32 v[76:77], v[216:217], v[184:185], v[76:77] op_sel:[0,0,0] op_sel_hi:[1,0,1]
  v_pk_fma_f32 v[78:79], v[218:219], v[184:185], v[78:79] op_sel:[0,0,0] op_sel_hi:[1,0,1]
  v_pk_fma_f32 v[92:93], v[216:217], v[184:185], v[92:93] op_sel:[0,1,0] op_sel_hi:[1,1,1]
  v_pk_fma_f32 v[94:95], v[218:219], v[184:185], v[94:95] op_sel:[0,1,0] op_sel_hi:[1,1,1]
  v_pk_mul_f32 v[76:77], v[76:77], v[236:237]
  v_pk_mul_f32 v[78:79], v[78:79], v[238:239]
  v_pk_mul_f32 v[92:93], v[92:93], v[236:237]
  v_pk_mul_f32 v[94:95], v[94:95], v[238:239]
  v_cvt_pk_bf16_f32 v148, v76, v77
  v_cvt_pk_bf16_f32 v149, v78, v79
  v_cvt_pk_bf16_f32 v158, v92, v93
  v_cvt_pk_bf16_f32 v159, v94, v95
  ds_write2st64_b64 v105, v[96:97], v[100:101] offset0:0 offset1:1
  ds_write2st64_b64 v105, v[44:45], v[148:149] offset0:4 offset1:5
  ds_write2st64_b64 v105, v[46:47], v[158:159] offset0:6 offset1:7
  s_add_u32 m0, s89, 0
  s_mov_b32 s92, 0
  buffer_load_dwordx4 v186, s[12:15], s92 offen lds
  v_pk_fma_f32 v[40:41], v[176:177], v[194:195], v[40:41] op_sel:[0,0,0] op_sel_hi:[1,0,1]
  v_pk_fma_f32 v[42:43], v[178:179], v[194:195], v[42:43] op_sel:[0,0,0] op_sel_hi:[1,0,1]
  v_pk_fma_f32 v[56:57], v[180:181], v[194:195], v[56:57] op_sel:[0,0,0] op_sel_hi:[1,0,1]
  v_pk_fma_f32 v[58:59], v[182:183], v[194:195], v[58:59] op_sel:[0,0,0] op_sel_hi:[1,0,1]
  v_pk_mul_f32 v[40:41], v[40:41], v[194:195] op_sel:[0,1] op_sel_hi:[1,1]
  v_pk_mul_f32 v[42:43], v[42:43], v[194:195] op_sel:[0,1] op_sel_hi:[1,1]
  v_pk_mul_f32 v[56:57], v[56:57], v[194:195] op_sel:[0,1] op_sel_hi:[1,1]
  v_pk_mul_f32 v[58:59], v[58:59], v[194:195] op_sel:[0,1] op_sel_hi:[1,1]
  v_cvt_pk_bf16_f32 v40, v40, v41
  v_cvt_pk_bf16_f32 v41, v42, v43
  v_cvt_pk_bf16_f32 v42, v56, v57
  v_cvt_pk_bf16_f32 v43, v58, v59
  s_add_u32 m0, s89, 4096
  s_mov_b32 s92, 65536
  buffer_load_dwordx4 v186, s[12:15], s92 offen lds
  v_pk_fma_f32 v[36:37], v[176:177], v[192:193], v[36:37] op_sel:[0,0,0] op_sel_hi:[1,0,1]
  v_pk_fma_f32 v[38:39], v[178:179], v[192:193], v[38:39] op_sel:[0,0,0] op_sel_hi:[1,0,1]
  v_pk_fma_f32 v[52:53], v[180:181], v[192:193], v[52:53] op_sel:[0,0,0] op_sel_hi:[1,0,1]
  v_pk_fma_f32 v[54:55], v[182:183], v[192:193], v[54:55] op_sel:[0,0,0] op_sel_hi:[1,0,1]
  v_pk_mul_f32 v[36:37], v[36:37], v[192:193] op_sel:[0,1] op_sel_hi:[1,1]
  v_pk_mul_f32 v[38:39], v[38:39], v[192:193] op_sel:[0,1] op_sel_hi:[1,1]
  v_pk_mul_f32 v[52:53], v[52:53], v[192:193] op_sel:[0,1] op_sel_hi:[1,1]
  v_pk_mul_f32 v[54:55], v[54:55], v[192:193] op_sel:[0,1] op_sel_hi:[1,1]
  v_cvt_pk_bf16_f32 v36, v36, v37
  v_cvt_pk_bf16_f32 v37, v38, v39
  v_cvt_pk_bf16_f32 v38, v52, v53
  v_cvt_pk_bf16_f32 v39, v54, v55
  s_add_u32 m0, s89, 8192
  s_mov_b32 s92, 131072
  buffer_load_dwordx4 v186, s[12:15], s92 offen lds
  v_pk_fma_f32 v[32:33], v[176:177], v[190:191], v[32:33] op_sel:[0,0,0] op_sel_hi:[1,0,1]
  v_pk_fma_f32 v[34:35], v[178:179], v[190:191], v[34:35] op_sel:[0,0,0] op_sel_hi:[1,0,1]
  v_pk_fma_f32 v[48:49], v[180:181], v[190:191], v[48:49] op_sel:[0,0,0] op_sel_hi:[1,0,1]
  v_pk_fma_f32 v[50:51], v[182:183], v[190:191], v[50:51] op_sel:[0,0,0] op_sel_hi:[1,0,1]
  v_pk_mul_f32 v[32:33], v[32:33], v[190:191] op_sel:[0,1] op_sel_hi:[1,1]
  v_pk_mul_f32 v[34:35], v[34:35], v[190:191] op_sel:[0,1] op_sel_hi:[1,1]
  v_pk_mul_f32 v[48:49], v[48:49], v[190:191] op_sel:[0,1] op_sel_hi:[1,1]
  v_pk_mul_f32 v[50:51], v[50:51], v[190:191] op_sel:[0,1] op_sel_hi:[1,1]
  v_cvt_pk_bf16_f32 v32, v32, v33
  v_cvt_pk_bf16_f32 v33, v34, v35
  v_cvt_pk_bf16_f32 v34, v48, v49
  v_cvt_pk_bf16_f32 v35, v50, v51
  s_waitcnt lgkmcnt(0)
  s_barrier
  ds_read_b64 v[120:121], v198
  ds_read_b64 v[122:123], v199
  ds_read_b64 v[140:141], v198 offset:512
  ds_read_b64 v[150:151], v199 offset:512
  v_mfma_f32_16x16x32_bf16 v[60:63], v[44:47], v[12:15], v[128:131]
  v_mfma_f32_16x16x32_bf16 v[28:31], v[40:43], v[12:15], v[132:135]
  v_mfma_f32_16x16x32_bf16 v[56:59], v[40:43], v[8:11], v[128:131]
  v_mfma_f32_16x16x32_bf16 v[24:27], v[36:39], v[8:11], v[132:135]
  v_mfma_f32_16x16x32_bf16 v[52:55], v[36:39], v[4:7], v[128:131]
  v_mfma_f32_16x16x32_bf16 v[20:23], v[32:35], v[4:7], v[132:135]
  v_mfma_f32_16x16x32_bf16 v[48:51], v[32:35], v[0:3], v[128:131]
  s_waitcnt lgkmcnt(0)
  v_mfma_f32_16x16x32_bf16 v[16:19], v[120:123], v[0:3], v[136:139]
  s_add_u32 m0, s89, 12288
  s_mov_b32 s92, 196608
  buffer_load_dwordx4 v186, s[12:15], s92 offen lds
  v_pk_fma_f32 v[64:65], v[204:205], v[184:185], v[64:65] op_sel:[0,0,0] op_sel_hi:[1,0,1]
  v_pk_fma_f32 v[66:67], v[206:207], v[184:185], v[66:67] op_sel:[0,0,0] op_sel_hi:[1,0,1]
  v_pk_fma_f32 v[80:81], v[204:205], v[184:185], v[80:81] op_sel:[0,1,0] op_sel_hi:[1,1,1]
  v_pk_fma_f32 v[82:83], v[206:207], v[184:185], v[82:83] op_sel:[0,1,0] op_sel_hi:[1,1,1]
  v_pk_mul_f32 v[64:65], v[64:65], v[224:225]
  v_pk_mul_f32 v[66:67], v[66:67], v[226:227]
  v_pk_mul_f32 v[80:81], v[80:81], v[224:225]
  v_pk_mul_f32 v[82:83], v[82:83], v[226:227]
  v_cvt_pk_bf16_f32 v142, v64, v65
  v_cvt_pk_bf16_f32 v143, v66, v67
  v_cvt_pk_bf16_f32 v152, v80, v81
  v_cvt_pk_bf16_f32 v153, v82, v83
  s_add_u32 m0, s89, 16384
  s_mov_b32 s92, 262144
  buffer_load_dwordx4 v186, s[12:15], s92 offen lds
  v_pk_fma_f32 v[68:69], v[208:209], v[184:185], v[68:69] op_sel:[0,0,0] op_sel_hi:[1,0,1]
  v_pk_fma_f32 v[70:71], v[210:211], v[184:185], v[70:71] op_sel:[0,0,0] op_sel_hi:[1,0,1]
  v_pk_fma_f32 v[84:85], v[208:209], v[184:185], v[84:85] op_sel:[0,1,0] op_sel_hi:[1,1,1]
  v_pk_fma_f32 v[86:87], v[210:211], v[184:185], v[86:87] op_sel:[0,1,0] op_sel_hi:[1,1,1]
  v_pk_mul_f32 v[68:69], v[68:69], v[228:229]
  v_pk_mul_f32 v[70:71], v[70:71], v[230:231]
  v_pk_mul_f32 v[84:85], v[84:85], v[228:229]
  v_pk_mul_f32 v[86:87], v[86:87], v[230:231]
  v_cvt_pk_bf16_f32 v144, v68, v69
  v_cvt_pk_bf16_f32 v145, v70, v71
  v_cvt_pk_bf16_f32 v154, v84, v85
  v_cvt_pk_bf16_f32 v155, v86, v87
  s_add_u32 m0, s89, 20480
  s_mov_b32 s92, 327680
  buffer_load_dwordx4 v186, s[12:15], s92 offen lds
  v_pk_fma_f32 v[72:73], v[212:213], v[184:185], v[72:73] op_sel:[0,0,0] op_sel_hi:[1,0,1]
  v_pk_fma_f32 v[74:75], v[214:215], v[184:185], v[74:75] op_sel:[0,0,0] op_sel_hi:[1,0,1]
  v_pk_fma_f32 v[88:89], v[212:213], v[184:185], v[88:89] op_sel:[0,1,0] op_sel_hi:[1,1,1]
  v_pk_fma_f32 v[90:91], v[214:215], v[184:185], v[90:91] op_sel:[0,1,0] op_sel_hi:[1,1,1]
  v_pk_mul_f32 v[72:73], v[72:73], v[232:233]
  v_pk_mul_f32 v[74:75], v[74:75], v[234:235]
  v_pk_mul_f32 v[88:89], v[88:89], v[232:233]
  v_pk_mul_f32 v[90:91], v[90:91], v[234:235]
  v_cvt_pk_bf16_f32 v146, v72, v73
  v_cvt_pk_bf16_f32 v147, v74, v75
  v_cvt_pk_bf16_f32 v156, v88, v89
  v_cvt_pk_bf16_f32 v157, v90, v91
  s_add_u32 m0, s89, 24576
  s_mov_b32 s92, 393216
  buffer_load_dwordx4 v186, s[12:15], s92 offen lds
  s_cmp_eq_u32 s57, 0
  s_cbranch_scc1 Lp1_nsw
  v_swap_b32 v140, v150
  v_swap_b32 v141, v151
  v_swap_b32 v142, v152
  v_swap_b32 v143, v153
  v_swap_b32 v144, v154
  v_swap_b32 v145, v155
  v_swap_b32 v146, v156
  v_swap_b32 v147, v157
  v_swap_b32 v148, v158
  v_swap_b32 v149, v159
Lp1_nsw:
  v_max3_f32 v240, v16, v17, v18
  v_max3_f32 v241, v20, v21, v22
  v_max3_f32 v242, v24, v25, v26
  v_max3_f32 v243, v28, v29, v30
  v_max3_f32 v240, v240, v19, v48
  v_max3_f32 v241, v241, v23, v52
  v_max3_f32 v242, v242, v27, v56
  v_max3_f32 v243, v243, v31, v60
  v_max3_f32 v240, v240, v49, v50
  v_max3_f32 v241, v241, v53, v54
  v_max3_f32 v242, v242, v57, v58
  v_max3_f32 v243, v243, v61, v62
  v_max_f32 v240, v240, v51
  v_max_f32 v241, v241, v55
  v_max_f32 v242, v242, v59
  v_max_f32 v243, v243, v63
  v_mov_b32 v244, v240
  v_mov_b32 v245, v241
  v_mov_b32 v246, v242
  v_mov_b32 v247, v243
  v_permlane32_swap_b32 v240, v244
  v_permlane32_swap_b32 v241, v245
  v_permlane32_swap_b32 v242, v246
  v_permlane32_swap_b32 v243, v247
  v_max_f32 v240, v240, v244
  v_max_f32 v241, v241, v245
  v_max_f32 v242, v242, v246
  v_max_f32 v243, v243, v247
  v_mov_b32 v244, v240
  v_mov_b32 v245, v241
  v_mov_b32 v246, v242
  v_mov_b32 v247, v243
  v_permlane16_swap_b32 v240, v244
  v_permlane16_swap_b32 v241, v245
  v_permlane16_swap_b32 v242, v246
  v_permlane16_swap_b32 v243, v247
  v_max_f32 v240, v240, v244
  v_max_f32 v241, v241, v245
  v_max_f32 v242, v242, v246
  v_max_f32 v243, v243, v247
  v_pk_mul_f32 v[240:241], v[240:241], v[108:109] neg_lo:[0,1] neg_hi:[0,1]
  v_pk_mul_f32 v[242:243], v[242:243], v[110:111] neg_lo:[0,1] neg_hi:[0,1]
  v_pk_fma_f32 v[16:17], v[16:17], v[108:109], v[240:241] op_sel:[0,0,0] op_sel_hi:[1,0,0]
  v_pk_fma_f32 v[18:19], v[18:19], v[108:109], v[240:241] op_sel:[0,0,0] op_sel_hi:[1,0,0]
  v_pk_fma_f32 v[48:49], v[48:49], v[108:109], v[240:241] op_sel:[0,0,0] op_sel_hi:[1,0,0]
  v_pk_fma_f32 v[50:51], v[50:51], v[108:109], v[240:241] op_sel:[0,0,0] op_sel_hi:[1,0,0]
  v_exp_f32 v16, v16
  v_exp_f32 v17, v17
  v_exp_f32 v18, v18
  v_exp_f32 v19, v19
  v_exp_f32 v48, v48
  v_exp_f32 v49, v49
  v_exp_f32 v50, v50
  v_exp_f32 v51, v51
  v_cvt_pk_bf16_f32 v0, v16, v17
  v_cvt_pk_bf16_f32 v1, v18, v19
  v_cvt_pk_bf16_f32 v2, v48, v49
  v_cvt_pk_bf16_f32 v3, v50, v51
  s_add_u32 m0, s89, 28672
  s_mov_b32 s92, 458752
  buffer_load_dwordx4 v186, s[12:15], s92 offen lds
  v_pk_fma_f32 v[20:21], v[20:21], v[108:109], v[240:241] op_sel:[0,1,1] op_sel_hi:[1,1,1]
  v_pk_fma_f32 v[22:23], v[22:23], v[108:109], v[240:241] op_sel:[0,1,1] op_sel_hi:[1,1,1]
  v_pk_fma_f32 v[52:53], v[52:53], v[108:109], v[240:241] op_sel:[0,1,1] op_sel_hi:[1,1,1]
  v_pk_fma_f32 v[54:55], v[54:55], v[108:109], v[240:241] op_sel:[0,1,1] op_sel_hi:[1,1,1]
  v_exp_f32 v20, v20
  v_exp_f32 v21, v21
  v_exp_f32 v22, v22
  v_exp_f32 v23, v23
  v_exp_f32 v52, v52
  v_exp_f32 v53, v53
  v_exp_f32 v54, v54
  v_exp_f32 v55, v55
  v_cvt_pk_bf16_f32 v4, v20, v21
  v_cvt_pk_bf16_f32 v5, v22, v23
  v_cvt_pk_bf16_f32 v6, v52, v53
  v_cvt_pk_bf16_f32 v7, v54, v55
  s_add_u32 m0, s89, 32768
  s_mov_b32 s92, 524288
  buffer_load_dwordx4 v186, s[12:15], s92 offen lds
  v_pk_fma_f32 v[24:25], v[24:25], v[110:111], v[242:243] op_sel:[0,0,0] op_sel_hi:[1,0,0]
  v_pk_fma_f32 v[26:27], v[26:27], v[110:111], v[242:243] op_sel:[0,0,0] op_sel_hi:[1,0,0]
  v_pk_fma_f32 v[56:57], v[56:57], v[110:111], v[242:243] op_sel:[0,0,0] op_sel_hi:[1,0,0]
  v_pk_fma_f32 v[58:59], v[58:59], v[110:111], v[242:243] op_sel:[0,0,0] op_sel_hi:[1,0,0]
  v_exp_f32 v24, v24
  v_exp_f32 v25, v25
  v_exp_f32 v26, v26
  v_exp_f32 v27, v27
  v_exp_f32 v56, v56
  v_exp_f32 v57, v57
  v_exp_f32 v58, v58
  v_exp_f32 v59, v59
  v_cvt_pk_bf16_f32 v8, v24, v25
  v_cvt_pk_bf16_f32 v9, v26, v27
  v_cvt_pk_bf16_f32 v10, v56, v57
  v_cvt_pk_bf16_f32 v11, v58, v59
  v_pk_fma_f32 v[28:29], v[28:29], v[110:111], v[242:243] op_sel:[0,1,1] op_sel_hi:[1,1,1]
  v_pk_fma_f32 v[30:31], v[30:31], v[110:111], v[242:243] op_sel:[0,1,1] op_sel_hi:[1,1,1]
  v_pk_fma_f32 v[60:61], v[60:61], v[110:111], v[242:243] op_sel:[0,1,1] op_sel_hi:[1,1,1]
  v_pk_fma_f32 v[62:63], v[62:63], v[110:111], v[242:243] op_sel:[0,1,1] op_sel_hi:[1,1,1]
  v_exp_f32 v28, v28
  v_exp_f32 v29, v29
  v_exp_f32 v30, v30
  v_exp_f32 v31, v31
  v_exp_f32 v60, v60
  v_exp_f32 v61, v61
  v_exp_f32 v62, v62
  v_exp_f32 v63, v63
  v_cvt_pk_bf16_f32 v12, v28, v29
  v_cvt_pk_bf16_f32 v13, v30, v31
  v_cvt_pk_bf16_f32 v14, v60, v61
  v_cvt_pk_bf16_f32 v15, v62, v63
  s_add_u32 m0, s89, 36864
  s_mov_b32 s92, 589824
  buffer_load_dwordx4 v186, s[12:15], s92 offen lds
  v_mfma_f32_16x16x32_bf16 v[32:35], v[160:163], v[0:3], 0
  s_lshl_b32 s43, s74, 15
  s_lshl_b32 s44, s75, 10
  v_mfma_f32_16x16x32_bf16 v[36:39], v[160:163], v[4:7], 0
  s_add_u32 s43, s43, s44
  s_add_u32 s43, s43, s42
  v_mfma_f32_16x16x32_bf16 v[40:43], v[160:163], v[8:11], 0
  s_add_u32 s46, s43, 8388608
  s_add_u32 s47, s46, 32768
  v_mfma_f32_16x16x32_bf16 v[44:47], v[160:163], v[12:15], 0
  s_add_u32 s48, s47, 32768
  s_add_u32 s49, s48, 32768
  v_mfma_f32_16x16x32_bf16 v[64:67], v[140:143], v[0:3], 0
  s_lshl_b32 s77, s50, 1
  v_mfma_f32_16x16x32_bf16 v[80:83], v[150:153], v[0:3], 0
  s_lshr_b32 s43, s51, 3
  v_mfma_f32_16x16x32_bf16 v[68:71], v[142:145], v[4:7], 0
  s_add_u32 s77, s77, s43
  v_mfma_f32_16x16x32_bf16 v[84:87], v[152:155], v[4:7], 0
  s_lshl_b32 s77, s77, 7
  v_mfma_f32_16x16x32_bf16 v[72:75], v[144:147], v[8:11], 0
  s_add_u32 s77, s77, s42
  v_rcp_f32 v32, v32
  v_mfma_f32_16x16x32_bf16 v[88:91], v[154:157], v[8:11], 0
  s_add_u32 s77, s77, 27787264
  v_rcp_f32 v36, v36
  v_mfma_f32_16x16x32_bf16 v[76:79], v[146:149], v[12:15], 0
  v_rcp_f32 v40, v40
  v_mfma_f32_16x16x32_bf16 v[92:95], v[156:159], v[12:15], 0
  v_rcp_f32 v44, v44
  v_pk_mul_f32 v[64:65], v[64:65], v[32:33] op_sel:[0,0] op_sel_hi:[1,0]
  v_pk_mul_f32 v[66:67], v[66:67], v[32:33] op_sel:[0,0] op_sel_hi:[1,0]
  v_pk_mul_f32 v[80:81], v[80:81], v[32:33] op_sel:[0,0] op_sel_hi:[1,0]
  v_pk_mul_f32 v[82:83], v[82:83], v[32:33] op_sel:[0,0] op_sel_hi:[1,0]
  v_cvt_pk_bf16_f32 v16, v64, v65
  v_cvt_pk_bf16_f32 v17, v66, v67
  v_cvt_pk_bf16_f32 v18, v80, v81
  v_cvt_pk_bf16_f32 v19, v82, v83
  buffer_store_dwordx4 v[16:19], v104, s[4:7], s46 offen sc1
  v_pk_mul_f32 v[68:69], v[68:69], v[36:37] op_sel:[0,0] op_sel_hi:[1,0]
  v_pk_mul_f32 v[70:71], v[70:71], v[36:37] op_sel:[0,0] op_sel_hi:[1,0]
  v_pk_mul_f32 v[84:85], v[84:85], v[36:37] op_sel:[0,0] op_sel_hi:[1,0]
  v_pk_mul_f32 v[86:87], v[86:87], v[36:37] op_sel:[0,0] op_sel_hi:[1,0]
  v_cvt_pk_bf16_f32 v20, v68, v69
  v_cvt_pk_bf16_f32 v21, v70, v71
  v_cvt_pk_bf16_f32 v22, v84, v85
  v_cvt_pk_bf16_f32 v23, v86, v87
  buffer_store_dwordx4 v[20:23], v104, s[4:7], s47 offen sc1
  v_pk_mul_f32 v[72:73], v[72:73], v[40:41] op_sel:[0,0] op_sel_hi:[1,0]
  v_pk_mul_f32 v[74:75], v[74:75], v[40:41] op_sel:[0,0] op_sel_hi:[1,0]
  v_pk_mul_f32 v[88:89], v[88:89], v[40:41] op_sel:[0,0] op_sel_hi:[1,0]
  v_pk_mul_f32 v[90:91], v[90:91], v[40:41] op_sel:[0,0] op_sel_hi:[1,0]
  v_cvt_pk_bf16_f32 v24, v72, v73
  v_cvt_pk_bf16_f32 v25, v74, v75
  v_cvt_pk_bf16_f32 v26, v88, v89
  v_cvt_pk_bf16_f32 v27, v90, v91
  buffer_store_dwordx4 v[24:27], v104, s[4:7], s48 offen sc1
  v_pk_mul_f32 v[76:77], v[76:77], v[44:45] op_sel:[0,0] op_sel_hi:[1,0]
  v_pk_mul_f32 v[78:79], v[78:79], v[44:45] op_sel:[0,0] op_sel_hi:[1,0]
  v_pk_mul_f32 v[92:93], v[92:93], v[44:45] op_sel:[0,0] op_sel_hi:[1,0]
  v_pk_mul_f32 v[94:95], v[94:95], v[44:45] op_sel:[0,0] op_sel_hi:[1,0]
  v_cvt_pk_bf16_f32 v28, v76, v77
  v_cvt_pk_bf16_f32 v29, v78, v79
  v_cvt_pk_bf16_f32 v30, v92, v93
  v_cvt_pk_bf16_f32 v31, v94, v95
  buffer_store_dwordx4 v[28:31], v104, s[4:7], s49 offen sc1
Lmk_p1end:
  s_lshl_b32 s44, s52, 3
  s_lshl_b32 s43, s40, 1
  s_add_u32 s44, s44, s43
  s_lshl_b32 s45, s44, 15
  s_add_u32 s57, s45, s42
  s_add_u32 s57, s57, 8388608
  s_lshl_b32 s43, s53, 11
  s_add_u32 s45, s45, s43
  s_add_u32 s45, s45, s42
  s_add_u32 s58, s45, 4194304
  s_add_u32 s59, s58, 32768
  s_lshl_b32 s44, s44, 11
  s_lshl_b32 s43, s53, 7
  s_add_u32 s44, s44, s43
  s_add_u32 s44, s44, s42
  s_add_u32 s60, s44, 27525120
  v_lshlrev_b32 v48, 4, v253
  v_add_u32 v49, 32768, v48
  s_cmp_eq_u32 s41, 0
  s_cselect_b32 s44, 32, 8
  s_cselect_b32 s45, 64, 0x400
  s_lshl_b32 s43, s40, 12
  s_add_u32 s43, s43, 90112
  v_xor_b32 v3, s44, v187
  v_xor_b32 v4, s45, v187
  v_xor_b32 v5, s45, v3
  v_add_u32 v2, s43, v187
  v_add_u32 v3, s43, v3
  v_add_u32 v4, s43, v4
  v_add_u32 v5, s43, v5
  s_waitcnt vmcnt(22)
  ds_read_b64 v[52:53], v2 offset:0
  ds_read_b64 v[54:55], v3 offset:0
  ds_read_b64 v[56:57], v4 offset:0
  ds_read_b64 v[58:59], v5 offset:0
  ds_read_b64 v[60:61], v2 offset:2048
  ds_read_b64 v[62:63], v3 offset:2048
  ds_read_b64 v[64:65], v4 offset:2048
  ds_read_b64 v[66:67], v5 offset:2048
  v_lshrrev_b32 v2, 2, v253
  v_bfe_u32 v3, v253, 3, 2
  v_and_b32 v4, 3, v253
  v_lshlrev_b32 v4, 3, v4
  v_lshl_add_u32 v4, v2, 7, v4
  v_xor_b32 v5, 0, v3
  v_lshl_add_u32 v40, v5, 5, v4
  v_xor_b32 v5, 1, v3
  v_lshl_add_u32 v41, v5, 5, v4
  v_xor_b32 v5, 2, v3
  v_lshl_add_u32 v42, v5, 5, v4
  v_xor_b32 v5, 3, v3
  v_lshl_add_u32 v43, v5, 5, v4
  s_cmp_eq_u32 s3, 0
  s_cbranch_scc1 Lsd6
  v_accvgpr_read_b32 v236, a176
  v_accvgpr_read_b32 v237, a177
  v_accvgpr_read_b32 v238, a178
  v_accvgpr_read_b32 v239, a179
  v_lshlrev_b32 v224, 16, v236
  v_and_b32 v225, 0xffff0000, v236
  v_lshlrev_b32 v226, 16, v237
  v_and_b32 v227, 0xffff0000, v237
  v_lshlrev_b32 v228, 16, v238
  v_and_b32 v229, 0xffff0000, v238
  v_lshlrev_b32 v230, 16, v239
  v_and_b32 v231, 0xffff0000, v239
  v_accvgpr_read_b32 v236, a180
  v_accvgpr_read_b32 v237, a181
  v_accvgpr_read_b32 v238, a182
  v_accvgpr_read_b32 v239, a183
  v_lshlrev_b32 v232, 16, v236
  v_and_b32 v233, 0xffff0000, v236
  v_pk_add_f32 v[224:225], v[224:225], v[232:233]
  v_lshlrev_b32 v232, 16, v237
  v_and_b32 v233, 0xffff0000, v237
  v_pk_add_f32 v[226:227], v[226:227], v[232:233]
  v_lshlrev_b32 v232, 16, v238
  v_and_b32 v233, 0xffff0000, v238
  v_pk_add_f32 v[228:229], v[228:229], v[232:233]
  v_lshlrev_b32 v232, 16, v239
  v_and_b32 v233, 0xffff0000, v239
  v_pk_add_f32 v[230:231], v[230:231], v[232:233]
  v_accvgpr_read_b32 v236, a184
  v_accvgpr_read_b32 v237, a185
  v_accvgpr_read_b32 v238, a186
  v_accvgpr_read_b32 v239, a187
  v_lshlrev_b32 v232, 16, v236
  v_and_b32 v233, 0xffff0000, v236
  v_pk_add_f32 v[224:225], v[224:225], v[232:233]
  v_lshlrev_b32 v232, 16, v237
  v_and_b32 v233, 0xffff0000, v237
  v_pk_add_f32 v[226:227], v[226:227], v[232:233]
  v_lshlrev_b32 v232, 16, v238
  v_and_b32 v233, 0xffff0000, v238
  v_pk_add_f32 v[228:229], v[228:229], v[232:233]
  v_lshlrev_b32 v232, 16, v239
  v_and_b32 v233, 0xffff0000, v239
  v_pk_add_f32 v[230:231], v[230:231], v[232:233]
  v_accvgpr_read_b32 v236, a188
  v_accvgpr_read_b32 v237, a189
  v_accvgpr_read_b32 v238, a190
  v_accvgpr_read_b32 v239, a191
  v_lshlrev_b32 v232, 16, v236
  v_and_b32 v233, 0xffff0000, v236
  v_pk_add_f32 v[224:225], v[224:225], v[232:233]
  v_lshlrev_b32 v232, 16, v237
  v_and_b32 v233, 0xffff0000, v237
  v_pk_add_f32 v[226:227], v[226:227], v[232:233]
  v_lshlrev_b32 v232, 16, v238
  v_and_b32 v233, 0xffff0000, v238
  v_pk_add_f32 v[228:229], v[228:229], v[232:233]
  v_lshlrev_b32 v232, 16, v239
  v_and_b32 v233, 0xffff0000, v239
  v_pk_add_f32 v[230:231], v[230:231], v[232:233]
  v_accvgpr_read_b32 v236, a192
  v_accvgpr_read_b32 v237, a193
  v_accvgpr_read_b32 v238, a194
  v_accvgpr_read_b32 v239, a195
  v_lshlrev_b32 v232, 16, v236
  v_and_b32 v233, 0xffff0000, v236
  v_pk_add_f32 v[224:225], v[224:225], v[232:233]
  v_lshlrev_b32 v232, 16, v237
  v_and_b32 v233, 0xffff0000, v237
  v_pk_add_f32 v[226:227], v[226:227], v[232:233]
  v_lshlrev_b32 v232, 16, v238
  v_and_b32 v233, 0xffff0000, v238
  v_pk_add_f32 v[228:229], v[228:229], v[232:233]
  v_lshlrev_b32 v232, 16, v239
  v_and_b32 v233, 0xffff0000, v239
  v_pk_add_f32 v[230:231], v[230:231], v[232:233]
  v_accvgpr_read_b32 v236, a196
  v_accvgpr_read_b32 v237, a197
  v_accvgpr_read_b32 v238, a198
  v_accvgpr_read_b32 v239, a199
  v_lshlrev_b32 v232, 16, v236
  v_and_b32 v233, 0xffff0000, v236
  v_pk_add_f32 v[224:225], v[224:225], v[232:233]
  v_lshlrev_b32 v232, 16, v237
  v_and_b32 v233, 0xffff0000, v237
  v_pk_add_f32 v[226:227], v[226:227], v[232:233]
  v_lshlrev_b32 v232, 16, v238
  v_and_b32 v233, 0xffff0000, v238
  v_pk_add_f32 v[228:229], v[228:229], v[232:233]
  v_lshlrev_b32 v232, 16, v239
  v_and_b32 v233, 0xffff0000, v239
  v_pk_add_f32 v[230:231], v[230:231], v[232:233]
  v_accvgpr_read_b32 v236, a200
  v_accvgpr_read_b32 v237, a201
  v_accvgpr_read_b32 v238, a202
  v_accvgpr_read_b32 v239, a203
  v_lshlrev_b32 v232, 16, v236
  v_and_b32 v233, 0xffff0000, v236
  v_pk_add_f32 v[224:225], v[224:225], v[232:233]
  v_lshlrev_b32 v232, 16, v237
  v_and_b32 v233, 0xffff0000, v237
  v_pk_add_f32 v[226:227], v[226:227], v[232:233]
  v_lshlrev_b32 v232, 16, v238
  v_and_b32 v233, 0xffff0000, v238
  v_pk_add_f32 v[228:229], v[228:229], v[232:233]
  v_lshlrev_b32 v232, 16, v239
  v_and_b32 v233, 0xffff0000, v239
  v_pk_add_f32 v[230:231], v[230:231], v[232:233]
  v_accvgpr_read_b32 v236, a204
  v_accvgpr_read_b32 v237, a205
  v_accvgpr_read_b32 v238, a206
  v_accvgpr_read_b32 v239, a207
  v_lshlrev_b32 v232, 16, v236
  v_and_b32 v233, 0xffff0000, v236
  v_pk_add_f32 v[224:225], v[224:225], v[232:233]
  v_lshlrev_b32 v232, 16, v237
  v_and_b32 v233, 0xffff0000, v237
  v_pk_add_f32 v[226:227], v[226:227], v[232:233]
  v_lshlrev_b32 v232, 16, v238
  v_and_b32 v233, 0xffff0000, v238
  v_pk_add_f32 v[228:229], v[228:229], v[232:233]
  v_lshlrev_b32 v232, 16, v239
  v_and_b32 v233, 0xffff0000, v239
  v_pk_add_f32 v[230:231], v[230:231], v[232:233]
Lsd6:
  s_waitcnt lgkmcnt(0)
  s_waitcnt vmcnt(0)
  s_barrier
  s_cmp_lg_u32 s40, 0
  s_cbranch_scc1 Lsig5
  v_mov_b32 v250, 1
  s_mov_b64 exec, 1
  buffer_atomic_add v250, v251, s[4:7], s77 offen sc1
  s_mov_b64 exec, -1
Lsig5:
  s_add_u32 m0, s89, 73728
  s_mov_b32 s92, 1179648
  buffer_load_dwordx4 v186, s[12:15], s92 offen lds
  s_add_u32 m0, s89, 77824
  s_mov_b32 s92, 1245184
  buffer_load_dwordx4 v186, s[12:15], s92 offen lds
  s_add_u32 m0, s89, 81920
  s_mov_b32 s92, 1310720
  buffer_load_dwordx4 v186, s[12:15], s92 offen lds
  s_add_u32 m0, s89, 86016
  s_mov_b32 s92, 1376256
  buffer_load_dwordx4 v186, s[12:15], s92 offen lds
  s_add_u32 m0, s89, 90112
  s_mov_b32 s92, 1441792
  buffer_load_dwordx4 v186, s[12:15], s92 offen lds
  s_add_u32 m0, s89, 94208
  s_mov_b32 s92, 1507328
  buffer_load_dwordx4 v186, s[12:15], s92 offen lds
  s_add_u32 m0, s89, 98304
  s_mov_b32 s92, 1572864
  buffer_load_dwordx4 v186, s[12:15], s92 offen lds
  s_add_u32 m0, s89, 102400
  s_mov_b32 s92, 1638400
  buffer_load_dwordx4 v186, s[12:15], s92 offen lds
  s_add_u32 m0, s89, 106496
  s_mov_b32 s92, 1703936
  buffer_load_dwordx4 v186, s[12:15], s92 offen lds
  s_add_u32 m0, s89, 110592
  s_mov_b32 s92, 1769472
  buffer_load_dwordx4 v186, s[12:15], s92 offen lds
  s_add_u32 m0, s89, 114688
  s_mov_b32 s92, 1835008
  buffer_load_dwordx4 v186, s[12:15], s92 offen lds
  s_add_u32 m0, s89, 118784
  s_mov_b32 s92, 1900544
  buffer_load_dwordx4 v186, s[12:15], s92 offen lds
  s_add_u32 m0, s89, 122880
  s_mov_b32 s92, 1966080
  buffer_load_dwordx4 v186, s[12:15], s92 offen lds
  s_add_u32 m0, s89, 126976
  s_mov_b32 s92, 2031616
  buffer_load_dwordx4 v186, s[12:15], s92 offen lds
  v_lshlrev_b32 v0, 16, v52
  v_and_b32 v1, 0xffff0000, v52
  v_lshlrev_b32 v2, 16, v53
  v_and_b32 v3, 0xffff0000, v53
  v_lshlrev_b32 v8, 16, v54
  v_and_b32 v9, 0xffff0000, v54
  v_lshlrev_b32 v10, 16, v55
  v_and_b32 v11, 0xffff0000, v55
  v_lshlrev_b32 v16, 16, v56
  v_and_b32 v17, 0xffff0000, v56
  v_lshlrev_b32 v18, 16, v57
  v_and_b32 v19, 0xffff0000, v57
  v_lshlrev_b32 v24, 16, v58
  v_and_b32 v25, 0xffff0000, v58
  v_lshlrev_b32 v26, 16, v59
  v_and_b32 v27, 0xffff0000, v59
  v_lshlrev_b32 v4, 16, v60
  v_and_b32 v5, 0xffff0000, v60
  v_lshlrev_b32 v6, 16, v61
  v_and_b32 v7, 0xffff0000, v61
  v_lshlrev_b32 v12, 16, v62
  v_and_b32 v13, 0xffff0000, v62
  v_lshlrev_b32 v14, 16, v63
  v_and_b32 v15, 0xffff0000, v63
  v_lshlrev_b32 v20, 16, v64
  v_and_b32 v21, 0xffff0000, v64
  v_lshlrev_b32 v22, 16, v65
  v_and_b32 v23, 0xffff0000, v65
  v_lshlrev_b32 v28, 16, v66
  v_and_b32 v29, 0xffff0000, v66
  v_lshlrev_b32 v30, 16, v67
  v_and_b32 v31, 0xffff0000, v67
  v_and_b32 v92, 15, v253
  v_lshrrev_b32 v93, 4, v253
  v_lshrrev_b32 v72, 2, v92
  v_cmp_eq_u32 vcc, v72, v93
  v_and_b32 v72, 3, v92
  v_lshlrev_b32 v92, 3, v92
  v_mov_b32 v93, 0x7ffffff0
  v_cndmask_b32 v92, v93, v92, vcc
  v_cmp_eq_u32 s[64:65], 1, v72
  v_cmp_eq_u32 s[66:67], 2, v72
  v_cmp_eq_u32 s[68:69], 3, v72
  v_mov_b32 v72, 0x3f803f80
  v_mov_b32 v73, 0x3f803f80
  v_mov_b32 v74, 0x3f803f80
  v_mov_b32 v75, 0x3f803f80
  s_cmp_eq_u32 s3, 0
  s_cbranch_scc1 Lsd7
  v_accvgpr_read_b32 v236, a208
  v_accvgpr_read_b32 v237, a209
  v_accvgpr_read_b32 v238, a210
  v_accvgpr_read_b32 v239, a211
  v_lshlrev_b32 v232, 16, v236
  v_and_b32 v233, 0xffff0000, v236
  v_pk_add_f32 v[224:225], v[224:225], v[232:233]
  v_lshlrev_b32 v232, 16, v237
  v_and_b32 v233, 0xffff0000, v237
  v_pk_add_f32 v[226:227], v[226:227], v[232:233]
  v_lshlrev_b32 v232, 16, v238
  v_and_b32 v233, 0xffff0000, v238
  v_pk_add_f32 v[228:229], v[228:229], v[232:233]
  v_lshlrev_b32 v232, 16, v239
  v_and_b32 v233, 0xffff0000, v239
  v_pk_add_f32 v[230:231], v[230:231], v[232:233]
  v_accvgpr_read_b32 v236, a212
  v_accvgpr_read_b32 v237, a213
  v_accvgpr_read_b32 v238, a214
  v_accvgpr_read_b32 v239, a215
  v_lshlrev_b32 v232, 16, v236
  v_and_b32 v233, 0xffff0000, v236
  v_pk_add_f32 v[224:225], v[224:225], v[232:233]
  v_lshlrev_b32 v232, 16, v237
  v_and_b32 v233, 0xffff0000, v237
  v_pk_add_f32 v[226:227], v[226:227], v[232:233]
  v_lshlrev_b32 v232, 16, v238
  v_and_b32 v233, 0xffff0000, v238
  v_pk_add_f32 v[228:229], v[228:229], v[232:233]
  v_lshlrev_b32 v232, 16, v239
  v_and_b32 v233, 0xffff0000, v239
  v_pk_add_f32 v[230:231], v[230:231], v[232:233]
  v_accvgpr_read_b32 v236, a216
  v_accvgpr_read_b32 v237, a217
  v_accvgpr_read_b32 v238, a218
  v_accvgpr_read_b32 v239, a219
  v_lshlrev_b32 v232, 16, v236
  v_and_b32 v233, 0xffff0000, v236
  v_pk_add_f32 v[224:225], v[224:225], v[232:233]
  v_lshlrev_b32 v232, 16, v237
  v_and_b32 v233, 0xffff0000, v237
  v_pk_add_f32 v[226:227], v[226:227], v[232:233]
  v_lshlrev_b32 v232, 16, v238
  v_and_b32 v233, 0xffff0000, v238
  v_pk_add_f32 v[228:229], v[228:229], v[232:233]
  v_lshlrev_b32 v232, 16, v239
  v_and_b32 v233, 0xffff0000, v239
  v_pk_add_f32 v[230:231], v[230:231], v[232:233]
  v_accvgpr_read_b32 v236, a220
  v_accvgpr_read_b32 v237, a221
  v_accvgpr_read_b32 v238, a222
  v_accvgpr_read_b32 v239, a223
  v_lshlrev_b32 v232, 16, v236
  v_and_b32 v233, 0xffff0000, v236
  v_pk_add_f32 v[224:225], v[224:225], v[232:233]
  v_lshlrev_b32 v232, 16, v237
  v_and_b32 v233, 0xffff0000, v237
  v_pk_add_f32 v[226:227], v[226:227], v[232:233]
  v_lshlrev_b32 v232, 16, v238
  v_and_b32 v233, 0xffff0000, v238
  v_pk_add_f32 v[228:229], v[228:229], v[232:233]
  v_lshlrev_b32 v232, 16, v239
  v_and_b32 v233, 0xffff0000, v239
  v_pk_add_f32 v[230:231], v[230:231], v[232:233]
  v_accvgpr_read_b32 v236, a224
  v_accvgpr_read_b32 v237, a225
  v_accvgpr_read_b32 v238, a226
  v_accvgpr_read_b32 v239, a227
  v_lshlrev_b32 v232, 16, v236
  v_and_b32 v233, 0xffff0000, v236
  v_pk_add_f32 v[224:225], v[224:225], v[232:233]
  v_lshlrev_b32 v232, 16, v237
  v_and_b32 v233, 0xffff0000, v237
  v_pk_add_f32 v[226:227], v[226:227], v[232:233]
  v_lshlrev_b32 v232, 16, v238
  v_and_b32 v233, 0xffff0000, v238
  v_pk_add_f32 v[228:229], v[228:229], v[232:233]
  v_lshlrev_b32 v232, 16, v239
  v_and_b32 v233, 0xffff0000, v239
  v_pk_add_f32 v[230:231], v[230:231], v[232:233]
  v_accvgpr_read_b32 v236, a228
  v_accvgpr_read_b32 v237, a229
  v_accvgpr_read_b32 v238, a230
  v_accvgpr_read_b32 v239, a231
  v_lshlrev_b32 v232, 16, v236
  v_and_b32 v233, 0xffff0000, v236
  v_pk_add_f32 v[224:225], v[224:225], v[232:233]
  v_lshlrev_b32 v232, 16, v237
  v_and_b32 v233, 0xffff0000, v237
  v_pk_add_f32 v[226:227], v[226:227], v[232:233]
  v_lshlrev_b32 v232, 16, v238
  v_and_b32 v233, 0xffff0000, v238
  v_pk_add_f32 v[228:229], v[228:229], v[232:233]
  v_lshlrev_b32 v232, 16, v239
  v_and_b32 v233, 0xffff0000, v239
  v_pk_add_f32 v[230:231], v[230:231], v[232:233]
  v_accvgpr_read_b32 v236, a232
  v_accvgpr_read_b32 v237, a233
  v_accvgpr_read_b32 v238, a234
  v_accvgpr_read_b32 v239, a235
  v_lshlrev_b32 v232, 16, v236
  v_and_b32 v233, 0xffff0000, v236
  v_pk_add_f32 v[224:225], v[224:225], v[232:233]
  v_lshlrev_b32 v232, 16, v237
  v_and_b32 v233, 0xffff0000, v237
  v_pk_add_f32 v[226:227], v[226:227], v[232:233]
  v_lshlrev_b32 v232, 16, v238
  v_and_b32 v233, 0xffff0000, v238
  v_pk_add_f32 v[228:229], v[228:229], v[232:233]
  v_lshlrev_b32 v232, 16, v239
  v_and_b32 v233, 0xffff0000, v239
  v_pk_add_f32 v[230:231], v[230:231], v[232:233]
  v_accvgpr_read_b32 v236, a236
  v_accvgpr_read_b32 v237, a237
  v_accvgpr_read_b32 v238, a238
  v_accvgpr_read_b32 v239, a239
  v_lshlrev_b32 v232, 16, v236
  v_and_b32 v233, 0xffff0000, v236
  v_pk_add_f32 v[224:225], v[224:225], v[232:233]
  v_lshlrev_b32 v232, 16, v237
  v_and_b32 v233, 0xffff0000, v237
  v_pk_add_f32 v[226:227], v[226:227], v[232:233]
  v_lshlrev_b32 v232, 16, v238
  v_and_b32 v233, 0xffff0000, v238
  v_pk_add_f32 v[228:229], v[228:229], v[232:233]
  v_lshlrev_b32 v232, 16, v239
  v_and_b32 v233, 0xffff0000, v239
  v_pk_add_f32 v[230:231], v[230:231], v[232:233]
  v_mov_b32 v232, v224
  v_mov_b32 v233, v225
  v_mov_b32 v234, v226
  v_mov_b32 v235, v227
  v_mov_b32 v236, v228
  v_mov_b32 v237, v229
  v_mov_b32 v238, v230
  v_mov_b32 v239, v231
  v_permlane32_swap_b32 v224, v232
  v_permlane32_swap_b32 v225, v233
  v_permlane32_swap_b32 v226, v234
  v_permlane32_swap_b32 v227, v235
  v_permlane32_swap_b32 v228, v236
  v_permlane32_swap_b32 v229, v237
  v_permlane32_swap_b32 v230, v238
  v_permlane32_swap_b32 v231, v239
  v_add_f32 v224, v224, v232
  v_add_f32 v225, v225, v233
  v_add_f32 v226, v226, v234
  v_add_f32 v227, v227, v235
  v_add_f32 v228, v228, v236
  v_add_f32 v229, v229, v237
  v_add_f32 v230, v230, v238
  v_add_f32 v231, v231, v239
  v_mov_b32 v232, v224
  v_mov_b32 v233, v225
  v_mov_b32 v234, v226
  v_mov_b32 v235, v227
  v_mov_b32 v236, v228
  v_mov_b32 v237, v229
  v_mov_b32 v238, v230
  v_mov_b32 v239, v231
  v_permlane16_swap_b32 v224, v232
  v_permlane16_swap_b32 v225, v233
  v_permlane16_swap_b32 v226, v234
  v_permlane16_swap_b32 v227, v235
  v_permlane16_swap_b32 v228, v236
  v_permlane16_swap_b32 v229, v237
  v_permlane16_swap_b32 v230, v238
  v_permlane16_swap_b32 v231, v239
  v_add_f32 v224, v224, v232
  v_add_f32 v225, v225, v233
  v_add_f32 v226, v226, v234
  v_add_f32 v227, v227, v235
  v_add_f32 v228, v228, v236
  v_add_f32 v229, v229, v237
  v_add_f32 v230, v230, v238
  v_add_f32 v231, v231, v239
  v_and_b32 v232, 7, v253
  s_lshl_b32 s43, s40, 8
  s_add_u32 s43, s43, 143360
  v_add_f32_dpp v224, v224, v224 row_ror:8 row_mask:0xf bank_mask:0xf
  v_add_f32_dpp v225, v225, v225 row_ror:8 row_mask:0xf bank_mask:0xf
  v_add_f32_dpp v226, v226, v226 row_ror:8 row_mask:0xf bank_mask:0xf
  v_add_f32_dpp v227, v227, v227 row_ror:8 row_mask:0xf bank_mask:0xf
  v_add_f32_dpp v228, v228, v228 row_ror:8 row_mask:0xf bank_mask:0xf
  v_add_f32_dpp v229, v229, v229 row_ror:8 row_mask:0xf bank_mask:0xf
  v_add_f32_dpp v230, v230, v230 row_ror:8 row_mask:0xf bank_mask:0xf
  v_add_f32_dpp v231, v231, v231 row_ror:8 row_mask:0xf bank_mask:0xf
  v_lshl_add_u32 v232, v232, 5, s43
  ds_write_b128 v232, v[224:227]
  ds_write_b128 v232, v[228:231] offset:16
Lsd7:
  s_lshl_b32 s77, s52, 8
  s_add_u32 s77, s77, 27787264
  v_lshlrev_b32 v249, 7, v253
  s_add_u32 s77, s77, s42
  s_cmp_lg_u32 s40, 0
  s_cbranch_scc1 Lpdn9
  s_mov_b32 s43, 0x40000
  s_mov_b64 exec, 3
Lpol8:
  buffer_load_dword v250, v249, s[4:7], s77 offen sc1
  s_waitcnt vmcnt(0)
  v_cmp_gt_u32 vcc, 8, v250
  s_cbranch_vccz Lpdn9x
  s_sub_u32 s43, s43, 1
  s_cmp_lg_u32 s43, 0
  s_cbranch_scc1 Lpol8
Lpdn9x:
  s_mov_b64 exec, -1
Lpdn9:
  s_waitcnt vmcnt(0) lgkmcnt(0)
  s_barrier
  buffer_load_dwordx4 a[0:3], v48, s[4:7], s57 offen offset:0 sc1
  buffer_load_dwordx4 a[4:7], v49, s[4:7], s57 offen offset:0 sc1
  buffer_load_dwordx4 a[8:11], v48, s[4:7], s57 offen offset:1024 sc1
  buffer_load_dwordx4 a[12:15], v49, s[4:7], s57 offen offset:1024 sc1
  buffer_load_dwordx4 a[16:19], v48, s[4:7], s57 offen offset:2048 sc1
  buffer_load_dwordx4 a[20:23], v49, s[4:7], s57 offen offset:2048 sc1
  buffer_load_dwordx4 a[24:27], v48, s[4:7], s57 offen offset:3072 sc1
  buffer_load_dwordx4 a[28:31], v49, s[4:7], s57 offen offset:3072 sc1
  s_add_u32 s57, s57, 4096
  buffer_load_dwordx4 a[32:35], v48, s[4:7], s57 offen offset:0 sc1
  buffer_load_dwordx4 a[36:39], v49, s[4:7], s57 offen offset:0 sc1
  buffer_load_dwordx4 a[40:43], v48, s[4:7], s57 offen offset:1024 sc1
  buffer_load_dwordx4 a[44:47], v49, s[4:7], s57 offen offset:1024 sc1
  s_cmp_eq_u32 s40, 1
  s_cselect_b32 s3, s3, 0
  s_cmp_eq_u32 s3, 0
  s_cbranch_scc1 Lsd10
  v_lshlrev_b32 v232, 2, v253
  v_add_u32 v233, 143360, v232
  ds_read_b32 v234, v233 offset:0
  ds_read_b32 v235, v233 offset:256
  ds_read_b32 v236, v233 offset:512
  ds_read_b32 v237, v233 offset:768
  s_waitcnt lgkmcnt(0)
  v_add_f32 v234, v234, v235
  v_add_f32 v236, v236, v237
  v_add_f32 v234, v234, v236
  buffer_store_dword v234, v232, s[4:7], s101 offen sc1
Lsd10:
  ds_read_b64_tr_b16 a[112:113], v40 offset:0
  ds_read_b64_tr_b16 a[114:115], v40 offset:2048
  ds_read_b64_tr_b16 a[128:129], v40 offset:4096
  ds_read_b64_tr_b16 a[130:131], v40 offset:6144
  ds_read_b64_tr_b16 a[116:117], v41 offset:0
  ds_read_b64_tr_b16 a[118:119], v41 offset:2048
  ds_read_b64_tr_b16 a[132:133], v41 offset:4096
  ds_read_b64_tr_b16 a[134:135], v41 offset:6144
  ds_read_b64_tr_b16 a[120:121], v42 offset:0
  ds_read_b64_tr_b16 a[122:123], v42 offset:2048
  ds_read_b64_tr_b16 a[136:137], v42 offset:4096
  ds_read_b64_tr_b16 a[138:139], v42 offset:6144
  ds_read_b64_tr_b16 a[124:125], v43 offset:0
  ds_read_b64_tr_b16 a[126:127], v43 offset:2048
  ds_read_b64_tr_b16 a[140:141], v43 offset:4096
  ds_read_b64_tr_b16 a[142:143], v43 offset:6144
  s_and_b32 s43, s53, 1
  s_mul_i32 s77, s52, 2
  s_add_u32 s77, s77, s43
  s_lshl_b32 s77, s77, 7
  s_add_u32 s77, s77, s42
  s_add_u32 s77, s77, 27807744
  s_mov_b32 s56, 3
.p2align 3
Lp2_loop:
  s_waitcnt vmcnt(8) lgkmcnt(8)
  v_mfma_f32_16x16x32_bf16 v[0:3], a[112:115], a[0:3], v[0:3]
  ds_read_b64_tr_b16 a[144:145], v40 offset:8192
  v_mfma_f32_16x16x32_bf16 v[0:3], a[128:131], a[8:11], v[0:3]
  ds_read_b64_tr_b16 a[146:147], v40 offset:10240
  buffer_load_dwordx4 a[48:51], v48, s[4:7], s57 offen offset:2048 sc1
  v_mfma_f32_16x16x32_bf16 v[4:7], a[128:131], a[12:15], v[4:7]
  ds_read_b64_tr_b16 a[160:161], v40 offset:12288
  v_mfma_f32_16x16x32_bf16 v[4:7], a[112:115], a[4:7], v[4:7]
  ds_read_b64_tr_b16 a[162:163], v40 offset:14336
  v_mfma_f32_16x16x32_bf16 v[12:15], a[116:119], a[4:7], v[12:15]
  ds_read_b64_tr_b16 a[148:149], v41 offset:8192
  v_mfma_f32_16x16x32_bf16 v[12:15], a[132:135], a[12:15], v[12:15]
  ds_read_b64_tr_b16 a[150:151], v41 offset:10240
  buffer_load_dwordx4 a[52:55], v49, s[4:7], s57 offen offset:2048 sc1
  v_mfma_f32_16x16x32_bf16 v[8:11], a[132:135], a[8:11], v[8:11]
  ds_read_b64_tr_b16 a[164:165], v41 offset:12288
  v_mfma_f32_16x16x32_bf16 v[8:11], a[116:119], a[0:3], v[8:11]
  ds_read_b64_tr_b16 a[166:167], v41 offset:14336
  s_waitcnt lgkmcnt(8)
  v_mfma_f32_16x16x32_bf16 v[16:19], a[120:123], a[0:3], v[16:19]
  ds_read_b64_tr_b16 a[152:153], v42 offset:8192
  v_mfma_f32_16x16x32_bf16 v[16:19], a[136:139], a[8:11], v[16:19]
  ds_read_b64_tr_b16 a[154:155], v42 offset:10240
  buffer_load_dwordx4 a[56:59], v48, s[4:7], s57 offen offset:3072 sc1
  v_mfma_f32_16x16x32_bf16 v[20:23], a[136:139], a[12:15], v[20:23]
  ds_read_b64_tr_b16 a[168:169], v42 offset:12288
  v_mfma_f32_16x16x32_bf16 v[20:23], a[120:123], a[4:7], v[20:23]
  ds_read_b64_tr_b16 a[170:171], v42 offset:14336
  v_mfma_f32_16x16x32_bf16 v[28:31], a[124:127], a[4:7], v[28:31]
  ds_read_b64_tr_b16 a[156:157], v43 offset:8192
  v_mfma_f32_16x16x32_bf16 v[28:31], a[140:143], a[12:15], v[28:31]
  ds_read_b64_tr_b16 a[158:159], v43 offset:10240
  buffer_load_dwordx4 a[60:63], v49, s[4:7], s57 offen offset:3072 sc1
  v_mfma_f32_16x16x32_bf16 v[24:27], a[140:143], a[8:11], v[24:27]
  ds_read_b64_tr_b16 a[172:173], v43 offset:12288
  v_mfma_f32_16x16x32_bf16 v[24:27], a[124:127], a[0:3], v[24:27]
  ds_read_b64_tr_b16 a[174:175], v43 offset:14336
  s_waitcnt vmcnt(8) lgkmcnt(8)
  v_mfma_f32_16x16x32_bf16 v[0:3], a[144:147], a[16:19], v[0:3]
  ds_read_b64_tr_b16 a[112:113], v40 offset:16384
  v_mfma_f32_16x16x32_bf16 v[0:3], a[160:163], a[24:27], v[0:3]
  s_add_u32 s57, s57, 4096
  ds_read_b64_tr_b16 a[114:115], v40 offset:18432
  buffer_load_dwordx4 a[0:3], v48, s[4:7], s57 offen offset:0 sc1
  v_mfma_f32_16x16x32_bf16 v[4:7], a[160:163], a[28:31], v[4:7]
  ds_read_b64_tr_b16 a[128:129], v40 offset:20480
  v_mfma_f32_16x16x32_bf16 v[4:7], a[144:147], a[20:23], v[4:7]
  ds_read_b64_tr_b16 a[130:131], v40 offset:22528
  v_mfma_f32_16x16x32_bf16 v[12:15], a[148:151], a[20:23], v[12:15]
  ds_read_b64_tr_b16 a[116:117], v41 offset:16384
  v_mfma_f32_16x16x32_bf16 v[12:15], a[164:167], a[28:31], v[12:15]
  ds_read_b64_tr_b16 a[118:119], v41 offset:18432
  buffer_load_dwordx4 a[4:7], v49, s[4:7], s57 offen offset:0 sc1
  v_mfma_f32_16x16x32_bf16 v[8:11], a[164:167], a[24:27], v[8:11]
  ds_read_b64_tr_b16 a[132:133], v41 offset:20480
  v_mfma_f32_16x16x32_bf16 v[8:11], a[148:151], a[16:19], v[8:11]
  ds_read_b64_tr_b16 a[134:135], v41 offset:22528
  s_waitcnt lgkmcnt(8)
  v_mfma_f32_16x16x32_bf16 v[16:19], a[152:155], a[16:19], v[16:19]
  ds_read_b64_tr_b16 a[120:121], v42 offset:16384
  v_mfma_f32_16x16x32_bf16 v[16:19], a[168:171], a[24:27], v[16:19]
  ds_read_b64_tr_b16 a[122:123], v42 offset:18432
  buffer_load_dwordx4 a[8:11], v48, s[4:7], s57 offen offset:1024 sc1
  v_mfma_f32_16x16x32_bf16 v[20:23], a[168:171], a[28:31], v[20:23]
  ds_read_b64_tr_b16 a[136:137], v42 offset:20480
  v_mfma_f32_16x16x32_bf16 v[20:23], a[152:155], a[20:23], v[20:23]
  ds_read_b64_tr_b16 a[138:139], v42 offset:22528
  v_mfma_f32_16x16x32_bf16 v[28:31], a[156:159], a[20:23], v[28:31]
  ds_read_b64_tr_b16 a[124:125], v43 offset:16384
  v_mfma_f32_16x16x32_bf16 v[28:31], a[172:175], a[28:31], v[28:31]
  ds_read_b64_tr_b16 a[126:127], v43 offset:18432
  buffer_load_dwordx4 a[12:15], v49, s[4:7], s57 offen offset:1024 sc1
  v_mfma_f32_16x16x32_bf16 v[24:27], a[172:175], a[24:27], v[24:27]
  ds_read_b64_tr_b16 a[140:141], v43 offset:20480
  v_mfma_f32_16x16x32_bf16 v[24:27], a[156:159], a[16:19], v[24:27]
  ds_read_b64_tr_b16 a[142:143], v43 offset:22528
  s_waitcnt vmcnt(8) lgkmcnt(8)
  v_mfma_f32_16x16x32_bf16 v[0:3], a[112:115], a[32:35], v[0:3]
  ds_read_b64_tr_b16 a[144:145], v40 offset:24576
  v_mfma_f32_16x16x32_bf16 v[0:3], a[128:131], a[40:43], v[0:3]
  ds_read_b64_tr_b16 a[146:147], v40 offset:26624
  buffer_load_dwordx4 a[16:19], v48, s[4:7], s57 offen offset:2048 sc1
  v_mfma_f32_16x16x32_bf16 v[4:7], a[128:131], a[44:47], v[4:7]
  ds_read_b64_tr_b16 a[160:161], v40 offset:28672
  v_mfma_f32_16x16x32_bf16 v[4:7], a[112:115], a[36:39], v[4:7]
  ds_read_b64_tr_b16 a[162:163], v40 offset:30720
  v_add_u32 v40, 32768, v40
  v_mfma_f32_16x16x32_bf16 v[12:15], a[116:119], a[36:39], v[12:15]
  ds_read_b64_tr_b16 a[148:149], v41 offset:24576
  v_mfma_f32_16x16x32_bf16 v[12:15], a[132:135], a[44:47], v[12:15]
  ds_read_b64_tr_b16 a[150:151], v41 offset:26624
  buffer_load_dwordx4 a[20:23], v49, s[4:7], s57 offen offset:2048 sc1
  v_mfma_f32_16x16x32_bf16 v[8:11], a[132:135], a[40:43], v[8:11]
  ds_read_b64_tr_b16 a[164:165], v41 offset:28672
  v_mfma_f32_16x16x32_bf16 v[8:11], a[116:119], a[32:35], v[8:11]
  s_waitcnt lgkmcnt(7)
  ds_read_b64_tr_b16 a[166:167], v41 offset:30720
  v_add_u32 v41, 32768, v41
  v_mfma_f32_16x16x32_bf16 v[16:19], a[120:123], a[32:35], v[16:19]
  ds_read_b64_tr_b16 a[152:153], v42 offset:24576
  v_mfma_f32_16x16x32_bf16 v[16:19], a[136:139], a[40:43], v[16:19]
  ds_read_b64_tr_b16 a[154:155], v42 offset:26624
  buffer_load_dwordx4 a[24:27], v48, s[4:7], s57 offen offset:3072 sc1
  v_mfma_f32_16x16x32_bf16 v[20:23], a[136:139], a[44:47], v[20:23]
  ds_read_b64_tr_b16 a[168:169], v42 offset:28672
  v_mfma_f32_16x16x32_bf16 v[20:23], a[120:123], a[36:39], v[20:23]
  ds_read_b64_tr_b16 a[170:171], v42 offset:30720
  v_add_u32 v42, 32768, v42
  v_mfma_f32_16x16x32_bf16 v[28:31], a[124:127], a[36:39], v[28:31]
  ds_read_b64_tr_b16 a[156:157], v43 offset:24576
  v_mfma_f32_16x16x32_bf16 v[28:31], a[140:143], a[44:47], v[28:31]
  ds_read_b64_tr_b16 a[158:159], v43 offset:26624
  buffer_load_dwordx4 a[28:31], v49, s[4:7], s57 offen offset:3072 sc1
  v_mfma_f32_16x16x32_bf16 v[24:27], a[140:143], a[40:43], v[24:27]
  ds_read_b64_tr_b16 a[172:173], v43 offset:28672
  v_mfma_f32_16x16x32_bf16 v[24:27], a[124:127], a[32:35], v[24:27]
  s_waitcnt vmcnt(8) lgkmcnt(7)
  ds_read_b64_tr_b16 a[174:175], v43 offset:30720
  v_add_u32 v43, 32768, v43
  v_mfma_f32_16x16x32_bf16 v[0:3], a[144:147], a[48:51], v[0:3]
  ds_read_b64_tr_b16 a[112:113], v40 offset:0
  v_mfma_f32_16x16x32_bf16 v[0:3], a[160:163], a[56:59], v[0:3]
  s_add_u32 s57, s57, 4096
  ds_read_b64_tr_b16 a[114:115], v40 offset:2048
  buffer_load_dwordx4 a[32:35], v48, s[4:7], s57 offen offset:0 sc1
  v_mfma_f32_16x16x32_bf16 v[4:7], a[160:163], a[60:63], v[4:7]
  ds_read_b64_tr_b16 a[128:129], v40 offset:4096
  v_mfma_f32_16x16x32_bf16 v[4:7], a[144:147], a[52:55], v[4:7]
  ds_read_b64_tr_b16 a[130:131], v40 offset:6144
  v_mfma_f32_16x16x32_bf16 v[12:15], a[148:151], a[52:55], v[12:15]
  ds_read_b64_tr_b16 a[116:117], v41 offset:0
  v_mfma_f32_16x16x32_bf16 v[12:15], a[164:167], a[60:63], v[12:15]
  ds_read_b64_tr_b16 a[118:119], v41 offset:2048
  buffer_load_dwordx4 a[36:39], v49, s[4:7], s57 offen offset:0 sc1
  v_mfma_f32_16x16x32_bf16 v[8:11], a[164:167], a[56:59], v[8:11]
  ds_read_b64_tr_b16 a[132:133], v41 offset:4096
  v_mfma_f32_16x16x32_bf16 v[8:11], a[148:151], a[48:51], v[8:11]
  ds_read_b64_tr_b16 a[134:135], v41 offset:6144
  s_waitcnt lgkmcnt(8)
  v_mfma_f32_16x16x32_bf16 v[16:19], a[152:155], a[48:51], v[16:19]
  ds_read_b64_tr_b16 a[120:121], v42 offset:0
  v_mfma_f32_16x16x32_bf16 v[16:19], a[168:171], a[56:59], v[16:19]
  ds_read_b64_tr_b16 a[122:123], v42 offset:2048
  buffer_load_dwordx4 a[40:43], v48, s[4:7], s57 offen offset:1024 sc1
  v_mfma_f32_16x16x32_bf16 v[20:23], a[168:171], a[60:63], v[20:23]
  ds_read_b64_tr_b16 a[136:137], v42 offset:4096
  v_mfma_f32_16x16x32_bf16 v[20:23], a[152:155], a[52:55], v[20:23]
  ds_read_b64_tr_b16 a[138:139], v42 offset:6144
  v_mfma_f32_16x16x32_bf16 v[28:31], a[156:159], a[52:55], v[28:31]
  ds_read_b64_tr_b16 a[124:125], v43 offset:0
  v_mfma_f32_16x16x32_bf16 v[28:31], a[172:175], a[60:63], v[28:31]
  ds_read_b64_tr_b16 a[126:127], v43 offset:2048
  buffer_load_dwordx4 a[44:47], v49, s[4:7], s57 offen offset:1024 sc1
  v_mfma_f32_16x16x32_bf16 v[24:27], a[172:175], a[56:59], v[24:27]
  ds_read_b64_tr_b16 a[140:141], v43 offset:4096
  v_mfma_f32_16x16x32_bf16 v[24:27], a[156:159], a[48:51], v[24:27]
  s_sub_u32 s56, s56, 1
  ds_read_b64_tr_b16 a[142:143], v43 offset:6144
  s_cmp_lg_u32 s56, 0
  s_cbranch_scc1 Lp2_loop
Lmk_Lp2_loop_tail:
  s_waitcnt vmcnt(8) lgkmcnt(8)
  v_mfma_f32_16x16x32_bf16 v[0:3], a[112:115], a[0:3], v[0:3]
  ds_read_b64_tr_b16 a[144:145], v40 offset:8192
  v_mfma_f32_16x16x32_bf16 v[0:3], a[128:131], a[8:11], v[0:3]
  ds_read_b64_tr_b16 a[146:147], v40 offset:10240
  buffer_load_dwordx4 a[48:51], v48, s[4:7], s57 offen offset:2048 sc1
  v_mfma_f32_16x16x32_bf16 v[4:7], a[128:131], a[12:15], v[4:7]
  ds_read_b64_tr_b16 a[160:161], v40 offset:12288
  v_mfma_f32_16x16x32_bf16 v[4:7], a[112:115], a[4:7], v[4:7]
  ds_read_b64_tr_b16 a[162:163], v40 offset:14336
  v_mfma_f32_16x16x32_bf16 v[12:15], a[116:119], a[4:7], v[12:15]
  ds_read_b64_tr_b16 a[148:149], v41 offset:8192
  v_mfma_f32_16x16x32_bf16 v[12:15], a[132:135], a[12:15], v[12:15]
  ds_read_b64_tr_b16 a[150:151], v41 offset:10240
  buffer_load_dwordx4 a[52:55], v49, s[4:7], s57 offen offset:2048 sc1
  v_mfma_f32_16x16x32_bf16 v[8:11], a[132:135], a[8:11], v[8:11]
  ds_read_b64_tr_b16 a[164:165], v41 offset:12288
  v_mfma_f32_16x16x32_bf16 v[8:11], a[116:119], a[0:3], v[8:11]
  ds_read_b64_tr_b16 a[166:167], v41 offset:14336
  s_waitcnt lgkmcnt(8)
  v_mfma_f32_16x16x32_bf16 v[16:19], a[120:123], a[0:3], v[16:19]
  ds_read_b64_tr_b16 a[152:153], v42 offset:8192
  v_mfma_f32_16x16x32_bf16 v[16:19], a[136:139], a[8:11], v[16:19]
  ds_read_b64_tr_b16 a[154:155], v42 offset:10240
  buffer_load_dwordx4 a[56:59], v48, s[4:7], s57 offen offset:3072 sc1
  v_mfma_f32_16x16x32_bf16 v[20:23], a[136:139], a[12:15], v[20:23]
  ds_read_b64_tr_b16 a[168:169], v42 offset:12288
  v_mfma_f32_16x16x32_bf16 v[20:23], a[120:123], a[4:7], v[20:23]
  ds_read_b64_tr_b16 a[170:171], v42 offset:14336
  v_mfma_f32_16x16x32_bf16 v[28:31], a[124:127], a[4:7], v[28:31]
  ds_read_b64_tr_b16 a[156:157], v43 offset:8192
  v_mfma_f32_16x16x32_bf16 v[28:31], a[140:143], a[12:15], v[28:31]
  ds_read_b64_tr_b16 a[158:159], v43 offset:10240
  buffer_load_dwordx4 a[60:63], v49, s[4:7], s57 offen offset:3072 sc1
  v_mfma_f32_16x16x32_bf16 v[24:27], a[140:143], a[8:11], v[24:27]
  ds_read_b64_tr_b16 a[172:173], v43 offset:12288
  v_mfma_f32_16x16x32_bf16 v[24:27], a[124:127], a[0:3], v[24:27]
  ds_read_b64_tr_b16 a[174:175], v43 offset:14336
  s_waitcnt vmcnt(8) lgkmcnt(8)
  v_mfma_f32_16x16x32_bf16 v[0:3], a[144:147], a[16:19], v[0:3]
  ds_read_b64_tr_b16 a[112:113], v40 offset:16384
  v_mfma_f32_16x16x32_bf16 v[0:3], a[160:163], a[24:27], v[0:3]
  ds_read_b64_tr_b16 a[114:115], v40 offset:18432
  v_mfma_f32_16x16x32_bf16 v[4:7], a[160:163], a[28:31], v[4:7]
  ds_read_b64_tr_b16 a[128:129], v40 offset:20480
  v_mfma_f32_16x16x32_bf16 v[4:7], a[144:147], a[20:23], v[4:7]
  ds_read_b64_tr_b16 a[130:131], v40 offset:22528
  v_mfma_f32_16x16x32_bf16 v[12:15], a[148:151], a[20:23], v[12:15]
  ds_read_b64_tr_b16 a[116:117], v41 offset:16384
  v_mfma_f32_16x16x32_bf16 v[12:15], a[164:167], a[28:31], v[12:15]
  ds_read_b64_tr_b16 a[118:119], v41 offset:18432
  v_mfma_f32_16x16x32_bf16 v[8:11], a[164:167], a[24:27], v[8:11]
  ds_read_b64_tr_b16 a[132:133], v41 offset:20480
  v_mfma_f32_16x16x32_bf16 v[8:11], a[148:151], a[16:19], v[8:11]
  ds_read_b64_tr_b16 a[134:135], v41 offset:22528
  s_waitcnt lgkmcnt(8)
  v_mfma_f32_16x16x32_bf16 v[16:19], a[152:155], a[16:19], v[16:19]
  ds_read_b64_tr_b16 a[120:121], v42 offset:16384
  v_mfma_f32_16x16x32_bf16 v[16:19], a[168:171], a[24:27], v[16:19]
  ds_read_b64_tr_b16 a[122:123], v42 offset:18432
  v_mfma_f32_16x16x32_bf16 v[20:23], a[168:171], a[28:31], v[20:23]
  ds_read_b64_tr_b16 a[136:137], v42 offset:20480
  v_mfma_f32_16x16x32_bf16 v[20:23], a[152:155], a[20:23], v[20:23]
  ds_read_b64_tr_b16 a[138:139], v42 offset:22528
  v_mfma_f32_16x16x32_bf16 v[28:31], a[156:159], a[20:23], v[28:31]
  ds_read_b64_tr_b16 a[124:125], v43 offset:16384
  v_mfma_f32_16x16x32_bf16 v[28:31], a[172:175], a[28:31], v[28:31]
  ds_read_b64_tr_b16 a[126:127], v43 offset:18432
  v_mfma_f32_16x16x32_bf16 v[24:27], a[172:175], a[24:27], v[24:27]
  ds_read_b64_tr_b16 a[140:141], v43 offset:20480
  v_mfma_f32_16x16x32_bf16 v[24:27], a[156:159], a[16:19], v[24:27]
  ds_read_b64_tr_b16 a[142:143], v43 offset:22528
  s_waitcnt vmcnt(4) lgkmcnt(8)
  v_mfma_f32_16x16x32_bf16 v[0:3], a[112:115], a[32:35], v[0:3]
  ds_read_b64_tr_b16 a[144:145], v40 offset:24576
  v_mfma_f32_16x16x32_bf16 v[0:3], a[128:131], a[40:43], v[0:3]
  ds_read_b64_tr_b16 a[146:147], v40 offset:26624
  v_mfma_f32_16x16x32_bf16 v[4:7], a[128:131], a[44:47], v[4:7]
  ds_read_b64_tr_b16 a[160:161], v40 offset:28672
  v_mfma_f32_16x16x32_bf16 v[4:7], a[112:115], a[36:39], v[4:7]
  ds_read_b64_tr_b16 a[162:163], v40 offset:30720
  v_add_u32 v40, 32768, v40
  v_mfma_f32_16x16x32_bf16 v[12:15], a[116:119], a[36:39], v[12:15]
  ds_read_b64_tr_b16 a[148:149], v41 offset:24576
  v_mfma_f32_16x16x32_bf16 v[12:15], a[132:135], a[44:47], v[12:15]
  ds_read_b64_tr_b16 a[150:151], v41 offset:26624
  v_mfma_f32_16x16x32_bf16 v[8:11], a[132:135], a[40:43], v[8:11]
  ds_read_b64_tr_b16 a[164:165], v41 offset:28672
  v_mfma_f32_16x16x32_bf16 v[8:11], a[116:119], a[32:35], v[8:11]
  s_waitcnt lgkmcnt(7)
  ds_read_b64_tr_b16 a[166:167], v41 offset:30720
  v_add_u32 v41, 32768, v41
  v_mfma_f32_16x16x32_bf16 v[16:19], a[120:123], a[32:35], v[16:19]
  ds_read_b64_tr_b16 a[152:153], v42 offset:24576
  v_mfma_f32_16x16x32_bf16 v[16:19], a[136:139], a[40:43], v[16:19]
  ds_read_b64_tr_b16 a[154:155], v42 offset:26624
  v_mfma_f32_16x16x32_bf16 v[20:23], a[136:139], a[44:47], v[20:23]
  ds_read_b64_tr_b16 a[168:169], v42 offset:28672
  v_mfma_f32_16x16x32_bf16 v[20:23], a[120:123], a[36:39], v[20:23]
  ds_read_b64_tr_b16 a[170:171], v42 offset:30720
  v_add_u32 v42, 32768, v42
  v_mfma_f32_16x16x32_bf16 v[28:31], a[124:127], a[36:39], v[28:31]
  ds_read_b64_tr_b16 a[156:157], v43 offset:24576
  v_mfma_f32_16x16x32_bf16 v[28:31], a[140:143], a[44:47], v[28:31]
  ds_read_b64_tr_b16 a[158:159], v43 offset:26624
  v_mfma_f32_16x16x32_bf16 v[24:27], a[140:143], a[40:43], v[24:27]
  ds_read_b64_tr_b16 a[172:173], v43 offset:28672
  v_mfma_f32_16x16x32_bf16 v[24:27], a[124:127], a[32:35], v[24:27]
  s_waitcnt vmcnt(0) lgkmcnt(7)
  ds_read_b64_tr_b16 a[174:175], v43 offset:30720
  v_add_u32 v43, 32768, v43
  v_mfma_f32_16x16x32_bf16 v[0:3], a[144:147], a[48:51], v[0:3]
  v_mfma_f32_16x16x32_bf16 v[0:3], a[160:163], a[56:59], v[0:3]
  v_mfma_f32_16x16x32_bf16 v[4:7], a[160:163], a[60:63], v[4:7]
  v_mfma_f32_16x16x32_bf16 v[4:7], a[144:147], a[52:55], v[4:7]
  v_mfma_f32_16x16x32_bf16 v[12:15], a[148:151], a[52:55], v[12:15]
  v_mfma_f32_16x16x32_bf16 v[12:15], a[164:167], a[60:63], v[12:15]
  v_mfma_f32_16x16x32_bf16 v[8:11], a[164:167], a[56:59], v[8:11]
  v_mfma_f32_16x16x32_bf16 v[8:11], a[148:151], a[48:51], v[8:11]
  s_waitcnt lgkmcnt(0)
  v_mfma_f32_16x16x32_bf16 v[16:19], a[152:155], a[48:51], v[16:19]
  s_nop 0
  v_mfma_f32_16x16x32_bf16 v[16:19], a[168:171], a[56:59], v[16:19]
  s_nop 0
  v_mfma_f32_16x16x32_bf16 v[20:23], a[168:171], a[60:63], v[20:23]
  s_nop 0
  v_mfma_f32_16x16x32_bf16 v[20:23], a[152:155], a[52:55], v[20:23]
  v_cvt_pk_bf16_f32 v60, v4, v5
  v_cvt_pk_bf16_f32 v61, v6, v7
  v_mfma_f32_16x16x32_bf16 v[28:31], a[156:159], a[52:55], v[28:31]
  v_cvt_pk_bf16_f32 v62, v12, v13
  v_cvt_pk_bf16_f32 v63, v14, v15
  v_mfma_f32_16x16x32_bf16 v[28:31], a[172:175], a[60:63], v[28:31]
  buffer_store_dwordx4 v[60:63], v48, s[4:7], s59 offen offset:0 sc1
  v_cvt_pk_bf16_f32 v52, v0, v1
  v_mfma_f32_16x16x32_bf16 v[24:27], a[172:175], a[56:59], v[24:27]
  v_cvt_pk_bf16_f32 v53, v2, v3
  v_cvt_pk_bf16_f32 v54, v8, v9
  v_mfma_f32_16x16x32_bf16 v[24:27], a[156:159], a[48:51], v[24:27]
  v_cvt_pk_bf16_f32 v55, v10, v11
  buffer_store_dwordx4 v[52:55], v48, s[4:7], s58 offen offset:0 sc1
  v_mfma_f32_16x16x32_bf16 v[88:91], v[60:63], v[60:63], 0
  v_mfma_f32_16x16x32_bf16 v[84:87], v[72:75], v[60:63], 0
  v_mfma_f32_16x16x32_bf16 v[80:83], v[52:55], v[52:55], 0
  v_mfma_f32_16x16x32_bf16 v[76:79], v[72:75], v[52:55], 0
  v_cvt_pk_bf16_f32 v64, v20, v21
  v_cvt_pk_bf16_f32 v65, v22, v23
  v_cvt_pk_bf16_f32 v66, v28, v29
  v_cvt_pk_bf16_f32 v67, v30, v31
  buffer_store_dwordx4 v[64:67], v48, s[4:7], s59 offen offset:1024 sc1
  v_cvt_pk_bf16_f32 v56, v16, v17
  v_cvt_pk_bf16_f32 v57, v18, v19
  v_cvt_pk_bf16_f32 v58, v24, v25
  v_cvt_pk_bf16_f32 v59, v26, v27
  buffer_store_dwordx4 v[56:59], v48, s[4:7], s58 offen offset:1024 sc1
  s_nop 0
  v_mfma_f32_16x16x32_bf16 v[88:91], v[64:67], v[64:67], v[88:91]
  v_mfma_f32_16x16x32_bf16 v[84:87], v[72:75], v[64:67], v[84:87]
  v_mfma_f32_16x16x32_bf16 v[80:83], v[56:59], v[56:59], v[80:83]
  v_mfma_f32_16x16x32_bf16 v[76:79], v[72:75], v[56:59], v[76:79]
  s_nop 5
  v_cndmask_b32 v85, v88, v89, s[64:65]
  v_cndmask_b32 v85, v85, v90, s[66:67]
  v_cndmask_b32 v85, v85, v91, s[68:69]
  buffer_store_dwordx2 v[84:85], v92, s[4:7], s60 offen offset:2048 sc1
  v_cndmask_b32 v77, v80, v81, s[64:65]
  v_cndmask_b32 v77, v77, v82, s[66:67]
  v_cndmask_b32 v77, v77, v83, s[68:69]
  buffer_store_dwordx2 v[76:77], v92, s[4:7], s60 offen offset:0 sc1
  s_and_b32 s66, s55, 1
  v_lshrrev_b32 v2, 4, v253
  v_bfe_u32 v3, v253, 1, 3
  v_and_b32 v4, 1, v253
  v_lshlrev_b32 v4, 4, v4
  v_mul_u32_u24 v5, 7168, v2
  v_add_u32 v5, v5, v4
  s_cmp_eq_u32 s66, 0
  s_cselect_b32 s44, 7, 0
  v_mov_b32 v7, 0x40000000
  v_add_u32 v6, 0, v2
  v_xor_b32 v6, v6, v3
  v_cmp_eq_u32 vcc, s44, v6
  v_lshl_add_u32 v6, v6, 5, v5
  v_add_u32 v6, 0, v6
  v_cndmask_b32 v232, v6, v7, vcc
  v_add_u32 v6, 4, v2
  v_xor_b32 v6, v6, v3
  v_cmp_eq_u32 vcc, s44, v6
  v_lshl_add_u32 v6, v6, 5, v5
  v_add_u32 v6, 27648, v6
  v_cndmask_b32 v233, v6, v7, vcc
  v_add_u32 v6, 0, v2
  v_xor_b32 v6, v6, v3
  v_cmp_eq_u32 vcc, s44, v6
  v_lshl_add_u32 v6, v6, 5, v5
  v_add_u32 v6, 55296, v6
  v_cndmask_b32 v234, v6, v7, vcc
  v_add_u32 v6, 4, v2
  v_xor_b32 v6, v6, v3
  v_cmp_eq_u32 vcc, s44, v6
  v_lshl_add_u32 v6, v6, 5, v5
  v_add_u32 v6, 82944, v6
  v_cndmask_b32 v235, v6, v7, vcc
  s_mul_i32 s67, s55, 224
  s_and_b32 s67, s67, 0xffffffc0
  s_mul_i32 s43, s40, 114688
  s_add_u32 s67, s67, s43
  s_lshl_b32 s68, s40, 12
  v_lshlrev_b32 v231, 4, v253
  s_lshl_b32 s43, s41, 30
  v_or_b32 v236, s43, v231
  s_lshl_b32 s43, s2, 2
  s_add_u32 s43, s43, s40
  s_mul_i32 s70, s43, 7168
  s_lshl_b32 s69, s54, 2
  s_add_u32 s69, s69, s40
  s_lshl_b32 s72, s69, 17
  s_add_u32 s72, s72, s42
  s_add_u32 s72, s72, 4194304
  s_add_u32 s73, s72, 32768
  s_add_u32 s74, s73, 32768
  s_add_u32 s75, s74, 32768
  s_lshl_b32 s71, s40, 11
  s_add_u32 s71, s71, 131072
  v_lshrrev_b32 v2, 2, v253
  v_and_b32 v3, 7, v2
  v_and_b32 v4, 3, v253
  v_lshlrev_b32 v5, 3, v4
  v_lshl_add_u32 v5, v2, 8, v5
  s_lshl_b32 s43, s66, 1
  s_cmp_eq_u32 s66, 0
  s_cselect_b32 s45, 6, 1
  s_add_u32 s46, s43, 0
  v_xor_b32 v6, s46, v3
  v_lshl_add_u32 v224, v6, 5, v5
  s_add_u32 s46, s43, 1
  v_xor_b32 v6, s46, v3
  v_lshl_add_u32 v225, v6, 5, v5
  s_add_u32 s46, s43, 2
  v_xor_b32 v6, s46, v3
  v_lshl_add_u32 v226, v6, 5, v5
  s_add_u32 s46, s43, 3
  v_xor_b32 v6, s46, v3
  v_lshl_add_u32 v227, v6, 5, v5
  s_add_u32 s46, s43, 4
  v_xor_b32 v6, s46, v3
  v_lshl_add_u32 v228, v6, 5, v5
  s_add_u32 s46, s43, 5
  v_xor_b32 v6, s46, v3
  v_lshl_add_u32 v229, v6, 5, v5
  v_xor_b32 v6, s45, v3
  v_lshl_add_u32 v230, v6, 5, v5
  s_mul_i32 s46, s55, 448
  s_add_u32 s46, s46, 27918336
  s_add_u32 s47, s46, 28672
  s_lshr_b32 s48, s55, 3
  s_lshl_b32 s48, s48, 7
  s_add_u32 s48, s48, 27794432
  s_lshl_b32 s44, s69, 13
  s_add_u32 s44, s44, s42
  s_add_u32 s44, s44, 27525120
  s_add_u32 s45, s44, 4096
  s_waitcnt vmcnt(0)
  s_barrier
  s_cmp_lg_u32 s40, 0
  s_cbranch_scc1 Lsig11
  v_mov_b32 v250, 1
  s_mov_b64 exec, 1
  buffer_atomic_add v250, v251, s[4:7], s77 offen sc1
  s_mov_b64 exec, -1
Lsig11:
  s_cmp_eq_u32 s3, 0
  s_cbranch_scc1 Lsd12
  s_bfe_u32 s43, s2, 0x20001
  s_lshl_b32 s43, s43, 7
  s_add_u32 s43, s43, 27794432
  v_mov_b32 v250, 1
  s_mov_b64 exec, 1
  buffer_atomic_add v250, v251, s[4:7], s43 offen sc1
  s_mov_b64 exec, -1
Lsd12:
  s_add_u32 m0, s68, 0
  s_nop 0
  buffer_load_dwordx4 v232, s[16:19], s67 offen offset:0  lds
  buffer_load_dwordx4 v233, s[16:19], s67 offen offset:1024  lds
  buffer_load_dwordx4 v234, s[16:19], s67 offen offset:2048  lds
  buffer_load_dwordx4 v235, s[16:19], s67 offen offset:3072  lds
  s_add_u32 m0, s68, 16384
  s_nop 0
  buffer_load_dwordx4 v232, s[20:23], s67 offen offset:0  lds
  buffer_load_dwordx4 v233, s[20:23], s67 offen offset:1024  lds
  buffer_load_dwordx4 v234, s[20:23], s67 offen offset:2048  lds
  buffer_load_dwordx4 v235, s[20:23], s67 offen offset:3072  lds
  s_add_u32 s67, s67, 458752
  s_add_u32 m0, s68, 32768
  s_nop 0
  buffer_load_dwordx4 v232, s[16:19], s67 offen offset:0  lds
  buffer_load_dwordx4 v233, s[16:19], s67 offen offset:1024  lds
  buffer_load_dwordx4 v234, s[16:19], s67 offen offset:2048  lds
  buffer_load_dwordx4 v235, s[16:19], s67 offen offset:3072  lds
  s_add_u32 m0, s68, 49152
  s_nop 0
  buffer_load_dwordx4 v232, s[20:23], s67 offen offset:0  lds
  buffer_load_dwordx4 v233, s[20:23], s67 offen offset:1024  lds
  buffer_load_dwordx4 v234, s[20:23], s67 offen offset:2048  lds
  buffer_load_dwordx4 v235, s[20:23], s67 offen offset:3072  lds
  s_add_u32 s67, s67, 458752
  s_xor_b32 s68, s68, 0x10000
  s_mul_i32 s77, s54, 512
  s_add_u32 s77, s77, s42
  s_add_u32 s77, s77, 27807744
  v_lshlrev_b32 v249, 7, v253
  s_cmp_lg_u32 s40, 0
  s_cbranch_scc1 Lpdn14
  s_mov_b32 s43, 0x40000
  s_mov_b64 exec, 15
Lpol13:
  buffer_load_dword v250, v249, s[4:7], s77 offen sc1
  s_waitcnt vmcnt(0)
  v_cmp_gt_u32 vcc, 8, v250
  s_cbranch_vccz Lpdn14x
  s_sub_u32 s43, s43, 1
  s_cmp_lg_u32 s43, 0
  s_cbranch_scc1 Lpol13
Lpdn14x:
  s_mov_b64 exec, -1
Lpdn14:
  s_waitcnt vmcnt(0) lgkmcnt(0)
  s_barrier
  buffer_load_dwordx4 a[0:3], v231, s[4:7], s72 offen offset:0 sc1
  buffer_load_dwordx4 a[16:19], v231, s[4:7], s72 offen offset:1024 sc1
  buffer_load_dwordx4 a[4:7], v231, s[4:7], s73 offen offset:0 sc1
  buffer_load_dwordx4 a[20:23], v231, s[4:7], s73 offen offset:1024 sc1
  buffer_load_dwordx4 a[8:11], v231, s[4:7], s74 offen offset:0 sc1
  buffer_load_dwordx4 a[24:27], v231, s[4:7], s74 offen offset:1024 sc1
  buffer_load_dwordx4 a[12:15], v231, s[4:7], s75 offen offset:0 sc1
  buffer_load_dwordx4 a[28:31], v231, s[4:7], s75 offen offset:1024 sc1
  ds_read_b64_tr_b16 a[64:65], v224 offset:0
  ds_read_b64_tr_b16 a[66:67], v224 offset:4096
  ds_read_b64_tr_b16 a[68:69], v224 offset:8192
  ds_read_b64_tr_b16 a[70:71], v224 offset:12288
  ds_read_b64_tr_b16 a[72:73], v224 offset:16384
  ds_read_b64_tr_b16 a[74:75], v224 offset:20480
  ds_read_b64_tr_b16 a[76:77], v224 offset:24576
  ds_read_b64_tr_b16 a[78:79], v224 offset:28672
Lmk_p3s0:
  s_waitcnt vmcnt(6) lgkmcnt(4)
  v_mfma_f32_16x16x32_bf16 v[0:3], a[64:67], a[0:3], 0
  ds_read_b64_tr_b16 a[80:81], v225 offset:0
  v_mfma_f32_16x16x32_bf16 v[0:3], a[68:71], a[16:19], v[0:3]
  s_waitcnt vmcnt(4)
  v_mfma_f32_16x16x32_bf16 v[4:7], a[68:71], a[20:23], 0
  ds_read_b64_tr_b16 a[82:83], v225 offset:4096
  v_mfma_f32_16x16x32_bf16 v[4:7], a[64:67], a[4:7], v[4:7]
  s_waitcnt vmcnt(2)
  v_mfma_f32_16x16x32_bf16 v[8:11], a[64:67], a[8:11], 0
  ds_read_b64_tr_b16 a[84:85], v225 offset:8192
  v_mfma_f32_16x16x32_bf16 v[8:11], a[68:71], a[24:27], v[8:11]
  s_waitcnt vmcnt(0)
  v_mfma_f32_16x16x32_bf16 v[12:15], a[68:71], a[28:31], 0
  ds_read_b64_tr_b16 a[86:87], v225 offset:12288
  v_mfma_f32_16x16x32_bf16 v[12:15], a[64:67], a[12:15], v[12:15]
  s_waitcnt lgkmcnt(4)
  v_mfma_f32_16x16x32_bf16 v[28:31], a[72:75], a[12:15], 0
  ds_read_b64_tr_b16 a[88:89], v225 offset:16384
  v_mfma_f32_16x16x32_bf16 v[28:31], a[76:79], a[28:31], v[28:31]
  buffer_load_dwordx4 a[32:35], v231, s[4:7], s72 offen offset:2048 sc1
  v_mfma_f32_16x16x32_bf16 v[24:27], a[76:79], a[24:27], 0
  ds_read_b64_tr_b16 a[90:91], v225 offset:20480
  v_mfma_f32_16x16x32_bf16 v[24:27], a[72:75], a[8:11], v[24:27]
  v_mfma_f32_16x16x32_bf16 v[20:23], a[72:75], a[4:7], 0
  ds_read_b64_tr_b16 a[92:93], v225 offset:24576
  v_mfma_f32_16x16x32_bf16 v[20:23], a[76:79], a[20:23], v[20:23]
  buffer_load_dwordx4 a[48:51], v231, s[4:7], s72 offen offset:3072 sc1
  v_mfma_f32_16x16x32_bf16 v[16:19], a[76:79], a[16:19], 0
  ds_read_b64_tr_b16 a[94:95], v225 offset:28672
  s_add_u32 s72, s72, 4096
  v_mfma_f32_16x16x32_bf16 v[16:19], a[72:75], a[0:3], v[16:19]
  s_waitcnt lgkmcnt(4)
  v_mfma_f32_16x16x32_bf16 v[32:35], a[80:83], a[0:3], 0
  ds_read_b64_tr_b16 a[64:65], v226 offset:0
  v_mfma_f32_16x16x32_bf16 v[32:35], a[84:87], a[16:19], v[32:35]
  buffer_load_dwordx4 a[36:39], v231, s[4:7], s73 offen offset:2048 sc1
  v_mfma_f32_16x16x32_bf16 v[36:39], a[84:87], a[20:23], 0
  ds_read_b64_tr_b16 a[66:67], v226 offset:4096
  v_mfma_f32_16x16x32_bf16 v[36:39], a[80:83], a[4:7], v[36:39]
  v_mfma_f32_16x16x32_bf16 v[40:43], a[80:83], a[8:11], 0
  ds_read_b64_tr_b16 a[68:69], v226 offset:8192
  v_mfma_f32_16x16x32_bf16 v[40:43], a[84:87], a[24:27], v[40:43]
  buffer_load_dwordx4 a[52:55], v231, s[4:7], s73 offen offset:3072 sc1
  v_mfma_f32_16x16x32_bf16 v[44:47], a[84:87], a[28:31], 0
  ds_read_b64_tr_b16 a[70:71], v226 offset:12288
  s_add_u32 s73, s73, 4096
  v_mfma_f32_16x16x32_bf16 v[44:47], a[80:83], a[12:15], v[44:47]
  s_waitcnt lgkmcnt(4)
  v_mfma_f32_16x16x32_bf16 v[60:63], a[88:91], a[12:15], 0
  ds_read_b64_tr_b16 a[72:73], v226 offset:16384
  v_mfma_f32_16x16x32_bf16 v[60:63], a[92:95], a[28:31], v[60:63]
  buffer_load_dwordx4 a[40:43], v231, s[4:7], s74 offen offset:2048 sc1
  v_mfma_f32_16x16x32_bf16 v[56:59], a[92:95], a[24:27], 0
  ds_read_b64_tr_b16 a[74:75], v226 offset:20480
  v_mfma_f32_16x16x32_bf16 v[56:59], a[88:91], a[8:11], v[56:59]
  v_mfma_f32_16x16x32_bf16 v[52:55], a[88:91], a[4:7], 0
  ds_read_b64_tr_b16 a[76:77], v226 offset:24576
  v_mfma_f32_16x16x32_bf16 v[52:55], a[92:95], a[20:23], v[52:55]
  buffer_load_dwordx4 a[56:59], v231, s[4:7], s74 offen offset:3072 sc1
  v_mfma_f32_16x16x32_bf16 v[48:51], a[92:95], a[16:19], 0
  ds_read_b64_tr_b16 a[78:79], v226 offset:28672
  s_add_u32 s74, s74, 4096
  v_mfma_f32_16x16x32_bf16 v[48:51], a[88:91], a[0:3], v[48:51]
  s_waitcnt lgkmcnt(4)
  v_mfma_f32_16x16x32_bf16 v[64:67], a[64:67], a[0:3], 0
  ds_read_b64_tr_b16 a[80:81], v227 offset:0
  v_mfma_f32_16x16x32_bf16 v[64:67], a[68:71], a[16:19], v[64:67]
  buffer_load_dwordx4 a[44:47], v231, s[4:7], s75 offen offset:2048 sc1
  v_mfma_f32_16x16x32_bf16 v[68:71], a[68:71], a[20:23], 0
  ds_read_b64_tr_b16 a[82:83], v227 offset:4096
  v_mfma_f32_16x16x32_bf16 v[68:71], a[64:67], a[4:7], v[68:71]
  v_mfma_f32_16x16x32_bf16 v[72:75], a[64:67], a[8:11], 0
  ds_read_b64_tr_b16 a[84:85], v227 offset:8192
  v_mfma_f32_16x16x32_bf16 v[72:75], a[68:71], a[24:27], v[72:75]
  buffer_load_dwordx4 a[60:63], v231, s[4:7], s75 offen offset:3072 sc1
  v_mfma_f32_16x16x32_bf16 v[76:79], a[68:71], a[28:31], 0
  ds_read_b64_tr_b16 a[86:87], v227 offset:12288
  s_add_u32 s75, s75, 4096
  v_mfma_f32_16x16x32_bf16 v[76:79], a[64:67], a[12:15], v[76:79]
  s_waitcnt lgkmcnt(4)
  v_mfma_f32_16x16x32_bf16 v[92:95], a[72:75], a[12:15], 0
  ds_read_b64_tr_b16 a[88:89], v227 offset:16384
  s_add_u32 m0, s68, 32768
  v_mfma_f32_16x16x32_bf16 v[92:95], a[76:79], a[28:31], v[92:95]
  buffer_load_dwordx4 v231, s[4:7], s44 offen offset:0 sc1 lds
  v_mfma_f32_16x16x32_bf16 v[88:91], a[76:79], a[24:27], 0
  ds_read_b64_tr_b16 a[90:91], v227 offset:20480
  v_mfma_f32_16x16x32_bf16 v[88:91], a[72:75], a[8:11], v[88:91]
  v_mfma_f32_16x16x32_bf16 v[84:87], a[72:75], a[4:7], 0
  ds_read_b64_tr_b16 a[92:93], v227 offset:24576
  v_mfma_f32_16x16x32_bf16 v[84:87], a[76:79], a[20:23], v[84:87]
  buffer_load_dwordx4 v231, s[4:7], s44 offen offset:1024 sc1 lds
  v_mfma_f32_16x16x32_bf16 v[80:83], a[76:79], a[16:19], 0
  ds_read_b64_tr_b16 a[94:95], v227 offset:28672
  v_mfma_f32_16x16x32_bf16 v[80:83], a[72:75], a[0:3], v[80:83]
  s_waitcnt lgkmcnt(4)
  v_mfma_f32_16x16x32_bf16 v[96:99], a[80:83], a[0:3], 0
  ds_read_b64_tr_b16 a[64:65], v228 offset:0
  v_mfma_f32_16x16x32_bf16 v[96:99], a[84:87], a[16:19], v[96:99]
  buffer_load_dwordx4 v231, s[4:7], s44 offen offset:2048 sc1 lds
  v_mfma_f32_16x16x32_bf16 v[100:103], a[84:87], a[20:23], 0
  ds_read_b64_tr_b16 a[66:67], v228 offset:4096
  v_mfma_f32_16x16x32_bf16 v[100:103], a[80:83], a[4:7], v[100:103]
  v_mfma_f32_16x16x32_bf16 v[104:107], a[80:83], a[8:11], 0
  ds_read_b64_tr_b16 a[68:69], v228 offset:8192
  v_mfma_f32_16x16x32_bf16 v[104:107], a[84:87], a[24:27], v[104:107]
  buffer_load_dwordx4 v231, s[4:7], s44 offen offset:3072 sc1 lds
  v_mfma_f32_16x16x32_bf16 v[108:111], a[84:87], a[28:31], 0
  ds_read_b64_tr_b16 a[70:71], v228 offset:12288
  v_mfma_f32_16x16x32_bf16 v[108:111], a[80:83], a[12:15], v[108:111]
  s_waitcnt lgkmcnt(4)
  v_mfma_f32_16x16x32_bf16 v[124:127], a[88:91], a[12:15], 0
  ds_read_b64_tr_b16 a[72:73], v228 offset:16384
  s_add_u32 m0, s68, 49152
  v_mfma_f32_16x16x32_bf16 v[124:127], a[92:95], a[28:31], v[124:127]
  buffer_load_dwordx4 v231, s[4:7], s45 offen offset:0 sc1 lds
  v_mfma_f32_16x16x32_bf16 v[120:123], a[92:95], a[24:27], 0
  ds_read_b64_tr_b16 a[74:75], v228 offset:20480
  v_mfma_f32_16x16x32_bf16 v[120:123], a[88:91], a[8:11], v[120:123]
  v_mfma_f32_16x16x32_bf16 v[116:119], a[88:91], a[4:7], 0
  ds_read_b64_tr_b16 a[76:77], v228 offset:24576
  v_mfma_f32_16x16x32_bf16 v[116:119], a[92:95], a[20:23], v[116:119]
  buffer_load_dwordx4 v231, s[4:7], s45 offen offset:1024 sc1 lds
  v_mfma_f32_16x16x32_bf16 v[112:115], a[92:95], a[16:19], 0
  ds_read_b64_tr_b16 a[78:79], v228 offset:28672
  v_mfma_f32_16x16x32_bf16 v[112:115], a[88:91], a[0:3], v[112:115]
  s_waitcnt lgkmcnt(4)
  v_mfma_f32_16x16x32_bf16 v[128:131], a[64:67], a[0:3], 0
  ds_read_b64_tr_b16 a[80:81], v229 offset:0
  v_mfma_f32_16x16x32_bf16 v[128:131], a[68:71], a[16:19], v[128:131]
  buffer_load_dwordx4 v231, s[4:7], s45 offen offset:2048 sc1 lds
  v_mfma_f32_16x16x32_bf16 v[132:135], a[68:71], a[20:23], 0
  ds_read_b64_tr_b16 a[82:83], v229 offset:4096
  v_mfma_f32_16x16x32_bf16 v[132:135], a[64:67], a[4:7], v[132:135]
  v_mfma_f32_16x16x32_bf16 v[136:139], a[64:67], a[8:11], 0
  ds_read_b64_tr_b16 a[84:85], v229 offset:8192
  v_mfma_f32_16x16x32_bf16 v[136:139], a[68:71], a[24:27], v[136:139]
  buffer_load_dwordx4 v231, s[4:7], s45 offen offset:3072 sc1 lds
  v_mfma_f32_16x16x32_bf16 v[140:143], a[68:71], a[28:31], 0
  ds_read_b64_tr_b16 a[86:87], v229 offset:12288
  v_mfma_f32_16x16x32_bf16 v[140:143], a[64:67], a[12:15], v[140:143]
  s_waitcnt lgkmcnt(4)
  v_mfma_f32_16x16x32_bf16 v[156:159], a[72:75], a[12:15], 0
  ds_read_b64_tr_b16 a[88:89], v229 offset:16384
  v_mfma_f32_16x16x32_bf16 v[156:159], a[76:79], a[28:31], v[156:159]
  v_mfma_f32_16x16x32_bf16 v[152:155], a[76:79], a[24:27], 0
  ds_read_b64_tr_b16 a[90:91], v229 offset:20480
  s_add_u32 m0, s68, 0
  v_mfma_f32_16x16x32_bf16 v[152:155], a[72:75], a[8:11], v[152:155]
  buffer_load_dwordx4 v232, s[16:19], s67 offen offset:0  lds
  v_mfma_f32_16x16x32_bf16 v[148:151], a[72:75], a[4:7], 0
  ds_read_b64_tr_b16 a[92:93], v229 offset:24576
  v_mfma_f32_16x16x32_bf16 v[148:151], a[76:79], a[20:23], v[148:151]
  v_mfma_f32_16x16x32_bf16 v[144:147], a[76:79], a[16:19], 0
  ds_read_b64_tr_b16 a[94:95], v229 offset:28672
  v_mfma_f32_16x16x32_bf16 v[144:147], a[72:75], a[0:3], v[144:147]
  buffer_load_dwordx4 v233, s[16:19], s67 offen offset:1024  lds
  s_waitcnt lgkmcnt(4)
  v_mfma_f32_16x16x32_bf16 v[160:163], a[80:83], a[0:3], 0
  ds_read_b64_tr_b16 a[64:65], v230 offset:0
  v_mfma_f32_16x16x32_bf16 v[160:163], a[84:87], a[16:19], v[160:163]
  v_mfma_f32_16x16x32_bf16 v[164:167], a[84:87], a[20:23], 0
  ds_read_b64_tr_b16 a[66:67], v230 offset:4096
  v_mfma_f32_16x16x32_bf16 v[164:167], a[80:83], a[4:7], v[164:167]
  buffer_load_dwordx4 v234, s[16:19], s67 offen offset:2048  lds
  v_mfma_f32_16x16x32_bf16 v[168:171], a[80:83], a[8:11], 0
  ds_read_b64_tr_b16 a[68:69], v230 offset:8192
  v_mfma_f32_16x16x32_bf16 v[168:171], a[84:87], a[24:27], v[168:171]
  v_mfma_f32_16x16x32_bf16 v[172:175], a[84:87], a[28:31], 0
  ds_read_b64_tr_b16 a[70:71], v230 offset:12288
  v_mfma_f32_16x16x32_bf16 v[172:175], a[80:83], a[12:15], v[172:175]
  buffer_load_dwordx4 v235, s[16:19], s67 offen offset:3072  lds
  s_waitcnt lgkmcnt(4)
  v_mfma_f32_16x16x32_bf16 v[188:191], a[88:91], a[12:15], 0
  ds_read_b64_tr_b16 a[72:73], v230 offset:16384
  v_mfma_f32_16x16x32_bf16 v[188:191], a[92:95], a[28:31], v[188:191]
  v_mfma_f32_16x16x32_bf16 v[184:187], a[92:95], a[24:27], 0
  ds_read_b64_tr_b16 a[74:75], v230 offset:20480
  s_add_u32 m0, s68, 16384
  v_mfma_f32_16x16x32_bf16 v[184:187], a[88:91], a[8:11], v[184:187]
  buffer_load_dwordx4 v232, s[20:23], s67 offen offset:0  lds
  v_mfma_f32_16x16x32_bf16 v[180:183], a[88:91], a[4:7], 0
  ds_read_b64_tr_b16 a[76:77], v230 offset:24576
  v_mfma_f32_16x16x32_bf16 v[180:183], a[92:95], a[20:23], v[180:183]
  v_mfma_f32_16x16x32_bf16 v[176:179], a[92:95], a[16:19], 0
  ds_read_b64_tr_b16 a[78:79], v230 offset:28672
  v_mfma_f32_16x16x32_bf16 v[176:179], a[88:91], a[0:3], v[176:179]
  buffer_load_dwordx4 v233, s[20:23], s67 offen offset:1024  lds
  s_waitcnt lgkmcnt(4)
  v_mfma_f32_16x16x32_bf16 v[192:195], a[64:67], a[0:3], 0
  s_barrier
  ds_read_b64_tr_b16 a[80:81], v224 offset:32768
  v_mfma_f32_16x16x32_bf16 v[192:195], a[68:71], a[16:19], v[192:195]
  v_mfma_f32_16x16x32_bf16 v[196:199], a[68:71], a[20:23], 0
  ds_read_b64_tr_b16 a[82:83], v224 offset:36864
  v_mfma_f32_16x16x32_bf16 v[196:199], a[64:67], a[4:7], v[196:199]
  buffer_load_dwordx4 v234, s[20:23], s67 offen offset:2048  lds
  v_mfma_f32_16x16x32_bf16 v[200:203], a[64:67], a[8:11], 0
  ds_read_b64_tr_b16 a[84:85], v224 offset:40960
  v_mfma_f32_16x16x32_bf16 v[200:203], a[68:71], a[24:27], v[200:203]
  v_mfma_f32_16x16x32_bf16 v[204:207], a[68:71], a[28:31], 0
  ds_read_b64_tr_b16 a[86:87], v224 offset:45056
  v_mfma_f32_16x16x32_bf16 v[204:207], a[64:67], a[12:15], v[204:207]
  buffer_load_dwordx4 v235, s[20:23], s67 offen offset:3072  lds
  s_waitcnt lgkmcnt(4)
  v_mfma_f32_16x16x32_bf16 v[220:223], a[72:75], a[12:15], 0
  ds_read_b64_tr_b16 a[88:89], v224 offset:49152
  s_add_u32 s67, s67, 458752
  v_mfma_f32_16x16x32_bf16 v[220:223], a[76:79], a[28:31], v[220:223]
  v_mfma_f32_16x16x32_bf16 v[216:219], a[76:79], a[24:27], 0
  ds_read_b64_tr_b16 a[90:91], v224 offset:53248
  v_mfma_f32_16x16x32_bf16 v[216:219], a[72:75], a[8:11], v[216:219]
  v_mfma_f32_16x16x32_bf16 v[212:215], a[72:75], a[4:7], 0
  ds_read_b64_tr_b16 a[92:93], v224 offset:57344
  buffer_load_dwordx4 a[96:99], v236, s[24:27], s70 offen
  v_mfma_f32_16x16x32_bf16 v[212:215], a[76:79], a[20:23], v[212:215]
  s_add_u32 s70, s70, 1024
  v_mfma_f32_16x16x32_bf16 v[208:211], a[76:79], a[16:19], 0
  ds_read_b64_tr_b16 a[94:95], v224 offset:61440
  v_xor_b32 v224, 0x10000, v224
  v_mfma_f32_16x16x32_bf16 v[208:211], a[72:75], a[0:3], v[208:211]
Lmk_p3s1:
  s_waitcnt vmcnt(17) lgkmcnt(4)
  v_mfma_f32_16x16x32_bf16 v[0:3], a[80:83], a[32:35], v[0:3]
  ds_read_b64_tr_b16 a[64:65], v225 offset:32768
  v_mfma_f32_16x16x32_bf16 v[0:3], a[84:87], a[48:51], v[0:3]
  v_mfma_f32_16x16x32_bf16 v[4:7], a[84:87], a[52:55], v[4:7]
  ds_read_b64_tr_b16 a[66:67], v225 offset:36864
  v_mfma_f32_16x16x32_bf16 v[4:7], a[80:83], a[36:39], v[4:7]
  buffer_load_dwordx4 a[0:3], v231, s[4:7], s72 offen offset:0 sc1
  v_mfma_f32_16x16x32_bf16 v[8:11], a[80:83], a[40:43], v[8:11]
  ds_read_b64_tr_b16 a[68:69], v225 offset:40960
  v_mfma_f32_16x16x32_bf16 v[8:11], a[84:87], a[56:59], v[8:11]
  s_add_u32 s43, s68, 32768
  v_lshlrev_b32 v250, 3, v253
  v_mfma_f32_16x16x32_bf16 v[12:15], a[84:87], a[60:63], v[12:15]
  ds_read_b64_tr_b16 a[70:71], v225 offset:45056
  v_add_u32 v250, s43, v250
  v_mfma_f32_16x16x32_bf16 v[12:15], a[80:83], a[44:47], v[12:15]
  s_waitcnt lgkmcnt(4)
  v_mfma_f32_16x16x32_bf16 v[28:31], a[88:91], a[44:47], v[28:31]
  ds_read_b64_tr_b16 a[72:73], v225 offset:49152
  v_mfma_f32_16x16x32_bf16 v[28:31], a[92:95], a[60:63], v[28:31]
  v_mfma_f32_16x16x32_bf16 v[24:27], a[92:95], a[56:59], v[24:27]
  ds_read_b64_tr_b16 a[74:75], v225 offset:53248
  buffer_load_dwordx4 a[16:19], v231, s[4:7], s72 offen offset:1024 sc1
  v_mfma_f32_16x16x32_bf16 v[24:27], a[88:91], a[40:43], v[24:27]
  v_mfma_f32_16x16x32_bf16 v[20:23], a[88:91], a[36:39], v[20:23]
  ds_read_b64_tr_b16 a[76:77], v225 offset:57344
  v_mfma_f32_16x16x32_bf16 v[20:23], a[92:95], a[52:55], v[20:23]
  s_waitcnt vmcnt(11)
  ds_read_b64 v[238:239], v250 offset:0
  v_mfma_f32_16x16x32_bf16 v[16:19], a[92:95], a[48:51], v[16:19]
  ds_read_b64_tr_b16 a[78:79], v225 offset:61440
  ds_read_b64 v[240:241], v250 offset:2048
  v_xor_b32 v225, 0x10000, v225
  v_mfma_f32_16x16x32_bf16 v[16:19], a[88:91], a[32:35], v[16:19]
  ds_read_b64 v[242:243], v250 offset:16384
  s_waitcnt lgkmcnt(7)
  v_mfma_f32_16x16x32_bf16 v[32:35], a[64:67], a[32:35], v[32:35]
  ds_read_b64_tr_b16 a[80:81], v226 offset:32768
  ds_read_b64 v[244:245], v250 offset:18432
  v_mfma_f32_16x16x32_bf16 v[32:35], a[68:71], a[48:51], v[32:35]
  buffer_load_dwordx4 a[4:7], v231, s[4:7], s73 offen offset:0 sc1
  ds_read_b64 v[246:247], v250 offset:512
  v_mfma_f32_16x16x32_bf16 v[36:39], a[68:71], a[52:55], v[36:39]
  ds_read_b64_tr_b16 a[82:83], v226 offset:36864
  v_mfma_f32_16x16x32_bf16 v[36:39], a[64:67], a[36:39], v[36:39]
  v_mfma_f32_16x16x32_bf16 v[40:43], a[64:67], a[40:43], v[40:43]
  ds_read_b64_tr_b16 a[84:85], v226 offset:40960
  ds_read_b64 v[248:249], v250 offset:2560
  v_mfma_f32_16x16x32_bf16 v[40:43], a[68:71], a[56:59], v[40:43]
  v_mfma_f32_16x16x32_bf16 v[44:47], a[68:71], a[60:63], v[44:47]
  s_waitcnt lgkmcnt(3)
  ds_read_b64_tr_b16 a[86:87], v226 offset:45056
  v_add_f32 v238, v238, v246
  v_add_f32 v239, v239, v247
  v_mfma_f32_16x16x32_bf16 v[44:47], a[64:67], a[44:47], v[44:47]
  ds_read_b64 v[246:247], v250 offset:16896
  v_mfma_f32_16x16x32_bf16 v[60:63], a[72:75], a[44:47], v[60:63]
  ds_read_b64_tr_b16 a[88:89], v226 offset:49152
  buffer_load_dwordx4 a[20:23], v231, s[4:7], s73 offen offset:1024 sc1
  v_mfma_f32_16x16x32_bf16 v[60:63], a[76:79], a[60:63], v[60:63]
  s_waitcnt lgkmcnt(3)
  v_add_f32 v240, v240, v248
  v_add_f32 v241, v241, v249
  v_mfma_f32_16x16x32_bf16 v[56:59], a[76:79], a[56:59], v[56:59]
  ds_read_b64_tr_b16 a[90:91], v226 offset:53248
  ds_read_b64 v[248:249], v250 offset:18944
  v_mfma_f32_16x16x32_bf16 v[56:59], a[72:75], a[40:43], v[56:59]
  v_mfma_f32_16x16x32_bf16 v[52:55], a[72:75], a[36:39], v[52:55]
  s_waitcnt lgkmcnt(3)
  ds_read_b64_tr_b16 a[92:93], v226 offset:57344
  v_add_f32 v242, v242, v246
  v_add_f32 v243, v243, v247
  v_mfma_f32_16x16x32_bf16 v[52:55], a[76:79], a[52:55], v[52:55]
  ds_read_b64 v[246:247], v250 offset:1024
  v_mfma_f32_16x16x32_bf16 v[48:51], a[76:79], a[48:51], v[48:51]
  ds_read_b64_tr_b16 a[94:95], v226 offset:61440
  v_xor_b32 v226, 0x10000, v226
  v_mfma_f32_16x16x32_bf16 v[48:51], a[72:75], a[32:35], v[48:51]
  s_waitcnt lgkmcnt(3)
  buffer_load_dwordx4 a[8:11], v231, s[4:7], s74 offen offset:0 sc1
  v_add_f32 v244, v244, v248
  v_add_f32 v245, v245, v249
  v_mfma_f32_16x16x32_bf16 v[64:67], a[80:83], a[32:35], v[64:67]
  ds_read_b64_tr_b16 a[64:65], v227 offset:32768
  ds_read_b64 v[248:249], v250 offset:3072
  v_mfma_f32_16x16x32_bf16 v[64:67], a[84:87], a[48:51], v[64:67]
  v_mfma_f32_16x16x32_bf16 v[68:71], a[84:87], a[52:55], v[68:71]
  s_waitcnt lgkmcnt(3)
  ds_read_b64_tr_b16 a[66:67], v227 offset:36864
  v_add_f32 v238, v238, v246
  v_add_f32 v239, v239, v247
  v_mfma_f32_16x16x32_bf16 v[68:71], a[80:83], a[36:39], v[68:71]
  ds_read_b64 v[246:247], v250 offset:17408
  v_mfma_f32_16x16x32_bf16 v[72:75], a[80:83], a[40:43], v[72:75]
  ds_read_b64_tr_b16 a[68:69], v227 offset:40960
  v_mfma_f32_16x16x32_bf16 v[72:75], a[84:87], a[56:59], v[72:75]
  s_waitcnt lgkmcnt(3)
  v_add_f32 v240, v240, v248
  v_add_f32 v241, v241, v249
  v_mfma_f32_16x16x32_bf16 v[76:79], a[84:87], a[60:63], v[76:79]
  ds_read_b64_tr_b16 a[70:71], v227 offset:45056
  buffer_load_dwordx4 a[24:27], v231, s[4:7], s74 offen offset:1024 sc1
  ds_read_b64 v[248:249], v250 offset:19456
  v_mfma_f32_16x16x32_bf16 v[76:79], a[80:83], a[44:47], v[76:79]
  v_mfma_f32_16x16x32_bf16 v[92:95], a[88:91], a[44:47], v[92:95]
  s_waitcnt lgkmcnt(3)
  ds_read_b64_tr_b16 a[72:73], v227 offset:49152
  v_add_f32 v242, v242, v246
  v_add_f32 v243, v243, v247
  v_mfma_f32_16x16x32_bf16 v[92:95], a[92:95], a[60:63], v[92:95]
  ds_read_b64 v[246:247], v250 offset:1536
  v_mfma_f32_16x16x32_bf16 v[88:91], a[92:95], a[56:59], v[88:91]
  ds_read_b64_tr_b16 a[74:75], v227 offset:53248
  v_mfma_f32_16x16x32_bf16 v[88:91], a[88:91], a[40:43], v[88:91]
  s_waitcnt lgkmcnt(3)
  v_add_f32 v244, v244, v248
  v_add_f32 v245, v245, v249
  v_mfma_f32_16x16x32_bf16 v[84:87], a[88:91], a[36:39], v[84:87]
  ds_read_b64_tr_b16 a[76:77], v227 offset:57344
  ds_read_b64 v[248:249], v250 offset:3584
  v_mfma_f32_16x16x32_bf16 v[84:87], a[92:95], a[52:55], v[84:87]
  buffer_load_dwordx4 a[12:15], v231, s[4:7], s75 offen offset:0 sc1
  v_mfma_f32_16x16x32_bf16 v[80:83], a[92:95], a[48:51], v[80:83]
  s_waitcnt lgkmcnt(3)
  ds_read_b64_tr_b16 a[78:79], v227 offset:61440
  v_xor_b32 v227, 0x10000, v227
  v_add_f32 v238, v238, v246
  v_add_f32 v239, v239, v247
  v_mfma_f32_16x16x32_bf16 v[80:83], a[88:91], a[32:35], v[80:83]
  ds_read_b64 v[246:247], v250 offset:17920
  buffer_load_dword v237, v251, s[4:7], s48 offen sc1
  v_mfma_f32_16x16x32_bf16 v[96:99], a[64:67], a[32:35], v[96:99]
  ds_read_b64_tr_b16 a[80:81], v228 offset:32768
  v_mfma_f32_16x16x32_bf16 v[96:99], a[68:71], a[48:51], v[96:99]
  s_waitcnt lgkmcnt(3)
  v_add_f32 v240, v240, v248
  v_add_f32 v241, v241, v249
  v_mfma_f32_16x16x32_bf16 v[100:103], a[68:71], a[52:55], v[100:103]
  ds_read_b64_tr_b16 a[82:83], v228 offset:36864
  ds_read_b64 v[248:249], v250 offset:19968
  v_mfma_f32_16x16x32_bf16 v[100:103], a[64:67], a[36:39], v[100:103]
  v_mfma_f32_16x16x32_bf16 v[104:107], a[64:67], a[40:43], v[104:107]
  s_waitcnt lgkmcnt(3)
  ds_read_b64_tr_b16 a[84:85], v228 offset:40960
  buffer_load_dwordx4 a[28:31], v231, s[4:7], s75 offen offset:1024 sc1
  v_add_f32 v242, v242, v246
  v_add_f32 v243, v243, v247
  v_mfma_f32_16x16x32_bf16 v[104:107], a[68:71], a[56:59], v[104:107]
  buffer_load_dwordx4 a[96:99], v236, s[24:27], s70 offen
  v_mfma_f32_16x16x32_bf16 v[108:111], a[68:71], a[60:63], v[108:111]
  ds_read_b64_tr_b16 a[86:87], v228 offset:45056
  s_add_u32 s70, s70, 1024
  v_mfma_f32_16x16x32_bf16 v[108:111], a[64:67], a[44:47], v[108:111]
  s_waitcnt lgkmcnt(2)
  v_add_f32 v244, v244, v248
  v_add_f32 v245, v245, v249
  v_mfma_f32_16x16x32_bf16 v[124:127], a[72:75], a[44:47], v[124:127]
  ds_read_b64_tr_b16 a[88:89], v228 offset:49152
  s_mov_b32 s43, 0x3a800000
  v_mfma_f32_16x16x32_bf16 v[124:127], a[76:79], a[60:63], v[124:127]
  v_mov_b32 v250, 0x3727c5ac
  v_lshlrev_b32 v246, 2, v253
  v_mfma_f32_16x16x32_bf16 v[120:123], a[76:79], a[56:59], v[120:123]
  ds_read_b64_tr_b16 a[90:91], v228 offset:53248
  s_add_u32 m0, s68, 32768
  v_mfma_f32_16x16x32_bf16 v[120:123], a[72:75], a[40:43], v[120:123]
  buffer_load_dwordx4 v232, s[16:19], s67 offen offset:0  lds
  v_add_u32 v246, s71, v246
  v_mfma_f32_16x16x32_bf16 v[116:119], a[72:75], a[36:39], v[116:119]
  ds_read_b64_tr_b16 a[92:93], v228 offset:57344
  v_permlane32_swap_b32 v238, v242
  v_mfma_f32_16x16x32_bf16 v[116:119], a[76:79], a[52:55], v[116:119]
  v_permlane32_swap_b32 v239, v243
  v_permlane32_swap_b32 v240, v244
  v_mfma_f32_16x16x32_bf16 v[112:115], a[76:79], a[48:51], v[112:115]
  ds_read_b64_tr_b16 a[94:95], v228 offset:61440
  v_xor_b32 v228, 0x10000, v228
  v_permlane32_swap_b32 v241, v245
  v_mfma_f32_16x16x32_bf16 v[112:115], a[72:75], a[32:35], v[112:115]
  s_waitcnt lgkmcnt(4)
  v_add_f32 v238, v238, v242
  v_add_f32 v240, v240, v244
  v_mfma_f32_16x16x32_bf16 v[128:131], a[80:83], a[32:35], v[128:131]
  ds_read_b64_tr_b16 a[64:65], v229 offset:32768
  v_add_f32 v239, v239, v243
  v_mfma_f32_16x16x32_bf16 v[128:131], a[84:87], a[48:51], v[128:131]
  v_add_f32 v241, v241, v245
  v_and_b32 v247, 0xffffff3f, v246
  v_mfma_f32_16x16x32_bf16 v[132:135], a[84:87], a[52:55], v[132:135]
  ds_read_b64_tr_b16 a[66:67], v229 offset:36864
  buffer_load_dwordx4 v233, s[16:19], s67 offen offset:1024  lds
  v_mfma_f32_16x16x32_bf16 v[132:135], a[80:83], a[36:39], v[132:135]
  v_permlane16_swap_b32 v238, v240
  v_permlane16_swap_b32 v239, v241
  v_mfma_f32_16x16x32_bf16 v[136:139], a[80:83], a[40:43], v[136:139]
  ds_read_b64_tr_b16 a[68:69], v229 offset:40960
  v_add_f32 v238, v238, v240
  v_mfma_f32_16x16x32_bf16 v[136:139], a[84:87], a[56:59], v[136:139]
  v_add_f32 v239, v239, v241
  v_add_u32 v247, 1024, v247
  v_mfma_f32_16x16x32_bf16 v[140:143], a[84:87], a[60:63], v[140:143]
  ds_read_b64_tr_b16 a[70:71], v229 offset:45056
  v_mul_f32 v238, 0xba800000, v238
  v_mfma_f32_16x16x32_bf16 v[140:143], a[80:83], a[44:47], v[140:143]
  s_waitcnt lgkmcnt(4)
  v_fma_f32 v239, v239, s43, v250
  v_fma_f32 v239, -v238, v238, v239
  v_mfma_f32_16x16x32_bf16 v[156:159], a[88:91], a[44:47], v[156:159]
  ds_read_b64_tr_b16 a[72:73], v229 offset:49152
  v_max_f32 v239, v239, v250
  v_mfma_f32_16x16x32_bf16 v[156:159], a[92:95], a[60:63], v[156:159]
  buffer_load_dwordx4 v234, s[16:19], s67 offen offset:2048  lds
  v_rsq_f32 v240, v239
  v_mfma_f32_16x16x32_bf16 v[152:155], a[92:95], a[56:59], v[152:155]
  ds_read_b64_tr_b16 a[74:75], v229 offset:53248
  ds_write_b32 v246, v238 offset:1024
  v_mfma_f32_16x16x32_bf16 v[152:155], a[88:91], a[40:43], v[152:155]
  ds_write_b32 v246, v239 offset:1536
  v_mul_f32 v240, 0xbfb8aa3b, v240
  v_mfma_f32_16x16x32_bf16 v[148:151], a[88:91], a[36:39], v[148:151]
  ds_read_b64_tr_b16 a[76:77], v229 offset:57344
  ds_write_b32 v246, v240 offset:1280
  v_mfma_f32_16x16x32_bf16 v[148:151], a[92:95], a[52:55], v[148:151]
  ds_read2_b32 v[238:239], v247 offset0:0 offset1:16
  ds_read2_b32 v[240:241], v247 offset0:32 offset1:48
  v_mfma_f32_16x16x32_bf16 v[144:147], a[92:95], a[48:51], v[144:147]
  ds_read_b64_tr_b16 a[78:79], v229 offset:61440
  v_xor_b32 v229, 0x10000, v229
  v_lshrrev_b32 v250, 3, v253
  v_mfma_f32_16x16x32_bf16 v[144:147], a[88:91], a[32:35], v[144:147]
  s_waitcnt lgkmcnt(9)
  v_add_u32 v250, s66, v250
  v_cmp_ne_u32 vcc, 7, v250
  v_mfma_f32_16x16x32_bf16 v[160:163], a[64:67], a[32:35], v[160:163]
  ds_read_b64_tr_b16 a[80:81], v230 offset:32768
  buffer_load_dwordx4 v235, s[16:19], s67 offen offset:3072  lds
  v_mfma_f32_16x16x32_bf16 v[160:163], a[68:71], a[48:51], v[160:163]
  v_bfe_u32 v242, v253, 2, 1
  v_mul_u32_u24 v242, 14336, v242
  v_mfma_f32_16x16x32_bf16 v[164:167], a[68:71], a[52:55], v[164:167]
  ds_read_b64_tr_b16 a[82:83], v230 offset:36864
  v_cndmask_b32 v250, 0, v250, vcc
  v_mfma_f32_16x16x32_bf16 v[164:167], a[64:67], a[36:39], v[164:167]
  v_lshl_add_u32 v250, v250, 6, v242
  v_and_b32 v242, 3, v253
  v_mfma_f32_16x16x32_bf16 v[168:171], a[64:67], a[40:43], v[168:171]
  ds_read_b64_tr_b16 a[84:85], v230 offset:40960
  v_lshl_add_u32 v250, v242, 4, v250
  v_mfma_f32_16x16x32_bf16 v[168:171], a[68:71], a[56:59], v[168:171]
  s_waitcnt vmcnt(6)
  v_cmp_gt_u32 vcc, 56, v237
  s_cbranch_vccz Lcdn16
  s_mov_b32 s43, 0x40000
Lchk15:
  s_sleep 8
  buffer_load_dword v237, v251, s[4:7], s48 offen sc1
  s_waitcnt vmcnt(0)
  v_cmp_gt_u32 vcc, 56, v237
  s_cbranch_vccz Lcdn16
  s_sub_u32 s43, s43, 1
  s_cmp_lg_u32 s43, 0
  s_cbranch_scc1 Lchk15
Lcdn16:
  buffer_load_dwordx4 v[242:245], v250, s[4:7], s46 offen sc1
  v_mfma_f32_16x16x32_bf16 v[172:175], a[68:71], a[60:63], v[172:175]
  ds_read_b64_tr_b16 a[86:87], v230 offset:45056
  s_add_u32 m0, s68, 49152
  v_mfma_f32_16x16x32_bf16 v[172:175], a[64:67], a[44:47], v[172:175]
  s_waitcnt lgkmcnt(4)
  buffer_load_dwordx4 v232, s[20:23], s67 offen offset:0  lds
  buffer_load_dwordx4 v[246:249], v250, s[4:7], s47 offen sc1
  v_mfma_f32_16x16x32_bf16 v[188:191], a[72:75], a[44:47], v[188:191]
  ds_read_b64_tr_b16 a[88:89], v230 offset:49152
  v_lshrrev_b32 v237, 4, v253
  v_mfma_f32_16x16x32_bf16 v[188:191], a[76:79], a[60:63], v[188:191]
  v_lshlrev_b32 v237, 4, v237
  v_add_u32 v237, s71, v237
  v_mfma_f32_16x16x32_bf16 v[184:187], a[76:79], a[56:59], v[184:187]
  ds_read_b64_tr_b16 a[90:91], v230 offset:53248
  v_add_u32 v250, s71, v231
  v_mfma_f32_16x16x32_bf16 v[184:187], a[72:75], a[40:43], v[184:187]
  v_mfma_f32_16x16x32_bf16 v[180:183], a[72:75], a[36:39], v[180:183]
  ds_read_b64_tr_b16 a[92:93], v230 offset:57344
  v_mfma_f32_16x16x32_bf16 v[180:183], a[76:79], a[52:55], v[180:183]
  v_mfma_f32_16x16x32_bf16 v[176:179], a[76:79], a[48:51], v[176:179]
  ds_read_b64_tr_b16 a[94:95], v230 offset:61440
  buffer_load_dwordx4 v233, s[20:23], s67 offen offset:1024  lds
  v_xor_b32 v230, 0x10000, v230
  v_mfma_f32_16x16x32_bf16 v[176:179], a[72:75], a[32:35], v[176:179]
  s_waitcnt lgkmcnt(4)
  v_mfma_f32_16x16x32_bf16 v[192:195], a[80:83], a[32:35], v[192:195]
  s_barrier
  ds_read_b64_tr_b16 a[64:65], v224 offset:0
  v_mfma_f32_16x16x32_bf16 v[192:195], a[84:87], a[48:51], v[192:195]
  v_mfma_f32_16x16x32_bf16 v[196:199], a[84:87], a[52:55], v[196:199]
  ds_read_b64_tr_b16 a[66:67], v224 offset:4096
  v_mfma_f32_16x16x32_bf16 v[196:199], a[80:83], a[36:39], v[196:199]
  v_mfma_f32_16x16x32_bf16 v[200:203], a[80:83], a[40:43], v[200:203]
  ds_read_b64_tr_b16 a[68:69], v224 offset:8192
  v_mfma_f32_16x16x32_bf16 v[200:203], a[84:87], a[56:59], v[200:203]
  buffer_load_dwordx4 v234, s[20:23], s67 offen offset:2048  lds
  v_mfma_f32_16x16x32_bf16 v[204:207], a[84:87], a[60:63], v[204:207]
  ds_read_b64_tr_b16 a[70:71], v224 offset:12288
  v_mfma_f32_16x16x32_bf16 v[204:207], a[80:83], a[44:47], v[204:207]
  s_waitcnt lgkmcnt(4)
  v_mfma_f32_16x16x32_bf16 v[220:223], a[88:91], a[44:47], v[220:223]
  ds_read_b64_tr_b16 a[72:73], v224 offset:16384
  v_mfma_f32_16x16x32_bf16 v[220:223], a[92:95], a[60:63], v[220:223]
  v_mfma_f32_16x16x32_bf16 v[216:219], a[92:95], a[56:59], v[216:219]
  ds_read_b64_tr_b16 a[74:75], v224 offset:20480
  v_mfma_f32_16x16x32_bf16 v[216:219], a[88:91], a[40:43], v[216:219]
  v_mfma_f32_16x16x32_bf16 v[212:215], a[88:91], a[36:39], v[212:215]
  ds_read_b64_tr_b16 a[76:77], v224 offset:24576
  buffer_load_dwordx4 v235, s[20:23], s67 offen offset:3072  lds
  v_mfma_f32_16x16x32_bf16 v[212:215], a[92:95], a[52:55], v[212:215]
  s_add_u32 s67, s67, 458752
  s_xor_b32 s68, s68, 0x10000
  v_mfma_f32_16x16x32_bf16 v[208:211], a[92:95], a[48:51], v[208:211]
  ds_read_b64_tr_b16 a[78:79], v224 offset:28672
  v_mfma_f32_16x16x32_bf16 v[208:211], a[88:91], a[32:35], v[208:211]
  s_mov_b32 s56, 5
.p2align 3
Lp3_loop:
  s_waitcnt vmcnt(8) lgkmcnt(4)
  v_mfma_f32_16x16x32_bf16 v[0:3], a[64:67], a[0:3], v[0:3]
  ds_read_b64_tr_b16 a[80:81], v225 offset:0
  v_mfma_f32_16x16x32_bf16 v[0:3], a[68:71], a[16:19], v[0:3]
  v_mfma_f32_16x16x32_bf16 v[4:7], a[68:71], a[20:23], v[4:7]
  ds_read_b64_tr_b16 a[82:83], v225 offset:4096
  v_mfma_f32_16x16x32_bf16 v[4:7], a[64:67], a[4:7], v[4:7]
  buffer_load_dwordx4 a[32:35], v231, s[4:7], s72 offen offset:2048 sc1
  v_mfma_f32_16x16x32_bf16 v[8:11], a[64:67], a[8:11], v[8:11]
  ds_read_b64_tr_b16 a[84:85], v225 offset:8192
  v_mfma_f32_16x16x32_bf16 v[8:11], a[68:71], a[24:27], v[8:11]
  v_mfma_f32_16x16x32_bf16 v[12:15], a[68:71], a[28:31], v[12:15]
  ds_read_b64_tr_b16 a[86:87], v225 offset:12288
  v_mfma_f32_16x16x32_bf16 v[12:15], a[64:67], a[12:15], v[12:15]
  s_waitcnt lgkmcnt(4)
  v_mfma_f32_16x16x32_bf16 v[28:31], a[72:75], a[12:15], v[28:31]
  ds_read_b64_tr_b16 a[88:89], v225 offset:16384
  v_mfma_f32_16x16x32_bf16 v[28:31], a[76:79], a[28:31], v[28:31]
  v_mfma_f32_16x16x32_bf16 v[24:27], a[76:79], a[24:27], v[24:27]
  ds_read_b64_tr_b16 a[90:91], v225 offset:20480
  buffer_load_dwordx4 a[48:51], v231, s[4:7], s72 offen offset:3072 sc1
  v_mfma_f32_16x16x32_bf16 v[24:27], a[72:75], a[8:11], v[24:27]
  s_add_u32 s72, s72, 4096
  v_mfma_f32_16x16x32_bf16 v[20:23], a[72:75], a[4:7], v[20:23]
  ds_read_b64_tr_b16 a[92:93], v225 offset:24576
  v_mfma_f32_16x16x32_bf16 v[20:23], a[76:79], a[20:23], v[20:23]
  v_mfma_f32_16x16x32_bf16 v[16:19], a[76:79], a[16:19], v[16:19]
  ds_read_b64_tr_b16 a[94:95], v225 offset:28672
  v_mfma_f32_16x16x32_bf16 v[16:19], a[72:75], a[0:3], v[16:19]
  s_waitcnt lgkmcnt(4)
  v_mfma_f32_16x16x32_bf16 v[32:35], a[80:83], a[0:3], v[32:35]
  ds_read_b64_tr_b16 a[64:65], v226 offset:0
  v_mfma_f32_16x16x32_bf16 v[32:35], a[84:87], a[16:19], v[32:35]
  buffer_load_dwordx4 a[36:39], v231, s[4:7], s73 offen offset:2048 sc1
  v_mfma_f32_16x16x32_bf16 v[36:39], a[84:87], a[20:23], v[36:39]
  ds_read_b64_tr_b16 a[66:67], v226 offset:4096
  v_mfma_f32_16x16x32_bf16 v[36:39], a[80:83], a[4:7], v[36:39]
  v_mfma_f32_16x16x32_bf16 v[40:43], a[80:83], a[8:11], v[40:43]
  ds_read_b64_tr_b16 a[68:69], v226 offset:8192
  v_mfma_f32_16x16x32_bf16 v[40:43], a[84:87], a[24:27], v[40:43]
  v_mfma_f32_16x16x32_bf16 v[44:47], a[84:87], a[28:31], v[44:47]
  ds_read_b64_tr_b16 a[70:71], v226 offset:12288
  v_mfma_f32_16x16x32_bf16 v[44:47], a[80:83], a[12:15], v[44:47]
  s_waitcnt lgkmcnt(4)
  v_mfma_f32_16x16x32_bf16 v[60:63], a[88:91], a[12:15], v[60:63]
  ds_read_b64_tr_b16 a[72:73], v226 offset:16384
  buffer_load_dwordx4 a[52:55], v231, s[4:7], s73 offen offset:3072 sc1
  v_mfma_f32_16x16x32_bf16 v[60:63], a[92:95], a[28:31], v[60:63]
  s_add_u32 s73, s73, 4096
  v_mfma_f32_16x16x32_bf16 v[56:59], a[92:95], a[24:27], v[56:59]
  ds_read_b64_tr_b16 a[74:75], v226 offset:20480
  v_mfma_f32_16x16x32_bf16 v[56:59], a[88:91], a[8:11], v[56:59]
  v_mfma_f32_16x16x32_bf16 v[52:55], a[88:91], a[4:7], v[52:55]
  ds_read_b64_tr_b16 a[76:77], v226 offset:24576
  v_mfma_f32_16x16x32_bf16 v[52:55], a[92:95], a[20:23], v[52:55]
  v_mfma_f32_16x16x32_bf16 v[48:51], a[92:95], a[16:19], v[48:51]
  ds_read_b64_tr_b16 a[78:79], v226 offset:28672
  v_mfma_f32_16x16x32_bf16 v[48:51], a[88:91], a[0:3], v[48:51]
  buffer_load_dwordx4 a[40:43], v231, s[4:7], s74 offen offset:2048 sc1
  s_waitcnt lgkmcnt(4)
  v_mfma_f32_16x16x32_bf16 v[64:67], a[64:67], a[0:3], v[64:67]
  ds_read_b64_tr_b16 a[80:81], v227 offset:0
  v_mfma_f32_16x16x32_bf16 v[64:67], a[68:71], a[16:19], v[64:67]
  v_mfma_f32_16x16x32_bf16 v[68:71], a[68:71], a[20:23], v[68:71]
  ds_read_b64_tr_b16 a[82:83], v227 offset:4096
  v_mfma_f32_16x16x32_bf16 v[68:71], a[64:67], a[4:7], v[68:71]
  v_mfma_f32_16x16x32_bf16 v[72:75], a[64:67], a[8:11], v[72:75]
  ds_read_b64_tr_b16 a[84:85], v227 offset:8192
  v_mfma_f32_16x16x32_bf16 v[72:75], a[68:71], a[24:27], v[72:75]
  v_mfma_f32_16x16x32_bf16 v[76:79], a[68:71], a[28:31], v[76:79]
  ds_read_b64_tr_b16 a[86:87], v227 offset:12288
  buffer_load_dwordx4 a[56:59], v231, s[4:7], s74 offen offset:3072 sc1
  v_mfma_f32_16x16x32_bf16 v[76:79], a[64:67], a[12:15], v[76:79]
  s_add_u32 s74, s74, 4096
  s_waitcnt lgkmcnt(4)
  v_mfma_f32_16x16x32_bf16 v[92:95], a[72:75], a[12:15], v[92:95]
  ds_read_b64_tr_b16 a[88:89], v227 offset:16384
  v_mfma_f32_16x16x32_bf16 v[92:95], a[76:79], a[28:31], v[92:95]
  v_mfma_f32_16x16x32_bf16 v[88:91], a[76:79], a[24:27], v[88:91]
  ds_read_b64_tr_b16 a[90:91], v227 offset:20480
  v_mfma_f32_16x16x32_bf16 v[88:91], a[72:75], a[8:11], v[88:91]
  v_mfma_f32_16x16x32_bf16 v[84:87], a[72:75], a[4:7], v[84:87]
  ds_read_b64_tr_b16 a[92:93], v227 offset:24576
  v_mfma_f32_16x16x32_bf16 v[84:87], a[76:79], a[20:23], v[84:87]
  buffer_load_dwordx4 a[44:47], v231, s[4:7], s75 offen offset:2048 sc1
  v_mfma_f32_16x16x32_bf16 v[80:83], a[76:79], a[16:19], v[80:83]
  ds_read_b64_tr_b16 a[94:95], v227 offset:28672
  v_mfma_f32_16x16x32_bf16 v[80:83], a[72:75], a[0:3], v[80:83]
  s_waitcnt lgkmcnt(4)
  v_mfma_f32_16x16x32_bf16 v[96:99], a[80:83], a[0:3], v[96:99]
  ds_read_b64_tr_b16 a[64:65], v228 offset:0
  v_mfma_f32_16x16x32_bf16 v[96:99], a[84:87], a[16:19], v[96:99]
  v_mfma_f32_16x16x32_bf16 v[100:103], a[84:87], a[20:23], v[100:103]
  ds_read_b64_tr_b16 a[66:67], v228 offset:4096
  v_mfma_f32_16x16x32_bf16 v[100:103], a[80:83], a[4:7], v[100:103]
  v_mfma_f32_16x16x32_bf16 v[104:107], a[80:83], a[8:11], v[104:107]
  ds_read_b64_tr_b16 a[68:69], v228 offset:8192
  buffer_load_dwordx4 a[60:63], v231, s[4:7], s75 offen offset:3072 sc1
  v_mfma_f32_16x16x32_bf16 v[104:107], a[84:87], a[24:27], v[104:107]
  s_add_u32 s75, s75, 4096
  buffer_load_dwordx4 a[96:99], v236, s[24:27], s70 offen
  v_mfma_f32_16x16x32_bf16 v[108:111], a[84:87], a[28:31], v[108:111]
  ds_read_b64_tr_b16 a[70:71], v228 offset:12288
  s_add_u32 s70, s70, 1024
  v_mfma_f32_16x16x32_bf16 v[108:111], a[80:83], a[12:15], v[108:111]
  s_waitcnt lgkmcnt(4)
  v_mfma_f32_16x16x32_bf16 v[124:127], a[88:91], a[12:15], v[124:127]
  ds_read_b64_tr_b16 a[72:73], v228 offset:16384
  v_mfma_f32_16x16x32_bf16 v[124:127], a[92:95], a[28:31], v[124:127]
  v_mfma_f32_16x16x32_bf16 v[120:123], a[92:95], a[24:27], v[120:123]
  ds_read_b64_tr_b16 a[74:75], v228 offset:20480
  s_add_u32 m0, s68, 0
  v_mfma_f32_16x16x32_bf16 v[120:123], a[88:91], a[8:11], v[120:123]
  buffer_load_dwordx4 v232, s[16:19], s67 offen offset:0  lds
  v_mfma_f32_16x16x32_bf16 v[116:119], a[88:91], a[4:7], v[116:119]
  ds_read_b64_tr_b16 a[76:77], v228 offset:24576
  v_mfma_f32_16x16x32_bf16 v[116:119], a[92:95], a[20:23], v[116:119]
  v_mfma_f32_16x16x32_bf16 v[112:115], a[92:95], a[16:19], v[112:115]
  ds_read_b64_tr_b16 a[78:79], v228 offset:28672
  v_mfma_f32_16x16x32_bf16 v[112:115], a[88:91], a[0:3], v[112:115]
  s_waitcnt lgkmcnt(4)
  v_mfma_f32_16x16x32_bf16 v[128:131], a[64:67], a[0:3], v[128:131]
  ds_read_b64_tr_b16 a[80:81], v229 offset:0
  v_mfma_f32_16x16x32_bf16 v[128:131], a[68:71], a[16:19], v[128:131]
  v_mfma_f32_16x16x32_bf16 v[132:135], a[68:71], a[20:23], v[132:135]
  ds_read_b64_tr_b16 a[82:83], v229 offset:4096
  buffer_load_dwordx4 v233, s[16:19], s67 offen offset:1024  lds
  v_mfma_f32_16x16x32_bf16 v[132:135], a[64:67], a[4:7], v[132:135]
  v_mfma_f32_16x16x32_bf16 v[136:139], a[64:67], a[8:11], v[136:139]
  ds_read_b64_tr_b16 a[84:85], v229 offset:8192
  v_mfma_f32_16x16x32_bf16 v[136:139], a[68:71], a[24:27], v[136:139]
  v_mfma_f32_16x16x32_bf16 v[140:143], a[68:71], a[28:31], v[140:143]
  ds_read_b64_tr_b16 a[86:87], v229 offset:12288
  v_mfma_f32_16x16x32_bf16 v[140:143], a[64:67], a[12:15], v[140:143]
  s_waitcnt lgkmcnt(4)
  v_mfma_f32_16x16x32_bf16 v[156:159], a[72:75], a[12:15], v[156:159]
  ds_read_b64_tr_b16 a[88:89], v229 offset:16384
  v_mfma_f32_16x16x32_bf16 v[156:159], a[76:79], a[28:31], v[156:159]
  buffer_load_dwordx4 v234, s[16:19], s67 offen offset:2048  lds
  v_mfma_f32_16x16x32_bf16 v[152:155], a[76:79], a[24:27], v[152:155]
  ds_read_b64_tr_b16 a[90:91], v229 offset:20480
  v_mfma_f32_16x16x32_bf16 v[152:155], a[72:75], a[8:11], v[152:155]
  v_mfma_f32_16x16x32_bf16 v[148:151], a[72:75], a[4:7], v[148:151]
  ds_read_b64_tr_b16 a[92:93], v229 offset:24576
  v_mfma_f32_16x16x32_bf16 v[148:151], a[76:79], a[20:23], v[148:151]
  v_mfma_f32_16x16x32_bf16 v[144:147], a[76:79], a[16:19], v[144:147]
  ds_read_b64_tr_b16 a[94:95], v229 offset:28672
  v_mfma_f32_16x16x32_bf16 v[144:147], a[72:75], a[0:3], v[144:147]
  s_waitcnt lgkmcnt(4)
  v_mfma_f32_16x16x32_bf16 v[160:163], a[80:83], a[0:3], v[160:163]
  ds_read_b64_tr_b16 a[64:65], v230 offset:0
  buffer_load_dwordx4 v235, s[16:19], s67 offen offset:3072  lds
  v_mfma_f32_16x16x32_bf16 v[160:163], a[84:87], a[16:19], v[160:163]
  v_mfma_f32_16x16x32_bf16 v[164:167], a[84:87], a[20:23], v[164:167]
  ds_read_b64_tr_b16 a[66:67], v230 offset:4096
  v_mfma_f32_16x16x32_bf16 v[164:167], a[80:83], a[4:7], v[164:167]
  v_mfma_f32_16x16x32_bf16 v[168:171], a[80:83], a[8:11], v[168:171]
  ds_read_b64_tr_b16 a[68:69], v230 offset:8192
  v_mfma_f32_16x16x32_bf16 v[168:171], a[84:87], a[24:27], v[168:171]
  v_mfma_f32_16x16x32_bf16 v[172:175], a[84:87], a[28:31], v[172:175]
  ds_read_b64_tr_b16 a[70:71], v230 offset:12288
  s_add_u32 m0, s68, 16384
  v_mfma_f32_16x16x32_bf16 v[172:175], a[80:83], a[12:15], v[172:175]
  buffer_load_dwordx4 v232, s[20:23], s67 offen offset:0  lds
  s_waitcnt lgkmcnt(4)
  v_mfma_f32_16x16x32_bf16 v[188:191], a[88:91], a[12:15], v[188:191]
  ds_read_b64_tr_b16 a[72:73], v230 offset:16384
  v_mfma_f32_16x16x32_bf16 v[188:191], a[92:95], a[28:31], v[188:191]
  v_mfma_f32_16x16x32_bf16 v[184:187], a[92:95], a[24:27], v[184:187]
  ds_read_b64_tr_b16 a[74:75], v230 offset:20480
  v_mfma_f32_16x16x32_bf16 v[184:187], a[88:91], a[8:11], v[184:187]
  v_mfma_f32_16x16x32_bf16 v[180:183], a[88:91], a[4:7], v[180:183]
  ds_read_b64_tr_b16 a[76:77], v230 offset:24576
  v_mfma_f32_16x16x32_bf16 v[180:183], a[92:95], a[20:23], v[180:183]
  v_mfma_f32_16x16x32_bf16 v[176:179], a[92:95], a[16:19], v[176:179]
  ds_read_b64_tr_b16 a[78:79], v230 offset:28672
  buffer_load_dwordx4 v233, s[20:23], s67 offen offset:1024  lds
  v_mfma_f32_16x16x32_bf16 v[176:179], a[88:91], a[0:3], v[176:179]
  s_waitcnt lgkmcnt(4)
  v_mfma_f32_16x16x32_bf16 v[192:195], a[64:67], a[0:3], v[192:195]
  s_waitcnt vmcnt(15)
  s_barrier
  ds_read_b64_tr_b16 a[80:81], v224 offset:32768
  v_mfma_f32_16x16x32_bf16 v[192:195], a[68:71], a[16:19], v[192:195]
  v_mfma_f32_16x16x32_bf16 v[196:199], a[68:71], a[20:23], v[196:199]
  ds_read_b64_tr_b16 a[82:83], v224 offset:36864
  v_mfma_f32_16x16x32_bf16 v[196:199], a[64:67], a[4:7], v[196:199]
  v_mfma_f32_16x16x32_bf16 v[200:203], a[64:67], a[8:11], v[200:203]
  ds_read_b64_tr_b16 a[84:85], v224 offset:40960
  v_mfma_f32_16x16x32_bf16 v[200:203], a[68:71], a[24:27], v[200:203]
  buffer_load_dwordx4 v234, s[20:23], s67 offen offset:2048  lds
  v_mfma_f32_16x16x32_bf16 v[204:207], a[68:71], a[28:31], v[204:207]
  ds_read_b64_tr_b16 a[86:87], v224 offset:45056
  v_mfma_f32_16x16x32_bf16 v[204:207], a[64:67], a[12:15], v[204:207]
  s_waitcnt lgkmcnt(4)
  v_mfma_f32_16x16x32_bf16 v[220:223], a[72:75], a[12:15], v[220:223]
  ds_read_b64_tr_b16 a[88:89], v224 offset:49152
  v_mfma_f32_16x16x32_bf16 v[220:223], a[76:79], a[28:31], v[220:223]
  v_mfma_f32_16x16x32_bf16 v[216:219], a[76:79], a[24:27], v[216:219]
  ds_read_b64_tr_b16 a[90:91], v224 offset:53248
  v_mfma_f32_16x16x32_bf16 v[216:219], a[72:75], a[8:11], v[216:219]
  v_mfma_f32_16x16x32_bf16 v[212:215], a[72:75], a[4:7], v[212:215]
  ds_read_b64_tr_b16 a[92:93], v224 offset:57344
  buffer_load_dwordx4 v235, s[20:23], s67 offen offset:3072  lds
  v_mfma_f32_16x16x32_bf16 v[212:215], a[76:79], a[20:23], v[212:215]
  s_add_u32 s67, s67, 458752
  v_mfma_f32_16x16x32_bf16 v[208:211], a[76:79], a[16:19], v[208:211]
  ds_read_b64_tr_b16 a[94:95], v224 offset:61440
  v_xor_b32 v224, 0x10000, v224
  v_mfma_f32_16x16x32_bf16 v[208:211], a[72:75], a[0:3], v[208:211]
  s_waitcnt vmcnt(9) lgkmcnt(4)
  v_mfma_f32_16x16x32_bf16 v[0:3], a[80:83], a[32:35], v[0:3]
  ds_read_b64_tr_b16 a[64:65], v225 offset:32768
  v_mfma_f32_16x16x32_bf16 v[0:3], a[84:87], a[48:51], v[0:3]
  v_mfma_f32_16x16x32_bf16 v[4:7], a[84:87], a[52:55], v[4:7]
  ds_read_b64_tr_b16 a[66:67], v225 offset:36864
  v_mfma_f32_16x16x32_bf16 v[4:7], a[80:83], a[36:39], v[4:7]
  buffer_load_dwordx4 a[0:3], v231, s[4:7], s72 offen offset:0 sc1
  v_mfma_f32_16x16x32_bf16 v[8:11], a[80:83], a[40:43], v[8:11]
  ds_read_b64_tr_b16 a[68:69], v225 offset:40960
  v_mfma_f32_16x16x32_bf16 v[8:11], a[84:87], a[56:59], v[8:11]
  v_mfma_f32_16x16x32_bf16 v[12:15], a[84:87], a[60:63], v[12:15]
  ds_read_b64_tr_b16 a[70:71], v225 offset:45056
  v_mfma_f32_16x16x32_bf16 v[12:15], a[80:83], a[44:47], v[12:15]
  s_waitcnt lgkmcnt(4)
  v_mfma_f32_16x16x32_bf16 v[28:31], a[88:91], a[44:47], v[28:31]
  ds_read_b64_tr_b16 a[72:73], v225 offset:49152
  v_mfma_f32_16x16x32_bf16 v[28:31], a[92:95], a[60:63], v[28:31]
  v_mfma_f32_16x16x32_bf16 v[24:27], a[92:95], a[56:59], v[24:27]
  ds_read_b64_tr_b16 a[74:75], v225 offset:53248
  buffer_load_dwordx4 a[16:19], v231, s[4:7], s72 offen offset:1024 sc1
  v_mfma_f32_16x16x32_bf16 v[24:27], a[88:91], a[40:43], v[24:27]
  v_mfma_f32_16x16x32_bf16 v[20:23], a[88:91], a[36:39], v[20:23]
  ds_read_b64_tr_b16 a[76:77], v225 offset:57344
  v_mfma_f32_16x16x32_bf16 v[20:23], a[92:95], a[52:55], v[20:23]
  v_mfma_f32_16x16x32_bf16 v[16:19], a[92:95], a[48:51], v[16:19]
  ds_read_b64_tr_b16 a[78:79], v225 offset:61440
  v_xor_b32 v225, 0x10000, v225
  v_mfma_f32_16x16x32_bf16 v[16:19], a[88:91], a[32:35], v[16:19]
  s_waitcnt lgkmcnt(4)
  v_mfma_f32_16x16x32_bf16 v[32:35], a[64:67], a[32:35], v[32:35]
  ds_read_b64_tr_b16 a[80:81], v226 offset:32768
  v_mfma_f32_16x16x32_bf16 v[32:35], a[68:71], a[48:51], v[32:35]
  buffer_load_dwordx4 a[4:7], v231, s[4:7], s73 offen offset:0 sc1
  v_mfma_f32_16x16x32_bf16 v[36:39], a[68:71], a[52:55], v[36:39]
  ds_read_b64_tr_b16 a[82:83], v226 offset:36864
  v_mfma_f32_16x16x32_bf16 v[36:39], a[64:67], a[36:39], v[36:39]
  v_mfma_f32_16x16x32_bf16 v[40:43], a[64:67], a[40:43], v[40:43]
  ds_read_b64_tr_b16 a[84:85], v226 offset:40960
  v_mfma_f32_16x16x32_bf16 v[40:43], a[68:71], a[56:59], v[40:43]
  v_mfma_f32_16x16x32_bf16 v[44:47], a[68:71], a[60:63], v[44:47]
  ds_read_b64_tr_b16 a[86:87], v226 offset:45056
  v_mfma_f32_16x16x32_bf16 v[44:47], a[64:67], a[44:47], v[44:47]
  s_waitcnt lgkmcnt(4)
  v_mfma_f32_16x16x32_bf16 v[60:63], a[72:75], a[44:47], v[60:63]
  ds_read_b64_tr_b16 a[88:89], v226 offset:49152
  buffer_load_dwordx4 a[20:23], v231, s[4:7], s73 offen offset:1024 sc1
  v_mfma_f32_16x16x32_bf16 v[60:63], a[76:79], a[60:63], v[60:63]
  v_mfma_f32_16x16x32_bf16 v[56:59], a[76:79], a[56:59], v[56:59]
  ds_read_b64_tr_b16 a[90:91], v226 offset:53248
  v_mfma_f32_16x16x32_bf16 v[56:59], a[72:75], a[40:43], v[56:59]
  v_mfma_f32_16x16x32_bf16 v[52:55], a[72:75], a[36:39], v[52:55]
  ds_read_b64_tr_b16 a[92:93], v226 offset:57344
  v_mfma_f32_16x16x32_bf16 v[52:55], a[76:79], a[52:55], v[52:55]
  v_mfma_f32_16x16x32_bf16 v[48:51], a[76:79], a[48:51], v[48:51]
  ds_read_b64_tr_b16 a[94:95], v226 offset:61440
  v_xor_b32 v226, 0x10000, v226
  v_mfma_f32_16x16x32_bf16 v[48:51], a[72:75], a[32:35], v[48:51]
  buffer_load_dwordx4 a[8:11], v231, s[4:7], s74 offen offset:0 sc1
  s_waitcnt lgkmcnt(4)
  v_mfma_f32_16x16x32_bf16 v[64:67], a[80:83], a[32:35], v[64:67]
  ds_read_b64_tr_b16 a[64:65], v227 offset:32768
  v_mfma_f32_16x16x32_bf16 v[64:67], a[84:87], a[48:51], v[64:67]
  v_mfma_f32_16x16x32_bf16 v[68:71], a[84:87], a[52:55], v[68:71]
  ds_read_b64_tr_b16 a[66:67], v227 offset:36864
  v_mfma_f32_16x16x32_bf16 v[68:71], a[80:83], a[36:39], v[68:71]
  v_mfma_f32_16x16x32_bf16 v[72:75], a[80:83], a[40:43], v[72:75]
  ds_read_b64_tr_b16 a[68:69], v227 offset:40960
  v_mfma_f32_16x16x32_bf16 v[72:75], a[84:87], a[56:59], v[72:75]
  v_mfma_f32_16x16x32_bf16 v[76:79], a[84:87], a[60:63], v[76:79]
  ds_read_b64_tr_b16 a[70:71], v227 offset:45056
  buffer_load_dwordx4 a[24:27], v231, s[4:7], s74 offen offset:1024 sc1
  v_mfma_f32_16x16x32_bf16 v[76:79], a[80:83], a[44:47], v[76:79]
  s_waitcnt lgkmcnt(4)
  v_mfma_f32_16x16x32_bf16 v[92:95], a[88:91], a[44:47], v[92:95]
  ds_read_b64_tr_b16 a[72:73], v227 offset:49152
  v_mfma_f32_16x16x32_bf16 v[92:95], a[92:95], a[60:63], v[92:95]
  v_mfma_f32_16x16x32_bf16 v[88:91], a[92:95], a[56:59], v[88:91]
  ds_read_b64_tr_b16 a[74:75], v227 offset:53248
  v_mfma_f32_16x16x32_bf16 v[88:91], a[88:91], a[40:43], v[88:91]
  v_mfma_f32_16x16x32_bf16 v[84:87], a[88:91], a[36:39], v[84:87]
  ds_read_b64_tr_b16 a[76:77], v227 offset:57344
  v_mfma_f32_16x16x32_bf16 v[84:87], a[92:95], a[52:55], v[84:87]
  buffer_load_dwordx4 a[12:15], v231, s[4:7], s75 offen offset:0 sc1
  v_mfma_f32_16x16x32_bf16 v[80:83], a[92:95], a[48:51], v[80:83]
  ds_read_b64_tr_b16 a[78:79], v227 offset:61440
  v_xor_b32 v227, 0x10000, v227
  v_mfma_f32_16x16x32_bf16 v[80:83], a[88:91], a[32:35], v[80:83]
  s_waitcnt lgkmcnt(4)
  v_mfma_f32_16x16x32_bf16 v[96:99], a[64:67], a[32:35], v[96:99]
  ds_read_b64_tr_b16 a[80:81], v228 offset:32768
  v_mfma_f32_16x16x32_bf16 v[96:99], a[68:71], a[48:51], v[96:99]
  v_mfma_f32_16x16x32_bf16 v[100:103], a[68:71], a[52:55], v[100:103]
  ds_read_b64_tr_b16 a[82:83], v228 offset:36864
  v_mfma_f32_16x16x32_bf16 v[100:103], a[64:67], a[36:39], v[100:103]
  v_mfma_f32_16x16x32_bf16 v[104:107], a[64:67], a[40:43], v[104:107]
  ds_read_b64_tr_b16 a[84:85], v228 offset:40960
  buffer_load_dwordx4 a[28:31], v231, s[4:7], s75 offen offset:1024 sc1
  v_mfma_f32_16x16x32_bf16 v[104:107], a[68:71], a[56:59], v[104:107]
  v_mfma_f32_16x16x32_bf16 v[108:111], a[68:71], a[60:63], v[108:111]
  ds_read_b64_tr_b16 a[86:87], v228 offset:45056
  v_mfma_f32_16x16x32_bf16 v[108:111], a[64:67], a[44:47], v[108:111]
  s_waitcnt lgkmcnt(4)
  v_mfma_f32_16x16x32_bf16 v[124:127], a[72:75], a[44:47], v[124:127]
  ds_read_b64_tr_b16 a[88:89], v228 offset:49152
  v_mfma_f32_16x16x32_bf16 v[124:127], a[76:79], a[60:63], v[124:127]
  v_mfma_f32_16x16x32_bf16 v[120:123], a[76:79], a[56:59], v[120:123]
  ds_read_b64_tr_b16 a[90:91], v228 offset:53248
  s_add_u32 m0, s68, 32768
  v_mfma_f32_16x16x32_bf16 v[120:123], a[72:75], a[40:43], v[120:123]
  buffer_load_dwordx4 v232, s[16:19], s67 offen offset:0  lds
  v_mfma_f32_16x16x32_bf16 v[116:119], a[72:75], a[36:39], v[116:119]
  ds_read_b64_tr_b16 a[92:93], v228 offset:57344
  v_mfma_f32_16x16x32_bf16 v[116:119], a[76:79], a[52:55], v[116:119]
  v_mfma_f32_16x16x32_bf16 v[112:115], a[76:79], a[48:51], v[112:115]
  ds_read_b64_tr_b16 a[94:95], v228 offset:61440
  v_xor_b32 v228, 0x10000, v228
  v_mfma_f32_16x16x32_bf16 v[112:115], a[72:75], a[32:35], v[112:115]
  s_waitcnt lgkmcnt(4)
  v_mfma_f32_16x16x32_bf16 v[128:131], a[80:83], a[32:35], v[128:131]
  ds_read_b64_tr_b16 a[64:65], v229 offset:32768
  v_mfma_f32_16x16x32_bf16 v[128:131], a[84:87], a[48:51], v[128:131]
  v_mfma_f32_16x16x32_bf16 v[132:135], a[84:87], a[52:55], v[132:135]
  ds_read_b64_tr_b16 a[66:67], v229 offset:36864
  buffer_load_dwordx4 v233, s[16:19], s67 offen offset:1024  lds
  v_mfma_f32_16x16x32_bf16 v[132:135], a[80:83], a[36:39], v[132:135]
  v_mfma_f32_16x16x32_bf16 v[136:139], a[80:83], a[40:43], v[136:139]
  ds_read_b64_tr_b16 a[68:69], v229 offset:40960
  v_mfma_f32_16x16x32_bf16 v[136:139], a[84:87], a[56:59], v[136:139]
  v_mfma_f32_16x16x32_bf16 v[140:143], a[84:87], a[60:63], v[140:143]
  ds_read_b64_tr_b16 a[70:71], v229 offset:45056
  v_mfma_f32_16x16x32_bf16 v[140:143], a[80:83], a[44:47], v[140:143]
  s_waitcnt lgkmcnt(4)
  v_mfma_f32_16x16x32_bf16 v[156:159], a[88:91], a[44:47], v[156:159]
  ds_read_b64_tr_b16 a[72:73], v229 offset:49152
  v_mfma_f32_16x16x32_bf16 v[156:159], a[92:95], a[60:63], v[156:159]
  buffer_load_dwordx4 v234, s[16:19], s67 offen offset:2048  lds
  v_mfma_f32_16x16x32_bf16 v[152:155], a[92:95], a[56:59], v[152:155]
  ds_read_b64_tr_b16 a[74:75], v229 offset:53248
  v_mfma_f32_16x16x32_bf16 v[152:155], a[88:91], a[40:43], v[152:155]
  v_mfma_f32_16x16x32_bf16 v[148:151], a[88:91], a[36:39], v[148:151]
  ds_read_b64_tr_b16 a[76:77], v229 offset:57344
  v_mfma_f32_16x16x32_bf16 v[148:151], a[92:95], a[52:55], v[148:151]
  v_mfma_f32_16x16x32_bf16 v[144:147], a[92:95], a[48:51], v[144:147]
  ds_read_b64_tr_b16 a[78:79], v229 offset:61440
  v_xor_b32 v229, 0x10000, v229
  v_mfma_f32_16x16x32_bf16 v[144:147], a[88:91], a[32:35], v[144:147]
  s_waitcnt lgkmcnt(4)
  v_mfma_f32_16x16x32_bf16 v[160:163], a[64:67], a[32:35], v[160:163]
  ds_read_b64_tr_b16 a[80:81], v230 offset:32768
  buffer_load_dwordx4 v235, s[16:19], s67 offen offset:3072  lds
  v_mfma_f32_16x16x32_bf16 v[160:163], a[68:71], a[48:51], v[160:163]
  v_mfma_f32_16x16x32_bf16 v[164:167], a[68:71], a[52:55], v[164:167]
  ds_read_b64_tr_b16 a[82:83], v230 offset:36864
  v_mfma_f32_16x16x32_bf16 v[164:167], a[64:67], a[36:39], v[164:167]
  v_mfma_f32_16x16x32_bf16 v[168:171], a[64:67], a[40:43], v[168:171]
  ds_read_b64_tr_b16 a[84:85], v230 offset:40960
  v_mfma_f32_16x16x32_bf16 v[168:171], a[68:71], a[56:59], v[168:171]
  v_mfma_f32_16x16x32_bf16 v[172:175], a[68:71], a[60:63], v[172:175]
  ds_read_b64_tr_b16 a[86:87], v230 offset:45056
  s_add_u32 m0, s68, 49152
  v_mfma_f32_16x16x32_bf16 v[172:175], a[64:67], a[44:47], v[172:175]
  buffer_load_dwordx4 v232, s[20:23], s67 offen offset:0  lds
  s_waitcnt lgkmcnt(4)
  v_mfma_f32_16x16x32_bf16 v[188:191], a[72:75], a[44:47], v[188:191]
  ds_read_b64_tr_b16 a[88:89], v230 offset:49152
  v_mfma_f32_16x16x32_bf16 v[188:191], a[76:79], a[60:63], v[188:191]
  v_mfma_f32_16x16x32_bf16 v[184:187], a[76:79], a[56:59], v[184:187]
  ds_read_b64_tr_b16 a[90:91], v230 offset:53248
  v_mfma_f32_16x16x32_bf16 v[184:187], a[72:75], a[40:43], v[184:187]
  v_mfma_f32_16x16x32_bf16 v[180:183], a[72:75], a[36:39], v[180:183]
  ds_read_b64_tr_b16 a[92:93], v230 offset:57344
  v_mfma_f32_16x16x32_bf16 v[180:183], a[76:79], a[52:55], v[180:183]
  v_mfma_f32_16x16x32_bf16 v[176:179], a[76:79], a[48:51], v[176:179]
  ds_read_b64_tr_b16 a[94:95], v230 offset:61440
  buffer_load_dwordx4 v233, s[20:23], s67 offen offset:1024  lds
  v_xor_b32 v230, 0x10000, v230
  v_mfma_f32_16x16x32_bf16 v[176:179], a[72:75], a[32:35], v[176:179]
  s_waitcnt lgkmcnt(4)
  v_mfma_f32_16x16x32_bf16 v[192:195], a[80:83], a[32:35], v[192:195]
  s_waitcnt vmcnt(14)
  s_barrier
  ds_read_b64_tr_b16 a[64:65], v224 offset:0
  v_mfma_f32_16x16x32_bf16 v[192:195], a[84:87], a[48:51], v[192:195]
  v_mfma_f32_16x16x32_bf16 v[196:199], a[84:87], a[52:55], v[196:199]
  ds_read_b64_tr_b16 a[66:67], v224 offset:4096
  v_mfma_f32_16x16x32_bf16 v[196:199], a[80:83], a[36:39], v[196:199]
  v_mfma_f32_16x16x32_bf16 v[200:203], a[80:83], a[40:43], v[200:203]
  ds_read_b64_tr_b16 a[68:69], v224 offset:8192
  v_mfma_f32_16x16x32_bf16 v[200:203], a[84:87], a[56:59], v[200:203]
  buffer_load_dwordx4 v234, s[20:23], s67 offen offset:2048  lds
  v_mfma_f32_16x16x32_bf16 v[204:207], a[84:87], a[60:63], v[204:207]
  ds_read_b64_tr_b16 a[70:71], v224 offset:12288
  v_mfma_f32_16x16x32_bf16 v[204:207], a[80:83], a[44:47], v[204:207]
  s_waitcnt lgkmcnt(4)
  v_mfma_f32_16x16x32_bf16 v[220:223], a[88:91], a[44:47], v[220:223]
  ds_read_b64_tr_b16 a[72:73], v224 offset:16384
  v_mfma_f32_16x16x32_bf16 v[220:223], a[92:95], a[60:63], v[220:223]
  v_mfma_f32_16x16x32_bf16 v[216:219], a[92:95], a[56:59], v[216:219]
  ds_read_b64_tr_b16 a[74:75], v224 offset:20480
  v_mfma_f32_16x16x32_bf16 v[216:219], a[88:91], a[40:43], v[216:219]
  v_mfma_f32_16x16x32_bf16 v[212:215], a[88:91], a[36:39], v[212:215]
  ds_read_b64_tr_b16 a[76:77], v224 offset:24576
  buffer_load_dwordx4 v235, s[20:23], s67 offen offset:3072  lds
  v_mfma_f32_16x16x32_bf16 v[212:215], a[92:95], a[52:55], v[212:215]
  s_add_u32 s67, s67, 458752
  s_xor_b32 s68, s68, 0x10000
  v_mfma_f32_16x16x32_bf16 v[208:211], a[92:95], a[48:51], v[208:211]
  ds_read_b64_tr_b16 a[78:79], v224 offset:28672
  v_mfma_f32_16x16x32_bf16 v[208:211], a[88:91], a[32:35], v[208:211]
  s_sub_u32 s56, s56, 1
  s_cmp_lg_u32 s56, 0
  s_cbranch_scc1 Lp3_loop
Lmk_Lp3_loop_tail:
  s_waitcnt vmcnt(8) lgkmcnt(4)
  v_mfma_f32_16x16x32_bf16 v[0:3], a[64:67], a[0:3], v[0:3]
  ds_read_b64_tr_b16 a[80:81], v225 offset:0
  v_add_f32 v242, v242, v246
  v_mfma_f32_16x16x32_bf16 v[0:3], a[68:71], a[16:19], v[0:3]
  v_add_f32 v243, v243, v247
  v_add_f32 v244, v244, v248
  v_mfma_f32_16x16x32_bf16 v[4:7], a[68:71], a[20:23], v[4:7]
  ds_read_b64_tr_b16 a[82:83], v225 offset:4096
  v_add_f32 v245, v245, v249
  v_mfma_f32_16x16x32_bf16 v[4:7], a[64:67], a[4:7], v[4:7]
  buffer_load_dwordx4 a[32:35], v231, s[4:7], s72 offen offset:2048 sc1
  ds_write_b128 v250, v[242:245]
  v_mfma_f32_16x16x32_bf16 v[8:11], a[64:67], a[8:11], v[8:11]
  ds_read_b64_tr_b16 a[84:85], v225 offset:8192
  v_mfma_f32_16x16x32_bf16 v[8:11], a[68:71], a[24:27], v[8:11]
  v_mfma_f32_16x16x32_bf16 v[12:15], a[68:71], a[28:31], v[12:15]
  ds_read_b64_tr_b16 a[86:87], v225 offset:12288
  v_mfma_f32_16x16x32_bf16 v[12:15], a[64:67], a[12:15], v[12:15]
  buffer_load_dwordx4 a[48:51], v231, s[4:7], s72 offen offset:3072 sc1
  s_waitcnt lgkmcnt(5)
  v_mfma_f32_16x16x32_bf16 v[28:31], a[72:75], a[12:15], v[28:31]
  s_add_u32 s72, s72, 4096
  ds_read_b64_tr_b16 a[88:89], v225 offset:16384
  v_mfma_f32_16x16x32_bf16 v[28:31], a[76:79], a[28:31], v[28:31]
  ds_read_b128 v[246:249], v237 offset:384
  v_mfma_f32_16x16x32_bf16 v[24:27], a[76:79], a[24:27], v[24:27]
  ds_read_b64_tr_b16 a[90:91], v225 offset:20480
  v_mfma_f32_16x16x32_bf16 v[24:27], a[72:75], a[8:11], v[24:27]
  v_mfma_f32_16x16x32_bf16 v[20:23], a[72:75], a[4:7], v[20:23]
  ds_read_b64_tr_b16 a[92:93], v225 offset:24576
  v_mfma_f32_16x16x32_bf16 v[20:23], a[76:79], a[20:23], v[20:23]
  buffer_load_dwordx4 a[36:39], v231, s[4:7], s73 offen offset:2048 sc1
  v_mfma_f32_16x16x32_bf16 v[16:19], a[76:79], a[16:19], v[16:19]
  ds_read_b64_tr_b16 a[94:95], v225 offset:28672
  v_mfma_f32_16x16x32_bf16 v[16:19], a[72:75], a[0:3], v[16:19]
  s_waitcnt lgkmcnt(5)
  v_mfma_f32_16x16x32_bf16 v[32:35], a[80:83], a[0:3], v[32:35]
  s_waitcnt lgkmcnt(3)
  ds_read_b64_tr_b16 a[64:65], v226 offset:0
  v_fmac_f32 v96, v246, v238
  v_mfma_f32_16x16x32_bf16 v[32:35], a[84:87], a[16:19], v[32:35]
  buffer_load_dwordx4 a[52:55], v231, s[4:7], s73 offen offset:3072 sc1
  ds_read_b128 v[242:245], v237 offset:0
  v_mfma_f32_16x16x32_bf16 v[36:39], a[84:87], a[20:23], v[36:39]
  s_add_u32 s73, s73, 4096
  ds_read_b64_tr_b16 a[66:67], v226 offset:4096
  v_fmac_f32 v97, v247, v238
  v_mfma_f32_16x16x32_bf16 v[36:39], a[80:83], a[4:7], v[36:39]
  v_fmac_f32 v98, v248, v238
  v_fmac_f32 v99, v249, v238
  v_mfma_f32_16x16x32_bf16 v[40:43], a[80:83], a[8:11], v[40:43]
  s_xor_b32 s93, s53, 1
  ds_read_b64_tr_b16 a[68:69], v226 offset:8192
  v_fmac_f32 v100, v246, v239
  v_mfma_f32_16x16x32_bf16 v[40:43], a[84:87], a[24:27], v[40:43]
  s_lshl_b32 s93, s93, 7
  v_fmac_f32 v101, v247, v239
  v_fmac_f32 v102, v248, v239
  v_mfma_f32_16x16x32_bf16 v[44:47], a[84:87], a[28:31], v[44:47]
  s_add_u32 s80, s24, s93
  s_addc_u32 s81, s25, 0
  ds_read_b64_tr_b16 a[70:71], v226 offset:12288
  v_fmac_f32 v103, v249, v239
  v_mfma_f32_16x16x32_bf16 v[44:47], a[80:83], a[12:15], v[44:47]
  s_sub_u32 s82, 7340032, s93
  buffer_load_dwordx4 a[40:43], v231, s[4:7], s74 offen offset:2048 sc1
  v_fmac_f32 v104, v246, v240
  s_waitcnt lgkmcnt(5)
  v_mfma_f32_16x16x32_bf16 v[60:63], a[88:91], a[12:15], v[60:63]
  s_mov_b32 s83, 0x20000
  ds_read_b64_tr_b16 a[72:73], v226 offset:16384
  v_fmac_f32 v105, v247, v240
  v_mfma_f32_16x16x32_bf16 v[60:63], a[92:95], a[28:31], v[60:63]
  s_lshl_b32 s93, s53, 7
  v_fmac_f32 v106, v248, v240
  v_fmac_f32 v107, v249, v240
  v_mfma_f32_16x16x32_bf16 v[56:59], a[92:95], a[24:27], v[56:59]
  s_add_u32 s84, s24, s93
  s_addc_u32 s85, s25, 0
  ds_read_b64_tr_b16 a[74:75], v226 offset:20480
  v_fmac_f32 v108, v246, v241
  v_mfma_f32_16x16x32_bf16 v[56:59], a[88:91], a[8:11], v[56:59]
  s_sub_u32 s84, s84, 1024
  s_subb_u32 s85, s85, 0
  buffer_load_dwordx4 a[56:59], v231, s[4:7], s74 offen offset:3072 sc1
  v_fmac_f32 v109, v247, v241
  v_mfma_f32_16x16x32_bf16 v[52:55], a[88:91], a[4:7], v[52:55]
  s_add_u32 s74, s74, 4096
  ds_read_b64_tr_b16 a[76:77], v226 offset:24576
  v_fmac_f32 v110, v248, v241
  v_mfma_f32_16x16x32_bf16 v[52:55], a[92:95], a[20:23], v[52:55]
  s_sub_u32 s86, 7341056, s93
  v_fmac_f32 v111, v249, v241
  v_mfma_f32_16x16x32_bf16 v[48:51], a[92:95], a[16:19], v[48:51]
  s_mov_b32 s87, 0x20000
  ds_read_b64_tr_b16 a[78:79], v226 offset:28672
  v_mfma_f32_16x16x32_bf16 v[48:51], a[88:91], a[0:3], v[48:51]
  s_and_b32 s93, s53, 1
  s_waitcnt lgkmcnt(4)
  v_mfma_f32_16x16x32_bf16 v[64:67], a[64:67], a[0:3], v[64:67]
  ds_read_b64_tr_b16 a[80:81], v227 offset:0
  v_fmac_f32 v0, v242, v238
  v_mfma_f32_16x16x32_bf16 v[64:67], a[68:71], a[16:19], v[64:67]
  s_mul_i32 s92, s93, 3670016
  buffer_load_dwordx4 a[44:47], v231, s[4:7], s75 offen offset:2048 sc1
  ds_read_b128 v[246:249], v237 offset:64
  v_mfma_f32_16x16x32_bf16 v[68:71], a[68:71], a[20:23], v[68:71]
  s_lshl_b32 s93, s40, 14
  ds_read_b64_tr_b16 a[82:83], v227 offset:4096
  v_fmac_f32 v1, v243, v238
  v_mfma_f32_16x16x32_bf16 v[68:71], a[64:67], a[4:7], v[68:71]
  s_add_u32 s92, s92, s93
  v_fmac_f32 v2, v244, v238
  v_fmac_f32 v3, v245, v238
  v_mfma_f32_16x16x32_bf16 v[72:75], a[64:67], a[8:11], v[72:75]
  s_lshl_b32 s79, s40, 11
  ds_read_b64_tr_b16 a[84:85], v227 offset:8192
  v_fmac_f32 v4, v242, v239
  v_mfma_f32_16x16x32_bf16 v[72:75], a[68:71], a[24:27], v[72:75]
  s_lshr_b32 s93, s53, 1
  buffer_load_dwordx4 a[60:63], v231, s[4:7], s75 offen offset:3072 sc1
  v_fmac_f32 v5, v243, v239
  v_mfma_f32_16x16x32_bf16 v[76:79], a[68:71], a[28:31], v[76:79]
  s_add_u32 s75, s75, 4096
  ds_read_b64_tr_b16 a[86:87], v227 offset:12288
  v_fmac_f32 v6, v244, v239
  v_mfma_f32_16x16x32_bf16 v[76:79], a[64:67], a[12:15], v[76:79]
  s_add_u32 s93, s93, s52
  v_fmac_f32 v7, v245, v239
  v_fmac_f32 v8, v242, v240
  s_waitcnt lgkmcnt(5)
  v_mfma_f32_16x16x32_bf16 v[92:95], a[72:75], a[12:15], v[92:95]
  s_and_b32 s93, s93, 3
  ds_read_b64_tr_b16 a[88:89], v227 offset:16384
  v_fmac_f32 v9, v243, v240
  v_mfma_f32_16x16x32_bf16 v[92:95], a[76:79], a[28:31], v[92:95]
  s_cmp_eq_u32 s93, 0
  s_cselect_b32 s88, 917504, 0
  v_fmac_f32 v10, v244, v240
  v_fmac_f32 v11, v245, v240
  v_mfma_f32_16x16x32_bf16 v[88:91], a[76:79], a[24:27], v[88:91]
  s_add_u32 m0, s68, 0
  ds_read_b64_tr_b16 a[90:91], v227 offset:20480
  v_fmac_f32 v12, v242, v241
  v_mfma_f32_16x16x32_bf16 v[88:91], a[72:75], a[8:11], v[88:91]
  s_cmp_eq_u32 s93, 1
  s_cselect_b32 s89, 917504, 0
  buffer_load_dwordx4 v232, s[16:19], s67 offen offset:0  lds
  v_fmac_f32 v13, v243, v241
  v_mfma_f32_16x16x32_bf16 v[84:87], a[72:75], a[4:7], v[84:87]
  s_cmp_eq_u32 s93, 2
  s_cselect_b32 s90, 917504, 0
  ds_read_b64_tr_b16 a[92:93], v227 offset:24576
  v_fmac_f32 v14, v244, v241
  v_mfma_f32_16x16x32_bf16 v[84:87], a[76:79], a[20:23], v[84:87]
  s_cmp_eq_u32 s93, 3
  s_cselect_b32 s91, 917504, 0
  v_fmac_f32 v15, v245, v241
  v_mfma_f32_16x16x32_bf16 v[80:83], a[76:79], a[16:19], v[80:83]
  s_cmp_eq_u32 s40, 1
  s_cselect_b32 s78, 16384, 0
  ds_read_b64_tr_b16 a[94:95], v227 offset:28672
  v_mfma_f32_16x16x32_bf16 v[80:83], a[72:75], a[0:3], v[80:83]
  s_cmp_eq_u32 s40, 2
  s_cselect_b32 s78, -16384, s78
  buffer_load_dwordx4 v233, s[16:19], s67 offen offset:1024  lds
  s_waitcnt lgkmcnt(4)
  v_mfma_f32_16x16x32_bf16 v[96:99], a[80:83], a[0:3], v[96:99]
  ds_read_b64_tr_b16 a[64:65], v228 offset:0
  v_fmac_f32 v16, v246, v238
  v_mfma_f32_16x16x32_bf16 v[96:99], a[84:87], a[16:19], v[96:99]
  s_mul_i32 s43, s69, 458752
  ds_read_b128 v[242:245], v237 offset:128
  v_fmac_f32 v17, v247, v238
  v_mfma_f32_16x16x32_bf16 v[100:103], a[84:87], a[20:23], v[100:103]
  s_lshr_b32 s45, s55, 4
  ds_read_b64_tr_b16 a[66:67], v228 offset:4096
  v_fmac_f32 v18, v248, v238
  v_mfma_f32_16x16x32_bf16 v[100:103], a[80:83], a[4:7], v[100:103]
  s_mul_i32 s45, s45, 57344
  v_fmac_f32 v19, v249, v238
  v_fmac_f32 v20, v246, v239
  v_mfma_f32_16x16x32_bf16 v[104:107], a[80:83], a[8:11], v[104:107]
  s_add_u32 s43, s43, s45
  ds_read_b64_tr_b16 a[68:69], v228 offset:8192
  v_fmac_f32 v21, v247, v239
  v_mfma_f32_16x16x32_bf16 v[104:107], a[84:87], a[24:27], v[104:107]
  s_add_u32 s43, s43, s42
  buffer_load_dwordx4 v234, s[16:19], s67 offen offset:2048  lds
  v_fmac_f32 v22, v248, v239
  v_mfma_f32_16x16x32_bf16 v[108:111], a[84:87], a[28:31], v[108:111]
  s_add_u32 s43, s43, 12582912
  ds_read_b64_tr_b16 a[70:71], v228 offset:12288
  v_fmac_f32 v23, v249, v239
  v_mfma_f32_16x16x32_bf16 v[108:111], a[80:83], a[12:15], v[108:111]
  s_and_b32 s44, s55, 15
  v_fmac_f32 v24, v246, v240
  v_fmac_f32 v25, v247, v240
  s_waitcnt lgkmcnt(5)
  v_mfma_f32_16x16x32_bf16 v[124:127], a[88:91], a[12:15], v[124:127]
  s_lshl_b32 s45, s44, 10
  ds_read_b64_tr_b16 a[72:73], v228 offset:16384
  v_fmac_f32 v26, v248, v240
  v_mfma_f32_16x16x32_bf16 v[124:127], a[92:95], a[28:31], v[124:127]
  s_add_u32 s57, s43, s45
  buffer_load_dwordx4 v235, s[16:19], s67 offen offset:3072  lds
  v_fmac_f32 v27, v249, v240
  v_mfma_f32_16x16x32_bf16 v[120:123], a[92:95], a[24:27], v[120:123]
  s_lshl_b32 s45, s44, 9
  ds_read_b64_tr_b16 a[74:75], v228 offset:20480
  v_fmac_f32 v28, v246, v241
  v_mfma_f32_16x16x32_bf16 v[120:123], a[88:91], a[8:11], v[120:123]
  s_add_u32 s61, s43, s45
  v_fmac_f32 v29, v247, v241
  v_fmac_f32 v30, v248, v241
  v_mfma_f32_16x16x32_bf16 v[116:119], a[88:91], a[4:7], v[116:119]
  s_add_u32 s61, s61, 49152
  ds_read_b64_tr_b16 a[76:77], v228 offset:24576
  v_fmac_f32 v31, v249, v241
  v_mfma_f32_16x16x32_bf16 v[116:119], a[92:95], a[20:23], v[116:119]
  s_add_u32 s62, s61, 229376
  v_mfma_f32_16x16x32_bf16 v[112:115], a[92:95], a[16:19], v[112:115]
  s_add_u32 m0, s68, 16384
  ds_read_b64_tr_b16 a[78:79], v228 offset:28672
  v_mfma_f32_16x16x32_bf16 v[112:115], a[88:91], a[0:3], v[112:115]
  s_add_u32 s58, s57, 114688
  buffer_load_dwordx4 v232, s[20:23], s67 offen offset:0  lds
  s_waitcnt lgkmcnt(4)
  v_mfma_f32_16x16x32_bf16 v[128:131], a[64:67], a[0:3], v[128:131]
  ds_read_b64_tr_b16 a[80:81], v229 offset:0
  v_fmac_f32 v32, v242, v238
  v_mfma_f32_16x16x32_bf16 v[128:131], a[68:71], a[16:19], v[128:131]
  s_add_u32 s59, s58, 114688
  ds_read_b128 v[246:249], v237 offset:192
  v_fmac_f32 v33, v243, v238
  v_mfma_f32_16x16x32_bf16 v[132:135], a[68:71], a[20:23], v[132:135]
  s_add_u32 s60, s59, 114688
  ds_read_b64_tr_b16 a[82:83], v229 offset:4096
  v_fmac_f32 v34, v244, v238
  v_mfma_f32_16x16x32_bf16 v[132:135], a[64:67], a[4:7], v[132:135]
  s_lshl_b32 s77, s54, 1
  buffer_load_dwordx4 v233, s[20:23], s67 offen offset:1024  lds
  v_fmac_f32 v35, v245, v238
  v_mfma_f32_16x16x32_bf16 v[136:139], a[64:67], a[8:11], v[136:139]
  s_lshr_b32 s43, s55, 4
  ds_read_b64_tr_b16 a[84:85], v229 offset:8192
  v_fmac_f32 v36, v242, v239
  v_mfma_f32_16x16x32_bf16 v[136:139], a[68:71], a[24:27], v[136:139]
  s_add_u32 s77, s77, s43
  v_fmac_f32 v37, v243, v239
  v_fmac_f32 v38, v244, v239
  v_mfma_f32_16x16x32_bf16 v[140:143], a[68:71], a[28:31], v[140:143]
  s_lshl_b32 s77, s77, 7
  ds_read_b64_tr_b16 a[86:87], v229 offset:12288
  v_fmac_f32 v39, v245, v239
  v_mfma_f32_16x16x32_bf16 v[140:143], a[64:67], a[12:15], v[140:143]
  s_add_u32 s77, s77, s42
  v_fmac_f32 v40, v242, v240
  v_fmac_f32 v41, v243, v240
  s_waitcnt lgkmcnt(5)
  v_mfma_f32_16x16x32_bf16 v[156:159], a[72:75], a[12:15], v[156:159]
  s_add_u32 s77, s77, 27795456
  ds_read_b64_tr_b16 a[88:89], v229 offset:16384
  v_fmac_f32 v42, v244, v240
  v_mfma_f32_16x16x32_bf16 v[156:159], a[76:79], a[28:31], v[156:159]
  s_and_b32 s43, s53, 1
  buffer_load_dwordx4 v234, s[20:23], s67 offen offset:2048  lds
  v_fmac_f32 v43, v245, v240
  v_mfma_f32_16x16x32_bf16 v[152:155], a[76:79], a[24:27], v[152:155]
  s_and_b32 s64, s52, 14
  ds_read_b64_tr_b16 a[90:91], v229 offset:20480
  v_fmac_f32 v44, v242, v241
  v_mfma_f32_16x16x32_bf16 v[152:155], a[72:75], a[8:11], v[152:155]
  s_add_u32 s64, s64, s43
  v_fmac_f32 v45, v243, v241
  v_fmac_f32 v46, v244, v241
  v_mfma_f32_16x16x32_bf16 v[148:151], a[72:75], a[4:7], v[148:151]
  s_lshl_b32 s64, s64, 7
  ds_read_b64_tr_b16 a[92:93], v229 offset:24576
  v_fmac_f32 v47, v245, v241
  v_mfma_f32_16x16x32_bf16 v[148:151], a[76:79], a[20:23], v[148:151]
  s_add_u32 s64, s64, s42
  buffer_load_dwordx4 v235, s[20:23], s67 offen offset:3072  lds
  v_mfma_f32_16x16x32_bf16 v[144:147], a[76:79], a[16:19], v[144:147]
  s_add_u32 s67, s67, 458752
  ds_read_b64_tr_b16 a[94:95], v229 offset:28672
  v_mfma_f32_16x16x32_bf16 v[144:147], a[72:75], a[0:3], v[144:147]
  s_add_u32 s64, s64, 27795456
  s_waitcnt lgkmcnt(4)
  v_mfma_f32_16x16x32_bf16 v[160:163], a[80:83], a[0:3], v[160:163]
  ds_read_b64_tr_b16 a[64:65], v230 offset:0
  v_fmac_f32 v48, v246, v238
  v_mfma_f32_16x16x32_bf16 v[160:163], a[84:87], a[16:19], v[160:163]
  s_lshl_b32 s49, s52, 3
  ds_read_b128 v[242:245], v237 offset:256
  v_fmac_f32 v49, v247, v238
  v_mfma_f32_16x16x32_bf16 v[164:167], a[84:87], a[20:23], v[164:167]
  s_lshl_b32 s43, s40, 1
  ds_read_b64_tr_b16 a[66:67], v230 offset:4096
  v_fmac_f32 v50, v248, v238
  v_mfma_f32_16x16x32_bf16 v[164:167], a[80:83], a[4:7], v[164:167]
  s_add_u32 s49, s49, s43
  buffer_load_dwordx4 a[192:195], v231, s[4:7], s72 offen offset:0 sc1
  v_fmac_f32 v51, v249, v238
  v_mfma_f32_16x16x32_bf16 v[168:171], a[80:83], a[8:11], v[168:171]
  s_lshl_b32 s76, s49, 15
  ds_read_b64_tr_b16 a[68:69], v230 offset:8192
  v_fmac_f32 v52, v246, v239
  v_mfma_f32_16x16x32_bf16 v[168:171], a[84:87], a[24:27], v[168:171]
  s_lshl_b32 s43, s53, 11
  v_fmac_f32 v53, v247, v239
  v_fmac_f32 v54, v248, v239
  v_mfma_f32_16x16x32_bf16 v[172:175], a[84:87], a[28:31], v[172:175]
  s_add_u32 s76, s76, s43
  ds_read_b64_tr_b16 a[70:71], v230 offset:12288
  v_fmac_f32 v55, v249, v239
  v_mfma_f32_16x16x32_bf16 v[172:175], a[80:83], a[12:15], v[172:175]
  s_add_u32 s76, s76, s42
  buffer_load_dwordx4 a[208:211], v231, s[4:7], s72 offen offset:1024 sc1
  v_fmac_f32 v56, v246, v240
  s_waitcnt lgkmcnt(5)
  v_mfma_f32_16x16x32_bf16 v[188:191], a[88:91], a[12:15], v[188:191]
  s_add_u32 s46, s76, 4194304
  ds_read_b64_tr_b16 a[72:73], v230 offset:16384
  v_fmac_f32 v57, v247, v240
  v_mfma_f32_16x16x32_bf16 v[188:191], a[92:95], a[28:31], v[188:191]
  s_add_u32 s47, s46, 32768
  v_fmac_f32 v58, v248, v240
  v_fmac_f32 v59, v249, v240
  v_mfma_f32_16x16x32_bf16 v[184:187], a[92:95], a[24:27], v[184:187]
  s_mul_i32 s48, s49, 114688
  ds_read_b64_tr_b16 a[74:75], v230 offset:20480
  v_fmac_f32 v60, v246, v241
  v_mfma_f32_16x16x32_bf16 v[184:187], a[88:91], a[8:11], v[184:187]
  s_and_b32 s43, s53, 1
  v_fmac_f32 v61, v247, v241
  v_fmac_f32 v62, v248, v241
  v_mfma_f32_16x16x32_bf16 v[180:183], a[88:91], a[4:7], v[180:183]
  s_mul_i32 s44, s43, 57344
  ds_read_b64_tr_b16 a[76:77], v230 offset:24576
  v_fmac_f32 v63, v249, v241
  v_mfma_f32_16x16x32_bf16 v[180:183], a[92:95], a[20:23], v[180:183]
  s_add_u32 s48, s48, s44
  buffer_load_dwordx4 a[196:199], v231, s[4:7], s73 offen offset:0 sc1
  v_mfma_f32_16x16x32_bf16 v[176:179], a[92:95], a[16:19], v[176:179]
  s_add_u32 s48, s48, s42
  ds_read_b64_tr_b16 a[78:79], v230 offset:28672
  v_mfma_f32_16x16x32_bf16 v[176:179], a[88:91], a[0:3], v[176:179]
  s_add_u32 s48, s48, 12582912
  s_waitcnt lgkmcnt(4)
  v_mfma_f32_16x16x32_bf16 v[192:195], a[64:67], a[0:3], v[192:195]
  s_waitcnt vmcnt(19)
  s_barrier
  ds_read_b64_tr_b16 a[80:81], v224 offset:32768
  v_mfma_f32_16x16x32_bf16 v[192:195], a[68:71], a[16:19], v[192:195]
  buffer_load_dwordx4 a[212:215], v231, s[4:7], s73 offen offset:1024 sc1
  ds_read_b128 v[246:249], v237 offset:320
  v_mfma_f32_16x16x32_bf16 v[196:199], a[68:71], a[20:23], v[196:199]
  ds_read_b64_tr_b16 a[82:83], v224 offset:36864
  v_fmac_f32 v64, v242, v238
  v_mfma_f32_16x16x32_bf16 v[196:199], a[64:67], a[4:7], v[196:199]
  v_fmac_f32 v65, v243, v238
  v_fmac_f32 v66, v244, v238
  v_mfma_f32_16x16x32_bf16 v[200:203], a[64:67], a[8:11], v[200:203]
  ds_read_b64_tr_b16 a[84:85], v224 offset:40960
  v_fmac_f32 v67, v245, v238
  v_mfma_f32_16x16x32_bf16 v[200:203], a[68:71], a[24:27], v[200:203]
  v_fmac_f32 v68, v242, v239
  v_fmac_f32 v69, v243, v239
  v_mfma_f32_16x16x32_bf16 v[204:207], a[68:71], a[28:31], v[204:207]
  ds_read_b64_tr_b16 a[86:87], v224 offset:45056
  v_fmac_f32 v70, v244, v239
  v_mfma_f32_16x16x32_bf16 v[204:207], a[64:67], a[12:15], v[204:207]
  s_waitcnt lgkmcnt(5)
  buffer_load_dwordx4 a[200:203], v231, s[4:7], s74 offen offset:0 sc1
  v_fmac_f32 v71, v245, v239
  v_mfma_f32_16x16x32_bf16 v[220:223], a[72:75], a[12:15], v[220:223]
  ds_read_b64_tr_b16 a[88:89], v224 offset:49152
  v_fmac_f32 v72, v242, v240
  v_mfma_f32_16x16x32_bf16 v[220:223], a[76:79], a[28:31], v[220:223]
  v_fmac_f32 v73, v243, v240
  v_fmac_f32 v74, v244, v240
  v_mfma_f32_16x16x32_bf16 v[216:219], a[76:79], a[24:27], v[216:219]
  ds_read_b64_tr_b16 a[90:91], v224 offset:53248
  v_fmac_f32 v75, v245, v240
  v_mfma_f32_16x16x32_bf16 v[216:219], a[72:75], a[8:11], v[216:219]
  buffer_load_dwordx4 a[216:219], v231, s[4:7], s74 offen offset:1024 sc1
  v_fmac_f32 v76, v242, v241
  v_mfma_f32_16x16x32_bf16 v[212:215], a[72:75], a[4:7], v[212:215]
  ds_read_b64_tr_b16 a[92:93], v224 offset:57344
  v_fmac_f32 v77, v243, v241
  v_mfma_f32_16x16x32_bf16 v[212:215], a[76:79], a[20:23], v[212:215]
  v_fmac_f32 v78, v244, v241
  v_fmac_f32 v79, v245, v241
  v_mfma_f32_16x16x32_bf16 v[208:211], a[76:79], a[16:19], v[208:211]
  ds_read_b64_tr_b16 a[94:95], v224 offset:61440
  v_xor_b32 v224, 0x10000, v224
  v_mfma_f32_16x16x32_bf16 v[208:211], a[72:75], a[0:3], v[208:211]
  s_waitcnt vmcnt(20) lgkmcnt(4)
  v_mfma_f32_16x16x32_bf16 v[0:3], a[80:83], a[32:35], v[0:3]
  ds_read_b64_tr_b16 a[64:65], v225 offset:32768
  v_fmac_f32 v80, v246, v238
  v_mfma_f32_16x16x32_bf16 v[0:3], a[84:87], a[48:51], v[0:3]
  s_waitcnt vmcnt(18)
  buffer_load_dwordx4 a[204:207], v231, s[4:7], s75 offen offset:0 sc1
  ds_read_b128 v[242:245], v237 offset:448
  v_mfma_f32_16x16x32_bf16 v[4:7], a[84:87], a[52:55], v[4:7]
  ds_read_b64_tr_b16 a[66:67], v225 offset:36864
  v_fmac_f32 v81, v247, v238
  v_mfma_f32_16x16x32_bf16 v[4:7], a[80:83], a[36:39], v[4:7]
  s_waitcnt vmcnt(17)
  v_fmac_f32 v82, v248, v238
  v_fmac_f32 v83, v249, v238
  v_mfma_f32_16x16x32_bf16 v[8:11], a[80:83], a[40:43], v[8:11]
  ds_read_b64_tr_b16 a[68:69], v225 offset:40960
  v_fmac_f32 v84, v246, v239
  v_mfma_f32_16x16x32_bf16 v[8:11], a[84:87], a[56:59], v[8:11]
  s_waitcnt vmcnt(15)
  buffer_load_dwordx4 a[220:223], v231, s[4:7], s75 offen offset:1024 sc1
  v_fmac_f32 v85, v247, v239
  v_mfma_f32_16x16x32_bf16 v[12:15], a[84:87], a[60:63], v[12:15]
  ds_read_b64_tr_b16 a[70:71], v225 offset:45056
  v_fmac_f32 v86, v248, v239
  v_mfma_f32_16x16x32_bf16 v[12:15], a[80:83], a[44:47], v[12:15]
  s_waitcnt lgkmcnt(5)
  v_fmac_f32 v87, v249, v239
  v_fmac_f32 v88, v246, v240
  v_mfma_f32_16x16x32_bf16 v[28:31], a[88:91], a[44:47], v[28:31]
  ds_read_b64_tr_b16 a[72:73], v225 offset:49152
  v_fmac_f32 v89, v247, v240
  v_mfma_f32_16x16x32_bf16 v[28:31], a[92:95], a[60:63], v[28:31]
  v_fmac_f32 v90, v248, v240
  v_fmac_f32 v91, v249, v240
  v_mfma_f32_16x16x32_bf16 v[24:27], a[92:95], a[56:59], v[24:27]
  s_add_u32 m0, s68, 32768
  ds_read_b64_tr_b16 a[74:75], v225 offset:53248
  v_fmac_f32 v92, v246, v241
  v_mfma_f32_16x16x32_bf16 v[24:27], a[88:91], a[40:43], v[24:27]
  buffer_load_dwordx4 v232, s[16:19], s67 offen offset:0  lds
  v_fmac_f32 v93, v247, v241
  v_mfma_f32_16x16x32_bf16 v[20:23], a[88:91], a[36:39], v[20:23]
  ds_read_b64_tr_b16 a[76:77], v225 offset:57344
  v_fmac_f32 v94, v248, v241
  v_mfma_f32_16x16x32_bf16 v[20:23], a[92:95], a[52:55], v[20:23]
  v_fmac_f32 v95, v249, v241
  v_mfma_f32_16x16x32_bf16 v[16:19], a[92:95], a[48:51], v[16:19]
  ds_read_b64_tr_b16 a[78:79], v225 offset:61440
  v_xor_b32 v225, 0x10000, v225
  v_mfma_f32_16x16x32_bf16 v[16:19], a[88:91], a[32:35], v[16:19]
  buffer_load_dwordx4 v233, s[16:19], s67 offen offset:1024  lds
  s_waitcnt lgkmcnt(4)
  v_mfma_f32_16x16x32_bf16 v[32:35], a[64:67], a[32:35], v[32:35]
  ds_read_b64_tr_b16 a[80:81], v226 offset:32768
  v_fmac_f32 v112, v242, v238
  v_mfma_f32_16x16x32_bf16 v[32:35], a[68:71], a[48:51], v[32:35]
  ds_read_b128 v[246:249], v237 offset:512
  v_fmac_f32 v113, v243, v238
  v_mfma_f32_16x16x32_bf16 v[36:39], a[68:71], a[52:55], v[36:39]
  ds_read_b64_tr_b16 a[82:83], v226 offset:36864
  v_fmac_f32 v114, v244, v238
  v_mfma_f32_16x16x32_bf16 v[36:39], a[64:67], a[36:39], v[36:39]
  v_fmac_f32 v115, v245, v238
  v_fmac_f32 v116, v242, v239
  v_mfma_f32_16x16x32_bf16 v[40:43], a[64:67], a[40:43], v[40:43]
  ds_read_b64_tr_b16 a[84:85], v226 offset:40960
  v_fmac_f32 v117, v243, v239
  v_mfma_f32_16x16x32_bf16 v[40:43], a[68:71], a[56:59], v[40:43]
  buffer_load_dwordx4 v234, s[16:19], s67 offen offset:2048  lds
  v_fmac_f32 v118, v244, v239
  v_mfma_f32_16x16x32_bf16 v[44:47], a[68:71], a[60:63], v[44:47]
  ds_read_b64_tr_b16 a[86:87], v226 offset:45056
  v_fmac_f32 v119, v245, v239
  v_mfma_f32_16x16x32_bf16 v[44:47], a[64:67], a[44:47], v[44:47]
  s_waitcnt lgkmcnt(5)
  v_fmac_f32 v120, v242, v240
  v_fmac_f32 v121, v243, v240
  v_mfma_f32_16x16x32_bf16 v[60:63], a[72:75], a[44:47], v[60:63]
  ds_read_b64_tr_b16 a[88:89], v226 offset:49152
  v_fmac_f32 v122, v244, v240
  v_mfma_f32_16x16x32_bf16 v[60:63], a[76:79], a[60:63], v[60:63]
  buffer_load_dwordx4 v235, s[16:19], s67 offen offset:3072  lds
  v_fmac_f32 v123, v245, v240
  v_mfma_f32_16x16x32_bf16 v[56:59], a[76:79], a[56:59], v[56:59]
  ds_read_b64_tr_b16 a[90:91], v226 offset:53248
  v_fmac_f32 v124, v242, v241
  v_mfma_f32_16x16x32_bf16 v[56:59], a[72:75], a[40:43], v[56:59]
  v_fmac_f32 v125, v243, v241
  v_fmac_f32 v126, v244, v241
  v_mfma_f32_16x16x32_bf16 v[52:55], a[72:75], a[36:39], v[52:55]
  ds_read_b64_tr_b16 a[92:93], v226 offset:57344
  v_fmac_f32 v127, v245, v241
  v_mfma_f32_16x16x32_bf16 v[52:55], a[76:79], a[52:55], v[52:55]
  v_mfma_f32_16x16x32_bf16 v[48:51], a[76:79], a[48:51], v[48:51]
  s_add_u32 m0, s68, 49152
  ds_read_b64_tr_b16 a[94:95], v226 offset:61440
  v_xor_b32 v226, 0x10000, v226
  v_mfma_f32_16x16x32_bf16 v[48:51], a[72:75], a[32:35], v[48:51]
  buffer_load_dwordx4 v232, s[20:23], s67 offen offset:0  lds
  s_waitcnt lgkmcnt(4)
  v_mfma_f32_16x16x32_bf16 v[64:67], a[80:83], a[32:35], v[64:67]
  ds_read_b64_tr_b16 a[64:65], v227 offset:32768
  v_fmac_f32 v128, v246, v238
  v_mfma_f32_16x16x32_bf16 v[64:67], a[84:87], a[48:51], v[64:67]
  ds_read_b128 v[242:245], v237 offset:576
  v_fmac_f32 v129, v247, v238
  v_mfma_f32_16x16x32_bf16 v[68:71], a[84:87], a[52:55], v[68:71]
  ds_read_b64_tr_b16 a[66:67], v227 offset:36864
  v_fmac_f32 v130, v248, v238
  v_mfma_f32_16x16x32_bf16 v[68:71], a[80:83], a[36:39], v[68:71]
  buffer_load_dwordx4 v233, s[20:23], s67 offen offset:1024  lds
  v_fmac_f32 v131, v249, v238
  v_mfma_f32_16x16x32_bf16 v[72:75], a[80:83], a[40:43], v[72:75]
  ds_read_b64_tr_b16 a[68:69], v227 offset:40960
  v_fmac_f32 v132, v246, v239
  v_mfma_f32_16x16x32_bf16 v[72:75], a[84:87], a[56:59], v[72:75]
  v_fmac_f32 v133, v247, v239
  v_fmac_f32 v134, v248, v239
  v_mfma_f32_16x16x32_bf16 v[76:79], a[84:87], a[60:63], v[76:79]
  ds_read_b64_tr_b16 a[70:71], v227 offset:45056
  v_fmac_f32 v135, v249, v239
  v_mfma_f32_16x16x32_bf16 v[76:79], a[80:83], a[44:47], v[76:79]
  s_waitcnt lgkmcnt(5)
  v_fmac_f32 v136, v246, v240
  v_fmac_f32 v137, v247, v240
  v_mfma_f32_16x16x32_bf16 v[92:95], a[88:91], a[44:47], v[92:95]
  ds_read_b64_tr_b16 a[72:73], v227 offset:49152
  v_fmac_f32 v138, v248, v240
  v_mfma_f32_16x16x32_bf16 v[92:95], a[92:95], a[60:63], v[92:95]
  buffer_load_dwordx4 v234, s[20:23], s67 offen offset:2048  lds
  v_fmac_f32 v139, v249, v240
  v_mfma_f32_16x16x32_bf16 v[88:91], a[92:95], a[56:59], v[88:91]
  ds_read_b64_tr_b16 a[74:75], v227 offset:53248
  v_fmac_f32 v140, v246, v241
  v_mfma_f32_16x16x32_bf16 v[88:91], a[88:91], a[40:43], v[88:91]
  v_fmac_f32 v141, v247, v241
  v_fmac_f32 v142, v248, v241
  v_mfma_f32_16x16x32_bf16 v[84:87], a[88:91], a[36:39], v[84:87]
  ds_read_b64_tr_b16 a[76:77], v227 offset:57344
  v_fmac_f32 v143, v249, v241
  v_mfma_f32_16x16x32_bf16 v[84:87], a[92:95], a[52:55], v[84:87]
  buffer_load_dwordx4 v235, s[20:23], s67 offen offset:3072  lds
  v_mfma_f32_16x16x32_bf16 v[80:83], a[92:95], a[48:51], v[80:83]
  s_add_u32 s67, s67, 458752
  s_xor_b32 s68, s68, 0x10000
  ds_read_b64_tr_b16 a[78:79], v227 offset:61440
  v_xor_b32 v227, 0x10000, v227
  v_mfma_f32_16x16x32_bf16 v[80:83], a[88:91], a[32:35], v[80:83]
  s_waitcnt lgkmcnt(4)
  v_mfma_f32_16x16x32_bf16 v[96:99], a[64:67], a[32:35], v[96:99]
  s_waitcnt vmcnt(16)
  s_barrier
  ds_read_b64_tr_b16 a[80:81], v224 offset:0
  v_mfma_f32_16x16x32_bf16 v[96:99], a[68:71], a[48:51], v[96:99]
  ds_read_b128 v[246:249], v237 offset:640
  v_fmac_f32 v144, v242, v238
  v_mfma_f32_16x16x32_bf16 v[100:103], a[68:71], a[52:55], v[100:103]
  ds_read_b64_tr_b16 a[82:83], v224 offset:4096
  v_fmac_f32 v145, v243, v238
  v_mfma_f32_16x16x32_bf16 v[100:103], a[64:67], a[36:39], v[100:103]
  buffer_load_dwordx4 a[224:227], v231, s[4:7], s72 offen offset:2048 sc1
  v_fmac_f32 v146, v244, v238
  v_mfma_f32_16x16x32_bf16 v[104:107], a[64:67], a[40:43], v[104:107]
  ds_read_b64_tr_b16 a[84:85], v224 offset:8192
  v_fmac_f32 v147, v245, v238
  v_mfma_f32_16x16x32_bf16 v[104:107], a[68:71], a[56:59], v[104:107]
  v_fmac_f32 v148, v242, v239
  v_fmac_f32 v149, v243, v239
  v_mfma_f32_16x16x32_bf16 v[108:111], a[68:71], a[60:63], v[108:111]
  ds_read_b64_tr_b16 a[86:87], v224 offset:12288
  v_fmac_f32 v150, v244, v239
  v_mfma_f32_16x16x32_bf16 v[108:111], a[64:67], a[44:47], v[108:111]
  s_waitcnt lgkmcnt(5)
  buffer_load_dwordx4 a[240:243], v231, s[4:7], s72 offen offset:3072 sc1
  v_fmac_f32 v151, v245, v239
  v_mfma_f32_16x16x32_bf16 v[124:127], a[72:75], a[44:47], v[124:127]
  s_add_u32 s72, s72, 4096
  ds_read_b64_tr_b16 a[88:89], v224 offset:16384
  v_fmac_f32 v152, v242, v240
  v_mfma_f32_16x16x32_bf16 v[124:127], a[76:79], a[60:63], v[124:127]
  v_fmac_f32 v153, v243, v240
  v_fmac_f32 v154, v244, v240
  v_mfma_f32_16x16x32_bf16 v[120:123], a[76:79], a[56:59], v[120:123]
  ds_read_b64_tr_b16 a[90:91], v224 offset:20480
  v_fmac_f32 v155, v245, v240
  v_mfma_f32_16x16x32_bf16 v[120:123], a[72:75], a[40:43], v[120:123]
  v_fmac_f32 v156, v242, v241
  v_fmac_f32 v157, v243, v241
  v_mfma_f32_16x16x32_bf16 v[116:119], a[72:75], a[36:39], v[116:119]
  ds_read_b64_tr_b16 a[92:93], v224 offset:24576
  v_fmac_f32 v158, v244, v241
  v_mfma_f32_16x16x32_bf16 v[116:119], a[76:79], a[52:55], v[116:119]
  buffer_load_dwordx4 a[228:231], v231, s[4:7], s73 offen offset:2048 sc1
  v_fmac_f32 v159, v245, v241
  v_mfma_f32_16x16x32_bf16 v[112:115], a[76:79], a[48:51], v[112:115]
  ds_read_b64_tr_b16 a[94:95], v224 offset:28672
  v_mfma_f32_16x16x32_bf16 v[112:115], a[72:75], a[32:35], v[112:115]
  s_waitcnt vmcnt(17) lgkmcnt(4)
  v_mfma_f32_16x16x32_bf16 v[0:3], a[80:83], a[192:195], v[0:3]
  ds_read_b64_tr_b16 a[64:65], v225 offset:0
  v_fmac_f32 v160, v246, v238
  v_mfma_f32_16x16x32_bf16 v[0:3], a[84:87], a[208:211], v[0:3]
  s_waitcnt vmcnt(15)
  buffer_load_dwordx4 a[244:247], v231, s[4:7], s73 offen offset:3072 sc1
  ds_read_b128 v[242:245], v237 offset:704
  v_mfma_f32_16x16x32_bf16 v[4:7], a[84:87], a[212:215], v[4:7]
  s_add_u32 s73, s73, 4096
  ds_read_b64_tr_b16 a[66:67], v225 offset:4096
  v_fmac_f32 v161, v247, v238
  v_mfma_f32_16x16x32_bf16 v[4:7], a[80:83], a[196:199], v[4:7]
  s_waitcnt vmcnt(14)
  v_fmac_f32 v162, v248, v238
  v_fmac_f32 v163, v249, v238
  v_mfma_f32_16x16x32_bf16 v[8:11], a[80:83], a[200:203], v[8:11]
  ds_read_b64_tr_b16 a[68:69], v225 offset:8192
  v_fmac_f32 v164, v246, v239
  v_mfma_f32_16x16x32_bf16 v[8:11], a[84:87], a[216:219], v[8:11]
  s_waitcnt vmcnt(12)
  v_fmac_f32 v165, v247, v239
  v_fmac_f32 v166, v248, v239
  v_mfma_f32_16x16x32_bf16 v[12:15], a[84:87], a[220:223], v[12:15]
  ds_read_b64_tr_b16 a[70:71], v225 offset:12288
  v_fmac_f32 v167, v249, v239
  v_mfma_f32_16x16x32_bf16 v[12:15], a[80:83], a[204:207], v[12:15]
  s_waitcnt lgkmcnt(5)
  buffer_load_dwordx4 a[232:235], v231, s[4:7], s74 offen offset:2048 sc1
  v_fmac_f32 v168, v246, v240
  v_mfma_f32_16x16x32_bf16 v[28:31], a[88:91], a[204:207], v[28:31]
  ds_read_b64_tr_b16 a[72:73], v225 offset:16384
  v_fmac_f32 v169, v247, v240
  v_mfma_f32_16x16x32_bf16 v[28:31], a[92:95], a[220:223], v[28:31]
  v_fmac_f32 v170, v248, v240
  v_fmac_f32 v171, v249, v240
  v_mfma_f32_16x16x32_bf16 v[24:27], a[92:95], a[216:219], v[24:27]
  ds_read_b64_tr_b16 a[74:75], v225 offset:20480
  v_fmac_f32 v172, v246, v241
  v_mfma_f32_16x16x32_bf16 v[24:27], a[88:91], a[200:203], v[24:27]
  buffer_load_dwordx4 a[248:251], v231, s[4:7], s74 offen offset:3072 sc1
  v_fmac_f32 v173, v247, v241
  v_mfma_f32_16x16x32_bf16 v[20:23], a[88:91], a[196:199], v[20:23]
  s_add_u32 s74, s74, 4096
  ds_read_b64_tr_b16 a[76:77], v225 offset:24576
  v_fmac_f32 v174, v248, v241
  v_mfma_f32_16x16x32_bf16 v[20:23], a[92:95], a[212:215], v[20:23]
  v_fmac_f32 v175, v249, v241
  v_mfma_f32_16x16x32_bf16 v[16:19], a[92:95], a[208:211], v[16:19]
  ds_read_b64_tr_b16 a[78:79], v225 offset:28672
  v_mfma_f32_16x16x32_bf16 v[16:19], a[88:91], a[192:195], v[16:19]
  s_waitcnt lgkmcnt(4)
  v_mfma_f32_16x16x32_bf16 v[32:35], a[64:67], a[192:195], v[32:35]
  ds_read_b64_tr_b16 a[80:81], v226 offset:0
  v_fmac_f32 v176, v242, v238
  v_mfma_f32_16x16x32_bf16 v[32:35], a[68:71], a[208:211], v[32:35]
  buffer_load_dwordx4 a[236:239], v231, s[4:7], s75 offen offset:2048 sc1
  ds_read_b128 v[246:249], v237 offset:768
  v_mfma_f32_16x16x32_bf16 v[36:39], a[68:71], a[212:215], v[36:39]
  ds_read_b64_tr_b16 a[82:83], v226 offset:4096
  v_fmac_f32 v177, v243, v238
  v_mfma_f32_16x16x32_bf16 v[36:39], a[64:67], a[196:199], v[36:39]
  v_fmac_f32 v178, v244, v238
  v_fmac_f32 v179, v245, v238
  v_mfma_f32_16x16x32_bf16 v[40:43], a[64:67], a[200:203], v[40:43]
  ds_read_b64_tr_b16 a[84:85], v226 offset:8192
  v_fmac_f32 v180, v242, v239
  v_mfma_f32_16x16x32_bf16 v[40:43], a[68:71], a[216:219], v[40:43]
  buffer_load_dwordx4 a[252:255], v231, s[4:7], s75 offen offset:3072 sc1
  v_fmac_f32 v181, v243, v239
  v_mfma_f32_16x16x32_bf16 v[44:47], a[68:71], a[220:223], v[44:47]
  s_add_u32 s75, s75, 4096
  ds_read_b64_tr_b16 a[86:87], v226 offset:12288
  v_fmac_f32 v182, v244, v239
  v_mfma_f32_16x16x32_bf16 v[44:47], a[64:67], a[204:207], v[44:47]
  s_waitcnt lgkmcnt(5)
  v_fmac_f32 v183, v245, v239
  v_fmac_f32 v184, v242, v240
  v_mfma_f32_16x16x32_bf16 v[60:63], a[72:75], a[204:207], v[60:63]
  ds_read_b64_tr_b16 a[88:89], v226 offset:16384
  v_fmac_f32 v185, v243, v240
  v_mfma_f32_16x16x32_bf16 v[60:63], a[76:79], a[220:223], v[60:63]
  v_fmac_f32 v186, v244, v240
  v_fmac_f32 v187, v245, v240
  v_mfma_f32_16x16x32_bf16 v[56:59], a[76:79], a[216:219], v[56:59]
  ds_read_b64_tr_b16 a[90:91], v226 offset:20480
  v_fmac_f32 v188, v242, v241
  v_mfma_f32_16x16x32_bf16 v[56:59], a[72:75], a[200:203], v[56:59]
  s_add_u32 m0, s79, 0
  v_fmac_f32 v189, v243, v241
  v_fmac_f32 v190, v244, v241
  v_mfma_f32_16x16x32_bf16 v[52:55], a[72:75], a[196:199], v[52:55]
  s_add_u32 s92, s92, 0
  s_add_u32 s93, s92, s88
  ds_read_b64_tr_b16 a[92:93], v226 offset:24576
  v_fmac_f32 v191, v245, v241
  v_mfma_f32_16x16x32_bf16 v[52:55], a[76:79], a[212:215], v[52:55]
  buffer_load_dwordx4 v252, s[80:83], s93 offen lds
  v_mfma_f32_16x16x32_bf16 v[48:51], a[76:79], a[208:211], v[48:51]
  ds_read_b64_tr_b16 a[94:95], v226 offset:28672
  v_mfma_f32_16x16x32_bf16 v[48:51], a[72:75], a[192:195], v[48:51]
  s_waitcnt lgkmcnt(4)
  v_mfma_f32_16x16x32_bf16 v[64:67], a[80:83], a[192:195], v[64:67]
  ds_read_b64_tr_b16 a[64:65], v228 offset:32768
  v_fmac_f32 v192, v246, v238
  v_mfma_f32_16x16x32_bf16 v[64:67], a[84:87], a[208:211], v[64:67]
  ds_read_b128 v[242:245], v237 offset:832
  v_fmac_f32 v193, v247, v238
  v_mfma_f32_16x16x32_bf16 v[68:71], a[84:87], a[212:215], v[68:71]
  ds_read_b64_tr_b16 a[66:67], v228 offset:36864
  v_fmac_f32 v194, v248, v238
  v_mfma_f32_16x16x32_bf16 v[68:71], a[80:83], a[196:199], v[68:71]
  buffer_load_dwordx4 v252, s[84:87], s93 offen offset:1024 lds
  v_fmac_f32 v195, v249, v238
  v_fmac_f32 v196, v246, v239
  v_mfma_f32_16x16x32_bf16 v[72:75], a[80:83], a[200:203], v[72:75]
  ds_read_b64_tr_b16 a[68:69], v228 offset:40960
  v_fmac_f32 v197, v247, v239
  v_mfma_f32_16x16x32_bf16 v[72:75], a[84:87], a[216:219], v[72:75]
  v_fmac_f32 v198, v248, v239
  v_fmac_f32 v199, v249, v239
  v_mfma_f32_16x16x32_bf16 v[76:79], a[84:87], a[220:223], v[76:79]
  ds_read_b64_tr_b16 a[70:71], v228 offset:45056
  v_fmac_f32 v200, v246, v240
  v_mfma_f32_16x16x32_bf16 v[76:79], a[80:83], a[204:207], v[76:79]
  s_add_u32 m0, s79, 8192
  v_fmac_f32 v201, v247, v240
  v_fmac_f32 v202, v248, v240
  s_waitcnt lgkmcnt(5)
  v_mfma_f32_16x16x32_bf16 v[92:95], a[88:91], a[204:207], v[92:95]
  s_add_u32 s92, s92, 262144
  s_add_u32 s93, s92, s89
  ds_read_b64_tr_b16 a[72:73], v228 offset:49152
  v_fmac_f32 v203, v249, v240
  v_mfma_f32_16x16x32_bf16 v[92:95], a[92:95], a[220:223], v[92:95]
  buffer_load_dwordx4 v252, s[80:83], s93 offen lds
  v_fmac_f32 v204, v246, v241
  v_fmac_f32 v205, v247, v241
  v_mfma_f32_16x16x32_bf16 v[88:91], a[92:95], a[216:219], v[88:91]
  ds_read_b64_tr_b16 a[74:75], v228 offset:53248
  v_fmac_f32 v206, v248, v241
  v_mfma_f32_16x16x32_bf16 v[88:91], a[88:91], a[200:203], v[88:91]
  v_fmac_f32 v207, v249, v241
  v_mfma_f32_16x16x32_bf16 v[84:87], a[88:91], a[196:199], v[84:87]
  ds_read_b64_tr_b16 a[76:77], v228 offset:57344
  v_mfma_f32_16x16x32_bf16 v[84:87], a[92:95], a[212:215], v[84:87]
  v_mfma_f32_16x16x32_bf16 v[80:83], a[92:95], a[208:211], v[80:83]
  ds_read_b64_tr_b16 a[78:79], v228 offset:61440
  v_xor_b32 v228, 0x10000, v228
  v_mfma_f32_16x16x32_bf16 v[80:83], a[88:91], a[192:195], v[80:83]
  buffer_load_dwordx4 v252, s[84:87], s93 offen offset:1024 lds
  s_waitcnt lgkmcnt(4)
  v_mfma_f32_16x16x32_bf16 v[128:131], a[64:67], a[32:35], v[128:131]
  s_waitcnt vmcnt(12)
  s_barrier
  ds_read_b64_tr_b16 a[80:81], v224 offset:32768
  v_mfma_f32_16x16x32_bf16 v[128:131], a[68:71], a[48:51], v[128:131]
  v_fmac_f32 v208, v242, v238
  v_fmac_f32 v209, v243, v238
  v_mfma_f32_16x16x32_bf16 v[132:135], a[68:71], a[52:55], v[132:135]
  ds_read_b64_tr_b16 a[82:83], v224 offset:36864
  v_fmac_f32 v210, v244, v238
  v_mfma_f32_16x16x32_bf16 v[132:135], a[64:67], a[36:39], v[132:135]
  s_add_u32 m0, s79, 16384
  v_fmac_f32 v211, v245, v238
  v_fmac_f32 v212, v242, v239
  v_mfma_f32_16x16x32_bf16 v[136:139], a[64:67], a[40:43], v[136:139]
  s_add_u32 s92, s92, 196608
  s_add_u32 s93, s92, s90
  ds_read_b64_tr_b16 a[84:85], v224 offset:40960
  v_fmac_f32 v213, v243, v239
  v_mfma_f32_16x16x32_bf16 v[136:139], a[68:71], a[56:59], v[136:139]
  buffer_load_dwordx4 v252, s[80:83], s93 offen lds
  v_fmac_f32 v214, v244, v239
  v_fmac_f32 v215, v245, v239
  v_mfma_f32_16x16x32_bf16 v[140:143], a[68:71], a[60:63], v[140:143]
  ds_read_b64_tr_b16 a[86:87], v224 offset:45056
  v_fmac_f32 v216, v242, v240
  v_mfma_f32_16x16x32_bf16 v[140:143], a[64:67], a[44:47], v[140:143]
  s_waitcnt lgkmcnt(4)
  v_fmac_f32 v217, v243, v240
  v_fmac_f32 v218, v244, v240
  v_mfma_f32_16x16x32_bf16 v[156:159], a[72:75], a[44:47], v[156:159]
  ds_read_b64_tr_b16 a[88:89], v224 offset:49152
  v_fmac_f32 v219, v245, v240
  v_mfma_f32_16x16x32_bf16 v[156:159], a[76:79], a[60:63], v[156:159]
  v_fmac_f32 v220, v242, v241
  v_fmac_f32 v221, v243, v241
  v_mfma_f32_16x16x32_bf16 v[152:155], a[76:79], a[56:59], v[152:155]
  ds_read_b64_tr_b16 a[90:91], v224 offset:53248
  v_fmac_f32 v222, v244, v241
  v_mfma_f32_16x16x32_bf16 v[152:155], a[72:75], a[40:43], v[152:155]
  buffer_load_dwordx4 v252, s[84:87], s93 offen offset:1024 lds
  v_fmac_f32 v223, v245, v241
  v_mfma_f32_16x16x32_bf16 v[148:151], a[72:75], a[36:39], v[148:151]
  ds_read_b64_tr_b16 a[92:93], v224 offset:57344
  v_mfma_f32_16x16x32_bf16 v[148:151], a[76:79], a[52:55], v[148:151]
  v_mfma_f32_16x16x32_bf16 v[144:147], a[76:79], a[48:51], v[144:147]
  ds_read_b64_tr_b16 a[94:95], v224 offset:61440
  v_mfma_f32_16x16x32_bf16 v[144:147], a[72:75], a[32:35], v[144:147]
  s_add_u32 m0, s79, 24576
  s_waitcnt vmcnt(12) lgkmcnt(4)
  v_mfma_f32_16x16x32_bf16 v[0:3], a[80:83], a[224:227], v[0:3]
  s_add_u32 s92, s92, 262144
  s_add_u32 s93, s92, s91
  ds_read_b64_tr_b16 a[64:65], v229 offset:32768
  v_and_b32 v236, 31, v253
  v_mfma_f32_16x16x32_bf16 v[0:3], a[84:87], a[240:243], v[0:3]
  s_waitcnt vmcnt(10)
  buffer_load_dwordx4 v252, s[80:83], s93 offen lds
  v_lshlrev_b32 v236, 4, v236
  v_mfma_f32_16x16x32_bf16 v[4:7], a[84:87], a[244:247], v[4:7]
  ds_read_b64_tr_b16 a[66:67], v229 offset:36864
  v_lshrrev_b32 v250, 5, v253
  v_mfma_f32_16x16x32_bf16 v[4:7], a[80:83], a[228:231], v[4:7]
  s_mov_b32 s43, 114688
  v_mad_u32_u24 v236, v250, s43, v236
  v_and_b32 v250, 15, v253
  s_waitcnt vmcnt(9)
  v_mfma_f32_16x16x32_bf16 v[8:11], a[80:83], a[232:235], v[8:11]
  s_add_u32 s43, s71, 1024
  ds_read_b64_tr_b16 a[68:69], v229 offset:40960
  v_lshl_add_u32 v250, v250, 2, s43
  v_mfma_f32_16x16x32_bf16 v[8:11], a[84:87], a[248:251], v[8:11]
  s_waitcnt vmcnt(7)
  ds_read2_b32 v[238:239], v250 offset0:64 offset1:80
  ds_read2_b32 v[240:241], v250 offset0:96 offset1:112
  v_mfma_f32_16x16x32_bf16 v[12:15], a[84:87], a[252:255], v[12:15]
  ds_read_b64_tr_b16 a[70:71], v229 offset:45056
  ds_read2_b32 v[232:233], v250 offset0:128 offset1:144
  v_mfma_f32_16x16x32_bf16 v[12:15], a[80:83], a[236:239], v[12:15]
  s_waitcnt lgkmcnt(7)
  buffer_load_dwordx4 v252, s[84:87], s93 offen offset:1024 lds
  ds_read2_b32 v[234:235], v250 offset0:160 offset1:176
  v_mfma_f32_16x16x32_bf16 v[28:31], a[88:91], a[236:239], v[28:31]
  ds_read_b64_tr_b16 a[72:73], v229 offset:49152
  v_mfma_f32_16x16x32_bf16 v[28:31], a[92:95], a[252:255], v[28:31]
  v_mfma_f32_16x16x32_bf16 v[24:27], a[92:95], a[248:251], v[24:27]
  ds_read_b64_tr_b16 a[74:75], v229 offset:53248
  v_mfma_f32_16x16x32_bf16 v[24:27], a[88:91], a[232:235], v[24:27]
  v_mfma_f32_16x16x32_bf16 v[20:23], a[88:91], a[228:231], v[20:23]
  ds_read_b64_tr_b16 a[76:77], v229 offset:57344
  v_mfma_f32_16x16x32_bf16 v[20:23], a[92:95], a[244:247], v[20:23]
  v_mfma_f32_16x16x32_bf16 v[16:19], a[92:95], a[240:243], v[16:19]
  ds_read_b64_tr_b16 a[78:79], v229 offset:61440
  v_xor_b32 v229, 0x10000, v229
  v_mfma_f32_16x16x32_bf16 v[16:19], a[88:91], a[224:227], v[16:19]
  s_waitcnt lgkmcnt(6)
  v_mfma_f32_16x16x32_bf16 v[160:163], a[64:67], a[32:35], v[160:163]
  ds_read_b64_tr_b16 a[80:81], v225 offset:32768
  v_mfma_f32_16x16x32_bf16 v[160:163], a[68:71], a[48:51], v[160:163]
  v_mfma_f32_16x16x32_bf16 v[164:167], a[68:71], a[52:55], v[164:167]
  s_waitcnt lgkmcnt(5)
  ds_read_b64_tr_b16 a[82:83], v225 offset:36864
  v_mfma_f32_16x16x32_bf16 v[164:167], a[64:67], a[36:39], v[164:167]
  v_pk_mul_f32 v[242:243], v[0:1], v[238:239] op_sel:[0,0] op_sel_hi:[1,0]
  v_pk_mul_f32 v[244:245], v[2:3], v[238:239] op_sel:[0,0] op_sel_hi:[1,0]
  v_pk_mul_f32 v[0:1], v[0:1], v[16:17]
  v_pk_mul_f32 v[2:3], v[2:3], v[18:19]
  v_mfma_f32_16x16x32_bf16 v[168:171], a[64:67], a[40:43], v[168:171]
  ds_read_b64_tr_b16 a[84:85], v225 offset:40960
  v_mfma_f32_16x16x32_bf16 v[168:171], a[68:71], a[56:59], v[168:171]
  v_mfma_f32_16x16x32_bf16 v[172:175], a[68:71], a[60:63], v[172:175]
  ds_read_b64_tr_b16 a[86:87], v225 offset:45056
  v_mfma_f32_16x16x32_bf16 v[172:175], a[64:67], a[44:47], v[172:175]
  s_waitcnt lgkmcnt(4)
  v_mfma_f32_16x16x32_bf16 v[188:191], a[72:75], a[44:47], v[188:191]
  v_exp_f32 v242, v242
  v_mfma_f32_16x16x32_bf16 v[188:191], a[76:79], a[60:63], v[188:191]
  v_exp_f32 v243, v243
  v_mfma_f32_16x16x32_bf16 v[184:187], a[76:79], a[56:59], v[184:187]
  ds_read_b64_tr_b16 a[88:89], v225 offset:49152
  ds_read_b64_tr_b16 a[90:91], v225 offset:53248
  v_mfma_f32_16x16x32_bf16 v[184:187], a[72:75], a[40:43], v[184:187]
  v_exp_f32 v244, v244
  v_exp_f32 v245, v245
  s_nop 0
  v_pk_fma_f32 v[242:243], v[242:243], v[232:233], v[232:233] op_sel:[0,0,0] op_sel_hi:[1,0,0]
  v_pk_fma_f32 v[244:245], v[244:245], v[232:233], v[232:233] op_sel:[0,0,0] op_sel_hi:[1,0,0]
  v_pk_mul_f32 v[246:247], v[4:5], v[238:239] op_sel:[0,1] op_sel_hi:[1,1]
  v_pk_mul_f32 v[248:249], v[6:7], v[238:239] op_sel:[0,1] op_sel_hi:[1,1]
  v_pk_mul_f32 v[4:5], v[4:5], v[20:21]
  v_pk_mul_f32 v[6:7], v[6:7], v[22:23]
  v_rcp_f32 v242, v242
  v_mfma_f32_16x16x32_bf16 v[180:183], a[72:75], a[36:39], v[180:183]
  v_rcp_f32 v243, v243
  v_mfma_f32_16x16x32_bf16 v[180:183], a[76:79], a[52:55], v[180:183]
  v_rcp_f32 v244, v244
  v_mfma_f32_16x16x32_bf16 v[176:179], a[76:79], a[48:51], v[176:179]
  ds_read_b64_tr_b16 a[92:93], v225 offset:57344
  v_mfma_f32_16x16x32_bf16 v[176:179], a[72:75], a[32:35], v[176:179]
  ds_read_b64_tr_b16 a[94:95], v225 offset:61440
  s_waitcnt lgkmcnt(4)
  v_mfma_f32_16x16x32_bf16 v[32:35], a[80:83], a[224:227], v[32:35]
  v_exp_f32 v246, v246
  v_mfma_f32_16x16x32_bf16 v[32:35], a[84:87], a[240:243], v[32:35]
  v_exp_f32 v247, v247
  v_mfma_f32_16x16x32_bf16 v[36:39], a[84:87], a[244:247], v[36:39]
  ds_read_b64_tr_b16 a[64:65], v230 offset:32768
  ds_read_b64_tr_b16 a[66:67], v230 offset:36864
  v_mfma_f32_16x16x32_bf16 v[36:39], a[80:83], a[228:231], v[36:39]
  v_exp_f32 v248, v248
  v_exp_f32 v249, v249
  v_rcp_f32 v245, v245
  v_pk_fma_f32 v[246:247], v[246:247], v[232:233], v[232:233] op_sel:[0,1,1] op_sel_hi:[1,1,1]
  v_pk_fma_f32 v[248:249], v[248:249], v[232:233], v[232:233] op_sel:[0,1,1] op_sel_hi:[1,1,1]
  v_pk_mul_f32 v[0:1], v[0:1], v[242:243]
  v_pk_mul_f32 v[2:3], v[2:3], v[244:245]
  v_pk_mul_f32 v[242:243], v[8:9], v[240:241] op_sel:[0,0] op_sel_hi:[1,0]
  v_pk_mul_f32 v[244:245], v[10:11], v[240:241] op_sel:[0,0] op_sel_hi:[1,0]
  v_pk_mul_f32 v[8:9], v[8:9], v[24:25]
  v_pk_mul_f32 v[10:11], v[10:11], v[26:27]
  v_rcp_f32 v246, v246
  v_mfma_f32_16x16x32_bf16 v[40:43], a[80:83], a[232:235], v[40:43]
  v_rcp_f32 v247, v247
  v_mfma_f32_16x16x32_bf16 v[40:43], a[84:87], a[248:251], v[40:43]
  v_rcp_f32 v248, v248
  v_mfma_f32_16x16x32_bf16 v[44:47], a[84:87], a[252:255], v[44:47]
  ds_read_b64_tr_b16 a[68:69], v230 offset:40960
  v_cvt_pk_bf16_f32 v16, v0, v1
  v_mfma_f32_16x16x32_bf16 v[44:47], a[80:83], a[236:239], v[44:47]
  s_waitcnt lgkmcnt(3)
  ds_read_b64_tr_b16 a[70:71], v230 offset:45056
  v_cvt_pk_bf16_f32 v17, v2, v3
  v_mfma_f32_16x16x32_bf16 v[60:63], a[88:91], a[236:239], v[60:63]
  v_exp_f32 v242, v242
  v_mfma_f32_16x16x32_bf16 v[60:63], a[92:95], a[252:255], v[60:63]
  v_exp_f32 v243, v243
  v_mfma_f32_16x16x32_bf16 v[56:59], a[92:95], a[248:251], v[56:59]
  ds_read_b64_tr_b16 a[72:73], v230 offset:49152
  ds_read_b64_tr_b16 a[74:75], v230 offset:53248
  v_mfma_f32_16x16x32_bf16 v[56:59], a[88:91], a[232:235], v[56:59]
  v_exp_f32 v244, v244
  v_exp_f32 v245, v245
  v_rcp_f32 v249, v249
  v_pk_fma_f32 v[242:243], v[242:243], v[234:235], v[234:235] op_sel:[0,0,0] op_sel_hi:[1,0,0]
  v_pk_fma_f32 v[244:245], v[244:245], v[234:235], v[234:235] op_sel:[0,0,0] op_sel_hi:[1,0,0]
  v_pk_mul_f32 v[4:5], v[4:5], v[246:247]
  v_pk_mul_f32 v[6:7], v[6:7], v[248:249]
  v_pk_mul_f32 v[246:247], v[12:13], v[240:241] op_sel:[0,1] op_sel_hi:[1,1]
  v_pk_mul_f32 v[248:249], v[14:15], v[240:241] op_sel:[0,1] op_sel_hi:[1,1]
  v_pk_mul_f32 v[12:13], v[12:13], v[28:29]
  v_pk_mul_f32 v[14:15], v[14:15], v[30:31]
  v_rcp_f32 v242, v242
  v_mfma_f32_16x16x32_bf16 v[52:55], a[88:91], a[228:231], v[52:55]
  v_rcp_f32 v243, v243
  v_mfma_f32_16x16x32_bf16 v[52:55], a[92:95], a[244:247], v[52:55]
  v_rcp_f32 v244, v244
  v_mfma_f32_16x16x32_bf16 v[48:51], a[92:95], a[240:243], v[48:51]
  ds_read_b64_tr_b16 a[76:77], v230 offset:57344
  v_cvt_pk_bf16_f32 v20, v4, v5
  v_mfma_f32_16x16x32_bf16 v[48:51], a[88:91], a[224:227], v[48:51]
  s_waitcnt lgkmcnt(3)
  ds_read_b64_tr_b16 a[78:79], v230 offset:61440
  v_xor_b32 v230, 0x10000, v230
  v_cvt_pk_bf16_f32 v21, v6, v7
  v_mfma_f32_16x16x32_bf16 v[192:195], a[64:67], a[32:35], v[192:195]
  v_exp_f32 v246, v246
  v_mfma_f32_16x16x32_bf16 v[192:195], a[68:71], a[48:51], v[192:195]
  v_exp_f32 v247, v247
  v_mfma_f32_16x16x32_bf16 v[196:199], a[68:71], a[52:55], v[196:199]
  ds_read_b64_tr_b16 a[80:81], v226 offset:32768
  ds_read_b64_tr_b16 a[82:83], v226 offset:36864
  v_mfma_f32_16x16x32_bf16 v[196:199], a[64:67], a[36:39], v[196:199]
  v_exp_f32 v248, v248
  v_exp_f32 v249, v249
  v_rcp_f32 v245, v245
  v_pk_fma_f32 v[246:247], v[246:247], v[234:235], v[234:235] op_sel:[0,1,1] op_sel_hi:[1,1,1]
  v_pk_fma_f32 v[248:249], v[248:249], v[234:235], v[234:235] op_sel:[0,1,1] op_sel_hi:[1,1,1]
  v_pk_mul_f32 v[8:9], v[8:9], v[242:243]
  v_pk_mul_f32 v[10:11], v[10:11], v[244:245]
  v_pk_mul_f32 v[242:243], v[32:33], v[238:239] op_sel:[0,0] op_sel_hi:[1,0]
  v_pk_mul_f32 v[244:245], v[34:35], v[238:239] op_sel:[0,0] op_sel_hi:[1,0]
  v_pk_mul_f32 v[32:33], v[32:33], v[48:49]
  v_pk_mul_f32 v[34:35], v[34:35], v[50:51]
  v_rcp_f32 v246, v246
  v_mfma_f32_16x16x32_bf16 v[200:203], a[64:67], a[40:43], v[200:203]
  v_rcp_f32 v247, v247
  v_mfma_f32_16x16x32_bf16 v[200:203], a[68:71], a[56:59], v[200:203]
  v_rcp_f32 v248, v248
  v_mfma_f32_16x16x32_bf16 v[204:207], a[68:71], a[60:63], v[204:207]
  ds_read_b64_tr_b16 a[84:85], v226 offset:40960
  v_cvt_pk_bf16_f32 v24, v8, v9
  v_mfma_f32_16x16x32_bf16 v[204:207], a[64:67], a[44:47], v[204:207]
  s_waitcnt lgkmcnt(3)
  ds_read_b64_tr_b16 a[86:87], v226 offset:45056
  v_cvt_pk_bf16_f32 v25, v10, v11
  v_mfma_f32_16x16x32_bf16 v[220:223], a[72:75], a[44:47], v[220:223]
  v_exp_f32 v242, v242
  v_mfma_f32_16x16x32_bf16 v[220:223], a[76:79], a[60:63], v[220:223]
  v_exp_f32 v243, v243
  v_mfma_f32_16x16x32_bf16 v[216:219], a[76:79], a[56:59], v[216:219]
  ds_read_b64_tr_b16 a[88:89], v226 offset:49152
  ds_read_b64_tr_b16 a[90:91], v226 offset:53248
  v_mfma_f32_16x16x32_bf16 v[216:219], a[72:75], a[40:43], v[216:219]
  v_exp_f32 v244, v244
  v_exp_f32 v245, v245
  v_rcp_f32 v249, v249
  v_pk_fma_f32 v[242:243], v[242:243], v[232:233], v[232:233] op_sel:[0,0,0] op_sel_hi:[1,0,0]
  v_pk_fma_f32 v[244:245], v[244:245], v[232:233], v[232:233] op_sel:[0,0,0] op_sel_hi:[1,0,0]
  v_pk_mul_f32 v[12:13], v[12:13], v[246:247]
  v_pk_mul_f32 v[14:15], v[14:15], v[248:249]
  v_pk_mul_f32 v[246:247], v[36:37], v[238:239] op_sel:[0,1] op_sel_hi:[1,1]
  v_pk_mul_f32 v[248:249], v[38:39], v[238:239] op_sel:[0,1] op_sel_hi:[1,1]
  v_pk_mul_f32 v[36:37], v[36:37], v[52:53]
  v_pk_mul_f32 v[38:39], v[38:39], v[54:55]
  v_rcp_f32 v242, v242
  v_mfma_f32_16x16x32_bf16 v[212:215], a[72:75], a[36:39], v[212:215]
  v_rcp_f32 v243, v243
  v_mfma_f32_16x16x32_bf16 v[212:215], a[76:79], a[52:55], v[212:215]
  v_rcp_f32 v244, v244
  v_mfma_f32_16x16x32_bf16 v[208:211], a[76:79], a[48:51], v[208:211]
  ds_read_b64_tr_b16 a[92:93], v226 offset:57344
  v_cvt_pk_bf16_f32 v28, v12, v13
  v_mfma_f32_16x16x32_bf16 v[208:211], a[72:75], a[32:35], v[208:211]
  s_waitcnt lgkmcnt(3)
  ds_read_b64_tr_b16 a[94:95], v226 offset:61440
  v_cvt_pk_bf16_f32 v29, v14, v15
  v_mfma_f32_16x16x32_bf16 v[64:67], a[80:83], a[224:227], v[64:67]
  v_exp_f32 v246, v246
  v_mfma_f32_16x16x32_bf16 v[64:67], a[84:87], a[240:243], v[64:67]
  v_exp_f32 v247, v247
  v_mfma_f32_16x16x32_bf16 v[68:71], a[84:87], a[244:247], v[68:71]
  ds_read_b64_tr_b16 a[64:65], v227 offset:0
  ds_read_b64_tr_b16 a[66:67], v227 offset:4096
  v_mfma_f32_16x16x32_bf16 v[68:71], a[80:83], a[228:231], v[68:71]
  v_exp_f32 v248, v248
  v_exp_f32 v249, v249
  v_rcp_f32 v245, v245
  v_pk_fma_f32 v[246:247], v[246:247], v[232:233], v[232:233] op_sel:[0,1,1] op_sel_hi:[1,1,1]
  v_pk_fma_f32 v[248:249], v[248:249], v[232:233], v[232:233] op_sel:[0,1,1] op_sel_hi:[1,1,1]
  v_pk_mul_f32 v[32:33], v[32:33], v[242:243]
  v_pk_mul_f32 v[34:35], v[34:35], v[244:245]
  v_pk_mul_f32 v[242:243], v[40:41], v[240:241] op_sel:[0,0] op_sel_hi:[1,0]
  v_pk_mul_f32 v[244:245], v[42:43], v[240:241] op_sel:[0,0] op_sel_hi:[1,0]
  v_pk_mul_f32 v[40:41], v[40:41], v[56:57]
  v_pk_mul_f32 v[42:43], v[42:43], v[58:59]
  v_rcp_f32 v246, v246
  v_mfma_f32_16x16x32_bf16 v[72:75], a[80:83], a[232:235], v[72:75]
  v_rcp_f32 v247, v247
  v_mfma_f32_16x16x32_bf16 v[72:75], a[84:87], a[248:251], v[72:75]
  v_rcp_f32 v248, v248
  v_mfma_f32_16x16x32_bf16 v[76:79], a[84:87], a[252:255], v[76:79]
  ds_read_b64_tr_b16 a[68:69], v227 offset:8192
  v_cvt_pk_bf16_f32 v18, v32, v33
  v_mfma_f32_16x16x32_bf16 v[76:79], a[80:83], a[236:239], v[76:79]
  s_waitcnt lgkmcnt(3)
  ds_read_b64_tr_b16 a[70:71], v227 offset:12288
  v_cvt_pk_bf16_f32 v19, v34, v35
  v_mfma_f32_16x16x32_bf16 v[92:95], a[88:91], a[236:239], v[92:95]
  buffer_store_dwordx4 v[16:19], v231, s[4:7], s57 offen sc1
  s_add_u32 s57, s57, 16384
  v_exp_f32 v242, v242
  v_mfma_f32_16x16x32_bf16 v[92:95], a[92:95], a[252:255], v[92:95]
  v_exp_f32 v243, v243
  v_mfma_f32_16x16x32_bf16 v[88:91], a[92:95], a[248:251], v[88:91]
  ds_read_b64_tr_b16 a[72:73], v227 offset:16384
  ds_read_b64_tr_b16 a[74:75], v227 offset:20480
  v_mfma_f32_16x16x32_bf16 v[88:91], a[88:91], a[232:235], v[88:91]
  v_exp_f32 v244, v244
  v_exp_f32 v245, v245
  v_rcp_f32 v249, v249
  v_pk_fma_f32 v[242:243], v[242:243], v[234:235], v[234:235] op_sel:[0,0,0] op_sel_hi:[1,0,0]
  v_pk_fma_f32 v[244:245], v[244:245], v[234:235], v[234:235] op_sel:[0,0,0] op_sel_hi:[1,0,0]
  v_pk_mul_f32 v[36:37], v[36:37], v[246:247]
  v_pk_mul_f32 v[38:39], v[38:39], v[248:249]
  v_pk_mul_f32 v[246:247], v[44:45], v[240:241] op_sel:[0,1] op_sel_hi:[1,1]
  v_pk_mul_f32 v[248:249], v[46:47], v[240:241] op_sel:[0,1] op_sel_hi:[1,1]
  v_pk_mul_f32 v[44:45], v[44:45], v[60:61]
  v_pk_mul_f32 v[46:47], v[46:47], v[62:63]
  v_rcp_f32 v242, v242
  v_mfma_f32_16x16x32_bf16 v[84:87], a[88:91], a[228:231], v[84:87]
  v_rcp_f32 v243, v243
  v_mfma_f32_16x16x32_bf16 v[84:87], a[92:95], a[244:247], v[84:87]
  v_rcp_f32 v244, v244
  v_mfma_f32_16x16x32_bf16 v[80:83], a[92:95], a[240:243], v[80:83]
  ds_read_b64_tr_b16 a[76:77], v227 offset:24576
  v_cvt_pk_bf16_f32 v22, v36, v37
  v_mfma_f32_16x16x32_bf16 v[80:83], a[88:91], a[224:227], v[80:83]
  s_waitcnt lgkmcnt(3)
  ds_read_b64_tr_b16 a[78:79], v227 offset:28672
  v_cvt_pk_bf16_f32 v23, v38, v39
  v_mfma_f32_16x16x32_bf16 v[96:99], a[64:67], a[192:195], v[96:99]
  buffer_store_dwordx4 v[20:23], v231, s[4:7], s58 offen sc1
  s_add_u32 s58, s58, 16384
  v_exp_f32 v246, v246
  v_mfma_f32_16x16x32_bf16 v[96:99], a[68:71], a[208:211], v[96:99]
  v_exp_f32 v247, v247
  v_mfma_f32_16x16x32_bf16 v[100:103], a[68:71], a[212:215], v[100:103]
  ds_read_b64_tr_b16 a[80:81], v227 offset:32768
  ds_read_b64_tr_b16 a[82:83], v227 offset:36864
  v_mfma_f32_16x16x32_bf16 v[100:103], a[64:67], a[196:199], v[100:103]
  v_exp_f32 v248, v248
  v_exp_f32 v249, v249
  v_rcp_f32 v245, v245
  v_pk_fma_f32 v[246:247], v[246:247], v[234:235], v[234:235] op_sel:[0,1,1] op_sel_hi:[1,1,1]
  v_pk_fma_f32 v[248:249], v[248:249], v[234:235], v[234:235] op_sel:[0,1,1] op_sel_hi:[1,1,1]
  v_pk_mul_f32 v[40:41], v[40:41], v[242:243]
  v_pk_mul_f32 v[42:43], v[42:43], v[244:245]
  v_pk_mul_f32 v[242:243], v[64:65], v[238:239] op_sel:[0,0] op_sel_hi:[1,0]
  v_pk_mul_f32 v[244:245], v[66:67], v[238:239] op_sel:[0,0] op_sel_hi:[1,0]
  v_pk_mul_f32 v[64:65], v[64:65], v[80:81]
  v_pk_mul_f32 v[66:67], v[66:67], v[82:83]
  v_rcp_f32 v246, v246
  v_mfma_f32_16x16x32_bf16 v[104:107], a[64:67], a[200:203], v[104:107]
  v_rcp_f32 v247, v247
  v_mfma_f32_16x16x32_bf16 v[104:107], a[68:71], a[216:219], v[104:107]
  v_rcp_f32 v248, v248
  v_mfma_f32_16x16x32_bf16 v[108:111], a[68:71], a[220:223], v[108:111]
  ds_read_b64_tr_b16 a[84:85], v227 offset:40960
  v_cvt_pk_bf16_f32 v26, v40, v41
  v_mfma_f32_16x16x32_bf16 v[108:111], a[64:67], a[204:207], v[108:111]
  s_waitcnt lgkmcnt(3)
  ds_read_b64_tr_b16 a[86:87], v227 offset:45056
  v_cvt_pk_bf16_f32 v27, v42, v43
  v_mfma_f32_16x16x32_bf16 v[124:127], a[72:75], a[204:207], v[124:127]
  buffer_store_dwordx4 v[24:27], v231, s[4:7], s59 offen sc1
  s_add_u32 s59, s59, 16384
  v_exp_f32 v242, v242
  v_mfma_f32_16x16x32_bf16 v[124:127], a[76:79], a[220:223], v[124:127]
  v_exp_f32 v243, v243
  v_mfma_f32_16x16x32_bf16 v[120:123], a[76:79], a[216:219], v[120:123]
  ds_read_b64_tr_b16 a[88:89], v227 offset:49152
  ds_read_b64_tr_b16 a[90:91], v227 offset:53248
  v_mfma_f32_16x16x32_bf16 v[120:123], a[72:75], a[200:203], v[120:123]
  v_exp_f32 v244, v244
  v_exp_f32 v245, v245
  v_rcp_f32 v249, v249
  v_pk_fma_f32 v[242:243], v[242:243], v[232:233], v[232:233] op_sel:[0,0,0] op_sel_hi:[1,0,0]
  v_pk_fma_f32 v[244:245], v[244:245], v[232:233], v[232:233] op_sel:[0,0,0] op_sel_hi:[1,0,0]
  v_pk_mul_f32 v[44:45], v[44:45], v[246:247]
  v_pk_mul_f32 v[46:47], v[46:47], v[248:249]
  v_pk_mul_f32 v[246:247], v[68:69], v[238:239] op_sel:[0,1] op_sel_hi:[1,1]
  v_pk_mul_f32 v[248:249], v[70:71], v[238:239] op_sel:[0,1] op_sel_hi:[1,1]
  v_pk_mul_f32 v[68:69], v[68:69], v[84:85]
  v_pk_mul_f32 v[70:71], v[70:71], v[86:87]
  v_rcp_f32 v242, v242
  v_mfma_f32_16x16x32_bf16 v[116:119], a[72:75], a[196:199], v[116:119]
  v_rcp_f32 v243, v243
  v_mfma_f32_16x16x32_bf16 v[116:119], a[76:79], a[212:215], v[116:119]
  v_rcp_f32 v244, v244
  v_mfma_f32_16x16x32_bf16 v[112:115], a[76:79], a[208:211], v[112:115]
  ds_read_b64_tr_b16 a[92:93], v227 offset:57344
  v_cvt_pk_bf16_f32 v30, v44, v45
  v_mfma_f32_16x16x32_bf16 v[112:115], a[72:75], a[192:195], v[112:115]
  s_waitcnt lgkmcnt(3)
  ds_read_b64_tr_b16 a[94:95], v227 offset:61440
  v_cvt_pk_bf16_f32 v31, v46, v47
  v_mfma_f32_16x16x32_bf16 v[96:99], a[80:83], a[224:227], v[96:99]
  buffer_store_dwordx4 v[28:31], v231, s[4:7], s60 offen sc1
  s_add_u32 s60, s60, 16384
  v_exp_f32 v246, v246
  v_mfma_f32_16x16x32_bf16 v[96:99], a[84:87], a[240:243], v[96:99]
  v_exp_f32 v247, v247
  v_mfma_f32_16x16x32_bf16 v[100:103], a[84:87], a[244:247], v[100:103]
  ds_read_b64_tr_b16 a[64:65], v228 offset:0
  ds_read_b64_tr_b16 a[66:67], v228 offset:4096
  v_mfma_f32_16x16x32_bf16 v[100:103], a[80:83], a[228:231], v[100:103]
  v_exp_f32 v248, v248
  v_exp_f32 v249, v249
  v_rcp_f32 v245, v245
  v_pk_fma_f32 v[246:247], v[246:247], v[232:233], v[232:233] op_sel:[0,1,1] op_sel_hi:[1,1,1]
  v_pk_fma_f32 v[248:249], v[248:249], v[232:233], v[232:233] op_sel:[0,1,1] op_sel_hi:[1,1,1]
  v_pk_mul_f32 v[64:65], v[64:65], v[242:243]
  v_pk_mul_f32 v[66:67], v[66:67], v[244:245]
  v_pk_mul_f32 v[242:243], v[72:73], v[240:241] op_sel:[0,0] op_sel_hi:[1,0]
  v_pk_mul_f32 v[244:245], v[74:75], v[240:241] op_sel:[0,0] op_sel_hi:[1,0]
  v_pk_mul_f32 v[72:73], v[72:73], v[88:89]
  v_pk_mul_f32 v[74:75], v[74:75], v[90:91]
  v_rcp_f32 v246, v246
  v_mfma_f32_16x16x32_bf16 v[104:107], a[80:83], a[232:235], v[104:107]
  v_rcp_f32 v247, v247
  v_lshlrev_b32 v8, 4, v253
  v_mfma_f32_16x16x32_bf16 v[104:107], a[84:87], a[248:251], v[104:107]
  v_rcp_f32 v248, v248
  v_add_u32 v9, 114688, v8
  v_mfma_f32_16x16x32_bf16 v[108:111], a[84:87], a[252:255], v[108:111]
  ds_read_b64_tr_b16 a[68:69], v228 offset:8192
  v_cvt_pk_bf16_f32 v80, v64, v65
  v_mfma_f32_16x16x32_bf16 v[108:111], a[80:83], a[236:239], v[108:111]
  s_waitcnt lgkmcnt(3)
  ds_read_b64_tr_b16 a[70:71], v228 offset:12288
  v_cvt_pk_bf16_f32 v81, v66, v67
  v_mfma_f32_16x16x32_bf16 v[124:127], a[88:91], a[236:239], v[124:127]
  buffer_load_dwordx4 v[16:19], v8, s[4:7], s46 offen offset:0 sc1
  v_exp_f32 v242, v242
  v_mfma_f32_16x16x32_bf16 v[124:127], a[92:95], a[252:255], v[124:127]
  buffer_load_dwordx4 v[20:23], v8, s[4:7], s46 offen offset:1024 sc1
  v_exp_f32 v243, v243
  v_mfma_f32_16x16x32_bf16 v[120:123], a[92:95], a[248:251], v[120:123]
  ds_read_b64_tr_b16 a[72:73], v228 offset:16384
  ds_read_b64_tr_b16 a[74:75], v228 offset:20480
  v_mfma_f32_16x16x32_bf16 v[120:123], a[88:91], a[232:235], v[120:123]
  v_exp_f32 v244, v244
  v_exp_f32 v245, v245
  v_rcp_f32 v249, v249
  v_pk_fma_f32 v[242:243], v[242:243], v[234:235], v[234:235] op_sel:[0,0,0] op_sel_hi:[1,0,0]
  v_pk_fma_f32 v[244:245], v[244:245], v[234:235], v[234:235] op_sel:[0,0,0] op_sel_hi:[1,0,0]
  v_pk_mul_f32 v[68:69], v[68:69], v[246:247]
  v_pk_mul_f32 v[70:71], v[70:71], v[248:249]
  v_pk_mul_f32 v[246:247], v[76:77], v[240:241] op_sel:[0,1] op_sel_hi:[1,1]
  v_pk_mul_f32 v[248:249], v[78:79], v[240:241] op_sel:[0,1] op_sel_hi:[1,1]
  v_pk_mul_f32 v[76:77], v[76:77], v[92:93]
  v_pk_mul_f32 v[78:79], v[78:79], v[94:95]
  v_rcp_f32 v242, v242
  v_mfma_f32_16x16x32_bf16 v[116:119], a[88:91], a[228:231], v[116:119]
  buffer_load_dwordx4 v[24:27], v8, s[4:7], s47 offen offset:0 sc1
  v_rcp_f32 v243, v243
  v_mfma_f32_16x16x32_bf16 v[116:119], a[92:95], a[244:247], v[116:119]
  buffer_load_dwordx4 v[28:31], v8, s[4:7], s47 offen offset:1024 sc1
  v_rcp_f32 v244, v244
  v_mfma_f32_16x16x32_bf16 v[112:115], a[92:95], a[240:243], v[112:115]
  ds_read_b64_tr_b16 a[76:77], v228 offset:24576
  v_cvt_pk_bf16_f32 v84, v68, v69
  v_mfma_f32_16x16x32_bf16 v[112:115], a[88:91], a[224:227], v[112:115]
  s_waitcnt lgkmcnt(3)
  ds_read_b64_tr_b16 a[78:79], v228 offset:28672
  v_cvt_pk_bf16_f32 v85, v70, v71
  v_mfma_f32_16x16x32_bf16 v[128:131], a[64:67], a[192:195], v[128:131]
  v_exp_f32 v246, v246
  v_bfe_u32 v11, v253, 2, 3
  v_mfma_f32_16x16x32_bf16 v[128:131], a[68:71], a[208:211], v[128:131]
  v_exp_f32 v247, v247
  v_bfe_u32 v12, v253, 3, 2
  v_mfma_f32_16x16x32_bf16 v[132:135], a[68:71], a[212:215], v[132:135]
  ds_read_b64_tr_b16 a[80:81], v228 offset:32768
  ds_read_b64_tr_b16 a[82:83], v228 offset:36864
  v_mfma_f32_16x16x32_bf16 v[132:135], a[64:67], a[196:199], v[132:135]
  v_exp_f32 v248, v248
  v_exp_f32 v249, v249
  v_rcp_f32 v245, v245
  v_pk_fma_f32 v[246:247], v[246:247], v[234:235], v[234:235] op_sel:[0,1,1] op_sel_hi:[1,1,1]
  v_pk_fma_f32 v[248:249], v[248:249], v[234:235], v[234:235] op_sel:[0,1,1] op_sel_hi:[1,1,1]
  v_pk_mul_f32 v[72:73], v[72:73], v[242:243]
  v_pk_mul_f32 v[74:75], v[74:75], v[244:245]
  v_pk_mul_f32 v[242:243], v[96:97], v[238:239] op_sel:[0,0] op_sel_hi:[1,0]
  v_pk_mul_f32 v[244:245], v[98:99], v[238:239] op_sel:[0,0] op_sel_hi:[1,0]
  v_pk_mul_f32 v[96:97], v[96:97], v[112:113]
  v_pk_mul_f32 v[98:99], v[98:99], v[114:115]
  v_rcp_f32 v246, v246
  v_mfma_f32_16x16x32_bf16 v[136:139], a[64:67], a[200:203], v[136:139]
  v_rcp_f32 v247, v247
  v_and_b32 v13, 3, v253
  v_mfma_f32_16x16x32_bf16 v[136:139], a[68:71], a[216:219], v[136:139]
  v_rcp_f32 v248, v248
  v_lshlrev_b32 v13, 3, v13
  v_mfma_f32_16x16x32_bf16 v[140:143], a[68:71], a[220:223], v[140:143]
  ds_read_b64_tr_b16 a[84:85], v228 offset:40960
  v_cvt_pk_bf16_f32 v88, v72, v73
  v_mfma_f32_16x16x32_bf16 v[140:143], a[64:67], a[204:207], v[140:143]
  s_waitcnt lgkmcnt(3)
  ds_read_b64_tr_b16 a[86:87], v228 offset:45056
  v_cvt_pk_bf16_f32 v89, v74, v75
  v_mfma_f32_16x16x32_bf16 v[156:159], a[72:75], a[204:207], v[156:159]
  v_exp_f32 v242, v242
  v_lshl_add_u32 v13, v11, 7, v13
  v_mfma_f32_16x16x32_bf16 v[156:159], a[76:79], a[220:223], v[156:159]
  v_exp_f32 v243, v243
  v_lshrrev_b32 v11, 5, v253
  v_mfma_f32_16x16x32_bf16 v[152:155], a[76:79], a[216:219], v[152:155]
  ds_read_b64_tr_b16 a[88:89], v228 offset:49152
  ds_read_b64_tr_b16 a[90:91], v228 offset:53248
  v_mfma_f32_16x16x32_bf16 v[152:155], a[72:75], a[200:203], v[152:155]
  v_exp_f32 v244, v244
  v_exp_f32 v245, v245
  v_rcp_f32 v249, v249
  v_pk_fma_f32 v[242:243], v[242:243], v[232:233], v[232:233] op_sel:[0,0,0] op_sel_hi:[1,0,0]
  v_pk_fma_f32 v[244:245], v[244:245], v[232:233], v[232:233] op_sel:[0,0,0] op_sel_hi:[1,0,0]
  v_pk_mul_f32 v[76:77], v[76:77], v[246:247]
  v_pk_mul_f32 v[78:79], v[78:79], v[248:249]
  v_pk_mul_f32 v[246:247], v[100:101], v[238:239] op_sel:[0,1] op_sel_hi:[1,1]
  v_pk_mul_f32 v[248:249], v[102:103], v[238:239] op_sel:[0,1] op_sel_hi:[1,1]
  v_pk_mul_f32 v[100:101], v[100:101], v[116:117]
  v_pk_mul_f32 v[102:103], v[102:103], v[118:119]
  v_rcp_f32 v242, v242
  v_mfma_f32_16x16x32_bf16 v[148:151], a[72:75], a[196:199], v[148:151]
  s_waitcnt vmcnt(4)
  s_barrier
  s_cmp_lg_u32 s40, 0
  s_cbranch_scc1 Lsgf17
  v_mov_b32 v250, 1
  s_mov_b64 exec, 1
  buffer_atomic_add v250, v251, s[4:7], s77 offen sc1
  s_mov_b64 exec, -1
Lsgf17:
  s_add_u32 s77, s77, 4096
  v_rcp_f32 v243, v243
  v_lshl_add_u32 v13, v11, 11, v13
  v_mfma_f32_16x16x32_bf16 v[148:151], a[76:79], a[212:215], v[148:151]
  s_add_u32 m0, s79, 32768
  v_rcp_f32 v244, v244
  v_xor_b32 v11, 0, v12
  v_mfma_f32_16x16x32_bf16 v[144:147], a[76:79], a[208:211], v[144:147]
  s_add_u32 s92, s92, 196608
  s_add_u32 s93, s92, s88
  ds_read_b64_tr_b16 a[92:93], v228 offset:57344
  v_cvt_pk_bf16_f32 v92, v76, v77
  v_mfma_f32_16x16x32_bf16 v[144:147], a[72:75], a[192:195], v[144:147]
  s_waitcnt lgkmcnt(3)
  ds_read_b64_tr_b16 a[94:95], v228 offset:61440
  v_cvt_pk_bf16_f32 v93, v78, v79
  v_mfma_f32_16x16x32_bf16 v[128:131], a[80:83], a[224:227], v[128:131]
  buffer_load_dwordx4 v252, s[80:83], s93 offen lds
  v_exp_f32 v246, v246
  v_mfma_f32_16x16x32_bf16 v[128:131], a[84:87], a[240:243], v[128:131]
  buffer_load_dwordx4 v252, s[84:87], s93 offen offset:1024 lds
  v_exp_f32 v247, v247
  v_mfma_f32_16x16x32_bf16 v[132:135], a[84:87], a[244:247], v[132:135]
  ds_read_b64_tr_b16 a[64:65], v229 offset:0
  ds_read_b64_tr_b16 a[66:67], v229 offset:4096
  v_mfma_f32_16x16x32_bf16 v[132:135], a[80:83], a[228:231], v[132:135]
  v_exp_f32 v248, v248
  v_exp_f32 v249, v249
  v_rcp_f32 v245, v245
  v_pk_fma_f32 v[246:247], v[246:247], v[232:233], v[232:233] op_sel:[0,1,1] op_sel_hi:[1,1,1]
  v_pk_fma_f32 v[248:249], v[248:249], v[232:233], v[232:233] op_sel:[0,1,1] op_sel_hi:[1,1,1]
  v_pk_mul_f32 v[96:97], v[96:97], v[242:243]
  v_pk_mul_f32 v[98:99], v[98:99], v[244:245]
  v_pk_mul_f32 v[242:243], v[104:105], v[240:241] op_sel:[0,0] op_sel_hi:[1,0]
  v_pk_mul_f32 v[244:245], v[106:107], v[240:241] op_sel:[0,0] op_sel_hi:[1,0]
  v_pk_mul_f32 v[104:105], v[104:105], v[120:121]
  v_pk_mul_f32 v[106:107], v[106:107], v[122:123]
  v_rcp_f32 v246, v246
  v_mfma_f32_16x16x32_bf16 v[136:139], a[80:83], a[232:235], v[136:139]
  s_add_u32 m0, s79, 40960
  v_rcp_f32 v247, v247
  v_lshl_add_u32 v0, v11, 5, v13
  v_mfma_f32_16x16x32_bf16 v[136:139], a[84:87], a[248:251], v[136:139]
  s_add_u32 s92, s92, 262144
  s_add_u32 s93, s92, s89
  buffer_load_dwordx4 v252, s[80:83], s93 offen lds
  v_rcp_f32 v248, v248
  v_mfma_f32_16x16x32_bf16 v[140:143], a[84:87], a[252:255], v[140:143]
  ds_read_b64_tr_b16 a[68:69], v229 offset:8192
  v_cvt_pk_bf16_f32 v82, v96, v97
  v_mfma_f32_16x16x32_bf16 v[140:143], a[80:83], a[236:239], v[140:143]
  s_waitcnt lgkmcnt(3)
  ds_read_b64_tr_b16 a[70:71], v229 offset:12288
  v_cvt_pk_bf16_f32 v83, v98, v99
  v_mfma_f32_16x16x32_bf16 v[156:159], a[88:91], a[236:239], v[156:159]
  buffer_load_dwordx4 v252, s[84:87], s93 offen offset:1024 lds
  buffer_store_dwordx4 v[80:83], v231, s[4:7], s57 offen sc1
  s_add_u32 s57, s57, 16384
  v_exp_f32 v242, v242
  v_mfma_f32_16x16x32_bf16 v[156:159], a[92:95], a[252:255], v[156:159]
  v_exp_f32 v243, v243
  v_add_u32 v4, 0x10000, v0
  v_mfma_f32_16x16x32_bf16 v[152:155], a[92:95], a[248:251], v[152:155]
  ds_read_b64_tr_b16 a[72:73], v229 offset:16384
  ds_read_b64_tr_b16 a[74:75], v229 offset:20480
  v_mfma_f32_16x16x32_bf16 v[152:155], a[88:91], a[232:235], v[152:155]
  v_exp_f32 v244, v244
  v_exp_f32 v245, v245
  v_rcp_f32 v249, v249
  v_pk_fma_f32 v[242:243], v[242:243], v[234:235], v[234:235] op_sel:[0,0,0] op_sel_hi:[1,0,0]
  v_pk_fma_f32 v[244:245], v[244:245], v[234:235], v[234:235] op_sel:[0,0,0] op_sel_hi:[1,0,0]
  v_pk_mul_f32 v[100:101], v[100:101], v[246:247]
  v_pk_mul_f32 v[102:103], v[102:103], v[248:249]
  v_pk_mul_f32 v[246:247], v[108:109], v[240:241] op_sel:[0,1] op_sel_hi:[1,1]
  v_pk_mul_f32 v[248:249], v[110:111], v[240:241] op_sel:[0,1] op_sel_hi:[1,1]
  v_pk_mul_f32 v[108:109], v[108:109], v[124:125]
  v_pk_mul_f32 v[110:111], v[110:111], v[126:127]
  v_rcp_f32 v242, v242
  v_mfma_f32_16x16x32_bf16 v[148:151], a[88:91], a[228:231], v[148:151]
  s_add_u32 m0, s79, 49152
  v_rcp_f32 v243, v243
  v_xor_b32 v11, 1, v12
  v_mfma_f32_16x16x32_bf16 v[148:151], a[92:95], a[244:247], v[148:151]
  s_add_u32 s92, s92, 196608
  s_add_u32 s93, s92, s90
  buffer_load_dwordx4 v252, s[80:83], s93 offen lds
  v_rcp_f32 v244, v244
  v_mfma_f32_16x16x32_bf16 v[144:147], a[92:95], a[240:243], v[144:147]
  ds_read_b64_tr_b16 a[76:77], v229 offset:24576
  v_cvt_pk_bf16_f32 v86, v100, v101
  v_mfma_f32_16x16x32_bf16 v[144:147], a[88:91], a[224:227], v[144:147]
  s_waitcnt lgkmcnt(3)
  ds_read_b64_tr_b16 a[78:79], v229 offset:28672
  v_cvt_pk_bf16_f32 v87, v102, v103
  v_mfma_f32_16x16x32_bf16 v[160:163], a[64:67], a[192:195], v[160:163]
  buffer_load_dwordx4 v252, s[84:87], s93 offen offset:1024 lds
  buffer_store_dwordx4 v[84:87], v231, s[4:7], s58 offen sc1
  s_add_u32 s58, s58, 16384
  v_exp_f32 v246, v246
  v_mfma_f32_16x16x32_bf16 v[160:163], a[68:71], a[208:211], v[160:163]
  v_exp_f32 v247, v247
  v_lshl_add_u32 v1, v11, 5, v13
  v_mfma_f32_16x16x32_bf16 v[164:167], a[68:71], a[212:215], v[164:167]
  ds_read_b64_tr_b16 a[80:81], v229 offset:32768
  ds_read_b64_tr_b16 a[82:83], v229 offset:36864
  v_mfma_f32_16x16x32_bf16 v[164:167], a[64:67], a[196:199], v[164:167]
  v_exp_f32 v248, v248
  v_exp_f32 v249, v249
  v_rcp_f32 v245, v245
  v_pk_fma_f32 v[246:247], v[246:247], v[234:235], v[234:235] op_sel:[0,1,1] op_sel_hi:[1,1,1]
  v_pk_fma_f32 v[248:249], v[248:249], v[234:235], v[234:235] op_sel:[0,1,1] op_sel_hi:[1,1,1]
  v_pk_mul_f32 v[104:105], v[104:105], v[242:243]
  v_pk_mul_f32 v[106:107], v[106:107], v[244:245]
  v_pk_mul_f32 v[242:243], v[128:129], v[238:239] op_sel:[0,0] op_sel_hi:[1,0]
  v_pk_mul_f32 v[244:245], v[130:131], v[238:239] op_sel:[0,0] op_sel_hi:[1,0]
  v_pk_mul_f32 v[128:129], v[128:129], v[144:145]
  v_pk_mul_f32 v[130:131], v[130:131], v[146:147]
  v_rcp_f32 v246, v246
  v_mfma_f32_16x16x32_bf16 v[168:171], a[64:67], a[200:203], v[168:171]
  s_add_u32 m0, s79, 57344
  v_rcp_f32 v247, v247
  v_add_u32 v5, 0x10000, v1
  v_mfma_f32_16x16x32_bf16 v[168:171], a[68:71], a[216:219], v[168:171]
  s_add_u32 s92, s92, 262144
  s_add_u32 s93, s92, s91
  buffer_load_dwordx4 v252, s[80:83], s93 offen lds
  v_rcp_f32 v248, v248
  v_mfma_f32_16x16x32_bf16 v[172:175], a[68:71], a[220:223], v[172:175]
  ds_read_b64_tr_b16 a[84:85], v229 offset:40960
  v_cvt_pk_bf16_f32 v90, v104, v105
  v_mfma_f32_16x16x32_bf16 v[172:175], a[64:67], a[204:207], v[172:175]
  s_waitcnt lgkmcnt(3)
  ds_read_b64_tr_b16 a[86:87], v229 offset:45056
  v_cvt_pk_bf16_f32 v91, v106, v107
  v_mfma_f32_16x16x32_bf16 v[188:191], a[72:75], a[204:207], v[188:191]
  buffer_load_dwordx4 v252, s[84:87], s93 offen offset:1024 lds
  buffer_store_dwordx4 v[88:91], v231, s[4:7], s59 offen sc1
  s_add_u32 s59, s59, 16384
  v_exp_f32 v242, v242
  v_mfma_f32_16x16x32_bf16 v[188:191], a[76:79], a[220:223], v[188:191]
  v_exp_f32 v243, v243
  v_xor_b32 v11, 2, v12
  v_mfma_f32_16x16x32_bf16 v[184:187], a[76:79], a[216:219], v[184:187]
  ds_read_b64_tr_b16 a[88:89], v229 offset:49152
  ds_read_b64_tr_b16 a[90:91], v229 offset:53248
  v_mfma_f32_16x16x32_bf16 v[184:187], a[72:75], a[200:203], v[184:187]
  v_exp_f32 v244, v244
  v_exp_f32 v245, v245
  v_rcp_f32 v249, v249
  v_pk_fma_f32 v[242:243], v[242:243], v[232:233], v[232:233] op_sel:[0,0,0] op_sel_hi:[1,0,0]
  v_pk_fma_f32 v[244:245], v[244:245], v[232:233], v[232:233] op_sel:[0,0,0] op_sel_hi:[1,0,0]
  v_pk_mul_f32 v[108:109], v[108:109], v[246:247]
  v_pk_mul_f32 v[110:111], v[110:111], v[248:249]
  v_pk_mul_f32 v[246:247], v[132:133], v[238:239] op_sel:[0,1] op_sel_hi:[1,1]
  v_pk_mul_f32 v[248:249], v[134:135], v[238:239] op_sel:[0,1] op_sel_hi:[1,1]
  v_pk_mul_f32 v[132:133], v[132:133], v[148:149]
  v_pk_mul_f32 v[134:135], v[134:135], v[150:151]
  v_rcp_f32 v242, v242
  v_mfma_f32_16x16x32_bf16 v[180:183], a[72:75], a[196:199], v[180:183]
  buffer_load_dword v10, v251, s[4:7], s64 offen sc1
  v_rcp_f32 v243, v243
  v_mfma_f32_16x16x32_bf16 v[180:183], a[76:79], a[212:215], v[180:183]
  v_rcp_f32 v244, v244
  v_lshl_add_u32 v2, v11, 5, v13
  v_mfma_f32_16x16x32_bf16 v[176:179], a[76:79], a[208:211], v[176:179]
  ds_read_b64_tr_b16 a[92:93], v229 offset:57344
  v_cvt_pk_bf16_f32 v94, v108, v109
  v_mfma_f32_16x16x32_bf16 v[176:179], a[72:75], a[192:195], v[176:179]
  s_waitcnt lgkmcnt(3)
  ds_read_b64_tr_b16 a[94:95], v229 offset:61440
  v_cvt_pk_bf16_f32 v95, v110, v111
  v_mfma_f32_16x16x32_bf16 v[160:163], a[80:83], a[224:227], v[160:163]
  buffer_store_dwordx4 v[92:95], v231, s[4:7], s60 offen sc1
  s_add_u32 s60, s60, 16384
  v_exp_f32 v246, v246
  v_mfma_f32_16x16x32_bf16 v[160:163], a[84:87], a[240:243], v[160:163]
  v_exp_f32 v247, v247
  v_add_u32 v6, 0x10000, v2
  v_mfma_f32_16x16x32_bf16 v[164:167], a[84:87], a[244:247], v[164:167]
  ds_read_b64_tr_b16 a[64:65], v230 offset:0
  ds_read_b64_tr_b16 a[66:67], v230 offset:4096
  v_mfma_f32_16x16x32_bf16 v[164:167], a[80:83], a[228:231], v[164:167]
  v_exp_f32 v248, v248
  v_exp_f32 v249, v249
  v_rcp_f32 v245, v245
  v_pk_fma_f32 v[246:247], v[246:247], v[232:233], v[232:233] op_sel:[0,1,1] op_sel_hi:[1,1,1]
  v_pk_fma_f32 v[248:249], v[248:249], v[232:233], v[232:233] op_sel:[0,1,1] op_sel_hi:[1,1,1]
  v_pk_mul_f32 v[128:129], v[128:129], v[242:243]
  v_pk_mul_f32 v[130:131], v[130:131], v[244:245]
  v_pk_mul_f32 v[242:243], v[136:137], v[240:241] op_sel:[0,0] op_sel_hi:[1,0]
  v_pk_mul_f32 v[244:245], v[138:139], v[240:241] op_sel:[0,0] op_sel_hi:[1,0]
  v_pk_mul_f32 v[136:137], v[136:137], v[152:153]
  v_pk_mul_f32 v[138:139], v[138:139], v[154:155]
  v_rcp_f32 v246, v246
  v_mfma_f32_16x16x32_bf16 v[168:171], a[80:83], a[232:235], v[168:171]
  v_rcp_f32 v247, v247
  v_xor_b32 v11, 3, v12
  v_mfma_f32_16x16x32_bf16 v[168:171], a[84:87], a[248:251], v[168:171]
  v_rcp_f32 v248, v248
  v_lshl_add_u32 v3, v11, 5, v13
  v_mfma_f32_16x16x32_bf16 v[172:175], a[84:87], a[252:255], v[172:175]
  ds_read_b64_tr_b16 a[68:69], v230 offset:8192
  v_cvt_pk_bf16_f32 v144, v128, v129
  v_mfma_f32_16x16x32_bf16 v[172:175], a[80:83], a[236:239], v[172:175]
  s_waitcnt lgkmcnt(3)
  ds_read_b64_tr_b16 a[70:71], v230 offset:12288
  v_cvt_pk_bf16_f32 v145, v130, v131
  v_mfma_f32_16x16x32_bf16 v[188:191], a[88:91], a[236:239], v[188:191]
  v_exp_f32 v242, v242
  v_add_u32 v7, 0x10000, v3
  v_mfma_f32_16x16x32_bf16 v[188:191], a[92:95], a[252:255], v[188:191]
  v_exp_f32 v243, v243
  v_mfma_f32_16x16x32_bf16 v[184:187], a[92:95], a[248:251], v[184:187]
  ds_read_b64_tr_b16 a[72:73], v230 offset:16384
  ds_read_b64_tr_b16 a[74:75], v230 offset:20480
  v_mfma_f32_16x16x32_bf16 v[184:187], a[88:91], a[232:235], v[184:187]
  v_exp_f32 v244, v244
  v_exp_f32 v245, v245
  v_rcp_f32 v249, v249
  v_pk_fma_f32 v[242:243], v[242:243], v[234:235], v[234:235] op_sel:[0,0,0] op_sel_hi:[1,0,0]
  v_pk_fma_f32 v[244:245], v[244:245], v[234:235], v[234:235] op_sel:[0,0,0] op_sel_hi:[1,0,0]
  v_pk_mul_f32 v[132:133], v[132:133], v[246:247]
  v_pk_mul_f32 v[134:135], v[134:135], v[248:249]
  v_pk_mul_f32 v[246:247], v[140:141], v[240:241] op_sel:[0,1] op_sel_hi:[1,1]
  v_pk_mul_f32 v[248:249], v[142:143], v[240:241] op_sel:[0,1] op_sel_hi:[1,1]
  v_pk_mul_f32 v[140:141], v[140:141], v[156:157]
  v_pk_mul_f32 v[142:143], v[142:143], v[158:159]
  v_rcp_f32 v242, v242
  v_mfma_f32_16x16x32_bf16 v[180:183], a[88:91], a[228:231], v[180:183]
  v_rcp_f32 v243, v243
  v_mfma_f32_16x16x32_bf16 v[180:183], a[92:95], a[244:247], v[180:183]
  v_rcp_f32 v244, v244
  v_mfma_f32_16x16x32_bf16 v[176:179], a[92:95], a[240:243], v[176:179]
  ds_read_b64_tr_b16 a[76:77], v230 offset:24576
  v_cvt_pk_bf16_f32 v148, v132, v133
  v_mfma_f32_16x16x32_bf16 v[176:179], a[88:91], a[224:227], v[176:179]
  s_waitcnt lgkmcnt(3)
  ds_read_b64_tr_b16 a[78:79], v230 offset:28672
  v_cvt_pk_bf16_f32 v149, v134, v135
  v_mfma_f32_16x16x32_bf16 v[192:195], a[64:67], a[192:195], v[192:195]
  v_exp_f32 v246, v246
  v_mfma_f32_16x16x32_bf16 v[192:195], a[68:71], a[208:211], v[192:195]
  v_exp_f32 v247, v247
  v_mfma_f32_16x16x32_bf16 v[196:199], a[68:71], a[212:215], v[196:199]
  ds_read_b64_tr_b16 a[80:81], v230 offset:32768
  ds_read_b64_tr_b16 a[82:83], v230 offset:36864
  v_mfma_f32_16x16x32_bf16 v[196:199], a[64:67], a[196:199], v[196:199]
  v_exp_f32 v248, v248
  v_exp_f32 v249, v249
  v_rcp_f32 v245, v245
  v_pk_fma_f32 v[246:247], v[246:247], v[234:235], v[234:235] op_sel:[0,1,1] op_sel_hi:[1,1,1]
  v_pk_fma_f32 v[248:249], v[248:249], v[234:235], v[234:235] op_sel:[0,1,1] op_sel_hi:[1,1,1]
  v_pk_mul_f32 v[136:137], v[136:137], v[242:243]
  v_pk_mul_f32 v[138:139], v[138:139], v[244:245]
  v_pk_mul_f32 v[242:243], v[160:161], v[238:239] op_sel:[0,0] op_sel_hi:[1,0]
  v_pk_mul_f32 v[244:245], v[162:163], v[238:239] op_sel:[0,0] op_sel_hi:[1,0]
  v_pk_mul_f32 v[160:161], v[160:161], v[176:177]
  v_pk_mul_f32 v[162:163], v[162:163], v[178:179]
  v_rcp_f32 v246, v246
  v_mfma_f32_16x16x32_bf16 v[200:203], a[64:67], a[200:203], v[200:203]
  s_waitcnt vmcnt(1)
  v_cmp_gt_u32 vcc, 16, v10
  s_cbranch_vccz Lp4a_ok
  s_mov_b32 s43, 0x40000
Lp4a_sp:
  s_sleep 10
  buffer_load_dword v10, v251, s[4:7], s64 offen sc1
  s_waitcnt vmcnt(0)
  v_cmp_gt_u32 vcc, 16, v10
  s_cbranch_vccz Lp4a_ok
  s_sub_u32 s43, s43, 1
  s_cmp_lg_u32 s43, 0
  s_cbranch_scc1 Lp4a_sp
Lp4a_ok:
  s_add_u32 s64, s64, 4096
  v_rcp_f32 v247, v247
  v_mfma_f32_16x16x32_bf16 v[200:203], a[68:71], a[216:219], v[200:203]
  s_min_u32 s63, s88, 4096
  s_add_u32 s63, s63, s48
  buffer_load_dwordx4 a[128:131], v8, s[4:7], s63 offen offset:0 sc1
  v_rcp_f32 v248, v248
  v_mfma_f32_16x16x32_bf16 v[204:207], a[68:71], a[220:223], v[204:207]
  ds_read_b64_tr_b16 a[84:85], v230 offset:40960
  v_cvt_pk_bf16_f32 v152, v136, v137
  v_mfma_f32_16x16x32_bf16 v[204:207], a[64:67], a[204:207], v[204:207]
  s_waitcnt lgkmcnt(3)
  ds_read_b64_tr_b16 a[86:87], v230 offset:45056
  v_cvt_pk_bf16_f32 v153, v138, v139
  v_mfma_f32_16x16x32_bf16 v[220:223], a[72:75], a[204:207], v[220:223]
  buffer_load_dwordx4 a[132:135], v9, s[4:7], s63 offen offset:0 sc1
  v_exp_f32 v242, v242
  v_mfma_f32_16x16x32_bf16 v[220:223], a[76:79], a[220:223], v[220:223]
  s_min_u32 s63, s89, 4096
  s_add_u32 s63, s63, s48
  buffer_load_dwordx4 a[136:139], v8, s[4:7], s63 offen offset:1024 sc1
  v_exp_f32 v243, v243
  v_mfma_f32_16x16x32_bf16 v[216:219], a[76:79], a[216:219], v[216:219]
  ds_read_b64_tr_b16 a[88:89], v230 offset:49152
  ds_read_b64_tr_b16 a[90:91], v230 offset:53248
  v_mfma_f32_16x16x32_bf16 v[216:219], a[72:75], a[200:203], v[216:219]
  buffer_load_dwordx4 a[140:143], v9, s[4:7], s63 offen offset:1024 sc1
  v_exp_f32 v244, v244
  v_exp_f32 v245, v245
  v_rcp_f32 v249, v249
  v_pk_fma_f32 v[242:243], v[242:243], v[232:233], v[232:233] op_sel:[0,0,0] op_sel_hi:[1,0,0]
  v_pk_fma_f32 v[244:245], v[244:245], v[232:233], v[232:233] op_sel:[0,0,0] op_sel_hi:[1,0,0]
  v_pk_mul_f32 v[140:141], v[140:141], v[246:247]
  v_pk_mul_f32 v[142:143], v[142:143], v[248:249]
  v_pk_mul_f32 v[246:247], v[164:165], v[238:239] op_sel:[0,1] op_sel_hi:[1,1]
  v_pk_mul_f32 v[248:249], v[166:167], v[238:239] op_sel:[0,1] op_sel_hi:[1,1]
  v_pk_mul_f32 v[164:165], v[164:165], v[180:181]
  v_pk_mul_f32 v[166:167], v[166:167], v[182:183]
  v_rcp_f32 v242, v242
  v_mfma_f32_16x16x32_bf16 v[212:215], a[72:75], a[196:199], v[212:215]
  s_min_u32 s63, s90, 4096
  s_add_u32 s63, s63, s48
  buffer_load_dwordx4 a[144:147], v8, s[4:7], s63 offen offset:2048 sc1
  v_rcp_f32 v243, v243
  v_mfma_f32_16x16x32_bf16 v[212:215], a[76:79], a[212:215], v[212:215]
  buffer_load_dwordx4 a[148:151], v9, s[4:7], s63 offen offset:2048 sc1
  v_rcp_f32 v244, v244
  v_mfma_f32_16x16x32_bf16 v[208:211], a[76:79], a[208:211], v[208:211]
  s_min_u32 s63, s91, 4096
  s_add_u32 s63, s63, s48
  ds_read_b64_tr_b16 a[92:93], v230 offset:57344
  v_cvt_pk_bf16_f32 v156, v140, v141
  v_mfma_f32_16x16x32_bf16 v[208:211], a[72:75], a[192:195], v[208:211]
  s_waitcnt lgkmcnt(3)
  ds_read_b64_tr_b16 a[94:95], v230 offset:61440
  v_cvt_pk_bf16_f32 v157, v142, v143
  v_mfma_f32_16x16x32_bf16 v[192:195], a[80:83], a[224:227], v[192:195]
  buffer_load_dwordx4 a[152:155], v8, s[4:7], s63 offen offset:3072 sc1
  v_exp_f32 v246, v246
  v_mfma_f32_16x16x32_bf16 v[192:195], a[84:87], a[240:243], v[192:195]
  buffer_load_dwordx4 a[156:159], v9, s[4:7], s63 offen offset:3072 sc1
  v_exp_f32 v247, v247
  v_mfma_f32_16x16x32_bf16 v[196:199], a[84:87], a[244:247], v[196:199]
  v_mfma_f32_16x16x32_bf16 v[196:199], a[80:83], a[228:231], v[196:199]
  v_exp_f32 v248, v248
  v_exp_f32 v249, v249
  v_rcp_f32 v245, v245
  v_pk_fma_f32 v[246:247], v[246:247], v[232:233], v[232:233] op_sel:[0,1,1] op_sel_hi:[1,1,1]
  v_pk_fma_f32 v[248:249], v[248:249], v[232:233], v[232:233] op_sel:[0,1,1] op_sel_hi:[1,1,1]
  v_pk_mul_f32 v[160:161], v[160:161], v[242:243]
  v_pk_mul_f32 v[162:163], v[162:163], v[244:245]
  v_pk_mul_f32 v[242:243], v[168:169], v[240:241] op_sel:[0,0] op_sel_hi:[1,0]
  v_pk_mul_f32 v[244:245], v[170:171], v[240:241] op_sel:[0,0] op_sel_hi:[1,0]
  v_pk_mul_f32 v[168:169], v[168:169], v[184:185]
  v_pk_mul_f32 v[170:171], v[170:171], v[186:187]
  v_rcp_f32 v246, v246
  v_mfma_f32_16x16x32_bf16 v[200:203], a[80:83], a[232:235], v[200:203]
  s_waitcnt vmcnt(8)
  s_barrier
  s_cmp_lg_u32 s40, 0
  s_cbranch_scc1 Lsgf18
  v_mov_b32 v250, 1
  s_mov_b64 exec, 1
  buffer_atomic_add v250, v251, s[4:7], s77 offen sc1
  s_mov_b64 exec, -1
Lsgf18:
  s_add_u32 s77, s77, 4096
  v_rcp_f32 v247, v247
  v_mfma_f32_16x16x32_bf16 v[200:203], a[84:87], a[248:251], v[200:203]
  s_add_u32 s48, s48, 4096
  s_min_u32 s63, s88, 4096
  s_add_u32 s63, s63, s48
  buffer_load_dwordx4 a[160:163], v8, s[4:7], s63 offen offset:0 sc1
  v_rcp_f32 v248, v248
  v_mfma_f32_16x16x32_bf16 v[204:207], a[84:87], a[252:255], v[204:207]
  v_cvt_pk_bf16_f32 v146, v160, v161
  v_mfma_f32_16x16x32_bf16 v[204:207], a[80:83], a[236:239], v[204:207]
  v_cvt_pk_bf16_f32 v147, v162, v163
  s_waitcnt lgkmcnt(0)
  v_mfma_f32_16x16x32_bf16 v[220:223], a[88:91], a[236:239], v[220:223]
  buffer_load_dwordx4 a[164:167], v9, s[4:7], s63 offen offset:0 sc1
  buffer_store_dwordx4 v[144:147], v231, s[4:7], s57 offen sc1
  s_add_u32 s57, s57, 16384
  v_exp_f32 v242, v242
  v_mfma_f32_16x16x32_bf16 v[220:223], a[92:95], a[252:255], v[220:223]
  s_min_u32 s63, s89, 4096
  s_add_u32 s63, s63, s48
  buffer_load_dwordx4 a[168:171], v8, s[4:7], s63 offen offset:1024 sc1
  v_exp_f32 v243, v243
  v_mfma_f32_16x16x32_bf16 v[216:219], a[92:95], a[248:251], v[216:219]
  v_mfma_f32_16x16x32_bf16 v[216:219], a[88:91], a[232:235], v[216:219]
  buffer_load_dwordx4 a[172:175], v9, s[4:7], s63 offen offset:1024 sc1
  v_exp_f32 v244, v244
  v_exp_f32 v245, v245
  v_rcp_f32 v249, v249
  v_pk_fma_f32 v[242:243], v[242:243], v[234:235], v[234:235] op_sel:[0,0,0] op_sel_hi:[1,0,0]
  v_pk_fma_f32 v[244:245], v[244:245], v[234:235], v[234:235] op_sel:[0,0,0] op_sel_hi:[1,0,0]
  v_pk_mul_f32 v[164:165], v[164:165], v[246:247]
  v_pk_mul_f32 v[166:167], v[166:167], v[248:249]
  v_pk_mul_f32 v[246:247], v[172:173], v[240:241] op_sel:[0,1] op_sel_hi:[1,1]
  v_pk_mul_f32 v[248:249], v[174:175], v[240:241] op_sel:[0,1] op_sel_hi:[1,1]
  v_pk_mul_f32 v[172:173], v[172:173], v[188:189]
  v_pk_mul_f32 v[174:175], v[174:175], v[190:191]
  v_rcp_f32 v242, v242
  v_mfma_f32_16x16x32_bf16 v[212:215], a[88:91], a[228:231], v[212:215]
  v_mfma_f32_16x16x32_bf16 v[212:215], a[92:95], a[244:247], v[212:215]
  v_mfma_f32_16x16x32_bf16 v[208:211], a[92:95], a[240:243], v[208:211]
  v_mfma_f32_16x16x32_bf16 v[208:211], a[88:91], a[224:227], v[208:211]
  ds_read_b64_tr_b16 a[0:1], v0 offset:0
  ds_read_b64_tr_b16 a[2:3], v0 offset:4096
  ds_read_b64_tr_b16 a[16:17], v0 offset:8192
  ds_read_b64_tr_b16 a[18:19], v0 offset:12288
  ds_read_b64_tr_b16 a[4:5], v1 offset:0
  ds_read_b64_tr_b16 a[6:7], v1 offset:4096
  ds_read_b64_tr_b16 a[20:21], v1 offset:8192
  ds_read_b64_tr_b16 a[22:23], v1 offset:12288
  ds_read_b64_tr_b16 a[8:9], v2 offset:0
  ds_read_b64_tr_b16 a[10:11], v2 offset:4096
  ds_read_b64_tr_b16 a[24:25], v2 offset:8192
  ds_read_b64_tr_b16 a[26:27], v2 offset:12288
  ds_read_b64_tr_b16 a[12:13], v3 offset:0
  ds_read_b64_tr_b16 a[14:15], v3 offset:4096
  ds_read_b64_tr_b16 a[28:29], v3 offset:8192
  ds_read_b64_tr_b16 a[30:31], v3 offset:12288
  s_min_u32 s63, s90, 4096
  s_add_u32 s63, s63, s48
  buffer_load_dwordx4 a[176:179], v8, s[4:7], s63 offen offset:2048 sc1
  buffer_load_dwordx4 a[180:183], v9, s[4:7], s63 offen offset:2048 sc1
  v_rcp_f32 v243, v243
  v_rcp_f32 v244, v244
  v_cvt_pk_bf16_f32 v150, v164, v165
  v_cvt_pk_bf16_f32 v151, v166, v167
  s_min_u32 s63, s91, 4096
  s_add_u32 s63, s63, s48
  buffer_load_dwordx4 a[184:187], v8, s[4:7], s63 offen offset:3072 sc1
  buffer_load_dwordx4 a[188:191], v9, s[4:7], s63 offen offset:3072 sc1
  buffer_store_dwordx4 v[148:151], v231, s[4:7], s58 offen sc1
  s_add_u32 s58, s58, 16384
  v_exp_f32 v246, v246
  v_exp_f32 v247, v247
  v_exp_f32 v248, v248
  v_exp_f32 v249, v249
  v_rcp_f32 v245, v245
  v_pk_fma_f32 v[246:247], v[246:247], v[234:235], v[234:235] op_sel:[0,1,1] op_sel_hi:[1,1,1]
  v_pk_fma_f32 v[248:249], v[248:249], v[234:235], v[234:235] op_sel:[0,1,1] op_sel_hi:[1,1,1]
  v_pk_mul_f32 v[168:169], v[168:169], v[242:243]
  v_pk_mul_f32 v[170:171], v[170:171], v[244:245]
  v_pk_mul_f32 v[242:243], v[192:193], v[238:239] op_sel:[0,0] op_sel_hi:[1,0]
  v_pk_mul_f32 v[244:245], v[194:195], v[238:239] op_sel:[0,0] op_sel_hi:[1,0]
  v_pk_mul_f32 v[192:193], v[192:193], v[208:209]
  v_pk_mul_f32 v[194:195], v[194:195], v[210:211]
  v_rcp_f32 v246, v246
  s_add_u32 m0, s79, 65536
  s_add_u32 s92, s92, 196608
  s_add_u32 s93, s92, s88
  v_rcp_f32 v247, v247
  v_rcp_f32 v248, v248
  v_cvt_pk_bf16_f32 v154, v168, v169
  v_cvt_pk_bf16_f32 v155, v170, v171
  buffer_load_dwordx4 v252, s[80:83], s93 offen lds
  buffer_load_dwordx4 v252, s[84:87], s93 offen offset:1024 lds
  buffer_store_dwordx4 v[152:155], v231, s[4:7], s59 offen sc1
  s_add_u32 s59, s59, 16384
  v_exp_f32 v242, v242
  v_exp_f32 v243, v243
  v_exp_f32 v244, v244
  v_exp_f32 v245, v245
  v_rcp_f32 v249, v249
  v_pk_fma_f32 v[242:243], v[242:243], v[232:233], v[232:233] op_sel:[0,0,0] op_sel_hi:[1,0,0]
  v_pk_fma_f32 v[244:245], v[244:245], v[232:233], v[232:233] op_sel:[0,0,0] op_sel_hi:[1,0,0]
  v_pk_mul_f32 v[172:173], v[172:173], v[246:247]
  v_pk_mul_f32 v[174:175], v[174:175], v[248:249]
  v_pk_mul_f32 v[246:247], v[196:197], v[238:239] op_sel:[0,1] op_sel_hi:[1,1]
  v_pk_mul_f32 v[248:249], v[198:199], v[238:239] op_sel:[0,1] op_sel_hi:[1,1]
  v_pk_mul_f32 v[196:197], v[196:197], v[212:213]
  v_pk_mul_f32 v[198:199], v[198:199], v[214:215]
  v_rcp_f32 v242, v242
  s_add_u32 m0, s79, 73728
  s_add_u32 s92, s92, 262144
  s_add_u32 s93, s92, s89
  v_rcp_f32 v243, v243
  v_rcp_f32 v244, v244
  v_cvt_pk_bf16_f32 v158, v172, v173
  v_cvt_pk_bf16_f32 v159, v174, v175
  buffer_load_dwordx4 v252, s[80:83], s93 offen lds
  buffer_load_dwordx4 v252, s[84:87], s93 offen offset:1024 lds
  buffer_store_dwordx4 v[156:159], v231, s[4:7], s60 offen sc1
  s_add_u32 s60, s60, 16384
  v_exp_f32 v246, v246
  v_exp_f32 v247, v247
  v_exp_f32 v248, v248
  v_exp_f32 v249, v249
  v_rcp_f32 v245, v245
  v_pk_fma_f32 v[246:247], v[246:247], v[232:233], v[232:233] op_sel:[0,1,1] op_sel_hi:[1,1,1]
  v_pk_fma_f32 v[248:249], v[248:249], v[232:233], v[232:233] op_sel:[0,1,1] op_sel_hi:[1,1,1]
  v_pk_mul_f32 v[192:193], v[192:193], v[242:243]
  v_pk_mul_f32 v[194:195], v[194:195], v[244:245]
  v_pk_mul_f32 v[242:243], v[200:201], v[240:241] op_sel:[0,0] op_sel_hi:[1,0]
  v_pk_mul_f32 v[244:245], v[202:203], v[240:241] op_sel:[0,0] op_sel_hi:[1,0]
  v_pk_mul_f32 v[200:201], v[200:201], v[216:217]
  v_pk_mul_f32 v[202:203], v[202:203], v[218:219]
  v_rcp_f32 v246, v246
  s_add_u32 m0, s79, 81920
  s_add_u32 s92, s92, 196608
  s_add_u32 s93, s92, s90
  v_rcp_f32 v247, v247
  v_rcp_f32 v248, v248
  v_cvt_pk_bf16_f32 v208, v192, v193
  v_cvt_pk_bf16_f32 v209, v194, v195
  buffer_load_dwordx4 v252, s[80:83], s93 offen lds
  buffer_load_dwordx4 v252, s[84:87], s93 offen offset:1024 lds
  v_exp_f32 v242, v242
  v_exp_f32 v243, v243
  v_exp_f32 v244, v244
  v_exp_f32 v245, v245
  v_rcp_f32 v249, v249
  v_pk_fma_f32 v[242:243], v[242:243], v[234:235], v[234:235] op_sel:[0,0,0] op_sel_hi:[1,0,0]
  v_pk_fma_f32 v[244:245], v[244:245], v[234:235], v[234:235] op_sel:[0,0,0] op_sel_hi:[1,0,0]
  v_pk_mul_f32 v[196:197], v[196:197], v[246:247]
  v_pk_mul_f32 v[198:199], v[198:199], v[248:249]
  v_pk_mul_f32 v[246:247], v[204:205], v[240:241] op_sel:[0,1] op_sel_hi:[1,1]
  v_pk_mul_f32 v[248:249], v[206:207], v[240:241] op_sel:[0,1] op_sel_hi:[1,1]
  v_pk_mul_f32 v[204:205], v[204:205], v[220:221]
  v_pk_mul_f32 v[206:207], v[206:207], v[222:223]
  v_rcp_f32 v242, v242
  s_add_u32 m0, s79, 90112
  s_add_u32 s92, s92, 262144
  s_add_u32 s93, s92, s91
  v_rcp_f32 v243, v243
  v_rcp_f32 v244, v244
  v_cvt_pk_bf16_f32 v210, v196, v197
  v_cvt_pk_bf16_f32 v211, v198, v199
  buffer_load_dwordx4 v252, s[80:83], s93 offen lds
  buffer_load_dwordx4 v252, s[84:87], s93 offen offset:1024 lds
  s_nop 1
  v_permlane32_swap_b32 v208, v210
  v_permlane32_swap_b32 v209, v211
  buffer_store_dwordx4 v[208:211], v236, s[4:7], s61 offen sc1
  v_exp_f32 v246, v246
  v_exp_f32 v247, v247
  v_exp_f32 v248, v248
  v_exp_f32 v249, v249
  v_rcp_f32 v245, v245
  v_pk_fma_f32 v[246:247], v[246:247], v[234:235], v[234:235] op_sel:[0,1,1] op_sel_hi:[1,1,1]
  v_pk_fma_f32 v[248:249], v[248:249], v[234:235], v[234:235] op_sel:[0,1,1] op_sel_hi:[1,1,1]
  v_pk_mul_f32 v[200:201], v[200:201], v[242:243]
  v_pk_mul_f32 v[202:203], v[202:203], v[244:245]
  v_rcp_f32 v246, v246
  v_rcp_f32 v247, v247
  v_rcp_f32 v248, v248
  v_cvt_pk_bf16_f32 v216, v200, v201
  v_cvt_pk_bf16_f32 v217, v202, v203
  v_rcp_f32 v249, v249
  s_nop 0
  v_pk_mul_f32 v[204:205], v[204:205], v[246:247]
  v_pk_mul_f32 v[206:207], v[206:207], v[248:249]
  v_cvt_pk_bf16_f32 v218, v204, v205
  v_cvt_pk_bf16_f32 v219, v206, v207
  s_nop 1
  v_permlane32_swap_b32 v216, v218
  v_permlane32_swap_b32 v217, v219
  buffer_store_dwordx4 v[216:219], v236, s[4:7], s62 offen sc1
  v_pk_mul_f32 v[32:33], v[250:251], 0 op_sel:[1,0] op_sel_hi:[1,0]
  v_pk_mul_f32 v[34:35], v[250:251], 0 op_sel:[1,0] op_sel_hi:[1,0]
  v_pk_mul_f32 v[36:37], v[250:251], 0 op_sel:[1,0] op_sel_hi:[1,0]
  v_pk_mul_f32 v[38:39], v[250:251], 0 op_sel:[1,0] op_sel_hi:[1,0]
  v_pk_mul_f32 v[40:41], v[250:251], 0 op_sel:[1,0] op_sel_hi:[1,0]
  v_pk_mul_f32 v[42:43], v[250:251], 0 op_sel:[1,0] op_sel_hi:[1,0]
  v_pk_mul_f32 v[44:45], v[250:251], 0 op_sel:[1,0] op_sel_hi:[1,0]
  v_pk_mul_f32 v[46:47], v[250:251], 0 op_sel:[1,0] op_sel_hi:[1,0]
  v_pk_mul_f32 v[48:49], v[250:251], 0 op_sel:[1,0] op_sel_hi:[1,0]
  v_pk_mul_f32 v[50:51], v[250:251], 0 op_sel:[1,0] op_sel_hi:[1,0]
  v_pk_mul_f32 v[52:53], v[250:251], 0 op_sel:[1,0] op_sel_hi:[1,0]
  v_pk_mul_f32 v[54:55], v[250:251], 0 op_sel:[1,0] op_sel_hi:[1,0]
  v_pk_mul_f32 v[56:57], v[250:251], 0 op_sel:[1,0] op_sel_hi:[1,0]
  v_pk_mul_f32 v[58:59], v[250:251], 0 op_sel:[1,0] op_sel_hi:[1,0]
  v_pk_mul_f32 v[60:61], v[250:251], 0 op_sel:[1,0] op_sel_hi:[1,0]
  v_pk_mul_f32 v[62:63], v[250:251], 0 op_sel:[1,0] op_sel_hi:[1,0]
  v_lshlrev_b32 v64, 16, v16
  v_and_b32 v65, 0xffff0000, v16
  v_lshlrev_b32 v66, 16, v17
  v_and_b32 v67, 0xffff0000, v17
  v_lshlrev_b32 v72, 16, v18
  v_and_b32 v73, 0xffff0000, v18
  v_lshlrev_b32 v74, 16, v19
  v_and_b32 v75, 0xffff0000, v19
  v_lshlrev_b32 v80, 16, v20
  v_and_b32 v81, 0xffff0000, v20
  v_lshlrev_b32 v82, 16, v21
  v_and_b32 v83, 0xffff0000, v21
  v_lshlrev_b32 v88, 16, v22
  v_and_b32 v89, 0xffff0000, v22
  v_lshlrev_b32 v90, 16, v23
  v_and_b32 v91, 0xffff0000, v23
  v_lshlrev_b32 v68, 16, v24
  v_and_b32 v69, 0xffff0000, v24
  v_lshlrev_b32 v70, 16, v25
  v_and_b32 v71, 0xffff0000, v25
  v_lshlrev_b32 v76, 16, v26
  v_and_b32 v77, 0xffff0000, v26
  v_lshlrev_b32 v78, 16, v27
  v_and_b32 v79, 0xffff0000, v27
  v_lshlrev_b32 v84, 16, v28
  v_and_b32 v85, 0xffff0000, v28
  v_lshlrev_b32 v86, 16, v29
  v_and_b32 v87, 0xffff0000, v29
  v_lshlrev_b32 v92, 16, v30
  v_and_b32 v93, 0xffff0000, v30
  v_lshlrev_b32 v94, 16, v31
  v_and_b32 v95, 0xffff0000, v31
  s_mov_b32 s56, 2
.p2align 3
Lp4_loop:
  s_waitcnt vmcnt(24) lgkmcnt(8)
  v_mfma_f32_16x16x32_bf16 v[32:35], a[0:3], a[128:131], v[32:35]
  s_waitcnt vmcnt(26)
  s_barrier
  ds_read_b64_tr_b16 a[32:33], v0 offset:1024
  s_add_u32 m0, s79, 98304
  s_add_u32 s92, s92, 196608
  s_cmp_lg_u32 s88, 0
  v_mfma_f32_16x16x32_bf16 v[32:35], a[16:19], a[136:139], v[32:35]
  s_cselect_b32 s93, -2686976, 0
  ds_read_b64_tr_b16 a[34:35], v0 offset:5120
  s_add_u32 s93, s93, s92
  v_mfma_f32_16x16x32_bf16 v[36:39], a[16:19], a[140:143], v[36:39]
  ds_read_b64_tr_b16 a[48:49], v0 offset:9216
  buffer_load_dwordx4 v252, s[80:83], s93 offen lds
  v_mfma_f32_16x16x32_bf16 v[36:39], a[0:3], a[132:135], v[36:39]
  ds_read_b64_tr_b16 a[50:51], v0 offset:13312
  v_mfma_f32_16x16x32_bf16 v[44:47], a[4:7], a[132:135], v[44:47]
  ds_read_b64_tr_b16 a[36:37], v1 offset:1024
  v_mfma_f32_16x16x32_bf16 v[44:47], a[20:23], a[140:143], v[44:47]
  ds_read_b64_tr_b16 a[38:39], v1 offset:5120
  v_mfma_f32_16x16x32_bf16 v[40:43], a[20:23], a[136:139], v[40:43]
  ds_read_b64_tr_b16 a[52:53], v1 offset:9216
  buffer_load_dwordx4 v252, s[84:87], s93 offen offset:1024 lds
  v_mfma_f32_16x16x32_bf16 v[40:43], a[4:7], a[128:131], v[40:43]
  ds_read_b64_tr_b16 a[54:55], v1 offset:13312
  s_waitcnt lgkmcnt(8)
  v_mfma_f32_16x16x32_bf16 v[48:51], a[8:11], a[128:131], v[48:51]
  ds_read_b64_tr_b16 a[40:41], v2 offset:1024
  v_mfma_f32_16x16x32_bf16 v[48:51], a[24:27], a[136:139], v[48:51]
  s_add_u32 s48, s48, 4096
  ds_read_b64_tr_b16 a[42:43], v2 offset:5120
  s_min_u32 s63, s88, 4096
  v_mfma_f32_16x16x32_bf16 v[52:55], a[24:27], a[140:143], v[52:55]
  s_add_u32 s63, s63, s48
  ds_read_b64_tr_b16 a[56:57], v2 offset:9216
  buffer_load_dwordx4 a[192:195], v8, s[4:7], s63 offen offset:0 sc1
  v_mfma_f32_16x16x32_bf16 v[52:55], a[8:11], a[132:135], v[52:55]
  ds_read_b64_tr_b16 a[58:59], v2 offset:13312
  v_mfma_f32_16x16x32_bf16 v[60:63], a[12:15], a[132:135], v[60:63]
  ds_read_b64_tr_b16 a[44:45], v3 offset:1024
  v_mfma_f32_16x16x32_bf16 v[60:63], a[28:31], a[140:143], v[60:63]
  ds_read_b64_tr_b16 a[46:47], v3 offset:5120
  v_mfma_f32_16x16x32_bf16 v[56:59], a[28:31], a[136:139], v[56:59]
  ds_read_b64_tr_b16 a[60:61], v3 offset:9216
  buffer_load_dwordx4 a[196:199], v9, s[4:7], s63 offen offset:0 sc1
  v_mfma_f32_16x16x32_bf16 v[56:59], a[12:15], a[128:131], v[56:59]
  ds_read_b64_tr_b16 a[62:63], v3 offset:13312
  s_waitcnt lgkmcnt(8)
  v_mfma_f32_16x16x32_bf16 v[64:67], a[32:35], a[128:131], v[64:67]
  s_add_u32 m0, s79, 106496
  ds_read_b64_tr_b16 a[0:1], v0 offset:16384
  buffer_load_dword v10, v251, s[4:7], s64 offen sc1
  s_add_u32 s92, s92, 262144
  s_cmp_lg_u32 s89, 0
  v_mfma_f32_16x16x32_bf16 v[64:67], a[48:51], a[136:139], v[64:67]
  s_cselect_b32 s93, -2686976, 0
  ds_read_b64_tr_b16 a[2:3], v0 offset:20480
  s_add_u32 s93, s93, s92
  v_mfma_f32_16x16x32_bf16 v[68:71], a[48:51], a[140:143], v[68:71]
  ds_read_b64_tr_b16 a[16:17], v0 offset:24576
  buffer_load_dwordx4 v252, s[80:83], s93 offen lds
  v_mfma_f32_16x16x32_bf16 v[68:71], a[32:35], a[132:135], v[68:71]
  ds_read_b64_tr_b16 a[18:19], v0 offset:28672
  v_mfma_f32_16x16x32_bf16 v[76:79], a[36:39], a[132:135], v[76:79]
  ds_read_b64_tr_b16 a[4:5], v1 offset:16384
  v_mfma_f32_16x16x32_bf16 v[76:79], a[52:55], a[140:143], v[76:79]
  ds_read_b64_tr_b16 a[6:7], v1 offset:20480
  v_mfma_f32_16x16x32_bf16 v[72:75], a[52:55], a[136:139], v[72:75]
  ds_read_b64_tr_b16 a[20:21], v1 offset:24576
  buffer_load_dwordx4 v252, s[84:87], s93 offen offset:1024 lds
  v_mfma_f32_16x16x32_bf16 v[72:75], a[36:39], a[128:131], v[72:75]
  ds_read_b64_tr_b16 a[22:23], v1 offset:28672
  s_waitcnt lgkmcnt(8)
  v_mfma_f32_16x16x32_bf16 v[80:83], a[40:43], a[128:131], v[80:83]
  ds_read_b64_tr_b16 a[8:9], v2 offset:16384
  v_mfma_f32_16x16x32_bf16 v[80:83], a[56:59], a[136:139], v[80:83]
  s_min_u32 s63, s89, 4096
  ds_read_b64_tr_b16 a[10:11], v2 offset:20480
  s_add_u32 s63, s63, s48
  v_mfma_f32_16x16x32_bf16 v[84:87], a[56:59], a[140:143], v[84:87]
  ds_read_b64_tr_b16 a[24:25], v2 offset:24576
  buffer_load_dwordx4 a[200:203], v8, s[4:7], s63 offen offset:1024 sc1
  v_mfma_f32_16x16x32_bf16 v[84:87], a[40:43], a[132:135], v[84:87]
  ds_read_b64_tr_b16 a[26:27], v2 offset:28672
  v_mfma_f32_16x16x32_bf16 v[92:95], a[44:47], a[132:135], v[92:95]
  ds_read_b64_tr_b16 a[12:13], v3 offset:16384
  v_mfma_f32_16x16x32_bf16 v[92:95], a[60:63], a[140:143], v[92:95]
  ds_read_b64_tr_b16 a[14:15], v3 offset:20480
  v_mfma_f32_16x16x32_bf16 v[88:91], a[60:63], a[136:139], v[88:91]
  ds_read_b64_tr_b16 a[28:29], v3 offset:24576
  buffer_load_dwordx4 a[204:207], v9, s[4:7], s63 offen offset:1024 sc1
  v_mfma_f32_16x16x32_bf16 v[88:91], a[44:47], a[128:131], v[88:91]
  ds_read_b64_tr_b16 a[30:31], v3 offset:28672
  s_waitcnt vmcnt(25) lgkmcnt(8)
  v_mfma_f32_16x16x32_bf16 v[32:35], a[0:3], a[144:147], v[32:35]
  s_add_u32 m0, s79, 114688
  ds_read_b64_tr_b16 a[32:33], v0 offset:17408
  s_add_u32 s92, s92, 196608
  s_cmp_lg_u32 s90, 0
  v_mfma_f32_16x16x32_bf16 v[32:35], a[16:19], a[152:155], v[32:35]
  s_cselect_b32 s93, -2686976, 0
  ds_read_b64_tr_b16 a[34:35], v0 offset:21504
  s_add_u32 s93, s93, s92
  v_mfma_f32_16x16x32_bf16 v[36:39], a[16:19], a[156:159], v[36:39]
  ds_read_b64_tr_b16 a[48:49], v0 offset:25600
  buffer_load_dwordx4 v252, s[80:83], s93 offen lds
  v_mfma_f32_16x16x32_bf16 v[36:39], a[0:3], a[148:151], v[36:39]
  ds_read_b64_tr_b16 a[50:51], v0 offset:29696
  v_mfma_f32_16x16x32_bf16 v[44:47], a[4:7], a[148:151], v[44:47]
  ds_read_b64_tr_b16 a[36:37], v1 offset:17408
  v_mfma_f32_16x16x32_bf16 v[44:47], a[20:23], a[156:159], v[44:47]
  ds_read_b64_tr_b16 a[38:39], v1 offset:21504
  v_mfma_f32_16x16x32_bf16 v[40:43], a[20:23], a[152:155], v[40:43]
  ds_read_b64_tr_b16 a[52:53], v1 offset:25600
  buffer_load_dwordx4 v252, s[84:87], s93 offen offset:1024 lds
  v_mfma_f32_16x16x32_bf16 v[40:43], a[4:7], a[144:147], v[40:43]
  ds_read_b64_tr_b16 a[54:55], v1 offset:29696
  s_waitcnt lgkmcnt(8)
  v_mfma_f32_16x16x32_bf16 v[48:51], a[8:11], a[144:147], v[48:51]
  ds_read_b64_tr_b16 a[40:41], v2 offset:17408
  v_mfma_f32_16x16x32_bf16 v[48:51], a[24:27], a[152:155], v[48:51]
  s_min_u32 s63, s90, 4096
  ds_read_b64_tr_b16 a[42:43], v2 offset:21504
  s_add_u32 s63, s63, s48
  v_mfma_f32_16x16x32_bf16 v[52:55], a[24:27], a[156:159], v[52:55]
  ds_read_b64_tr_b16 a[56:57], v2 offset:25600
  buffer_load_dwordx4 a[208:211], v8, s[4:7], s63 offen offset:2048 sc1
  v_mfma_f32_16x16x32_bf16 v[52:55], a[8:11], a[148:151], v[52:55]
  ds_read_b64_tr_b16 a[58:59], v2 offset:29696
  v_mfma_f32_16x16x32_bf16 v[60:63], a[12:15], a[148:151], v[60:63]
  ds_read_b64_tr_b16 a[44:45], v3 offset:17408
  v_mfma_f32_16x16x32_bf16 v[60:63], a[28:31], a[156:159], v[60:63]
  ds_read_b64_tr_b16 a[46:47], v3 offset:21504
  v_mfma_f32_16x16x32_bf16 v[56:59], a[28:31], a[152:155], v[56:59]
  ds_read_b64_tr_b16 a[60:61], v3 offset:25600
  buffer_load_dwordx4 a[212:215], v9, s[4:7], s63 offen offset:2048 sc1
  v_mfma_f32_16x16x32_bf16 v[56:59], a[12:15], a[144:147], v[56:59]
  ds_read_b64_tr_b16 a[62:63], v3 offset:29696
  s_waitcnt lgkmcnt(8)
  v_mfma_f32_16x16x32_bf16 v[64:67], a[32:35], a[144:147], v[64:67]
  s_add_u32 m0, s79, 122880
  ds_read_b64_tr_b16 a[0:1], v0 offset:32768
  s_add_u32 s92, s92, 262144
  s_cmp_lg_u32 s91, 0
  v_mfma_f32_16x16x32_bf16 v[64:67], a[48:51], a[152:155], v[64:67]
  s_cselect_b32 s93, -2686976, 0
  ds_read_b64_tr_b16 a[2:3], v0 offset:36864
  s_add_u32 s93, s93, s92
  v_mfma_f32_16x16x32_bf16 v[68:71], a[48:51], a[156:159], v[68:71]
  ds_read_b64_tr_b16 a[16:17], v0 offset:40960
  buffer_load_dwordx4 v252, s[80:83], s93 offen lds
  v_mfma_f32_16x16x32_bf16 v[68:71], a[32:35], a[148:151], v[68:71]
  ds_read_b64_tr_b16 a[18:19], v0 offset:45056
  v_mfma_f32_16x16x32_bf16 v[76:79], a[36:39], a[148:151], v[76:79]
  ds_read_b64_tr_b16 a[4:5], v1 offset:32768
  v_mfma_f32_16x16x32_bf16 v[76:79], a[52:55], a[156:159], v[76:79]
  ds_read_b64_tr_b16 a[6:7], v1 offset:36864
  v_mfma_f32_16x16x32_bf16 v[72:75], a[52:55], a[152:155], v[72:75]
  ds_read_b64_tr_b16 a[20:21], v1 offset:40960
  buffer_load_dwordx4 v252, s[84:87], s93 offen offset:1024 lds
  v_mfma_f32_16x16x32_bf16 v[72:75], a[36:39], a[144:147], v[72:75]
  ds_read_b64_tr_b16 a[22:23], v1 offset:45056
  s_waitcnt lgkmcnt(8)
  v_mfma_f32_16x16x32_bf16 v[80:83], a[40:43], a[144:147], v[80:83]
  ds_read_b64_tr_b16 a[8:9], v2 offset:32768
  v_mfma_f32_16x16x32_bf16 v[80:83], a[56:59], a[152:155], v[80:83]
  s_min_u32 s63, s91, 4096
  ds_read_b64_tr_b16 a[10:11], v2 offset:36864
  s_add_u32 s63, s63, s48
  v_mfma_f32_16x16x32_bf16 v[84:87], a[56:59], a[156:159], v[84:87]
  ds_read_b64_tr_b16 a[24:25], v2 offset:40960
  buffer_load_dwordx4 a[216:219], v8, s[4:7], s63 offen offset:3072 sc1
  v_mfma_f32_16x16x32_bf16 v[84:87], a[40:43], a[148:151], v[84:87]
  ds_read_b64_tr_b16 a[26:27], v2 offset:45056
  v_mfma_f32_16x16x32_bf16 v[92:95], a[44:47], a[148:151], v[92:95]
  ds_read_b64_tr_b16 a[12:13], v3 offset:32768
  v_mfma_f32_16x16x32_bf16 v[92:95], a[60:63], a[156:159], v[92:95]
  ds_read_b64_tr_b16 a[14:15], v3 offset:36864
  v_mfma_f32_16x16x32_bf16 v[88:91], a[60:63], a[152:155], v[88:91]
  ds_read_b64_tr_b16 a[28:29], v3 offset:40960
  buffer_load_dwordx4 a[220:223], v9, s[4:7], s63 offen offset:3072 sc1
  v_mfma_f32_16x16x32_bf16 v[88:91], a[44:47], a[144:147], v[88:91]
  ds_read_b64_tr_b16 a[30:31], v3 offset:45056
  s_waitcnt vmcnt(25) lgkmcnt(8)
  v_mfma_f32_16x16x32_bf16 v[32:35], a[0:3], a[160:163], v[32:35]
  s_waitcnt vmcnt(24)
  s_barrier
  ds_read_b64_tr_b16 a[32:33], v0 offset:33792
  s_waitcnt vmcnt(12)
  v_cmp_gt_u32 vcc, 16, v10
  s_cbranch_vccz Lp4b_ok
  s_mov_b32 s43, 0x40000
Lp4b_sp:
  s_sleep 10
  buffer_load_dword v10, v251, s[4:7], s64 offen sc1
  s_waitcnt vmcnt(0)
  v_cmp_gt_u32 vcc, 16, v10
  s_cbranch_vccz Lp4b_ok
  s_sub_u32 s43, s43, 1
  s_cmp_lg_u32 s43, 0
  s_cbranch_scc1 Lp4b_sp
Lp4b_ok:
  s_add_u32 s64, s64, 4096
  v_mfma_f32_16x16x32_bf16 v[32:35], a[16:19], a[168:171], v[32:35]
  s_add_u32 m0, s79, 0
  ds_read_b64_tr_b16 a[34:35], v0 offset:37888
  s_add_u32 s92, s92, -3407872
  v_mfma_f32_16x16x32_bf16 v[36:39], a[16:19], a[172:175], v[36:39]
  s_add_u32 s93, s92, s88
  ds_read_b64_tr_b16 a[48:49], v0 offset:41984
  buffer_load_dwordx4 v252, s[80:83], s93 offen lds
  v_mfma_f32_16x16x32_bf16 v[36:39], a[0:3], a[164:167], v[36:39]
  ds_read_b64_tr_b16 a[50:51], v0 offset:46080
  v_mfma_f32_16x16x32_bf16 v[44:47], a[4:7], a[164:167], v[44:47]
  ds_read_b64_tr_b16 a[36:37], v1 offset:33792
  v_mfma_f32_16x16x32_bf16 v[44:47], a[20:23], a[172:175], v[44:47]
  ds_read_b64_tr_b16 a[38:39], v1 offset:37888
  v_mfma_f32_16x16x32_bf16 v[40:43], a[20:23], a[168:171], v[40:43]
  ds_read_b64_tr_b16 a[52:53], v1 offset:41984
  buffer_load_dwordx4 v252, s[84:87], s93 offen offset:1024 lds
  v_mfma_f32_16x16x32_bf16 v[40:43], a[4:7], a[160:163], v[40:43]
  ds_read_b64_tr_b16 a[54:55], v1 offset:46080
  s_waitcnt lgkmcnt(8)
  v_mfma_f32_16x16x32_bf16 v[48:51], a[8:11], a[160:163], v[48:51]
  ds_read_b64_tr_b16 a[40:41], v2 offset:33792
  v_mfma_f32_16x16x32_bf16 v[48:51], a[24:27], a[168:171], v[48:51]
  s_add_u32 s48, s48, 4096
  ds_read_b64_tr_b16 a[42:43], v2 offset:37888
  s_min_u32 s63, s88, 4096
  v_mfma_f32_16x16x32_bf16 v[52:55], a[24:27], a[172:175], v[52:55]
  s_add_u32 s63, s63, s48
  ds_read_b64_tr_b16 a[56:57], v2 offset:41984
  buffer_load_dwordx4 a[224:227], v8, s[4:7], s63 offen offset:0 sc1
  v_mfma_f32_16x16x32_bf16 v[52:55], a[8:11], a[164:167], v[52:55]
  ds_read_b64_tr_b16 a[58:59], v2 offset:46080
  v_mfma_f32_16x16x32_bf16 v[60:63], a[12:15], a[164:167], v[60:63]
  ds_read_b64_tr_b16 a[44:45], v3 offset:33792
  v_mfma_f32_16x16x32_bf16 v[60:63], a[28:31], a[172:175], v[60:63]
  ds_read_b64_tr_b16 a[46:47], v3 offset:37888
  v_mfma_f32_16x16x32_bf16 v[56:59], a[28:31], a[168:171], v[56:59]
  ds_read_b64_tr_b16 a[60:61], v3 offset:41984
  buffer_load_dwordx4 a[228:231], v9, s[4:7], s63 offen offset:0 sc1
  v_mfma_f32_16x16x32_bf16 v[56:59], a[12:15], a[160:163], v[56:59]
  ds_read_b64_tr_b16 a[62:63], v3 offset:46080
  s_waitcnt lgkmcnt(8)
  v_mfma_f32_16x16x32_bf16 v[64:67], a[32:35], a[160:163], v[64:67]
  ds_read_b64_tr_b16 a[0:1], v0 offset:49152
  s_add_u32 m0, s79, 8192
  v_mfma_f32_16x16x32_bf16 v[64:67], a[48:51], a[168:171], v[64:67]
  s_add_u32 s92, s92, 262144
  ds_read_b64_tr_b16 a[2:3], v0 offset:53248
  s_add_u32 s93, s92, s89
  v_mfma_f32_16x16x32_bf16 v[68:71], a[48:51], a[172:175], v[68:71]
  ds_read_b64_tr_b16 a[16:17], v0 offset:57344
  buffer_load_dwordx4 v252, s[80:83], s93 offen lds
  v_mfma_f32_16x16x32_bf16 v[68:71], a[32:35], a[164:167], v[68:71]
  ds_read_b64_tr_b16 a[18:19], v0 offset:61440
  v_mfma_f32_16x16x32_bf16 v[76:79], a[36:39], a[164:167], v[76:79]
  ds_read_b64_tr_b16 a[4:5], v1 offset:49152
  v_mfma_f32_16x16x32_bf16 v[76:79], a[52:55], a[172:175], v[76:79]
  ds_read_b64_tr_b16 a[6:7], v1 offset:53248
  v_mfma_f32_16x16x32_bf16 v[72:75], a[52:55], a[168:171], v[72:75]
  ds_read_b64_tr_b16 a[20:21], v1 offset:57344
  buffer_load_dwordx4 v252, s[84:87], s93 offen offset:1024 lds
  v_mfma_f32_16x16x32_bf16 v[72:75], a[36:39], a[160:163], v[72:75]
  ds_read_b64_tr_b16 a[22:23], v1 offset:61440
  s_waitcnt lgkmcnt(8)
  v_mfma_f32_16x16x32_bf16 v[80:83], a[40:43], a[160:163], v[80:83]
  ds_read_b64_tr_b16 a[8:9], v2 offset:49152
  v_mfma_f32_16x16x32_bf16 v[80:83], a[56:59], a[168:171], v[80:83]
  s_min_u32 s63, s89, 4096
  ds_read_b64_tr_b16 a[10:11], v2 offset:53248
  s_add_u32 s63, s63, s48
  v_mfma_f32_16x16x32_bf16 v[84:87], a[56:59], a[172:175], v[84:87]
  ds_read_b64_tr_b16 a[24:25], v2 offset:57344
  buffer_load_dwordx4 a[232:235], v8, s[4:7], s63 offen offset:1024 sc1
  v_mfma_f32_16x16x32_bf16 v[84:87], a[40:43], a[164:167], v[84:87]
  ds_read_b64_tr_b16 a[26:27], v2 offset:61440
  v_mfma_f32_16x16x32_bf16 v[92:95], a[44:47], a[164:167], v[92:95]
  ds_read_b64_tr_b16 a[12:13], v3 offset:49152
  v_mfma_f32_16x16x32_bf16 v[92:95], a[60:63], a[172:175], v[92:95]
  ds_read_b64_tr_b16 a[14:15], v3 offset:53248
  v_mfma_f32_16x16x32_bf16 v[88:91], a[60:63], a[168:171], v[88:91]
  ds_read_b64_tr_b16 a[28:29], v3 offset:57344
  buffer_load_dwordx4 a[236:239], v9, s[4:7], s63 offen offset:1024 sc1
  v_mfma_f32_16x16x32_bf16 v[88:91], a[44:47], a[160:163], v[88:91]
  ds_read_b64_tr_b16 a[30:31], v3 offset:61440
  s_waitcnt vmcnt(25) lgkmcnt(8)
  v_mfma_f32_16x16x32_bf16 v[32:35], a[0:3], a[176:179], v[32:35]
  ds_read_b64_tr_b16 a[32:33], v0 offset:50176
  s_add_u32 m0, s79, 16384
  v_mfma_f32_16x16x32_bf16 v[32:35], a[16:19], a[184:187], v[32:35]
  s_add_u32 s92, s92, 196608
  ds_read_b64_tr_b16 a[34:35], v0 offset:54272
  s_add_u32 s93, s92, s90
  v_mfma_f32_16x16x32_bf16 v[36:39], a[16:19], a[188:191], v[36:39]
  ds_read_b64_tr_b16 a[48:49], v0 offset:58368
  buffer_load_dwordx4 v252, s[80:83], s93 offen lds
  v_mfma_f32_16x16x32_bf16 v[36:39], a[0:3], a[180:183], v[36:39]
  ds_read_b64_tr_b16 a[50:51], v0 offset:62464
  v_mfma_f32_16x16x32_bf16 v[44:47], a[4:7], a[180:183], v[44:47]
  ds_read_b64_tr_b16 a[36:37], v1 offset:50176
  v_mfma_f32_16x16x32_bf16 v[44:47], a[20:23], a[188:191], v[44:47]
  ds_read_b64_tr_b16 a[38:39], v1 offset:54272
  v_mfma_f32_16x16x32_bf16 v[40:43], a[20:23], a[184:187], v[40:43]
  ds_read_b64_tr_b16 a[52:53], v1 offset:58368
  buffer_load_dwordx4 v252, s[84:87], s93 offen offset:1024 lds
  v_mfma_f32_16x16x32_bf16 v[40:43], a[4:7], a[176:179], v[40:43]
  ds_read_b64_tr_b16 a[54:55], v1 offset:62464
  s_waitcnt lgkmcnt(8)
  v_mfma_f32_16x16x32_bf16 v[48:51], a[8:11], a[176:179], v[48:51]
  ds_read_b64_tr_b16 a[40:41], v2 offset:50176
  v_mfma_f32_16x16x32_bf16 v[48:51], a[24:27], a[184:187], v[48:51]
  s_min_u32 s63, s90, 4096
  ds_read_b64_tr_b16 a[42:43], v2 offset:54272
  s_add_u32 s63, s63, s48
  v_mfma_f32_16x16x32_bf16 v[52:55], a[24:27], a[188:191], v[52:55]
  ds_read_b64_tr_b16 a[56:57], v2 offset:58368
  buffer_load_dwordx4 a[240:243], v8, s[4:7], s63 offen offset:2048 sc1
  v_mfma_f32_16x16x32_bf16 v[52:55], a[8:11], a[180:183], v[52:55]
  ds_read_b64_tr_b16 a[58:59], v2 offset:62464
  v_mfma_f32_16x16x32_bf16 v[60:63], a[12:15], a[180:183], v[60:63]
  ds_read_b64_tr_b16 a[44:45], v3 offset:50176
  v_mfma_f32_16x16x32_bf16 v[60:63], a[28:31], a[188:191], v[60:63]
  ds_read_b64_tr_b16 a[46:47], v3 offset:54272
  v_mfma_f32_16x16x32_bf16 v[56:59], a[28:31], a[184:187], v[56:59]
  ds_read_b64_tr_b16 a[60:61], v3 offset:58368
  buffer_load_dwordx4 a[244:247], v9, s[4:7], s63 offen offset:2048 sc1
  v_mfma_f32_16x16x32_bf16 v[56:59], a[12:15], a[176:179], v[56:59]
  ds_read_b64_tr_b16 a[62:63], v3 offset:62464
  s_waitcnt lgkmcnt(8)
  v_mfma_f32_16x16x32_bf16 v[64:67], a[32:35], a[176:179], v[64:67]
  ds_read_b64_tr_b16 a[0:1], v4 offset:0
  s_add_u32 m0, s79, 24576
  v_mfma_f32_16x16x32_bf16 v[64:67], a[48:51], a[184:187], v[64:67]
  s_add_u32 s92, s92, 262144
  ds_read_b64_tr_b16 a[2:3], v4 offset:4096
  s_add_u32 s93, s92, s91
  v_mfma_f32_16x16x32_bf16 v[68:71], a[48:51], a[188:191], v[68:71]
  ds_read_b64_tr_b16 a[16:17], v4 offset:8192
  buffer_load_dwordx4 v252, s[80:83], s93 offen lds
  v_mfma_f32_16x16x32_bf16 v[68:71], a[32:35], a[180:183], v[68:71]
  ds_read_b64_tr_b16 a[18:19], v4 offset:12288
  v_mfma_f32_16x16x32_bf16 v[76:79], a[36:39], a[180:183], v[76:79]
  ds_read_b64_tr_b16 a[4:5], v5 offset:0
  v_mfma_f32_16x16x32_bf16 v[76:79], a[52:55], a[188:191], v[76:79]
  ds_read_b64_tr_b16 a[6:7], v5 offset:4096
  v_mfma_f32_16x16x32_bf16 v[72:75], a[52:55], a[184:187], v[72:75]
  ds_read_b64_tr_b16 a[20:21], v5 offset:8192
  buffer_load_dwordx4 v252, s[84:87], s93 offen offset:1024 lds
  v_mfma_f32_16x16x32_bf16 v[72:75], a[36:39], a[176:179], v[72:75]
  ds_read_b64_tr_b16 a[22:23], v5 offset:12288
  s_waitcnt lgkmcnt(8)
  v_mfma_f32_16x16x32_bf16 v[80:83], a[40:43], a[176:179], v[80:83]
  ds_read_b64_tr_b16 a[8:9], v6 offset:0
  v_mfma_f32_16x16x32_bf16 v[80:83], a[56:59], a[184:187], v[80:83]
  s_min_u32 s63, s91, 4096
  ds_read_b64_tr_b16 a[10:11], v6 offset:4096
  s_add_u32 s63, s63, s48
  v_mfma_f32_16x16x32_bf16 v[84:87], a[56:59], a[188:191], v[84:87]
  ds_read_b64_tr_b16 a[24:25], v6 offset:8192
  buffer_load_dwordx4 a[248:251], v8, s[4:7], s63 offen offset:3072 sc1
  v_mfma_f32_16x16x32_bf16 v[84:87], a[40:43], a[180:183], v[84:87]
  ds_read_b64_tr_b16 a[26:27], v6 offset:12288
  v_mfma_f32_16x16x32_bf16 v[92:95], a[44:47], a[180:183], v[92:95]
  ds_read_b64_tr_b16 a[12:13], v7 offset:0
  v_mfma_f32_16x16x32_bf16 v[92:95], a[60:63], a[188:191], v[92:95]
  ds_read_b64_tr_b16 a[14:15], v7 offset:4096
  v_mfma_f32_16x16x32_bf16 v[88:91], a[60:63], a[184:187], v[88:91]
  ds_read_b64_tr_b16 a[28:29], v7 offset:8192
  buffer_load_dwordx4 a[252:255], v9, s[4:7], s63 offen offset:3072 sc1
  v_mfma_f32_16x16x32_bf16 v[88:91], a[44:47], a[176:179], v[88:91]
  ds_read_b64_tr_b16 a[30:31], v7 offset:12288
  s_waitcnt vmcnt(24) lgkmcnt(8)
  v_mfma_f32_16x16x32_bf16 v[32:35], a[0:3], a[192:195], v[32:35]
  s_waitcnt vmcnt(26)
  s_barrier
  s_xor_b32 s43, s56, 2
  s_or_b32 s43, s43, s40
  s_cbranch_scc1 Lp3_sgl
  v_mov_b32 v250, 1
  s_mov_b64 exec, 1
  buffer_atomic_add v250, v251, s[4:7], s77 offen sc1
  s_mov_b64 exec, -1
Lp3_sgl:
  ds_read_b64_tr_b16 a[32:33], v4 offset:1024
  v_mfma_f32_16x16x32_bf16 v[32:35], a[16:19], a[200:203], v[32:35]
  s_add_u32 m0, s79, 32768
  ds_read_b64_tr_b16 a[34:35], v4 offset:5120
  s_add_u32 s92, s92, 196608
  v_mfma_f32_16x16x32_bf16 v[36:39], a[16:19], a[204:207], v[36:39]
  s_add_u32 s93, s92, s88
  ds_read_b64_tr_b16 a[48:49], v4 offset:9216
  buffer_load_dwordx4 v252, s[80:83], s93 offen lds
  v_mfma_f32_16x16x32_bf16 v[36:39], a[0:3], a[196:199], v[36:39]
  ds_read_b64_tr_b16 a[50:51], v4 offset:13312
  v_mfma_f32_16x16x32_bf16 v[44:47], a[4:7], a[196:199], v[44:47]
  ds_read_b64_tr_b16 a[36:37], v5 offset:1024
  v_mfma_f32_16x16x32_bf16 v[44:47], a[20:23], a[204:207], v[44:47]
  ds_read_b64_tr_b16 a[38:39], v5 offset:5120
  v_mfma_f32_16x16x32_bf16 v[40:43], a[20:23], a[200:203], v[40:43]
  ds_read_b64_tr_b16 a[52:53], v5 offset:9216
  buffer_load_dwordx4 v252, s[84:87], s93 offen offset:1024 lds
  v_mfma_f32_16x16x32_bf16 v[40:43], a[4:7], a[192:195], v[40:43]
  ds_read_b64_tr_b16 a[54:55], v5 offset:13312
  s_waitcnt lgkmcnt(8)
  v_mfma_f32_16x16x32_bf16 v[48:51], a[8:11], a[192:195], v[48:51]
  ds_read_b64_tr_b16 a[40:41], v6 offset:1024
  v_mfma_f32_16x16x32_bf16 v[48:51], a[24:27], a[200:203], v[48:51]
  s_add_u32 s48, s48, 4096
  ds_read_b64_tr_b16 a[42:43], v6 offset:5120
  s_min_u32 s63, s88, 4096
  v_mfma_f32_16x16x32_bf16 v[52:55], a[24:27], a[204:207], v[52:55]
  s_add_u32 s63, s63, s48
  ds_read_b64_tr_b16 a[56:57], v6 offset:9216
  buffer_load_dwordx4 a[128:131], v8, s[4:7], s63 offen offset:0 sc1
  v_mfma_f32_16x16x32_bf16 v[52:55], a[8:11], a[196:199], v[52:55]
  ds_read_b64_tr_b16 a[58:59], v6 offset:13312
  v_mfma_f32_16x16x32_bf16 v[60:63], a[12:15], a[196:199], v[60:63]
  ds_read_b64_tr_b16 a[44:45], v7 offset:1024
  v_mfma_f32_16x16x32_bf16 v[60:63], a[28:31], a[204:207], v[60:63]
  ds_read_b64_tr_b16 a[46:47], v7 offset:5120
  v_mfma_f32_16x16x32_bf16 v[56:59], a[28:31], a[200:203], v[56:59]
  ds_read_b64_tr_b16 a[60:61], v7 offset:9216
  buffer_load_dwordx4 a[132:135], v9, s[4:7], s63 offen offset:0 sc1
  v_mfma_f32_16x16x32_bf16 v[56:59], a[12:15], a[192:195], v[56:59]
  ds_read_b64_tr_b16 a[62:63], v7 offset:13312
  s_waitcnt lgkmcnt(8)
  v_mfma_f32_16x16x32_bf16 v[64:67], a[32:35], a[192:195], v[64:67]
  ds_read_b64_tr_b16 a[0:1], v4 offset:16384
  s_add_u32 m0, s79, 40960
  v_mfma_f32_16x16x32_bf16 v[64:67], a[48:51], a[200:203], v[64:67]
  s_add_u32 s92, s92, 262144
  ds_read_b64_tr_b16 a[2:3], v4 offset:20480
  s_add_u32 s93, s92, s89
  v_mfma_f32_16x16x32_bf16 v[68:71], a[48:51], a[204:207], v[68:71]
  ds_read_b64_tr_b16 a[16:17], v4 offset:24576
  buffer_load_dwordx4 v252, s[80:83], s93 offen lds
  v_mfma_f32_16x16x32_bf16 v[68:71], a[32:35], a[196:199], v[68:71]
  ds_read_b64_tr_b16 a[18:19], v4 offset:28672
  v_mfma_f32_16x16x32_bf16 v[76:79], a[36:39], a[196:199], v[76:79]
  ds_read_b64_tr_b16 a[4:5], v5 offset:16384
  v_mfma_f32_16x16x32_bf16 v[76:79], a[52:55], a[204:207], v[76:79]
  ds_read_b64_tr_b16 a[6:7], v5 offset:20480
  v_mfma_f32_16x16x32_bf16 v[72:75], a[52:55], a[200:203], v[72:75]
  ds_read_b64_tr_b16 a[20:21], v5 offset:24576
  buffer_load_dwordx4 v252, s[84:87], s93 offen offset:1024 lds
  v_mfma_f32_16x16x32_bf16 v[72:75], a[36:39], a[192:195], v[72:75]
  ds_read_b64_tr_b16 a[22:23], v5 offset:28672
  s_waitcnt lgkmcnt(8)
  v_mfma_f32_16x16x32_bf16 v[80:83], a[40:43], a[192:195], v[80:83]
  ds_read_b64_tr_b16 a[8:9], v6 offset:16384
  v_mfma_f32_16x16x32_bf16 v[80:83], a[56:59], a[200:203], v[80:83]
  s_min_u32 s63, s89, 4096
  ds_read_b64_tr_b16 a[10:11], v6 offset:20480
  s_add_u32 s63, s63, s48
  v_mfma_f32_16x16x32_bf16 v[84:87], a[56:59], a[204:207], v[84:87]
  ds_read_b64_tr_b16 a[24:25], v6 offset:24576
  buffer_load_dwordx4 a[136:139], v8, s[4:7], s63 offen offset:1024 sc1
  v_mfma_f32_16x16x32_bf16 v[84:87], a[40:43], a[196:199], v[84:87]
  ds_read_b64_tr_b16 a[26:27], v6 offset:28672
  v_mfma_f32_16x16x32_bf16 v[92:95], a[44:47], a[196:199], v[92:95]
  ds_read_b64_tr_b16 a[12:13], v7 offset:16384
  v_mfma_f32_16x16x32_bf16 v[92:95], a[60:63], a[204:207], v[92:95]
  ds_read_b64_tr_b16 a[14:15], v7 offset:20480
  v_mfma_f32_16x16x32_bf16 v[88:91], a[60:63], a[200:203], v[88:91]
  ds_read_b64_tr_b16 a[28:29], v7 offset:24576
  buffer_load_dwordx4 a[140:143], v9, s[4:7], s63 offen offset:1024 sc1
  v_mfma_f32_16x16x32_bf16 v[88:91], a[44:47], a[192:195], v[88:91]
  ds_read_b64_tr_b16 a[30:31], v7 offset:28672
  s_waitcnt vmcnt(24) lgkmcnt(8)
  v_mfma_f32_16x16x32_bf16 v[32:35], a[0:3], a[208:211], v[32:35]
  ds_read_b64_tr_b16 a[32:33], v4 offset:17408
  s_add_u32 m0, s79, 49152
  v_mfma_f32_16x16x32_bf16 v[32:35], a[16:19], a[216:219], v[32:35]
  s_add_u32 s92, s92, 196608
  ds_read_b64_tr_b16 a[34:35], v4 offset:21504
  s_add_u32 s93, s92, s90
  v_mfma_f32_16x16x32_bf16 v[36:39], a[16:19], a[220:223], v[36:39]
  ds_read_b64_tr_b16 a[48:49], v4 offset:25600
  buffer_load_dwordx4 v252, s[80:83], s93 offen lds
  v_mfma_f32_16x16x32_bf16 v[36:39], a[0:3], a[212:215], v[36:39]
  ds_read_b64_tr_b16 a[50:51], v4 offset:29696
  v_mfma_f32_16x16x32_bf16 v[44:47], a[4:7], a[212:215], v[44:47]
  ds_read_b64_tr_b16 a[36:37], v5 offset:17408
  v_mfma_f32_16x16x32_bf16 v[44:47], a[20:23], a[220:223], v[44:47]
  ds_read_b64_tr_b16 a[38:39], v5 offset:21504
  v_mfma_f32_16x16x32_bf16 v[40:43], a[20:23], a[216:219], v[40:43]
  ds_read_b64_tr_b16 a[52:53], v5 offset:25600
  buffer_load_dwordx4 v252, s[84:87], s93 offen offset:1024 lds
  v_mfma_f32_16x16x32_bf16 v[40:43], a[4:7], a[208:211], v[40:43]
  ds_read_b64_tr_b16 a[54:55], v5 offset:29696
  s_waitcnt lgkmcnt(8)
  v_mfma_f32_16x16x32_bf16 v[48:51], a[8:11], a[208:211], v[48:51]
  ds_read_b64_tr_b16 a[40:41], v6 offset:17408
  v_mfma_f32_16x16x32_bf16 v[48:51], a[24:27], a[216:219], v[48:51]
  s_min_u32 s63, s90, 4096
  ds_read_b64_tr_b16 a[42:43], v6 offset:21504
  s_add_u32 s63, s63, s48
  v_mfma_f32_16x16x32_bf16 v[52:55], a[24:27], a[220:223], v[52:55]
  ds_read_b64_tr_b16 a[56:57], v6 offset:25600
  buffer_load_dwordx4 a[144:147], v8, s[4:7], s63 offen offset:2048 sc1
  v_mfma_f32_16x16x32_bf16 v[52:55], a[8:11], a[212:215], v[52:55]
  ds_read_b64_tr_b16 a[58:59], v6 offset:29696
  v_mfma_f32_16x16x32_bf16 v[60:63], a[12:15], a[212:215], v[60:63]
  ds_read_b64_tr_b16 a[44:45], v7 offset:17408
  v_mfma_f32_16x16x32_bf16 v[60:63], a[28:31], a[220:223], v[60:63]
  ds_read_b64_tr_b16 a[46:47], v7 offset:21504
  v_mfma_f32_16x16x32_bf16 v[56:59], a[28:31], a[216:219], v[56:59]
  ds_read_b64_tr_b16 a[60:61], v7 offset:25600
  buffer_load_dwordx4 a[148:151], v9, s[4:7], s63 offen offset:2048 sc1
  v_mfma_f32_16x16x32_bf16 v[56:59], a[12:15], a[208:211], v[56:59]
  ds_read_b64_tr_b16 a[62:63], v7 offset:29696
  s_waitcnt lgkmcnt(8)
  v_mfma_f32_16x16x32_bf16 v[64:67], a[32:35], a[208:211], v[64:67]
  ds_read_b64_tr_b16 a[0:1], v4 offset:32768
  s_add_u32 m0, s79, 57344
  v_mfma_f32_16x16x32_bf16 v[64:67], a[48:51], a[216:219], v[64:67]
  s_add_u32 s92, s92, 262144
  ds_read_b64_tr_b16 a[2:3], v4 offset:36864
  s_add_u32 s93, s92, s91
  v_mfma_f32_16x16x32_bf16 v[68:71], a[48:51], a[220:223], v[68:71]
  ds_read_b64_tr_b16 a[16:17], v4 offset:40960
  buffer_load_dwordx4 v252, s[80:83], s93 offen lds
  v_mfma_f32_16x16x32_bf16 v[68:71], a[32:35], a[212:215], v[68:71]
  ds_read_b64_tr_b16 a[18:19], v4 offset:45056
  v_mfma_f32_16x16x32_bf16 v[76:79], a[36:39], a[212:215], v[76:79]
  ds_read_b64_tr_b16 a[4:5], v5 offset:32768
  v_mfma_f32_16x16x32_bf16 v[76:79], a[52:55], a[220:223], v[76:79]
  ds_read_b64_tr_b16 a[6:7], v5 offset:36864
  v_mfma_f32_16x16x32_bf16 v[72:75], a[52:55], a[216:219], v[72:75]
  ds_read_b64_tr_b16 a[20:21], v5 offset:40960
  buffer_load_dwordx4 v252, s[84:87], s93 offen offset:1024 lds
  v_mfma_f32_16x16x32_bf16 v[72:75], a[36:39], a[208:211], v[72:75]
  ds_read_b64_tr_b16 a[22:23], v5 offset:45056
  s_waitcnt lgkmcnt(8)
  v_mfma_f32_16x16x32_bf16 v[80:83], a[40:43], a[208:211], v[80:83]
  ds_read_b64_tr_b16 a[8:9], v6 offset:32768
  v_mfma_f32_16x16x32_bf16 v[80:83], a[56:59], a[216:219], v[80:83]
  s_min_u32 s63, s91, 4096
  ds_read_b64_tr_b16 a[10:11], v6 offset:36864
  s_add_u32 s63, s63, s48
  v_mfma_f32_16x16x32_bf16 v[84:87], a[56:59], a[220:223], v[84:87]
  ds_read_b64_tr_b16 a[24:25], v6 offset:40960
  buffer_load_dwordx4 a[152:155], v8, s[4:7], s63 offen offset:3072 sc1
  v_mfma_f32_16x16x32_bf16 v[84:87], a[40:43], a[212:215], v[84:87]
  ds_read_b64_tr_b16 a[26:27], v6 offset:45056
  v_mfma_f32_16x16x32_bf16 v[92:95], a[44:47], a[212:215], v[92:95]
  ds_read_b64_tr_b16 a[12:13], v7 offset:32768
  v_mfma_f32_16x16x32_bf16 v[92:95], a[60:63], a[220:223], v[92:95]
  ds_read_b64_tr_b16 a[14:15], v7 offset:36864
  v_mfma_f32_16x16x32_bf16 v[88:91], a[60:63], a[216:219], v[88:91]
  ds_read_b64_tr_b16 a[28:29], v7 offset:40960
  buffer_load_dwordx4 a[156:159], v9, s[4:7], s63 offen offset:3072 sc1
  v_mfma_f32_16x16x32_bf16 v[88:91], a[44:47], a[208:211], v[88:91]
  ds_read_b64_tr_b16 a[30:31], v7 offset:45056
  s_waitcnt vmcnt(24) lgkmcnt(8)
  v_mfma_f32_16x16x32_bf16 v[32:35], a[0:3], a[224:227], v[32:35]
  s_waitcnt vmcnt(26)
  s_barrier
  ds_read_b64_tr_b16 a[32:33], v4 offset:33792
  v_mfma_f32_16x16x32_bf16 v[32:35], a[16:19], a[232:235], v[32:35]
  s_add_u32 m0, s79, 65536
  ds_read_b64_tr_b16 a[34:35], v4 offset:37888
  s_add_u32 s92, s92, 196608
  v_mfma_f32_16x16x32_bf16 v[36:39], a[16:19], a[236:239], v[36:39]
  s_add_u32 s93, s92, s88
  ds_read_b64_tr_b16 a[48:49], v4 offset:41984
  buffer_load_dwordx4 v252, s[80:83], s93 offen lds
  v_mfma_f32_16x16x32_bf16 v[36:39], a[0:3], a[228:231], v[36:39]
  ds_read_b64_tr_b16 a[50:51], v4 offset:46080
  v_mfma_f32_16x16x32_bf16 v[44:47], a[4:7], a[228:231], v[44:47]
  ds_read_b64_tr_b16 a[36:37], v5 offset:33792
  v_mfma_f32_16x16x32_bf16 v[44:47], a[20:23], a[236:239], v[44:47]
  ds_read_b64_tr_b16 a[38:39], v5 offset:37888
  v_mfma_f32_16x16x32_bf16 v[40:43], a[20:23], a[232:235], v[40:43]
  ds_read_b64_tr_b16 a[52:53], v5 offset:41984
  buffer_load_dwordx4 v252, s[84:87], s93 offen offset:1024 lds
  v_mfma_f32_16x16x32_bf16 v[40:43], a[4:7], a[224:227], v[40:43]
  ds_read_b64_tr_b16 a[54:55], v5 offset:46080
  s_waitcnt lgkmcnt(8)
  v_mfma_f32_16x16x32_bf16 v[48:51], a[8:11], a[224:227], v[48:51]
  ds_read_b64_tr_b16 a[40:41], v6 offset:33792
  v_mfma_f32_16x16x32_bf16 v[48:51], a[24:27], a[232:235], v[48:51]
  s_add_u32 s48, s48, 4096
  ds_read_b64_tr_b16 a[42:43], v6 offset:37888
  s_min_u32 s63, s88, 4096
  v_mfma_f32_16x16x32_bf16 v[52:55], a[24:27], a[236:239], v[52:55]
  s_add_u32 s63, s63, s48
  ds_read_b64_tr_b16 a[56:57], v6 offset:41984
  buffer_load_dwordx4 a[160:163], v8, s[4:7], s63 offen offset:0 sc1
  v_mfma_f32_16x16x32_bf16 v[52:55], a[8:11], a[228:231], v[52:55]
  ds_read_b64_tr_b16 a[58:59], v6 offset:46080
  v_mfma_f32_16x16x32_bf16 v[60:63], a[12:15], a[228:231], v[60:63]
  ds_read_b64_tr_b16 a[44:45], v7 offset:33792
  v_mfma_f32_16x16x32_bf16 v[60:63], a[28:31], a[236:239], v[60:63]
  ds_read_b64_tr_b16 a[46:47], v7 offset:37888
  v_mfma_f32_16x16x32_bf16 v[56:59], a[28:31], a[232:235], v[56:59]
  ds_read_b64_tr_b16 a[60:61], v7 offset:41984
  buffer_load_dwordx4 a[164:167], v9, s[4:7], s63 offen offset:0 sc1
  v_mfma_f32_16x16x32_bf16 v[56:59], a[12:15], a[224:227], v[56:59]
  ds_read_b64_tr_b16 a[62:63], v7 offset:46080
  s_waitcnt lgkmcnt(8)
  v_mfma_f32_16x16x32_bf16 v[64:67], a[32:35], a[224:227], v[64:67]
  ds_read_b64_tr_b16 a[0:1], v4 offset:49152
  s_add_u32 m0, s79, 73728
  v_mfma_f32_16x16x32_bf16 v[64:67], a[48:51], a[232:235], v[64:67]
  s_add_u32 s92, s92, 262144
  ds_read_b64_tr_b16 a[2:3], v4 offset:53248
  s_add_u32 s93, s92, s89
  v_mfma_f32_16x16x32_bf16 v[68:71], a[48:51], a[236:239], v[68:71]
  ds_read_b64_tr_b16 a[16:17], v4 offset:57344
  buffer_load_dwordx4 v252, s[80:83], s93 offen lds
  v_mfma_f32_16x16x32_bf16 v[68:71], a[32:35], a[228:231], v[68:71]
  ds_read_b64_tr_b16 a[18:19], v4 offset:61440
  v_mfma_f32_16x16x32_bf16 v[76:79], a[36:39], a[228:231], v[76:79]
  ds_read_b64_tr_b16 a[4:5], v5 offset:49152
  v_mfma_f32_16x16x32_bf16 v[76:79], a[52:55], a[236:239], v[76:79]
  ds_read_b64_tr_b16 a[6:7], v5 offset:53248
  v_mfma_f32_16x16x32_bf16 v[72:75], a[52:55], a[232:235], v[72:75]
  ds_read_b64_tr_b16 a[20:21], v5 offset:57344
  buffer_load_dwordx4 v252, s[84:87], s93 offen offset:1024 lds
  v_mfma_f32_16x16x32_bf16 v[72:75], a[36:39], a[224:227], v[72:75]
  ds_read_b64_tr_b16 a[22:23], v5 offset:61440
  s_waitcnt lgkmcnt(8)
  v_mfma_f32_16x16x32_bf16 v[80:83], a[40:43], a[224:227], v[80:83]
  ds_read_b64_tr_b16 a[8:9], v6 offset:49152
  v_mfma_f32_16x16x32_bf16 v[80:83], a[56:59], a[232:235], v[80:83]
  s_min_u32 s63, s89, 4096
  ds_read_b64_tr_b16 a[10:11], v6 offset:53248
  s_add_u32 s63, s63, s48
  v_mfma_f32_16x16x32_bf16 v[84:87], a[56:59], a[236:239], v[84:87]
  ds_read_b64_tr_b16 a[24:25], v6 offset:57344
  buffer_load_dwordx4 a[168:171], v8, s[4:7], s63 offen offset:1024 sc1
  v_mfma_f32_16x16x32_bf16 v[84:87], a[40:43], a[228:231], v[84:87]
  ds_read_b64_tr_b16 a[26:27], v6 offset:61440
  v_mfma_f32_16x16x32_bf16 v[92:95], a[44:47], a[228:231], v[92:95]
  ds_read_b64_tr_b16 a[12:13], v7 offset:49152
  v_mfma_f32_16x16x32_bf16 v[92:95], a[60:63], a[236:239], v[92:95]
  ds_read_b64_tr_b16 a[14:15], v7 offset:53248
  v_mfma_f32_16x16x32_bf16 v[88:91], a[60:63], a[232:235], v[88:91]
  ds_read_b64_tr_b16 a[28:29], v7 offset:57344
  buffer_load_dwordx4 a[172:175], v9, s[4:7], s63 offen offset:1024 sc1
  v_mfma_f32_16x16x32_bf16 v[88:91], a[44:47], a[224:227], v[88:91]
  ds_read_b64_tr_b16 a[30:31], v7 offset:61440
  s_waitcnt vmcnt(24) lgkmcnt(8)
  v_mfma_f32_16x16x32_bf16 v[32:35], a[0:3], a[240:243], v[32:35]
  ds_read_b64_tr_b16 a[32:33], v4 offset:50176
  s_add_u32 m0, s79, 81920
  v_mfma_f32_16x16x32_bf16 v[32:35], a[16:19], a[248:251], v[32:35]
  s_add_u32 s92, s92, 196608
  ds_read_b64_tr_b16 a[34:35], v4 offset:54272
  s_add_u32 s93, s92, s90
  v_mfma_f32_16x16x32_bf16 v[36:39], a[16:19], a[252:255], v[36:39]
  ds_read_b64_tr_b16 a[48:49], v4 offset:58368
  buffer_load_dwordx4 v252, s[80:83], s93 offen lds
  v_mfma_f32_16x16x32_bf16 v[36:39], a[0:3], a[244:247], v[36:39]
  ds_read_b64_tr_b16 a[50:51], v4 offset:62464
  v_mfma_f32_16x16x32_bf16 v[44:47], a[4:7], a[244:247], v[44:47]
  ds_read_b64_tr_b16 a[36:37], v5 offset:50176
  v_mfma_f32_16x16x32_bf16 v[44:47], a[20:23], a[252:255], v[44:47]
  ds_read_b64_tr_b16 a[38:39], v5 offset:54272
  v_mfma_f32_16x16x32_bf16 v[40:43], a[20:23], a[248:251], v[40:43]
  ds_read_b64_tr_b16 a[52:53], v5 offset:58368
  buffer_load_dwordx4 v252, s[84:87], s93 offen offset:1024 lds
  v_mfma_f32_16x16x32_bf16 v[40:43], a[4:7], a[240:243], v[40:43]
  ds_read_b64_tr_b16 a[54:55], v5 offset:62464
  s_waitcnt lgkmcnt(8)
  v_mfma_f32_16x16x32_bf16 v[48:51], a[8:11], a[240:243], v[48:51]
  ds_read_b64_tr_b16 a[40:41], v6 offset:50176
  v_mfma_f32_16x16x32_bf16 v[48:51], a[24:27], a[248:251], v[48:51]
  s_min_u32 s63, s90, 4096
  ds_read_b64_tr_b16 a[42:43], v6 offset:54272
  s_add_u32 s63, s63, s48
  v_mfma_f32_16x16x32_bf16 v[52:55], a[24:27], a[252:255], v[52:55]
  ds_read_b64_tr_b16 a[56:57], v6 offset:58368
  buffer_load_dwordx4 a[176:179], v8, s[4:7], s63 offen offset:2048 sc1
  v_mfma_f32_16x16x32_bf16 v[52:55], a[8:11], a[244:247], v[52:55]
  ds_read_b64_tr_b16 a[58:59], v6 offset:62464
  v_mfma_f32_16x16x32_bf16 v[60:63], a[12:15], a[244:247], v[60:63]
  ds_read_b64_tr_b16 a[44:45], v7 offset:50176
  v_mfma_f32_16x16x32_bf16 v[60:63], a[28:31], a[252:255], v[60:63]
  ds_read_b64_tr_b16 a[46:47], v7 offset:54272
  v_mfma_f32_16x16x32_bf16 v[56:59], a[28:31], a[248:251], v[56:59]
  ds_read_b64_tr_b16 a[60:61], v7 offset:58368
  buffer_load_dwordx4 a[180:183], v9, s[4:7], s63 offen offset:2048 sc1
  v_mfma_f32_16x16x32_bf16 v[56:59], a[12:15], a[240:243], v[56:59]
  ds_read_b64_tr_b16 a[62:63], v7 offset:62464
  s_waitcnt lgkmcnt(8)
  v_mfma_f32_16x16x32_bf16 v[64:67], a[32:35], a[240:243], v[64:67]
  ds_read_b64_tr_b16 a[0:1], v0 offset:0
  s_add_u32 m0, s79, 90112
  v_mfma_f32_16x16x32_bf16 v[64:67], a[48:51], a[248:251], v[64:67]
  s_add_u32 s92, s92, 262144
  ds_read_b64_tr_b16 a[2:3], v0 offset:4096
  s_add_u32 s93, s92, s91
  v_mfma_f32_16x16x32_bf16 v[68:71], a[48:51], a[252:255], v[68:71]
  ds_read_b64_tr_b16 a[16:17], v0 offset:8192
  buffer_load_dwordx4 v252, s[80:83], s93 offen lds
  v_mfma_f32_16x16x32_bf16 v[68:71], a[32:35], a[244:247], v[68:71]
  ds_read_b64_tr_b16 a[18:19], v0 offset:12288
  v_mfma_f32_16x16x32_bf16 v[76:79], a[36:39], a[244:247], v[76:79]
  ds_read_b64_tr_b16 a[4:5], v1 offset:0
  v_mfma_f32_16x16x32_bf16 v[76:79], a[52:55], a[252:255], v[76:79]
  ds_read_b64_tr_b16 a[6:7], v1 offset:4096
  v_mfma_f32_16x16x32_bf16 v[72:75], a[52:55], a[248:251], v[72:75]
  ds_read_b64_tr_b16 a[20:21], v1 offset:8192
  buffer_load_dwordx4 v252, s[84:87], s93 offen offset:1024 lds
  v_mfma_f32_16x16x32_bf16 v[72:75], a[36:39], a[240:243], v[72:75]
  ds_read_b64_tr_b16 a[22:23], v1 offset:12288
  s_waitcnt lgkmcnt(8)
  v_mfma_f32_16x16x32_bf16 v[80:83], a[40:43], a[240:243], v[80:83]
  ds_read_b64_tr_b16 a[8:9], v2 offset:0
  v_mfma_f32_16x16x32_bf16 v[80:83], a[56:59], a[248:251], v[80:83]
  s_min_u32 s63, s91, 4096
  ds_read_b64_tr_b16 a[10:11], v2 offset:4096
  s_add_u32 s63, s63, s48
  v_mfma_f32_16x16x32_bf16 v[84:87], a[56:59], a[252:255], v[84:87]
  ds_read_b64_tr_b16 a[24:25], v2 offset:8192
  buffer_load_dwordx4 a[184:187], v8, s[4:7], s63 offen offset:3072 sc1
  v_mfma_f32_16x16x32_bf16 v[84:87], a[40:43], a[244:247], v[84:87]
  ds_read_b64_tr_b16 a[26:27], v2 offset:12288
  v_mfma_f32_16x16x32_bf16 v[92:95], a[44:47], a[244:247], v[92:95]
  ds_read_b64_tr_b16 a[12:13], v3 offset:0
  v_mfma_f32_16x16x32_bf16 v[92:95], a[60:63], a[252:255], v[92:95]
  ds_read_b64_tr_b16 a[14:15], v3 offset:4096
  v_mfma_f32_16x16x32_bf16 v[88:91], a[60:63], a[248:251], v[88:91]
  ds_read_b64_tr_b16 a[28:29], v3 offset:8192
  buffer_load_dwordx4 a[188:191], v9, s[4:7], s63 offen offset:3072 sc1
  v_mfma_f32_16x16x32_bf16 v[88:91], a[44:47], a[240:243], v[88:91]
  s_sub_u32 s56, s56, 1
  ds_read_b64_tr_b16 a[30:31], v3 offset:12288
  s_cmp_lg_u32 s56, 0
  s_cbranch_scc1 Lp4_loop
Lmk_Lp4_loop_tail:
  s_waitcnt vmcnt(24) lgkmcnt(8)
  v_mfma_f32_16x16x32_bf16 v[32:35], a[0:3], a[128:131], v[32:35]
  s_waitcnt vmcnt(26)
  s_barrier
  ds_read_b64_tr_b16 a[32:33], v0 offset:1024
  s_add_u32 m0, s79, 98304
  s_add_u32 s92, s92, 196608
  s_cmp_lg_u32 s88, 0
  s_cselect_b32 s93, -2686976, 0
  s_cselect_b32 s43, s78, 0
  v_mfma_f32_16x16x32_bf16 v[32:35], a[16:19], a[136:139], v[32:35]
  s_add_u32 s93, s93, s43
  ds_read_b64_tr_b16 a[34:35], v0 offset:5120
  s_add_u32 s93, s93, s92
  v_mfma_f32_16x16x32_bf16 v[36:39], a[16:19], a[140:143], v[36:39]
  ds_read_b64_tr_b16 a[48:49], v0 offset:9216
  buffer_load_dwordx4 v252, s[80:83], s93 offen lds
  v_mfma_f32_16x16x32_bf16 v[36:39], a[0:3], a[132:135], v[36:39]
  ds_read_b64_tr_b16 a[50:51], v0 offset:13312
  v_mfma_f32_16x16x32_bf16 v[44:47], a[4:7], a[132:135], v[44:47]
  ds_read_b64_tr_b16 a[36:37], v1 offset:1024
  v_mfma_f32_16x16x32_bf16 v[44:47], a[20:23], a[140:143], v[44:47]
  ds_read_b64_tr_b16 a[38:39], v1 offset:5120
  v_mfma_f32_16x16x32_bf16 v[40:43], a[20:23], a[136:139], v[40:43]
  ds_read_b64_tr_b16 a[52:53], v1 offset:9216
  buffer_load_dwordx4 v252, s[84:87], s93 offen offset:1024 lds
  v_mfma_f32_16x16x32_bf16 v[40:43], a[4:7], a[128:131], v[40:43]
  ds_read_b64_tr_b16 a[54:55], v1 offset:13312
  s_waitcnt lgkmcnt(8)
  v_mfma_f32_16x16x32_bf16 v[48:51], a[8:11], a[128:131], v[48:51]
  ds_read_b64_tr_b16 a[40:41], v2 offset:1024
  v_mfma_f32_16x16x32_bf16 v[48:51], a[24:27], a[136:139], v[48:51]
  s_add_u32 s48, s48, 4096
  ds_read_b64_tr_b16 a[42:43], v2 offset:5120
  s_min_u32 s63, s88, 4096
  v_mfma_f32_16x16x32_bf16 v[52:55], a[24:27], a[140:143], v[52:55]
  s_add_u32 s63, s63, s48
  ds_read_b64_tr_b16 a[56:57], v2 offset:9216
  buffer_load_dwordx4 a[192:195], v8, s[4:7], s63 offen offset:0 sc1
  v_mfma_f32_16x16x32_bf16 v[52:55], a[8:11], a[132:135], v[52:55]
  ds_read_b64_tr_b16 a[58:59], v2 offset:13312
  v_mfma_f32_16x16x32_bf16 v[60:63], a[12:15], a[132:135], v[60:63]
  ds_read_b64_tr_b16 a[44:45], v3 offset:1024
  v_mfma_f32_16x16x32_bf16 v[60:63], a[28:31], a[140:143], v[60:63]
  ds_read_b64_tr_b16 a[46:47], v3 offset:5120
  v_mfma_f32_16x16x32_bf16 v[56:59], a[28:31], a[136:139], v[56:59]
  ds_read_b64_tr_b16 a[60:61], v3 offset:9216
  buffer_load_dwordx4 a[196:199], v9, s[4:7], s63 offen offset:0 sc1
  v_mfma_f32_16x16x32_bf16 v[56:59], a[12:15], a[128:131], v[56:59]
  ds_read_b64_tr_b16 a[62:63], v3 offset:13312
  s_waitcnt lgkmcnt(8)
  v_mfma_f32_16x16x32_bf16 v[64:67], a[32:35], a[128:131], v[64:67]
  s_add_u32 m0, s79, 106496
  ds_read_b64_tr_b16 a[0:1], v0 offset:16384
  s_add_u32 s92, s92, 262144
  s_cmp_lg_u32 s89, 0
  s_cselect_b32 s93, -2490368, 0
  s_cselect_b32 s43, s78, 0
  v_mfma_f32_16x16x32_bf16 v[64:67], a[48:51], a[136:139], v[64:67]
  s_add_u32 s93, s93, s43
  ds_read_b64_tr_b16 a[2:3], v0 offset:20480
  s_add_u32 s93, s93, s92
  v_mfma_f32_16x16x32_bf16 v[68:71], a[48:51], a[140:143], v[68:71]
  ds_read_b64_tr_b16 a[16:17], v0 offset:24576
  buffer_load_dwordx4 v252, s[80:83], s93 offen lds
  v_mfma_f32_16x16x32_bf16 v[68:71], a[32:35], a[132:135], v[68:71]
  ds_read_b64_tr_b16 a[18:19], v0 offset:28672
  v_mfma_f32_16x16x32_bf16 v[76:79], a[36:39], a[132:135], v[76:79]
  ds_read_b64_tr_b16 a[4:5], v1 offset:16384
  v_mfma_f32_16x16x32_bf16 v[76:79], a[52:55], a[140:143], v[76:79]
  ds_read_b64_tr_b16 a[6:7], v1 offset:20480
  v_mfma_f32_16x16x32_bf16 v[72:75], a[52:55], a[136:139], v[72:75]
  ds_read_b64_tr_b16 a[20:21], v1 offset:24576
  buffer_load_dwordx4 v252, s[84:87], s93 offen offset:1024 lds
  v_mfma_f32_16x16x32_bf16 v[72:75], a[36:39], a[128:131], v[72:75]
  ds_read_b64_tr_b16 a[22:23], v1 offset:28672
  s_waitcnt lgkmcnt(8)
  v_mfma_f32_16x16x32_bf16 v[80:83], a[40:43], a[128:131], v[80:83]
  ds_read_b64_tr_b16 a[8:9], v2 offset:16384
  v_mfma_f32_16x16x32_bf16 v[80:83], a[56:59], a[136:139], v[80:83]
  s_min_u32 s63, s89, 4096
  ds_read_b64_tr_b16 a[10:11], v2 offset:20480
  s_add_u32 s63, s63, s48
  v_mfma_f32_16x16x32_bf16 v[84:87], a[56:59], a[140:143], v[84:87]
  ds_read_b64_tr_b16 a[24:25], v2 offset:24576
  buffer_load_dwordx4 a[200:203], v8, s[4:7], s63 offen offset:1024 sc1
  v_mfma_f32_16x16x32_bf16 v[84:87], a[40:43], a[132:135], v[84:87]
  ds_read_b64_tr_b16 a[26:27], v2 offset:28672
  v_mfma_f32_16x16x32_bf16 v[92:95], a[44:47], a[132:135], v[92:95]
  ds_read_b64_tr_b16 a[12:13], v3 offset:16384
  v_mfma_f32_16x16x32_bf16 v[92:95], a[60:63], a[140:143], v[92:95]
  ds_read_b64_tr_b16 a[14:15], v3 offset:20480
  v_mfma_f32_16x16x32_bf16 v[88:91], a[60:63], a[136:139], v[88:91]
  ds_read_b64_tr_b16 a[28:29], v3 offset:24576
  buffer_load_dwordx4 a[204:207], v9, s[4:7], s63 offen offset:1024 sc1
  v_mfma_f32_16x16x32_bf16 v[88:91], a[44:47], a[128:131], v[88:91]
  ds_read_b64_tr_b16 a[30:31], v3 offset:28672
  s_waitcnt vmcnt(24) lgkmcnt(8)
  v_mfma_f32_16x16x32_bf16 v[32:35], a[0:3], a[144:147], v[32:35]
  s_add_u32 m0, s79, 114688
  ds_read_b64_tr_b16 a[32:33], v0 offset:17408
  s_add_u32 s92, s92, 196608
  s_cmp_lg_u32 s90, 0
  s_cselect_b32 s93, -2228224, 0
  s_cselect_b32 s43, s78, 0
  v_mfma_f32_16x16x32_bf16 v[32:35], a[16:19], a[152:155], v[32:35]
  s_add_u32 s93, s93, s43
  ds_read_b64_tr_b16 a[34:35], v0 offset:21504
  s_add_u32 s93, s93, s92
  v_mfma_f32_16x16x32_bf16 v[36:39], a[16:19], a[156:159], v[36:39]
  ds_read_b64_tr_b16 a[48:49], v0 offset:25600
  buffer_load_dwordx4 v252, s[80:83], s93 offen lds
  v_mfma_f32_16x16x32_bf16 v[36:39], a[0:3], a[148:151], v[36:39]
  ds_read_b64_tr_b16 a[50:51], v0 offset:29696
  v_mfma_f32_16x16x32_bf16 v[44:47], a[4:7], a[148:151], v[44:47]
  ds_read_b64_tr_b16 a[36:37], v1 offset:17408
  v_mfma_f32_16x16x32_bf16 v[44:47], a[20:23], a[156:159], v[44:47]
  ds_read_b64_tr_b16 a[38:39], v1 offset:21504
  v_mfma_f32_16x16x32_bf16 v[40:43], a[20:23], a[152:155], v[40:43]
  ds_read_b64_tr_b16 a[52:53], v1 offset:25600
  buffer_load_dwordx4 v252, s[84:87], s93 offen offset:1024 lds
  v_mfma_f32_16x16x32_bf16 v[40:43], a[4:7], a[144:147], v[40:43]
  ds_read_b64_tr_b16 a[54:55], v1 offset:29696
  s_waitcnt lgkmcnt(8)
  v_mfma_f32_16x16x32_bf16 v[48:51], a[8:11], a[144:147], v[48:51]
  ds_read_b64_tr_b16 a[40:41], v2 offset:17408
  v_mfma_f32_16x16x32_bf16 v[48:51], a[24:27], a[152:155], v[48:51]
  s_min_u32 s63, s90, 4096
  ds_read_b64_tr_b16 a[42:43], v2 offset:21504
  s_add_u32 s63, s63, s48
  v_mfma_f32_16x16x32_bf16 v[52:55], a[24:27], a[156:159], v[52:55]
  ds_read_b64_tr_b16 a[56:57], v2 offset:25600
  buffer_load_dwordx4 a[208:211], v8, s[4:7], s63 offen offset:2048 sc1
  v_mfma_f32_16x16x32_bf16 v[52:55], a[8:11], a[148:151], v[52:55]
  ds_read_b64_tr_b16 a[58:59], v2 offset:29696
  v_mfma_f32_16x16x32_bf16 v[60:63], a[12:15], a[148:151], v[60:63]
  ds_read_b64_tr_b16 a[44:45], v3 offset:17408
  v_mfma_f32_16x16x32_bf16 v[60:63], a[28:31], a[156:159], v[60:63]
  ds_read_b64_tr_b16 a[46:47], v3 offset:21504
  v_mfma_f32_16x16x32_bf16 v[56:59], a[28:31], a[152:155], v[56:59]
  ds_read_b64_tr_b16 a[60:61], v3 offset:25600
  buffer_load_dwordx4 a[212:215], v9, s[4:7], s63 offen offset:2048 sc1
  v_mfma_f32_16x16x32_bf16 v[56:59], a[12:15], a[144:147], v[56:59]
  ds_read_b64_tr_b16 a[62:63], v3 offset:29696
  s_waitcnt lgkmcnt(8)
  v_mfma_f32_16x16x32_bf16 v[64:67], a[32:35], a[144:147], v[64:67]
  s_add_u32 m0, s79, 122880
  ds_read_b64_tr_b16 a[0:1], v0 offset:32768
  s_add_u32 s92, s92, 262144
  s_cmp_lg_u32 s91, 0
  s_cselect_b32 s93, -2031616, 0
  s_cselect_b32 s43, s78, 0
  v_mfma_f32_16x16x32_bf16 v[64:67], a[48:51], a[152:155], v[64:67]
  s_add_u32 s93, s93, s43
  ds_read_b64_tr_b16 a[2:3], v0 offset:36864
  s_add_u32 s93, s93, s92
  v_mfma_f32_16x16x32_bf16 v[68:71], a[48:51], a[156:159], v[68:71]
  ds_read_b64_tr_b16 a[16:17], v0 offset:40960
  buffer_load_dwordx4 v252, s[80:83], s93 offen lds
  v_mfma_f32_16x16x32_bf16 v[68:71], a[32:35], a[148:151], v[68:71]
  ds_read_b64_tr_b16 a[18:19], v0 offset:45056
  v_mfma_f32_16x16x32_bf16 v[76:79], a[36:39], a[148:151], v[76:79]
  ds_read_b64_tr_b16 a[4:5], v1 offset:32768
  v_mfma_f32_16x16x32_bf16 v[76:79], a[52:55], a[156:159], v[76:79]
  ds_read_b64_tr_b16 a[6:7], v1 offset:36864
  v_mfma_f32_16x16x32_bf16 v[72:75], a[52:55], a[152:155], v[72:75]
  ds_read_b64_tr_b16 a[20:21], v1 offset:40960
  buffer_load_dwordx4 v252, s[84:87], s93 offen offset:1024 lds
  v_mfma_f32_16x16x32_bf16 v[72:75], a[36:39], a[144:147], v[72:75]
  ds_read_b64_tr_b16 a[22:23], v1 offset:45056
  s_waitcnt lgkmcnt(8)
  v_mfma_f32_16x16x32_bf16 v[80:83], a[40:43], a[144:147], v[80:83]
  ds_read_b64_tr_b16 a[8:9], v2 offset:32768
  v_mfma_f32_16x16x32_bf16 v[80:83], a[56:59], a[152:155], v[80:83]
  s_min_u32 s63, s91, 4096
  ds_read_b64_tr_b16 a[10:11], v2 offset:36864
  s_add_u32 s63, s63, s48
  v_mfma_f32_16x16x32_bf16 v[84:87], a[56:59], a[156:159], v[84:87]
  ds_read_b64_tr_b16 a[24:25], v2 offset:40960
  buffer_load_dwordx4 a[216:219], v8, s[4:7], s63 offen offset:3072 sc1
  v_mfma_f32_16x16x32_bf16 v[84:87], a[40:43], a[148:151], v[84:87]
  ds_read_b64_tr_b16 a[26:27], v2 offset:45056
  v_mfma_f32_16x16x32_bf16 v[92:95], a[44:47], a[148:151], v[92:95]
  ds_read_b64_tr_b16 a[12:13], v3 offset:32768
  v_mfma_f32_16x16x32_bf16 v[92:95], a[60:63], a[156:159], v[92:95]
  ds_read_b64_tr_b16 a[14:15], v3 offset:36864
  v_mfma_f32_16x16x32_bf16 v[88:91], a[60:63], a[152:155], v[88:91]
  ds_read_b64_tr_b16 a[28:29], v3 offset:40960
  buffer_load_dwordx4 a[220:223], v9, s[4:7], s63 offen offset:3072 sc1
  v_mfma_f32_16x16x32_bf16 v[88:91], a[44:47], a[144:147], v[88:91]
  ds_read_b64_tr_b16 a[30:31], v3 offset:45056
  s_waitcnt vmcnt(24) lgkmcnt(8)
  v_mfma_f32_16x16x32_bf16 v[32:35], a[0:3], a[160:163], v[32:35]
  s_waitcnt vmcnt(26)
  s_barrier
  ds_read_b64_tr_b16 a[32:33], v0 offset:33792
  s_add_u32 m0, s79, 0
  s_add_u32 s92, s92, -3407872
  s_add_u32 s92, s92, s78
  s_cmp_lg_u32 s88, 0
  v_mfma_f32_16x16x32_bf16 v[32:35], a[16:19], a[168:171], v[32:35]
  s_cselect_b32 s93, 1835008, 0
  ds_read_b64_tr_b16 a[34:35], v0 offset:37888
  s_add_u32 s93, s93, s92
  v_mfma_f32_16x16x32_bf16 v[36:39], a[16:19], a[172:175], v[36:39]
  ds_read_b64_tr_b16 a[48:49], v0 offset:41984
  buffer_load_dwordx4 v252, s[80:83], s93 offen lds
  v_mfma_f32_16x16x32_bf16 v[36:39], a[0:3], a[164:167], v[36:39]
  ds_read_b64_tr_b16 a[50:51], v0 offset:46080
  v_mfma_f32_16x16x32_bf16 v[44:47], a[4:7], a[164:167], v[44:47]
  ds_read_b64_tr_b16 a[36:37], v1 offset:33792
  v_mfma_f32_16x16x32_bf16 v[44:47], a[20:23], a[172:175], v[44:47]
  ds_read_b64_tr_b16 a[38:39], v1 offset:37888
  v_mfma_f32_16x16x32_bf16 v[40:43], a[20:23], a[168:171], v[40:43]
  ds_read_b64_tr_b16 a[52:53], v1 offset:41984
  buffer_load_dwordx4 v252, s[84:87], s93 offen offset:1024 lds
  v_mfma_f32_16x16x32_bf16 v[40:43], a[4:7], a[160:163], v[40:43]
  ds_read_b64_tr_b16 a[54:55], v1 offset:46080
  s_waitcnt lgkmcnt(8)
  v_mfma_f32_16x16x32_bf16 v[48:51], a[8:11], a[160:163], v[48:51]
  ds_read_b64_tr_b16 a[40:41], v2 offset:33792
  v_mfma_f32_16x16x32_bf16 v[48:51], a[24:27], a[168:171], v[48:51]
  s_add_u32 s48, s48, 4096
  ds_read_b64_tr_b16 a[42:43], v2 offset:37888
  s_min_u32 s63, s88, 4096
  v_mfma_f32_16x16x32_bf16 v[52:55], a[24:27], a[172:175], v[52:55]
  s_add_u32 s63, s63, s48
  ds_read_b64_tr_b16 a[56:57], v2 offset:41984
  buffer_load_dwordx4 a[224:227], v8, s[4:7], s63 offen offset:0 sc1
  v_mfma_f32_16x16x32_bf16 v[52:55], a[8:11], a[164:167], v[52:55]
  ds_read_b64_tr_b16 a[58:59], v2 offset:46080
  v_mfma_f32_16x16x32_bf16 v[60:63], a[12:15], a[164:167], v[60:63]
  ds_read_b64_tr_b16 a[44:45], v3 offset:33792
  v_mfma_f32_16x16x32_bf16 v[60:63], a[28:31], a[172:175], v[60:63]
  ds_read_b64_tr_b16 a[46:47], v3 offset:37888
  v_mfma_f32_16x16x32_bf16 v[56:59], a[28:31], a[168:171], v[56:59]
  ds_read_b64_tr_b16 a[60:61], v3 offset:41984
  buffer_load_dwordx4 a[228:231], v9, s[4:7], s63 offen offset:0 sc1
  v_mfma_f32_16x16x32_bf16 v[56:59], a[12:15], a[160:163], v[56:59]
  ds_read_b64_tr_b16 a[62:63], v3 offset:46080
  s_waitcnt lgkmcnt(8)
  v_mfma_f32_16x16x32_bf16 v[64:67], a[32:35], a[160:163], v[64:67]
  s_add_u32 m0, s79, 8192
  ds_read_b64_tr_b16 a[0:1], v0 offset:49152
  s_add_u32 s92, s92, 458752
  s_cmp_lg_u32 s89, 0
  v_mfma_f32_16x16x32_bf16 v[64:67], a[48:51], a[168:171], v[64:67]
  s_cselect_b32 s93, 1835008, 0
  ds_read_b64_tr_b16 a[2:3], v0 offset:53248
  s_add_u32 s93, s93, s92
  v_mfma_f32_16x16x32_bf16 v[68:71], a[48:51], a[172:175], v[68:71]
  ds_read_b64_tr_b16 a[16:17], v0 offset:57344
  buffer_load_dwordx4 v252, s[80:83], s93 offen lds
  v_mfma_f32_16x16x32_bf16 v[68:71], a[32:35], a[164:167], v[68:71]
  ds_read_b64_tr_b16 a[18:19], v0 offset:61440
  v_mfma_f32_16x16x32_bf16 v[76:79], a[36:39], a[164:167], v[76:79]
  ds_read_b64_tr_b16 a[4:5], v1 offset:49152
  v_mfma_f32_16x16x32_bf16 v[76:79], a[52:55], a[172:175], v[76:79]
  ds_read_b64_tr_b16 a[6:7], v1 offset:53248
  v_mfma_f32_16x16x32_bf16 v[72:75], a[52:55], a[168:171], v[72:75]
  ds_read_b64_tr_b16 a[20:21], v1 offset:57344
  buffer_load_dwordx4 v252, s[84:87], s93 offen offset:1024 lds
  v_mfma_f32_16x16x32_bf16 v[72:75], a[36:39], a[160:163], v[72:75]
  ds_read_b64_tr_b16 a[22:23], v1 offset:61440
  s_waitcnt lgkmcnt(8)
  v_mfma_f32_16x16x32_bf16 v[80:83], a[40:43], a[160:163], v[80:83]
  ds_read_b64_tr_b16 a[8:9], v2 offset:49152
  v_mfma_f32_16x16x32_bf16 v[80:83], a[56:59], a[168:171], v[80:83]
  s_min_u32 s63, s89, 4096
  ds_read_b64_tr_b16 a[10:11], v2 offset:53248
  s_add_u32 s63, s63, s48
  v_mfma_f32_16x16x32_bf16 v[84:87], a[56:59], a[172:175], v[84:87]
  ds_read_b64_tr_b16 a[24:25], v2 offset:57344
  buffer_load_dwordx4 a[232:235], v8, s[4:7], s63 offen offset:1024 sc1
  v_mfma_f32_16x16x32_bf16 v[84:87], a[40:43], a[164:167], v[84:87]
  ds_read_b64_tr_b16 a[26:27], v2 offset:61440
  v_mfma_f32_16x16x32_bf16 v[92:95], a[44:47], a[164:167], v[92:95]
  ds_read_b64_tr_b16 a[12:13], v3 offset:49152
  v_mfma_f32_16x16x32_bf16 v[92:95], a[60:63], a[172:175], v[92:95]
  ds_read_b64_tr_b16 a[14:15], v3 offset:53248
  v_mfma_f32_16x16x32_bf16 v[88:91], a[60:63], a[168:171], v[88:91]
  ds_read_b64_tr_b16 a[28:29], v3 offset:57344
  buffer_load_dwordx4 a[236:239], v9, s[4:7], s63 offen offset:1024 sc1
  v_mfma_f32_16x16x32_bf16 v[88:91], a[44:47], a[160:163], v[88:91]
  ds_read_b64_tr_b16 a[30:31], v3 offset:61440
  s_waitcnt vmcnt(24) lgkmcnt(8)
  v_mfma_f32_16x16x32_bf16 v[32:35], a[0:3], a[176:179], v[32:35]
  s_add_u32 m0, s79, 16384
  ds_read_b64_tr_b16 a[32:33], v0 offset:50176
  s_add_u32 s92, s92, 458752
  s_cmp_lg_u32 s90, 0
  v_mfma_f32_16x16x32_bf16 v[32:35], a[16:19], a[184:187], v[32:35]
  s_cselect_b32 s93, 1835008, 0
  ds_read_b64_tr_b16 a[34:35], v0 offset:54272
  s_add_u32 s93, s93, s92
  v_mfma_f32_16x16x32_bf16 v[36:39], a[16:19], a[188:191], v[36:39]
  ds_read_b64_tr_b16 a[48:49], v0 offset:58368
  buffer_load_dwordx4 v252, s[80:83], s93 offen lds
  v_mfma_f32_16x16x32_bf16 v[36:39], a[0:3], a[180:183], v[36:39]
  ds_read_b64_tr_b16 a[50:51], v0 offset:62464
  v_mfma_f32_16x16x32_bf16 v[44:47], a[4:7], a[180:183], v[44:47]
  ds_read_b64_tr_b16 a[36:37], v1 offset:50176
  v_mfma_f32_16x16x32_bf16 v[44:47], a[20:23], a[188:191], v[44:47]
  ds_read_b64_tr_b16 a[38:39], v1 offset:54272
  v_mfma_f32_16x16x32_bf16 v[40:43], a[20:23], a[184:187], v[40:43]
  ds_read_b64_tr_b16 a[52:53], v1 offset:58368
  buffer_load_dwordx4 v252, s[84:87], s93 offen offset:1024 lds
  v_mfma_f32_16x16x32_bf16 v[40:43], a[4:7], a[176:179], v[40:43]
  ds_read_b64_tr_b16 a[54:55], v1 offset:62464
  s_waitcnt lgkmcnt(8)
  v_mfma_f32_16x16x32_bf16 v[48:51], a[8:11], a[176:179], v[48:51]
  ds_read_b64_tr_b16 a[40:41], v2 offset:50176
  v_mfma_f32_16x16x32_bf16 v[48:51], a[24:27], a[184:187], v[48:51]
  s_min_u32 s63, s90, 4096
  ds_read_b64_tr_b16 a[42:43], v2 offset:54272
  s_add_u32 s63, s63, s48
  v_mfma_f32_16x16x32_bf16 v[52:55], a[24:27], a[188:191], v[52:55]
  ds_read_b64_tr_b16 a[56:57], v2 offset:58368
  buffer_load_dwordx4 a[240:243], v8, s[4:7], s63 offen offset:2048 sc1
  v_mfma_f32_16x16x32_bf16 v[52:55], a[8:11], a[180:183], v[52:55]
  ds_read_b64_tr_b16 a[58:59], v2 offset:62464
  v_mfma_f32_16x16x32_bf16 v[60:63], a[12:15], a[180:183], v[60:63]
  ds_read_b64_tr_b16 a[44:45], v3 offset:50176
  v_mfma_f32_16x16x32_bf16 v[60:63], a[28:31], a[188:191], v[60:63]
  ds_read_b64_tr_b16 a[46:47], v3 offset:54272
  v_mfma_f32_16x16x32_bf16 v[56:59], a[28:31], a[184:187], v[56:59]
  ds_read_b64_tr_b16 a[60:61], v3 offset:58368
  buffer_load_dwordx4 a[244:247], v9, s[4:7], s63 offen offset:2048 sc1
  v_mfma_f32_16x16x32_bf16 v[56:59], a[12:15], a[176:179], v[56:59]
  ds_read_b64_tr_b16 a[62:63], v3 offset:62464
  s_waitcnt lgkmcnt(8)
  v_mfma_f32_16x16x32_bf16 v[64:67], a[32:35], a[176:179], v[64:67]
  s_add_u32 m0, s79, 24576
  ds_read_b64_tr_b16 a[0:1], v4 offset:0
  s_add_u32 s92, s92, 458752
  s_cmp_lg_u32 s91, 0
  v_mfma_f32_16x16x32_bf16 v[64:67], a[48:51], a[184:187], v[64:67]
  s_cselect_b32 s93, 1835008, 0
  ds_read_b64_tr_b16 a[2:3], v4 offset:4096
  s_add_u32 s93, s93, s92
  v_mfma_f32_16x16x32_bf16 v[68:71], a[48:51], a[188:191], v[68:71]
  ds_read_b64_tr_b16 a[16:17], v4 offset:8192
  buffer_load_dwordx4 v252, s[80:83], s93 offen lds
  v_mfma_f32_16x16x32_bf16 v[68:71], a[32:35], a[180:183], v[68:71]
  ds_read_b64_tr_b16 a[18:19], v4 offset:12288
  v_mfma_f32_16x16x32_bf16 v[76:79], a[36:39], a[180:183], v[76:79]
  ds_read_b64_tr_b16 a[4:5], v5 offset:0
  v_mfma_f32_16x16x32_bf16 v[76:79], a[52:55], a[188:191], v[76:79]
  ds_read_b64_tr_b16 a[6:7], v5 offset:4096
  v_mfma_f32_16x16x32_bf16 v[72:75], a[52:55], a[184:187], v[72:75]
  ds_read_b64_tr_b16 a[20:21], v5 offset:8192
  buffer_load_dwordx4 v252, s[84:87], s93 offen offset:1024 lds
  v_mfma_f32_16x16x32_bf16 v[72:75], a[36:39], a[176:179], v[72:75]
  ds_read_b64_tr_b16 a[22:23], v5 offset:12288
  s_waitcnt lgkmcnt(8)
  v_mfma_f32_16x16x32_bf16 v[80:83], a[40:43], a[176:179], v[80:83]
  ds_read_b64_tr_b16 a[8:9], v6 offset:0
  v_mfma_f32_16x16x32_bf16 v[80:83], a[56:59], a[184:187], v[80:83]
  s_min_u32 s63, s91, 4096
  ds_read_b64_tr_b16 a[10:11], v6 offset:4096
  s_add_u32 s63, s63, s48
  v_mfma_f32_16x16x32_bf16 v[84:87], a[56:59], a[188:191], v[84:87]
  ds_read_b64_tr_b16 a[24:25], v6 offset:8192
  buffer_load_dwordx4 a[248:251], v8, s[4:7], s63 offen offset:3072 sc1
  v_mfma_f32_16x16x32_bf16 v[84:87], a[40:43], a[180:183], v[84:87]
  ds_read_b64_tr_b16 a[26:27], v6 offset:12288
  v_mfma_f32_16x16x32_bf16 v[92:95], a[44:47], a[180:183], v[92:95]
  ds_read_b64_tr_b16 a[12:13], v7 offset:0
  v_mfma_f32_16x16x32_bf16 v[92:95], a[60:63], a[188:191], v[92:95]
  ds_read_b64_tr_b16 a[14:15], v7 offset:4096
  v_mfma_f32_16x16x32_bf16 v[88:91], a[60:63], a[184:187], v[88:91]
  ds_read_b64_tr_b16 a[28:29], v7 offset:8192
  buffer_load_dwordx4 a[252:255], v9, s[4:7], s63 offen offset:3072 sc1
  v_mfma_f32_16x16x32_bf16 v[88:91], a[44:47], a[176:179], v[88:91]
  ds_read_b64_tr_b16 a[30:31], v7 offset:12288
  s_waitcnt vmcnt(24) lgkmcnt(8)
  v_mfma_f32_16x16x32_bf16 v[32:35], a[0:3], a[192:195], v[32:35]
  s_waitcnt vmcnt(26)
  s_barrier
  ds_read_b64_tr_b16 a[32:33], v4 offset:16384
  s_add_u32 m0, s79, 32768
  s_add_u32 s92, s92, 458752
  s_cmp_lg_u32 s88, 0
  s_cselect_b32 s93, -2031616, 0
  s_cselect_b32 s43, s78, 0
  v_mfma_f32_16x16x32_bf16 v[32:35], a[16:19], a[200:203], v[32:35]
  s_sub_u32 s93, s93, s43
  ds_read_b64_tr_b16 a[34:35], v4 offset:20480
  s_add_u32 s93, s93, s92
  v_mfma_f32_16x16x32_bf16 v[36:39], a[16:19], a[204:207], v[36:39]
  ds_read_b64_tr_b16 a[48:49], v4 offset:24576
  buffer_load_dwordx4 v252, s[80:83], s93 offen lds
  v_mfma_f32_16x16x32_bf16 v[36:39], a[0:3], a[196:199], v[36:39]
  ds_read_b64_tr_b16 a[50:51], v4 offset:28672
  v_mfma_f32_16x16x32_bf16 v[44:47], a[4:7], a[196:199], v[44:47]
  ds_read_b64_tr_b16 a[36:37], v5 offset:16384
  buffer_load_dwordx4 v252, s[84:87], s93 offen offset:1024 lds
  v_mfma_f32_16x16x32_bf16 v[44:47], a[20:23], a[204:207], v[44:47]
  s_add_u32 s48, s48, 4096
  ds_read_b64_tr_b16 a[38:39], v5 offset:20480
  s_min_u32 s63, s88, 4096
  v_mfma_f32_16x16x32_bf16 v[40:43], a[20:23], a[200:203], v[40:43]
  s_add_u32 s63, s63, s48
  ds_read_b64_tr_b16 a[52:53], v5 offset:24576
  buffer_load_dwordx4 a[128:131], v8, s[4:7], s63 offen offset:0 sc1
  v_mfma_f32_16x16x32_bf16 v[40:43], a[4:7], a[192:195], v[40:43]
  ds_read_b64_tr_b16 a[54:55], v5 offset:28672
  s_waitcnt lgkmcnt(8)
  v_mfma_f32_16x16x32_bf16 v[48:51], a[8:11], a[192:195], v[48:51]
  s_add_u32 m0, s79, 40960
  ds_read_b64_tr_b16 a[40:41], v6 offset:16384
  buffer_load_dwordx4 a[132:135], v9, s[4:7], s63 offen offset:0 sc1
  s_add_u32 s92, s92, 458752
  s_cmp_lg_u32 s89, 0
  s_cselect_b32 s93, -2228224, 0
  s_cselect_b32 s43, s78, 0
  v_mfma_f32_16x16x32_bf16 v[48:51], a[24:27], a[200:203], v[48:51]
  s_sub_u32 s93, s93, s43
  ds_read_b64_tr_b16 a[42:43], v6 offset:20480
  s_add_u32 s93, s93, s92
  v_mfma_f32_16x16x32_bf16 v[52:55], a[24:27], a[204:207], v[52:55]
  ds_read_b64_tr_b16 a[56:57], v6 offset:24576
  buffer_load_dwordx4 v252, s[80:83], s93 offen lds
  v_mfma_f32_16x16x32_bf16 v[52:55], a[8:11], a[196:199], v[52:55]
  ds_read_b64_tr_b16 a[58:59], v6 offset:28672
  v_mfma_f32_16x16x32_bf16 v[60:63], a[12:15], a[196:199], v[60:63]
  ds_read_b64_tr_b16 a[44:45], v7 offset:16384
  buffer_load_dwordx4 v252, s[84:87], s93 offen offset:1024 lds
  v_mfma_f32_16x16x32_bf16 v[60:63], a[28:31], a[204:207], v[60:63]
  s_min_u32 s63, s89, 4096
  ds_read_b64_tr_b16 a[46:47], v7 offset:20480
  s_add_u32 s63, s63, s48
  v_mfma_f32_16x16x32_bf16 v[56:59], a[28:31], a[200:203], v[56:59]
  ds_read_b64_tr_b16 a[60:61], v7 offset:24576
  buffer_load_dwordx4 a[136:139], v8, s[4:7], s63 offen offset:1024 sc1
  v_mfma_f32_16x16x32_bf16 v[56:59], a[12:15], a[192:195], v[56:59]
  s_waitcnt vmcnt(23) lgkmcnt(7)
  ds_read_b64_tr_b16 a[62:63], v7 offset:28672
  buffer_load_dwordx4 a[140:143], v9, s[4:7], s63 offen offset:1024 sc1
  v_mfma_f32_16x16x32_bf16 v[32:35], a[32:35], a[208:211], v[32:35]
  s_add_u32 m0, s79, 49152
  ds_read_b64_tr_b16 a[0:1], v4 offset:32768
  s_add_u32 s92, s92, 458752
  s_cmp_lg_u32 s90, 0
  s_cselect_b32 s93, -2490368, 0
  s_cselect_b32 s43, s78, 0
  v_mfma_f32_16x16x32_bf16 v[32:35], a[48:51], a[216:219], v[32:35]
  s_sub_u32 s93, s93, s43
  ds_read_b64_tr_b16 a[2:3], v4 offset:36864
  s_add_u32 s93, s93, s92
  v_mfma_f32_16x16x32_bf16 v[36:39], a[48:51], a[220:223], v[36:39]
  ds_read_b64_tr_b16 a[16:17], v4 offset:40960
  buffer_load_dwordx4 v252, s[80:83], s93 offen lds
  v_mfma_f32_16x16x32_bf16 v[36:39], a[32:35], a[212:215], v[36:39]
  ds_read_b64_tr_b16 a[18:19], v4 offset:45056
  v_mfma_f32_16x16x32_bf16 v[44:47], a[36:39], a[212:215], v[44:47]
  ds_read_b64_tr_b16 a[4:5], v5 offset:32768
  buffer_load_dwordx4 v252, s[84:87], s93 offen offset:1024 lds
  v_mfma_f32_16x16x32_bf16 v[44:47], a[52:55], a[220:223], v[44:47]
  s_min_u32 s63, s90, 4096
  ds_read_b64_tr_b16 a[6:7], v5 offset:36864
  s_add_u32 s63, s63, s48
  v_mfma_f32_16x16x32_bf16 v[40:43], a[52:55], a[216:219], v[40:43]
  ds_read_b64_tr_b16 a[20:21], v5 offset:40960
  buffer_load_dwordx4 a[144:147], v8, s[4:7], s63 offen offset:2048 sc1
  v_mfma_f32_16x16x32_bf16 v[40:43], a[36:39], a[208:211], v[40:43]
  ds_read_b64_tr_b16 a[22:23], v5 offset:45056
  s_waitcnt lgkmcnt(8)
  v_mfma_f32_16x16x32_bf16 v[48:51], a[40:43], a[208:211], v[48:51]
  s_add_u32 m0, s79, 57344
  ds_read_b64_tr_b16 a[8:9], v6 offset:32768
  buffer_load_dwordx4 a[148:151], v9, s[4:7], s63 offen offset:2048 sc1
  s_add_u32 s92, s92, 458752
  s_cmp_lg_u32 s91, 0
  s_cselect_b32 s93, -2686976, 0
  s_cselect_b32 s43, s78, 0
  v_mfma_f32_16x16x32_bf16 v[48:51], a[56:59], a[216:219], v[48:51]
  s_sub_u32 s93, s93, s43
  ds_read_b64_tr_b16 a[10:11], v6 offset:36864
  s_add_u32 s93, s93, s92
  v_mfma_f32_16x16x32_bf16 v[52:55], a[56:59], a[220:223], v[52:55]
  ds_read_b64_tr_b16 a[24:25], v6 offset:40960
  buffer_load_dwordx4 v252, s[80:83], s93 offen lds
  v_mfma_f32_16x16x32_bf16 v[52:55], a[40:43], a[212:215], v[52:55]
  ds_read_b64_tr_b16 a[26:27], v6 offset:45056
  v_mfma_f32_16x16x32_bf16 v[60:63], a[44:47], a[212:215], v[60:63]
  ds_read_b64_tr_b16 a[12:13], v7 offset:32768
  buffer_load_dwordx4 v252, s[84:87], s93 offen offset:1024 lds
  v_mfma_f32_16x16x32_bf16 v[60:63], a[60:63], a[220:223], v[60:63]
  s_min_u32 s63, s91, 4096
  ds_read_b64_tr_b16 a[14:15], v7 offset:36864
  s_add_u32 s63, s63, s48
  v_mfma_f32_16x16x32_bf16 v[56:59], a[60:63], a[216:219], v[56:59]
  ds_read_b64_tr_b16 a[28:29], v7 offset:40960
  buffer_load_dwordx4 a[152:155], v8, s[4:7], s63 offen offset:3072 sc1
  v_mfma_f32_16x16x32_bf16 v[56:59], a[44:47], a[208:211], v[56:59]
  s_waitcnt vmcnt(23) lgkmcnt(7)
  ds_read_b64_tr_b16 a[30:31], v7 offset:45056
  buffer_load_dwordx4 a[156:159], v9, s[4:7], s63 offen offset:3072 sc1
  v_mfma_f32_16x16x32_bf16 v[32:35], a[0:3], a[224:227], v[32:35]
  s_waitcnt vmcnt(26)
  s_barrier
  ds_read_b64_tr_b16 a[32:33], v4 offset:49152
  v_mfma_f32_16x16x32_bf16 v[32:35], a[16:19], a[232:235], v[32:35]
  s_add_u32 s48, s48, 4096
  ds_read_b64_tr_b16 a[34:35], v4 offset:53248
  s_min_u32 s63, s88, 4096
  s_mul_i32 s63, s63, -13
  v_mfma_f32_16x16x32_bf16 v[36:39], a[16:19], a[236:239], v[36:39]
  s_add_u32 s63, s63, s48
  ds_read_b64_tr_b16 a[48:49], v4 offset:57344
  buffer_load_dwordx4 a[160:163], v8, s[4:7], s63 offen offset:0 sc1
  v_mfma_f32_16x16x32_bf16 v[36:39], a[0:3], a[228:231], v[36:39]
  ds_read_b64_tr_b16 a[50:51], v4 offset:61440
  v_mfma_f32_16x16x32_bf16 v[44:47], a[4:7], a[228:231], v[44:47]
  ds_read_b64_tr_b16 a[36:37], v5 offset:49152
  v_mfma_f32_16x16x32_bf16 v[44:47], a[20:23], a[236:239], v[44:47]
  ds_read_b64_tr_b16 a[38:39], v5 offset:53248
  v_mfma_f32_16x16x32_bf16 v[40:43], a[20:23], a[232:235], v[40:43]
  ds_read_b64_tr_b16 a[52:53], v5 offset:57344
  buffer_load_dwordx4 a[164:167], v9, s[4:7], s63 offen offset:0 sc1
  v_mfma_f32_16x16x32_bf16 v[40:43], a[4:7], a[224:227], v[40:43]
  ds_read_b64_tr_b16 a[54:55], v5 offset:61440
  s_waitcnt lgkmcnt(8)
  v_mfma_f32_16x16x32_bf16 v[48:51], a[8:11], a[224:227], v[48:51]
  ds_read_b64_tr_b16 a[40:41], v6 offset:49152
  v_mfma_f32_16x16x32_bf16 v[48:51], a[24:27], a[232:235], v[48:51]
  s_min_u32 s63, s89, 4096
  ds_read_b64_tr_b16 a[42:43], v6 offset:53248
  s_mul_i32 s63, s63, -13
  v_mfma_f32_16x16x32_bf16 v[52:55], a[24:27], a[236:239], v[52:55]
  s_add_u32 s63, s63, s48
  ds_read_b64_tr_b16 a[56:57], v6 offset:57344
  buffer_load_dwordx4 a[168:171], v8, s[4:7], s63 offen offset:1024 sc1
  v_mfma_f32_16x16x32_bf16 v[52:55], a[8:11], a[228:231], v[52:55]
  ds_read_b64_tr_b16 a[58:59], v6 offset:61440
  v_mfma_f32_16x16x32_bf16 v[60:63], a[12:15], a[228:231], v[60:63]
  ds_read_b64_tr_b16 a[44:45], v7 offset:49152
  v_mfma_f32_16x16x32_bf16 v[60:63], a[28:31], a[236:239], v[60:63]
  ds_read_b64_tr_b16 a[46:47], v7 offset:53248
  v_mfma_f32_16x16x32_bf16 v[56:59], a[28:31], a[232:235], v[56:59]
  ds_read_b64_tr_b16 a[60:61], v7 offset:57344
  buffer_load_dwordx4 a[172:175], v9, s[4:7], s63 offen offset:1024 sc1
  v_mfma_f32_16x16x32_bf16 v[56:59], a[12:15], a[224:227], v[56:59]
  ds_read_b64_tr_b16 a[62:63], v7 offset:61440
  s_waitcnt vmcnt(20) lgkmcnt(8)
  v_mfma_f32_16x16x32_bf16 v[32:35], a[32:35], a[240:243], v[32:35]
  ds_read_b64_tr_b16 a[0:1], v0 offset:0
  v_mfma_f32_16x16x32_bf16 v[32:35], a[48:51], a[248:251], v[32:35]
  s_min_u32 s63, s90, 4096
  ds_read_b64_tr_b16 a[2:3], v0 offset:4096
  s_mul_i32 s63, s63, -13
  v_mfma_f32_16x16x32_bf16 v[36:39], a[48:51], a[252:255], v[36:39]
  s_add_u32 s63, s63, s48
  ds_read_b64_tr_b16 a[16:17], v0 offset:8192
  buffer_load_dwordx4 a[176:179], v8, s[4:7], s63 offen offset:2048 sc1
  v_mfma_f32_16x16x32_bf16 v[36:39], a[32:35], a[244:247], v[36:39]
  ds_read_b64_tr_b16 a[18:19], v0 offset:12288
  v_mfma_f32_16x16x32_bf16 v[44:47], a[36:39], a[244:247], v[44:47]
  ds_read_b64_tr_b16 a[4:5], v1 offset:0
  v_mfma_f32_16x16x32_bf16 v[44:47], a[52:55], a[252:255], v[44:47]
  ds_read_b64_tr_b16 a[6:7], v1 offset:4096
  v_mfma_f32_16x16x32_bf16 v[40:43], a[52:55], a[248:251], v[40:43]
  ds_read_b64_tr_b16 a[20:21], v1 offset:8192
  buffer_load_dwordx4 a[180:183], v9, s[4:7], s63 offen offset:2048 sc1
  v_mfma_f32_16x16x32_bf16 v[40:43], a[36:39], a[240:243], v[40:43]
  ds_read_b64_tr_b16 a[22:23], v1 offset:12288
  s_waitcnt lgkmcnt(8)
  v_mfma_f32_16x16x32_bf16 v[48:51], a[40:43], a[240:243], v[48:51]
  ds_read_b64_tr_b16 a[8:9], v2 offset:0
  v_mfma_f32_16x16x32_bf16 v[48:51], a[56:59], a[248:251], v[48:51]
  s_min_u32 s63, s91, 4096
  ds_read_b64_tr_b16 a[10:11], v2 offset:4096
  s_mul_i32 s63, s63, -13
  v_mfma_f32_16x16x32_bf16 v[52:55], a[56:59], a[252:255], v[52:55]
  s_add_u32 s63, s63, s48
  ds_read_b64_tr_b16 a[24:25], v2 offset:8192
  buffer_load_dwordx4 a[184:187], v8, s[4:7], s63 offen offset:3072 sc1
  v_mfma_f32_16x16x32_bf16 v[52:55], a[40:43], a[244:247], v[52:55]
  ds_read_b64_tr_b16 a[26:27], v2 offset:12288
  v_mfma_f32_16x16x32_bf16 v[60:63], a[44:47], a[244:247], v[60:63]
  ds_read_b64_tr_b16 a[12:13], v3 offset:0
  v_mfma_f32_16x16x32_bf16 v[60:63], a[60:63], a[252:255], v[60:63]
  ds_read_b64_tr_b16 a[14:15], v3 offset:4096
  v_mfma_f32_16x16x32_bf16 v[56:59], a[60:63], a[248:251], v[56:59]
  ds_read_b64_tr_b16 a[28:29], v3 offset:8192
  buffer_load_dwordx4 a[188:191], v9, s[4:7], s63 offen offset:3072 sc1
  v_mfma_f32_16x16x32_bf16 v[56:59], a[44:47], a[240:243], v[56:59]
  ds_read_b64_tr_b16 a[30:31], v3 offset:12288
  s_waitcnt vmcnt(16) lgkmcnt(8)
  v_mfma_f32_16x16x32_bf16 v[32:35], a[0:3], a[128:131], v[32:35]
  s_waitcnt vmcnt(18)
  s_barrier
  ds_read_b64_tr_b16 a[32:33], v0 offset:16384
  v_mfma_f32_16x16x32_bf16 v[32:35], a[16:19], a[136:139], v[32:35]
  ds_read_b64_tr_b16 a[34:35], v0 offset:20480
  v_mfma_f32_16x16x32_bf16 v[36:39], a[16:19], a[140:143], v[36:39]
  ds_read_b64_tr_b16 a[48:49], v0 offset:24576
  v_mfma_f32_16x16x32_bf16 v[36:39], a[0:3], a[132:135], v[36:39]
  ds_read_b64_tr_b16 a[50:51], v0 offset:28672
  v_mfma_f32_16x16x32_bf16 v[44:47], a[4:7], a[132:135], v[44:47]
  ds_read_b64_tr_b16 a[36:37], v1 offset:16384
  v_mfma_f32_16x16x32_bf16 v[44:47], a[20:23], a[140:143], v[44:47]
  ds_read_b64_tr_b16 a[38:39], v1 offset:20480
  v_mfma_f32_16x16x32_bf16 v[40:43], a[20:23], a[136:139], v[40:43]
  ds_read_b64_tr_b16 a[52:53], v1 offset:24576
  v_mfma_f32_16x16x32_bf16 v[40:43], a[4:7], a[128:131], v[40:43]
  ds_read_b64_tr_b16 a[54:55], v1 offset:28672
  s_waitcnt lgkmcnt(8)
  v_mfma_f32_16x16x32_bf16 v[48:51], a[8:11], a[128:131], v[48:51]
  ds_read_b64_tr_b16 a[40:41], v2 offset:16384
  v_mfma_f32_16x16x32_bf16 v[48:51], a[24:27], a[136:139], v[48:51]
  ds_read_b64_tr_b16 a[42:43], v2 offset:20480
  v_mfma_f32_16x16x32_bf16 v[52:55], a[24:27], a[140:143], v[52:55]
  ds_read_b64_tr_b16 a[56:57], v2 offset:24576
  v_mfma_f32_16x16x32_bf16 v[52:55], a[8:11], a[132:135], v[52:55]
  ds_read_b64_tr_b16 a[58:59], v2 offset:28672
  v_mfma_f32_16x16x32_bf16 v[60:63], a[12:15], a[132:135], v[60:63]
  ds_read_b64_tr_b16 a[44:45], v3 offset:16384
  v_mfma_f32_16x16x32_bf16 v[60:63], a[28:31], a[140:143], v[60:63]
  ds_read_b64_tr_b16 a[46:47], v3 offset:20480
  v_mfma_f32_16x16x32_bf16 v[56:59], a[28:31], a[136:139], v[56:59]
  ds_read_b64_tr_b16 a[60:61], v3 offset:24576
  v_mfma_f32_16x16x32_bf16 v[56:59], a[12:15], a[128:131], v[56:59]
  ds_read_b64_tr_b16 a[62:63], v3 offset:28672
  s_waitcnt vmcnt(8) lgkmcnt(8)
  v_mfma_f32_16x16x32_bf16 v[32:35], a[32:35], a[144:147], v[32:35]
  ds_read_b64_tr_b16 a[0:1], v0 offset:32768
  v_mfma_f32_16x16x32_bf16 v[32:35], a[48:51], a[152:155], v[32:35]
  ds_read_b64_tr_b16 a[2:3], v0 offset:36864
  v_mfma_f32_16x16x32_bf16 v[36:39], a[48:51], a[156:159], v[36:39]
  ds_read_b64_tr_b16 a[16:17], v0 offset:40960
  v_mfma_f32_16x16x32_bf16 v[36:39], a[32:35], a[148:151], v[36:39]
  ds_read_b64_tr_b16 a[18:19], v0 offset:45056
  v_mfma_f32_16x16x32_bf16 v[44:47], a[36:39], a[148:151], v[44:47]
  ds_read_b64_tr_b16 a[4:5], v1 offset:32768
  v_mfma_f32_16x16x32_bf16 v[44:47], a[52:55], a[156:159], v[44:47]
  ds_read_b64_tr_b16 a[6:7], v1 offset:36864
  v_mfma_f32_16x16x32_bf16 v[40:43], a[52:55], a[152:155], v[40:43]
  ds_read_b64_tr_b16 a[20:21], v1 offset:40960
  v_mfma_f32_16x16x32_bf16 v[40:43], a[36:39], a[144:147], v[40:43]
  ds_read_b64_tr_b16 a[22:23], v1 offset:45056
  s_waitcnt lgkmcnt(8)
  v_mfma_f32_16x16x32_bf16 v[48:51], a[40:43], a[144:147], v[48:51]
  ds_read_b64_tr_b16 a[8:9], v2 offset:32768
  v_mfma_f32_16x16x32_bf16 v[48:51], a[56:59], a[152:155], v[48:51]
  ds_read_b64_tr_b16 a[10:11], v2 offset:36864
  v_mfma_f32_16x16x32_bf16 v[52:55], a[56:59], a[156:159], v[52:55]
  ds_read_b64_tr_b16 a[24:25], v2 offset:40960
  v_mfma_f32_16x16x32_bf16 v[52:55], a[40:43], a[148:151], v[52:55]
  ds_read_b64_tr_b16 a[26:27], v2 offset:45056
  v_mfma_f32_16x16x32_bf16 v[60:63], a[44:47], a[148:151], v[60:63]
  ds_read_b64_tr_b16 a[12:13], v3 offset:32768
  v_mfma_f32_16x16x32_bf16 v[60:63], a[60:63], a[156:159], v[60:63]
  ds_read_b64_tr_b16 a[14:15], v3 offset:36864
  v_mfma_f32_16x16x32_bf16 v[56:59], a[60:63], a[152:155], v[56:59]
  ds_read_b64_tr_b16 a[28:29], v3 offset:40960
  v_mfma_f32_16x16x32_bf16 v[56:59], a[44:47], a[144:147], v[56:59]
  ds_read_b64_tr_b16 a[30:31], v3 offset:45056
  s_waitcnt vmcnt(4) lgkmcnt(8)
  v_mfma_f32_16x16x32_bf16 v[32:35], a[0:3], a[160:163], v[32:35]
  s_waitcnt vmcnt(10)
  s_barrier
  ds_read_b64_tr_b16 a[32:33], v0 offset:49152
  v_mfma_f32_16x16x32_bf16 v[32:35], a[16:19], a[168:171], v[32:35]
  ds_read_b64_tr_b16 a[34:35], v0 offset:53248
  v_mfma_f32_16x16x32_bf16 v[36:39], a[16:19], a[172:175], v[36:39]
  ds_read_b64_tr_b16 a[48:49], v0 offset:57344
  v_mfma_f32_16x16x32_bf16 v[36:39], a[0:3], a[164:167], v[36:39]
  ds_read_b64_tr_b16 a[50:51], v0 offset:61440
  v_mfma_f32_16x16x32_bf16 v[44:47], a[4:7], a[164:167], v[44:47]
  ds_read_b64_tr_b16 a[36:37], v1 offset:49152
  v_mfma_f32_16x16x32_bf16 v[44:47], a[20:23], a[172:175], v[44:47]
  ds_read_b64_tr_b16 a[38:39], v1 offset:53248
  v_mfma_f32_16x16x32_bf16 v[40:43], a[20:23], a[168:171], v[40:43]
  ds_read_b64_tr_b16 a[52:53], v1 offset:57344
  v_mfma_f32_16x16x32_bf16 v[40:43], a[4:7], a[160:163], v[40:43]
  ds_read_b64_tr_b16 a[54:55], v1 offset:61440
  s_waitcnt lgkmcnt(8)
  v_mfma_f32_16x16x32_bf16 v[48:51], a[8:11], a[160:163], v[48:51]
  ds_read_b64_tr_b16 a[40:41], v2 offset:49152
  v_mfma_f32_16x16x32_bf16 v[48:51], a[24:27], a[168:171], v[48:51]
  ds_read_b64_tr_b16 a[42:43], v2 offset:53248
  v_mfma_f32_16x16x32_bf16 v[52:55], a[24:27], a[172:175], v[52:55]
  ds_read_b64_tr_b16 a[56:57], v2 offset:57344
  v_mfma_f32_16x16x32_bf16 v[52:55], a[8:11], a[164:167], v[52:55]
  ds_read_b64_tr_b16 a[58:59], v2 offset:61440
  v_mfma_f32_16x16x32_bf16 v[60:63], a[12:15], a[164:167], v[60:63]
  ds_read_b64_tr_b16 a[44:45], v3 offset:49152
  v_mfma_f32_16x16x32_bf16 v[60:63], a[28:31], a[172:175], v[60:63]
  ds_read_b64_tr_b16 a[46:47], v3 offset:53248
  v_mfma_f32_16x16x32_bf16 v[56:59], a[28:31], a[168:171], v[56:59]
  ds_read_b64_tr_b16 a[60:61], v3 offset:57344
  v_mfma_f32_16x16x32_bf16 v[56:59], a[12:15], a[160:163], v[56:59]
  ds_read_b64_tr_b16 a[62:63], v3 offset:61440
  s_waitcnt vmcnt(0) lgkmcnt(8)
  v_mfma_f32_16x16x32_bf16 v[32:35], a[32:35], a[176:179], v[32:35]
  ds_read_b64_tr_b16 a[0:1], v4 offset:1024
  v_mfma_f32_16x16x32_bf16 v[32:35], a[48:51], a[184:187], v[32:35]
  ds_read_b64_tr_b16 a[2:3], v4 offset:5120
  v_mfma_f32_16x16x32_bf16 v[36:39], a[48:51], a[188:191], v[36:39]
  ds_read_b64_tr_b16 a[16:17], v4 offset:9216
  v_mfma_f32_16x16x32_bf16 v[36:39], a[32:35], a[180:183], v[36:39]
  ds_read_b64_tr_b16 a[18:19], v4 offset:13312
  v_mfma_f32_16x16x32_bf16 v[44:47], a[36:39], a[180:183], v[44:47]
  ds_read_b64_tr_b16 a[4:5], v5 offset:1024
  v_mfma_f32_16x16x32_bf16 v[44:47], a[52:55], a[188:191], v[44:47]
  ds_read_b64_tr_b16 a[6:7], v5 offset:5120
  v_mfma_f32_16x16x32_bf16 v[40:43], a[52:55], a[184:187], v[40:43]
  ds_read_b64_tr_b16 a[20:21], v5 offset:9216
  v_mfma_f32_16x16x32_bf16 v[40:43], a[36:39], a[176:179], v[40:43]
  ds_read_b64_tr_b16 a[22:23], v5 offset:13312
  s_waitcnt lgkmcnt(8)
  v_mfma_f32_16x16x32_bf16 v[48:51], a[40:43], a[176:179], v[48:51]
  ds_read_b64_tr_b16 a[8:9], v6 offset:1024
  v_mfma_f32_16x16x32_bf16 v[48:51], a[56:59], a[184:187], v[48:51]
  ds_read_b64_tr_b16 a[10:11], v6 offset:5120
  v_mfma_f32_16x16x32_bf16 v[52:55], a[56:59], a[188:191], v[52:55]
  ds_read_b64_tr_b16 a[24:25], v6 offset:9216
  v_mfma_f32_16x16x32_bf16 v[52:55], a[40:43], a[180:183], v[52:55]
  ds_read_b64_tr_b16 a[26:27], v6 offset:13312
  v_mfma_f32_16x16x32_bf16 v[60:63], a[44:47], a[180:183], v[60:63]
  ds_read_b64_tr_b16 a[12:13], v7 offset:1024
  v_mfma_f32_16x16x32_bf16 v[60:63], a[60:63], a[188:191], v[60:63]
  ds_read_b64_tr_b16 a[14:15], v7 offset:5120
  v_mfma_f32_16x16x32_bf16 v[56:59], a[60:63], a[184:187], v[56:59]
  ds_read_b64_tr_b16 a[28:29], v7 offset:9216
  v_mfma_f32_16x16x32_bf16 v[56:59], a[44:47], a[176:179], v[56:59]
  ds_read_b64_tr_b16 a[30:31], v7 offset:13312
  s_waitcnt lgkmcnt(8)
  v_mfma_f32_16x16x32_bf16 v[64:67], a[0:3], a[192:195], v[64:67]
  s_lshl_b32 s45, s2, 2
  ds_read_b64_tr_b16 a[32:33], v4 offset:17408
  s_add_u32 s45, s45, s40
  v_mfma_f32_16x16x32_bf16 v[64:67], a[16:19], a[200:203], v[64:67]
  s_lshl_b32 s45, s45, 12
  ds_read_b64_tr_b16 a[34:35], v4 offset:21504
  s_xor_b32 s44, s45, 32768
  v_mfma_f32_16x16x32_bf16 v[68:71], a[16:19], a[204:207], v[68:71]
  s_add_u32 s43, s42, 28311552
  ds_read_b64_tr_b16 a[48:49], v4 offset:25600
  s_add_u32 s44, s44, s43
  v_mfma_f32_16x16x32_bf16 v[68:71], a[0:3], a[196:199], v[68:71]
  s_add_u32 s45, s45, s43
  ds_read_b64_tr_b16 a[50:51], v4 offset:29696
  v_cvt_pk_bf16_f32 v16, v32, v33
  v_mfma_f32_16x16x32_bf16 v[76:79], a[4:7], a[196:199], v[76:79]
  ds_read_b64_tr_b16 a[36:37], v5 offset:17408
  v_cvt_pk_bf16_f32 v17, v34, v35
  v_cvt_pk_bf16_f32 v18, v40, v41
  v_mfma_f32_16x16x32_bf16 v[76:79], a[20:23], a[204:207], v[76:79]
  ds_read_b64_tr_b16 a[38:39], v5 offset:21504
  v_cvt_pk_bf16_f32 v19, v42, v43
  buffer_store_dwordx4 v[16:19], v8, s[4:7], s44 offen offset:0 sc1
  v_mfma_f32_16x16x32_bf16 v[72:75], a[20:23], a[200:203], v[72:75]
  ds_read_b64_tr_b16 a[52:53], v5 offset:25600
  v_cvt_pk_bf16_f32 v24, v36, v37
  v_cvt_pk_bf16_f32 v25, v38, v39
  v_mfma_f32_16x16x32_bf16 v[72:75], a[4:7], a[192:195], v[72:75]
  s_waitcnt lgkmcnt(7)
  ds_read_b64_tr_b16 a[54:55], v5 offset:29696
  v_cvt_pk_bf16_f32 v26, v44, v45
  v_cvt_pk_bf16_f32 v27, v46, v47
  v_mfma_f32_16x16x32_bf16 v[80:83], a[8:11], a[192:195], v[80:83]
  ds_read_b64_tr_b16 a[40:41], v6 offset:17408
  buffer_store_dwordx4 v[24:27], v8, s[4:7], s44 offen offset:2048 sc1
  v_cvt_pk_bf16_f32 v20, v48, v49
  v_mfma_f32_16x16x32_bf16 v[80:83], a[24:27], a[200:203], v[80:83]
  ds_read_b64_tr_b16 a[42:43], v6 offset:21504
  v_cvt_pk_bf16_f32 v21, v50, v51
  v_cvt_pk_bf16_f32 v22, v56, v57
  v_mfma_f32_16x16x32_bf16 v[84:87], a[24:27], a[204:207], v[84:87]
  ds_read_b64_tr_b16 a[56:57], v6 offset:25600
  v_cvt_pk_bf16_f32 v23, v58, v59
  buffer_store_dwordx4 v[20:23], v8, s[4:7], s44 offen offset:1024 sc1
  v_mfma_f32_16x16x32_bf16 v[84:87], a[8:11], a[196:199], v[84:87]
  ds_read_b64_tr_b16 a[58:59], v6 offset:29696
  v_cvt_pk_bf16_f32 v28, v52, v53
  v_cvt_pk_bf16_f32 v29, v54, v55
  v_mfma_f32_16x16x32_bf16 v[92:95], a[12:15], a[196:199], v[92:95]
  ds_read_b64_tr_b16 a[44:45], v7 offset:17408
  v_cvt_pk_bf16_f32 v30, v60, v61
  v_cvt_pk_bf16_f32 v31, v62, v63
  v_mfma_f32_16x16x32_bf16 v[92:95], a[28:31], a[204:207], v[92:95]
  ds_read_b64_tr_b16 a[46:47], v7 offset:21504
  buffer_store_dwordx4 v[28:31], v8, s[4:7], s44 offen offset:3072 sc1
  v_mfma_f32_16x16x32_bf16 v[88:91], a[28:31], a[200:203], v[88:91]
  ds_read_b64_tr_b16 a[60:61], v7 offset:25600
  v_mfma_f32_16x16x32_bf16 v[88:91], a[12:15], a[192:195], v[88:91]
  ds_read_b64_tr_b16 a[62:63], v7 offset:29696
  s_waitcnt lgkmcnt(8)
  v_mfma_f32_16x16x32_bf16 v[64:67], a[32:35], a[208:211], v[64:67]
  ds_read_b64_tr_b16 a[0:1], v4 offset:33792
  v_and_b32 v148, 15, v253
  v_mfma_f32_16x16x32_bf16 v[64:67], a[48:51], a[216:219], v[64:67]
  ds_read_b64_tr_b16 a[2:3], v4 offset:37888
  v_lshrrev_b32 v149, 4, v253
  v_mfma_f32_16x16x32_bf16 v[68:71], a[48:51], a[220:223], v[68:71]
  ds_read_b64_tr_b16 a[16:17], v4 offset:41984
  v_lshrrev_b32 v128, 2, v148
  v_mfma_f32_16x16x32_bf16 v[68:71], a[32:35], a[212:215], v[68:71]
  ds_read_b64_tr_b16 a[18:19], v4 offset:46080
  v_cmp_eq_u32 vcc, v128, v149
  v_mfma_f32_16x16x32_bf16 v[76:79], a[36:39], a[212:215], v[76:79]
  ds_read_b64_tr_b16 a[4:5], v5 offset:33792
  v_and_b32 v128, 3, v148
  v_mfma_f32_16x16x32_bf16 v[76:79], a[52:55], a[220:223], v[76:79]
  ds_read_b64_tr_b16 a[6:7], v5 offset:37888
  v_lshlrev_b32 v148, 3, v148
  v_mfma_f32_16x16x32_bf16 v[72:75], a[52:55], a[216:219], v[72:75]
  ds_read_b64_tr_b16 a[20:21], v5 offset:41984
  v_mov_b32 v149, 0x7ffffff0
  v_mfma_f32_16x16x32_bf16 v[72:75], a[36:39], a[208:211], v[72:75]
  s_waitcnt lgkmcnt(7)
  ds_read_b64_tr_b16 a[22:23], v5 offset:46080
  v_cndmask_b32 v148, v149, v148, vcc
  v_mfma_f32_16x16x32_bf16 v[80:83], a[40:43], a[208:211], v[80:83]
  ds_read_b64_tr_b16 a[8:9], v6 offset:33792
  v_cmp_eq_u32 s[66:67], 1, v128
  v_mfma_f32_16x16x32_bf16 v[80:83], a[56:59], a[216:219], v[80:83]
  ds_read_b64_tr_b16 a[10:11], v6 offset:37888
  v_cmp_eq_u32 s[68:69], 2, v128
  v_mfma_f32_16x16x32_bf16 v[84:87], a[56:59], a[220:223], v[84:87]
  ds_read_b64_tr_b16 a[24:25], v6 offset:41984
  v_cmp_eq_u32 s[70:71], 3, v128
  v_mfma_f32_16x16x32_bf16 v[84:87], a[40:43], a[212:215], v[84:87]
  ds_read_b64_tr_b16 a[26:27], v6 offset:46080
  v_mov_b32 v128, 0x3f803f80
  v_mfma_f32_16x16x32_bf16 v[92:95], a[44:47], a[212:215], v[92:95]
  ds_read_b64_tr_b16 a[12:13], v7 offset:33792
  v_mov_b32 v129, 0x3f803f80
  v_mfma_f32_16x16x32_bf16 v[92:95], a[60:63], a[220:223], v[92:95]
  ds_read_b64_tr_b16 a[14:15], v7 offset:37888
  v_mov_b32 v130, 0x3f803f80
  v_mfma_f32_16x16x32_bf16 v[88:91], a[60:63], a[216:219], v[88:91]
  ds_read_b64_tr_b16 a[28:29], v7 offset:41984
  v_mov_b32 v131, 0x3f803f80
  v_mfma_f32_16x16x32_bf16 v[88:91], a[44:47], a[208:211], v[88:91]
  ds_read_b64_tr_b16 a[30:31], v7 offset:46080
  s_waitcnt lgkmcnt(8)
  v_mfma_f32_16x16x32_bf16 v[64:67], a[0:3], a[224:227], v[64:67]
  ds_read_b64_tr_b16 a[32:33], v4 offset:50176
  v_and_b32 v152, 15, v253
  v_lshrrev_b32 v153, 4, v253
  v_mfma_f32_16x16x32_bf16 v[64:67], a[16:19], a[232:235], v[64:67]
  ds_read_b64_tr_b16 a[34:35], v4 offset:54272
  v_lshrrev_b32 v155, 1, v153
  v_and_b32 v153, 1, v153
  v_mfma_f32_16x16x32_bf16 v[68:71], a[16:19], a[236:239], v[68:71]
  ds_read_b64_tr_b16 a[48:49], v4 offset:58368
  v_lshl_add_u32 v153, v153, 1, v155
  v_and_b32 v155, 7, v253
  v_mfma_f32_16x16x32_bf16 v[68:71], a[0:3], a[228:231], v[68:71]
  ds_read_b64_tr_b16 a[50:51], v4 offset:62464
  v_xor_b32 v153, v153, v155
  v_lshlrev_b32 v153, 4, v153
  v_mfma_f32_16x16x32_bf16 v[76:79], a[4:7], a[228:231], v[76:79]
  s_lshl_b32 s43, s40, 12
  ds_read_b64_tr_b16 a[36:37], v5 offset:50176
  v_lshl_add_u32 v152, v152, 7, v153
  v_mfma_f32_16x16x32_bf16 v[76:79], a[20:23], a[236:239], v[76:79]
  ds_read_b64_tr_b16 a[38:39], v5 offset:54272
  v_add_u32 v152, s43, v152
  v_xor_b32 v153, 64, v152
  v_mfma_f32_16x16x32_bf16 v[72:75], a[20:23], a[232:235], v[72:75]
  ds_read_b64_tr_b16 a[52:53], v5 offset:58368
  v_lshrrev_b32 v156, 3, v253
  v_xor_b32 v154, v156, v155
  v_mfma_f32_16x16x32_bf16 v[72:75], a[4:7], a[224:227], v[72:75]
  s_waitcnt lgkmcnt(7)
  ds_read_b64_tr_b16 a[54:55], v5 offset:62464
  v_lshlrev_b32 v154, 4, v154
  v_lshl_add_u32 v154, v156, 7, v154
  v_mfma_f32_16x16x32_bf16 v[80:83], a[8:11], a[224:227], v[80:83]
  ds_read_b64_tr_b16 a[40:41], v6 offset:50176
  v_add_u32 v154, s43, v154
  v_lshlrev_b32 v155, 4, v155
  v_mfma_f32_16x16x32_bf16 v[80:83], a[24:27], a[232:235], v[80:83]
  ds_read_b64_tr_b16 a[42:43], v6 offset:54272
  v_lshl_add_u32 v155, v156, 12, v155
  v_mfma_f32_16x16x32_bf16 v[84:87], a[24:27], a[236:239], v[84:87]
  ds_read_b64_tr_b16 a[56:57], v6 offset:58368
  v_mfma_f32_16x16x32_bf16 v[84:87], a[8:11], a[228:231], v[84:87]
  ds_read_b64_tr_b16 a[58:59], v6 offset:62464
  v_mfma_f32_16x16x32_bf16 v[92:95], a[12:15], a[228:231], v[92:95]
  ds_read_b64_tr_b16 a[44:45], v7 offset:50176
  v_mfma_f32_16x16x32_bf16 v[92:95], a[28:31], a[236:239], v[92:95]
  ds_read_b64_tr_b16 a[46:47], v7 offset:54272
  v_mfma_f32_16x16x32_bf16 v[88:91], a[28:31], a[232:235], v[88:91]
  ds_read_b64_tr_b16 a[60:61], v7 offset:58368
  v_mfma_f32_16x16x32_bf16 v[88:91], a[12:15], a[224:227], v[88:91]
  ds_read_b64_tr_b16 a[62:63], v7 offset:62464
  s_waitcnt lgkmcnt(8)
  v_mfma_f32_16x16x32_bf16 v[64:67], a[32:35], a[240:243], v[64:67]
  s_add_u32 s46, s76, 41943040
  ds_read_b64_tr_b16 a[0:1], v0 offset:1024
  s_add_u32 s47, s46, 32768
  v_mfma_f32_16x16x32_bf16 v[64:67], a[48:51], a[248:251], v[64:67]
  s_lshl_b32 s48, s49, 11
  ds_read_b64_tr_b16 a[2:3], v0 offset:5120
  s_lshl_b32 s43, s53, 7
  v_mfma_f32_16x16x32_bf16 v[68:71], a[48:51], a[252:255], v[68:71]
  s_add_u32 s48, s48, s43
  ds_read_b64_tr_b16 a[16:17], v0 offset:9216
  s_add_u32 s48, s48, 69206016
  v_mfma_f32_16x16x32_bf16 v[68:71], a[32:35], a[244:247], v[68:71]
  s_and_b32 s57, s49, 63
  ds_read_b64_tr_b16 a[18:19], v0 offset:13312
  s_lshl_b32 s57, s57, 16
  v_mfma_f32_16x16x32_bf16 v[76:79], a[36:39], a[244:247], v[76:79]
  s_add_u32 s57, s57, s43
  ds_read_b64_tr_b16 a[4:5], v1 offset:1024
  s_lshr_b32 s43, s49, 6
  v_mfma_f32_16x16x32_bf16 v[76:79], a[52:55], a[252:255], v[76:79]
  s_lshl_b32 s43, s43, 11
  ds_read_b64_tr_b16 a[6:7], v1 offset:5120
  s_add_u32 s57, s57, s43
  v_mfma_f32_16x16x32_bf16 v[72:75], a[52:55], a[248:251], v[72:75]
  s_and_b32 s43, s53, 1
  ds_read_b64_tr_b16 a[20:21], v1 offset:9216
  s_mul_i32 s77, s52, 2
  v_mfma_f32_16x16x32_bf16 v[72:75], a[36:39], a[240:243], v[72:75]
  s_add_u32 s77, s77, s43
  ds_read_b64_tr_b16 a[22:23], v1 offset:13312
  s_lshl_b32 s77, s77, 7
  s_waitcnt lgkmcnt(8)
  v_mfma_f32_16x16x32_bf16 v[80:83], a[40:43], a[240:243], v[80:83]
  ds_read_b64_tr_b16 a[8:9], v2 offset:1024
  s_add_u32 s77, s77, 27811840
  v_mfma_f32_16x16x32_bf16 v[80:83], a[56:59], a[248:251], v[80:83]
  ds_read_b64_tr_b16 a[10:11], v2 offset:5120
  v_mfma_f32_16x16x32_bf16 v[84:87], a[56:59], a[252:255], v[84:87]
  ds_read_b64_tr_b16 a[24:25], v2 offset:9216
  v_mfma_f32_16x16x32_bf16 v[84:87], a[40:43], a[244:247], v[84:87]
  ds_read_b64_tr_b16 a[26:27], v2 offset:13312
  v_mfma_f32_16x16x32_bf16 v[92:95], a[44:47], a[244:247], v[92:95]
  ds_read_b64_tr_b16 a[12:13], v3 offset:1024
  v_mfma_f32_16x16x32_bf16 v[92:95], a[60:63], a[252:255], v[92:95]
  ds_read_b64_tr_b16 a[14:15], v3 offset:5120
  v_mfma_f32_16x16x32_bf16 v[88:91], a[60:63], a[248:251], v[88:91]
  ds_read_b64_tr_b16 a[28:29], v3 offset:9216
  v_mfma_f32_16x16x32_bf16 v[88:91], a[44:47], a[240:243], v[88:91]
  ds_read_b64_tr_b16 a[30:31], v3 offset:13312
  s_waitcnt lgkmcnt(8)
  v_mfma_f32_16x16x32_bf16 v[64:67], a[0:3], a[128:131], v[64:67]
  ds_read_b64_tr_b16 a[32:33], v0 offset:17408
  v_mfma_f32_16x16x32_bf16 v[64:67], a[16:19], a[136:139], v[64:67]
  ds_read_b64_tr_b16 a[34:35], v0 offset:21504
  v_mfma_f32_16x16x32_bf16 v[68:71], a[16:19], a[140:143], v[68:71]
  ds_read_b64_tr_b16 a[48:49], v0 offset:25600
  v_mfma_f32_16x16x32_bf16 v[68:71], a[0:3], a[132:135], v[68:71]
  ds_read_b64_tr_b16 a[50:51], v0 offset:29696
  v_mfma_f32_16x16x32_bf16 v[76:79], a[4:7], a[132:135], v[76:79]
  ds_read_b64_tr_b16 a[36:37], v1 offset:17408
  v_mfma_f32_16x16x32_bf16 v[76:79], a[20:23], a[140:143], v[76:79]
  ds_read_b64_tr_b16 a[38:39], v1 offset:21504
  v_mfma_f32_16x16x32_bf16 v[72:75], a[20:23], a[136:139], v[72:75]
  ds_read_b64_tr_b16 a[52:53], v1 offset:25600
  v_mfma_f32_16x16x32_bf16 v[72:75], a[4:7], a[128:131], v[72:75]
  ds_read_b64_tr_b16 a[54:55], v1 offset:29696
  s_waitcnt lgkmcnt(8)
  v_mfma_f32_16x16x32_bf16 v[80:83], a[8:11], a[128:131], v[80:83]
  ds_read_b64_tr_b16 a[40:41], v2 offset:17408
  v_mfma_f32_16x16x32_bf16 v[80:83], a[24:27], a[136:139], v[80:83]
  ds_read_b64_tr_b16 a[42:43], v2 offset:21504
  v_mfma_f32_16x16x32_bf16 v[84:87], a[24:27], a[140:143], v[84:87]
  ds_read_b64_tr_b16 a[56:57], v2 offset:25600
  v_mfma_f32_16x16x32_bf16 v[84:87], a[8:11], a[132:135], v[84:87]
  ds_read_b64_tr_b16 a[58:59], v2 offset:29696
  v_mfma_f32_16x16x32_bf16 v[92:95], a[12:15], a[132:135], v[92:95]
  ds_read_b64_tr_b16 a[44:45], v3 offset:17408
  v_mfma_f32_16x16x32_bf16 v[92:95], a[28:31], a[140:143], v[92:95]
  ds_read_b64_tr_b16 a[46:47], v3 offset:21504
  v_mfma_f32_16x16x32_bf16 v[88:91], a[28:31], a[136:139], v[88:91]
  ds_read_b64_tr_b16 a[60:61], v3 offset:25600
  v_mfma_f32_16x16x32_bf16 v[88:91], a[12:15], a[128:131], v[88:91]
  ds_read_b64_tr_b16 a[62:63], v3 offset:29696
  s_waitcnt lgkmcnt(8)
  v_mfma_f32_16x16x32_bf16 v[64:67], a[32:35], a[144:147], v[64:67]
  ds_read_b64_tr_b16 a[0:1], v0 offset:33792
  v_mfma_f32_16x16x32_bf16 v[64:67], a[48:51], a[152:155], v[64:67]
  ds_read_b64_tr_b16 a[2:3], v0 offset:37888
  v_mfma_f32_16x16x32_bf16 v[68:71], a[48:51], a[156:159], v[68:71]
  ds_read_b64_tr_b16 a[16:17], v0 offset:41984
  v_mfma_f32_16x16x32_bf16 v[68:71], a[32:35], a[148:151], v[68:71]
  ds_read_b64_tr_b16 a[18:19], v0 offset:46080
  v_mfma_f32_16x16x32_bf16 v[76:79], a[36:39], a[148:151], v[76:79]
  ds_read_b64_tr_b16 a[4:5], v1 offset:33792
  buffer_load_dwordx4 v[96:99], v8, s[4:7], s45 offen offset:0 sc1
  buffer_load_dwordx4 v[100:103], v8, s[4:7], s45 offen offset:1024 sc1
  v_mfma_f32_16x16x32_bf16 v[76:79], a[52:55], a[156:159], v[76:79]
  ds_read_b64_tr_b16 a[6:7], v1 offset:37888
  v_mfma_f32_16x16x32_bf16 v[72:75], a[52:55], a[152:155], v[72:75]
  ds_read_b64_tr_b16 a[20:21], v1 offset:41984
  buffer_load_dwordx4 v[104:107], v8, s[4:7], s45 offen offset:2048 sc1
  buffer_load_dwordx4 v[108:111], v8, s[4:7], s45 offen offset:3072 sc1
  v_mfma_f32_16x16x32_bf16 v[72:75], a[36:39], a[144:147], v[72:75]
  ds_read_b64_tr_b16 a[22:23], v1 offset:46080
  s_waitcnt lgkmcnt(8)
  v_mfma_f32_16x16x32_bf16 v[80:83], a[40:43], a[144:147], v[80:83]
  ds_read_b64_tr_b16 a[8:9], v2 offset:33792
  v_mfma_f32_16x16x32_bf16 v[80:83], a[56:59], a[152:155], v[80:83]
  ds_read_b64_tr_b16 a[10:11], v2 offset:37888
  v_mfma_f32_16x16x32_bf16 v[84:87], a[56:59], a[156:159], v[84:87]
  ds_read_b64_tr_b16 a[24:25], v2 offset:41984
  v_mfma_f32_16x16x32_bf16 v[84:87], a[40:43], a[148:151], v[84:87]
  ds_read_b64_tr_b16 a[26:27], v2 offset:46080
  v_mfma_f32_16x16x32_bf16 v[92:95], a[44:47], a[148:151], v[92:95]
  ds_read_b64_tr_b16 a[12:13], v3 offset:33792
  v_mfma_f32_16x16x32_bf16 v[92:95], a[60:63], a[156:159], v[92:95]
  ds_read_b64_tr_b16 a[14:15], v3 offset:37888
  v_mfma_f32_16x16x32_bf16 v[88:91], a[60:63], a[152:155], v[88:91]
  ds_read_b64_tr_b16 a[28:29], v3 offset:41984
  v_mfma_f32_16x16x32_bf16 v[88:91], a[44:47], a[144:147], v[88:91]
  ds_read_b64_tr_b16 a[30:31], v3 offset:46080
  s_waitcnt lgkmcnt(8)
  v_mfma_f32_16x16x32_bf16 v[64:67], a[0:3], a[160:163], v[64:67]
  ds_read_b64_tr_b16 a[32:33], v0 offset:50176
  v_mfma_f32_16x16x32_bf16 v[64:67], a[16:19], a[168:171], v[64:67]
  ds_read_b64_tr_b16 a[34:35], v0 offset:54272
  v_mfma_f32_16x16x32_bf16 v[68:71], a[16:19], a[172:175], v[68:71]
  ds_read_b64_tr_b16 a[48:49], v0 offset:58368
  v_mfma_f32_16x16x32_bf16 v[68:71], a[0:3], a[164:167], v[68:71]
  ds_read_b64_tr_b16 a[50:51], v0 offset:62464
  v_mfma_f32_16x16x32_bf16 v[76:79], a[4:7], a[164:167], v[76:79]
  ds_read_b64_tr_b16 a[36:37], v1 offset:50176
  v_mfma_f32_16x16x32_bf16 v[76:79], a[20:23], a[172:175], v[76:79]
  ds_read_b64_tr_b16 a[38:39], v1 offset:54272
  v_mfma_f32_16x16x32_bf16 v[72:75], a[20:23], a[168:171], v[72:75]
  ds_read_b64_tr_b16 a[52:53], v1 offset:58368
  v_mfma_f32_16x16x32_bf16 v[72:75], a[4:7], a[160:163], v[72:75]
  ds_read_b64_tr_b16 a[54:55], v1 offset:62464
  s_waitcnt lgkmcnt(8)
  v_mfma_f32_16x16x32_bf16 v[80:83], a[8:11], a[160:163], v[80:83]
  ds_read_b64_tr_b16 a[40:41], v2 offset:50176
  v_mfma_f32_16x16x32_bf16 v[80:83], a[24:27], a[168:171], v[80:83]
  ds_read_b64_tr_b16 a[42:43], v2 offset:54272
  v_mfma_f32_16x16x32_bf16 v[84:87], a[24:27], a[172:175], v[84:87]
  ds_read_b64_tr_b16 a[56:57], v2 offset:58368
  v_mfma_f32_16x16x32_bf16 v[84:87], a[8:11], a[164:167], v[84:87]
  ds_read_b64_tr_b16 a[58:59], v2 offset:62464
  v_mfma_f32_16x16x32_bf16 v[92:95], a[12:15], a[164:167], v[92:95]
  ds_read_b64_tr_b16 a[44:45], v3 offset:50176
  v_mfma_f32_16x16x32_bf16 v[92:95], a[28:31], a[172:175], v[92:95]
  ds_read_b64_tr_b16 a[46:47], v3 offset:54272
  v_mfma_f32_16x16x32_bf16 v[88:91], a[28:31], a[168:171], v[88:91]
  ds_read_b64_tr_b16 a[60:61], v3 offset:58368
  v_mfma_f32_16x16x32_bf16 v[88:91], a[12:15], a[160:163], v[88:91]
  ds_read_b64_tr_b16 a[62:63], v3 offset:62464
  s_mov_b32 s43, 0x40000
Lp4_mb:
  s_waitcnt vmcnt(0)
  v_max3_u32 v112, v96, v97, v98
  v_max3_u32 v113, v99, v100, v101
  v_max3_u32 v112, v112, v102, v103
  v_max3_u32 v113, v113, v104, v105
  v_max3_u32 v112, v112, v106, v107
  v_max3_u32 v113, v113, v108, v109
  v_max3_u32 v112, v112, v110, v111
  v_max_u32 v112, v112, v113
  v_cmp_eq_u32 vcc, -1, v112
  s_cbranch_vccz Lp4_mbok
  buffer_load_dwordx4 v[96:99], v8, s[4:7], s45 offen offset:0 sc1
  buffer_load_dwordx4 v[100:103], v8, s[4:7], s45 offen offset:1024 sc1
  buffer_load_dwordx4 v[104:107], v8, s[4:7], s45 offen offset:2048 sc1
  buffer_load_dwordx4 v[108:111], v8, s[4:7], s45 offen offset:3072 sc1
  s_sub_u32 s43, s43, 1
  s_cmp_lg_u32 s43, 0
  s_cbranch_scc1 Lp4_mb
  s_waitcnt vmcnt(0)
Lp4_mbok:
  s_waitcnt lgkmcnt(8)
  v_mfma_f32_16x16x32_bf16 v[64:67], a[32:35], a[176:179], v[64:67]
  v_lshlrev_b32 v32, 16, v96
  v_and_b32 v33, 0xffff0000, v96
  v_mfma_f32_16x16x32_bf16 v[64:67], a[48:51], a[184:187], v[64:67]
  v_lshlrev_b32 v34, 16, v97
  v_and_b32 v35, 0xffff0000, v97
  v_mfma_f32_16x16x32_bf16 v[68:71], a[48:51], a[188:191], v[68:71]
  v_lshlrev_b32 v40, 16, v98
  v_and_b32 v41, 0xffff0000, v98
  v_mfma_f32_16x16x32_bf16 v[68:71], a[32:35], a[180:183], v[68:71]
  v_lshlrev_b32 v42, 16, v99
  v_and_b32 v43, 0xffff0000, v99
  v_mfma_f32_16x16x32_bf16 v[76:79], a[36:39], a[180:183], v[76:79]
  v_lshlrev_b32 v36, 16, v104
  v_and_b32 v37, 0xffff0000, v104
  v_mfma_f32_16x16x32_bf16 v[76:79], a[52:55], a[188:191], v[76:79]
  v_lshlrev_b32 v38, 16, v105
  v_and_b32 v39, 0xffff0000, v105
  v_mfma_f32_16x16x32_bf16 v[72:75], a[52:55], a[184:187], v[72:75]
  v_lshlrev_b32 v44, 16, v106
  v_and_b32 v45, 0xffff0000, v106
  v_mfma_f32_16x16x32_bf16 v[72:75], a[36:39], a[176:179], v[72:75]
  s_waitcnt lgkmcnt(0)
  v_lshlrev_b32 v46, 16, v107
  v_and_b32 v47, 0xffff0000, v107
  v_mfma_f32_16x16x32_bf16 v[80:83], a[40:43], a[176:179], v[80:83]
  v_lshlrev_b32 v48, 16, v100
  v_and_b32 v49, 0xffff0000, v100
  v_mfma_f32_16x16x32_bf16 v[80:83], a[56:59], a[184:187], v[80:83]
  s_barrier
  v_lshlrev_b32 v50, 16, v101
  v_mfma_f32_16x16x32_bf16 v[84:87], a[56:59], a[188:191], v[84:87]
  v_and_b32 v51, 0xffff0000, v101
  v_lshlrev_b32 v56, 16, v102
  v_mfma_f32_16x16x32_bf16 v[84:87], a[40:43], a[180:183], v[84:87]
  v_and_b32 v57, 0xffff0000, v102
  v_lshlrev_b32 v58, 16, v103
  v_mfma_f32_16x16x32_bf16 v[92:95], a[44:47], a[180:183], v[92:95]
  v_and_b32 v59, 0xffff0000, v103
  v_lshlrev_b32 v52, 16, v108
  v_mfma_f32_16x16x32_bf16 v[92:95], a[60:63], a[188:191], v[92:95]
  v_and_b32 v53, 0xffff0000, v108
  v_lshlrev_b32 v54, 16, v109
  v_mfma_f32_16x16x32_bf16 v[88:91], a[60:63], a[184:187], v[88:91]
  v_and_b32 v55, 0xffff0000, v109
  v_lshlrev_b32 v60, 16, v110
  v_mfma_f32_16x16x32_bf16 v[88:91], a[44:47], a[176:179], v[88:91]
  v_and_b32 v61, 0xffff0000, v110
  v_lshlrev_b32 v62, 16, v111
  v_and_b32 v63, 0xffff0000, v111
  v_pk_add_f32 v[68:69], v[68:69], v[36:37]
  v_pk_add_f32 v[70:71], v[70:71], v[38:39]
  v_pk_add_f32 v[76:77], v[76:77], v[44:45]
  v_pk_add_f32 v[78:79], v[78:79], v[46:47]
  v_cvt_pk_bf16_f32 v24, v68, v69
  v_cvt_pk_bf16_f32 v25, v70, v71
  v_cvt_pk_bf16_f32 v26, v76, v77
  v_cvt_pk_bf16_f32 v27, v78, v79
  v_pk_add_f32 v[64:65], v[64:65], v[32:33]
  v_pk_add_f32 v[66:67], v[66:67], v[34:35]
  v_pk_add_f32 v[72:73], v[72:73], v[40:41]
  v_pk_add_f32 v[74:75], v[74:75], v[42:43]
  v_cvt_pk_bf16_f32 v16, v64, v65
  v_cvt_pk_bf16_f32 v17, v66, v67
  v_cvt_pk_bf16_f32 v18, v72, v73
  v_cvt_pk_bf16_f32 v19, v74, v75
  v_pk_add_f32 v[84:85], v[84:85], v[52:53]
  v_pk_add_f32 v[86:87], v[86:87], v[54:55]
  v_pk_add_f32 v[92:93], v[92:93], v[60:61]
  v_pk_add_f32 v[94:95], v[94:95], v[62:63]
  v_cvt_pk_bf16_f32 v28, v84, v85
  v_cvt_pk_bf16_f32 v29, v86, v87
  v_cvt_pk_bf16_f32 v30, v92, v93
  v_cvt_pk_bf16_f32 v31, v94, v95
  v_pk_add_f32 v[80:81], v[80:81], v[48:49]
  v_pk_add_f32 v[82:83], v[82:83], v[50:51]
  v_pk_add_f32 v[88:89], v[88:89], v[56:57]
  v_pk_add_f32 v[90:91], v[90:91], v[58:59]
  v_cvt_pk_bf16_f32 v20, v80, v81
  v_cvt_pk_bf16_f32 v21, v82, v83
  v_cvt_pk_bf16_f32 v22, v88, v89
  v_cvt_pk_bf16_f32 v23, v90, v91
  s_cmp_eq_u32 s41, 0
  s_cbranch_scc1 Lp4_mid
  v_permlane16_swap_b32 v16, v18
  v_permlane16_swap_b32 v17, v19
  v_permlane16_swap_b32 v20, v22
  v_permlane16_swap_b32 v21, v23
  ds_write_b128 v152, v[16:19] offset:0
  ds_write_b128 v153, v[20:23] offset:0
  ds_read_b128 v[96:99], v154 offset:0
  ds_read_b128 v[100:103], v154 offset:1024
  v_permlane16_swap_b32 v24, v26
  v_permlane16_swap_b32 v25, v27
  v_permlane16_swap_b32 v28, v30
  v_permlane16_swap_b32 v29, v31
  ds_write_b128 v152, v[24:27] offset:2048
  ds_write_b128 v153, v[28:31] offset:2048
  ds_read_b128 v[104:107], v154 offset:2048
  ds_read_b128 v[108:111], v154 offset:3072
  s_waitcnt lgkmcnt(5)
  buffer_store_dwordx4 v[96:99], v155, s[32:35], s57 offen sc1
  s_add_u32 s57, s57, 32768
  s_waitcnt lgkmcnt(4)
  buffer_store_dwordx4 v[100:103], v155, s[32:35], s57 offen sc1
  s_add_u32 s57, s57, 32768
  s_waitcnt lgkmcnt(1)
  buffer_store_dwordx4 v[104:107], v155, s[32:35], s57 offen sc1
  s_add_u32 s57, s57, 32768
  s_waitcnt lgkmcnt(0)
  buffer_store_dwordx4 v[108:111], v155, s[32:35], s57 offen sc1
  s_add_u32 s57, s57, 32768
  s_endpgm
Lp4_mid:
  buffer_store_dwordx4 v[16:19], v8, s[4:7], s46 offen offset:0 sc1
  buffer_store_dwordx4 v[24:27], v8, s[4:7], s47 offen offset:0 sc1
  v_mfma_f32_16x16x32_bf16 v[144:147], v[24:27], v[24:27], 0
  v_mfma_f32_16x16x32_bf16 v[140:143], v[128:131], v[24:27], 0
  v_mfma_f32_16x16x32_bf16 v[136:139], v[16:19], v[16:19], 0
  v_mfma_f32_16x16x32_bf16 v[132:135], v[128:131], v[16:19], 0
  buffer_store_dwordx4 v[20:23], v8, s[4:7], s46 offen offset:1024 sc1
  buffer_store_dwordx4 v[28:31], v8, s[4:7], s47 offen offset:1024 sc1
  v_mfma_f32_16x16x32_bf16 v[144:147], v[28:31], v[28:31], v[144:147]
  v_mfma_f32_16x16x32_bf16 v[140:143], v[128:131], v[28:31], v[140:143]
  v_mfma_f32_16x16x32_bf16 v[136:139], v[20:23], v[20:23], v[136:139]
  v_mfma_f32_16x16x32_bf16 v[132:135], v[128:131], v[20:23], v[132:135]
  s_nop 5
  v_cndmask_b32 v141, v144, v145, s[66:67]
  v_cndmask_b32 v141, v141, v146, s[68:69]
  v_cndmask_b32 v141, v141, v147, s[70:71]
  buffer_store_dwordx2 v[140:141], v148, s[4:7], s48 offen offset:2048 sc1
  v_cndmask_b32 v133, v136, v137, s[66:67]
  v_cndmask_b32 v133, v133, v138, s[68:69]
  v_cndmask_b32 v133, v133, v139, s[70:71]
  buffer_store_dwordx2 v[132:133], v148, s[4:7], s48 offen offset:0 sc1
  s_mov_b32 s41, 1
  s_mov_b32 s42, 0x2800000
  s_mov_b32 s28, s4
  s_mov_b32 s29, s5
  s_mov_b32 s30, 0x10000000
  s_lshr_b32 s57, s40, 1
  s_and_b32 s58, s40, 1
  s_lshl_b32 s71, s50, 3
  s_mov_b32 s67, 0
  s_lshl_b32 s62, s40, 12
  s_mul_i32 s63, s40, 6144
  s_add_u32 s76, s63, 139264
  s_and_b32 s43, s50, 7
  s_cmp_lg_u32 s43, 0
  s_cselect_b32 s43, 1, 0
  s_sub_u32 s72, s71, s43
  v_lshrrev_b32 v2, 3, v253
  v_bfe_u32 v3, v253, 1, 2
  v_lshrrev_b32 v4, 4, v253
  v_xor_b32 v3, v3, v4
  v_and_b32 v5, 1, v253
  v_mov_b32 v6, v2
  s_lshl_b32 s43, s40, 4
  v_mul_u32_u24 v6, 6144, v6
  v_lshl_add_u32 v6, v3, 5, v6
  v_lshl_add_u32 v124, v5, 4, v6
  v_add_u32 v125, 48128, v124
  s_mul_i32 s43, s43, 6144
  s_lshl_b32 s60, s51, 7
  s_add_u32 s60, s60, s43
  v_and_b32 v3, 7, v253
  s_lshl_b32 s43, s40, 1
  s_add_u32 s43, s43, s71
  v_lshlrev_b32 v120, 4, v253
  v_mov_b32 v121, v120
  v_add_u32 v122, 30720, v120
  v_add_u32 v123, 30720, v120
  v_lshlrev_b32 v5, 8, v2
  v_lshl_add_u32 v5, v3, 4, v5
  v_add_u32 v126, 128, v5
  s_lshl_b32 s43, s43, 15
  s_mov_b32 s44, 41943040
  s_add_u32 s59, s43, s44
  s_lshl_b32 s43, s72, 15
  s_add_u32 s73, s43, s44
  s_movk_i32 s61, 2048
  v_and_b32 v2, 15, v253
  v_lshrrev_b32 v3, 4, v253
  v_and_b32 v4, 7, v253
  v_lshlrev_b32 v6, 4, v253
  v_add_u32 v7, 1024, v6
  v_lshlrev_b32 v5, 7, v3
  v_lshl_add_u32 v8, v4, 4, v5
  v_add_u32 v9, 512, v8
  s_lshl_b32 s43, s57, 13
  s_add_u32 s43, s43, 73728
  v_add_u32 v112, s43, v6
  v_add_u32 v113, s43, v7
  v_add_u32 v114, 122880, v8
  v_add_u32 v115, 122880, v9
  s_lshl_b32 s43, s52, 3
  s_lshl_b32 s44, s40, 1
  s_add_u32 s43, s43, s44
  v_mov_b32 v187, v6
  s_lshl_b32 s43, s43, 15
  s_lshl_b32 s44, s53, 11
  s_add_u32 s43, s43, s44
  s_add_u32 s64, s43, 41943040
  v_lshrrev_b32 v2, 2, v253
  v_bfe_u32 v3, v253, 3, 2
  v_and_b32 v4, 3, v253
  v_lshlrev_b32 v4, 3, v4
  v_lshl_add_u32 v4, v2, 7, v4
  s_lshl_b32 s43, s58, 1
  s_or_b32 s43, s43, s57
  v_xor_b32 v5, s43, v3
  v_lshl_add_u32 v116, v5, 5, v4
  v_xor_b32 v5, 1, v5
  v_lshl_add_u32 v117, v5, 5, v4
  v_add_u32 v118, 49152, v116
  v_add_u32 v119, 49152, v117
  s_mov_b32 s84, s16
  s_mov_b32 s85, s17
  s_mov_b32 s86, 7340032
  s_mov_b32 s87, 0x20000
  s_mov_b32 s3, 0
  s_mov_b32 s88, 63
  s_mov_b32 s100, 0
  v_mov_b32 v238, 0x40000000
  s_waitcnt vmcnt(0)
  s_barrier
  s_cmp_lg_u32 s40, 0
  s_cbranch_scc1 Lsig19
  v_mov_b32 v250, 1
  s_mov_b64 exec, 1
  buffer_atomic_add v250, v251, s[4:7], s77 offen sc1
  s_mov_b64 exec, -1
Lsig19:
  s_add_u32 s44, s67, 0
  s_and_b32 s44, s44, 15
  s_mul_i32 s45, s44, 393216
  s_add_u32 s69, s45, s60
  s_add_u32 s70, s69, 4096
  s_add_u32 m0, s63, 0
  s_nop 0
  buffer_load_dwordx4 v124, s[8:11], s69 offen offset:0  lds
  buffer_load_dwordx4 v125, s[8:11], s69 offen offset:1024  lds
  buffer_load_dwordx4 v124, s[8:11], s69 offen offset:2048  lds
  buffer_load_dwordx4 v125, s[8:11], s69 offen offset:3072  lds
  s_add_u32 m0, s63, 4096
  s_nop 0
  buffer_load_dwordx4 v124, s[8:11], s70 offen offset:0  lds
  buffer_load_dwordx4 v125, s[8:11], s70 offen offset:1024  lds
  s_add_u32 s44, s67, 1
  s_and_b32 s44, s44, 15
  s_mul_i32 s45, s44, 393216
  s_add_u32 s69, s45, s60
  s_add_u32 s70, s69, 4096
  s_add_u32 m0, s63, 24576
  s_nop 0
  buffer_load_dwordx4 v124, s[8:11], s69 offen offset:0  lds
  buffer_load_dwordx4 v125, s[8:11], s69 offen offset:1024  lds
  buffer_load_dwordx4 v124, s[8:11], s69 offen offset:2048  lds
  buffer_load_dwordx4 v125, s[8:11], s69 offen offset:3072  lds
  s_add_u32 m0, s63, 28672
  s_nop 0
  buffer_load_dwordx4 v124, s[8:11], s70 offen offset:0  lds
  buffer_load_dwordx4 v125, s[8:11], s70 offen offset:1024  lds
  s_add_u32 s44, s67, 2
  s_and_b32 s44, s44, 15
  s_mul_i32 s45, s44, 393216
  s_add_u32 s69, s45, s60
  s_add_u32 s70, s69, 4096
  s_add_u32 m0, s63, 49152
  s_nop 0
  buffer_load_dwordx4 v124, s[8:11], s69 offen offset:0  lds
  buffer_load_dwordx4 v125, s[8:11], s69 offen offset:1024  lds
  buffer_load_dwordx4 v124, s[8:11], s69 offen offset:2048  lds
  buffer_load_dwordx4 v125, s[8:11], s69 offen offset:3072  lds
  s_add_u32 m0, s63, 53248
  s_nop 0
  buffer_load_dwordx4 v124, s[8:11], s70 offen offset:0  lds
  buffer_load_dwordx4 v125, s[8:11], s70 offen offset:1024  lds
  v_mov_b32 v0, 0
  v_mov_b32 v1, 0
  v_mov_b32 v2, 0
  v_mov_b32 v3, 0
  v_mov_b32 v4, 0
  v_mov_b32 v5, 0
  v_mov_b32 v6, 0
  v_mov_b32 v7, 0
  v_mov_b32 v8, 0
  v_mov_b32 v9, 0
  v_mov_b32 v10, 0
  v_mov_b32 v11, 0
  v_mov_b32 v12, 0
  v_mov_b32 v13, 0
  v_mov_b32 v14, 0
  v_mov_b32 v15, 0
  v_mov_b32 v16, 0
  v_mov_b32 v17, 0
  v_mov_b32 v18, 0
  v_mov_b32 v19, 0
  v_mov_b32 v20, 0
  v_mov_b32 v21, 0
  v_mov_b32 v22, 0
  v_mov_b32 v23, 0
  v_mov_b32 v24, 0
  v_mov_b32 v25, 0
  v_mov_b32 v26, 0
  v_mov_b32 v27, 0
  v_mov_b32 v28, 0
  v_mov_b32 v29, 0
  v_mov_b32 v30, 0
  v_mov_b32 v31, 0
  v_mov_b32 v32, 0
  v_mov_b32 v33, 0
  v_mov_b32 v34, 0
  v_mov_b32 v35, 0
  v_mov_b32 v36, 0
  v_mov_b32 v37, 0
  v_mov_b32 v38, 0
  v_mov_b32 v39, 0
  v_mov_b32 v40, 0
  v_mov_b32 v41, 0
  v_mov_b32 v42, 0
  v_mov_b32 v43, 0
  v_mov_b32 v44, 0
  v_mov_b32 v45, 0
  v_mov_b32 v46, 0
  v_mov_b32 v47, 0
  v_mov_b32 v48, 0
  v_mov_b32 v49, 0
  v_mov_b32 v50, 0
  v_mov_b32 v51, 0
  v_mov_b32 v52, 0
  v_mov_b32 v53, 0
  v_mov_b32 v54, 0
  v_mov_b32 v55, 0
  v_mov_b32 v56, 0
  v_mov_b32 v57, 0
  v_mov_b32 v58, 0
  v_mov_b32 v59, 0
  v_mov_b32 v60, 0
  v_mov_b32 v61, 0
  v_mov_b32 v62, 0
  v_mov_b32 v63, 0
  v_mov_b32 v64, 0
  v_mov_b32 v65, 0
  v_mov_b32 v66, 0
  v_mov_b32 v67, 0
  v_mov_b32 v68, 0
  v_mov_b32 v69, 0
  v_mov_b32 v70, 0
  v_mov_b32 v71, 0
  v_mov_b32 v72, 0
  v_mov_b32 v73, 0
  v_mov_b32 v74, 0
  v_mov_b32 v75, 0
  v_mov_b32 v76, 0
  v_mov_b32 v77, 0
  v_mov_b32 v78, 0
  v_mov_b32 v79, 0
  v_mov_b32 v80, 0
  v_mov_b32 v81, 0
  v_mov_b32 v82, 0
  v_mov_b32 v83, 0
  v_mov_b32 v84, 0
  v_mov_b32 v85, 0
  v_mov_b32 v86, 0
  v_mov_b32 v87, 0
  v_mov_b32 v88, 0
  v_mov_b32 v89, 0
  v_mov_b32 v90, 0
  v_mov_b32 v91, 0
  v_mov_b32 v92, 0
  v_mov_b32 v93, 0
  v_mov_b32 v94, 0
  v_mov_b32 v95, 0
  v_mov_b32 v96, 0
  v_mov_b32 v97, 0
  v_mov_b32 v98, 0
  v_mov_b32 v99, 0
  v_mov_b32 v100, 0
  v_mov_b32 v101, 0
  v_mov_b32 v102, 0
  v_mov_b32 v103, 0
  s_mul_i32 s77, s50, 256
  s_add_u32 s77, s77, 27811584
  s_and_b32 s43, s50, 7
  s_cmp_eq_u32 s43, 0
  s_cselect_b32 s43, 256, 0
  v_lshlrev_b32 v249, 7, v253
  v_or_b32 v249, s43, v249
  s_branch Llayer
Lend:
  s_endpgm
Lside_sub:
  s_cmp_eq_u32 s90, 1
  s_cbranch_scc0 Lside_l
  s_cmp_lg_u32 s40, 0
  s_cbranch_scc1 Lside_a
  s_and_b32 s43, s2, 1
  s_lshl_b32 s43, s43, 7
  v_mov_b32 v250, 1
  s_mov_b64 exec, 1
  buffer_atomic_add v250, v251, s[36:39], s43 offen sc1
  s_mov_b64 exec, -1
Lside_a:
  s_add_u32 s88, s88, 3
  s_add_u32 s90, s90, 1
  s_setpc_b64 s[78:79]
Lside_l:
  buffer_load_dwordx4 a[240:243], v239, s[12:15], s89 offen
  s_add_u32 s89, s89, 1024
  s_cmp_eq_u32 s90, 0
  s_cbranch_scc0 Lside_b
  buffer_load_dwordx4 a[176:179], v238, s[84:87], s100 offen
  s_add_u32 s100, s100, 57344
  buffer_load_dwordx4 a[180:183], v238, s[84:87], s100 offen
  s_add_u32 s100, s100, 57344
  buffer_load_dwordx4 a[184:187], v238, s[84:87], s100 offen
  s_add_u32 s100, s100, 57344
  buffer_load_dwordx4 a[188:191], v238, s[84:87], s100 offen
  s_add_u32 s100, s100, 57344
  buffer_load_dwordx4 a[192:195], v238, s[84:87], s100 offen
  s_add_u32 s100, s100, 57344
  buffer_load_dwordx4 a[196:199], v238, s[84:87], s100 offen
  s_add_u32 s100, s100, 57344
  buffer_load_dwordx4 a[200:203], v238, s[84:87], s100 offen
  s_add_u32 s100, s100, 57344
  buffer_load_dwordx4 a[204:207], v238, s[84:87], s100 offen
  s_add_u32 s100, s100, 57344
  s_add_u32 s100, s100, 3211264
  s_add_u32 s88, s88, 3
  s_add_u32 s90, s90, 1
  s_setpc_b64 s[78:79]
Lside_b:
  buffer_load_dwordx4 a[208:211], v238, s[84:87], s100 offen
  s_add_u32 s100, s100, 57344
  buffer_load_dwordx4 a[212:215], v238, s[84:87], s100 offen
  s_add_u32 s100, s100, 57344
  buffer_load_dwordx4 a[216:219], v238, s[84:87], s100 offen
  s_add_u32 s100, s100, 57344
  buffer_load_dwordx4 a[220:223], v238, s[84:87], s100 offen
  s_add_u32 s100, s100, 57344
  buffer_load_dwordx4 a[224:227], v238, s[84:87], s100 offen
  s_add_u32 s100, s100, 57344
  buffer_load_dwordx4 a[228:231], v238, s[84:87], s100 offen
  s_add_u32 s100, s100, 57344
  buffer_load_dwordx4 a[232:235], v238, s[84:87], s100 offen
  s_add_u32 s100, s100, 57344
  buffer_load_dwordx4 a[236:239], v238, s[84:87], s100 offen
  s_add_u32 s100, s100, 57344
  s_mov_b32 s88, 63
  s_setpc_b64 s[78:79]
Lcode_end:
.fill (Lpc0 + 69632 - Lcode_end)/4, 4, 0xbf810000
.section .rodata,"a"
.p2align 6
.amdhsa_kernel interleave_layers__sliding_local_dilated__swiglu_ffn__prompt_kernel
  .amdhsa_next_free_vgpr 512
  .amdhsa_next_free_sgpr 102
  .amdhsa_accum_offset 256
  .amdhsa_group_segment_fixed_size 0
  .amdhsa_kernarg_size 80
  .amdhsa_user_sgpr_count 2
  .amdhsa_user_sgpr_kernarg_segment_ptr 1
  .amdhsa_system_sgpr_workgroup_id_x 1
  .amdhsa_float_denorm_mode_32 3
.end_amdhsa_kernel
```

```asm
; @launch grid=(256,1,1) block=(256,1,1) lds=163840
.amdgcn_target "amdgcn-amd-amdhsa--gfx950"
.text
.globl interleave_layers__sliding_local_dilated__swiglu_ffn__prompt_kernel
.p2align 8
.type interleave_layers__sliding_local_dilated__swiglu_ffn__prompt_kernel,@function
interleave_layers__sliding_local_dilated__swiglu_ffn__prompt_kernel:
  s_cmp_lt_u32 s2, 256
  s_cbranch_scc1 Lgo
  s_endpgm
Lgo:
  s_load_dwordx2 s[28:29], s[0:1], 0
  s_load_dwordx2 s[8:9], s[0:1], 8
  s_getpc_b64 s[44:45]
Lpc0:
  s_bfe_u32 s43, s2, 0x40003
  s_lshl_b32 s43, s43, 12
  v_lshl_add_u32 v2, v0, 4, s43
  s_and_b32 s44, s44, 0xffffff80
  global_load_dwordx4 a[240:243], v2, s[44:45]
  v_lshrrev_b32 v1, 6, v0
  v_and_b32 v253, 63, v0
  v_readfirstlane_b32 s40, v1
  v_mov_b32 v251, 0
  s_mov_b32 s30, 0x400000
  s_mov_b32 s31, 0x20000
  s_mov_b32 s10, 0x600000
  s_mov_b32 s11, 0x20000
  s_and_b32 s44, s2, 1
  s_bfe_u32 s45, s2, 0x20001
  s_lshr_b32 s46, s2, 3
  s_lshl_b32 s47, s44, 3
  s_and_b32 s43, s46, 7
  s_add_u32 s50, s47, s43
  s_lshl_b32 s43, s45, 2
  s_lshr_b32 s51, s46, 3
  s_add_u32 s51, s51, s43
  s_lshr_b32 s57, s40, 1
  s_and_b32 s58, s40, 1
  s_lshl_b32 s71, s50, 3
  s_add_u32 s67, s50, s51
  s_and_b32 s67, s67, 15
  s_lshl_b32 s62, s40, 12
  s_mul_i32 s63, s40, 6144
  s_add_u32 s76, s63, 139264
  s_and_b32 s43, s50, 7
  s_cmp_lg_u32 s43, 0
  s_cselect_b32 s43, 1, 0
  s_sub_u32 s72, s71, s43
  v_lshrrev_b32 v2, 3, v253
  v_bfe_u32 v3, v253, 1, 2
  v_lshrrev_b32 v4, 4, v253
  v_xor_b32 v3, v3, v4
  v_and_b32 v5, 1, v253
  v_lshrrev_b32 v6, 5, v253
  v_lshl_add_u32 v6, v6, 2, v2
  s_lshl_b32 s43, s57, 5
  s_lshl_b32 s44, s58, 2
  s_add_u32 s43, s43, s44
  v_mul_u32_u24 v6, 6144, v6
  v_lshl_add_u32 v6, v3, 5, v6
  v_lshl_add_u32 v124, v5, 4, v6
  v_add_u32 v125, 97280, v124
  s_mul_i32 s43, s43, 6144
  s_lshl_b32 s60, s51, 7
  s_add_u32 s60, s60, s43
  v_and_b32 v3, 7, v253
  s_lshl_b32 s43, s40, 1
  s_add_u32 s43, s43, s71
  v_add_u32 v5, 0, v4
  v_xor_b32 v5, v5, v3
  v_lshlrev_b32 v5, 4, v5
  v_lshl_add_u32 v5, v2, 12, v5
  v_add_u32 v120, 0, v5
  v_add_u32 v5, 4, v4
  v_xor_b32 v5, v5, v3
  v_lshlrev_b32 v5, 4, v5
  v_lshl_add_u32 v5, v2, 12, v5
  v_add_u32 v121, 31744, v5
  v_add_u32 v5, 0, v4
  v_xor_b32 v5, v5, v3
  v_lshlrev_b32 v5, 4, v5
  v_lshl_add_u32 v5, v2, 12, v5
  v_add_u32 v122, 63488, v5
  v_add_u32 v5, 4, v4
  v_xor_b32 v5, v5, v3
  v_lshlrev_b32 v5, 4, v5
  v_lshl_add_u32 v5, v2, 12, v5
  v_add_u32 v123, 95232, v5
  v_and_b32 v5, 6, v2
  v_xor_b32 v5, v5, v3
  v_lshlrev_b32 v5, 4, v5
  v_lshl_add_u32 v5, v2, 12, v5
  v_add_u32 v126, 32768, v5
  s_lshr_b32 s44, s50, 3
  s_lshl_b32 s44, s44, 11
  s_and_b32 s43, s43, 63
  s_lshl_b32 s43, s43, 16
  s_add_u32 s59, s43, s44
  s_and_b32 s43, s72, 63
  s_lshl_b32 s43, s43, 16
  s_add_u32 s73, s43, s44
  s_movk_i32 s61, 128
  s_waitcnt lgkmcnt(0)
  s_add_u32 s44, s67, 0
  s_and_b32 s44, s44, 15
  s_mul_i32 s45, s44, s61
  s_add_u32 s68, s45, s59
  s_add_u32 m0, s62, 73728
  s_nop 0
  buffer_load_dwordx4 v120, s[28:31], s68 offen offset:0 sc1  lds
  buffer_load_dwordx4 v121, s[28:31], s68 offen offset:1024 sc1  lds
  buffer_load_dwordx4 v122, s[28:31], s68 offen offset:2048 sc1  lds
  buffer_load_dwordx4 v123, s[28:31], s68 offen offset:3072 sc1  lds
  s_add_u32 s44, s67, 0
  s_and_b32 s44, s44, 15
  s_mul_i32 s45, s44, 393216
  s_add_u32 s69, s45, s60
  s_add_u32 s70, s69, 4096
  s_add_u32 m0, s63, 0
  s_nop 0
  buffer_load_dwordx4 v124, s[8:11], s69 offen offset:0  lds
  buffer_load_dwordx4 v125, s[8:11], s69 offen offset:1024  lds
  buffer_load_dwordx4 v124, s[8:11], s69 offen offset:2048  lds
  buffer_load_dwordx4 v125, s[8:11], s69 offen offset:3072  lds
  s_add_u32 m0, s63, 4096
  s_nop 0
  buffer_load_dwordx4 v124, s[8:11], s70 offen offset:0  lds
  buffer_load_dwordx4 v125, s[8:11], s70 offen offset:1024  lds
  s_add_u32 s44, s67, s40
  s_add_u32 s44, s44, 0
  s_and_b32 s44, s44, 15
  s_mul_i32 s44, s44, s61
  s_lshl_b32 s45, s40, 10
  s_add_u32 m0, s45, 122880
  s_add_u32 s44, s44, s73
  buffer_load_dwordx4 v126, s[28:31], s44 offen sc1 lds
  s_load_dwordx2 s[4:5], s[0:1], 72
  s_load_dwordx2 s[12:13], s[0:1], 16
  s_load_dwordx2 s[16:17], s[0:1], 32
  s_load_dwordx2 s[20:21], s[0:1], 40
  s_load_dwordx2 s[24:25], s[0:1], 48
  s_load_dwordx2 s[32:33], s[0:1], 56
  s_load_dwordx2 s[36:37], s[0:1], 64
  s_mov_b32 s6, 0x10000000
  s_mov_b32 s7, 0x20000
  s_mov_b32 s14, 0x200000
  s_mov_b32 s15, 0x20000
  s_mov_b32 s18, 0x700000
  s_mov_b32 s19, 0x20000
  s_mov_b32 s22, 0x700000
  s_mov_b32 s23, 0x20000
  s_mov_b32 s26, 0x700000
  s_mov_b32 s27, 0x20000
  s_mov_b32 s34, 0x400000
  s_mov_b32 s35, 0x20000
  s_mov_b32 s38, 0x100
  s_mov_b32 s39, 0x20000
  s_mov_b32 s41, 0
  s_mov_b32 s42, 0
  s_and_b32 s44, s2, 1
  s_bfe_u32 s45, s2, 0x20001
  s_lshr_b32 s46, s2, 3
  s_lshl_b32 s47, s44, 3
  s_lshr_b32 s43, s45, 1
  s_lshl_b32 s43, s43, 2
  s_add_u32 s52, s47, s43
  s_and_b32 s48, s46, 3
  s_add_u32 s52, s52, s48
  s_and_b32 s43, s45, 1
  s_lshr_b32 s49, s46, 2
  s_lshl_b32 s53, s49, 1
  s_add_u32 s53, s53, s43
  s_lshl_b32 s43, s44, 2
  s_add_u32 s54, s43, s48
  s_lshl_b32 s43, s45, 3
  s_add_u32 s55, s43, s49
  v_lshrrev_b32 v2, 3, v253
  v_bfe_u32 v3, v253, 1, 2
  v_lshrrev_b32 v4, 4, v253
  v_xor_b32 v3, v3, v4
  v_and_b32 v4, 1, v253
  v_lshlrev_b32 v2, 11, v2
  v_lshl_add_u32 v2, v3, 5, v2
  v_lshl_add_u32 v252, v4, 4, v2
  s_waitcnt lgkmcnt(0)
  s_and_b32 s43, s40, 1
  s_mul_i32 s43, s43, 41943040
  s_lshl_b32 s44, s2, 7
  s_add_u32 s43, s43, s44
  s_add_u32 s43, s43, 27787264
  buffer_store_dword v251, v251, s[4:7], s43 offen sc1
  v_and_b32 v2, 15, v253
  v_lshrrev_b32 v3, 4, v253
  v_and_b32 v4, 7, v253
  v_lshrrev_b32 v5, 1, v2
  v_xor_b32 v5, v5, v3
  v_lshlrev_b32 v5, 4, v5
  v_lshl_add_u32 v6, v2, 7, v5
  v_xor_b32 v7, 64, v6
  v_and_b32 v5, 6, v4
  v_xor_b32 v5, v5, v3
  v_lshlrev_b32 v5, 4, v5
  v_lshl_add_u32 v8, v4, 7, v5
  v_xor_b32 v9, 64, v8
  s_lshl_b32 s43, s57, 13
  s_add_u32 s43, s43, 73728
  v_add_u32 v112, s43, v6
  v_add_u32 v113, s43, v7
  v_add_u32 v114, 122880, v8
  v_add_u32 v115, 122880, v9
  s_lshl_b32 s43, s52, 3
  s_lshl_b32 s44, s40, 1
  s_add_u32 s43, s43, s44
  v_lshrrev_b32 v5, 1, v3
  v_lshrrev_b32 v187, 1, v2
  v_xor_b32 v5, v5, v187
  v_lshlrev_b32 v5, 4, v5
  v_lshl_add_u32 v187, v2, 7, v5
  v_and_b32 v5, 1, v3
  v_lshl_add_u32 v187, v5, 3, v187
  s_lshr_b32 s44, s43, 6
  s_lshl_b32 s44, s44, 11
  s_and_b32 s43, s43, 63
  s_lshl_b32 s43, s43, 16
  s_add_u32 s43, s43, s44
  s_lshl_b32 s44, s53, 7
  s_add_u32 s64, s43, s44
  v_lshrrev_b32 v2, 2, v253
  v_bfe_u32 v3, v253, 3, 2
  v_and_b32 v4, 3, v253
  v_lshlrev_b32 v4, 3, v4
  v_lshl_add_u32 v4, v2, 7, v4
  s_lshl_b32 s43, s58, 1
  s_or_b32 s43, s43, s57
  v_xor_b32 v5, s43, v3
  v_lshl_add_u32 v116, v5, 5, v4
  v_xor_b32 v5, 1, v5
  v_lshl_add_u32 v117, v5, 5, v4
  v_add_u32 v118, 49152, v116
  v_add_u32 v119, 49152, v117
  v_and_b32 v235, 15, v253
  v_lshrrev_b32 v236, 4, v253
  v_lshlrev_b32 v236, 2, v236
  v_sub_u32 v235, v235, v236
  v_mov_b32 v237, 0xf149f2ca
  v_subrev_u32 v238, 0, v235
  v_cmp_gt_u32 vcc, 8, v238
  v_add_u32 v238, 16, v238
  v_cmp_gt_u32 s[78:79], 8, v238
  v_cndmask_b32 v132, v237, 0, vcc
  s_nop 0
  v_cndmask_b32 v136, v237, 0, s[78:79]
  v_subrev_u32 v238, 1, v235
  v_cmp_gt_u32 vcc, 8, v238
  v_add_u32 v238, 16, v238
  v_cmp_gt_u32 s[78:79], 8, v238
  v_cndmask_b32 v133, v237, 0, vcc
  s_nop 0
  v_cndmask_b32 v137, v237, 0, s[78:79]
  v_subrev_u32 v238, 2, v235
  v_cmp_gt_u32 vcc, 8, v238
  v_add_u32 v238, 16, v238
  v_cmp_gt_u32 s[78:79], 8, v238
  v_cndmask_b32 v134, v237, 0, vcc
  s_nop 0
  v_cndmask_b32 v138, v237, 0, s[78:79]
  v_subrev_u32 v238, 3, v235
  v_cmp_gt_u32 vcc, 8, v238
  v_add_u32 v238, 16, v238
  v_cmp_gt_u32 s[78:79], 8, v238
  v_cndmask_b32 v135, v237, 0, vcc
  s_nop 0
  v_cndmask_b32 v139, v237, 0, s[78:79]
  v_lshlrev_b32 v232, 4, v253
  v_add_u32 v232, 149504, v232
  ds_write_b128 v232, v[132:135]
  ds_write_b128 v232, v[136:139] offset:1024
  s_lshr_b32 s46, s2, 3
  s_cmp_ge_u32 s46, 14
  s_cselect_b32 s44, 14, 0
  s_cselect_b32 s45, 1, 0
  s_cselect_b32 s84, s20, s16
  s_cselect_b32 s85, s21, s17
  s_mov_b32 s86, 7340032
  s_mov_b32 s87, 0x20000
  s_sub_u32 s44, s46, s44
  s_bfe_u32 s47, s2, 0x20001
  s_mul_i32 s47, s47, 14
  s_add_u32 s44, s44, s47
  s_and_b32 s47, s2, 1
  s_lshl_b32 s48, s47, 1
  s_add_u32 s48, s48, s45
  s_mul_i32 s48, s48, 14336
  s_lshl_b32 s49, s44, 8
  s_add_u32 s48, s48, s49
  s_add_u32 s101, s48, 27918336
  s_lshl_b32 s47, s47, 2
  s_add_u32 s47, s47, s40
  s_mul_i32 s47, s47, 458752
  s_lshl_b32 s44, s44, 7
  s_add_u32 s100, s47, s44
  s_cmp_lt_u32 s46, 28
  s_cselect_b32 s3, 1, 0
  s_cmp_eq_u32 s41, 0
  s_cselect_b32 s3, s3, 0
  v_lshrrev_b32 v238, 3, v253
  v_mul_u32_u24 v238, 7168, v238
  v_and_b32 v239, 7, v253
  v_lshl_add_u32 v238, v239, 4, v238
  s_cmp_eq_u32 s3, 0
  s_cselect_b32 s43, 0x40000000, 0
  v_or_b32 v238, s43, v238
  v_lshlrev_b32 v239, 4, v253
  s_lshl_b32 s43, s2, 2
  s_add_u32 s43, s43, s40
  s_lshl_b32 s89, s43, 11
  s_mul_i32 s43, s46, 43
  s_lshr_b32 s43, s43, 8
  s_mul_i32 s43, s43, 6
  s_sub_u32 s43, s46, s43
  s_add_u32 s43, s43, 5
  s_cmp_eq_u32 s41, 0
  s_cselect_b32 s88, s43, 63
  s_mov_b32 s90, 0
  s_lshl_b32 s43, s58, 12
  v_add_u32 v132, s43, v112
  v_add_u32 v133, s43, v113
  v_and_b32 v128, 15, v253
  v_lshrrev_b32 v129, 4, v253
  v_cmp_eq_u32 vcc, 0, v128
  v_lshlrev_b32 v129, 4, v129
  v_mov_b32 v130, 0x40000000
  v_cndmask_b32 v136, v130, v129, vcc
  v_mov_b32 v156, 0x3f803f80
  v_mov_b32 v157, 0x3f803f80
  v_mov_b32 v158, 0x3f803f80
  v_mov_b32 v159, 0x3f803f80
  s_lshl_b32 s43, s40, 1
  s_add_u32 s43, s43, s71
  s_lshl_b32 s48, s43, 11
  s_lshl_b32 s43, s67, 7
  s_add_u32 s48, s48, s43
  s_add_u32 s48, s48, 27262976
  s_lshl_b32 s43, s51, 2
  s_lshl_b32 s44, s58, 1
  s_add_u32 s43, s43, s44
  s_add_u32 s43, s43, s57
  s_lshl_b32 s43, s43, 6
  s_mul_i32 s49, s67, 12288
  s_add_u32 s49, s49, s43
  s_add_u32 s49, s49, 27983872
  v_and_b32 v212, 15, v253
  v_lshrrev_b32 v213, 4, v253
  v_lshrrev_b32 v192, 2, v212
  v_cmp_eq_u32 vcc, v192, v213
  v_and_b32 v192, 3, v212
  v_lshlrev_b32 v212, 3, v212
  v_mov_b32 v213, 0x7ffffff0
  v_cndmask_b32 v212, v213, v212, vcc
  v_cmp_eq_u32 s[78:79], 1, v192
  v_cmp_eq_u32 s[80:81], 2, v192
  v_cmp_eq_u32 s[82:83], 3, v192
  v_mov_b32 v192, 0x3f803f80
  v_mov_b32 v193, 0x3f803f80
  v_mov_b32 v194, 0x3f803f80
  v_mov_b32 v195, 0x3f803f80
  s_add_u32 s44, s67, 1
  s_and_b32 s44, s44, 15
  s_mul_i32 s45, s44, s61
  s_add_u32 s68, s45, s59
  s_add_u32 m0, s62, 90112
  s_nop 0
  buffer_load_dwordx4 v120, s[28:31], s68 offen offset:0 sc1  lds
  buffer_load_dwordx4 v121, s[28:31], s68 offen offset:1024 sc1  lds
  buffer_load_dwordx4 v122, s[28:31], s68 offen offset:2048 sc1  lds
  buffer_load_dwordx4 v123, s[28:31], s68 offen offset:3072 sc1  lds
  s_waitcnt vmcnt(5)
  s_barrier
  ds_read_b64_tr_b16 a[40:41], v116 offset:0
  ds_read_b64_tr_b16 a[42:43], v116 offset:6144
  ds_read_b64_tr_b16 a[64:65], v116 offset:12288
  ds_read_b64_tr_b16 a[66:67], v116 offset:18432
  ds_read_b128 a[4:7], v112 offset:0
  ds_read_b128 a[24:27], v113 offset:0
  ds_read_b128 a[8:11], v112 offset:2048
  ds_read_b128 a[28:31], v113 offset:2048
  ds_read_b128 a[12:15], v112 offset:4096
  ds_read_b128 a[32:35], v113 offset:4096
  ds_read_b128 a[16:19], v112 offset:6144
  ds_read_b128 a[36:39], v113 offset:6144
  ds_read_b64_tr_b16 a[44:45], v117 offset:0
  ds_read_b64_tr_b16 a[46:47], v117 offset:6144
  ds_read_b64_tr_b16 a[68:69], v117 offset:12288
  ds_read_b64_tr_b16 a[70:71], v117 offset:18432
  ds_read_b128 a[0:3], v114 offset:0
  ds_read_b128 a[20:23], v115 offset:0
  ds_read_b64_tr_b16 a[48:49], v116 offset:2048
  ds_read_b64_tr_b16 a[50:51], v116 offset:8192
  ds_read_b64_tr_b16 a[72:73], v116 offset:14336
  ds_read_b64_tr_b16 a[74:75], v116 offset:20480
  ds_read_b64_tr_b16 a[52:53], v117 offset:2048
  ds_read_b64_tr_b16 a[54:55], v117 offset:8192
  ds_read_b64_tr_b16 a[76:77], v117 offset:14336
  ds_read_b64_tr_b16 a[78:79], v117 offset:20480
  ds_read_b64_tr_b16 a[56:57], v116 offset:4096
  ds_read_b64_tr_b16 a[58:59], v116 offset:10240
  ds_read_b64_tr_b16 a[80:81], v116 offset:16384
  ds_read_b64_tr_b16 a[82:83], v116 offset:22528
  ds_read_b64_tr_b16 a[60:61], v117 offset:4096
  ds_read_b64_tr_b16 a[62:63], v117 offset:10240
  ds_read_b64_tr_b16 a[84:85], v117 offset:16384
  ds_read_b64_tr_b16 a[86:87], v117 offset:22528
  ds_read_b128 v[140:143], v132 offset:0
  ds_read_b128 v[144:147], v133 offset:0
  ds_read_b128 v[148:151], v132 offset:2048
  ds_read_b128 v[152:155], v133 offset:2048
  s_add_u32 s44, s67, 1
  s_and_b32 s44, s44, 15
  s_mul_i32 s45, s44, 393216
  s_add_u32 s69, s45, s60
  s_add_u32 s70, s69, 4096
  s_add_u32 m0, s63, 24576
  s_nop 0
  buffer_load_dwordx4 v124, s[8:11], s69 offen offset:0  lds
  buffer_load_dwordx4 v125, s[8:11], s69 offen offset:1024  lds
  buffer_load_dwordx4 v124, s[8:11], s69 offen offset:2048  lds
  buffer_load_dwordx4 v125, s[8:11], s69 offen offset:3072  lds
  s_add_u32 m0, s63, 28672
  s_nop 0
  buffer_load_dwordx4 v124, s[8:11], s70 offen offset:0  lds
  buffer_load_dwordx4 v125, s[8:11], s70 offen offset:1024  lds
  s_waitcnt lgkmcnt(15)
  v_mfma_f32_16x16x32_bf16 v[0:3], a[40:43], a[4:7], 0
  s_add_u32 s44, s67, 2
  s_and_b32 s44, s44, 15
  s_mul_i32 s45, s44, 393216
  s_add_u32 s69, s45, s60
  s_add_u32 s70, s69, 4096
  s_add_u32 m0, s63, 49152
  s_nop 0
  v_mfma_f32_16x16x32_bf16 v[0:3], a[64:67], a[24:27], v[0:3]
  buffer_load_dwordx4 v124, s[8:11], s69 offen offset:0  lds
  v_mfma_f32_16x16x32_bf16 v[4:7], a[64:67], a[28:31], 0
  v_mfma_f32_16x16x32_bf16 v[4:7], a[40:43], a[8:11], v[4:7]
  buffer_load_dwordx4 v125, s[8:11], s69 offen offset:1024  lds
  v_mfma_f32_16x16x32_bf16 v[8:11], a[40:43], a[12:15], 0
  v_mfma_f32_16x16x32_bf16 v[8:11], a[64:67], a[32:35], v[8:11]
  v_mfma_f32_16x16x32_bf16 v[12:15], a[64:67], a[36:39], 0
  buffer_load_dwordx4 v124, s[8:11], s69 offen offset:2048  lds
  v_mfma_f32_16x16x32_bf16 v[12:15], a[40:43], a[16:19], v[12:15]
  v_mfma_f32_16x16x32_bf16 v[28:31], a[44:47], a[16:19], 0
  v_mfma_f32_16x16x32_bf16 v[28:31], a[68:71], a[36:39], v[28:31]
  buffer_load_dwordx4 v125, s[8:11], s69 offen offset:3072  lds
  s_add_u32 m0, s63, 53248
  s_nop 0
  v_mfma_f32_16x16x32_bf16 v[24:27], a[68:71], a[32:35], 0
  v_mfma_f32_16x16x32_bf16 v[24:27], a[44:47], a[12:15], v[24:27]
  buffer_load_dwordx4 v124, s[8:11], s70 offen offset:0  lds
  v_mfma_f32_16x16x32_bf16 v[20:23], a[44:47], a[8:11], 0
  v_mfma_f32_16x16x32_bf16 v[20:23], a[68:71], a[28:31], v[20:23]
  v_mfma_f32_16x16x32_bf16 v[16:19], a[68:71], a[24:27], 0
  s_add_u32 s44, s67, 2
  buffer_load_dwordx4 v125, s[8:11], s70 offen offset:1024  lds
  s_and_b32 s44, s44, 15
  s_mul_i32 s45, s44, s61
  s_add_u32 s68, s45, s59
  s_add_u32 m0, s62, 106496
  s_nop 0
  v_mfma_f32_16x16x32_bf16 v[16:19], a[44:47], a[4:7], v[16:19]
  v_mfma_f32_16x16x32_bf16 v[96:99], a[48:51], a[0:3], 0
  s_waitcnt vmcnt(6) lgkmcnt(0)
  s_barrier
  ds_read_b64_tr_b16 a[128:129], v116 offset:24576
  v_mfma_f32_16x16x32_bf16 v[96:99], a[72:75], a[20:23], v[96:99]
  ds_read_b64_tr_b16 a[130:131], v116 offset:30720
  buffer_load_dwordx4 v120, s[28:31], s68 offen offset:0 sc1  lds
  v_mfma_f32_16x16x32_bf16 v[32:35], a[72:75], a[24:27], 0
  ds_read_b64_tr_b16 a[152:153], v116 offset:36864
  v_mfma_f32_16x16x32_bf16 v[32:35], a[48:51], a[4:7], v[32:35]
  ds_read_b64_tr_b16 a[154:155], v116 offset:43008
  v_mfma_f32_16x16x32_bf16 v[36:39], a[48:51], a[8:11], 0
  ds_read_b128 a[92:95], v112 offset:16384
  buffer_load_dwordx4 v121, s[28:31], s68 offen offset:1024 sc1  lds
  v_mfma_f32_16x16x32_bf16 v[36:39], a[72:75], a[28:31], v[36:39]
  ds_read_b128 a[112:115], v113 offset:16384
  v_mfma_f32_16x16x32_bf16 v[40:43], a[72:75], a[32:35], 0
  ds_read_b128 a[96:99], v112 offset:18432
  buffer_load_dwordx4 v122, s[28:31], s68 offen offset:2048 sc1  lds
  v_mfma_f32_16x16x32_bf16 v[40:43], a[48:51], a[12:15], v[40:43]
  ds_read_b128 a[116:119], v113 offset:18432
  v_mfma_f32_16x16x32_bf16 v[44:47], a[48:51], a[16:19], 0
  ds_read_b128 a[100:103], v112 offset:20480
  v_mfma_f32_16x16x32_bf16 v[44:47], a[72:75], a[36:39], v[44:47]
  s_add_u32 s44, s67, s40
  ds_read_b128 a[120:123], v113 offset:20480
  buffer_load_dwordx4 v123, s[28:31], s68 offen offset:3072 sc1  lds
  s_add_u32 s44, s44, 4
  s_and_b32 s44, s44, 15
  s_mul_i32 s44, s44, s61
  s_lshl_b32 s45, s40, 10
  v_mfma_f32_16x16x32_bf16 v[60:63], a[76:79], a[36:39], 0
  s_add_u32 m0, s45, 126976
  s_add_u32 s44, s44, s73
  ds_read_b128 a[104:107], v112 offset:22528
  v_mfma_f32_16x16x32_bf16 v[60:63], a[52:55], a[16:19], v[60:63]
  ds_read_b128 a[124:127], v113 offset:22528
  v_mfma_f32_16x16x32_bf16 v[56:59], a[52:55], a[12:15], 0
  ds_read_b64_tr_b16 a[132:133], v117 offset:24576
  buffer_load_dwordx4 v126, s[28:31], s44 offen sc1 lds
  s_add_u32 s44, s67, s40
  s_add_u32 s44, s44, 8
  s_and_b32 s44, s44, 15
  s_mul_i32 s44, s44, s61
  s_lshl_b32 s45, s40, 10
  v_mfma_f32_16x16x32_bf16 v[56:59], a[76:79], a[32:35], v[56:59]
  s_add_u32 m0, s45, 131072
  s_add_u32 s44, s44, s73
  ds_read_b64_tr_b16 a[134:135], v117 offset:30720
  v_mfma_f32_16x16x32_bf16 v[160:163], a[40:43], v[156:159], 0
  ds_read_b64_tr_b16 a[156:157], v117 offset:36864
  v_mfma_f32_16x16x32_bf16 v[164:167], a[48:51], v[156:159], 0
  ds_read_b64_tr_b16 a[158:159], v117 offset:43008
  buffer_load_dwordx4 v126, s[28:31], s44 offen sc1 lds
  s_add_u32 s44, s67, s40
  s_add_u32 s44, s44, 12
  s_and_b32 s44, s44, 15
  s_mul_i32 s44, s44, s61
  s_lshl_b32 s45, s40, 10
  v_mfma_f32_16x16x32_bf16 v[168:171], a[56:59], v[156:159], 0
  s_add_u32 m0, s45, 135168
  s_add_u32 s44, s44, s73
  ds_read_b128 a[88:91], v114 offset:1024
  v_mfma_f32_16x16x32_bf16 v[160:163], a[64:67], v[156:159], v[160:163]
  ds_read_b128 a[108:111], v115 offset:1024
  buffer_load_dwordx4 v126, s[28:31], s44 offen sc1 lds
  s_add_u32 s44, s67, 3
  s_and_b32 s44, s44, 15
  s_mul_i32 s45, s44, s61
  s_add_u32 s68, s45, s59
  s_add_u32 m0, s62, 73728
  s_nop 0
  v_mfma_f32_16x16x32_bf16 v[164:167], a[72:75], v[156:159], v[164:167]
  ds_read_b64_tr_b16 a[136:137], v116 offset:26624
  v_mfma_f32_16x16x32_bf16 v[168:171], a[80:83], v[156:159], v[168:171]
  ds_read_b64_tr_b16 a[138:139], v116 offset:32768
  v_mfma_f32_16x16x32_bf16 v[208:211], v[148:151], v[148:151], 0
  ds_read_b64_tr_b16 a[160:161], v116 offset:38912
  buffer_load_dwordx4 v120, s[28:31], s68 offen offset:0 sc1  lds
  v_mfma_f32_16x16x32_bf16 v[204:207], v[192:195], v[148:151], 0
  ds_read_b64_tr_b16 a[162:163], v116 offset:45056
  v_mfma_f32_16x16x32_bf16 v[200:203], v[140:143], v[140:143], 0
  ds_read_b64_tr_b16 a[140:141], v117 offset:26624
  v_mfma_f32_16x16x32_bf16 v[196:199], v[192:195], v[140:143], 0
  ds_read_b64_tr_b16 a[142:143], v117 offset:32768
  buffer_load_dwordx4 v121, s[28:31], s68 offen offset:1024 sc1  lds
  v_mfma_f32_16x16x32_bf16 v[208:211], v[152:155], v[152:155], v[208:211]
  ds_read_b64_tr_b16 a[164:165], v117 offset:38912
  v_mfma_f32_16x16x32_bf16 v[204:207], v[192:195], v[152:155], v[204:207]
  ds_read_b64_tr_b16 a[166:167], v117 offset:45056
  v_mfma_f32_16x16x32_bf16 v[200:203], v[144:147], v[144:147], v[200:203]
  ds_read_b64_tr_b16 a[144:145], v116 offset:28672
  buffer_load_dwordx4 v122, s[28:31], s68 offen offset:2048 sc1  lds
  v_mfma_f32_16x16x32_bf16 v[196:199], v[192:195], v[144:147], v[196:199]
  ds_read_b64_tr_b16 a[146:147], v116 offset:34816
  v_mfma_f32_16x16x32_bf16 v[52:55], a[76:79], a[28:31], 0
  s_add_u32 s44, s67, 3
  ds_read_b64_tr_b16 a[168:169], v116 offset:40960
  buffer_load_dwordx4 v123, s[28:31], s68 offen offset:3072 sc1  lds
  s_and_b32 s44, s44, 15
  s_mul_i32 s45, s44, 393216
  s_add_u32 s69, s45, s60
  s_add_u32 s70, s69, 4096
  s_add_u32 m0, s63, 0
  s_nop 0
  v_mfma_f32_16x16x32_bf16 v[52:55], a[52:55], a[8:11], v[52:55]
  ds_read_b64_tr_b16 a[170:171], v116 offset:47104
  v_mfma_f32_16x16x32_bf16 v[48:51], a[52:55], a[4:7], 0
  ds_read_b64_tr_b16 a[148:149], v117 offset:28672
  v_mfma_f32_16x16x32_bf16 v[48:51], a[76:79], a[24:27], v[48:51]
  ds_read_b64_tr_b16 a[150:151], v117 offset:34816
  buffer_load_dwordx4 v124, s[8:11], s69 offen offset:0  lds
  v_mfma_f32_16x16x32_bf16 v[100:103], a[20:23], a[80:83], 0
  ds_read_b64_tr_b16 a[172:173], v117 offset:40960
  v_mfma_f32_16x16x32_bf16 v[100:103], a[0:3], a[56:59], v[100:103]
  ds_read_b64_tr_b16 a[174:175], v117 offset:47104
  v_mfma_f32_16x16x32_bf16 v[64:67], a[4:7], a[56:59], 0
  buffer_load_dwordx4 v125, s[8:11], s69 offen offset:1024  lds
  v_mfma_f32_16x16x32_bf16 v[64:67], a[24:27], a[80:83], v[64:67]
  v_cndmask_b32 v205, v208, v209, s[78:79]
  v_cndmask_b32 v205, v205, v210, s[80:81]
  v_cndmask_b32 v205, v205, v211, s[82:83]
  v_mfma_f32_16x16x32_bf16 v[68:71], a[28:31], a[80:83], 0
  buffer_store_dwordx2 v[204:205], v212, s[4:7], s48 offen offset:2048 sc1
  v_cndmask_b32 v197, v200, v201, s[78:79]
  v_cndmask_b32 v197, v197, v202, s[80:81]
  v_mfma_f32_16x16x32_bf16 v[68:71], a[8:11], a[56:59], v[68:71]
  buffer_load_dwordx4 v124, s[8:11], s69 offen offset:2048  lds
  v_cndmask_b32 v197, v197, v203, s[82:83]
  buffer_store_dwordx2 v[196:197], v212, s[4:7], s48 offen offset:0 sc1
  v_mfma_f32_16x16x32_bf16 v[72:75], a[12:15], a[56:59], 0
  buffer_store_dwordx4 v[160:163], v136, s[4:7], s49 offen sc1
  v_mfma_f32_16x16x32_bf16 v[72:75], a[32:35], a[80:83], v[72:75]
  s_add_u32 s49, s49, 4096
  buffer_load_dwordx4 v125, s[8:11], s69 offen offset:3072  lds
  s_add_u32 m0, s63, 4096
  s_nop 0
  v_mfma_f32_16x16x32_bf16 v[76:79], a[36:39], a[80:83], 0
  buffer_store_dwordx4 v[164:167], v136, s[4:7], s49 offen sc1
  v_mfma_f32_16x16x32_bf16 v[76:79], a[16:19], a[56:59], v[76:79]
  s_add_u32 s49, s49, 4096
  buffer_store_dwordx4 v[168:171], v136, s[4:7], s49 offen sc1
  v_mfma_f32_16x16x32_bf16 v[92:95], a[16:19], a[60:63], 0
  s_add_u32 s49, s49, 4096
  buffer_load_dwordx4 v124, s[8:11], s70 offen offset:0  lds
  v_mfma_f32_16x16x32_bf16 v[92:95], a[36:39], a[84:87], v[92:95]
  v_mfma_f32_16x16x32_bf16 v[88:91], a[32:35], a[84:87], 0
  v_mfma_f32_16x16x32_bf16 v[88:91], a[12:15], a[60:63], v[88:91]
  buffer_load_dwordx4 v125, s[8:11], s70 offen offset:1024  lds
  v_mfma_f32_16x16x32_bf16 v[84:87], a[8:11], a[60:63], 0
  v_mfma_f32_16x16x32_bf16 v[84:87], a[28:31], a[84:87], v[84:87]
  v_mfma_f32_16x16x32_bf16 v[80:83], a[24:27], a[84:87], 0
  v_mfma_f32_16x16x32_bf16 v[80:83], a[4:7], a[60:63], v[80:83]
  s_add_u32 s44, s67, 4
  s_and_b32 s44, s44, 15
  s_mul_i32 s45, s44, s61
  s_add_u32 s68, s45, s59
  s_mov_b32 s66, 5
  s_mov_b32 s56, 2
  s_cmp_eq_u32 s66, s88
  s_cbranch_scc0 Lside_skip9
  s_call_b64 s[78:79], Lside_sub
Lside_skip9:
  s_branch Lp1_u1
  s_branch Lp1_common
Llayer:
  s_cmp_lg_u32 s40, 0
  s_cbranch_scc1 Lpdn2
  s_mov_b32 s43, 0x40000
  s_mov_b64 exec, 15
Lpol1:
  buffer_load_dword v250, v249, s[4:7], s77 offen sc1
  s_waitcnt vmcnt(0)
  v_cmp_gt_u32 vcc, 8, v250
  s_cbranch_vccz Lpdn2x
  s_sub_u32 s43, s43, 1
  s_cmp_lg_u32 s43, 0
  s_cbranch_scc1 Lpol1
Lpdn2x:
  s_mov_b64 exec, -1
Lpdn2:
  s_waitcnt vmcnt(0) lgkmcnt(0)
  s_barrier
  s_add_u32 s44, s67, 0
  s_and_b32 s44, s44, 15
  s_mul_i32 s45, s44, s61
  s_add_u32 s68, s45, s59
  s_add_u32 m0, s62, 73728
  s_nop 0
  buffer_load_dwordx4 v120, s[28:31], s68 offen offset:0 sc1  lds
  buffer_load_dwordx4 v121, s[28:31], s68 offen offset:1024 sc1  lds
  buffer_load_dwordx4 v122, s[28:31], s68 offen offset:2048 sc1  lds
  buffer_load_dwordx4 v123, s[28:31], s68 offen offset:3072 sc1  lds
  s_add_u32 s44, s67, s40
  s_add_u32 s44, s44, 0
  s_and_b32 s44, s44, 15
  s_mul_i32 s44, s44, s61
  s_lshl_b32 s45, s40, 10
  s_add_u32 m0, s45, 122880
  s_add_u32 s44, s44, s73
  buffer_load_dwordx4 v126, s[28:31], s44 offen sc1 lds
  s_add_u32 s44, s67, 1
  s_and_b32 s44, s44, 15
  s_mul_i32 s45, s44, s61
  s_add_u32 s68, s45, s59
  s_add_u32 m0, s62, 90112
  s_nop 0
  buffer_load_dwordx4 v120, s[28:31], s68 offen offset:0 sc1  lds
  buffer_load_dwordx4 v121, s[28:31], s68 offen offset:1024 sc1  lds
  buffer_load_dwordx4 v122, s[28:31], s68 offen offset:2048 sc1  lds
  buffer_load_dwordx4 v123, s[28:31], s68 offen offset:3072 sc1  lds
  ds_read_b64_tr_b16 a[40:41], v116 offset:0
  ds_read_b64_tr_b16 a[42:43], v116 offset:6144
  ds_read_b64_tr_b16 a[64:65], v116 offset:12288
  ds_read_b64_tr_b16 a[66:67], v116 offset:18432
  ds_read_b64_tr_b16 a[44:45], v117 offset:0
  ds_read_b64_tr_b16 a[46:47], v117 offset:6144
  ds_read_b64_tr_b16 a[68:69], v117 offset:12288
  ds_read_b64_tr_b16 a[70:71], v117 offset:18432
  ds_read_b64_tr_b16 a[48:49], v116 offset:2048
  ds_read_b64_tr_b16 a[50:51], v116 offset:8192
  ds_read_b64_tr_b16 a[72:73], v116 offset:14336
  ds_read_b64_tr_b16 a[74:75], v116 offset:20480
  ds_read_b64_tr_b16 a[52:53], v117 offset:2048
  ds_read_b64_tr_b16 a[54:55], v117 offset:8192
  ds_read_b64_tr_b16 a[76:77], v117 offset:14336
  ds_read_b64_tr_b16 a[78:79], v117 offset:20480
  ds_read_b64_tr_b16 a[56:57], v116 offset:4096
  ds_read_b64_tr_b16 a[58:59], v116 offset:10240
  ds_read_b64_tr_b16 a[80:81], v116 offset:16384
  ds_read_b64_tr_b16 a[82:83], v116 offset:22528
  ds_read_b64_tr_b16 a[60:61], v117 offset:4096
  ds_read_b64_tr_b16 a[62:63], v117 offset:10240
  ds_read_b64_tr_b16 a[84:85], v117 offset:16384
  ds_read_b64_tr_b16 a[86:87], v117 offset:22528
  s_waitcnt vmcnt(4)
  s_barrier
  ds_read_b128 a[4:7], v112 offset:0
  ds_read_b128 a[24:27], v113 offset:0
  ds_read_b128 a[8:11], v112 offset:2048
  ds_read_b128 a[28:31], v113 offset:2048
  ds_read_b128 a[12:15], v112 offset:4096
  ds_read_b128 a[32:35], v113 offset:4096
  ds_read_b128 a[16:19], v112 offset:6144
  ds_read_b128 a[36:39], v113 offset:6144
  ds_read_b128 a[0:3], v114 offset:0
  ds_read_b128 a[20:23], v115 offset:0
  s_add_u32 s44, s67, s40
  s_add_u32 s44, s44, 4
  s_and_b32 s44, s44, 15
  s_mul_i32 s44, s44, s61
  s_lshl_b32 s45, s40, 10
  s_add_u32 m0, s45, 126976
  s_add_u32 s44, s44, s73
  buffer_load_dwordx4 v126, s[28:31], s44 offen sc1 lds
  s_add_u32 s44, s67, s40
  s_add_u32 s44, s44, 8
  s_and_b32 s44, s44, 15
  s_mul_i32 s44, s44, s61
  s_lshl_b32 s45, s40, 10
  s_add_u32 m0, s45, 131072
  s_add_u32 s44, s44, s73
  buffer_load_dwordx4 v126, s[28:31], s44 offen sc1 lds
  s_add_u32 s44, s67, s40
  s_add_u32 s44, s44, 12
  s_and_b32 s44, s44, 15
  s_mul_i32 s44, s44, s61
  s_lshl_b32 s45, s40, 10
  s_add_u32 m0, s45, 135168
  s_add_u32 s44, s44, s73
  buffer_load_dwordx4 v126, s[28:31], s44 offen sc1 lds
  s_add_u32 s44, s67, 2
  s_and_b32 s44, s44, 15
  s_mul_i32 s45, s44, s61
  s_add_u32 s68, s45, s59
  s_add_u32 m0, s62, 106496
  s_nop 0
  buffer_load_dwordx4 v120, s[28:31], s68 offen offset:0 sc1  lds
  buffer_load_dwordx4 v121, s[28:31], s68 offen offset:1024 sc1  lds
  buffer_load_dwordx4 v122, s[28:31], s68 offen offset:2048 sc1  lds
  buffer_load_dwordx4 v123, s[28:31], s68 offen offset:3072 sc1  lds
  s_waitcnt lgkmcnt(0)
Lp1_common:
  s_mov_b32 s66, 4
  s_add_u32 s44, s67, 3
  s_and_b32 s44, s44, 15
  s_mul_i32 s45, s44, s61
  s_add_u32 s68, s45, s59
  s_mov_b32 s56, 2
.p2align 3
Lp1_loop:
  s_waitcnt lgkmcnt(15)
  v_mfma_f32_16x16x32_bf16 v[0:3], a[40:43], a[4:7], v[0:3]
  s_mul_i32 s45, s44, 393216
  v_mfma_f32_16x16x32_bf16 v[0:3], a[64:67], a[24:27], v[0:3]
  s_add_u32 s69, s45, s60
  v_mfma_f32_16x16x32_bf16 v[4:7], a[64:67], a[28:31], v[4:7]
  s_add_u32 s70, s69, 4096
  v_mfma_f32_16x16x32_bf16 v[4:7], a[40:43], a[8:11], v[4:7]
  v_mfma_f32_16x16x32_bf16 v[8:11], a[40:43], a[12:15], v[8:11]
  v_mfma_f32_16x16x32_bf16 v[8:11], a[64:67], a[32:35], v[8:11]
  v_mfma_f32_16x16x32_bf16 v[12:15], a[64:67], a[36:39], v[12:15]
  v_mfma_f32_16x16x32_bf16 v[12:15], a[40:43], a[16:19], v[12:15]
  v_mfma_f32_16x16x32_bf16 v[28:31], a[44:47], a[16:19], v[28:31]
  v_mfma_f32_16x16x32_bf16 v[28:31], a[68:71], a[36:39], v[28:31]
  v_mfma_f32_16x16x32_bf16 v[24:27], a[68:71], a[32:35], v[24:27]
  s_waitcnt vmcnt(7) lgkmcnt(0)
  s_barrier
  ds_read_b64_tr_b16 a[128:129], v116 offset:24576
  v_mfma_f32_16x16x32_bf16 v[24:27], a[44:47], a[12:15], v[24:27]
  s_add_u32 m0, s62, 73728
  ds_read_b64_tr_b16 a[130:131], v116 offset:30720
  v_mfma_f32_16x16x32_bf16 v[20:23], a[44:47], a[8:11], v[20:23]
  ds_read_b64_tr_b16 a[152:153], v116 offset:36864
  buffer_load_dwordx4 v120, s[28:31], s68 offen offset:0 sc1  lds
  v_mfma_f32_16x16x32_bf16 v[20:23], a[68:71], a[28:31], v[20:23]
  ds_read_b64_tr_b16 a[154:155], v116 offset:43008
  v_mfma_f32_16x16x32_bf16 v[16:19], a[68:71], a[24:27], v[16:19]
  ds_read_b128 a[92:95], v112 offset:16384
  v_mfma_f32_16x16x32_bf16 v[16:19], a[44:47], a[4:7], v[16:19]
  ds_read_b128 a[112:115], v113 offset:16384
  v_mfma_f32_16x16x32_bf16 v[96:99], a[48:51], a[0:3], v[96:99]
  ds_read_b128 a[96:99], v112 offset:18432
  buffer_load_dwordx4 v121, s[28:31], s68 offen offset:1024 sc1  lds
  v_mfma_f32_16x16x32_bf16 v[96:99], a[72:75], a[20:23], v[96:99]
  ds_read_b128 a[116:119], v113 offset:18432
  v_mfma_f32_16x16x32_bf16 v[32:35], a[72:75], a[24:27], v[32:35]
  ds_read_b128 a[100:103], v112 offset:20480
  v_mfma_f32_16x16x32_bf16 v[32:35], a[48:51], a[4:7], v[32:35]
  ds_read_b128 a[120:123], v113 offset:20480
  v_mfma_f32_16x16x32_bf16 v[36:39], a[48:51], a[8:11], v[36:39]
  ds_read_b128 a[104:107], v112 offset:22528
  buffer_load_dwordx4 v122, s[28:31], s68 offen offset:2048 sc1  lds
  v_mfma_f32_16x16x32_bf16 v[36:39], a[72:75], a[28:31], v[36:39]
  ds_read_b128 a[124:127], v113 offset:22528
  v_mfma_f32_16x16x32_bf16 v[40:43], a[72:75], a[32:35], v[40:43]
  ds_read_b64_tr_b16 a[132:133], v117 offset:24576
  v_mfma_f32_16x16x32_bf16 v[40:43], a[48:51], a[12:15], v[40:43]
  ds_read_b64_tr_b16 a[134:135], v117 offset:30720
  v_mfma_f32_16x16x32_bf16 v[44:47], a[48:51], a[16:19], v[44:47]
  ds_read_b64_tr_b16 a[156:157], v117 offset:36864
  buffer_load_dwordx4 v123, s[28:31], s68 offen offset:3072 sc1  lds
  v_mfma_f32_16x16x32_bf16 v[44:47], a[72:75], a[36:39], v[44:47]
  ds_read_b64_tr_b16 a[158:159], v117 offset:43008
  v_mfma_f32_16x16x32_bf16 v[60:63], a[76:79], a[36:39], v[60:63]
  ds_read_b128 a[88:91], v114 offset:1024
  v_mfma_f32_16x16x32_bf16 v[60:63], a[52:55], a[16:19], v[60:63]
  s_add_u32 m0, s63, 0
  ds_read_b128 a[108:111], v115 offset:1024
  v_mfma_f32_16x16x32_bf16 v[56:59], a[52:55], a[12:15], v[56:59]
  ds_read_b64_tr_b16 a[136:137], v116 offset:26624
  buffer_load_dwordx4 v124, s[8:11], s69 offen offset:0  lds
  v_mfma_f32_16x16x32_bf16 v[56:59], a[76:79], a[32:35], v[56:59]
  ds_read_b64_tr_b16 a[138:139], v116 offset:32768
  v_mfma_f32_16x16x32_bf16 v[52:55], a[76:79], a[28:31], v[52:55]
  s_add_u32 s44, s44, 1
  ds_read_b64_tr_b16 a[160:161], v116 offset:38912
  v_mfma_f32_16x16x32_bf16 v[52:55], a[52:55], a[8:11], v[52:55]
  s_and_b32 s44, s44, 15
  ds_read_b64_tr_b16 a[162:163], v116 offset:45056
  v_mfma_f32_16x16x32_bf16 v[48:51], a[52:55], a[4:7], v[48:51]
  s_add_u32 s66, s66, 1
  ds_read_b64_tr_b16 a[140:141], v117 offset:26624
  buffer_load_dwordx4 v125, s[8:11], s69 offen offset:1024  lds
  v_mfma_f32_16x16x32_bf16 v[48:51], a[76:79], a[24:27], v[48:51]
  s_mul_i32 s45, s44, s61
  ds_read_b64_tr_b16 a[142:143], v117 offset:32768
  v_mfma_f32_16x16x32_bf16 v[100:103], a[20:23], a[80:83], v[100:103]
  s_add_u32 s68, s45, s59
  ds_read_b64_tr_b16 a[164:165], v117 offset:38912
  v_mfma_f32_16x16x32_bf16 v[100:103], a[0:3], a[56:59], v[100:103]
  ds_read_b64_tr_b16 a[166:167], v117 offset:45056
  v_mfma_f32_16x16x32_bf16 v[64:67], a[4:7], a[56:59], v[64:67]
  ds_read_b64_tr_b16 a[144:145], v116 offset:28672
  buffer_load_dwordx4 v124, s[8:11], s69 offen offset:2048  lds
  v_mfma_f32_16x16x32_bf16 v[64:67], a[24:27], a[80:83], v[64:67]
  ds_read_b64_tr_b16 a[146:147], v116 offset:34816
  v_mfma_f32_16x16x32_bf16 v[68:71], a[28:31], a[80:83], v[68:71]
  ds_read_b64_tr_b16 a[168:169], v116 offset:40960
  v_mfma_f32_16x16x32_bf16 v[68:71], a[8:11], a[56:59], v[68:71]
  ds_read_b64_tr_b16 a[170:171], v116 offset:47104
  v_mfma_f32_16x16x32_bf16 v[72:75], a[12:15], a[56:59], v[72:75]
  ds_read_b64_tr_b16 a[148:149], v117 offset:28672
  buffer_load_dwordx4 v125, s[8:11], s69 offen offset:3072  lds
  v_mfma_f32_16x16x32_bf16 v[72:75], a[32:35], a[80:83], v[72:75]
  ds_read_b64_tr_b16 a[150:151], v117 offset:34816
  v_mfma_f32_16x16x32_bf16 v[76:79], a[36:39], a[80:83], v[76:79]
  ds_read_b64_tr_b16 a[172:173], v117 offset:40960
  v_mfma_f32_16x16x32_bf16 v[76:79], a[16:19], a[56:59], v[76:79]
  s_add_u32 m0, s63, 4096
  ds_read_b64_tr_b16 a[174:175], v117 offset:47104
  v_mfma_f32_16x16x32_bf16 v[92:95], a[16:19], a[60:63], v[92:95]
  buffer_load_dwordx4 v124, s[8:11], s70 offen offset:0  lds
  v_mfma_f32_16x16x32_bf16 v[92:95], a[36:39], a[84:87], v[92:95]
  v_mfma_f32_16x16x32_bf16 v[88:91], a[32:35], a[84:87], v[88:91]
  v_mfma_f32_16x16x32_bf16 v[88:91], a[12:15], a[60:63], v[88:91]
  v_mfma_f32_16x16x32_bf16 v[84:87], a[8:11], a[60:63], v[84:87]
  buffer_load_dwordx4 v125, s[8:11], s70 offen offset:1024  lds
  v_mfma_f32_16x16x32_bf16 v[84:87], a[28:31], a[84:87], v[84:87]
  v_mfma_f32_16x16x32_bf16 v[80:83], a[24:27], a[84:87], v[80:83]
  v_mfma_f32_16x16x32_bf16 v[80:83], a[4:7], a[60:63], v[80:83]
  s_cmp_eq_u32 s66, s88
  s_cbranch_scc0 Lside_skip0
  s_call_b64 s[78:79], Lside_sub
Lside_skip0:
Lp1_u1:
  s_waitcnt lgkmcnt(15)
  v_mfma_f32_16x16x32_bf16 v[0:3], a[128:131], a[92:95], v[0:3]
  s_mul_i32 s45, s44, 393216
  v_mfma_f32_16x16x32_bf16 v[0:3], a[152:155], a[112:115], v[0:3]
  s_add_u32 s69, s45, s60
  v_mfma_f32_16x16x32_bf16 v[4:7], a[152:155], a[116:119], v[4:7]
  s_add_u32 s70, s69, 4096
  v_mfma_f32_16x16x32_bf16 v[4:7], a[128:131], a[96:99], v[4:7]
  v_mfma_f32_16x16x32_bf16 v[8:11], a[128:131], a[100:103], v[8:11]
  v_mfma_f32_16x16x32_bf16 v[8:11], a[152:155], a[120:123], v[8:11]
  v_mfma_f32_16x16x32_bf16 v[12:15], a[152:155], a[124:127], v[12:15]
  v_mfma_f32_16x16x32_bf16 v[12:15], a[128:131], a[104:107], v[12:15]
  v_mfma_f32_16x16x32_bf16 v[28:31], a[132:135], a[104:107], v[28:31]
  v_mfma_f32_16x16x32_bf16 v[28:31], a[156:159], a[124:127], v[28:31]
  v_mfma_f32_16x16x32_bf16 v[24:27], a[156:159], a[120:123], v[24:27]
  s_waitcnt vmcnt(10) lgkmcnt(0)
  s_barrier
  ds_read_b64_tr_b16 a[40:41], v118 offset:0
  v_mfma_f32_16x16x32_bf16 v[24:27], a[132:135], a[100:103], v[24:27]
  s_add_u32 m0, s62, 90112
  ds_read_b64_tr_b16 a[42:43], v118 offset:6144
  v_mfma_f32_16x16x32_bf16 v[20:23], a[132:135], a[96:99], v[20:23]
  ds_read_b64_tr_b16 a[64:65], v118 offset:12288
  buffer_load_dwordx4 v120, s[28:31], s68 offen offset:0 sc1  lds
  v_mfma_f32_16x16x32_bf16 v[20:23], a[156:159], a[116:119], v[20:23]
  ds_read_b64_tr_b16 a[66:67], v118 offset:18432
  v_mfma_f32_16x16x32_bf16 v[16:19], a[156:159], a[112:115], v[16:19]
  ds_read_b128 a[4:7], v112 offset:32768
  v_mfma_f32_16x16x32_bf16 v[16:19], a[132:135], a[92:95], v[16:19]
  ds_read_b128 a[24:27], v113 offset:32768
  v_mfma_f32_16x16x32_bf16 v[96:99], a[136:139], a[88:91], v[96:99]
  ds_read_b128 a[8:11], v112 offset:34816
  buffer_load_dwordx4 v121, s[28:31], s68 offen offset:1024 sc1  lds
  v_mfma_f32_16x16x32_bf16 v[96:99], a[160:163], a[108:111], v[96:99]
  ds_read_b128 a[28:31], v113 offset:34816
  v_mfma_f32_16x16x32_bf16 v[32:35], a[160:163], a[112:115], v[32:35]
  ds_read_b128 a[12:15], v112 offset:36864
  v_mfma_f32_16x16x32_bf16 v[32:35], a[136:139], a[92:95], v[32:35]
  ds_read_b128 a[32:35], v113 offset:36864
  v_mfma_f32_16x16x32_bf16 v[36:39], a[136:139], a[96:99], v[36:39]
  ds_read_b128 a[16:19], v112 offset:38912
  buffer_load_dwordx4 v122, s[28:31], s68 offen offset:2048 sc1  lds
  v_mfma_f32_16x16x32_bf16 v[36:39], a[160:163], a[116:119], v[36:39]
  ds_read_b128 a[36:39], v113 offset:38912
  v_mfma_f32_16x16x32_bf16 v[40:43], a[160:163], a[120:123], v[40:43]
  ds_read_b64_tr_b16 a[44:45], v119 offset:0
  v_mfma_f32_16x16x32_bf16 v[40:43], a[136:139], a[100:103], v[40:43]
  ds_read_b64_tr_b16 a[46:47], v119 offset:6144
  v_mfma_f32_16x16x32_bf16 v[44:47], a[136:139], a[104:107], v[44:47]
  ds_read_b64_tr_b16 a[68:69], v119 offset:12288
  buffer_load_dwordx4 v123, s[28:31], s68 offen offset:3072 sc1  lds
  v_mfma_f32_16x16x32_bf16 v[44:47], a[160:163], a[124:127], v[44:47]
  ds_read_b64_tr_b16 a[70:71], v119 offset:18432
  v_mfma_f32_16x16x32_bf16 v[60:63], a[164:167], a[124:127], v[60:63]
  ds_read_b128 a[0:3], v114 offset:2048
  v_mfma_f32_16x16x32_bf16 v[60:63], a[140:143], a[104:107], v[60:63]
  s_add_u32 m0, s63, 24576
  ds_read_b128 a[20:23], v115 offset:2048
  v_mfma_f32_16x16x32_bf16 v[56:59], a[140:143], a[100:103], v[56:59]
  ds_read_b64_tr_b16 a[48:49], v118 offset:2048
  buffer_load_dwordx4 v124, s[8:11], s69 offen offset:0  lds
  v_mfma_f32_16x16x32_bf16 v[56:59], a[164:167], a[120:123], v[56:59]
  ds_read_b64_tr_b16 a[50:51], v118 offset:8192
  v_mfma_f32_16x16x32_bf16 v[52:55], a[164:167], a[116:119], v[52:55]
  s_add_u32 s44, s44, 1
  ds_read_b64_tr_b16 a[72:73], v118 offset:14336
  v_mfma_f32_16x16x32_bf16 v[52:55], a[140:143], a[96:99], v[52:55]
  s_and_b32 s44, s44, 15
  ds_read_b64_tr_b16 a[74:75], v118 offset:20480
  v_mfma_f32_16x16x32_bf16 v[48:51], a[140:143], a[92:95], v[48:51]
  s_add_u32 s66, s66, 1
  ds_read_b64_tr_b16 a[52:53], v119 offset:2048
  buffer_load_dwordx4 v125, s[8:11], s69 offen offset:1024  lds
  v_mfma_f32_16x16x32_bf16 v[48:51], a[164:167], a[112:115], v[48:51]
  s_mul_i32 s45, s44, s61
  ds_read_b64_tr_b16 a[54:55], v119 offset:8192
  v_mfma_f32_16x16x32_bf16 v[100:103], a[108:111], a[168:171], v[100:103]
  s_add_u32 s68, s45, s59
  ds_read_b64_tr_b16 a[76:77], v119 offset:14336
  v_mfma_f32_16x16x32_bf16 v[100:103], a[88:91], a[144:147], v[100:103]
  ds_read_b64_tr_b16 a[78:79], v119 offset:20480
  v_mfma_f32_16x16x32_bf16 v[64:67], a[92:95], a[144:147], v[64:67]
  ds_read_b64_tr_b16 a[56:57], v118 offset:4096
  buffer_load_dwordx4 v124, s[8:11], s69 offen offset:2048  lds
  v_mfma_f32_16x16x32_bf16 v[64:67], a[112:115], a[168:171], v[64:67]
  ds_read_b64_tr_b16 a[58:59], v118 offset:10240
  v_mfma_f32_16x16x32_bf16 v[68:71], a[116:119], a[168:171], v[68:71]
  ds_read_b64_tr_b16 a[80:81], v118 offset:16384
  v_mfma_f32_16x16x32_bf16 v[68:71], a[96:99], a[144:147], v[68:71]
  ds_read_b64_tr_b16 a[82:83], v118 offset:22528
  v_mfma_f32_16x16x32_bf16 v[72:75], a[100:103], a[144:147], v[72:75]
  ds_read_b64_tr_b16 a[60:61], v119 offset:4096
  buffer_load_dwordx4 v125, s[8:11], s69 offen offset:3072  lds
  v_mfma_f32_16x16x32_bf16 v[72:75], a[120:123], a[168:171], v[72:75]
  ds_read_b64_tr_b16 a[62:63], v119 offset:10240
  v_mfma_f32_16x16x32_bf16 v[76:79], a[124:127], a[168:171], v[76:79]
  ds_read_b64_tr_b16 a[84:85], v119 offset:16384
  v_mfma_f32_16x16x32_bf16 v[76:79], a[104:107], a[144:147], v[76:79]
  s_add_u32 m0, s63, 28672
  ds_read_b64_tr_b16 a[86:87], v119 offset:22528
  v_mfma_f32_16x16x32_bf16 v[92:95], a[104:107], a[148:151], v[92:95]
  buffer_load_dwordx4 v124, s[8:11], s70 offen offset:0  lds
  v_mfma_f32_16x16x32_bf16 v[92:95], a[124:127], a[172:175], v[92:95]
  v_mfma_f32_16x16x32_bf16 v[88:91], a[120:123], a[172:175], v[88:91]
  v_mfma_f32_16x16x32_bf16 v[88:91], a[100:103], a[148:151], v[88:91]
  v_mfma_f32_16x16x32_bf16 v[84:87], a[96:99], a[148:151], v[84:87]
  buffer_load_dwordx4 v125, s[8:11], s70 offen offset:1024  lds
  v_mfma_f32_16x16x32_bf16 v[84:87], a[116:119], a[172:175], v[84:87]
  v_mfma_f32_16x16x32_bf16 v[80:83], a[112:115], a[172:175], v[80:83]
  v_mfma_f32_16x16x32_bf16 v[80:83], a[92:95], a[148:151], v[80:83]
  s_cmp_eq_u32 s66, s88
  s_cbranch_scc0 Lside_skip1
  s_call_b64 s[78:79], Lside_sub
Lside_skip1:
  s_waitcnt lgkmcnt(15)
  v_mfma_f32_16x16x32_bf16 v[0:3], a[40:43], a[4:7], v[0:3]
  s_mul_i32 s45, s44, 393216
  v_mfma_f32_16x16x32_bf16 v[0:3], a[64:67], a[24:27], v[0:3]
  s_add_u32 s69, s45, s60
  v_mfma_f32_16x16x32_bf16 v[4:7], a[64:67], a[28:31], v[4:7]
  s_add_u32 s70, s69, 4096
  v_mfma_f32_16x16x32_bf16 v[4:7], a[40:43], a[8:11], v[4:7]
  v_mfma_f32_16x16x32_bf16 v[8:11], a[40:43], a[12:15], v[8:11]
  v_mfma_f32_16x16x32_bf16 v[8:11], a[64:67], a[32:35], v[8:11]
  v_mfma_f32_16x16x32_bf16 v[12:15], a[64:67], a[36:39], v[12:15]
  v_mfma_f32_16x16x32_bf16 v[12:15], a[40:43], a[16:19], v[12:15]
  v_mfma_f32_16x16x32_bf16 v[28:31], a[44:47], a[16:19], v[28:31]
  v_mfma_f32_16x16x32_bf16 v[28:31], a[68:71], a[36:39], v[28:31]
  v_mfma_f32_16x16x32_bf16 v[24:27], a[68:71], a[32:35], v[24:27]
  s_waitcnt vmcnt(10) lgkmcnt(0)
  s_barrier
  ds_read_b64_tr_b16 a[128:129], v116 offset:0
  v_mfma_f32_16x16x32_bf16 v[24:27], a[44:47], a[12:15], v[24:27]
  s_add_u32 m0, s62, 106496
  ds_read_b64_tr_b16 a[130:131], v116 offset:6144
  v_mfma_f32_16x16x32_bf16 v[20:23], a[44:47], a[8:11], v[20:23]
  ds_read_b64_tr_b16 a[152:153], v116 offset:12288
  buffer_load_dwordx4 v120, s[28:31], s68 offen offset:0 sc1  lds
  v_mfma_f32_16x16x32_bf16 v[20:23], a[68:71], a[28:31], v[20:23]
  ds_read_b64_tr_b16 a[154:155], v116 offset:18432
  v_mfma_f32_16x16x32_bf16 v[16:19], a[68:71], a[24:27], v[16:19]
  ds_read_b128 a[92:95], v112 offset:0
  v_mfma_f32_16x16x32_bf16 v[16:19], a[44:47], a[4:7], v[16:19]
  ds_read_b128 a[112:115], v113 offset:0
  v_mfma_f32_16x16x32_bf16 v[96:99], a[48:51], a[0:3], v[96:99]
  ds_read_b128 a[96:99], v112 offset:2048
  buffer_load_dwordx4 v121, s[28:31], s68 offen offset:1024 sc1  lds
  v_mfma_f32_16x16x32_bf16 v[96:99], a[72:75], a[20:23], v[96:99]
  ds_read_b128 a[116:119], v113 offset:2048
  v_mfma_f32_16x16x32_bf16 v[32:35], a[72:75], a[24:27], v[32:35]
  ds_read_b128 a[100:103], v112 offset:4096
  v_mfma_f32_16x16x32_bf16 v[32:35], a[48:51], a[4:7], v[32:35]
  ds_read_b128 a[120:123], v113 offset:4096
  v_mfma_f32_16x16x32_bf16 v[36:39], a[48:51], a[8:11], v[36:39]
  ds_read_b128 a[104:107], v112 offset:6144
  buffer_load_dwordx4 v122, s[28:31], s68 offen offset:2048 sc1  lds
  v_mfma_f32_16x16x32_bf16 v[36:39], a[72:75], a[28:31], v[36:39]
  ds_read_b128 a[124:127], v113 offset:6144
  v_mfma_f32_16x16x32_bf16 v[40:43], a[72:75], a[32:35], v[40:43]
  ds_read_b64_tr_b16 a[132:133], v117 offset:0
  v_mfma_f32_16x16x32_bf16 v[40:43], a[48:51], a[12:15], v[40:43]
  ds_read_b64_tr_b16 a[134:135], v117 offset:6144
  v_mfma_f32_16x16x32_bf16 v[44:47], a[48:51], a[16:19], v[44:47]
  ds_read_b64_tr_b16 a[156:157], v117 offset:12288
  buffer_load_dwordx4 v123, s[28:31], s68 offen offset:3072 sc1  lds
  v_mfma_f32_16x16x32_bf16 v[44:47], a[72:75], a[36:39], v[44:47]
  ds_read_b64_tr_b16 a[158:159], v117 offset:18432
  v_mfma_f32_16x16x32_bf16 v[60:63], a[76:79], a[36:39], v[60:63]
  ds_read_b128 a[88:91], v114 offset:3072
  v_mfma_f32_16x16x32_bf16 v[60:63], a[52:55], a[16:19], v[60:63]
  s_add_u32 m0, s63, 49152
  ds_read_b128 a[108:111], v115 offset:3072
  v_mfma_f32_16x16x32_bf16 v[56:59], a[52:55], a[12:15], v[56:59]
  ds_read_b64_tr_b16 a[136:137], v116 offset:2048
  buffer_load_dwordx4 v124, s[8:11], s69 offen offset:0  lds
  v_mfma_f32_16x16x32_bf16 v[56:59], a[76:79], a[32:35], v[56:59]
  ds_read_b64_tr_b16 a[138:139], v116 offset:8192
  v_mfma_f32_16x16x32_bf16 v[52:55], a[76:79], a[28:31], v[52:55]
  s_add_u32 s44, s44, 1
  ds_read_b64_tr_b16 a[160:161], v116 offset:14336
  v_mfma_f32_16x16x32_bf16 v[52:55], a[52:55], a[8:11], v[52:55]
  s_and_b32 s44, s44, 15
  ds_read_b64_tr_b16 a[162:163], v116 offset:20480
  v_mfma_f32_16x16x32_bf16 v[48:51], a[52:55], a[4:7], v[48:51]
  s_add_u32 s66, s66, 1
  ds_read_b64_tr_b16 a[140:141], v117 offset:2048
  buffer_load_dwordx4 v125, s[8:11], s69 offen offset:1024  lds
  v_mfma_f32_16x16x32_bf16 v[48:51], a[76:79], a[24:27], v[48:51]
  s_mul_i32 s45, s44, s61
  ds_read_b64_tr_b16 a[142:143], v117 offset:8192
  v_mfma_f32_16x16x32_bf16 v[100:103], a[20:23], a[80:83], v[100:103]
  s_add_u32 s68, s45, s59
  ds_read_b64_tr_b16 a[164:165], v117 offset:14336
  v_mfma_f32_16x16x32_bf16 v[100:103], a[0:3], a[56:59], v[100:103]
  ds_read_b64_tr_b16 a[166:167], v117 offset:20480
  v_mfma_f32_16x16x32_bf16 v[64:67], a[4:7], a[56:59], v[64:67]
  ds_read_b64_tr_b16 a[144:145], v116 offset:4096
  buffer_load_dwordx4 v124, s[8:11], s69 offen offset:2048  lds
  v_mfma_f32_16x16x32_bf16 v[64:67], a[24:27], a[80:83], v[64:67]
  ds_read_b64_tr_b16 a[146:147], v116 offset:10240
  v_mfma_f32_16x16x32_bf16 v[68:71], a[28:31], a[80:83], v[68:71]
  ds_read_b64_tr_b16 a[168:169], v116 offset:16384
  v_mfma_f32_16x16x32_bf16 v[68:71], a[8:11], a[56:59], v[68:71]
  ds_read_b64_tr_b16 a[170:171], v116 offset:22528
  v_mfma_f32_16x16x32_bf16 v[72:75], a[12:15], a[56:59], v[72:75]
  ds_read_b64_tr_b16 a[148:149], v117 offset:4096
  buffer_load_dwordx4 v125, s[8:11], s69 offen offset:3072  lds
  v_mfma_f32_16x16x32_bf16 v[72:75], a[32:35], a[80:83], v[72:75]
  ds_read_b64_tr_b16 a[150:151], v117 offset:10240
  v_mfma_f32_16x16x32_bf16 v[76:79], a[36:39], a[80:83], v[76:79]
  ds_read_b64_tr_b16 a[172:173], v117 offset:16384
  v_mfma_f32_16x16x32_bf16 v[76:79], a[16:19], a[56:59], v[76:79]
  s_add_u32 m0, s63, 53248
  ds_read_b64_tr_b16 a[174:175], v117 offset:22528
  v_mfma_f32_16x16x32_bf16 v[92:95], a[16:19], a[60:63], v[92:95]
  buffer_load_dwordx4 v124, s[8:11], s70 offen offset:0  lds
  v_mfma_f32_16x16x32_bf16 v[92:95], a[36:39], a[84:87], v[92:95]
  v_mfma_f32_16x16x32_bf16 v[88:91], a[32:35], a[84:87], v[88:91]
  v_mfma_f32_16x16x32_bf16 v[88:91], a[12:15], a[60:63], v[88:91]
  v_mfma_f32_16x16x32_bf16 v[84:87], a[8:11], a[60:63], v[84:87]
  buffer_load_dwordx4 v125, s[8:11], s70 offen offset:1024  lds
  v_mfma_f32_16x16x32_bf16 v[84:87], a[28:31], a[84:87], v[84:87]
  v_mfma_f32_16x16x32_bf16 v[80:83], a[24:27], a[84:87], v[80:83]
  v_mfma_f32_16x16x32_bf16 v[80:83], a[4:7], a[60:63], v[80:83]
  s_cmp_eq_u32 s66, s88
  s_cbranch_scc0 Lside_skip2
  s_call_b64 s[78:79], Lside_sub
Lside_skip2:
  s_waitcnt lgkmcnt(15)
  v_mfma_f32_16x16x32_bf16 v[0:3], a[128:131], a[92:95], v[0:3]
  s_mul_i32 s45, s44, 393216
  v_mfma_f32_16x16x32_bf16 v[0:3], a[152:155], a[112:115], v[0:3]
  s_add_u32 s69, s45, s60
  v_mfma_f32_16x16x32_bf16 v[4:7], a[152:155], a[116:119], v[4:7]
  s_add_u32 s70, s69, 4096
  v_mfma_f32_16x16x32_bf16 v[4:7], a[128:131], a[96:99], v[4:7]
  v_mfma_f32_16x16x32_bf16 v[8:11], a[128:131], a[100:103], v[8:11]
  v_mfma_f32_16x16x32_bf16 v[8:11], a[152:155], a[120:123], v[8:11]
  v_mfma_f32_16x16x32_bf16 v[12:15], a[152:155], a[124:127], v[12:15]
  v_mfma_f32_16x16x32_bf16 v[12:15], a[128:131], a[104:107], v[12:15]
  v_mfma_f32_16x16x32_bf16 v[28:31], a[132:135], a[104:107], v[28:31]
  v_mfma_f32_16x16x32_bf16 v[28:31], a[156:159], a[124:127], v[28:31]
  v_mfma_f32_16x16x32_bf16 v[24:27], a[156:159], a[120:123], v[24:27]
  s_waitcnt vmcnt(10) lgkmcnt(0)
  s_barrier
  ds_read_b64_tr_b16 a[40:41], v116 offset:24576
  v_mfma_f32_16x16x32_bf16 v[24:27], a[132:135], a[100:103], v[24:27]
  s_add_u32 m0, s62, 73728
  ds_read_b64_tr_b16 a[42:43], v116 offset:30720
  v_mfma_f32_16x16x32_bf16 v[20:23], a[132:135], a[96:99], v[20:23]
  ds_read_b64_tr_b16 a[64:65], v116 offset:36864
  buffer_load_dwordx4 v120, s[28:31], s68 offen offset:0 sc1  lds
  v_mfma_f32_16x16x32_bf16 v[20:23], a[156:159], a[116:119], v[20:23]
  ds_read_b64_tr_b16 a[66:67], v116 offset:43008
  v_mfma_f32_16x16x32_bf16 v[16:19], a[156:159], a[112:115], v[16:19]
  ds_read_b128 a[4:7], v112 offset:16384
  v_mfma_f32_16x16x32_bf16 v[16:19], a[132:135], a[92:95], v[16:19]
  ds_read_b128 a[24:27], v113 offset:16384
  v_mfma_f32_16x16x32_bf16 v[96:99], a[136:139], a[88:91], v[96:99]
  ds_read_b128 a[8:11], v112 offset:18432
  buffer_load_dwordx4 v121, s[28:31], s68 offen offset:1024 sc1  lds
  v_mfma_f32_16x16x32_bf16 v[96:99], a[160:163], a[108:111], v[96:99]
  ds_read_b128 a[28:31], v113 offset:18432
  v_mfma_f32_16x16x32_bf16 v[32:35], a[160:163], a[112:115], v[32:35]
  ds_read_b128 a[12:15], v112 offset:20480
  v_mfma_f32_16x16x32_bf16 v[32:35], a[136:139], a[92:95], v[32:35]
  ds_read_b128 a[32:35], v113 offset:20480
  v_mfma_f32_16x16x32_bf16 v[36:39], a[136:139], a[96:99], v[36:39]
  ds_read_b128 a[16:19], v112 offset:22528
  buffer_load_dwordx4 v122, s[28:31], s68 offen offset:2048 sc1  lds
  v_mfma_f32_16x16x32_bf16 v[36:39], a[160:163], a[116:119], v[36:39]
  ds_read_b128 a[36:39], v113 offset:22528
  v_mfma_f32_16x16x32_bf16 v[40:43], a[160:163], a[120:123], v[40:43]
  ds_read_b64_tr_b16 a[44:45], v117 offset:24576
  v_mfma_f32_16x16x32_bf16 v[40:43], a[136:139], a[100:103], v[40:43]
  ds_read_b64_tr_b16 a[46:47], v117 offset:30720
  v_mfma_f32_16x16x32_bf16 v[44:47], a[136:139], a[104:107], v[44:47]
  ds_read_b64_tr_b16 a[68:69], v117 offset:36864
  buffer_load_dwordx4 v123, s[28:31], s68 offen offset:3072 sc1  lds
  v_mfma_f32_16x16x32_bf16 v[44:47], a[160:163], a[124:127], v[44:47]
  ds_read_b64_tr_b16 a[70:71], v117 offset:43008
  v_mfma_f32_16x16x32_bf16 v[60:63], a[164:167], a[124:127], v[60:63]
  ds_read_b128 a[0:3], v114 offset:4096
  v_mfma_f32_16x16x32_bf16 v[60:63], a[140:143], a[104:107], v[60:63]
  s_add_u32 m0, s63, 0
  ds_read_b128 a[20:23], v115 offset:4096
  v_mfma_f32_16x16x32_bf16 v[56:59], a[140:143], a[100:103], v[56:59]
  ds_read_b64_tr_b16 a[48:49], v116 offset:26624
  buffer_load_dwordx4 v124, s[8:11], s69 offen offset:0  lds
  v_mfma_f32_16x16x32_bf16 v[56:59], a[164:167], a[120:123], v[56:59]
  ds_read_b64_tr_b16 a[50:51], v116 offset:32768
  v_mfma_f32_16x16x32_bf16 v[52:55], a[164:167], a[116:119], v[52:55]
  s_add_u32 s44, s44, 1
  ds_read_b64_tr_b16 a[72:73], v116 offset:38912
  v_mfma_f32_16x16x32_bf16 v[52:55], a[140:143], a[96:99], v[52:55]
  s_and_b32 s44, s44, 15
  ds_read_b64_tr_b16 a[74:75], v116 offset:45056
  v_mfma_f32_16x16x32_bf16 v[48:51], a[140:143], a[92:95], v[48:51]
  s_add_u32 s66, s66, 1
  ds_read_b64_tr_b16 a[52:53], v117 offset:26624
  buffer_load_dwordx4 v125, s[8:11], s69 offen offset:1024  lds
  v_mfma_f32_16x16x32_bf16 v[48:51], a[164:167], a[112:115], v[48:51]
  s_mul_i32 s45, s44, s61
  ds_read_b64_tr_b16 a[54:55], v117 offset:32768
  v_mfma_f32_16x16x32_bf16 v[100:103], a[108:111], a[168:171], v[100:103]
  s_add_u32 s68, s45, s59
  ds_read_b64_tr_b16 a[76:77], v117 offset:38912
  v_mfma_f32_16x16x32_bf16 v[100:103], a[88:91], a[144:147], v[100:103]
  ds_read_b64_tr_b16 a[78:79], v117 offset:45056
  v_mfma_f32_16x16x32_bf16 v[64:67], a[92:95], a[144:147], v[64:67]
  ds_read_b64_tr_b16 a[56:57], v116 offset:28672
  buffer_load_dwordx4 v124, s[8:11], s69 offen offset:2048  lds
  v_mfma_f32_16x16x32_bf16 v[64:67], a[112:115], a[168:171], v[64:67]
  ds_read_b64_tr_b16 a[58:59], v116 offset:34816
  v_mfma_f32_16x16x32_bf16 v[68:71], a[116:119], a[168:171], v[68:71]
  ds_read_b64_tr_b16 a[80:81], v116 offset:40960
  v_mfma_f32_16x16x32_bf16 v[68:71], a[96:99], a[144:147], v[68:71]
  ds_read_b64_tr_b16 a[82:83], v116 offset:47104
  v_mfma_f32_16x16x32_bf16 v[72:75], a[100:103], a[144:147], v[72:75]
  ds_read_b64_tr_b16 a[60:61], v117 offset:28672
  buffer_load_dwordx4 v125, s[8:11], s69 offen offset:3072  lds
  v_mfma_f32_16x16x32_bf16 v[72:75], a[120:123], a[168:171], v[72:75]
  ds_read_b64_tr_b16 a[62:63], v117 offset:34816
  v_mfma_f32_16x16x32_bf16 v[76:79], a[124:127], a[168:171], v[76:79]
  ds_read_b64_tr_b16 a[84:85], v117 offset:40960
  v_mfma_f32_16x16x32_bf16 v[76:79], a[104:107], a[144:147], v[76:79]
  s_add_u32 m0, s63, 4096
  ds_read_b64_tr_b16 a[86:87], v117 offset:47104
  v_mfma_f32_16x16x32_bf16 v[92:95], a[104:107], a[148:151], v[92:95]
  buffer_load_dwordx4 v124, s[8:11], s70 offen offset:0  lds
  v_mfma_f32_16x16x32_bf16 v[92:95], a[124:127], a[172:175], v[92:95]
  v_mfma_f32_16x16x32_bf16 v[88:91], a[120:123], a[172:175], v[88:91]
  v_mfma_f32_16x16x32_bf16 v[88:91], a[100:103], a[148:151], v[88:91]
  v_mfma_f32_16x16x32_bf16 v[84:87], a[96:99], a[148:151], v[84:87]
  buffer_load_dwordx4 v125, s[8:11], s70 offen offset:1024  lds
  v_mfma_f32_16x16x32_bf16 v[84:87], a[116:119], a[172:175], v[84:87]
  v_mfma_f32_16x16x32_bf16 v[80:83], a[112:115], a[172:175], v[80:83]
  v_mfma_f32_16x16x32_bf16 v[80:83], a[92:95], a[148:151], v[80:83]
  s_cmp_eq_u32 s66, s88
  s_cbranch_scc0 Lside_skip3
  s_call_b64 s[78:79], Lside_sub
Lside_skip3:
  s_waitcnt lgkmcnt(15)
  v_mfma_f32_16x16x32_bf16 v[0:3], a[40:43], a[4:7], v[0:3]
  s_mul_i32 s45, s44, 393216
  v_mfma_f32_16x16x32_bf16 v[0:3], a[64:67], a[24:27], v[0:3]
  s_add_u32 s69, s45, s60
  v_mfma_f32_16x16x32_bf16 v[4:7], a[64:67], a[28:31], v[4:7]
  s_add_u32 s70, s69, 4096
  v_mfma_f32_16x16x32_bf16 v[4:7], a[40:43], a[8:11], v[4:7]
  v_mfma_f32_16x16x32_bf16 v[8:11], a[40:43], a[12:15], v[8:11]
  v_mfma_f32_16x16x32_bf16 v[8:11], a[64:67], a[32:35], v[8:11]
  v_mfma_f32_16x16x32_bf16 v[12:15], a[64:67], a[36:39], v[12:15]
  v_mfma_f32_16x16x32_bf16 v[12:15], a[40:43], a[16:19], v[12:15]
  v_mfma_f32_16x16x32_bf16 v[28:31], a[44:47], a[16:19], v[28:31]
  v_mfma_f32_16x16x32_bf16 v[28:31], a[68:71], a[36:39], v[28:31]
  v_mfma_f32_16x16x32_bf16 v[24:27], a[68:71], a[32:35], v[24:27]
  s_waitcnt vmcnt(10) lgkmcnt(0)
  s_barrier
  ds_read_b64_tr_b16 a[128:129], v118 offset:0
  v_mfma_f32_16x16x32_bf16 v[24:27], a[44:47], a[12:15], v[24:27]
  s_add_u32 m0, s62, 90112
  ds_read_b64_tr_b16 a[130:131], v118 offset:6144
  v_mfma_f32_16x16x32_bf16 v[20:23], a[44:47], a[8:11], v[20:23]
  ds_read_b64_tr_b16 a[152:153], v118 offset:12288
  buffer_load_dwordx4 v120, s[28:31], s68 offen offset:0 sc1  lds
  v_mfma_f32_16x16x32_bf16 v[20:23], a[68:71], a[28:31], v[20:23]
  ds_read_b64_tr_b16 a[154:155], v118 offset:18432
  v_mfma_f32_16x16x32_bf16 v[16:19], a[68:71], a[24:27], v[16:19]
  ds_read_b128 a[92:95], v112 offset:32768
  v_mfma_f32_16x16x32_bf16 v[16:19], a[44:47], a[4:7], v[16:19]
  ds_read_b128 a[112:115], v113 offset:32768
  v_mfma_f32_16x16x32_bf16 v[96:99], a[48:51], a[0:3], v[96:99]
  ds_read_b128 a[96:99], v112 offset:34816
  buffer_load_dwordx4 v121, s[28:31], s68 offen offset:1024 sc1  lds
  v_mfma_f32_16x16x32_bf16 v[96:99], a[72:75], a[20:23], v[96:99]
  ds_read_b128 a[116:119], v113 offset:34816
  v_mfma_f32_16x16x32_bf16 v[32:35], a[72:75], a[24:27], v[32:35]
  ds_read_b128 a[100:103], v112 offset:36864
  v_mfma_f32_16x16x32_bf16 v[32:35], a[48:51], a[4:7], v[32:35]
  ds_read_b128 a[120:123], v113 offset:36864
  v_mfma_f32_16x16x32_bf16 v[36:39], a[48:51], a[8:11], v[36:39]
  ds_read_b128 a[104:107], v112 offset:38912
  buffer_load_dwordx4 v122, s[28:31], s68 offen offset:2048 sc1  lds
  v_mfma_f32_16x16x32_bf16 v[36:39], a[72:75], a[28:31], v[36:39]
  ds_read_b128 a[124:127], v113 offset:38912
  v_mfma_f32_16x16x32_bf16 v[40:43], a[72:75], a[32:35], v[40:43]
  ds_read_b64_tr_b16 a[132:133], v119 offset:0
  v_mfma_f32_16x16x32_bf16 v[40:43], a[48:51], a[12:15], v[40:43]
  ds_read_b64_tr_b16 a[134:135], v119 offset:6144
  v_mfma_f32_16x16x32_bf16 v[44:47], a[48:51], a[16:19], v[44:47]
  ds_read_b64_tr_b16 a[156:157], v119 offset:12288
  buffer_load_dwordx4 v123, s[28:31], s68 offen offset:3072 sc1  lds
  v_mfma_f32_16x16x32_bf16 v[44:47], a[72:75], a[36:39], v[44:47]
  ds_read_b64_tr_b16 a[158:159], v119 offset:18432
  v_mfma_f32_16x16x32_bf16 v[60:63], a[76:79], a[36:39], v[60:63]
  ds_read_b128 a[88:91], v114 offset:5120
  v_mfma_f32_16x16x32_bf16 v[60:63], a[52:55], a[16:19], v[60:63]
  s_add_u32 m0, s63, 24576
  ds_read_b128 a[108:111], v115 offset:5120
  v_mfma_f32_16x16x32_bf16 v[56:59], a[52:55], a[12:15], v[56:59]
  ds_read_b64_tr_b16 a[136:137], v118 offset:2048
  buffer_load_dwordx4 v124, s[8:11], s69 offen offset:0  lds
  v_mfma_f32_16x16x32_bf16 v[56:59], a[76:79], a[32:35], v[56:59]
  ds_read_b64_tr_b16 a[138:139], v118 offset:8192
  v_mfma_f32_16x16x32_bf16 v[52:55], a[76:79], a[28:31], v[52:55]
  s_add_u32 s44, s44, 1
  ds_read_b64_tr_b16 a[160:161], v118 offset:14336
  v_mfma_f32_16x16x32_bf16 v[52:55], a[52:55], a[8:11], v[52:55]
  s_and_b32 s44, s44, 15
  ds_read_b64_tr_b16 a[162:163], v118 offset:20480
  v_mfma_f32_16x16x32_bf16 v[48:51], a[52:55], a[4:7], v[48:51]
  s_add_u32 s66, s66, 1
  ds_read_b64_tr_b16 a[140:141], v119 offset:2048
  buffer_load_dwordx4 v125, s[8:11], s69 offen offset:1024  lds
  v_mfma_f32_16x16x32_bf16 v[48:51], a[76:79], a[24:27], v[48:51]
  s_mul_i32 s45, s44, s61
  ds_read_b64_tr_b16 a[142:143], v119 offset:8192
  v_mfma_f32_16x16x32_bf16 v[100:103], a[20:23], a[80:83], v[100:103]
  s_add_u32 s68, s45, s59
  ds_read_b64_tr_b16 a[164:165], v119 offset:14336
  v_mfma_f32_16x16x32_bf16 v[100:103], a[0:3], a[56:59], v[100:103]
  ds_read_b64_tr_b16 a[166:167], v119 offset:20480
  v_mfma_f32_16x16x32_bf16 v[64:67], a[4:7], a[56:59], v[64:67]
  ds_read_b64_tr_b16 a[144:145], v118 offset:4096
  buffer_load_dwordx4 v124, s[8:11], s69 offen offset:2048  lds
  v_mfma_f32_16x16x32_bf16 v[64:67], a[24:27], a[80:83], v[64:67]
  ds_read_b64_tr_b16 a[146:147], v118 offset:10240
  v_mfma_f32_16x16x32_bf16 v[68:71], a[28:31], a[80:83], v[68:71]
  ds_read_b64_tr_b16 a[168:169], v118 offset:16384
  v_mfma_f32_16x16x32_bf16 v[68:71], a[8:11], a[56:59], v[68:71]
  ds_read_b64_tr_b16 a[170:171], v118 offset:22528
  v_mfma_f32_16x16x32_bf16 v[72:75], a[12:15], a[56:59], v[72:75]
  ds_read_b64_tr_b16 a[148:149], v119 offset:4096
  buffer_load_dwordx4 v125, s[8:11], s69 offen offset:3072  lds
  v_mfma_f32_16x16x32_bf16 v[72:75], a[32:35], a[80:83], v[72:75]
  ds_read_b64_tr_b16 a[150:151], v119 offset:10240
  v_mfma_f32_16x16x32_bf16 v[76:79], a[36:39], a[80:83], v[76:79]
  ds_read_b64_tr_b16 a[172:173], v119 offset:16384
  v_mfma_f32_16x16x32_bf16 v[76:79], a[16:19], a[56:59], v[76:79]
  s_add_u32 m0, s63, 28672
  ds_read_b64_tr_b16 a[174:175], v119 offset:22528
  v_mfma_f32_16x16x32_bf16 v[92:95], a[16:19], a[60:63], v[92:95]
  buffer_load_dwordx4 v124, s[8:11], s70 offen offset:0  lds
  v_mfma_f32_16x16x32_bf16 v[92:95], a[36:39], a[84:87], v[92:95]
  v_mfma_f32_16x16x32_bf16 v[88:91], a[32:35], a[84:87], v[88:91]
  v_mfma_f32_16x16x32_bf16 v[88:91], a[12:15], a[60:63], v[88:91]
  v_mfma_f32_16x16x32_bf16 v[84:87], a[8:11], a[60:63], v[84:87]
  buffer_load_dwordx4 v125, s[8:11], s70 offen offset:1024  lds
  v_mfma_f32_16x16x32_bf16 v[84:87], a[28:31], a[84:87], v[84:87]
  v_mfma_f32_16x16x32_bf16 v[80:83], a[24:27], a[84:87], v[80:83]
  v_mfma_f32_16x16x32_bf16 v[80:83], a[4:7], a[60:63], v[80:83]
  s_cmp_eq_u32 s66, s88
  s_cbranch_scc0 Lside_skip4
  s_call_b64 s[78:79], Lside_sub
Lside_skip4:
  s_waitcnt lgkmcnt(15)
  v_mfma_f32_16x16x32_bf16 v[0:3], a[128:131], a[92:95], v[0:3]
  s_mul_i32 s45, s44, 393216
  v_mfma_f32_16x16x32_bf16 v[0:3], a[152:155], a[112:115], v[0:3]
  s_add_u32 s69, s45, s60
  v_mfma_f32_16x16x32_bf16 v[4:7], a[152:155], a[116:119], v[4:7]
  s_add_u32 s70, s69, 4096
  v_mfma_f32_16x16x32_bf16 v[4:7], a[128:131], a[96:99], v[4:7]
  v_mfma_f32_16x16x32_bf16 v[8:11], a[128:131], a[100:103], v[8:11]
  v_mfma_f32_16x16x32_bf16 v[8:11], a[152:155], a[120:123], v[8:11]
  v_mfma_f32_16x16x32_bf16 v[12:15], a[152:155], a[124:127], v[12:15]
  v_mfma_f32_16x16x32_bf16 v[12:15], a[128:131], a[104:107], v[12:15]
  v_mfma_f32_16x16x32_bf16 v[28:31], a[132:135], a[104:107], v[28:31]
  v_mfma_f32_16x16x32_bf16 v[28:31], a[156:159], a[124:127], v[28:31]
  v_mfma_f32_16x16x32_bf16 v[24:27], a[156:159], a[120:123], v[24:27]
  s_waitcnt vmcnt(10) lgkmcnt(0)
  s_barrier
  ds_read_b64_tr_b16 a[40:41], v116 offset:0
  v_mfma_f32_16x16x32_bf16 v[24:27], a[132:135], a[100:103], v[24:27]
  s_add_u32 m0, s62, 106496
  ds_read_b64_tr_b16 a[42:43], v116 offset:6144
  v_mfma_f32_16x16x32_bf16 v[20:23], a[132:135], a[96:99], v[20:23]
  ds_read_b64_tr_b16 a[64:65], v116 offset:12288
  buffer_load_dwordx4 v120, s[28:31], s68 offen offset:0 sc1  lds
  v_mfma_f32_16x16x32_bf16 v[20:23], a[156:159], a[116:119], v[20:23]
  ds_read_b64_tr_b16 a[66:67], v116 offset:18432
  v_mfma_f32_16x16x32_bf16 v[16:19], a[156:159], a[112:115], v[16:19]
  ds_read_b128 a[4:7], v112 offset:0
  v_mfma_f32_16x16x32_bf16 v[16:19], a[132:135], a[92:95], v[16:19]
  ds_read_b128 a[24:27], v113 offset:0
  v_mfma_f32_16x16x32_bf16 v[96:99], a[136:139], a[88:91], v[96:99]
  ds_read_b128 a[8:11], v112 offset:2048
  buffer_load_dwordx4 v121, s[28:31], s68 offen offset:1024 sc1  lds
  v_mfma_f32_16x16x32_bf16 v[96:99], a[160:163], a[108:111], v[96:99]
  ds_read_b128 a[28:31], v113 offset:2048
  v_mfma_f32_16x16x32_bf16 v[32:35], a[160:163], a[112:115], v[32:35]
  ds_read_b128 a[12:15], v112 offset:4096
  v_mfma_f32_16x16x32_bf16 v[32:35], a[136:139], a[92:95], v[32:35]
  ds_read_b128 a[32:35], v113 offset:4096
  v_mfma_f32_16x16x32_bf16 v[36:39], a[136:139], a[96:99], v[36:39]
  ds_read_b128 a[16:19], v112 offset:6144
  buffer_load_dwordx4 v122, s[28:31], s68 offen offset:2048 sc1  lds
  v_mfma_f32_16x16x32_bf16 v[36:39], a[160:163], a[116:119], v[36:39]
  ds_read_b128 a[36:39], v113 offset:6144
  v_mfma_f32_16x16x32_bf16 v[40:43], a[160:163], a[120:123], v[40:43]
  ds_read_b64_tr_b16 a[44:45], v117 offset:0
  v_mfma_f32_16x16x32_bf16 v[40:43], a[136:139], a[100:103], v[40:43]
  ds_read_b64_tr_b16 a[46:47], v117 offset:6144
  v_mfma_f32_16x16x32_bf16 v[44:47], a[136:139], a[104:107], v[44:47]
  ds_read_b64_tr_b16 a[68:69], v117 offset:12288
  buffer_load_dwordx4 v123, s[28:31], s68 offen offset:3072 sc1  lds
  v_mfma_f32_16x16x32_bf16 v[44:47], a[160:163], a[124:127], v[44:47]
  ds_read_b64_tr_b16 a[70:71], v117 offset:18432
  v_mfma_f32_16x16x32_bf16 v[60:63], a[164:167], a[124:127], v[60:63]
  ds_read_b128 a[0:3], v114 offset:6144
  v_add_u32 v114, 6144, v114
  v_mfma_f32_16x16x32_bf16 v[60:63], a[140:143], a[104:107], v[60:63]
  s_add_u32 m0, s63, 49152
  ds_read_b128 a[20:23], v115 offset:6144
  v_add_u32 v115, 6144, v115
  v_mfma_f32_16x16x32_bf16 v[56:59], a[140:143], a[100:103], v[56:59]
  ds_read_b64_tr_b16 a[48:49], v116 offset:2048
  buffer_load_dwordx4 v124, s[8:11], s69 offen offset:0  lds
  v_mfma_f32_16x16x32_bf16 v[56:59], a[164:167], a[120:123], v[56:59]
  ds_read_b64_tr_b16 a[50:51], v116 offset:8192
  v_mfma_f32_16x16x32_bf16 v[52:55], a[164:167], a[116:119], v[52:55]
  s_add_u32 s44, s44, 1
  ds_read_b64_tr_b16 a[72:73], v116 offset:14336
  v_mfma_f32_16x16x32_bf16 v[52:55], a[140:143], a[96:99], v[52:55]
  s_and_b32 s44, s44, 15
  ds_read_b64_tr_b16 a[74:75], v116 offset:20480
  v_mfma_f32_16x16x32_bf16 v[48:51], a[140:143], a[92:95], v[48:51]
  s_add_u32 s66, s66, 1
  ds_read_b64_tr_b16 a[52:53], v117 offset:2048
  buffer_load_dwordx4 v125, s[8:11], s69 offen offset:1024  lds
  v_mfma_f32_16x16x32_bf16 v[48:51], a[164:167], a[112:115], v[48:51]
  s_mul_i32 s45, s44, s61
  ds_read_b64_tr_b16 a[54:55], v117 offset:8192
  v_mfma_f32_16x16x32_bf16 v[100:103], a[108:111], a[168:171], v[100:103]
  s_add_u32 s68, s45, s59
  ds_read_b64_tr_b16 a[76:77], v117 offset:14336
  v_mfma_f32_16x16x32_bf16 v[100:103], a[88:91], a[144:147], v[100:103]
  ds_read_b64_tr_b16 a[78:79], v117 offset:20480
  v_mfma_f32_16x16x32_bf16 v[64:67], a[92:95], a[144:147], v[64:67]
  ds_read_b64_tr_b16 a[56:57], v116 offset:4096
  buffer_load_dwordx4 v124, s[8:11], s69 offen offset:2048  lds
  v_mfma_f32_16x16x32_bf16 v[64:67], a[112:115], a[168:171], v[64:67]
  ds_read_b64_tr_b16 a[58:59], v116 offset:10240
  v_mfma_f32_16x16x32_bf16 v[68:71], a[116:119], a[168:171], v[68:71]
  ds_read_b64_tr_b16 a[80:81], v116 offset:16384
  v_mfma_f32_16x16x32_bf16 v[68:71], a[96:99], a[144:147], v[68:71]
  ds_read_b64_tr_b16 a[82:83], v116 offset:22528
  v_mfma_f32_16x16x32_bf16 v[72:75], a[100:103], a[144:147], v[72:75]
  ds_read_b64_tr_b16 a[60:61], v117 offset:4096
  buffer_load_dwordx4 v125, s[8:11], s69 offen offset:3072  lds
  v_mfma_f32_16x16x32_bf16 v[72:75], a[120:123], a[168:171], v[72:75]
  ds_read_b64_tr_b16 a[62:63], v117 offset:10240
  v_mfma_f32_16x16x32_bf16 v[76:79], a[124:127], a[168:171], v[76:79]
  ds_read_b64_tr_b16 a[84:85], v117 offset:16384
  v_mfma_f32_16x16x32_bf16 v[76:79], a[104:107], a[144:147], v[76:79]
  s_add_u32 m0, s63, 53248
  ds_read_b64_tr_b16 a[86:87], v117 offset:22528
  v_mfma_f32_16x16x32_bf16 v[92:95], a[104:107], a[148:151], v[92:95]
  buffer_load_dwordx4 v124, s[8:11], s70 offen offset:0  lds
  v_mfma_f32_16x16x32_bf16 v[92:95], a[124:127], a[172:175], v[92:95]
  v_mfma_f32_16x16x32_bf16 v[88:91], a[120:123], a[172:175], v[88:91]
  v_mfma_f32_16x16x32_bf16 v[88:91], a[100:103], a[148:151], v[88:91]
  v_mfma_f32_16x16x32_bf16 v[84:87], a[96:99], a[148:151], v[84:87]
  buffer_load_dwordx4 v125, s[8:11], s70 offen offset:1024  lds
  v_mfma_f32_16x16x32_bf16 v[84:87], a[116:119], a[172:175], v[84:87]
  v_mfma_f32_16x16x32_bf16 v[80:83], a[112:115], a[172:175], v[80:83]
  v_mfma_f32_16x16x32_bf16 v[80:83], a[92:95], a[148:151], v[80:83]
  s_cmp_eq_u32 s66, s88
  s_cbranch_scc0 Lside_skip5
  s_call_b64 s[78:79], Lside_sub
Lside_skip5:
  s_sub_u32 s56, s56, 1
  s_cmp_lg_u32 s56, 0
  s_cbranch_scc1 Lp1_loop
Lmk_Lp1_loop_tail:
  s_waitcnt lgkmcnt(15)
  v_mfma_f32_16x16x32_bf16 v[0:3], a[40:43], a[4:7], v[0:3]
  s_mul_i32 s45, s44, 393216
  v_and_b32 v240, 1, v253
  v_lshlrev_b32 v240, 7, v240
  v_mfma_f32_16x16x32_bf16 v[0:3], a[64:67], a[24:27], v[0:3]
  s_add_u32 s69, s45, s60
  v_mfma_f32_16x16x32_bf16 v[4:7], a[64:67], a[28:31], v[4:7]
  s_add_u32 s70, s69, 4096
  buffer_load_dword v127, v240, s[36:39], 0 offen sc1
  v_mfma_f32_16x16x32_bf16 v[4:7], a[40:43], a[8:11], v[4:7]
  s_lshl_b32 s43, s57, 2
  v_mfma_f32_16x16x32_bf16 v[8:11], a[40:43], a[12:15], v[8:11]
  s_add_u32 s74, s71, s43
  v_mfma_f32_16x16x32_bf16 v[8:11], a[64:67], a[32:35], v[8:11]
  s_add_u32 s45, s42, 27262976
  v_mfma_f32_16x16x32_bf16 v[12:15], a[64:67], a[36:39], v[12:15]
  s_lshl_b32 s44, s72, 11
  v_mfma_f32_16x16x32_bf16 v[12:15], a[40:43], a[16:19], v[12:15]
  s_add_u32 s77, s44, s45
  v_mfma_f32_16x16x32_bf16 v[28:31], a[44:47], a[16:19], v[28:31]
  s_lshl_b32 s44, s40, 1
  v_mfma_f32_16x16x32_bf16 v[28:31], a[68:71], a[36:39], v[28:31]
  s_add_u32 s44, s44, s71
  v_mfma_f32_16x16x32_bf16 v[24:27], a[68:71], a[32:35], v[24:27]
  s_waitcnt vmcnt(11) lgkmcnt(0)
  s_barrier
  ds_read_b64_tr_b16 a[128:129], v116 offset:24576
  v_mfma_f32_16x16x32_bf16 v[24:27], a[44:47], a[12:15], v[24:27]
  s_add_u32 m0, s62, 73728
  ds_read_b64_tr_b16 a[130:131], v116 offset:30720
  v_mfma_f32_16x16x32_bf16 v[20:23], a[44:47], a[8:11], v[20:23]
  s_lshl_b32 s44, s44, 11
  ds_read_b64_tr_b16 a[152:153], v116 offset:36864
  buffer_load_dwordx4 v120, s[28:31], s68 offen offset:0 sc1  lds
  v_mfma_f32_16x16x32_bf16 v[20:23], a[68:71], a[28:31], v[20:23]
  s_add_u32 s78, s44, s45
  ds_read_b64_tr_b16 a[154:155], v116 offset:43008
  v_mfma_f32_16x16x32_bf16 v[16:19], a[68:71], a[24:27], v[16:19]
  s_lshl_b32 s43, s51, 1
  ds_read_b128 a[92:95], v112 offset:16384
  v_mfma_f32_16x16x32_bf16 v[16:19], a[44:47], a[4:7], v[16:19]
  s_add_u32 s75, s43, s58
  ds_read_b128 a[112:115], v113 offset:16384
  v_mfma_f32_16x16x32_bf16 v[96:99], a[48:51], a[0:3], v[96:99]
  s_lshl_b32 s43, s75, 7
  ds_read_b128 a[96:99], v112 offset:18432
  buffer_load_dwordx4 v121, s[28:31], s68 offen offset:1024 sc1  lds
  v_mfma_f32_16x16x32_bf16 v[96:99], a[72:75], a[20:23], v[96:99]
  s_add_u32 s46, s43, 27983872
  ds_read_b128 a[116:119], v113 offset:18432
  v_mfma_f32_16x16x32_bf16 v[32:35], a[72:75], a[24:27], v[32:35]
  s_lshl_b32 s43, s57, 6
  ds_read_b128 a[100:103], v112 offset:20480
  v_mfma_f32_16x16x32_bf16 v[32:35], a[48:51], a[4:7], v[32:35]
  ds_read_b128 a[120:123], v113 offset:20480
  v_mfma_f32_16x16x32_bf16 v[36:39], a[48:51], a[8:11], v[36:39]
  ds_read_b128 a[104:107], v112 offset:22528
  buffer_load_dwordx4 v122, s[28:31], s68 offen offset:2048 sc1  lds
  v_mfma_f32_16x16x32_bf16 v[36:39], a[72:75], a[28:31], v[36:39]
  ds_read_b128 a[124:127], v113 offset:22528
  v_mfma_f32_16x16x32_bf16 v[40:43], a[72:75], a[32:35], v[40:43]
  ds_read_b64_tr_b16 a[132:133], v117 offset:24576
  v_mfma_f32_16x16x32_bf16 v[40:43], a[48:51], a[12:15], v[40:43]
  ds_read_b64_tr_b16 a[134:135], v117 offset:30720
  v_mfma_f32_16x16x32_bf16 v[44:47], a[48:51], a[16:19], v[44:47]
  ds_read_b64_tr_b16 a[156:157], v117 offset:36864
  buffer_load_dwordx4 v123, s[28:31], s68 offen offset:3072 sc1  lds
  v_mfma_f32_16x16x32_bf16 v[44:47], a[72:75], a[36:39], v[44:47]
  ds_read_b64_tr_b16 a[158:159], v117 offset:43008
  v_mfma_f32_16x16x32_bf16 v[60:63], a[76:79], a[36:39], v[60:63]
  ds_read_b128 a[88:91], v114 offset:1024
  v_mfma_f32_16x16x32_bf16 v[60:63], a[52:55], a[16:19], v[60:63]
  s_add_u32 m0, s63, 0
  ds_read_b128 a[108:111], v115 offset:1024
  v_mfma_f32_16x16x32_bf16 v[56:59], a[52:55], a[12:15], v[56:59]
  ds_read_b64_tr_b16 a[136:137], v116 offset:26624
  buffer_load_dwordx4 v124, s[8:11], s69 offen offset:0  lds
  v_mfma_f32_16x16x32_bf16 v[56:59], a[76:79], a[32:35], v[56:59]
  ds_read_b64_tr_b16 a[138:139], v116 offset:32768
  v_mfma_f32_16x16x32_bf16 v[52:55], a[76:79], a[28:31], v[52:55]
  ds_read_b64_tr_b16 a[160:161], v116 offset:38912
  v_lshlrev_b32 v105, 3, v253
  v_mfma_f32_16x16x32_bf16 v[52:55], a[52:55], a[8:11], v[52:55]
  ds_read_b64_tr_b16 a[162:163], v116 offset:45056
  v_lshlrev_b32 v104, 4, v253
  v_mfma_f32_16x16x32_bf16 v[48:51], a[52:55], a[4:7], v[48:51]
  ds_read_b64_tr_b16 a[140:141], v117 offset:26624
  buffer_load_dwordx4 v125, s[8:11], s69 offen offset:1024  lds
  v_mfma_f32_16x16x32_bf16 v[48:51], a[76:79], a[24:27], v[48:51]
  ds_read_b64_tr_b16 a[142:143], v117 offset:32768
  v_xor_b32 v126, s43, v104
  v_mfma_f32_16x16x32_bf16 v[100:103], a[20:23], a[80:83], v[100:103]
  ds_read_b64_tr_b16 a[164:165], v117 offset:38912
  v_add_u32 v126, s76, v126
  v_mfma_f32_16x16x32_bf16 v[100:103], a[0:3], a[56:59], v[100:103]
  ds_read_b64_tr_b16 a[166:167], v117 offset:45056
  v_bfe_u32 v106, v253, 3, 2
  v_mfma_f32_16x16x32_bf16 v[64:67], a[4:7], a[56:59], v[64:67]
  ds_read_b64_tr_b16 a[144:145], v116 offset:28672
  buffer_load_dwordx4 v124, s[8:11], s69 offen offset:2048  lds
  v_mfma_f32_16x16x32_bf16 v[64:67], a[24:27], a[80:83], v[64:67]
  ds_read_b64_tr_b16 a[146:147], v116 offset:34816
  v_lshrrev_b32 v107, 5, v253
  v_mfma_f32_16x16x32_bf16 v[68:71], a[28:31], a[80:83], v[68:71]
  ds_read_b64_tr_b16 a[168:169], v116 offset:40960
  v_mad_u32_u24 v106, v107, 3, v106
  v_mfma_f32_16x16x32_bf16 v[68:71], a[8:11], a[56:59], v[68:71]
  ds_read_b64_tr_b16 a[170:171], v116 offset:47104
  v_and_b32 v107, 7, v253
  v_mfma_f32_16x16x32_bf16 v[72:75], a[12:15], a[56:59], v[72:75]
  ds_read_b64_tr_b16 a[148:149], v117 offset:28672
  buffer_load_dwordx4 v125, s[8:11], s69 offen offset:3072  lds
  v_mfma_f32_16x16x32_bf16 v[72:75], a[32:35], a[80:83], v[72:75]
  ds_read_b64_tr_b16 a[150:151], v117 offset:34816
  v_lshlrev_b32 v107, 4, v107
  v_mfma_f32_16x16x32_bf16 v[76:79], a[36:39], a[80:83], v[76:79]
  ds_read_b64_tr_b16 a[172:173], v117 offset:40960
  v_lshl_add_u32 v106, v106, 12, v107
  v_mfma_f32_16x16x32_bf16 v[76:79], a[16:19], a[56:59], v[76:79]
  s_add_u32 m0, s63, 4096
  ds_read_b64_tr_b16 a[174:175], v117 offset:47104
  v_mfma_f32_16x16x32_bf16 v[92:95], a[16:19], a[60:63], v[92:95]
  buffer_load_dwordx4 v124, s[8:11], s70 offen offset:0  lds
  v_mfma_f32_16x16x32_bf16 v[92:95], a[36:39], a[84:87], v[92:95]
  v_mfma_f32_16x16x32_bf16 v[88:91], a[32:35], a[84:87], v[88:91]
  v_mfma_f32_16x16x32_bf16 v[88:91], a[12:15], a[60:63], v[88:91]
  s_waitcnt vmcnt(9)
  v_cmp_gt_u32 vcc, 128, v127
  s_cbranch_vccz Lcdn4
  s_mov_b32 s43, 0x40000
Lchk3:
  s_sleep 8
  buffer_load_dword v127, v240, s[36:39], 0 offen sc1
  s_waitcnt vmcnt(0)
  v_cmp_gt_u32 vcc, 128, v127
  s_cbranch_vccz Lcdn4
  s_sub_u32 s43, s43, 1
  s_cmp_lg_u32 s43, 0
  s_cbranch_scc1 Lchk3
Lcdn4:
  v_mfma_f32_16x16x32_bf16 v[84:87], a[8:11], a[60:63], v[84:87]
  buffer_load_dwordx4 v125, s[8:11], s70 offen offset:1024  lds
  v_mfma_f32_16x16x32_bf16 v[84:87], a[28:31], a[84:87], v[84:87]
  v_mfma_f32_16x16x32_bf16 v[80:83], a[24:27], a[84:87], v[80:83]
  v_mfma_f32_16x16x32_bf16 v[80:83], a[4:7], a[60:63], v[80:83]
  s_waitcnt lgkmcnt(15)
  v_mfma_f32_16x16x32_bf16 v[0:3], a[128:131], a[92:95], v[0:3]
  s_cmp_lg_u32 s41, 0
  s_cbranch_scc1 Lp1_csl0
  buffer_load_dwordx4 v[200:203], v106, s[4:7], s46 offen sc1
  s_add_u32 s46, s46, 24576
  buffer_load_dwordx4 v[204:207], v106, s[4:7], s46 offen sc1
  s_add_u32 s46, s46, 24576
Lp1_csl0:
  v_mfma_f32_16x16x32_bf16 v[0:3], a[152:155], a[112:115], v[0:3]
  s_lshl_b32 s92, s53, 7
  s_lshl_b32 s93, s40, 14
  s_add_u32 s92, s92, s93
  v_mfma_f32_16x16x32_bf16 v[4:7], a[152:155], a[116:119], v[4:7]
  s_lshl_b32 s89, s40, 10
  v_add_u32 v186, s92, v252
  s_bfe_u32 s88, s2, 0x5
  v_mfma_f32_16x16x32_bf16 v[4:7], a[128:131], a[96:99], v[4:7]
  s_lshl_b32 s88, s88, 21
  buffer_load_dwordx2 v[128:129], v105, s[4:7], s78 offen offset:0 sc1
  v_mfma_f32_16x16x32_bf16 v[8:11], a[128:131], a[100:103], v[8:11]
  v_mfma_f32_16x16x32_bf16 v[8:11], a[152:155], a[120:123], v[8:11]
  v_mfma_f32_16x16x32_bf16 v[12:15], a[152:155], a[124:127], v[12:15]
  s_cmp_lg_u32 s41, 0
  s_cbranch_scc1 Lp1_csl1
  buffer_load_dwordx4 v[208:211], v106, s[4:7], s46 offen sc1
  s_add_u32 s46, s46, 24576
  buffer_load_dwordx4 v[212:215], v106, s[4:7], s46 offen sc1
  s_add_u32 s46, s46, 24576
Lp1_csl1:
  v_mfma_f32_16x16x32_bf16 v[12:15], a[128:131], a[104:107], v[12:15]
  buffer_load_dwordx2 v[130:131], v105, s[4:7], s78 offen offset:512 sc1
  v_mfma_f32_16x16x32_bf16 v[28:31], a[132:135], a[104:107], v[28:31]
  v_mfma_f32_16x16x32_bf16 v[28:31], a[156:159], a[124:127], v[28:31]
  v_mfma_f32_16x16x32_bf16 v[24:27], a[156:159], a[120:123], v[24:27]
  s_waitcnt lgkmcnt(0)
  s_barrier
  ds_read_b64_tr_b16 a[40:41], v118 offset:0
  v_mfma_f32_16x16x32_bf16 v[24:27], a[132:135], a[100:103], v[24:27]
  ds_read_b64_tr_b16 a[42:43], v118 offset:6144
  buffer_load_dwordx2 v[132:133], v105, s[4:7], s78 offen offset:1024 sc1
  v_mfma_f32_16x16x32_bf16 v[20:23], a[132:135], a[96:99], v[20:23]
  s_cmp_lg_u32 s41, 0
  s_cbranch_scc1 Lp1_csl2
  buffer_load_dwordx4 v[216:219], v106, s[4:7], s46 offen sc1
  s_add_u32 s46, s46, 24576
  buffer_load_dwordx4 v[220:223], v106, s[4:7], s46 offen sc1
  s_add_u32 s46, s46, 24576
Lp1_csl2:
  ds_read_b64_tr_b16 a[64:65], v118 offset:12288
  v_mfma_f32_16x16x32_bf16 v[20:23], a[156:159], a[116:119], v[20:23]
  ds_read_b64_tr_b16 a[66:67], v118 offset:18432
  v_mfma_f32_16x16x32_bf16 v[16:19], a[156:159], a[112:115], v[16:19]
  ds_read_b128 a[4:7], v112 offset:32768
  v_mfma_f32_16x16x32_bf16 v[16:19], a[132:135], a[92:95], v[16:19]
  ds_read_b128 a[24:27], v113 offset:32768
  buffer_load_dwordx2 v[134:135], v105, s[4:7], s78 offen offset:1536 sc1
  v_mfma_f32_16x16x32_bf16 v[96:99], a[136:139], a[88:91], v[96:99]
  ds_read_b128 a[8:11], v112 offset:34816
  v_mfma_f32_16x16x32_bf16 v[96:99], a[160:163], a[108:111], v[96:99]
  ds_read_b128 a[28:31], v113 offset:34816
  v_mfma_f32_16x16x32_bf16 v[32:35], a[160:163], a[112:115], v[32:35]
  s_cmp_lg_u32 s41, 0
  s_cbranch_scc1 Lp1_csl3
  buffer_load_dwordx4 v[224:227], v106, s[4:7], s46 offen sc1
  s_add_u32 s46, s46, 24576
  buffer_load_dwordx4 v[228:231], v106, s[4:7], s46 offen sc1
  s_add_u32 s46, s46, 24576
Lp1_csl3:
  ds_read_b128 a[12:15], v112 offset:36864
  v_mfma_f32_16x16x32_bf16 v[32:35], a[136:139], a[92:95], v[32:35]
  ds_read_b128 a[32:35], v113 offset:36864
  buffer_load_dwordx2 v[136:137], v105, s[4:7], s78 offen offset:2048 sc1
  v_mfma_f32_16x16x32_bf16 v[36:39], a[136:139], a[96:99], v[36:39]
  ds_read_b128 a[16:19], v112 offset:38912
  v_mfma_f32_16x16x32_bf16 v[36:39], a[160:163], a[116:119], v[36:39]
  ds_read_b128 a[36:39], v113 offset:38912
  v_mfma_f32_16x16x32_bf16 v[40:43], a[160:163], a[120:123], v[40:43]
  ds_read_b64_tr_b16 a[44:45], v119 offset:0
  v_mfma_f32_16x16x32_bf16 v[40:43], a[136:139], a[100:103], v[40:43]
  ds_read_b64_tr_b16 a[46:47], v119 offset:6144
  buffer_load_dwordx2 v[138:139], v105, s[4:7], s78 offen offset:2560 sc1
  v_mfma_f32_16x16x32_bf16 v[44:47], a[136:139], a[104:107], v[44:47]
  ds_read_b64_tr_b16 a[68:69], v119 offset:12288
  v_lshrrev_b32 v240, 4, v253
  v_mfma_f32_16x16x32_bf16 v[44:47], a[160:163], a[124:127], v[44:47]
  ds_read_b64_tr_b16 a[70:71], v119 offset:18432
  v_lshlrev_b32 v124, 4, v240
  v_mfma_f32_16x16x32_bf16 v[60:63], a[164:167], a[124:127], v[60:63]
  ds_read_b128 a[0:3], v114 offset:2048
  v_and_b32 v125, 15, v253
  v_mfma_f32_16x16x32_bf16 v[60:63], a[140:143], a[104:107], v[60:63]
  ds_read_b128 a[20:23], v115 offset:2048
  buffer_load_dwordx2 v[140:141], v105, s[4:7], s78 offen offset:3072 sc1
  v_mfma_f32_16x16x32_bf16 v[56:59], a[140:143], a[100:103], v[56:59]
  ds_read_b64_tr_b16 a[48:49], v118 offset:2048
  v_lshlrev_b32 v125, 2, v125
  v_mfma_f32_16x16x32_bf16 v[56:59], a[164:167], a[120:123], v[56:59]
  s_lshl_b32 s43, s57, 9
  ds_read_b64_tr_b16 a[50:51], v118 offset:8192
  v_add_u32 v164, 155648, v124
  v_mfma_f32_16x16x32_bf16 v[52:55], a[164:167], a[116:119], v[52:55]
  ds_read_b64_tr_b16 a[72:73], v118 offset:14336
  v_add_u32 v166, 155648, v125
  v_mfma_f32_16x16x32_bf16 v[52:55], a[140:143], a[96:99], v[52:55]
  ds_read_b64_tr_b16 a[74:75], v118 offset:20480
  buffer_load_dwordx2 v[142:143], v105, s[4:7], s78 offen offset:3584 sc1
  v_mfma_f32_16x16x32_bf16 v[48:51], a[140:143], a[92:95], v[48:51]
  ds_read_b64_tr_b16 a[52:53], v119 offset:2048
  v_add_u32 v165, s43, v164
  v_mfma_f32_16x16x32_bf16 v[48:51], a[164:167], a[112:115], v[48:51]
  ds_read_b64_tr_b16 a[54:55], v119 offset:8192
  v_add_u32 v167, s43, v166
  v_mfma_f32_16x16x32_bf16 v[100:103], a[108:111], a[168:171], v[100:103]
  s_lshl_b32 s43, s40, 1
  ds_read_b64_tr_b16 a[76:77], v119 offset:14336
  v_mfma_f32_16x16x32_bf16 v[100:103], a[88:91], a[144:147], v[100:103]
  s_add_u32 s43, s43, 1
  ds_read_b64_tr_b16 a[78:79], v119 offset:20480
  buffer_load_dwordx2 v[144:145], v105, s[4:7], s77 offen offset:0 sc1
  v_mfma_f32_16x16x32_bf16 v[64:67], a[92:95], a[144:147], v[64:67]
  ds_read_b64_tr_b16 a[56:57], v118 offset:4096
  v_add_u32 v241, s43, v240
  v_mfma_f32_16x16x32_bf16 v[64:67], a[112:115], a[168:171], v[64:67]
  ds_read_b64_tr_b16 a[58:59], v118 offset:10240
  v_cmp_gt_u32 vcc, 2, v240
  v_mfma_f32_16x16x32_bf16 v[68:71], a[116:119], a[168:171], v[68:71]
  ds_read_b64_tr_b16 a[80:81], v118 offset:16384
  v_and_b32 v240, 1, v240
  v_mfma_f32_16x16x32_bf16 v[68:71], a[96:99], a[144:147], v[68:71]
  ds_read_b64_tr_b16 a[82:83], v118 offset:22528
  buffer_load_dwordx2 v[146:147], v105, s[4:7], s77 offen offset:512 sc1
  v_mfma_f32_16x16x32_bf16 v[72:75], a[100:103], a[144:147], v[72:75]
  ds_read_b64_tr_b16 a[60:61], v119 offset:4096
  v_mul_u32_u24 v240, 9, v240
  v_mfma_f32_16x16x32_bf16 v[72:75], a[120:123], a[168:171], v[72:75]
  ds_read_b64_tr_b16 a[62:63], v119 offset:10240
  v_cndmask_b32 v240, v240, v241, vcc
  v_mfma_f32_16x16x32_bf16 v[76:79], a[124:127], a[168:171], v[76:79]
  ds_read_b64_tr_b16 a[84:85], v119 offset:16384
  v_lshl_add_u32 v106, v240, 7, v166
  v_mfma_f32_16x16x32_bf16 v[76:79], a[104:107], a[144:147], v[76:79]
  ds_read_b64_tr_b16 a[86:87], v119 offset:22528
  buffer_load_dwordx2 v[148:149], v105, s[4:7], s77 offen offset:1024 sc1
  v_mfma_f32_16x16x32_bf16 v[92:95], a[104:107], a[148:151], v[92:95]
  v_add_u32 v124, s76, v124
  v_add_u32 v125, s76, v125
  v_mfma_f32_16x16x32_bf16 v[92:95], a[124:127], a[172:175], v[92:95]
  v_add_u32 v107, 149504, v104
  v_mfma_f32_16x16x32_bf16 v[88:91], a[120:123], a[172:175], v[88:91]
  v_mfma_f32_16x16x32_bf16 v[88:91], a[100:103], a[148:151], v[88:91]
  buffer_load_dwordx2 v[150:151], v105, s[4:7], s77 offen offset:1536 sc1
  v_mfma_f32_16x16x32_bf16 v[84:87], a[96:99], a[148:151], v[84:87]
  v_mfma_f32_16x16x32_bf16 v[84:87], a[116:119], a[172:175], v[84:87]
  v_mfma_f32_16x16x32_bf16 v[80:83], a[112:115], a[172:175], v[80:83]
  v_mfma_f32_16x16x32_bf16 v[80:83], a[92:95], a[148:151], v[80:83]
  s_waitcnt lgkmcnt(15)
  v_mfma_f32_16x16x32_bf16 v[0:3], a[40:43], a[4:7], v[0:3]
  s_lshl_b32 s44, s2, 2
  s_add_u32 s44, s44, s40
  s_lshl_b32 s44, s44, 12
  v_mfma_f32_16x16x32_bf16 v[0:3], a[64:67], a[24:27], v[0:3]
  s_add_u32 s44, s44, s42
  v_mfma_f32_16x16x32_bf16 v[4:7], a[64:67], a[28:31], v[4:7]
  s_add_u32 s44, s44, 28311552
  v_mov_b32 v246, -1
  v_mov_b32 v247, -1
  v_mfma_f32_16x16x32_bf16 v[4:7], a[40:43], a[8:11], v[4:7]
  v_mov_b32 v248, -1
  v_mov_b32 v249, -1
  v_mfma_f32_16x16x32_bf16 v[8:11], a[40:43], a[12:15], v[8:11]
  v_mfma_f32_16x16x32_bf16 v[8:11], a[64:67], a[32:35], v[8:11]
  v_mfma_f32_16x16x32_bf16 v[12:15], a[64:67], a[36:39], v[12:15]
  s_waitcnt vmcnt(8)
  v_add_u32 v198, 1024, v125
  v_add_f32 v128, v128, v130
  v_mfma_f32_16x16x32_bf16 v[12:15], a[40:43], a[16:19], v[12:15]
  v_add_f32 v129, v129, v131
  v_add_f32 v132, v132, v134
  v_mfma_f32_16x16x32_bf16 v[28:31], a[44:47], a[16:19], v[28:31]
  buffer_store_dwordx4 v[246:249], v104, s[4:7], s44 offen offset:0 sc1
  v_add_f32 v133, v133, v135
  v_mfma_f32_16x16x32_bf16 v[28:31], a[68:71], a[36:39], v[28:31]
  v_add_f32 v128, v128, v132
  v_add_f32 v129, v129, v133
  v_mfma_f32_16x16x32_bf16 v[24:27], a[68:71], a[32:35], v[24:27]
  s_waitcnt lgkmcnt(0)
  s_barrier
  ds_read_b64_tr_b16 a[128:129], v116 offset:0
  s_waitcnt vmcnt(5)
  s_cmp_lg_u32 s41, 0
  s_cbranch_scc1 Lp1_css
  v_pk_add_f32 v[200:201], v[200:201], v[216:217]
  v_pk_add_f32 v[202:203], v[202:203], v[218:219]
  v_pk_add_f32 v[204:205], v[204:205], v[220:221]
  v_pk_add_f32 v[206:207], v[206:207], v[222:223]
  v_pk_add_f32 v[208:209], v[208:209], v[224:225]
  v_pk_add_f32 v[210:211], v[210:211], v[226:227]
  v_pk_add_f32 v[212:213], v[212:213], v[228:229]
  v_pk_add_f32 v[214:215], v[214:215], v[230:231]
  v_pk_add_f32 v[200:201], v[200:201], v[208:209]
  v_pk_add_f32 v[202:203], v[202:203], v[210:211]
  v_pk_add_f32 v[204:205], v[204:205], v[212:213]
  v_pk_add_f32 v[206:207], v[206:207], v[214:215]
  v_pk_add_f32 v[200:201], v[200:201], v[204:205]
  v_pk_add_f32 v[202:203], v[202:203], v[206:207]
  v_mov_b32 v204, v200
  v_mov_b32 v205, v201
  v_mov_b32 v206, v202
  v_mov_b32 v207, v203
  v_permlane32_swap_b32 v200, v204
  v_permlane32_swap_b32 v201, v205
  v_permlane32_swap_b32 v202, v206
  v_permlane32_swap_b32 v203, v207
  v_add_f32 v200, v200, v204
  v_add_f32 v201, v201, v205
  v_add_f32 v202, v202, v206
  v_add_f32 v203, v203, v207
  ds_write_b128 v126, v[200:203] offset:1024
Lp1_css:
  v_mfma_f32_16x16x32_bf16 v[24:27], a[44:47], a[12:15], v[24:27]
  ds_read_b64_tr_b16 a[130:131], v116 offset:6144
  ds_read_b128 v[168:171], v124 offset:1024
  v_mfma_f32_16x16x32_bf16 v[20:23], a[44:47], a[8:11], v[20:23]
  ds_read_b64_tr_b16 a[152:153], v116 offset:12288
  buffer_store_dwordx4 v[246:249], v104, s[4:7], s44 offen offset:1024 sc1
  v_mfma_f32_16x16x32_bf16 v[20:23], a[68:71], a[28:31], v[20:23]
  ds_read_b64_tr_b16 a[154:155], v116 offset:18432
  ds_read_b128 v[172:175], v124 offset:1088
  v_mfma_f32_16x16x32_bf16 v[16:19], a[68:71], a[24:27], v[16:19]
  ds_read_b128 a[92:95], v112 offset:0
  ds_read_b128 v[176:179], v124 offset:1152
  v_mfma_f32_16x16x32_bf16 v[16:19], a[44:47], a[4:7], v[16:19]
  ds_read_b128 a[112:115], v113 offset:0
  ds_read_b128 v[180:183], v124 offset:1216
  v_mfma_f32_16x16x32_bf16 v[96:99], a[48:51], a[0:3], v[96:99]
  ds_read_b128 a[96:99], v112 offset:2048
  buffer_store_dwordx4 v[246:249], v104, s[4:7], s44 offen offset:2048 sc1
  v_mfma_f32_16x16x32_bf16 v[96:99], a[72:75], a[20:23], v[96:99]
  ds_read_b128 a[116:119], v113 offset:2048
  ds_read2_b32 v[184:185], v198 offset0:64 offset1:80
  v_mfma_f32_16x16x32_bf16 v[32:35], a[72:75], a[24:27], v[32:35]
  s_xor_b32 s47, s40, 2
  ds_read_b128 a[100:103], v112 offset:4096
  s_mul_i32 s47, s47, 6144
  v_mfma_f32_16x16x32_bf16 v[32:35], a[48:51], a[4:7], v[32:35]
  s_add_u32 s47, s47, 139264
  ds_read_b128 a[120:123], v113 offset:4096
  s_add_u32 s49, s47, 3072
  v_mfma_f32_16x16x32_bf16 v[36:39], a[48:51], a[8:11], v[36:39]
  s_add_u32 s79, s47, 2048
  ds_read_b128 a[104:107], v112 offset:6144
  buffer_store_dwordx4 v[246:249], v104, s[4:7], s44 offen offset:3072 sc1
  v_mfma_f32_16x16x32_bf16 v[36:39], a[72:75], a[28:31], v[36:39]
  s_cmp_eq_u32 s57, 0
  s_cselect_b32 s49, s76, s49
  s_cselect_b32 s79, s47, s79
  ds_read_b128 a[124:127], v113 offset:6144
  v_add_u32 v198, s49, v105
  v_mfma_f32_16x16x32_bf16 v[40:43], a[72:75], a[32:35], v[40:43]
  ds_read_b64_tr_b16 a[132:133], v117 offset:0
  v_add_u32 v199, s79, v105
  v_mfma_f32_16x16x32_bf16 v[40:43], a[48:51], a[12:15], v[40:43]
  s_add_u32 m0, s62, 90112
  ds_read_b64_tr_b16 a[134:135], v117 offset:6144
  v_add_u32 v105, s76, v105
  v_mfma_f32_16x16x32_bf16 v[44:47], a[48:51], a[16:19], v[44:47]
  ds_read_b64_tr_b16 a[156:157], v117 offset:12288
  buffer_load_dwordx4 v120, s[28:31], s64 offen offset:0 sc1 lds
  v_mfma_f32_16x16x32_bf16 v[44:47], a[72:75], a[36:39], v[44:47]
  ds_read_b64_tr_b16 a[158:159], v117 offset:18432
  v_add_f32 v136, v136, v138
  v_mfma_f32_16x16x32_bf16 v[60:63], a[76:79], a[36:39], v[60:63]
  ds_read_b128 a[88:91], v114 offset:3072
  v_add_f32 v137, v137, v139
  v_mfma_f32_16x16x32_bf16 v[60:63], a[52:55], a[16:19], v[60:63]
  ds_read_b128 a[108:111], v115 offset:3072
  v_add_f32 v140, v140, v142
  v_mfma_f32_16x16x32_bf16 v[56:59], a[52:55], a[12:15], v[56:59]
  ds_read_b64_tr_b16 a[136:137], v116 offset:2048
  v_add_f32 v141, v141, v143
  v_mfma_f32_16x16x32_bf16 v[56:59], a[76:79], a[32:35], v[56:59]
  ds_read_b64_tr_b16 a[138:139], v116 offset:8192
  v_add_f32 v136, v136, v140
  v_mfma_f32_16x16x32_bf16 v[52:55], a[76:79], a[28:31], v[52:55]
  ds_read_b64_tr_b16 a[160:161], v116 offset:14336
  v_add_f32 v137, v137, v141
  v_mfma_f32_16x16x32_bf16 v[52:55], a[52:55], a[8:11], v[52:55]
  s_waitcnt vmcnt(5)
  ds_read_b64_tr_b16 a[162:163], v116 offset:20480
  v_add_f32 v144, v144, v146
  v_mfma_f32_16x16x32_bf16 v[48:51], a[52:55], a[4:7], v[48:51]
  ds_read_b64_tr_b16 a[140:141], v117 offset:2048
  buffer_load_dwordx4 v121, s[28:31], s64 offen offset:1024 sc1 lds
  v_mfma_f32_16x16x32_bf16 v[48:51], a[76:79], a[24:27], v[48:51]
  ds_read_b64_tr_b16 a[142:143], v117 offset:8192
  v_add_f32 v145, v145, v147
  v_mfma_f32_16x16x32_bf16 v[100:103], a[20:23], a[80:83], v[100:103]
  ds_read_b64_tr_b16 a[164:165], v117 offset:14336
  v_add_f32 v148, v148, v150
  v_mfma_f32_16x16x32_bf16 v[100:103], a[0:3], a[56:59], v[100:103]
  ds_read_b64_tr_b16 a[166:167], v117 offset:20480
  v_add_f32 v149, v149, v151
  v_mfma_f32_16x16x32_bf16 v[64:67], a[4:7], a[56:59], v[64:67]
  ds_read_b64_tr_b16 a[144:145], v116 offset:4096
  v_add_f32 v144, v144, v148
  v_mfma_f32_16x16x32_bf16 v[64:67], a[24:27], a[80:83], v[64:67]
  ds_read_b64_tr_b16 a[146:147], v116 offset:10240
  v_add_f32 v145, v145, v149
  v_mfma_f32_16x16x32_bf16 v[68:71], a[28:31], a[80:83], v[68:71]
  s_mov_b32 s48, 0x3a800000
  ds_read_b64_tr_b16 a[168:169], v116 offset:16384
  v_mov_b32 v240, 0x3727c5ac
  v_mfma_f32_16x16x32_bf16 v[68:71], a[8:11], a[56:59], v[68:71]
  ds_read_b64_tr_b16 a[170:171], v116 offset:22528
  v_permlane32_swap_b32 v136, v130
  v_mfma_f32_16x16x32_bf16 v[72:75], a[12:15], a[56:59], v[72:75]
  ds_read_b64_tr_b16 a[148:149], v117 offset:4096
  buffer_load_dwordx4 v122, s[28:31], s64 offen offset:2048 sc1 lds
  v_mfma_f32_16x16x32_bf16 v[72:75], a[32:35], a[80:83], v[72:75]
  ds_read_b64_tr_b16 a[150:151], v117 offset:10240
  v_permlane32_swap_b32 v137, v131
  v_mfma_f32_16x16x32_bf16 v[76:79], a[36:39], a[80:83], v[76:79]
  ds_read_b64_tr_b16 a[172:173], v117 offset:16384
  v_permlane32_swap_b32 v128, v144
  v_mfma_f32_16x16x32_bf16 v[76:79], a[16:19], a[56:59], v[76:79]
  ds_read_b64_tr_b16 a[174:175], v117 offset:22528
  v_permlane32_swap_b32 v129, v145
  v_mfma_f32_16x16x32_bf16 v[92:95], a[16:19], a[60:63], v[92:95]
  v_add_f32 v136, v136, v130
  v_add_f32 v128, v128, v144
  v_mfma_f32_16x16x32_bf16 v[92:95], a[36:39], a[84:87], v[92:95]
  v_add_f32 v137, v137, v131
  v_add_f32 v129, v129, v145
  v_mfma_f32_16x16x32_bf16 v[88:91], a[32:35], a[84:87], v[88:91]
  v_permlane16_swap_b32 v128, v136
  v_mfma_f32_16x16x32_bf16 v[88:91], a[12:15], a[60:63], v[88:91]
  s_nop 0
  v_permlane16_swap_b32 v129, v137
  v_add_f32 v128, v128, v136
  v_mfma_f32_16x16x32_bf16 v[84:87], a[8:11], a[60:63], v[84:87]
  buffer_load_dwordx4 v123, s[28:31], s64 offen offset:3072 sc1 lds
  v_add_f32 v129, v129, v137
  v_mfma_f32_16x16x32_bf16 v[84:87], a[28:31], a[84:87], v[84:87]
  v_mul_f32 v128, 0xba800000, v128
  v_fma_f32 v129, v129, s48, v240
  v_mfma_f32_16x16x32_bf16 v[80:83], a[24:27], a[84:87], v[80:83]
  v_fma_f32 v129, -v128, v128, v129
  v_max_f32 v129, v129, v240
  v_mfma_f32_16x16x32_bf16 v[80:83], a[4:7], a[60:63], v[80:83]
  v_rsq_f32 v129, v129
  s_nop 0
  s_waitcnt lgkmcnt(15)
  v_mfma_f32_16x16x32_bf16 v[0:3], a[128:131], a[92:95], v[0:3]
  ds_write2_b32 v106, v128, v129 offset0:0 offset1:16
  v_mfma_f32_16x16x32_bf16 v[0:3], a[152:155], a[112:115], v[0:3]
  s_add_u32 m0, s89, 40960
  v_mfma_f32_16x16x32_bf16 v[4:7], a[152:155], a[116:119], v[4:7]
  s_xor_b32 s92, s88, 655360
  v_mfma_f32_16x16x32_bf16 v[4:7], a[128:131], a[96:99], v[4:7]
  buffer_load_dwordx4 v186, s[12:15], s92 offen lds
  v_mfma_f32_16x16x32_bf16 v[8:11], a[128:131], a[100:103], v[8:11]
  v_mfma_f32_16x16x32_bf16 v[8:11], a[152:155], a[120:123], v[8:11]
  v_mfma_f32_16x16x32_bf16 v[12:15], a[152:155], a[124:127], v[12:15]
  v_mfma_f32_16x16x32_bf16 v[12:15], a[128:131], a[104:107], v[12:15]
  s_add_u32 m0, s89, 45056
  v_mfma_f32_16x16x32_bf16 v[28:31], a[132:135], a[104:107], v[28:31]
  s_xor_b32 s92, s88, 720896
  v_mfma_f32_16x16x32_bf16 v[28:31], a[156:159], a[124:127], v[28:31]
  buffer_load_dwordx4 v186, s[12:15], s92 offen lds
  v_mfma_f32_16x16x32_bf16 v[24:27], a[156:159], a[120:123], v[24:27]
  s_waitcnt lgkmcnt(0)
  s_barrier
  ds_read2_b32 v[190:191], v167 offset0:32 offset1:48
  ds_read2_b32 v[192:193], v167 offset0:64 offset1:80
  v_mfma_f32_16x16x32_bf16 v[24:27], a[132:135], a[100:103], v[24:27]
  ds_read2_b32 v[194:195], v167 offset0:96 offset1:112
  ds_read2_b32 v[196:197], v167 offset0:128 offset1:144
  v_mfma_f32_16x16x32_bf16 v[20:23], a[132:135], a[96:99], v[20:23]
  ds_read2_b32 v[188:189], v166 offset0:0 offset1:16
  ds_read_b128 v[128:131], v107
  v_mfma_f32_16x16x32_bf16 v[20:23], a[156:159], a[116:119], v[20:23]
  s_add_u32 m0, s89, 49152
  ds_read_b128 v[132:135], v107 offset:1024
  ds_read_b128 v[200:203], v164 offset:0
  v_mfma_f32_16x16x32_bf16 v[16:19], a[156:159], a[112:115], v[16:19]
  s_xor_b32 s92, s88, 786432
  ds_read_b128 v[220:223], v164 offset:64
  ds_read_b128 v[216:219], v165 offset:512
  v_mfma_f32_16x16x32_bf16 v[16:19], a[132:135], a[92:95], v[16:19]
  buffer_load_dwordx4 v186, s[12:15], s92 offen lds
  ds_read_b128 v[236:239], v165 offset:576
  v_mfma_f32_16x16x32_bf16 v[96:99], a[136:139], a[88:91], v[96:99]
  ds_read_b128 v[204:207], v165 offset:128
  ds_read_b128 v[224:227], v165 offset:192
  v_mfma_f32_16x16x32_bf16 v[96:99], a[160:163], a[108:111], v[96:99]
  ds_read_b128 v[208:211], v165 offset:256
  ds_read_b128 v[228:231], v165 offset:320
  v_mfma_f32_16x16x32_bf16 v[32:35], a[160:163], a[112:115], v[32:35]
  ds_read_b128 v[212:215], v165 offset:384
  ds_read_b128 v[232:235], v165 offset:448
  v_mfma_f32_16x16x32_bf16 v[32:35], a[136:139], a[92:95], v[32:35]
  s_add_u32 m0, s89, 53248
  s_and_b32 s43, s50, 7
  s_or_b32 s43, s43, s57
  v_mfma_f32_16x16x32_bf16 v[36:39], a[136:139], a[96:99], v[36:39]
  s_cselect_b64 s[46:47], -1, 0
  s_xor_b32 s92, s88, 851968
  v_mov_b32 v245, 0xf149f2ca
  v_mfma_f32_16x16x32_bf16 v[36:39], a[160:163], a[116:119], v[36:39]
  s_waitcnt lgkmcnt(10)
  buffer_load_dwordx4 v186, s[12:15], s92 offen lds
  v_fmac_f32 v12, v168, v196
  v_mfma_f32_16x16x32_bf16 v[40:43], a[160:163], a[120:123], v[40:43]
  v_fmac_f32 v13, v169, v196
  v_fmac_f32 v14, v170, v196
  v_mfma_f32_16x16x32_bf16 v[40:43], a[136:139], a[100:103], v[40:43]
  v_fmac_f32 v15, v171, v196
  v_fmac_f32 v28, v172, v196
  v_mfma_f32_16x16x32_bf16 v[44:47], a[136:139], a[104:107], v[44:47]
  v_fmac_f32 v29, v173, v196
  v_fmac_f32 v30, v174, v196
  v_mfma_f32_16x16x32_bf16 v[44:47], a[160:163], a[124:127], v[44:47]
  s_add_u32 m0, s89, 57344
  v_fmac_f32 v31, v175, v196
  v_cvt_pk_bf16_f32 v12, v12, v13
  v_mfma_f32_16x16x32_bf16 v[60:63], a[164:167], a[124:127], v[60:63]
  s_xor_b32 s92, s88, 917504
  v_cvt_pk_bf16_f32 v13, v14, v15
  v_cvt_pk_bf16_f32 v14, v28, v29
  v_mfma_f32_16x16x32_bf16 v[60:63], a[140:143], a[104:107], v[60:63]
  buffer_load_dwordx4 v186, s[12:15], s92 offen lds
  v_cvt_pk_bf16_f32 v15, v30, v31
  v_mfma_f32_16x16x32_bf16 v[56:59], a[140:143], a[100:103], v[56:59]
  v_fmac_f32 v8, v168, v194
  v_fmac_f32 v9, v169, v194
  v_mfma_f32_16x16x32_bf16 v[56:59], a[164:167], a[120:123], v[56:59]
  v_fmac_f32 v10, v170, v194
  v_fmac_f32 v11, v171, v194
  v_mfma_f32_16x16x32_bf16 v[52:55], a[164:167], a[116:119], v[52:55]
  v_fmac_f32 v24, v172, v194
  v_fmac_f32 v25, v173, v194
  v_mfma_f32_16x16x32_bf16 v[52:55], a[140:143], a[96:99], v[52:55]
  s_add_u32 m0, s89, 61440
  v_fmac_f32 v26, v174, v194
  v_fmac_f32 v27, v175, v194
  v_mfma_f32_16x16x32_bf16 v[48:51], a[140:143], a[92:95], v[48:51]
  s_xor_b32 s92, s88, 983040
  v_cvt_pk_bf16_f32 v8, v8, v9
  v_cvt_pk_bf16_f32 v9, v10, v11
  v_mfma_f32_16x16x32_bf16 v[48:51], a[164:167], a[112:115], v[48:51]
  buffer_load_dwordx4 v186, s[12:15], s92 offen lds
  v_cvt_pk_bf16_f32 v10, v24, v25
  v_mfma_f32_16x16x32_bf16 v[100:103], a[108:111], a[168:171], v[100:103]
  v_cvt_pk_bf16_f32 v11, v26, v27
  v_fmac_f32 v4, v168, v192
  v_mfma_f32_16x16x32_bf16 v[100:103], a[88:91], a[144:147], v[100:103]
  v_fmac_f32 v5, v169, v192
  v_fmac_f32 v6, v170, v192
  v_mfma_f32_16x16x32_bf16 v[64:67], a[92:95], a[144:147], v[64:67]
  v_fmac_f32 v7, v171, v192
  v_fmac_f32 v20, v172, v192
  v_mfma_f32_16x16x32_bf16 v[64:67], a[112:115], a[168:171], v[64:67]
  s_add_u32 m0, s89, 65536
  v_fmac_f32 v21, v173, v192
  v_fmac_f32 v22, v174, v192
  v_mfma_f32_16x16x32_bf16 v[68:71], a[116:119], a[168:171], v[68:71]
  s_xor_b32 s92, s88, 1048576
  v_fmac_f32 v23, v175, v192
  v_cvt_pk_bf16_f32 v4, v4, v5
  v_mfma_f32_16x16x32_bf16 v[68:71], a[96:99], a[144:147], v[68:71]
  buffer_load_dwordx4 v186, s[12:15], s92 offen lds
  v_cvt_pk_bf16_f32 v5, v6, v7
  v_mfma_f32_16x16x32_bf16 v[72:75], a[100:103], a[144:147], v[72:75]
  v_cvt_pk_bf16_f32 v6, v20, v21
  v_cvt_pk_bf16_f32 v7, v22, v23
  v_mfma_f32_16x16x32_bf16 v[72:75], a[120:123], a[168:171], v[72:75]
  v_fmac_f32 v0, v168, v190
  v_fmac_f32 v1, v169, v190
  v_mfma_f32_16x16x32_bf16 v[76:79], a[124:127], a[168:171], v[76:79]
  v_fmac_f32 v2, v170, v190
  v_fmac_f32 v3, v171, v190
  v_mfma_f32_16x16x32_bf16 v[76:79], a[104:107], a[144:147], v[76:79]
  s_add_u32 m0, s89, 69632
  v_fmac_f32 v16, v172, v190
  v_fmac_f32 v17, v173, v190
  v_mfma_f32_16x16x32_bf16 v[92:95], a[104:107], a[148:151], v[92:95]
  s_xor_b32 s92, s88, 1114112
  v_fmac_f32 v18, v174, v190
  v_fmac_f32 v19, v175, v190
  v_mfma_f32_16x16x32_bf16 v[92:95], a[124:127], a[172:175], v[92:95]
  buffer_load_dwordx4 v186, s[12:15], s92 offen lds
  v_cvt_pk_bf16_f32 v0, v0, v1
  v_mfma_f32_16x16x32_bf16 v[88:91], a[120:123], a[172:175], v[88:91]
  v_cvt_pk_bf16_f32 v1, v2, v3
  v_cvt_pk_bf16_f32 v2, v16, v17
  v_mfma_f32_16x16x32_bf16 v[88:91], a[100:103], a[148:151], v[88:91]
  v_cvt_pk_bf16_f32 v3, v18, v19
  v_cndmask_b32 v136, v245, v132, s[46:47]
  v_mfma_f32_16x16x32_bf16 v[84:87], a[96:99], a[148:151], v[84:87]
  v_mov_b32 v160, 0x3f803f80
  v_mul_f32 v108, 0x3e8293ee, v191
  v_mfma_f32_16x16x32_bf16 v[84:87], a[116:119], a[172:175], v[84:87]
  v_cndmask_b32 v137, v245, v133, s[46:47]
  v_mov_b32 v161, 0x3f803f80
  v_mfma_f32_16x16x32_bf16 v[80:83], a[112:115], a[172:175], v[80:83]
  v_mul_f32 v109, 0x3e8293ee, v193
  v_cndmask_b32 v138, v245, v134, s[46:47]
  v_mfma_f32_16x16x32_bf16 v[80:83], a[92:95], a[148:151], v[80:83]
  v_mov_b32 v162, 0x3f803f80
  v_mul_f32 v110, 0x3e8293ee, v195
Lmk_p1epi:
  v_cndmask_b32 v139, v245, v135, s[46:47]
  v_mov_b32 v163, 0x3f803f80
  v_mul_f32 v111, 0x3e8293ee, v197
  s_waitcnt lgkmcnt(0)
  v_pk_fma_f32 v[96:97], v[176:177], v[188:189], v[96:97] op_sel:[0,0,0] op_sel_hi:[1,0,1]
  v_pk_fma_f32 v[98:99], v[178:179], v[188:189], v[98:99] op_sel:[0,0,0] op_sel_hi:[1,0,1]
  v_pk_mul_f32 v[96:97], v[96:97], v[188:189] op_sel:[0,1] op_sel_hi:[1,1]
  v_pk_mul_f32 v[98:99], v[98:99], v[188:189] op_sel:[0,1] op_sel_hi:[1,1]
  v_cvt_pk_bf16_f32 v96, v96, v97
  v_cvt_pk_bf16_f32 v97, v98, v99
  v_pk_fma_f32 v[44:45], v[176:177], v[196:197], v[44:45] op_sel:[0,0,0] op_sel_hi:[1,0,1]
  v_pk_fma_f32 v[46:47], v[178:179], v[196:197], v[46:47] op_sel:[0,0,0] op_sel_hi:[1,0,1]
  v_pk_fma_f32 v[60:61], v[180:181], v[196:197], v[60:61] op_sel:[0,0,0] op_sel_hi:[1,0,1]
  v_pk_fma_f32 v[62:63], v[182:183], v[196:197], v[62:63] op_sel:[0,0,0] op_sel_hi:[1,0,1]
  v_pk_mul_f32 v[44:45], v[44:45], v[196:197] op_sel:[0,1] op_sel_hi:[1,1]
  v_pk_mul_f32 v[46:47], v[46:47], v[196:197] op_sel:[0,1] op_sel_hi:[1,1]
  v_pk_mul_f32 v[60:61], v[60:61], v[196:197] op_sel:[0,1] op_sel_hi:[1,1]
  v_pk_mul_f32 v[62:63], v[62:63], v[196:197] op_sel:[0,1] op_sel_hi:[1,1]
  v_cvt_pk_bf16_f32 v44, v44, v45
  v_cvt_pk_bf16_f32 v45, v46, v47
  v_cvt_pk_bf16_f32 v46, v60, v61
  v_cvt_pk_bf16_f32 v47, v62, v63
  v_pk_fma_f32 v[100:101], v[200:201], v[184:185], v[100:101] op_sel:[0,0,0] op_sel_hi:[1,0,1]
  v_pk_fma_f32 v[102:103], v[202:203], v[184:185], v[102:103] op_sel:[0,0,0] op_sel_hi:[1,0,1]
  v_pk_mul_f32 v[100:101], v[100:101], v[220:221]
  v_pk_mul_f32 v[102:103], v[102:103], v[222:223]
  v_cvt_pk_bf16_f32 v100, v100, v101
  v_cvt_pk_bf16_f32 v101, v102, v103
  v_pk_fma_f32 v[76:77], v[216:217], v[184:185], v[76:77] op_sel:[0,0,0] op_sel_hi:[1,0,1]
  v_pk_fma_f32 v[78:79], v[218:219], v[184:185], v[78:79] op_sel:[0,0,0] op_sel_hi:[1,0,1]
  v_pk_fma_f32 v[92:93], v[216:217], v[184:185], v[92:93] op_sel:[0,1,0] op_sel_hi:[1,1,1]
  v_pk_fma_f32 v[94:95], v[218:219], v[184:185], v[94:95] op_sel:[0,1,0] op_sel_hi:[1,1,1]
  v_pk_mul_f32 v[76:77], v[76:77], v[236:237]
  v_pk_mul_f32 v[78:79], v[78:79], v[238:239]
  v_pk_mul_f32 v[92:93], v[92:93], v[236:237]
  v_pk_mul_f32 v[94:95], v[94:95], v[238:239]
  v_cvt_pk_bf16_f32 v148, v76, v77
  v_cvt_pk_bf16_f32 v149, v78, v79
  v_cvt_pk_bf16_f32 v158, v92, v93
  v_cvt_pk_bf16_f32 v159, v94, v95
  ds_write2st64_b64 v105, v[96:97], v[100:101] offset0:0 offset1:1
  ds_write2st64_b64 v105, v[44:45], v[148:149] offset0:4 offset1:5
  ds_write2st64_b64 v105, v[46:47], v[158:159] offset0:6 offset1:7
  s_add_u32 m0, s89, 0
  s_xor_b32 s92, s88, 0
  buffer_load_dwordx4 v186, s[12:15], s92 offen lds
  v_pk_fma_f32 v[40:41], v[176:177], v[194:195], v[40:41] op_sel:[0,0,0] op_sel_hi:[1,0,1]
  v_pk_fma_f32 v[42:43], v[178:179], v[194:195], v[42:43] op_sel:[0,0,0] op_sel_hi:[1,0,1]
  v_pk_fma_f32 v[56:57], v[180:181], v[194:195], v[56:57] op_sel:[0,0,0] op_sel_hi:[1,0,1]
  v_pk_fma_f32 v[58:59], v[182:183], v[194:195], v[58:59] op_sel:[0,0,0] op_sel_hi:[1,0,1]
  v_pk_mul_f32 v[40:41], v[40:41], v[194:195] op_sel:[0,1] op_sel_hi:[1,1]
  v_pk_mul_f32 v[42:43], v[42:43], v[194:195] op_sel:[0,1] op_sel_hi:[1,1]
  v_pk_mul_f32 v[56:57], v[56:57], v[194:195] op_sel:[0,1] op_sel_hi:[1,1]
  v_pk_mul_f32 v[58:59], v[58:59], v[194:195] op_sel:[0,1] op_sel_hi:[1,1]
  v_cvt_pk_bf16_f32 v40, v40, v41
  v_cvt_pk_bf16_f32 v41, v42, v43
  v_cvt_pk_bf16_f32 v42, v56, v57
  v_cvt_pk_bf16_f32 v43, v58, v59
  s_add_u32 m0, s89, 4096
  s_xor_b32 s92, s88, 65536
  buffer_load_dwordx4 v186, s[12:15], s92 offen lds
  v_pk_fma_f32 v[36:37], v[176:177], v[192:193], v[36:37] op_sel:[0,0,0] op_sel_hi:[1,0,1]
  v_pk_fma_f32 v[38:39], v[178:179], v[192:193], v[38:39] op_sel:[0,0,0] op_sel_hi:[1,0,1]
  v_pk_fma_f32 v[52:53], v[180:181], v[192:193], v[52:53] op_sel:[0,0,0] op_sel_hi:[1,0,1]
  v_pk_fma_f32 v[54:55], v[182:183], v[192:193], v[54:55] op_sel:[0,0,0] op_sel_hi:[1,0,1]
  v_pk_mul_f32 v[36:37], v[36:37], v[192:193] op_sel:[0,1] op_sel_hi:[1,1]
  v_pk_mul_f32 v[38:39], v[38:39], v[192:193] op_sel:[0,1] op_sel_hi:[1,1]
  v_pk_mul_f32 v[52:53], v[52:53], v[192:193] op_sel:[0,1] op_sel_hi:[1,1]
  v_pk_mul_f32 v[54:55], v[54:55], v[192:193] op_sel:[0,1] op_sel_hi:[1,1]
  v_cvt_pk_bf16_f32 v36, v36, v37
  v_cvt_pk_bf16_f32 v37, v38, v39
  v_cvt_pk_bf16_f32 v38, v52, v53
  v_cvt_pk_bf16_f32 v39, v54, v55
  s_add_u32 m0, s89, 8192
  s_xor_b32 s92, s88, 131072
  buffer_load_dwordx4 v186, s[12:15], s92 offen lds
  v_pk_fma_f32 v[32:33], v[176:177], v[190:191], v[32:33] op_sel:[0,0,0] op_sel_hi:[1,0,1]
  v_pk_fma_f32 v[34:35], v[178:179], v[190:191], v[34:35] op_sel:[0,0,0] op_sel_hi:[1,0,1]
  v_pk_fma_f32 v[48:49], v[180:181], v[190:191], v[48:49] op_sel:[0,0,0] op_sel_hi:[1,0,1]
  v_pk_fma_f32 v[50:51], v[182:183], v[190:191], v[50:51] op_sel:[0,0,0] op_sel_hi:[1,0,1]
  v_pk_mul_f32 v[32:33], v[32:33], v[190:191] op_sel:[0,1] op_sel_hi:[1,1]
  v_pk_mul_f32 v[34:35], v[34:35], v[190:191] op_sel:[0,1] op_sel_hi:[1,1]
  v_pk_mul_f32 v[48:49], v[48:49], v[190:191] op_sel:[0,1] op_sel_hi:[1,1]
  v_pk_mul_f32 v[50:51], v[50:51], v[190:191] op_sel:[0,1] op_sel_hi:[1,1]
  v_cvt_pk_bf16_f32 v32, v32, v33
  v_cvt_pk_bf16_f32 v33, v34, v35
  v_cvt_pk_bf16_f32 v34, v48, v49
  v_cvt_pk_bf16_f32 v35, v50, v51
  s_waitcnt lgkmcnt(0)
  s_barrier
  ds_read_b64 v[120:121], v198
  ds_read_b64 v[122:123], v199
  ds_read_b64 v[140:141], v198 offset:512
  ds_read_b64 v[150:151], v199 offset:512
  v_mfma_f32_16x16x32_bf16 v[60:63], v[44:47], v[12:15], v[128:131]
  v_mfma_f32_16x16x32_bf16 v[28:31], v[40:43], v[12:15], v[132:135]
  v_mfma_f32_16x16x32_bf16 v[56:59], v[40:43], v[8:11], v[128:131]
  v_mfma_f32_16x16x32_bf16 v[24:27], v[36:39], v[8:11], v[132:135]
  v_mfma_f32_16x16x32_bf16 v[52:55], v[36:39], v[4:7], v[128:131]
  v_mfma_f32_16x16x32_bf16 v[20:23], v[32:35], v[4:7], v[132:135]
  v_mfma_f32_16x16x32_bf16 v[48:51], v[32:35], v[0:3], v[128:131]
  s_waitcnt lgkmcnt(0)
  v_mfma_f32_16x16x32_bf16 v[16:19], v[120:123], v[0:3], v[136:139]
  s_add_u32 m0, s89, 12288
  s_xor_b32 s92, s88, 196608
  buffer_load_dwordx4 v186, s[12:15], s92 offen lds
  v_pk_fma_f32 v[64:65], v[204:205], v[184:185], v[64:65] op_sel:[0,0,0] op_sel_hi:[1,0,1]
  v_pk_fma_f32 v[66:67], v[206:207], v[184:185], v[66:67] op_sel:[0,0,0] op_sel_hi:[1,0,1]
  v_pk_fma_f32 v[80:81], v[204:205], v[184:185], v[80:81] op_sel:[0,1,0] op_sel_hi:[1,1,1]
  v_pk_fma_f32 v[82:83], v[206:207], v[184:185], v[82:83] op_sel:[0,1,0] op_sel_hi:[1,1,1]
  v_pk_mul_f32 v[64:65], v[64:65], v[224:225]
  v_pk_mul_f32 v[66:67], v[66:67], v[226:227]
  v_pk_mul_f32 v[80:81], v[80:81], v[224:225]
  v_pk_mul_f32 v[82:83], v[82:83], v[226:227]
  v_cvt_pk_bf16_f32 v142, v64, v65
  v_cvt_pk_bf16_f32 v143, v66, v67
  v_cvt_pk_bf16_f32 v152, v80, v81
  v_cvt_pk_bf16_f32 v153, v82, v83
  s_add_u32 m0, s89, 16384
  s_xor_b32 s92, s88, 262144
  buffer_load_dwordx4 v186, s[12:15], s92 offen lds
  v_pk_fma_f32 v[68:69], v[208:209], v[184:185], v[68:69] op_sel:[0,0,0] op_sel_hi:[1,0,1]
  v_pk_fma_f32 v[70:71], v[210:211], v[184:185], v[70:71] op_sel:[0,0,0] op_sel_hi:[1,0,1]
  v_pk_fma_f32 v[84:85], v[208:209], v[184:185], v[84:85] op_sel:[0,1,0] op_sel_hi:[1,1,1]
  v_pk_fma_f32 v[86:87], v[210:211], v[184:185], v[86:87] op_sel:[0,1,0] op_sel_hi:[1,1,1]
  v_pk_mul_f32 v[68:69], v[68:69], v[228:229]
  v_pk_mul_f32 v[70:71], v[70:71], v[230:231]
  v_pk_mul_f32 v[84:85], v[84:85], v[228:229]
  v_pk_mul_f32 v[86:87], v[86:87], v[230:231]
  v_cvt_pk_bf16_f32 v144, v68, v69
  v_cvt_pk_bf16_f32 v145, v70, v71
  v_cvt_pk_bf16_f32 v154, v84, v85
  v_cvt_pk_bf16_f32 v155, v86, v87
  s_add_u32 m0, s89, 20480
  s_xor_b32 s92, s88, 327680
  buffer_load_dwordx4 v186, s[12:15], s92 offen lds
  v_pk_fma_f32 v[72:73], v[212:213], v[184:185], v[72:73] op_sel:[0,0,0] op_sel_hi:[1,0,1]
  v_pk_fma_f32 v[74:75], v[214:215], v[184:185], v[74:75] op_sel:[0,0,0] op_sel_hi:[1,0,1]
  v_pk_fma_f32 v[88:89], v[212:213], v[184:185], v[88:89] op_sel:[0,1,0] op_sel_hi:[1,1,1]
  v_pk_fma_f32 v[90:91], v[214:215], v[184:185], v[90:91] op_sel:[0,1,0] op_sel_hi:[1,1,1]
  v_pk_mul_f32 v[72:73], v[72:73], v[232:233]
  v_pk_mul_f32 v[74:75], v[74:75], v[234:235]
  v_pk_mul_f32 v[88:89], v[88:89], v[232:233]
  v_pk_mul_f32 v[90:91], v[90:91], v[234:235]
  v_cvt_pk_bf16_f32 v146, v72, v73
  v_cvt_pk_bf16_f32 v147, v74, v75
  v_cvt_pk_bf16_f32 v156, v88, v89
  v_cvt_pk_bf16_f32 v157, v90, v91
  s_add_u32 m0, s89, 24576
  s_xor_b32 s92, s88, 393216
  buffer_load_dwordx4 v186, s[12:15], s92 offen lds
  s_cmp_eq_u32 s57, 0
  s_cbranch_scc1 Lp1_nsw
  v_swap_b32 v140, v150
  v_swap_b32 v141, v151
  v_swap_b32 v142, v152
  v_swap_b32 v143, v153
  v_swap_b32 v144, v154
  v_swap_b32 v145, v155
  v_swap_b32 v146, v156
  v_swap_b32 v147, v157
  v_swap_b32 v148, v158
  v_swap_b32 v149, v159
Lp1_nsw:
  v_max3_f32 v240, v16, v17, v18
  v_max3_f32 v241, v20, v21, v22
  v_max3_f32 v242, v24, v25, v26
  v_max3_f32 v243, v28, v29, v30
  v_max3_f32 v240, v240, v19, v48
  v_max3_f32 v241, v241, v23, v52
  v_max3_f32 v242, v242, v27, v56
  v_max3_f32 v243, v243, v31, v60
  v_max3_f32 v240, v240, v49, v50
  v_max3_f32 v241, v241, v53, v54
  v_max3_f32 v242, v242, v57, v58
  v_max3_f32 v243, v243, v61, v62
  v_max_f32 v240, v240, v51
  v_max_f32 v241, v241, v55
  v_max_f32 v242, v242, v59
  v_max_f32 v243, v243, v63
  v_mov_b32 v244, v240
  v_mov_b32 v245, v241
  v_mov_b32 v246, v242
  v_mov_b32 v247, v243
  v_permlane32_swap_b32 v240, v244
  v_permlane32_swap_b32 v241, v245
  v_permlane32_swap_b32 v242, v246
  v_permlane32_swap_b32 v243, v247
  v_max_f32 v240, v240, v244
  v_max_f32 v241, v241, v245
  v_max_f32 v242, v242, v246
  v_max_f32 v243, v243, v247
  v_mov_b32 v244, v240
  v_mov_b32 v245, v241
  v_mov_b32 v246, v242
  v_mov_b32 v247, v243
  v_permlane16_swap_b32 v240, v244
  v_permlane16_swap_b32 v241, v245
  v_permlane16_swap_b32 v242, v246
  v_permlane16_swap_b32 v243, v247
  v_max_f32 v240, v240, v244
  v_max_f32 v241, v241, v245
  v_max_f32 v242, v242, v246
  v_max_f32 v243, v243, v247
  v_pk_mul_f32 v[240:241], v[240:241], v[108:109] neg_lo:[0,1] neg_hi:[0,1]
  v_pk_mul_f32 v[242:243], v[242:243], v[110:111] neg_lo:[0,1] neg_hi:[0,1]
  v_pk_fma_f32 v[16:17], v[16:17], v[108:109], v[240:241] op_sel:[0,0,0] op_sel_hi:[1,0,0]
  v_pk_fma_f32 v[18:19], v[18:19], v[108:109], v[240:241] op_sel:[0,0,0] op_sel_hi:[1,0,0]
  v_pk_fma_f32 v[48:49], v[48:49], v[108:109], v[240:241] op_sel:[0,0,0] op_sel_hi:[1,0,0]
  v_pk_fma_f32 v[50:51], v[50:51], v[108:109], v[240:241] op_sel:[0,0,0] op_sel_hi:[1,0,0]
  v_exp_f32 v16, v16
  v_exp_f32 v17, v17
  v_exp_f32 v18, v18
  v_exp_f32 v19, v19
  v_exp_f32 v48, v48
  v_exp_f32 v49, v49
  v_exp_f32 v50, v50
  v_exp_f32 v51, v51
  v_cvt_pk_bf16_f32 v0, v16, v17
  v_cvt_pk_bf16_f32 v1, v18, v19
  v_cvt_pk_bf16_f32 v2, v48, v49
  v_cvt_pk_bf16_f32 v3, v50, v51
  s_add_u32 m0, s89, 28672
  s_xor_b32 s92, s88, 458752
  buffer_load_dwordx4 v186, s[12:15], s92 offen lds
  v_pk_fma_f32 v[20:21], v[20:21], v[108:109], v[240:241] op_sel:[0,1,1] op_sel_hi:[1,1,1]
  v_pk_fma_f32 v[22:23], v[22:23], v[108:109], v[240:241] op_sel:[0,1,1] op_sel_hi:[1,1,1]
  v_pk_fma_f32 v[52:53], v[52:53], v[108:109], v[240:241] op_sel:[0,1,1] op_sel_hi:[1,1,1]
  v_pk_fma_f32 v[54:55], v[54:55], v[108:109], v[240:241] op_sel:[0,1,1] op_sel_hi:[1,1,1]
  v_exp_f32 v20, v20
  v_exp_f32 v21, v21
  v_exp_f32 v22, v22
  v_exp_f32 v23, v23
  v_exp_f32 v52, v52
  v_exp_f32 v53, v53
  v_exp_f32 v54, v54
  v_exp_f32 v55, v55
  v_cvt_pk_bf16_f32 v4, v20, v21
  v_cvt_pk_bf16_f32 v5, v22, v23
  v_cvt_pk_bf16_f32 v6, v52, v53
  v_cvt_pk_bf16_f32 v7, v54, v55
  s_add_u32 m0, s89, 32768
  s_xor_b32 s92, s88, 524288
  buffer_load_dwordx4 v186, s[12:15], s92 offen lds
  v_pk_fma_f32 v[24:25], v[24:25], v[110:111], v[242:243] op_sel:[0,0,0] op_sel_hi:[1,0,0]
  v_pk_fma_f32 v[26:27], v[26:27], v[110:111], v[242:243] op_sel:[0,0,0] op_sel_hi:[1,0,0]
  v_pk_fma_f32 v[56:57], v[56:57], v[110:111], v[242:243] op_sel:[0,0,0] op_sel_hi:[1,0,0]
  v_pk_fma_f32 v[58:59], v[58:59], v[110:111], v[242:243] op_sel:[0,0,0] op_sel_hi:[1,0,0]
  v_exp_f32 v24, v24
  v_exp_f32 v25, v25
  v_exp_f32 v26, v26
  v_exp_f32 v27, v27
  v_exp_f32 v56, v56
  v_exp_f32 v57, v57
  v_exp_f32 v58, v58
  v_exp_f32 v59, v59
  v_cvt_pk_bf16_f32 v8, v24, v25
  v_cvt_pk_bf16_f32 v9, v26, v27
  v_cvt_pk_bf16_f32 v10, v56, v57
  v_cvt_pk_bf16_f32 v11, v58, v59
  v_pk_fma_f32 v[28:29], v[28:29], v[110:111], v[242:243] op_sel:[0,1,1] op_sel_hi:[1,1,1]
  v_pk_fma_f32 v[30:31], v[30:31], v[110:111], v[242:243] op_sel:[0,1,1] op_sel_hi:[1,1,1]
  v_pk_fma_f32 v[60:61], v[60:61], v[110:111], v[242:243] op_sel:[0,1,1] op_sel_hi:[1,1,1]
  v_pk_fma_f32 v[62:63], v[62:63], v[110:111], v[242:243] op_sel:[0,1,1] op_sel_hi:[1,1,1]
  v_exp_f32 v28, v28
  v_exp_f32 v29, v29
  v_exp_f32 v30, v30
  v_exp_f32 v31, v31
  v_exp_f32 v60, v60
  v_exp_f32 v61, v61
  v_exp_f32 v62, v62
  v_exp_f32 v63, v63
  v_cvt_pk_bf16_f32 v12, v28, v29
  v_cvt_pk_bf16_f32 v13, v30, v31
  v_cvt_pk_bf16_f32 v14, v60, v61
  v_cvt_pk_bf16_f32 v15, v62, v63
  s_add_u32 m0, s89, 36864
  s_xor_b32 s92, s88, 589824
  buffer_load_dwordx4 v186, s[12:15], s92 offen lds
  v_mfma_f32_16x16x32_bf16 v[32:35], v[160:163], v[0:3], 0
  s_lshl_b32 s43, s74, 15
  s_lshl_b32 s44, s75, 10
  v_mfma_f32_16x16x32_bf16 v[36:39], v[160:163], v[4:7], 0
  s_add_u32 s43, s43, s44
  s_add_u32 s43, s43, s42
  v_mfma_f32_16x16x32_bf16 v[40:43], v[160:163], v[8:11], 0
  s_add_u32 s46, s43, 8388608
  s_add_u32 s47, s46, 32768
  v_mfma_f32_16x16x32_bf16 v[44:47], v[160:163], v[12:15], 0
  s_add_u32 s48, s47, 32768
  s_add_u32 s49, s48, 32768
  v_mfma_f32_16x16x32_bf16 v[64:67], v[140:143], v[0:3], 0
  s_lshl_b32 s77, s50, 1
  v_mfma_f32_16x16x32_bf16 v[80:83], v[150:153], v[0:3], 0
  s_lshr_b32 s43, s51, 3
  v_mfma_f32_16x16x32_bf16 v[68:71], v[142:145], v[4:7], 0
  s_add_u32 s77, s77, s43
  v_mfma_f32_16x16x32_bf16 v[84:87], v[152:155], v[4:7], 0
  s_lshl_b32 s77, s77, 7
  v_mfma_f32_16x16x32_bf16 v[72:75], v[144:147], v[8:11], 0
  s_add_u32 s77, s77, s42
  v_rcp_f32 v32, v32
  v_mfma_f32_16x16x32_bf16 v[88:91], v[154:157], v[8:11], 0
  s_add_u32 s77, s77, 27787264
  v_rcp_f32 v36, v36
  v_mfma_f32_16x16x32_bf16 v[76:79], v[146:149], v[12:15], 0
  v_rcp_f32 v40, v40
  v_mfma_f32_16x16x32_bf16 v[92:95], v[156:159], v[12:15], 0
  v_rcp_f32 v44, v44
  v_pk_mul_f32 v[64:65], v[64:65], v[32:33] op_sel:[0,0] op_sel_hi:[1,0]
  v_pk_mul_f32 v[66:67], v[66:67], v[32:33] op_sel:[0,0] op_sel_hi:[1,0]
  v_pk_mul_f32 v[80:81], v[80:81], v[32:33] op_sel:[0,0] op_sel_hi:[1,0]
  v_pk_mul_f32 v[82:83], v[82:83], v[32:33] op_sel:[0,0] op_sel_hi:[1,0]
  v_cvt_pk_bf16_f32 v16, v64, v65
  v_cvt_pk_bf16_f32 v17, v66, v67
  v_cvt_pk_bf16_f32 v18, v80, v81
  v_cvt_pk_bf16_f32 v19, v82, v83
  buffer_store_dwordx4 v[16:19], v104, s[4:7], s46 offen sc1
  v_pk_mul_f32 v[68:69], v[68:69], v[36:37] op_sel:[0,0] op_sel_hi:[1,0]
  v_pk_mul_f32 v[70:71], v[70:71], v[36:37] op_sel:[0,0] op_sel_hi:[1,0]
  v_pk_mul_f32 v[84:85], v[84:85], v[36:37] op_sel:[0,0] op_sel_hi:[1,0]
  v_pk_mul_f32 v[86:87], v[86:87], v[36:37] op_sel:[0,0] op_sel_hi:[1,0]
  v_cvt_pk_bf16_f32 v20, v68, v69
  v_cvt_pk_bf16_f32 v21, v70, v71
  v_cvt_pk_bf16_f32 v22, v84, v85
  v_cvt_pk_bf16_f32 v23, v86, v87
  buffer_store_dwordx4 v[20:23], v104, s[4:7], s47 offen sc1
  v_pk_mul_f32 v[72:73], v[72:73], v[40:41] op_sel:[0,0] op_sel_hi:[1,0]
  v_pk_mul_f32 v[74:75], v[74:75], v[40:41] op_sel:[0,0] op_sel_hi:[1,0]
  v_pk_mul_f32 v[88:89], v[88:89], v[40:41] op_sel:[0,0] op_sel_hi:[1,0]
  v_pk_mul_f32 v[90:91], v[90:91], v[40:41] op_sel:[0,0] op_sel_hi:[1,0]
  v_cvt_pk_bf16_f32 v24, v72, v73
  v_cvt_pk_bf16_f32 v25, v74, v75
  v_cvt_pk_bf16_f32 v26, v88, v89
  v_cvt_pk_bf16_f32 v27, v90, v91
  buffer_store_dwordx4 v[24:27], v104, s[4:7], s48 offen sc1
  v_pk_mul_f32 v[76:77], v[76:77], v[44:45] op_sel:[0,0] op_sel_hi:[1,0]
  v_pk_mul_f32 v[78:79], v[78:79], v[44:45] op_sel:[0,0] op_sel_hi:[1,0]
  v_pk_mul_f32 v[92:93], v[92:93], v[44:45] op_sel:[0,0] op_sel_hi:[1,0]
  v_pk_mul_f32 v[94:95], v[94:95], v[44:45] op_sel:[0,0] op_sel_hi:[1,0]
  v_cvt_pk_bf16_f32 v28, v76, v77
  v_cvt_pk_bf16_f32 v29, v78, v79
  v_cvt_pk_bf16_f32 v30, v92, v93
  v_cvt_pk_bf16_f32 v31, v94, v95
  buffer_store_dwordx4 v[28:31], v104, s[4:7], s49 offen sc1
Lmk_p1end:
  s_lshl_b32 s44, s52, 3
  s_lshl_b32 s43, s40, 1
  s_add_u32 s44, s44, s43
  s_lshl_b32 s45, s44, 15
  s_add_u32 s57, s45, s42
  s_add_u32 s57, s57, 8388608
  s_lshl_b32 s43, s53, 11
  s_add_u32 s45, s45, s43
  s_add_u32 s45, s45, s42
  s_add_u32 s58, s45, 4194304
  s_add_u32 s59, s58, 32768
  s_lshl_b32 s44, s44, 11
  s_lshl_b32 s43, s53, 7
  s_add_u32 s44, s44, s43
  s_add_u32 s44, s44, s42
  s_add_u32 s60, s44, 27525120
  v_lshlrev_b32 v48, 4, v253
  v_add_u32 v49, 32768, v48
  s_cmp_eq_u32 s41, 0
  s_cselect_b32 s44, 32, 8
  s_cselect_b32 s45, 64, 0x400
  s_lshl_b32 s43, s40, 12
  s_add_u32 s43, s43, 90112
  v_xor_b32 v3, s44, v187
  v_xor_b32 v4, s45, v187
  v_xor_b32 v5, s45, v3
  v_add_u32 v2, s43, v187
  v_add_u32 v3, s43, v3
  v_add_u32 v4, s43, v4
  v_add_u32 v5, s43, v5
  s_waitcnt vmcnt(22)
  ds_read_b64 v[52:53], v2 offset:0
  ds_read_b64 v[54:55], v3 offset:0
  ds_read_b64 v[56:57], v4 offset:0
  ds_read_b64 v[58:59], v5 offset:0
  ds_read_b64 v[60:61], v2 offset:2048
  ds_read_b64 v[62:63], v3 offset:2048
  ds_read_b64 v[64:65], v4 offset:2048
  ds_read_b64 v[66:67], v5 offset:2048
  v_lshrrev_b32 v2, 2, v253
  v_bfe_u32 v3, v253, 3, 2
  v_and_b32 v4, 3, v253
  v_lshlrev_b32 v4, 3, v4
  v_lshl_add_u32 v4, v2, 7, v4
  v_xor_b32 v5, 0, v3
  v_lshl_add_u32 v40, v5, 5, v4
  v_xor_b32 v5, 1, v3
  v_lshl_add_u32 v41, v5, 5, v4
  v_xor_b32 v5, 2, v3
  v_lshl_add_u32 v42, v5, 5, v4
  v_xor_b32 v5, 3, v3
  v_lshl_add_u32 v43, v5, 5, v4
  s_cmp_eq_u32 s3, 0
  s_cbranch_scc1 Lsd6
  v_accvgpr_read_b32 v236, a176
  v_accvgpr_read_b32 v237, a177
  v_accvgpr_read_b32 v238, a178
  v_accvgpr_read_b32 v239, a179
  v_lshlrev_b32 v224, 16, v236
  v_and_b32 v225, 0xffff0000, v236
  v_lshlrev_b32 v226, 16, v237
  v_and_b32 v227, 0xffff0000, v237
  v_lshlrev_b32 v228, 16, v238
  v_and_b32 v229, 0xffff0000, v238
  v_lshlrev_b32 v230, 16, v239
  v_and_b32 v231, 0xffff0000, v239
  v_accvgpr_read_b32 v236, a180
  v_accvgpr_read_b32 v237, a181
  v_accvgpr_read_b32 v238, a182
  v_accvgpr_read_b32 v239, a183
  v_lshlrev_b32 v232, 16, v236
  v_and_b32 v233, 0xffff0000, v236
  v_pk_add_f32 v[224:225], v[224:225], v[232:233]
  v_lshlrev_b32 v232, 16, v237
  v_and_b32 v233, 0xffff0000, v237
  v_pk_add_f32 v[226:227], v[226:227], v[232:233]
  v_lshlrev_b32 v232, 16, v238
  v_and_b32 v233, 0xffff0000, v238
  v_pk_add_f32 v[228:229], v[228:229], v[232:233]
  v_lshlrev_b32 v232, 16, v239
  v_and_b32 v233, 0xffff0000, v239
  v_pk_add_f32 v[230:231], v[230:231], v[232:233]
  v_accvgpr_read_b32 v236, a184
  v_accvgpr_read_b32 v237, a185
  v_accvgpr_read_b32 v238, a186
  v_accvgpr_read_b32 v239, a187
  v_lshlrev_b32 v232, 16, v236
  v_and_b32 v233, 0xffff0000, v236
  v_pk_add_f32 v[224:225], v[224:225], v[232:233]
  v_lshlrev_b32 v232, 16, v237
  v_and_b32 v233, 0xffff0000, v237
  v_pk_add_f32 v[226:227], v[226:227], v[232:233]
  v_lshlrev_b32 v232, 16, v238
  v_and_b32 v233, 0xffff0000, v238
  v_pk_add_f32 v[228:229], v[228:229], v[232:233]
  v_lshlrev_b32 v232, 16, v239
  v_and_b32 v233, 0xffff0000, v239
  v_pk_add_f32 v[230:231], v[230:231], v[232:233]
  v_accvgpr_read_b32 v236, a188
  v_accvgpr_read_b32 v237, a189
  v_accvgpr_read_b32 v238, a190
  v_accvgpr_read_b32 v239, a191
  v_lshlrev_b32 v232, 16, v236
  v_and_b32 v233, 0xffff0000, v236
  v_pk_add_f32 v[224:225], v[224:225], v[232:233]
  v_lshlrev_b32 v232, 16, v237
  v_and_b32 v233, 0xffff0000, v237
  v_pk_add_f32 v[226:227], v[226:227], v[232:233]
  v_lshlrev_b32 v232, 16, v238
  v_and_b32 v233, 0xffff0000, v238
  v_pk_add_f32 v[228:229], v[228:229], v[232:233]
  v_lshlrev_b32 v232, 16, v239
  v_and_b32 v233, 0xffff0000, v239
  v_pk_add_f32 v[230:231], v[230:231], v[232:233]
  v_accvgpr_read_b32 v236, a192
  v_accvgpr_read_b32 v237, a193
  v_accvgpr_read_b32 v238, a194
  v_accvgpr_read_b32 v239, a195
  v_lshlrev_b32 v232, 16, v236
  v_and_b32 v233, 0xffff0000, v236
  v_pk_add_f32 v[224:225], v[224:225], v[232:233]
  v_lshlrev_b32 v232, 16, v237
  v_and_b32 v233, 0xffff0000, v237
  v_pk_add_f32 v[226:227], v[226:227], v[232:233]
  v_lshlrev_b32 v232, 16, v238
  v_and_b32 v233, 0xffff0000, v238
  v_pk_add_f32 v[228:229], v[228:229], v[232:233]
  v_lshlrev_b32 v232, 16, v239
  v_and_b32 v233, 0xffff0000, v239
  v_pk_add_f32 v[230:231], v[230:231], v[232:233]
  v_accvgpr_read_b32 v236, a196
  v_accvgpr_read_b32 v237, a197
  v_accvgpr_read_b32 v238, a198
  v_accvgpr_read_b32 v239, a199
  v_lshlrev_b32 v232, 16, v236
  v_and_b32 v233, 0xffff0000, v236
  v_pk_add_f32 v[224:225], v[224:225], v[232:233]
  v_lshlrev_b32 v232, 16, v237
  v_and_b32 v233, 0xffff0000, v237
  v_pk_add_f32 v[226:227], v[226:227], v[232:233]
  v_lshlrev_b32 v232, 16, v238
  v_and_b32 v233, 0xffff0000, v238
  v_pk_add_f32 v[228:229], v[228:229], v[232:233]
  v_lshlrev_b32 v232, 16, v239
  v_and_b32 v233, 0xffff0000, v239
  v_pk_add_f32 v[230:231], v[230:231], v[232:233]
  v_accvgpr_read_b32 v236, a200
  v_accvgpr_read_b32 v237, a201
  v_accvgpr_read_b32 v238, a202
  v_accvgpr_read_b32 v239, a203
  v_lshlrev_b32 v232, 16, v236
  v_and_b32 v233, 0xffff0000, v236
  v_pk_add_f32 v[224:225], v[224:225], v[232:233]
  v_lshlrev_b32 v232, 16, v237
  v_and_b32 v233, 0xffff0000, v237
  v_pk_add_f32 v[226:227], v[226:227], v[232:233]
  v_lshlrev_b32 v232, 16, v238
  v_and_b32 v233, 0xffff0000, v238
  v_pk_add_f32 v[228:229], v[228:229], v[232:233]
  v_lshlrev_b32 v232, 16, v239
  v_and_b32 v233, 0xffff0000, v239
  v_pk_add_f32 v[230:231], v[230:231], v[232:233]
  v_accvgpr_read_b32 v236, a204
  v_accvgpr_read_b32 v237, a205
  v_accvgpr_read_b32 v238, a206
  v_accvgpr_read_b32 v239, a207
  v_lshlrev_b32 v232, 16, v236
  v_and_b32 v233, 0xffff0000, v236
  v_pk_add_f32 v[224:225], v[224:225], v[232:233]
  v_lshlrev_b32 v232, 16, v237
  v_and_b32 v233, 0xffff0000, v237
  v_pk_add_f32 v[226:227], v[226:227], v[232:233]
  v_lshlrev_b32 v232, 16, v238
  v_and_b32 v233, 0xffff0000, v238
  v_pk_add_f32 v[228:229], v[228:229], v[232:233]
  v_lshlrev_b32 v232, 16, v239
  v_and_b32 v233, 0xffff0000, v239
  v_pk_add_f32 v[230:231], v[230:231], v[232:233]
Lsd6:
  s_waitcnt lgkmcnt(0)
  s_waitcnt vmcnt(0)
  s_barrier
  s_cmp_lg_u32 s40, 0
  s_cbranch_scc1 Lsig5
  v_mov_b32 v250, 1
  s_mov_b64 exec, 1
  buffer_atomic_add v250, v251, s[4:7], s77 offen sc1
  s_mov_b64 exec, -1
Lsig5:
  s_add_u32 m0, s89, 73728
  s_xor_b32 s92, s88, 1179648
  buffer_load_dwordx4 v186, s[12:15], s92 offen lds
  s_add_u32 m0, s89, 77824
  s_xor_b32 s92, s88, 1245184
  buffer_load_dwordx4 v186, s[12:15], s92 offen lds
  s_add_u32 m0, s89, 81920
  s_xor_b32 s92, s88, 1310720
  buffer_load_dwordx4 v186, s[12:15], s92 offen lds
  s_add_u32 m0, s89, 86016
  s_xor_b32 s92, s88, 1376256
  buffer_load_dwordx4 v186, s[12:15], s92 offen lds
  s_add_u32 m0, s89, 90112
  s_xor_b32 s92, s88, 1441792
  buffer_load_dwordx4 v186, s[12:15], s92 offen lds
  s_add_u32 m0, s89, 94208
  s_xor_b32 s92, s88, 1507328
  buffer_load_dwordx4 v186, s[12:15], s92 offen lds
  s_add_u32 m0, s89, 98304
  s_xor_b32 s92, s88, 1572864
  buffer_load_dwordx4 v186, s[12:15], s92 offen lds
  s_add_u32 m0, s89, 102400
  s_xor_b32 s92, s88, 1638400
  buffer_load_dwordx4 v186, s[12:15], s92 offen lds
  s_add_u32 m0, s89, 106496
  s_xor_b32 s92, s88, 1703936
  buffer_load_dwordx4 v186, s[12:15], s92 offen lds
  s_add_u32 m0, s89, 110592
  s_xor_b32 s92, s88, 1769472
  buffer_load_dwordx4 v186, s[12:15], s92 offen lds
  s_add_u32 m0, s89, 114688
  s_xor_b32 s92, s88, 1835008
  buffer_load_dwordx4 v186, s[12:15], s92 offen lds
  s_add_u32 m0, s89, 118784
  s_xor_b32 s92, s88, 1900544
  buffer_load_dwordx4 v186, s[12:15], s92 offen lds
  s_add_u32 m0, s89, 122880
  s_xor_b32 s92, s88, 1966080
  buffer_load_dwordx4 v186, s[12:15], s92 offen lds
  s_add_u32 m0, s89, 126976
  s_xor_b32 s92, s88, 2031616
  buffer_load_dwordx4 v186, s[12:15], s92 offen lds
  v_lshlrev_b32 v0, 16, v52
  v_and_b32 v1, 0xffff0000, v52
  v_lshlrev_b32 v2, 16, v53
  v_and_b32 v3, 0xffff0000, v53
  v_lshlrev_b32 v8, 16, v54
  v_and_b32 v9, 0xffff0000, v54
  v_lshlrev_b32 v10, 16, v55
  v_and_b32 v11, 0xffff0000, v55
  v_lshlrev_b32 v16, 16, v56
  v_and_b32 v17, 0xffff0000, v56
  v_lshlrev_b32 v18, 16, v57
  v_and_b32 v19, 0xffff0000, v57
  v_lshlrev_b32 v24, 16, v58
  v_and_b32 v25, 0xffff0000, v58
  v_lshlrev_b32 v26, 16, v59
  v_and_b32 v27, 0xffff0000, v59
  v_lshlrev_b32 v4, 16, v60
  v_and_b32 v5, 0xffff0000, v60
  v_lshlrev_b32 v6, 16, v61
  v_and_b32 v7, 0xffff0000, v61
  v_lshlrev_b32 v12, 16, v62
  v_and_b32 v13, 0xffff0000, v62
  v_lshlrev_b32 v14, 16, v63
  v_and_b32 v15, 0xffff0000, v63
  v_lshlrev_b32 v20, 16, v64
  v_and_b32 v21, 0xffff0000, v64
  v_lshlrev_b32 v22, 16, v65
  v_and_b32 v23, 0xffff0000, v65
  v_lshlrev_b32 v28, 16, v66
  v_and_b32 v29, 0xffff0000, v66
  v_lshlrev_b32 v30, 16, v67
  v_and_b32 v31, 0xffff0000, v67
  v_and_b32 v92, 15, v253
  v_lshrrev_b32 v93, 4, v253
  v_lshrrev_b32 v72, 2, v92
  v_cmp_eq_u32 vcc, v72, v93
  v_and_b32 v72, 3, v92
  v_lshlrev_b32 v92, 3, v92
  v_mov_b32 v93, 0x7ffffff0
  v_cndmask_b32 v92, v93, v92, vcc
  v_cmp_eq_u32 s[64:65], 1, v72
  v_cmp_eq_u32 s[66:67], 2, v72
  v_cmp_eq_u32 s[68:69], 3, v72
  v_mov_b32 v72, 0x3f803f80
  v_mov_b32 v73, 0x3f803f80
  v_mov_b32 v74, 0x3f803f80
  v_mov_b32 v75, 0x3f803f80
  s_cmp_eq_u32 s3, 0
  s_cbranch_scc1 Lsd7
  v_accvgpr_read_b32 v236, a208
  v_accvgpr_read_b32 v237, a209
  v_accvgpr_read_b32 v238, a210
  v_accvgpr_read_b32 v239, a211
  v_lshlrev_b32 v232, 16, v236
  v_and_b32 v233, 0xffff0000, v236
  v_pk_add_f32 v[224:225], v[224:225], v[232:233]
  v_lshlrev_b32 v232, 16, v237
  v_and_b32 v233, 0xffff0000, v237
  v_pk_add_f32 v[226:227], v[226:227], v[232:233]
  v_lshlrev_b32 v232, 16, v238
  v_and_b32 v233, 0xffff0000, v238
  v_pk_add_f32 v[228:229], v[228:229], v[232:233]
  v_lshlrev_b32 v232, 16, v239
  v_and_b32 v233, 0xffff0000, v239
  v_pk_add_f32 v[230:231], v[230:231], v[232:233]
  v_accvgpr_read_b32 v236, a212
  v_accvgpr_read_b32 v237, a213
  v_accvgpr_read_b32 v238, a214
  v_accvgpr_read_b32 v239, a215
  v_lshlrev_b32 v232, 16, v236
  v_and_b32 v233, 0xffff0000, v236
  v_pk_add_f32 v[224:225], v[224:225], v[232:233]
  v_lshlrev_b32 v232, 16, v237
  v_and_b32 v233, 0xffff0000, v237
  v_pk_add_f32 v[226:227], v[226:227], v[232:233]
  v_lshlrev_b32 v232, 16, v238
  v_and_b32 v233, 0xffff0000, v238
  v_pk_add_f32 v[228:229], v[228:229], v[232:233]
  v_lshlrev_b32 v232, 16, v239
  v_and_b32 v233, 0xffff0000, v239
  v_pk_add_f32 v[230:231], v[230:231], v[232:233]
  v_accvgpr_read_b32 v236, a216
  v_accvgpr_read_b32 v237, a217
  v_accvgpr_read_b32 v238, a218
  v_accvgpr_read_b32 v239, a219
  v_lshlrev_b32 v232, 16, v236
  v_and_b32 v233, 0xffff0000, v236
  v_pk_add_f32 v[224:225], v[224:225], v[232:233]
  v_lshlrev_b32 v232, 16, v237
  v_and_b32 v233, 0xffff0000, v237
  v_pk_add_f32 v[226:227], v[226:227], v[232:233]
  v_lshlrev_b32 v232, 16, v238
  v_and_b32 v233, 0xffff0000, v238
  v_pk_add_f32 v[228:229], v[228:229], v[232:233]
  v_lshlrev_b32 v232, 16, v239
  v_and_b32 v233, 0xffff0000, v239
  v_pk_add_f32 v[230:231], v[230:231], v[232:233]
  v_accvgpr_read_b32 v236, a220
  v_accvgpr_read_b32 v237, a221
  v_accvgpr_read_b32 v238, a222
  v_accvgpr_read_b32 v239, a223
  v_lshlrev_b32 v232, 16, v236
  v_and_b32 v233, 0xffff0000, v236
  v_pk_add_f32 v[224:225], v[224:225], v[232:233]
  v_lshlrev_b32 v232, 16, v237
  v_and_b32 v233, 0xffff0000, v237
  v_pk_add_f32 v[226:227], v[226:227], v[232:233]
  v_lshlrev_b32 v232, 16, v238
  v_and_b32 v233, 0xffff0000, v238
  v_pk_add_f32 v[228:229], v[228:229], v[232:233]
  v_lshlrev_b32 v232, 16, v239
  v_and_b32 v233, 0xffff0000, v239
  v_pk_add_f32 v[230:231], v[230:231], v[232:233]
  v_accvgpr_read_b32 v236, a224
  v_accvgpr_read_b32 v237, a225
  v_accvgpr_read_b32 v238, a226
  v_accvgpr_read_b32 v239, a227
  v_lshlrev_b32 v232, 16, v236
  v_and_b32 v233, 0xffff0000, v236
  v_pk_add_f32 v[224:225], v[224:225], v[232:233]
  v_lshlrev_b32 v232, 16, v237
  v_and_b32 v233, 0xffff0000, v237
  v_pk_add_f32 v[226:227], v[226:227], v[232:233]
  v_lshlrev_b32 v232, 16, v238
  v_and_b32 v233, 0xffff0000, v238
  v_pk_add_f32 v[228:229], v[228:229], v[232:233]
  v_lshlrev_b32 v232, 16, v239
  v_and_b32 v233, 0xffff0000, v239
  v_pk_add_f32 v[230:231], v[230:231], v[232:233]
  v_accvgpr_read_b32 v236, a228
  v_accvgpr_read_b32 v237, a229
  v_accvgpr_read_b32 v238, a230
  v_accvgpr_read_b32 v239, a231
  v_lshlrev_b32 v232, 16, v236
  v_and_b32 v233, 0xffff0000, v236
  v_pk_add_f32 v[224:225], v[224:225], v[232:233]
  v_lshlrev_b32 v232, 16, v237
  v_and_b32 v233, 0xffff0000, v237
  v_pk_add_f32 v[226:227], v[226:227], v[232:233]
  v_lshlrev_b32 v232, 16, v238
  v_and_b32 v233, 0xffff0000, v238
  v_pk_add_f32 v[228:229], v[228:229], v[232:233]
  v_lshlrev_b32 v232, 16, v239
  v_and_b32 v233, 0xffff0000, v239
  v_pk_add_f32 v[230:231], v[230:231], v[232:233]
  v_accvgpr_read_b32 v236, a232
  v_accvgpr_read_b32 v237, a233
  v_accvgpr_read_b32 v238, a234
  v_accvgpr_read_b32 v239, a235
  v_lshlrev_b32 v232, 16, v236
  v_and_b32 v233, 0xffff0000, v236
  v_pk_add_f32 v[224:225], v[224:225], v[232:233]
  v_lshlrev_b32 v232, 16, v237
  v_and_b32 v233, 0xffff0000, v237
  v_pk_add_f32 v[226:227], v[226:227], v[232:233]
  v_lshlrev_b32 v232, 16, v238
  v_and_b32 v233, 0xffff0000, v238
  v_pk_add_f32 v[228:229], v[228:229], v[232:233]
  v_lshlrev_b32 v232, 16, v239
  v_and_b32 v233, 0xffff0000, v239
  v_pk_add_f32 v[230:231], v[230:231], v[232:233]
  v_accvgpr_read_b32 v236, a236
  v_accvgpr_read_b32 v237, a237
  v_accvgpr_read_b32 v238, a238
  v_accvgpr_read_b32 v239, a239
  v_lshlrev_b32 v232, 16, v236
  v_and_b32 v233, 0xffff0000, v236
  v_pk_add_f32 v[224:225], v[224:225], v[232:233]
  v_lshlrev_b32 v232, 16, v237
  v_and_b32 v233, 0xffff0000, v237
  v_pk_add_f32 v[226:227], v[226:227], v[232:233]
  v_lshlrev_b32 v232, 16, v238
  v_and_b32 v233, 0xffff0000, v238
  v_pk_add_f32 v[228:229], v[228:229], v[232:233]
  v_lshlrev_b32 v232, 16, v239
  v_and_b32 v233, 0xffff0000, v239
  v_pk_add_f32 v[230:231], v[230:231], v[232:233]
  v_mov_b32 v232, v224
  v_mov_b32 v233, v225
  v_mov_b32 v234, v226
  v_mov_b32 v235, v227
  v_mov_b32 v236, v228
  v_mov_b32 v237, v229
  v_mov_b32 v238, v230
  v_mov_b32 v239, v231
  v_permlane32_swap_b32 v224, v232
  v_permlane32_swap_b32 v225, v233
  v_permlane32_swap_b32 v226, v234
  v_permlane32_swap_b32 v227, v235
  v_permlane32_swap_b32 v228, v236
  v_permlane32_swap_b32 v229, v237
  v_permlane32_swap_b32 v230, v238
  v_permlane32_swap_b32 v231, v239
  v_add_f32 v224, v224, v232
  v_add_f32 v225, v225, v233
  v_add_f32 v226, v226, v234
  v_add_f32 v227, v227, v235
  v_add_f32 v228, v228, v236
  v_add_f32 v229, v229, v237
  v_add_f32 v230, v230, v238
  v_add_f32 v231, v231, v239
  v_mov_b32 v232, v224
  v_mov_b32 v233, v225
  v_mov_b32 v234, v226
  v_mov_b32 v235, v227
  v_mov_b32 v236, v228
  v_mov_b32 v237, v229
  v_mov_b32 v238, v230
  v_mov_b32 v239, v231
  v_permlane16_swap_b32 v224, v232
  v_permlane16_swap_b32 v225, v233
  v_permlane16_swap_b32 v226, v234
  v_permlane16_swap_b32 v227, v235
  v_permlane16_swap_b32 v228, v236
  v_permlane16_swap_b32 v229, v237
  v_permlane16_swap_b32 v230, v238
  v_permlane16_swap_b32 v231, v239
  v_add_f32 v224, v224, v232
  v_add_f32 v225, v225, v233
  v_add_f32 v226, v226, v234
  v_add_f32 v227, v227, v235
  v_add_f32 v228, v228, v236
  v_add_f32 v229, v229, v237
  v_add_f32 v230, v230, v238
  v_add_f32 v231, v231, v239
  v_and_b32 v232, 7, v253
  s_lshl_b32 s43, s40, 8
  s_add_u32 s43, s43, 143360
  v_add_f32_dpp v224, v224, v224 row_ror:8 row_mask:0xf bank_mask:0xf
  v_add_f32_dpp v225, v225, v225 row_ror:8 row_mask:0xf bank_mask:0xf
  v_add_f32_dpp v226, v226, v226 row_ror:8 row_mask:0xf bank_mask:0xf
  v_add_f32_dpp v227, v227, v227 row_ror:8 row_mask:0xf bank_mask:0xf
  v_add_f32_dpp v228, v228, v228 row_ror:8 row_mask:0xf bank_mask:0xf
  v_add_f32_dpp v229, v229, v229 row_ror:8 row_mask:0xf bank_mask:0xf
  v_add_f32_dpp v230, v230, v230 row_ror:8 row_mask:0xf bank_mask:0xf
  v_add_f32_dpp v231, v231, v231 row_ror:8 row_mask:0xf bank_mask:0xf
  v_lshl_add_u32 v232, v232, 5, s43
  ds_write_b128 v232, v[224:227]
  ds_write_b128 v232, v[228:231] offset:16
Lsd7:
  s_lshl_b32 s77, s52, 8
  s_add_u32 s77, s77, 27787264
  v_lshlrev_b32 v249, 7, v253
  s_add_u32 s77, s77, s42
  s_cmp_lg_u32 s40, 0
  s_cbranch_scc1 Lpdn9
  s_mov_b32 s43, 0x40000
  s_mov_b64 exec, 3
Lpol8:
  buffer_load_dword v250, v249, s[4:7], s77 offen sc1
  s_waitcnt vmcnt(0)
  v_cmp_gt_u32 vcc, 8, v250
  s_cbranch_vccz Lpdn9x
  s_sub_u32 s43, s43, 1
  s_cmp_lg_u32 s43, 0
  s_cbranch_scc1 Lpol8
Lpdn9x:
  s_mov_b64 exec, -1
Lpdn9:
  s_waitcnt vmcnt(0) lgkmcnt(0)
  s_barrier
  s_lshr_b32 s88, s88, 6
  s_xor_b32 s93, s57, s88
  buffer_load_dwordx4 a[0:3], v48, s[4:7], s93 offen offset:0 sc1
  buffer_load_dwordx4 a[4:7], v49, s[4:7], s93 offen offset:0 sc1
  buffer_load_dwordx4 a[8:11], v48, s[4:7], s93 offen offset:1024 sc1
  buffer_load_dwordx4 a[12:15], v49, s[4:7], s93 offen offset:1024 sc1
  buffer_load_dwordx4 a[16:19], v48, s[4:7], s93 offen offset:2048 sc1
  buffer_load_dwordx4 a[20:23], v49, s[4:7], s93 offen offset:2048 sc1
  buffer_load_dwordx4 a[24:27], v48, s[4:7], s93 offen offset:3072 sc1
  buffer_load_dwordx4 a[28:31], v49, s[4:7], s93 offen offset:3072 sc1
  s_add_u32 s57, s57, 4096
  s_xor_b32 s93, s57, s88
  buffer_load_dwordx4 a[32:35], v48, s[4:7], s93 offen offset:0 sc1
  buffer_load_dwordx4 a[36:39], v49, s[4:7], s93 offen offset:0 sc1
  buffer_load_dwordx4 a[40:43], v48, s[4:7], s93 offen offset:1024 sc1
  buffer_load_dwordx4 a[44:47], v49, s[4:7], s93 offen offset:1024 sc1
  s_cmp_eq_u32 s40, 1
  s_cselect_b32 s3, s3, 0
  s_cmp_eq_u32 s3, 0
  s_cbranch_scc1 Lsd10
  v_lshlrev_b32 v232, 2, v253
  v_add_u32 v233, 143360, v232
  ds_read_b32 v234, v233 offset:0
  ds_read_b32 v235, v233 offset:256
  ds_read_b32 v236, v233 offset:512
  ds_read_b32 v237, v233 offset:768
  s_waitcnt lgkmcnt(0)
  v_add_f32 v234, v234, v235
  v_add_f32 v236, v236, v237
  v_add_f32 v234, v234, v236
  buffer_store_dword v234, v232, s[4:7], s101 offen sc1
Lsd10:
  ds_read_b64_tr_b16 a[128:129], v40 offset:0
  ds_read_b64_tr_b16 a[130:131], v40 offset:2048
  ds_read_b64_tr_b16 a[144:145], v40 offset:4096
  ds_read_b64_tr_b16 a[146:147], v40 offset:6144
  ds_read_b64_tr_b16 a[132:133], v41 offset:0
  ds_read_b64_tr_b16 a[134:135], v41 offset:2048
  ds_read_b64_tr_b16 a[148:149], v41 offset:4096
  ds_read_b64_tr_b16 a[150:151], v41 offset:6144
  ds_read_b64_tr_b16 a[136:137], v42 offset:0
  ds_read_b64_tr_b16 a[138:139], v42 offset:2048
  ds_read_b64_tr_b16 a[152:153], v42 offset:4096
  ds_read_b64_tr_b16 a[154:155], v42 offset:6144
  ds_read_b64_tr_b16 a[140:141], v43 offset:0
  ds_read_b64_tr_b16 a[142:143], v43 offset:2048
  ds_read_b64_tr_b16 a[156:157], v43 offset:4096
  ds_read_b64_tr_b16 a[158:159], v43 offset:6144
  s_and_b32 s43, s53, 1
  s_mul_i32 s77, s52, 2
  s_add_u32 s77, s77, s43
  s_lshl_b32 s77, s77, 7
  s_add_u32 s77, s77, s42
  s_add_u32 s77, s77, 27807744
  s_mov_b32 s56, 3
.p2align 3
Lp2_loop:
  s_waitcnt vmcnt(8) lgkmcnt(8)
  v_mfma_f32_16x16x32_bf16 v[0:3], a[128:131], a[0:3], v[0:3]
  ds_read_b64_tr_b16 a[160:161], v40 offset:8192
  v_mfma_f32_16x16x32_bf16 v[0:3], a[144:147], a[8:11], v[0:3]
  ds_read_b64_tr_b16 a[162:163], v40 offset:10240
  buffer_load_dwordx4 a[48:51], v48, s[4:7], s93 offen offset:2048 sc1
  v_mfma_f32_16x16x32_bf16 v[4:7], a[144:147], a[12:15], v[4:7]
  ds_read_b64_tr_b16 a[176:177], v40 offset:12288
  v_mfma_f32_16x16x32_bf16 v[4:7], a[128:131], a[4:7], v[4:7]
  ds_read_b64_tr_b16 a[178:179], v40 offset:14336
  v_mfma_f32_16x16x32_bf16 v[12:15], a[132:135], a[4:7], v[12:15]
  ds_read_b64_tr_b16 a[164:165], v41 offset:8192
  v_mfma_f32_16x16x32_bf16 v[12:15], a[148:151], a[12:15], v[12:15]
  ds_read_b64_tr_b16 a[166:167], v41 offset:10240
  buffer_load_dwordx4 a[52:55], v49, s[4:7], s93 offen offset:2048 sc1
  v_mfma_f32_16x16x32_bf16 v[8:11], a[148:151], a[8:11], v[8:11]
  ds_read_b64_tr_b16 a[180:181], v41 offset:12288
  v_mfma_f32_16x16x32_bf16 v[8:11], a[132:135], a[0:3], v[8:11]
  ds_read_b64_tr_b16 a[182:183], v41 offset:14336
  s_waitcnt lgkmcnt(8)
  v_mfma_f32_16x16x32_bf16 v[16:19], a[136:139], a[0:3], v[16:19]
  ds_read_b64_tr_b16 a[168:169], v42 offset:8192
  v_mfma_f32_16x16x32_bf16 v[16:19], a[152:155], a[8:11], v[16:19]
  ds_read_b64_tr_b16 a[170:171], v42 offset:10240
  buffer_load_dwordx4 a[56:59], v48, s[4:7], s93 offen offset:3072 sc1
  v_mfma_f32_16x16x32_bf16 v[20:23], a[152:155], a[12:15], v[20:23]
  ds_read_b64_tr_b16 a[184:185], v42 offset:12288
  v_mfma_f32_16x16x32_bf16 v[20:23], a[136:139], a[4:7], v[20:23]
  ds_read_b64_tr_b16 a[186:187], v42 offset:14336
  v_mfma_f32_16x16x32_bf16 v[28:31], a[140:143], a[4:7], v[28:31]
  ds_read_b64_tr_b16 a[172:173], v43 offset:8192
  v_mfma_f32_16x16x32_bf16 v[28:31], a[156:159], a[12:15], v[28:31]
  ds_read_b64_tr_b16 a[174:175], v43 offset:10240
  buffer_load_dwordx4 a[60:63], v49, s[4:7], s93 offen offset:3072 sc1
  v_mfma_f32_16x16x32_bf16 v[24:27], a[156:159], a[8:11], v[24:27]
  ds_read_b64_tr_b16 a[188:189], v43 offset:12288
  v_mfma_f32_16x16x32_bf16 v[24:27], a[140:143], a[0:3], v[24:27]
  ds_read_b64_tr_b16 a[190:191], v43 offset:14336
  s_waitcnt vmcnt(8) lgkmcnt(8)
  v_mfma_f32_16x16x32_bf16 v[0:3], a[160:163], a[16:19], v[0:3]
  ds_read_b64_tr_b16 a[128:129], v40 offset:16384
  v_mfma_f32_16x16x32_bf16 v[0:3], a[176:179], a[24:27], v[0:3]
  s_add_u32 s57, s57, 4096
  s_xor_b32 s93, s57, s88
  ds_read_b64_tr_b16 a[130:131], v40 offset:18432
  buffer_load_dwordx4 a[0:3], v48, s[4:7], s93 offen offset:0 sc1
  v_mfma_f32_16x16x32_bf16 v[4:7], a[176:179], a[28:31], v[4:7]
  ds_read_b64_tr_b16 a[144:145], v40 offset:20480
  v_mfma_f32_16x16x32_bf16 v[4:7], a[160:163], a[20:23], v[4:7]
  ds_read_b64_tr_b16 a[146:147], v40 offset:22528
  v_mfma_f32_16x16x32_bf16 v[12:15], a[164:167], a[20:23], v[12:15]
  ds_read_b64_tr_b16 a[132:133], v41 offset:16384
  v_mfma_f32_16x16x32_bf16 v[12:15], a[180:183], a[28:31], v[12:15]
  ds_read_b64_tr_b16 a[134:135], v41 offset:18432
  buffer_load_dwordx4 a[4:7], v49, s[4:7], s93 offen offset:0 sc1
  v_mfma_f32_16x16x32_bf16 v[8:11], a[180:183], a[24:27], v[8:11]
  ds_read_b64_tr_b16 a[148:149], v41 offset:20480
  v_mfma_f32_16x16x32_bf16 v[8:11], a[164:167], a[16:19], v[8:11]
  ds_read_b64_tr_b16 a[150:151], v41 offset:22528
  s_waitcnt lgkmcnt(8)
  v_mfma_f32_16x16x32_bf16 v[16:19], a[168:171], a[16:19], v[16:19]
  ds_read_b64_tr_b16 a[136:137], v42 offset:16384
  v_mfma_f32_16x16x32_bf16 v[16:19], a[184:187], a[24:27], v[16:19]
  ds_read_b64_tr_b16 a[138:139], v42 offset:18432
  buffer_load_dwordx4 a[8:11], v48, s[4:7], s93 offen offset:1024 sc1
  v_mfma_f32_16x16x32_bf16 v[20:23], a[184:187], a[28:31], v[20:23]
  ds_read_b64_tr_b16 a[152:153], v42 offset:20480
  v_mfma_f32_16x16x32_bf16 v[20:23], a[168:171], a[20:23], v[20:23]
  ds_read_b64_tr_b16 a[154:155], v42 offset:22528
  v_mfma_f32_16x16x32_bf16 v[28:31], a[172:175], a[20:23], v[28:31]
  ds_read_b64_tr_b16 a[140:141], v43 offset:16384
  v_mfma_f32_16x16x32_bf16 v[28:31], a[188:191], a[28:31], v[28:31]
  ds_read_b64_tr_b16 a[142:143], v43 offset:18432
  buffer_load_dwordx4 a[12:15], v49, s[4:7], s93 offen offset:1024 sc1
  v_mfma_f32_16x16x32_bf16 v[24:27], a[188:191], a[24:27], v[24:27]
  ds_read_b64_tr_b16 a[156:157], v43 offset:20480
  v_mfma_f32_16x16x32_bf16 v[24:27], a[172:175], a[16:19], v[24:27]
  ds_read_b64_tr_b16 a[158:159], v43 offset:22528
  s_waitcnt vmcnt(8) lgkmcnt(8)
  v_mfma_f32_16x16x32_bf16 v[0:3], a[128:131], a[32:35], v[0:3]
  ds_read_b64_tr_b16 a[160:161], v40 offset:24576
  v_mfma_f32_16x16x32_bf16 v[0:3], a[144:147], a[40:43], v[0:3]
  ds_read_b64_tr_b16 a[162:163], v40 offset:26624
  buffer_load_dwordx4 a[16:19], v48, s[4:7], s93 offen offset:2048 sc1
  v_mfma_f32_16x16x32_bf16 v[4:7], a[144:147], a[44:47], v[4:7]
  ds_read_b64_tr_b16 a[176:177], v40 offset:28672
  v_mfma_f32_16x16x32_bf16 v[4:7], a[128:131], a[36:39], v[4:7]
  ds_read_b64_tr_b16 a[178:179], v40 offset:30720
  v_add_u32 v40, 32768, v40
  v_mfma_f32_16x16x32_bf16 v[12:15], a[132:135], a[36:39], v[12:15]
  ds_read_b64_tr_b16 a[164:165], v41 offset:24576
  v_mfma_f32_16x16x32_bf16 v[12:15], a[148:151], a[44:47], v[12:15]
  ds_read_b64_tr_b16 a[166:167], v41 offset:26624
  buffer_load_dwordx4 a[20:23], v49, s[4:7], s93 offen offset:2048 sc1
  v_mfma_f32_16x16x32_bf16 v[8:11], a[148:151], a[40:43], v[8:11]
  ds_read_b64_tr_b16 a[180:181], v41 offset:28672
  v_mfma_f32_16x16x32_bf16 v[8:11], a[132:135], a[32:35], v[8:11]
  s_waitcnt lgkmcnt(7)
  ds_read_b64_tr_b16 a[182:183], v41 offset:30720
  v_add_u32 v41, 32768, v41
  v_mfma_f32_16x16x32_bf16 v[16:19], a[136:139], a[32:35], v[16:19]
  ds_read_b64_tr_b16 a[168:169], v42 offset:24576
  v_mfma_f32_16x16x32_bf16 v[16:19], a[152:155], a[40:43], v[16:19]
  ds_read_b64_tr_b16 a[170:171], v42 offset:26624
  buffer_load_dwordx4 a[24:27], v48, s[4:7], s93 offen offset:3072 sc1
  v_mfma_f32_16x16x32_bf16 v[20:23], a[152:155], a[44:47], v[20:23]
  ds_read_b64_tr_b16 a[184:185], v42 offset:28672
  v_mfma_f32_16x16x32_bf16 v[20:23], a[136:139], a[36:39], v[20:23]
  ds_read_b64_tr_b16 a[186:187], v42 offset:30720
  v_add_u32 v42, 32768, v42
  v_mfma_f32_16x16x32_bf16 v[28:31], a[140:143], a[36:39], v[28:31]
  ds_read_b64_tr_b16 a[172:173], v43 offset:24576
  v_mfma_f32_16x16x32_bf16 v[28:31], a[156:159], a[44:47], v[28:31]
  ds_read_b64_tr_b16 a[174:175], v43 offset:26624
  buffer_load_dwordx4 a[28:31], v49, s[4:7], s93 offen offset:3072 sc1
  v_mfma_f32_16x16x32_bf16 v[24:27], a[156:159], a[40:43], v[24:27]
  ds_read_b64_tr_b16 a[188:189], v43 offset:28672
  v_mfma_f32_16x16x32_bf16 v[24:27], a[140:143], a[32:35], v[24:27]
  s_waitcnt vmcnt(8) lgkmcnt(7)
  ds_read_b64_tr_b16 a[190:191], v43 offset:30720
  v_add_u32 v43, 32768, v43
  v_mfma_f32_16x16x32_bf16 v[0:3], a[160:163], a[48:51], v[0:3]
  ds_read_b64_tr_b16 a[128:129], v40 offset:0
  v_mfma_f32_16x16x32_bf16 v[0:3], a[176:179], a[56:59], v[0:3]
  s_add_u32 s57, s57, 4096
  s_xor_b32 s93, s57, s88
  ds_read_b64_tr_b16 a[130:131], v40 offset:2048
  buffer_load_dwordx4 a[32:35], v48, s[4:7], s93 offen offset:0 sc1
  v_mfma_f32_16x16x32_bf16 v[4:7], a[176:179], a[60:63], v[4:7]
  ds_read_b64_tr_b16 a[144:145], v40 offset:4096
  v_mfma_f32_16x16x32_bf16 v[4:7], a[160:163], a[52:55], v[4:7]
  ds_read_b64_tr_b16 a[146:147], v40 offset:6144
  v_mfma_f32_16x16x32_bf16 v[12:15], a[164:167], a[52:55], v[12:15]
  ds_read_b64_tr_b16 a[132:133], v41 offset:0
  v_mfma_f32_16x16x32_bf16 v[12:15], a[180:183], a[60:63], v[12:15]
  ds_read_b64_tr_b16 a[134:135], v41 offset:2048
  buffer_load_dwordx4 a[36:39], v49, s[4:7], s93 offen offset:0 sc1
  v_mfma_f32_16x16x32_bf16 v[8:11], a[180:183], a[56:59], v[8:11]
  ds_read_b64_tr_b16 a[148:149], v41 offset:4096
  v_mfma_f32_16x16x32_bf16 v[8:11], a[164:167], a[48:51], v[8:11]
  ds_read_b64_tr_b16 a[150:151], v41 offset:6144
  s_waitcnt lgkmcnt(8)
  v_mfma_f32_16x16x32_bf16 v[16:19], a[168:171], a[48:51], v[16:19]
  ds_read_b64_tr_b16 a[136:137], v42 offset:0
  v_mfma_f32_16x16x32_bf16 v[16:19], a[184:187], a[56:59], v[16:19]
  ds_read_b64_tr_b16 a[138:139], v42 offset:2048
  buffer_load_dwordx4 a[40:43], v48, s[4:7], s93 offen offset:1024 sc1
  v_mfma_f32_16x16x32_bf16 v[20:23], a[184:187], a[60:63], v[20:23]
  ds_read_b64_tr_b16 a[152:153], v42 offset:4096
  v_mfma_f32_16x16x32_bf16 v[20:23], a[168:171], a[52:55], v[20:23]
  ds_read_b64_tr_b16 a[154:155], v42 offset:6144
  v_mfma_f32_16x16x32_bf16 v[28:31], a[172:175], a[52:55], v[28:31]
  ds_read_b64_tr_b16 a[140:141], v43 offset:0
  v_mfma_f32_16x16x32_bf16 v[28:31], a[188:191], a[60:63], v[28:31]
  ds_read_b64_tr_b16 a[142:143], v43 offset:2048
  buffer_load_dwordx4 a[44:47], v49, s[4:7], s93 offen offset:1024 sc1
  v_mfma_f32_16x16x32_bf16 v[24:27], a[188:191], a[56:59], v[24:27]
  ds_read_b64_tr_b16 a[156:157], v43 offset:4096
  v_mfma_f32_16x16x32_bf16 v[24:27], a[172:175], a[48:51], v[24:27]
  s_sub_u32 s56, s56, 1
  ds_read_b64_tr_b16 a[158:159], v43 offset:6144
  s_cmp_lg_u32 s56, 0
  s_cbranch_scc1 Lp2_loop
Lmk_Lp2_loop_tail:
  s_waitcnt vmcnt(8) lgkmcnt(8)
  v_mfma_f32_16x16x32_bf16 v[0:3], a[128:131], a[0:3], v[0:3]
  ds_read_b64_tr_b16 a[160:161], v40 offset:8192
  v_mfma_f32_16x16x32_bf16 v[0:3], a[144:147], a[8:11], v[0:3]
  ds_read_b64_tr_b16 a[162:163], v40 offset:10240
  buffer_load_dwordx4 a[48:51], v48, s[4:7], s93 offen offset:2048 sc1
  v_mfma_f32_16x16x32_bf16 v[4:7], a[144:147], a[12:15], v[4:7]
  ds_read_b64_tr_b16 a[176:177], v40 offset:12288
  v_mfma_f32_16x16x32_bf16 v[4:7], a[128:131], a[4:7], v[4:7]
  ds_read_b64_tr_b16 a[178:179], v40 offset:14336
  v_mfma_f32_16x16x32_bf16 v[12:15], a[132:135], a[4:7], v[12:15]
  ds_read_b64_tr_b16 a[164:165], v41 offset:8192
  v_mfma_f32_16x16x32_bf16 v[12:15], a[148:151], a[12:15], v[12:15]
  ds_read_b64_tr_b16 a[166:167], v41 offset:10240
  buffer_load_dwordx4 a[52:55], v49, s[4:7], s93 offen offset:2048 sc1
  v_mfma_f32_16x16x32_bf16 v[8:11], a[148:151], a[8:11], v[8:11]
  ds_read_b64_tr_b16 a[180:181], v41 offset:12288
  v_mfma_f32_16x16x32_bf16 v[8:11], a[132:135], a[0:3], v[8:11]
  ds_read_b64_tr_b16 a[182:183], v41 offset:14336
  s_waitcnt lgkmcnt(8)
  v_mfma_f32_16x16x32_bf16 v[16:19], a[136:139], a[0:3], v[16:19]
  ds_read_b64_tr_b16 a[168:169], v42 offset:8192
  v_mfma_f32_16x16x32_bf16 v[16:19], a[152:155], a[8:11], v[16:19]
  ds_read_b64_tr_b16 a[170:171], v42 offset:10240
  buffer_load_dwordx4 a[56:59], v48, s[4:7], s93 offen offset:3072 sc1
  v_mfma_f32_16x16x32_bf16 v[20:23], a[152:155], a[12:15], v[20:23]
  ds_read_b64_tr_b16 a[184:185], v42 offset:12288
  v_mfma_f32_16x16x32_bf16 v[20:23], a[136:139], a[4:7], v[20:23]
  ds_read_b64_tr_b16 a[186:187], v42 offset:14336
  v_mfma_f32_16x16x32_bf16 v[28:31], a[140:143], a[4:7], v[28:31]
  ds_read_b64_tr_b16 a[172:173], v43 offset:8192
  v_mfma_f32_16x16x32_bf16 v[28:31], a[156:159], a[12:15], v[28:31]
  ds_read_b64_tr_b16 a[174:175], v43 offset:10240
  buffer_load_dwordx4 a[60:63], v49, s[4:7], s93 offen offset:3072 sc1
  v_mfma_f32_16x16x32_bf16 v[24:27], a[156:159], a[8:11], v[24:27]
  ds_read_b64_tr_b16 a[188:189], v43 offset:12288
  v_mfma_f32_16x16x32_bf16 v[24:27], a[140:143], a[0:3], v[24:27]
  ds_read_b64_tr_b16 a[190:191], v43 offset:14336
  s_waitcnt vmcnt(8) lgkmcnt(8)
  v_mfma_f32_16x16x32_bf16 v[0:3], a[160:163], a[16:19], v[0:3]
  ds_read_b64_tr_b16 a[128:129], v40 offset:16384
  v_mfma_f32_16x16x32_bf16 v[0:3], a[176:179], a[24:27], v[0:3]
  ds_read_b64_tr_b16 a[130:131], v40 offset:18432
  v_mfma_f32_16x16x32_bf16 v[4:7], a[176:179], a[28:31], v[4:7]
  ds_read_b64_tr_b16 a[144:145], v40 offset:20480
  v_mfma_f32_16x16x32_bf16 v[4:7], a[160:163], a[20:23], v[4:7]
  ds_read_b64_tr_b16 a[146:147], v40 offset:22528
  v_mfma_f32_16x16x32_bf16 v[12:15], a[164:167], a[20:23], v[12:15]
  ds_read_b64_tr_b16 a[132:133], v41 offset:16384
  v_mfma_f32_16x16x32_bf16 v[12:15], a[180:183], a[28:31], v[12:15]
  ds_read_b64_tr_b16 a[134:135], v41 offset:18432
  v_mfma_f32_16x16x32_bf16 v[8:11], a[180:183], a[24:27], v[8:11]
  ds_read_b64_tr_b16 a[148:149], v41 offset:20480
  v_mfma_f32_16x16x32_bf16 v[8:11], a[164:167], a[16:19], v[8:11]
  ds_read_b64_tr_b16 a[150:151], v41 offset:22528
  s_waitcnt lgkmcnt(8)
  v_mfma_f32_16x16x32_bf16 v[16:19], a[168:171], a[16:19], v[16:19]
  ds_read_b64_tr_b16 a[136:137], v42 offset:16384
  v_mfma_f32_16x16x32_bf16 v[16:19], a[184:187], a[24:27], v[16:19]
  ds_read_b64_tr_b16 a[138:139], v42 offset:18432
  v_mfma_f32_16x16x32_bf16 v[20:23], a[184:187], a[28:31], v[20:23]
  ds_read_b64_tr_b16 a[152:153], v42 offset:20480
  v_mfma_f32_16x16x32_bf16 v[20:23], a[168:171], a[20:23], v[20:23]
  ds_read_b64_tr_b16 a[154:155], v42 offset:22528
  v_mfma_f32_16x16x32_bf16 v[28:31], a[172:175], a[20:23], v[28:31]
  ds_read_b64_tr_b16 a[140:141], v43 offset:16384
  v_mfma_f32_16x16x32_bf16 v[28:31], a[188:191], a[28:31], v[28:31]
  ds_read_b64_tr_b16 a[142:143], v43 offset:18432
  v_mfma_f32_16x16x32_bf16 v[24:27], a[188:191], a[24:27], v[24:27]
  ds_read_b64_tr_b16 a[156:157], v43 offset:20480
  v_mfma_f32_16x16x32_bf16 v[24:27], a[172:175], a[16:19], v[24:27]
  ds_read_b64_tr_b16 a[158:159], v43 offset:22528
  s_waitcnt vmcnt(4) lgkmcnt(8)
  v_mfma_f32_16x16x32_bf16 v[0:3], a[128:131], a[32:35], v[0:3]
  ds_read_b64_tr_b16 a[160:161], v40 offset:24576
  v_mfma_f32_16x16x32_bf16 v[0:3], a[144:147], a[40:43], v[0:3]
  ds_read_b64_tr_b16 a[162:163], v40 offset:26624
  v_mfma_f32_16x16x32_bf16 v[4:7], a[144:147], a[44:47], v[4:7]
  ds_read_b64_tr_b16 a[176:177], v40 offset:28672
  v_mfma_f32_16x16x32_bf16 v[4:7], a[128:131], a[36:39], v[4:7]
  ds_read_b64_tr_b16 a[178:179], v40 offset:30720
  v_add_u32 v40, 32768, v40
  v_mfma_f32_16x16x32_bf16 v[12:15], a[132:135], a[36:39], v[12:15]
  ds_read_b64_tr_b16 a[164:165], v41 offset:24576
  v_mfma_f32_16x16x32_bf16 v[12:15], a[148:151], a[44:47], v[12:15]
  ds_read_b64_tr_b16 a[166:167], v41 offset:26624
  v_mfma_f32_16x16x32_bf16 v[8:11], a[148:151], a[40:43], v[8:11]
  ds_read_b64_tr_b16 a[180:181], v41 offset:28672
  v_mfma_f32_16x16x32_bf16 v[8:11], a[132:135], a[32:35], v[8:11]
  s_waitcnt lgkmcnt(7)
  ds_read_b64_tr_b16 a[182:183], v41 offset:30720
  v_add_u32 v41, 32768, v41
  v_mfma_f32_16x16x32_bf16 v[16:19], a[136:139], a[32:35], v[16:19]
  ds_read_b64_tr_b16 a[168:169], v42 offset:24576
  v_mfma_f32_16x16x32_bf16 v[16:19], a[152:155], a[40:43], v[16:19]
  ds_read_b64_tr_b16 a[170:171], v42 offset:26624
  v_mfma_f32_16x16x32_bf16 v[20:23], a[152:155], a[44:47], v[20:23]
  ds_read_b64_tr_b16 a[184:185], v42 offset:28672
  v_mfma_f32_16x16x32_bf16 v[20:23], a[136:139], a[36:39], v[20:23]
  ds_read_b64_tr_b16 a[186:187], v42 offset:30720
  v_add_u32 v42, 32768, v42
  v_mfma_f32_16x16x32_bf16 v[28:31], a[140:143], a[36:39], v[28:31]
  ds_read_b64_tr_b16 a[172:173], v43 offset:24576
  v_mfma_f32_16x16x32_bf16 v[28:31], a[156:159], a[44:47], v[28:31]
  ds_read_b64_tr_b16 a[174:175], v43 offset:26624
  v_mfma_f32_16x16x32_bf16 v[24:27], a[156:159], a[40:43], v[24:27]
  ds_read_b64_tr_b16 a[188:189], v43 offset:28672
  v_mfma_f32_16x16x32_bf16 v[24:27], a[140:143], a[32:35], v[24:27]
  s_waitcnt vmcnt(0) lgkmcnt(7)
  ds_read_b64_tr_b16 a[190:191], v43 offset:30720
  v_add_u32 v43, 32768, v43
  v_mfma_f32_16x16x32_bf16 v[0:3], a[160:163], a[48:51], v[0:3]
  v_mfma_f32_16x16x32_bf16 v[0:3], a[176:179], a[56:59], v[0:3]
  v_mfma_f32_16x16x32_bf16 v[4:7], a[176:179], a[60:63], v[4:7]
  v_mfma_f32_16x16x32_bf16 v[4:7], a[160:163], a[52:55], v[4:7]
  v_mfma_f32_16x16x32_bf16 v[12:15], a[164:167], a[52:55], v[12:15]
  v_mfma_f32_16x16x32_bf16 v[12:15], a[180:183], a[60:63], v[12:15]
  v_mfma_f32_16x16x32_bf16 v[8:11], a[180:183], a[56:59], v[8:11]
  v_mfma_f32_16x16x32_bf16 v[8:11], a[164:167], a[48:51], v[8:11]
  s_waitcnt lgkmcnt(0)
  v_mfma_f32_16x16x32_bf16 v[16:19], a[168:171], a[48:51], v[16:19]
  s_nop 0
  v_mfma_f32_16x16x32_bf16 v[16:19], a[184:187], a[56:59], v[16:19]
  s_nop 0
  v_mfma_f32_16x16x32_bf16 v[20:23], a[184:187], a[60:63], v[20:23]
  s_nop 0
  v_mfma_f32_16x16x32_bf16 v[20:23], a[168:171], a[52:55], v[20:23]
  v_cvt_pk_bf16_f32 v60, v4, v5
  v_cvt_pk_bf16_f32 v61, v6, v7
  v_mfma_f32_16x16x32_bf16 v[28:31], a[172:175], a[52:55], v[28:31]
  v_cvt_pk_bf16_f32 v62, v12, v13
  v_cvt_pk_bf16_f32 v63, v14, v15
  v_mfma_f32_16x16x32_bf16 v[28:31], a[188:191], a[60:63], v[28:31]
  buffer_store_dwordx4 v[60:63], v48, s[4:7], s59 offen offset:0 sc1
  v_cvt_pk_bf16_f32 v52, v0, v1
  v_mfma_f32_16x16x32_bf16 v[24:27], a[188:191], a[56:59], v[24:27]
  v_cvt_pk_bf16_f32 v53, v2, v3
  v_cvt_pk_bf16_f32 v54, v8, v9
  v_mfma_f32_16x16x32_bf16 v[24:27], a[172:175], a[48:51], v[24:27]
  v_cvt_pk_bf16_f32 v55, v10, v11
  buffer_store_dwordx4 v[52:55], v48, s[4:7], s58 offen offset:0 sc1
  v_mfma_f32_16x16x32_bf16 v[88:91], v[60:63], v[60:63], 0
  v_mfma_f32_16x16x32_bf16 v[84:87], v[72:75], v[60:63], 0
  v_mfma_f32_16x16x32_bf16 v[80:83], v[52:55], v[52:55], 0
  v_mfma_f32_16x16x32_bf16 v[76:79], v[72:75], v[52:55], 0
  v_cvt_pk_bf16_f32 v64, v20, v21
  v_cvt_pk_bf16_f32 v65, v22, v23
  v_cvt_pk_bf16_f32 v66, v28, v29
  v_cvt_pk_bf16_f32 v67, v30, v31
  buffer_store_dwordx4 v[64:67], v48, s[4:7], s59 offen offset:1024 sc1
  v_cvt_pk_bf16_f32 v56, v16, v17
  v_cvt_pk_bf16_f32 v57, v18, v19
  v_cvt_pk_bf16_f32 v58, v24, v25
  v_cvt_pk_bf16_f32 v59, v26, v27
  buffer_store_dwordx4 v[56:59], v48, s[4:7], s58 offen offset:1024 sc1
  s_nop 0
  v_mfma_f32_16x16x32_bf16 v[88:91], v[64:67], v[64:67], v[88:91]
  v_mfma_f32_16x16x32_bf16 v[84:87], v[72:75], v[64:67], v[84:87]
  v_mfma_f32_16x16x32_bf16 v[80:83], v[56:59], v[56:59], v[80:83]
  v_mfma_f32_16x16x32_bf16 v[76:79], v[72:75], v[56:59], v[76:79]
  s_nop 5
  v_cndmask_b32 v85, v88, v89, s[64:65]
  v_cndmask_b32 v85, v85, v90, s[66:67]
  v_cndmask_b32 v85, v85, v91, s[68:69]
  buffer_store_dwordx2 v[84:85], v92, s[4:7], s60 offen offset:2048 sc1
  v_cndmask_b32 v77, v80, v81, s[64:65]
  v_cndmask_b32 v77, v77, v82, s[66:67]
  v_cndmask_b32 v77, v77, v83, s[68:69]
  buffer_store_dwordx2 v[76:77], v92, s[4:7], s60 offen offset:0 sc1
  s_and_b32 s66, s55, 1
  v_lshrrev_b32 v2, 4, v253
  v_bfe_u32 v3, v253, 1, 3
  v_and_b32 v4, 1, v253
  v_lshlrev_b32 v4, 4, v4
  v_mul_u32_u24 v5, 7168, v2
  v_add_u32 v5, v5, v4
  s_cmp_eq_u32 s66, 0
  s_cselect_b32 s44, 7, 0
  v_mov_b32 v7, 0x40000000
  v_add_u32 v6, 0, v2
  v_xor_b32 v6, v6, v3
  v_cmp_eq_u32 vcc, s44, v6
  v_lshl_add_u32 v6, v6, 5, v5
  v_add_u32 v6, 0, v6
  v_cndmask_b32 v232, v6, v7, vcc
  v_add_u32 v6, 4, v2
  v_xor_b32 v6, v6, v3
  v_cmp_eq_u32 vcc, s44, v6
  v_lshl_add_u32 v6, v6, 5, v5
  v_add_u32 v6, 27648, v6
  v_cndmask_b32 v233, v6, v7, vcc
  v_add_u32 v6, 0, v2
  v_xor_b32 v6, v6, v3
  v_cmp_eq_u32 vcc, s44, v6
  v_lshl_add_u32 v6, v6, 5, v5
  v_add_u32 v6, 55296, v6
  v_cndmask_b32 v234, v6, v7, vcc
  v_add_u32 v6, 4, v2
  v_xor_b32 v6, v6, v3
  v_cmp_eq_u32 vcc, s44, v6
  v_lshl_add_u32 v6, v6, 5, v5
  v_add_u32 v6, 82944, v6
  v_cndmask_b32 v235, v6, v7, vcc
  s_mul_i32 s67, s55, 224
  s_and_b32 s67, s67, 0xffffffc0
  s_mul_i32 s43, s40, 114688
  s_add_u32 s67, s67, s43
  s_lshl_b32 s68, s40, 12
  v_lshlrev_b32 v231, 4, v253
  s_lshl_b32 s43, s41, 30
  v_or_b32 v236, s43, v231
  s_lshl_b32 s43, s2, 2
  s_add_u32 s43, s43, s40
  s_mul_i32 s70, s43, 7168
  s_lshl_b32 s69, s54, 2
  s_add_u32 s69, s69, s40
  s_lshl_b32 s72, s69, 17
  s_add_u32 s72, s72, s42
  s_add_u32 s72, s72, 4194304
  s_add_u32 s73, s72, 32768
  s_add_u32 s74, s73, 32768
  s_add_u32 s75, s74, 32768
  s_lshl_b32 s71, s40, 11
  s_add_u32 s71, s71, 131072
  v_lshrrev_b32 v2, 2, v253
  v_and_b32 v3, 7, v2
  v_and_b32 v4, 3, v253
  v_lshlrev_b32 v5, 3, v4
  v_lshl_add_u32 v5, v2, 8, v5
  s_lshl_b32 s43, s66, 1
  s_cmp_eq_u32 s66, 0
  s_cselect_b32 s45, 6, 1
  s_add_u32 s46, s43, 0
  v_xor_b32 v6, s46, v3
  v_lshl_add_u32 v224, v6, 5, v5
  s_add_u32 s46, s43, 1
  v_xor_b32 v6, s46, v3
  v_lshl_add_u32 v225, v6, 5, v5
  s_add_u32 s46, s43, 2
  v_xor_b32 v6, s46, v3
  v_lshl_add_u32 v226, v6, 5, v5
  s_add_u32 s46, s43, 3
  v_xor_b32 v6, s46, v3
  v_lshl_add_u32 v227, v6, 5, v5
  s_add_u32 s46, s43, 4
  v_xor_b32 v6, s46, v3
  v_lshl_add_u32 v228, v6, 5, v5
  s_add_u32 s46, s43, 5
  v_xor_b32 v6, s46, v3
  v_lshl_add_u32 v229, v6, 5, v5
  v_xor_b32 v6, s45, v3
  v_lshl_add_u32 v230, v6, 5, v5
  s_mul_i32 s46, s55, 448
  s_add_u32 s46, s46, 27918336
  s_add_u32 s47, s46, 28672
  s_lshr_b32 s48, s55, 3
  s_lshl_b32 s48, s48, 7
  s_add_u32 s48, s48, 27794432
  s_lshl_b32 s44, s69, 13
  s_add_u32 s44, s44, s42
  s_add_u32 s44, s44, 27525120
  s_add_u32 s45, s44, 4096
  s_waitcnt vmcnt(0)
  s_barrier
  s_cmp_lg_u32 s40, 0
  s_cbranch_scc1 Lsig11
  v_mov_b32 v250, 1
  s_mov_b64 exec, 1
  buffer_atomic_add v250, v251, s[4:7], s77 offen sc1
  s_mov_b64 exec, -1
Lsig11:
  s_cmp_eq_u32 s3, 0
  s_cbranch_scc1 Lsd12
  s_bfe_u32 s43, s2, 0x20001
  s_lshl_b32 s43, s43, 7
  s_add_u32 s43, s43, 27794432
  v_mov_b32 v250, 1
  s_mov_b64 exec, 1
  buffer_atomic_add v250, v251, s[4:7], s43 offen sc1
  s_mov_b64 exec, -1
Lsd12:
  s_add_u32 m0, s68, 0
  s_nop 0
  buffer_load_dwordx4 v232, s[16:19], s67 offen offset:0  lds
  buffer_load_dwordx4 v233, s[16:19], s67 offen offset:1024  lds
  buffer_load_dwordx4 v234, s[16:19], s67 offen offset:2048  lds
  buffer_load_dwordx4 v235, s[16:19], s67 offen offset:3072  lds
  s_add_u32 m0, s68, 16384
  s_nop 0
  buffer_load_dwordx4 v232, s[20:23], s67 offen offset:0  lds
  buffer_load_dwordx4 v233, s[20:23], s67 offen offset:1024  lds
  buffer_load_dwordx4 v234, s[20:23], s67 offen offset:2048  lds
  buffer_load_dwordx4 v235, s[20:23], s67 offen offset:3072  lds
  s_add_u32 s67, s67, 458752
  s_add_u32 m0, s68, 32768
  s_nop 0
  buffer_load_dwordx4 v232, s[16:19], s67 offen offset:0  lds
  buffer_load_dwordx4 v233, s[16:19], s67 offen offset:1024  lds
  buffer_load_dwordx4 v234, s[16:19], s67 offen offset:2048  lds
  buffer_load_dwordx4 v235, s[16:19], s67 offen offset:3072  lds
  s_add_u32 m0, s68, 49152
  s_nop 0
  buffer_load_dwordx4 v232, s[20:23], s67 offen offset:0  lds
  buffer_load_dwordx4 v233, s[20:23], s67 offen offset:1024  lds
  buffer_load_dwordx4 v234, s[20:23], s67 offen offset:2048  lds
  buffer_load_dwordx4 v235, s[20:23], s67 offen offset:3072  lds
  s_add_u32 s67, s67, 458752
  s_xor_b32 s68, s68, 0x10000
  s_mul_i32 s77, s54, 512
  s_add_u32 s77, s77, s42
  s_add_u32 s77, s77, 27807744
  v_lshlrev_b32 v249, 7, v253
  s_cmp_lg_u32 s40, 0
  s_cbranch_scc1 Lpdn14
  s_mov_b32 s43, 0x40000
  s_mov_b64 exec, 15
Lpol13:
  buffer_load_dword v250, v249, s[4:7], s77 offen sc1
  s_waitcnt vmcnt(0)
  v_cmp_gt_u32 vcc, 8, v250
  s_cbranch_vccz Lpdn14x
  s_sub_u32 s43, s43, 1
  s_cmp_lg_u32 s43, 0
  s_cbranch_scc1 Lpol13
Lpdn14x:
  s_mov_b64 exec, -1
Lpdn14:
  s_waitcnt vmcnt(0) lgkmcnt(0)
  s_barrier
  buffer_load_dwordx4 a[0:3], v231, s[4:7], s72 offen offset:0 sc1
  buffer_load_dwordx4 a[16:19], v231, s[4:7], s72 offen offset:1024 sc1
  buffer_load_dwordx4 a[4:7], v231, s[4:7], s73 offen offset:0 sc1
  buffer_load_dwordx4 a[20:23], v231, s[4:7], s73 offen offset:1024 sc1
  buffer_load_dwordx4 a[8:11], v231, s[4:7], s74 offen offset:0 sc1
  buffer_load_dwordx4 a[24:27], v231, s[4:7], s74 offen offset:1024 sc1
  buffer_load_dwordx4 a[12:15], v231, s[4:7], s75 offen offset:0 sc1
  buffer_load_dwordx4 a[28:31], v231, s[4:7], s75 offen offset:1024 sc1
  ds_read_b64_tr_b16 a[64:65], v224 offset:0
  ds_read_b64_tr_b16 a[66:67], v224 offset:4096
  ds_read_b64_tr_b16 a[68:69], v224 offset:8192
  ds_read_b64_tr_b16 a[70:71], v224 offset:12288
  ds_read_b64_tr_b16 a[72:73], v224 offset:16384
  ds_read_b64_tr_b16 a[74:75], v224 offset:20480
  ds_read_b64_tr_b16 a[76:77], v224 offset:24576
  ds_read_b64_tr_b16 a[78:79], v224 offset:28672
Lmk_p3s0:
  s_waitcnt vmcnt(6) lgkmcnt(4)
  v_mfma_f32_16x16x32_bf16 v[0:3], a[64:67], a[0:3], 0
  ds_read_b64_tr_b16 a[80:81], v225 offset:0
  v_mfma_f32_16x16x32_bf16 v[0:3], a[68:71], a[16:19], v[0:3]
  s_waitcnt vmcnt(4)
  v_mfma_f32_16x16x32_bf16 v[4:7], a[68:71], a[20:23], 0
  ds_read_b64_tr_b16 a[82:83], v225 offset:4096
  v_mfma_f32_16x16x32_bf16 v[4:7], a[64:67], a[4:7], v[4:7]
  s_waitcnt vmcnt(2)
  v_mfma_f32_16x16x32_bf16 v[8:11], a[64:67], a[8:11], 0
  ds_read_b64_tr_b16 a[84:85], v225 offset:8192
  v_mfma_f32_16x16x32_bf16 v[8:11], a[68:71], a[24:27], v[8:11]
  s_waitcnt vmcnt(0)
  v_mfma_f32_16x16x32_bf16 v[12:15], a[68:71], a[28:31], 0
  ds_read_b64_tr_b16 a[86:87], v225 offset:12288
  v_mfma_f32_16x16x32_bf16 v[12:15], a[64:67], a[12:15], v[12:15]
  s_waitcnt lgkmcnt(4)
  v_mfma_f32_16x16x32_bf16 v[28:31], a[72:75], a[12:15], 0
  ds_read_b64_tr_b16 a[88:89], v225 offset:16384
  v_mfma_f32_16x16x32_bf16 v[28:31], a[76:79], a[28:31], v[28:31]
  buffer_load_dwordx4 a[32:35], v231, s[4:7], s72 offen offset:2048 sc1
  v_mfma_f32_16x16x32_bf16 v[24:27], a[76:79], a[24:27], 0
  ds_read_b64_tr_b16 a[90:91], v225 offset:20480
  v_mfma_f32_16x16x32_bf16 v[24:27], a[72:75], a[8:11], v[24:27]
  v_mfma_f32_16x16x32_bf16 v[20:23], a[72:75], a[4:7], 0
  ds_read_b64_tr_b16 a[92:93], v225 offset:24576
  v_mfma_f32_16x16x32_bf16 v[20:23], a[76:79], a[20:23], v[20:23]
  buffer_load_dwordx4 a[48:51], v231, s[4:7], s72 offen offset:3072 sc1
  v_mfma_f32_16x16x32_bf16 v[16:19], a[76:79], a[16:19], 0
  ds_read_b64_tr_b16 a[94:95], v225 offset:28672
  s_add_u32 s72, s72, 4096
  v_mfma_f32_16x16x32_bf16 v[16:19], a[72:75], a[0:3], v[16:19]
  s_waitcnt lgkmcnt(4)
  v_mfma_f32_16x16x32_bf16 v[32:35], a[80:83], a[0:3], 0
  ds_read_b64_tr_b16 a[64:65], v226 offset:0
  v_mfma_f32_16x16x32_bf16 v[32:35], a[84:87], a[16:19], v[32:35]
  buffer_load_dwordx4 a[36:39], v231, s[4:7], s73 offen offset:2048 sc1
  v_mfma_f32_16x16x32_bf16 v[36:39], a[84:87], a[20:23], 0
  ds_read_b64_tr_b16 a[66:67], v226 offset:4096
  v_mfma_f32_16x16x32_bf16 v[36:39], a[80:83], a[4:7], v[36:39]
  v_mfma_f32_16x16x32_bf16 v[40:43], a[80:83], a[8:11], 0
  ds_read_b64_tr_b16 a[68:69], v226 offset:8192
  v_mfma_f32_16x16x32_bf16 v[40:43], a[84:87], a[24:27], v[40:43]
  buffer_load_dwordx4 a[52:55], v231, s[4:7], s73 offen offset:3072 sc1
  v_mfma_f32_16x16x32_bf16 v[44:47], a[84:87], a[28:31], 0
  ds_read_b64_tr_b16 a[70:71], v226 offset:12288
  s_add_u32 s73, s73, 4096
  v_mfma_f32_16x16x32_bf16 v[44:47], a[80:83], a[12:15], v[44:47]
  s_waitcnt lgkmcnt(4)
  v_mfma_f32_16x16x32_bf16 v[60:63], a[88:91], a[12:15], 0
  ds_read_b64_tr_b16 a[72:73], v226 offset:16384
  v_mfma_f32_16x16x32_bf16 v[60:63], a[92:95], a[28:31], v[60:63]
  buffer_load_dwordx4 a[40:43], v231, s[4:7], s74 offen offset:2048 sc1
  v_mfma_f32_16x16x32_bf16 v[56:59], a[92:95], a[24:27], 0
  ds_read_b64_tr_b16 a[74:75], v226 offset:20480
  v_mfma_f32_16x16x32_bf16 v[56:59], a[88:91], a[8:11], v[56:59]
  v_mfma_f32_16x16x32_bf16 v[52:55], a[88:91], a[4:7], 0
  ds_read_b64_tr_b16 a[76:77], v226 offset:24576
  v_mfma_f32_16x16x32_bf16 v[52:55], a[92:95], a[20:23], v[52:55]
  buffer_load_dwordx4 a[56:59], v231, s[4:7], s74 offen offset:3072 sc1
  v_mfma_f32_16x16x32_bf16 v[48:51], a[92:95], a[16:19], 0
  ds_read_b64_tr_b16 a[78:79], v226 offset:28672
  s_add_u32 s74, s74, 4096
  v_mfma_f32_16x16x32_bf16 v[48:51], a[88:91], a[0:3], v[48:51]
  s_waitcnt lgkmcnt(4)
  v_mfma_f32_16x16x32_bf16 v[64:67], a[64:67], a[0:3], 0
  ds_read_b64_tr_b16 a[80:81], v227 offset:0
  v_mfma_f32_16x16x32_bf16 v[64:67], a[68:71], a[16:19], v[64:67]
  buffer_load_dwordx4 a[44:47], v231, s[4:7], s75 offen offset:2048 sc1
  v_mfma_f32_16x16x32_bf16 v[68:71], a[68:71], a[20:23], 0
  ds_read_b64_tr_b16 a[82:83], v227 offset:4096
  v_mfma_f32_16x16x32_bf16 v[68:71], a[64:67], a[4:7], v[68:71]
  v_mfma_f32_16x16x32_bf16 v[72:75], a[64:67], a[8:11], 0
  ds_read_b64_tr_b16 a[84:85], v227 offset:8192
  v_mfma_f32_16x16x32_bf16 v[72:75], a[68:71], a[24:27], v[72:75]
  buffer_load_dwordx4 a[60:63], v231, s[4:7], s75 offen offset:3072 sc1
  v_mfma_f32_16x16x32_bf16 v[76:79], a[68:71], a[28:31], 0
  ds_read_b64_tr_b16 a[86:87], v227 offset:12288
  s_add_u32 s75, s75, 4096
  v_mfma_f32_16x16x32_bf16 v[76:79], a[64:67], a[12:15], v[76:79]
  s_waitcnt lgkmcnt(4)
  v_mfma_f32_16x16x32_bf16 v[92:95], a[72:75], a[12:15], 0
  ds_read_b64_tr_b16 a[88:89], v227 offset:16384
  s_add_u32 m0, s68, 32768
  v_mfma_f32_16x16x32_bf16 v[92:95], a[76:79], a[28:31], v[92:95]
  buffer_load_dwordx4 v231, s[4:7], s44 offen offset:0 sc1 lds
  v_mfma_f32_16x16x32_bf16 v[88:91], a[76:79], a[24:27], 0
  ds_read_b64_tr_b16 a[90:91], v227 offset:20480
  v_mfma_f32_16x16x32_bf16 v[88:91], a[72:75], a[8:11], v[88:91]
  v_mfma_f32_16x16x32_bf16 v[84:87], a[72:75], a[4:7], 0
  ds_read_b64_tr_b16 a[92:93], v227 offset:24576
  v_mfma_f32_16x16x32_bf16 v[84:87], a[76:79], a[20:23], v[84:87]
  buffer_load_dwordx4 v231, s[4:7], s44 offen offset:1024 sc1 lds
  v_mfma_f32_16x16x32_bf16 v[80:83], a[76:79], a[16:19], 0
  ds_read_b64_tr_b16 a[94:95], v227 offset:28672
  v_mfma_f32_16x16x32_bf16 v[80:83], a[72:75], a[0:3], v[80:83]
  s_waitcnt lgkmcnt(4)
  v_mfma_f32_16x16x32_bf16 v[96:99], a[80:83], a[0:3], 0
  ds_read_b64_tr_b16 a[64:65], v228 offset:0
  v_mfma_f32_16x16x32_bf16 v[96:99], a[84:87], a[16:19], v[96:99]
  buffer_load_dwordx4 v231, s[4:7], s44 offen offset:2048 sc1 lds
  v_mfma_f32_16x16x32_bf16 v[100:103], a[84:87], a[20:23], 0
  ds_read_b64_tr_b16 a[66:67], v228 offset:4096
  v_mfma_f32_16x16x32_bf16 v[100:103], a[80:83], a[4:7], v[100:103]
  v_mfma_f32_16x16x32_bf16 v[104:107], a[80:83], a[8:11], 0
  ds_read_b64_tr_b16 a[68:69], v228 offset:8192
  v_mfma_f32_16x16x32_bf16 v[104:107], a[84:87], a[24:27], v[104:107]
  buffer_load_dwordx4 v231, s[4:7], s44 offen offset:3072 sc1 lds
  v_mfma_f32_16x16x32_bf16 v[108:111], a[84:87], a[28:31], 0
  ds_read_b64_tr_b16 a[70:71], v228 offset:12288
  v_mfma_f32_16x16x32_bf16 v[108:111], a[80:83], a[12:15], v[108:111]
  s_waitcnt lgkmcnt(4)
  v_mfma_f32_16x16x32_bf16 v[124:127], a[88:91], a[12:15], 0
  ds_read_b64_tr_b16 a[72:73], v228 offset:16384
  s_add_u32 m0, s68, 49152
  v_mfma_f32_16x16x32_bf16 v[124:127], a[92:95], a[28:31], v[124:127]
  buffer_load_dwordx4 v231, s[4:7], s45 offen offset:0 sc1 lds
  v_mfma_f32_16x16x32_bf16 v[120:123], a[92:95], a[24:27], 0
  ds_read_b64_tr_b16 a[74:75], v228 offset:20480
  v_mfma_f32_16x16x32_bf16 v[120:123], a[88:91], a[8:11], v[120:123]
  v_mfma_f32_16x16x32_bf16 v[116:119], a[88:91], a[4:7], 0
  ds_read_b64_tr_b16 a[76:77], v228 offset:24576
  v_mfma_f32_16x16x32_bf16 v[116:119], a[92:95], a[20:23], v[116:119]
  buffer_load_dwordx4 v231, s[4:7], s45 offen offset:1024 sc1 lds
  v_mfma_f32_16x16x32_bf16 v[112:115], a[92:95], a[16:19], 0
  ds_read_b64_tr_b16 a[78:79], v228 offset:28672
  v_mfma_f32_16x16x32_bf16 v[112:115], a[88:91], a[0:3], v[112:115]
  s_waitcnt lgkmcnt(4)
  v_mfma_f32_16x16x32_bf16 v[128:131], a[64:67], a[0:3], 0
  ds_read_b64_tr_b16 a[80:81], v229 offset:0
  v_mfma_f32_16x16x32_bf16 v[128:131], a[68:71], a[16:19], v[128:131]
  buffer_load_dwordx4 v231, s[4:7], s45 offen offset:2048 sc1 lds
  v_mfma_f32_16x16x32_bf16 v[132:135], a[68:71], a[20:23], 0
  ds_read_b64_tr_b16 a[82:83], v229 offset:4096
  v_mfma_f32_16x16x32_bf16 v[132:135], a[64:67], a[4:7], v[132:135]
  v_mfma_f32_16x16x32_bf16 v[136:139], a[64:67], a[8:11], 0
  ds_read_b64_tr_b16 a[84:85], v229 offset:8192
  v_mfma_f32_16x16x32_bf16 v[136:139], a[68:71], a[24:27], v[136:139]
  buffer_load_dwordx4 v231, s[4:7], s45 offen offset:3072 sc1 lds
  v_mfma_f32_16x16x32_bf16 v[140:143], a[68:71], a[28:31], 0
  ds_read_b64_tr_b16 a[86:87], v229 offset:12288
  v_mfma_f32_16x16x32_bf16 v[140:143], a[64:67], a[12:15], v[140:143]
  s_waitcnt lgkmcnt(4)
  v_mfma_f32_16x16x32_bf16 v[156:159], a[72:75], a[12:15], 0
  ds_read_b64_tr_b16 a[88:89], v229 offset:16384
  v_mfma_f32_16x16x32_bf16 v[156:159], a[76:79], a[28:31], v[156:159]
  v_mfma_f32_16x16x32_bf16 v[152:155], a[76:79], a[24:27], 0
  ds_read_b64_tr_b16 a[90:91], v229 offset:20480
  s_add_u32 m0, s68, 0
  v_mfma_f32_16x16x32_bf16 v[152:155], a[72:75], a[8:11], v[152:155]
  buffer_load_dwordx4 v232, s[16:19], s67 offen offset:0  lds
  v_mfma_f32_16x16x32_bf16 v[148:151], a[72:75], a[4:7], 0
  ds_read_b64_tr_b16 a[92:93], v229 offset:24576
  v_mfma_f32_16x16x32_bf16 v[148:151], a[76:79], a[20:23], v[148:151]
  v_mfma_f32_16x16x32_bf16 v[144:147], a[76:79], a[16:19], 0
  ds_read_b64_tr_b16 a[94:95], v229 offset:28672
  v_mfma_f32_16x16x32_bf16 v[144:147], a[72:75], a[0:3], v[144:147]
  buffer_load_dwordx4 v233, s[16:19], s67 offen offset:1024  lds
  s_waitcnt lgkmcnt(4)
  v_mfma_f32_16x16x32_bf16 v[160:163], a[80:83], a[0:3], 0
  ds_read_b64_tr_b16 a[64:65], v230 offset:0
  v_mfma_f32_16x16x32_bf16 v[160:163], a[84:87], a[16:19], v[160:163]
  v_mfma_f32_16x16x32_bf16 v[164:167], a[84:87], a[20:23], 0
  ds_read_b64_tr_b16 a[66:67], v230 offset:4096
  v_mfma_f32_16x16x32_bf16 v[164:167], a[80:83], a[4:7], v[164:167]
  buffer_load_dwordx4 v234, s[16:19], s67 offen offset:2048  lds
  v_mfma_f32_16x16x32_bf16 v[168:171], a[80:83], a[8:11], 0
  ds_read_b64_tr_b16 a[68:69], v230 offset:8192
  v_mfma_f32_16x16x32_bf16 v[168:171], a[84:87], a[24:27], v[168:171]
  v_mfma_f32_16x16x32_bf16 v[172:175], a[84:87], a[28:31], 0
  ds_read_b64_tr_b16 a[70:71], v230 offset:12288
  v_mfma_f32_16x16x32_bf16 v[172:175], a[80:83], a[12:15], v[172:175]
  buffer_load_dwordx4 v235, s[16:19], s67 offen offset:3072  lds
  s_waitcnt lgkmcnt(4)
  v_mfma_f32_16x16x32_bf16 v[188:191], a[88:91], a[12:15], 0
  ds_read_b64_tr_b16 a[72:73], v230 offset:16384
  v_mfma_f32_16x16x32_bf16 v[188:191], a[92:95], a[28:31], v[188:191]
  v_mfma_f32_16x16x32_bf16 v[184:187], a[92:95], a[24:27], 0
  ds_read_b64_tr_b16 a[74:75], v230 offset:20480
  s_add_u32 m0, s68, 16384
  v_mfma_f32_16x16x32_bf16 v[184:187], a[88:91], a[8:11], v[184:187]
  buffer_load_dwordx4 v232, s[20:23], s67 offen offset:0  lds
  v_mfma_f32_16x16x32_bf16 v[180:183], a[88:91], a[4:7], 0
  ds_read_b64_tr_b16 a[76:77], v230 offset:24576
  v_mfma_f32_16x16x32_bf16 v[180:183], a[92:95], a[20:23], v[180:183]
  v_mfma_f32_16x16x32_bf16 v[176:179], a[92:95], a[16:19], 0
  ds_read_b64_tr_b16 a[78:79], v230 offset:28672
  v_mfma_f32_16x16x32_bf16 v[176:179], a[88:91], a[0:3], v[176:179]
  buffer_load_dwordx4 v233, s[20:23], s67 offen offset:1024  lds
  s_waitcnt lgkmcnt(4)
  v_mfma_f32_16x16x32_bf16 v[192:195], a[64:67], a[0:3], 0
  s_barrier
  ds_read_b64_tr_b16 a[80:81], v224 offset:32768
  v_mfma_f32_16x16x32_bf16 v[192:195], a[68:71], a[16:19], v[192:195]
  v_mfma_f32_16x16x32_bf16 v[196:199], a[68:71], a[20:23], 0
  ds_read_b64_tr_b16 a[82:83], v224 offset:36864
  v_mfma_f32_16x16x32_bf16 v[196:199], a[64:67], a[4:7], v[196:199]
  buffer_load_dwordx4 v234, s[20:23], s67 offen offset:2048  lds
  v_mfma_f32_16x16x32_bf16 v[200:203], a[64:67], a[8:11], 0
  ds_read_b64_tr_b16 a[84:85], v224 offset:40960
  v_mfma_f32_16x16x32_bf16 v[200:203], a[68:71], a[24:27], v[200:203]
  v_mfma_f32_16x16x32_bf16 v[204:207], a[68:71], a[28:31], 0
  ds_read_b64_tr_b16 a[86:87], v224 offset:45056
  v_mfma_f32_16x16x32_bf16 v[204:207], a[64:67], a[12:15], v[204:207]
  buffer_load_dwordx4 v235, s[20:23], s67 offen offset:3072  lds
  s_waitcnt lgkmcnt(4)
  v_mfma_f32_16x16x32_bf16 v[220:223], a[72:75], a[12:15], 0
  ds_read_b64_tr_b16 a[88:89], v224 offset:49152
  s_add_u32 s67, s67, 458752
  v_mfma_f32_16x16x32_bf16 v[220:223], a[76:79], a[28:31], v[220:223]
  v_mfma_f32_16x16x32_bf16 v[216:219], a[76:79], a[24:27], 0
  ds_read_b64_tr_b16 a[90:91], v224 offset:53248
  v_mfma_f32_16x16x32_bf16 v[216:219], a[72:75], a[8:11], v[216:219]
  v_mfma_f32_16x16x32_bf16 v[212:215], a[72:75], a[4:7], 0
  ds_read_b64_tr_b16 a[92:93], v224 offset:57344
  buffer_load_dwordx4 a[96:99], v236, s[24:27], s70 offen
  v_mfma_f32_16x16x32_bf16 v[212:215], a[76:79], a[20:23], v[212:215]
  s_add_u32 s70, s70, 1024
  v_mfma_f32_16x16x32_bf16 v[208:211], a[76:79], a[16:19], 0
  ds_read_b64_tr_b16 a[94:95], v224 offset:61440
  v_xor_b32 v224, 0x10000, v224
  v_mfma_f32_16x16x32_bf16 v[208:211], a[72:75], a[0:3], v[208:211]
Lmk_p3s1:
  s_waitcnt vmcnt(17) lgkmcnt(4)
  v_mfma_f32_16x16x32_bf16 v[0:3], a[80:83], a[32:35], v[0:3]
  ds_read_b64_tr_b16 a[64:65], v225 offset:32768
  v_mfma_f32_16x16x32_bf16 v[0:3], a[84:87], a[48:51], v[0:3]
  v_mfma_f32_16x16x32_bf16 v[4:7], a[84:87], a[52:55], v[4:7]
  ds_read_b64_tr_b16 a[66:67], v225 offset:36864
  v_mfma_f32_16x16x32_bf16 v[4:7], a[80:83], a[36:39], v[4:7]
  buffer_load_dwordx4 a[0:3], v231, s[4:7], s72 offen offset:0 sc1
  v_mfma_f32_16x16x32_bf16 v[8:11], a[80:83], a[40:43], v[8:11]
  ds_read_b64_tr_b16 a[68:69], v225 offset:40960
  v_mfma_f32_16x16x32_bf16 v[8:11], a[84:87], a[56:59], v[8:11]
  s_add_u32 s43, s68, 32768
  v_lshlrev_b32 v250, 3, v253
  v_mfma_f32_16x16x32_bf16 v[12:15], a[84:87], a[60:63], v[12:15]
  ds_read_b64_tr_b16 a[70:71], v225 offset:45056
  v_add_u32 v250, s43, v250
  v_mfma_f32_16x16x32_bf16 v[12:15], a[80:83], a[44:47], v[12:15]
  s_waitcnt lgkmcnt(4)
  v_mfma_f32_16x16x32_bf16 v[28:31], a[88:91], a[44:47], v[28:31]
  ds_read_b64_tr_b16 a[72:73], v225 offset:49152
  v_mfma_f32_16x16x32_bf16 v[28:31], a[92:95], a[60:63], v[28:31]
  v_mfma_f32_16x16x32_bf16 v[24:27], a[92:95], a[56:59], v[24:27]
  ds_read_b64_tr_b16 a[74:75], v225 offset:53248
  buffer_load_dwordx4 a[16:19], v231, s[4:7], s72 offen offset:1024 sc1
  v_mfma_f32_16x16x32_bf16 v[24:27], a[88:91], a[40:43], v[24:27]
  v_mfma_f32_16x16x32_bf16 v[20:23], a[88:91], a[36:39], v[20:23]
  ds_read_b64_tr_b16 a[76:77], v225 offset:57344
  v_mfma_f32_16x16x32_bf16 v[20:23], a[92:95], a[52:55], v[20:23]
  s_waitcnt vmcnt(11)
  ds_read_b64 v[238:239], v250 offset:0
  v_mfma_f32_16x16x32_bf16 v[16:19], a[92:95], a[48:51], v[16:19]
  ds_read_b64_tr_b16 a[78:79], v225 offset:61440
  ds_read_b64 v[240:241], v250 offset:2048
  v_xor_b32 v225, 0x10000, v225
  v_mfma_f32_16x16x32_bf16 v[16:19], a[88:91], a[32:35], v[16:19]
  ds_read_b64 v[242:243], v250 offset:16384
  s_waitcnt lgkmcnt(7)
  v_mfma_f32_16x16x32_bf16 v[32:35], a[64:67], a[32:35], v[32:35]
  ds_read_b64_tr_b16 a[80:81], v226 offset:32768
  ds_read_b64 v[244:245], v250 offset:18432
  v_mfma_f32_16x16x32_bf16 v[32:35], a[68:71], a[48:51], v[32:35]
  buffer_load_dwordx4 a[4:7], v231, s[4:7], s73 offen offset:0 sc1
  ds_read_b64 v[246:247], v250 offset:512
  v_mfma_f32_16x16x32_bf16 v[36:39], a[68:71], a[52:55], v[36:39]
  ds_read_b64_tr_b16 a[82:83], v226 offset:36864
  v_mfma_f32_16x16x32_bf16 v[36:39], a[64:67], a[36:39], v[36:39]
  v_mfma_f32_16x16x32_bf16 v[40:43], a[64:67], a[40:43], v[40:43]
  ds_read_b64_tr_b16 a[84:85], v226 offset:40960
  ds_read_b64 v[248:249], v250 offset:2560
  v_mfma_f32_16x16x32_bf16 v[40:43], a[68:71], a[56:59], v[40:43]
  v_mfma_f32_16x16x32_bf16 v[44:47], a[68:71], a[60:63], v[44:47]
  s_waitcnt lgkmcnt(3)
  ds_read_b64_tr_b16 a[86:87], v226 offset:45056
  v_add_f32 v238, v238, v246
  v_add_f32 v239, v239, v247
  v_mfma_f32_16x16x32_bf16 v[44:47], a[64:67], a[44:47], v[44:47]
  ds_read_b64 v[246:247], v250 offset:16896
  v_mfma_f32_16x16x32_bf16 v[60:63], a[72:75], a[44:47], v[60:63]
  ds_read_b64_tr_b16 a[88:89], v226 offset:49152
  buffer_load_dwordx4 a[20:23], v231, s[4:7], s73 offen offset:1024 sc1
  v_mfma_f32_16x16x32_bf16 v[60:63], a[76:79], a[60:63], v[60:63]
  s_waitcnt lgkmcnt(3)
  v_add_f32 v240, v240, v248
  v_add_f32 v241, v241, v249
  v_mfma_f32_16x16x32_bf16 v[56:59], a[76:79], a[56:59], v[56:59]
  ds_read_b64_tr_b16 a[90:91], v226 offset:53248
  ds_read_b64 v[248:249], v250 offset:18944
  v_mfma_f32_16x16x32_bf16 v[56:59], a[72:75], a[40:43], v[56:59]
  v_mfma_f32_16x16x32_bf16 v[52:55], a[72:75], a[36:39], v[52:55]
  s_waitcnt lgkmcnt(3)
  ds_read_b64_tr_b16 a[92:93], v226 offset:57344
  v_add_f32 v242, v242, v246
  v_add_f32 v243, v243, v247
  v_mfma_f32_16x16x32_bf16 v[52:55], a[76:79], a[52:55], v[52:55]
  ds_read_b64 v[246:247], v250 offset:1024
  v_mfma_f32_16x16x32_bf16 v[48:51], a[76:79], a[48:51], v[48:51]
  ds_read_b64_tr_b16 a[94:95], v226 offset:61440
  v_xor_b32 v226, 0x10000, v226
  v_mfma_f32_16x16x32_bf16 v[48:51], a[72:75], a[32:35], v[48:51]
  s_waitcnt lgkmcnt(3)
  buffer_load_dwordx4 a[8:11], v231, s[4:7], s74 offen offset:0 sc1
  v_add_f32 v244, v244, v248
  v_add_f32 v245, v245, v249
  v_mfma_f32_16x16x32_bf16 v[64:67], a[80:83], a[32:35], v[64:67]
  ds_read_b64_tr_b16 a[64:65], v227 offset:32768
  ds_read_b64 v[248:249], v250 offset:3072
  v_mfma_f32_16x16x32_bf16 v[64:67], a[84:87], a[48:51], v[64:67]
  v_mfma_f32_16x16x32_bf16 v[68:71], a[84:87], a[52:55], v[68:71]
  s_waitcnt lgkmcnt(3)
  ds_read_b64_tr_b16 a[66:67], v227 offset:36864
  v_add_f32 v238, v238, v246
  v_add_f32 v239, v239, v247
  v_mfma_f32_16x16x32_bf16 v[68:71], a[80:83], a[36:39], v[68:71]
  ds_read_b64 v[246:247], v250 offset:17408
  v_mfma_f32_16x16x32_bf16 v[72:75], a[80:83], a[40:43], v[72:75]
  ds_read_b64_tr_b16 a[68:69], v227 offset:40960
  v_mfma_f32_16x16x32_bf16 v[72:75], a[84:87], a[56:59], v[72:75]
  s_waitcnt lgkmcnt(3)
  v_add_f32 v240, v240, v248
  v_add_f32 v241, v241, v249
  v_mfma_f32_16x16x32_bf16 v[76:79], a[84:87], a[60:63], v[76:79]
  ds_read_b64_tr_b16 a[70:71], v227 offset:45056
  buffer_load_dwordx4 a[24:27], v231, s[4:7], s74 offen offset:1024 sc1
  ds_read_b64 v[248:249], v250 offset:19456
  v_mfma_f32_16x16x32_bf16 v[76:79], a[80:83], a[44:47], v[76:79]
  v_mfma_f32_16x16x32_bf16 v[92:95], a[88:91], a[44:47], v[92:95]
  s_waitcnt lgkmcnt(3)
  ds_read_b64_tr_b16 a[72:73], v227 offset:49152
  v_add_f32 v242, v242, v246
  v_add_f32 v243, v243, v247
  v_mfma_f32_16x16x32_bf16 v[92:95], a[92:95], a[60:63], v[92:95]
  ds_read_b64 v[246:247], v250 offset:1536
  v_mfma_f32_16x16x32_bf16 v[88:91], a[92:95], a[56:59], v[88:91]
  ds_read_b64_tr_b16 a[74:75], v227 offset:53248
  v_mfma_f32_16x16x32_bf16 v[88:91], a[88:91], a[40:43], v[88:91]
  s_waitcnt lgkmcnt(3)
  v_add_f32 v244, v244, v248
  v_add_f32 v245, v245, v249
  v_mfma_f32_16x16x32_bf16 v[84:87], a[88:91], a[36:39], v[84:87]
  ds_read_b64_tr_b16 a[76:77], v227 offset:57344
  ds_read_b64 v[248:249], v250 offset:3584
  v_mfma_f32_16x16x32_bf16 v[84:87], a[92:95], a[52:55], v[84:87]
  buffer_load_dwordx4 a[12:15], v231, s[4:7], s75 offen offset:0 sc1
  v_mfma_f32_16x16x32_bf16 v[80:83], a[92:95], a[48:51], v[80:83]
  s_waitcnt lgkmcnt(3)
  ds_read_b64_tr_b16 a[78:79], v227 offset:61440
  v_xor_b32 v227, 0x10000, v227
  v_add_f32 v238, v238, v246
  v_add_f32 v239, v239, v247
  v_mfma_f32_16x16x32_bf16 v[80:83], a[88:91], a[32:35], v[80:83]
  ds_read_b64 v[246:247], v250 offset:17920
  buffer_load_dword v237, v251, s[4:7], s48 offen sc1
  v_mfma_f32_16x16x32_bf16 v[96:99], a[64:67], a[32:35], v[96:99]
  ds_read_b64_tr_b16 a[80:81], v228 offset:32768
  v_mfma_f32_16x16x32_bf16 v[96:99], a[68:71], a[48:51], v[96:99]
  s_waitcnt lgkmcnt(3)
  v_add_f32 v240, v240, v248
  v_add_f32 v241, v241, v249
  v_mfma_f32_16x16x32_bf16 v[100:103], a[68:71], a[52:55], v[100:103]
  ds_read_b64_tr_b16 a[82:83], v228 offset:36864
  ds_read_b64 v[248:249], v250 offset:19968
  v_mfma_f32_16x16x32_bf16 v[100:103], a[64:67], a[36:39], v[100:103]
  v_mfma_f32_16x16x32_bf16 v[104:107], a[64:67], a[40:43], v[104:107]
  s_waitcnt lgkmcnt(3)
  ds_read_b64_tr_b16 a[84:85], v228 offset:40960
  buffer_load_dwordx4 a[28:31], v231, s[4:7], s75 offen offset:1024 sc1
  v_add_f32 v242, v242, v246
  v_add_f32 v243, v243, v247
  v_mfma_f32_16x16x32_bf16 v[104:107], a[68:71], a[56:59], v[104:107]
  buffer_load_dwordx4 a[96:99], v236, s[24:27], s70 offen
  v_mfma_f32_16x16x32_bf16 v[108:111], a[68:71], a[60:63], v[108:111]
  ds_read_b64_tr_b16 a[86:87], v228 offset:45056
  s_add_u32 s70, s70, 1024
  v_mfma_f32_16x16x32_bf16 v[108:111], a[64:67], a[44:47], v[108:111]
  s_waitcnt lgkmcnt(2)
  v_add_f32 v244, v244, v248
  v_add_f32 v245, v245, v249
  v_mfma_f32_16x16x32_bf16 v[124:127], a[72:75], a[44:47], v[124:127]
  ds_read_b64_tr_b16 a[88:89], v228 offset:49152
  s_mov_b32 s43, 0x3a800000
  v_mfma_f32_16x16x32_bf16 v[124:127], a[76:79], a[60:63], v[124:127]
  v_mov_b32 v250, 0x3727c5ac
  v_lshlrev_b32 v246, 2, v253
  v_mfma_f32_16x16x32_bf16 v[120:123], a[76:79], a[56:59], v[120:123]
  ds_read_b64_tr_b16 a[90:91], v228 offset:53248
  s_add_u32 m0, s68, 32768
  v_mfma_f32_16x16x32_bf16 v[120:123], a[72:75], a[40:43], v[120:123]
  buffer_load_dwordx4 v232, s[16:19], s67 offen offset:0  lds
  v_add_u32 v246, s71, v246
  v_mfma_f32_16x16x32_bf16 v[116:119], a[72:75], a[36:39], v[116:119]
  ds_read_b64_tr_b16 a[92:93], v228 offset:57344
  v_permlane32_swap_b32 v238, v242
  v_mfma_f32_16x16x32_bf16 v[116:119], a[76:79], a[52:55], v[116:119]
  v_permlane32_swap_b32 v239, v243
  v_permlane32_swap_b32 v240, v244
  v_mfma_f32_16x16x32_bf16 v[112:115], a[76:79], a[48:51], v[112:115]
  ds_read_b64_tr_b16 a[94:95], v228 offset:61440
  v_xor_b32 v228, 0x10000, v228
  v_permlane32_swap_b32 v241, v245
  v_mfma_f32_16x16x32_bf16 v[112:115], a[72:75], a[32:35], v[112:115]
  s_waitcnt lgkmcnt(4)
  v_add_f32 v238, v238, v242
  v_add_f32 v240, v240, v244
  v_mfma_f32_16x16x32_bf16 v[128:131], a[80:83], a[32:35], v[128:131]
  ds_read_b64_tr_b16 a[64:65], v229 offset:32768
  v_add_f32 v239, v239, v243
  v_mfma_f32_16x16x32_bf16 v[128:131], a[84:87], a[48:51], v[128:131]
  v_add_f32 v241, v241, v245
  v_and_b32 v247, 0xffffff3f, v246
  v_mfma_f32_16x16x32_bf16 v[132:135], a[84:87], a[52:55], v[132:135]
  ds_read_b64_tr_b16 a[66:67], v229 offset:36864
  buffer_load_dwordx4 v233, s[16:19], s67 offen offset:1024  lds
  v_mfma_f32_16x16x32_bf16 v[132:135], a[80:83], a[36:39], v[132:135]
  v_permlane16_swap_b32 v238, v240
  v_permlane16_swap_b32 v239, v241
  v_mfma_f32_16x16x32_bf16 v[136:139], a[80:83], a[40:43], v[136:139]
  ds_read_b64_tr_b16 a[68:69], v229 offset:40960
  v_add_f32 v238, v238, v240
  v_mfma_f32_16x16x32_bf16 v[136:139], a[84:87], a[56:59], v[136:139]
  v_add_f32 v239, v239, v241
  v_add_u32 v247, 1024, v247
  v_mfma_f32_16x16x32_bf16 v[140:143], a[84:87], a[60:63], v[140:143]
  ds_read_b64_tr_b16 a[70:71], v229 offset:45056
  v_mul_f32 v238, 0xba800000, v238
  v_mfma_f32_16x16x32_bf16 v[140:143], a[80:83], a[44:47], v[140:143]
  s_waitcnt lgkmcnt(4)
  v_fma_f32 v239, v239, s43, v250
  v_fma_f32 v239, -v238, v238, v239
  v_mfma_f32_16x16x32_bf16 v[156:159], a[88:91], a[44:47], v[156:159]
  ds_read_b64_tr_b16 a[72:73], v229 offset:49152
  v_max_f32 v239, v239, v250
  v_mfma_f32_16x16x32_bf16 v[156:159], a[92:95], a[60:63], v[156:159]
  buffer_load_dwordx4 v234, s[16:19], s67 offen offset:2048  lds
  v_rsq_f32 v240, v239
  v_mfma_f32_16x16x32_bf16 v[152:155], a[92:95], a[56:59], v[152:155]
  ds_read_b64_tr_b16 a[74:75], v229 offset:53248
  ds_write_b32 v246, v238 offset:1024
  v_mfma_f32_16x16x32_bf16 v[152:155], a[88:91], a[40:43], v[152:155]
  ds_write_b32 v246, v239 offset:1536
  v_mul_f32 v240, 0xbfb8aa3b, v240
  v_mfma_f32_16x16x32_bf16 v[148:151], a[88:91], a[36:39], v[148:151]
  ds_read_b64_tr_b16 a[76:77], v229 offset:57344
  ds_write_b32 v246, v240 offset:1280
  v_mfma_f32_16x16x32_bf16 v[148:151], a[92:95], a[52:55], v[148:151]
  ds_read2_b32 v[238:239], v247 offset0:0 offset1:16
  ds_read2_b32 v[240:241], v247 offset0:32 offset1:48
  v_mfma_f32_16x16x32_bf16 v[144:147], a[92:95], a[48:51], v[144:147]
  ds_read_b64_tr_b16 a[78:79], v229 offset:61440
  v_xor_b32 v229, 0x10000, v229
  v_lshrrev_b32 v250, 3, v253
  v_mfma_f32_16x16x32_bf16 v[144:147], a[88:91], a[32:35], v[144:147]
  s_waitcnt lgkmcnt(9)
  v_add_u32 v250, s66, v250
  v_cmp_ne_u32 vcc, 7, v250
  v_mfma_f32_16x16x32_bf16 v[160:163], a[64:67], a[32:35], v[160:163]
  ds_read_b64_tr_b16 a[80:81], v230 offset:32768
  buffer_load_dwordx4 v235, s[16:19], s67 offen offset:3072  lds
  v_mfma_f32_16x16x32_bf16 v[160:163], a[68:71], a[48:51], v[160:163]
  v_bfe_u32 v242, v253, 2, 1
  v_mul_u32_u24 v242, 14336, v242
  v_mfma_f32_16x16x32_bf16 v[164:167], a[68:71], a[52:55], v[164:167]
  ds_read_b64_tr_b16 a[82:83], v230 offset:36864
  v_cndmask_b32 v250, 0, v250, vcc
  v_mfma_f32_16x16x32_bf16 v[164:167], a[64:67], a[36:39], v[164:167]
  v_lshl_add_u32 v250, v250, 6, v242
  v_and_b32 v242, 3, v253
  v_mfma_f32_16x16x32_bf16 v[168:171], a[64:67], a[40:43], v[168:171]
  ds_read_b64_tr_b16 a[84:85], v230 offset:40960
  v_lshl_add_u32 v250, v242, 4, v250
  v_mfma_f32_16x16x32_bf16 v[168:171], a[68:71], a[56:59], v[168:171]
  s_waitcnt vmcnt(6)
  v_cmp_gt_u32 vcc, 56, v237
  s_cbranch_vccz Lcdn16
  s_mov_b32 s43, 0x40000
Lchk15:
  s_sleep 8
  buffer_load_dword v237, v251, s[4:7], s48 offen sc1
  s_waitcnt vmcnt(0)
  v_cmp_gt_u32 vcc, 56, v237
  s_cbranch_vccz Lcdn16
  s_sub_u32 s43, s43, 1
  s_cmp_lg_u32 s43, 0
  s_cbranch_scc1 Lchk15
Lcdn16:
  buffer_load_dwordx4 v[242:245], v250, s[4:7], s46 offen sc1
  v_mfma_f32_16x16x32_bf16 v[172:175], a[68:71], a[60:63], v[172:175]
  ds_read_b64_tr_b16 a[86:87], v230 offset:45056
  s_add_u32 m0, s68, 49152
  v_mfma_f32_16x16x32_bf16 v[172:175], a[64:67], a[44:47], v[172:175]
  s_waitcnt lgkmcnt(4)
  buffer_load_dwordx4 v232, s[20:23], s67 offen offset:0  lds
  buffer_load_dwordx4 v[246:249], v250, s[4:7], s47 offen sc1
  v_mfma_f32_16x16x32_bf16 v[188:191], a[72:75], a[44:47], v[188:191]
  ds_read_b64_tr_b16 a[88:89], v230 offset:49152
  v_lshrrev_b32 v237, 4, v253
  v_mfma_f32_16x16x32_bf16 v[188:191], a[76:79], a[60:63], v[188:191]
  v_lshlrev_b32 v237, 4, v237
  v_add_u32 v237, s71, v237
  v_mfma_f32_16x16x32_bf16 v[184:187], a[76:79], a[56:59], v[184:187]
  ds_read_b64_tr_b16 a[90:91], v230 offset:53248
  v_add_u32 v250, s71, v231
  v_mfma_f32_16x16x32_bf16 v[184:187], a[72:75], a[40:43], v[184:187]
  v_mfma_f32_16x16x32_bf16 v[180:183], a[72:75], a[36:39], v[180:183]
  ds_read_b64_tr_b16 a[92:93], v230 offset:57344
  v_mfma_f32_16x16x32_bf16 v[180:183], a[76:79], a[52:55], v[180:183]
  v_mfma_f32_16x16x32_bf16 v[176:179], a[76:79], a[48:51], v[176:179]
  ds_read_b64_tr_b16 a[94:95], v230 offset:61440
  buffer_load_dwordx4 v233, s[20:23], s67 offen offset:1024  lds
  v_xor_b32 v230, 0x10000, v230
  v_mfma_f32_16x16x32_bf16 v[176:179], a[72:75], a[32:35], v[176:179]
  s_waitcnt lgkmcnt(4)
  v_mfma_f32_16x16x32_bf16 v[192:195], a[80:83], a[32:35], v[192:195]
  s_barrier
  ds_read_b64_tr_b16 a[64:65], v224 offset:0
  v_mfma_f32_16x16x32_bf16 v[192:195], a[84:87], a[48:51], v[192:195]
  v_mfma_f32_16x16x32_bf16 v[196:199], a[84:87], a[52:55], v[196:199]
  ds_read_b64_tr_b16 a[66:67], v224 offset:4096
  v_mfma_f32_16x16x32_bf16 v[196:199], a[80:83], a[36:39], v[196:199]
  v_mfma_f32_16x16x32_bf16 v[200:203], a[80:83], a[40:43], v[200:203]
  ds_read_b64_tr_b16 a[68:69], v224 offset:8192
  v_mfma_f32_16x16x32_bf16 v[200:203], a[84:87], a[56:59], v[200:203]
  buffer_load_dwordx4 v234, s[20:23], s67 offen offset:2048  lds
  v_mfma_f32_16x16x32_bf16 v[204:207], a[84:87], a[60:63], v[204:207]
  ds_read_b64_tr_b16 a[70:71], v224 offset:12288
  v_mfma_f32_16x16x32_bf16 v[204:207], a[80:83], a[44:47], v[204:207]
  s_waitcnt lgkmcnt(4)
  v_mfma_f32_16x16x32_bf16 v[220:223], a[88:91], a[44:47], v[220:223]
  ds_read_b64_tr_b16 a[72:73], v224 offset:16384
  v_mfma_f32_16x16x32_bf16 v[220:223], a[92:95], a[60:63], v[220:223]
  v_mfma_f32_16x16x32_bf16 v[216:219], a[92:95], a[56:59], v[216:219]
  ds_read_b64_tr_b16 a[74:75], v224 offset:20480
  v_mfma_f32_16x16x32_bf16 v[216:219], a[88:91], a[40:43], v[216:219]
  v_mfma_f32_16x16x32_bf16 v[212:215], a[88:91], a[36:39], v[212:215]
  ds_read_b64_tr_b16 a[76:77], v224 offset:24576
  buffer_load_dwordx4 v235, s[20:23], s67 offen offset:3072  lds
  v_mfma_f32_16x16x32_bf16 v[212:215], a[92:95], a[52:55], v[212:215]
  s_add_u32 s67, s67, 458752
  s_xor_b32 s68, s68, 0x10000
  v_mfma_f32_16x16x32_bf16 v[208:211], a[92:95], a[48:51], v[208:211]
  ds_read_b64_tr_b16 a[78:79], v224 offset:28672
  v_mfma_f32_16x16x32_bf16 v[208:211], a[88:91], a[32:35], v[208:211]
  s_mov_b32 s56, 5
.p2align 3
Lp3_loop:
  s_waitcnt vmcnt(8) lgkmcnt(4)
  v_mfma_f32_16x16x32_bf16 v[0:3], a[64:67], a[0:3], v[0:3]
  ds_read_b64_tr_b16 a[80:81], v225 offset:0
  v_mfma_f32_16x16x32_bf16 v[0:3], a[68:71], a[16:19], v[0:3]
  v_mfma_f32_16x16x32_bf16 v[4:7], a[68:71], a[20:23], v[4:7]
  ds_read_b64_tr_b16 a[82:83], v225 offset:4096
  v_mfma_f32_16x16x32_bf16 v[4:7], a[64:67], a[4:7], v[4:7]
  buffer_load_dwordx4 a[32:35], v231, s[4:7], s72 offen offset:2048 sc1
  v_mfma_f32_16x16x32_bf16 v[8:11], a[64:67], a[8:11], v[8:11]
  ds_read_b64_tr_b16 a[84:85], v225 offset:8192
  v_mfma_f32_16x16x32_bf16 v[8:11], a[68:71], a[24:27], v[8:11]
  v_mfma_f32_16x16x32_bf16 v[12:15], a[68:71], a[28:31], v[12:15]
  ds_read_b64_tr_b16 a[86:87], v225 offset:12288
  v_mfma_f32_16x16x32_bf16 v[12:15], a[64:67], a[12:15], v[12:15]
  s_waitcnt lgkmcnt(4)
  v_mfma_f32_16x16x32_bf16 v[28:31], a[72:75], a[12:15], v[28:31]
  ds_read_b64_tr_b16 a[88:89], v225 offset:16384
  v_mfma_f32_16x16x32_bf16 v[28:31], a[76:79], a[28:31], v[28:31]
  v_mfma_f32_16x16x32_bf16 v[24:27], a[76:79], a[24:27], v[24:27]
  ds_read_b64_tr_b16 a[90:91], v225 offset:20480
  buffer_load_dwordx4 a[48:51], v231, s[4:7], s72 offen offset:3072 sc1
  v_mfma_f32_16x16x32_bf16 v[24:27], a[72:75], a[8:11], v[24:27]
  s_add_u32 s72, s72, 4096
  v_mfma_f32_16x16x32_bf16 v[20:23], a[72:75], a[4:7], v[20:23]
  ds_read_b64_tr_b16 a[92:93], v225 offset:24576
  v_mfma_f32_16x16x32_bf16 v[20:23], a[76:79], a[20:23], v[20:23]
  v_mfma_f32_16x16x32_bf16 v[16:19], a[76:79], a[16:19], v[16:19]
  ds_read_b64_tr_b16 a[94:95], v225 offset:28672
  v_mfma_f32_16x16x32_bf16 v[16:19], a[72:75], a[0:3], v[16:19]
  s_waitcnt lgkmcnt(4)
  v_mfma_f32_16x16x32_bf16 v[32:35], a[80:83], a[0:3], v[32:35]
  ds_read_b64_tr_b16 a[64:65], v226 offset:0
  v_mfma_f32_16x16x32_bf16 v[32:35], a[84:87], a[16:19], v[32:35]
  buffer_load_dwordx4 a[36:39], v231, s[4:7], s73 offen offset:2048 sc1
  v_mfma_f32_16x16x32_bf16 v[36:39], a[84:87], a[20:23], v[36:39]
  ds_read_b64_tr_b16 a[66:67], v226 offset:4096
  v_mfma_f32_16x16x32_bf16 v[36:39], a[80:83], a[4:7], v[36:39]
  v_mfma_f32_16x16x32_bf16 v[40:43], a[80:83], a[8:11], v[40:43]
  ds_read_b64_tr_b16 a[68:69], v226 offset:8192
  v_mfma_f32_16x16x32_bf16 v[40:43], a[84:87], a[24:27], v[40:43]
  v_mfma_f32_16x16x32_bf16 v[44:47], a[84:87], a[28:31], v[44:47]
  ds_read_b64_tr_b16 a[70:71], v226 offset:12288
  v_mfma_f32_16x16x32_bf16 v[44:47], a[80:83], a[12:15], v[44:47]
  s_waitcnt lgkmcnt(4)
  v_mfma_f32_16x16x32_bf16 v[60:63], a[88:91], a[12:15], v[60:63]
  ds_read_b64_tr_b16 a[72:73], v226 offset:16384
  buffer_load_dwordx4 a[52:55], v231, s[4:7], s73 offen offset:3072 sc1
  v_mfma_f32_16x16x32_bf16 v[60:63], a[92:95], a[28:31], v[60:63]
  s_add_u32 s73, s73, 4096
  v_mfma_f32_16x16x32_bf16 v[56:59], a[92:95], a[24:27], v[56:59]
  ds_read_b64_tr_b16 a[74:75], v226 offset:20480
  v_mfma_f32_16x16x32_bf16 v[56:59], a[88:91], a[8:11], v[56:59]
  v_mfma_f32_16x16x32_bf16 v[52:55], a[88:91], a[4:7], v[52:55]
  ds_read_b64_tr_b16 a[76:77], v226 offset:24576
  v_mfma_f32_16x16x32_bf16 v[52:55], a[92:95], a[20:23], v[52:55]
  v_mfma_f32_16x16x32_bf16 v[48:51], a[92:95], a[16:19], v[48:51]
  ds_read_b64_tr_b16 a[78:79], v226 offset:28672
  v_mfma_f32_16x16x32_bf16 v[48:51], a[88:91], a[0:3], v[48:51]
  buffer_load_dwordx4 a[40:43], v231, s[4:7], s74 offen offset:2048 sc1
  s_waitcnt lgkmcnt(4)
  v_mfma_f32_16x16x32_bf16 v[64:67], a[64:67], a[0:3], v[64:67]
  ds_read_b64_tr_b16 a[80:81], v227 offset:0
  v_mfma_f32_16x16x32_bf16 v[64:67], a[68:71], a[16:19], v[64:67]
  v_mfma_f32_16x16x32_bf16 v[68:71], a[68:71], a[20:23], v[68:71]
  ds_read_b64_tr_b16 a[82:83], v227 offset:4096
  v_mfma_f32_16x16x32_bf16 v[68:71], a[64:67], a[4:7], v[68:71]
  v_mfma_f32_16x16x32_bf16 v[72:75], a[64:67], a[8:11], v[72:75]
  ds_read_b64_tr_b16 a[84:85], v227 offset:8192
  v_mfma_f32_16x16x32_bf16 v[72:75], a[68:71], a[24:27], v[72:75]
  v_mfma_f32_16x16x32_bf16 v[76:79], a[68:71], a[28:31], v[76:79]
  ds_read_b64_tr_b16 a[86:87], v227 offset:12288
  buffer_load_dwordx4 a[56:59], v231, s[4:7], s74 offen offset:3072 sc1
  v_mfma_f32_16x16x32_bf16 v[76:79], a[64:67], a[12:15], v[76:79]
  s_add_u32 s74, s74, 4096
  s_waitcnt lgkmcnt(4)
  v_mfma_f32_16x16x32_bf16 v[92:95], a[72:75], a[12:15], v[92:95]
  ds_read_b64_tr_b16 a[88:89], v227 offset:16384
  v_mfma_f32_16x16x32_bf16 v[92:95], a[76:79], a[28:31], v[92:95]
  v_mfma_f32_16x16x32_bf16 v[88:91], a[76:79], a[24:27], v[88:91]
  ds_read_b64_tr_b16 a[90:91], v227 offset:20480
  v_mfma_f32_16x16x32_bf16 v[88:91], a[72:75], a[8:11], v[88:91]
  v_mfma_f32_16x16x32_bf16 v[84:87], a[72:75], a[4:7], v[84:87]
  ds_read_b64_tr_b16 a[92:93], v227 offset:24576
  v_mfma_f32_16x16x32_bf16 v[84:87], a[76:79], a[20:23], v[84:87]
  buffer_load_dwordx4 a[44:47], v231, s[4:7], s75 offen offset:2048 sc1
  v_mfma_f32_16x16x32_bf16 v[80:83], a[76:79], a[16:19], v[80:83]
  ds_read_b64_tr_b16 a[94:95], v227 offset:28672
  v_mfma_f32_16x16x32_bf16 v[80:83], a[72:75], a[0:3], v[80:83]
  s_waitcnt lgkmcnt(4)
  v_mfma_f32_16x16x32_bf16 v[96:99], a[80:83], a[0:3], v[96:99]
  ds_read_b64_tr_b16 a[64:65], v228 offset:0
  v_mfma_f32_16x16x32_bf16 v[96:99], a[84:87], a[16:19], v[96:99]
  v_mfma_f32_16x16x32_bf16 v[100:103], a[84:87], a[20:23], v[100:103]
  ds_read_b64_tr_b16 a[66:67], v228 offset:4096
  v_mfma_f32_16x16x32_bf16 v[100:103], a[80:83], a[4:7], v[100:103]
  v_mfma_f32_16x16x32_bf16 v[104:107], a[80:83], a[8:11], v[104:107]
  ds_read_b64_tr_b16 a[68:69], v228 offset:8192
  buffer_load_dwordx4 a[60:63], v231, s[4:7], s75 offen offset:3072 sc1
  v_mfma_f32_16x16x32_bf16 v[104:107], a[84:87], a[24:27], v[104:107]
  s_add_u32 s75, s75, 4096
  buffer_load_dwordx4 a[96:99], v236, s[24:27], s70 offen
  v_mfma_f32_16x16x32_bf16 v[108:111], a[84:87], a[28:31], v[108:111]
  ds_read_b64_tr_b16 a[70:71], v228 offset:12288
  s_add_u32 s70, s70, 1024
  v_mfma_f32_16x16x32_bf16 v[108:111], a[80:83], a[12:15], v[108:111]
  s_waitcnt lgkmcnt(4)
  v_mfma_f32_16x16x32_bf16 v[124:127], a[88:91], a[12:15], v[124:127]
  ds_read_b64_tr_b16 a[72:73], v228 offset:16384
  v_mfma_f32_16x16x32_bf16 v[124:127], a[92:95], a[28:31], v[124:127]
  v_mfma_f32_16x16x32_bf16 v[120:123], a[92:95], a[24:27], v[120:123]
  ds_read_b64_tr_b16 a[74:75], v228 offset:20480
  s_add_u32 m0, s68, 0
  v_mfma_f32_16x16x32_bf16 v[120:123], a[88:91], a[8:11], v[120:123]
  buffer_load_dwordx4 v232, s[16:19], s67 offen offset:0  lds
  v_mfma_f32_16x16x32_bf16 v[116:119], a[88:91], a[4:7], v[116:119]
  ds_read_b64_tr_b16 a[76:77], v228 offset:24576
  v_mfma_f32_16x16x32_bf16 v[116:119], a[92:95], a[20:23], v[116:119]
  v_mfma_f32_16x16x32_bf16 v[112:115], a[92:95], a[16:19], v[112:115]
  ds_read_b64_tr_b16 a[78:79], v228 offset:28672
  v_mfma_f32_16x16x32_bf16 v[112:115], a[88:91], a[0:3], v[112:115]
  s_waitcnt lgkmcnt(4)
  v_mfma_f32_16x16x32_bf16 v[128:131], a[64:67], a[0:3], v[128:131]
  ds_read_b64_tr_b16 a[80:81], v229 offset:0
  v_mfma_f32_16x16x32_bf16 v[128:131], a[68:71], a[16:19], v[128:131]
  v_mfma_f32_16x16x32_bf16 v[132:135], a[68:71], a[20:23], v[132:135]
  ds_read_b64_tr_b16 a[82:83], v229 offset:4096
  buffer_load_dwordx4 v233, s[16:19], s67 offen offset:1024  lds
  v_mfma_f32_16x16x32_bf16 v[132:135], a[64:67], a[4:7], v[132:135]
  v_mfma_f32_16x16x32_bf16 v[136:139], a[64:67], a[8:11], v[136:139]
  ds_read_b64_tr_b16 a[84:85], v229 offset:8192
  v_mfma_f32_16x16x32_bf16 v[136:139], a[68:71], a[24:27], v[136:139]
  v_mfma_f32_16x16x32_bf16 v[140:143], a[68:71], a[28:31], v[140:143]
  ds_read_b64_tr_b16 a[86:87], v229 offset:12288
  v_mfma_f32_16x16x32_bf16 v[140:143], a[64:67], a[12:15], v[140:143]
  s_waitcnt lgkmcnt(4)
  v_mfma_f32_16x16x32_bf16 v[156:159], a[72:75], a[12:15], v[156:159]
  ds_read_b64_tr_b16 a[88:89], v229 offset:16384
  v_mfma_f32_16x16x32_bf16 v[156:159], a[76:79], a[28:31], v[156:159]
  buffer_load_dwordx4 v234, s[16:19], s67 offen offset:2048  lds
  v_mfma_f32_16x16x32_bf16 v[152:155], a[76:79], a[24:27], v[152:155]
  ds_read_b64_tr_b16 a[90:91], v229 offset:20480
  v_mfma_f32_16x16x32_bf16 v[152:155], a[72:75], a[8:11], v[152:155]
  v_mfma_f32_16x16x32_bf16 v[148:151], a[72:75], a[4:7], v[148:151]
  ds_read_b64_tr_b16 a[92:93], v229 offset:24576
  v_mfma_f32_16x16x32_bf16 v[148:151], a[76:79], a[20:23], v[148:151]
  v_mfma_f32_16x16x32_bf16 v[144:147], a[76:79], a[16:19], v[144:147]
  ds_read_b64_tr_b16 a[94:95], v229 offset:28672
  v_mfma_f32_16x16x32_bf16 v[144:147], a[72:75], a[0:3], v[144:147]
  s_waitcnt lgkmcnt(4)
  v_mfma_f32_16x16x32_bf16 v[160:163], a[80:83], a[0:3], v[160:163]
  ds_read_b64_tr_b16 a[64:65], v230 offset:0
  buffer_load_dwordx4 v235, s[16:19], s67 offen offset:3072  lds
  v_mfma_f32_16x16x32_bf16 v[160:163], a[84:87], a[16:19], v[160:163]
  v_mfma_f32_16x16x32_bf16 v[164:167], a[84:87], a[20:23], v[164:167]
  ds_read_b64_tr_b16 a[66:67], v230 offset:4096
  v_mfma_f32_16x16x32_bf16 v[164:167], a[80:83], a[4:7], v[164:167]
  v_mfma_f32_16x16x32_bf16 v[168:171], a[80:83], a[8:11], v[168:171]
  ds_read_b64_tr_b16 a[68:69], v230 offset:8192
  v_mfma_f32_16x16x32_bf16 v[168:171], a[84:87], a[24:27], v[168:171]
  v_mfma_f32_16x16x32_bf16 v[172:175], a[84:87], a[28:31], v[172:175]
  ds_read_b64_tr_b16 a[70:71], v230 offset:12288
  s_add_u32 m0, s68, 16384
  v_mfma_f32_16x16x32_bf16 v[172:175], a[80:83], a[12:15], v[172:175]
  buffer_load_dwordx4 v232, s[20:23], s67 offen offset:0  lds
  s_waitcnt lgkmcnt(4)
  v_mfma_f32_16x16x32_bf16 v[188:191], a[88:91], a[12:15], v[188:191]
  ds_read_b64_tr_b16 a[72:73], v230 offset:16384
  v_mfma_f32_16x16x32_bf16 v[188:191], a[92:95], a[28:31], v[188:191]
  v_mfma_f32_16x16x32_bf16 v[184:187], a[92:95], a[24:27], v[184:187]
  ds_read_b64_tr_b16 a[74:75], v230 offset:20480
  v_mfma_f32_16x16x32_bf16 v[184:187], a[88:91], a[8:11], v[184:187]
  v_mfma_f32_16x16x32_bf16 v[180:183], a[88:91], a[4:7], v[180:183]
  ds_read_b64_tr_b16 a[76:77], v230 offset:24576
  v_mfma_f32_16x16x32_bf16 v[180:183], a[92:95], a[20:23], v[180:183]
  v_mfma_f32_16x16x32_bf16 v[176:179], a[92:95], a[16:19], v[176:179]
  ds_read_b64_tr_b16 a[78:79], v230 offset:28672
  buffer_load_dwordx4 v233, s[20:23], s67 offen offset:1024  lds
  v_mfma_f32_16x16x32_bf16 v[176:179], a[88:91], a[0:3], v[176:179]
  s_waitcnt lgkmcnt(4)
  v_mfma_f32_16x16x32_bf16 v[192:195], a[64:67], a[0:3], v[192:195]
  s_waitcnt vmcnt(15)
  s_barrier
  ds_read_b64_tr_b16 a[80:81], v224 offset:32768
  v_mfma_f32_16x16x32_bf16 v[192:195], a[68:71], a[16:19], v[192:195]
  v_mfma_f32_16x16x32_bf16 v[196:199], a[68:71], a[20:23], v[196:199]
  ds_read_b64_tr_b16 a[82:83], v224 offset:36864
  v_mfma_f32_16x16x32_bf16 v[196:199], a[64:67], a[4:7], v[196:199]
  v_mfma_f32_16x16x32_bf16 v[200:203], a[64:67], a[8:11], v[200:203]
  ds_read_b64_tr_b16 a[84:85], v224 offset:40960
  v_mfma_f32_16x16x32_bf16 v[200:203], a[68:71], a[24:27], v[200:203]
  buffer_load_dwordx4 v234, s[20:23], s67 offen offset:2048  lds
  v_mfma_f32_16x16x32_bf16 v[204:207], a[68:71], a[28:31], v[204:207]
  ds_read_b64_tr_b16 a[86:87], v224 offset:45056
  v_mfma_f32_16x16x32_bf16 v[204:207], a[64:67], a[12:15], v[204:207]
  s_waitcnt lgkmcnt(4)
  v_mfma_f32_16x16x32_bf16 v[220:223], a[72:75], a[12:15], v[220:223]
  ds_read_b64_tr_b16 a[88:89], v224 offset:49152
  v_mfma_f32_16x16x32_bf16 v[220:223], a[76:79], a[28:31], v[220:223]
  v_mfma_f32_16x16x32_bf16 v[216:219], a[76:79], a[24:27], v[216:219]
  ds_read_b64_tr_b16 a[90:91], v224 offset:53248
  v_mfma_f32_16x16x32_bf16 v[216:219], a[72:75], a[8:11], v[216:219]
  v_mfma_f32_16x16x32_bf16 v[212:215], a[72:75], a[4:7], v[212:215]
  ds_read_b64_tr_b16 a[92:93], v224 offset:57344
  buffer_load_dwordx4 v235, s[20:23], s67 offen offset:3072  lds
  v_mfma_f32_16x16x32_bf16 v[212:215], a[76:79], a[20:23], v[212:215]
  s_add_u32 s67, s67, 458752
  v_mfma_f32_16x16x32_bf16 v[208:211], a[76:79], a[16:19], v[208:211]
  ds_read_b64_tr_b16 a[94:95], v224 offset:61440
  v_xor_b32 v224, 0x10000, v224
  v_mfma_f32_16x16x32_bf16 v[208:211], a[72:75], a[0:3], v[208:211]
  s_waitcnt vmcnt(9) lgkmcnt(4)
  v_mfma_f32_16x16x32_bf16 v[0:3], a[80:83], a[32:35], v[0:3]
  ds_read_b64_tr_b16 a[64:65], v225 offset:32768
  v_mfma_f32_16x16x32_bf16 v[0:3], a[84:87], a[48:51], v[0:3]
  v_mfma_f32_16x16x32_bf16 v[4:7], a[84:87], a[52:55], v[4:7]
  ds_read_b64_tr_b16 a[66:67], v225 offset:36864
  v_mfma_f32_16x16x32_bf16 v[4:7], a[80:83], a[36:39], v[4:7]
  buffer_load_dwordx4 a[0:3], v231, s[4:7], s72 offen offset:0 sc1
  v_mfma_f32_16x16x32_bf16 v[8:11], a[80:83], a[40:43], v[8:11]
  ds_read_b64_tr_b16 a[68:69], v225 offset:40960
  v_mfma_f32_16x16x32_bf16 v[8:11], a[84:87], a[56:59], v[8:11]
  v_mfma_f32_16x16x32_bf16 v[12:15], a[84:87], a[60:63], v[12:15]
  ds_read_b64_tr_b16 a[70:71], v225 offset:45056
  v_mfma_f32_16x16x32_bf16 v[12:15], a[80:83], a[44:47], v[12:15]
  s_waitcnt lgkmcnt(4)
  v_mfma_f32_16x16x32_bf16 v[28:31], a[88:91], a[44:47], v[28:31]
  ds_read_b64_tr_b16 a[72:73], v225 offset:49152
  v_mfma_f32_16x16x32_bf16 v[28:31], a[92:95], a[60:63], v[28:31]
  v_mfma_f32_16x16x32_bf16 v[24:27], a[92:95], a[56:59], v[24:27]
  ds_read_b64_tr_b16 a[74:75], v225 offset:53248
  buffer_load_dwordx4 a[16:19], v231, s[4:7], s72 offen offset:1024 sc1
  v_mfma_f32_16x16x32_bf16 v[24:27], a[88:91], a[40:43], v[24:27]
  v_mfma_f32_16x16x32_bf16 v[20:23], a[88:91], a[36:39], v[20:23]
  ds_read_b64_tr_b16 a[76:77], v225 offset:57344
  v_mfma_f32_16x16x32_bf16 v[20:23], a[92:95], a[52:55], v[20:23]
  v_mfma_f32_16x16x32_bf16 v[16:19], a[92:95], a[48:51], v[16:19]
  ds_read_b64_tr_b16 a[78:79], v225 offset:61440
  v_xor_b32 v225, 0x10000, v225
  v_mfma_f32_16x16x32_bf16 v[16:19], a[88:91], a[32:35], v[16:19]
  s_waitcnt lgkmcnt(4)
  v_mfma_f32_16x16x32_bf16 v[32:35], a[64:67], a[32:35], v[32:35]
  ds_read_b64_tr_b16 a[80:81], v226 offset:32768
  v_mfma_f32_16x16x32_bf16 v[32:35], a[68:71], a[48:51], v[32:35]
  buffer_load_dwordx4 a[4:7], v231, s[4:7], s73 offen offset:0 sc1
  v_mfma_f32_16x16x32_bf16 v[36:39], a[68:71], a[52:55], v[36:39]
  ds_read_b64_tr_b16 a[82:83], v226 offset:36864
  v_mfma_f32_16x16x32_bf16 v[36:39], a[64:67], a[36:39], v[36:39]
  v_mfma_f32_16x16x32_bf16 v[40:43], a[64:67], a[40:43], v[40:43]
  ds_read_b64_tr_b16 a[84:85], v226 offset:40960
  v_mfma_f32_16x16x32_bf16 v[40:43], a[68:71], a[56:59], v[40:43]
  v_mfma_f32_16x16x32_bf16 v[44:47], a[68:71], a[60:63], v[44:47]
  ds_read_b64_tr_b16 a[86:87], v226 offset:45056
  v_mfma_f32_16x16x32_bf16 v[44:47], a[64:67], a[44:47], v[44:47]
  s_waitcnt lgkmcnt(4)
  v_mfma_f32_16x16x32_bf16 v[60:63], a[72:75], a[44:47], v[60:63]
  ds_read_b64_tr_b16 a[88:89], v226 offset:49152
  buffer_load_dwordx4 a[20:23], v231, s[4:7], s73 offen offset:1024 sc1
  v_mfma_f32_16x16x32_bf16 v[60:63], a[76:79], a[60:63], v[60:63]
  v_mfma_f32_16x16x32_bf16 v[56:59], a[76:79], a[56:59], v[56:59]
  ds_read_b64_tr_b16 a[90:91], v226 offset:53248
  v_mfma_f32_16x16x32_bf16 v[56:59], a[72:75], a[40:43], v[56:59]
  v_mfma_f32_16x16x32_bf16 v[52:55], a[72:75], a[36:39], v[52:55]
  ds_read_b64_tr_b16 a[92:93], v226 offset:57344
  v_mfma_f32_16x16x32_bf16 v[52:55], a[76:79], a[52:55], v[52:55]
  v_mfma_f32_16x16x32_bf16 v[48:51], a[76:79], a[48:51], v[48:51]
  ds_read_b64_tr_b16 a[94:95], v226 offset:61440
  v_xor_b32 v226, 0x10000, v226
  v_mfma_f32_16x16x32_bf16 v[48:51], a[72:75], a[32:35], v[48:51]
  buffer_load_dwordx4 a[8:11], v231, s[4:7], s74 offen offset:0 sc1
  s_waitcnt lgkmcnt(4)
  v_mfma_f32_16x16x32_bf16 v[64:67], a[80:83], a[32:35], v[64:67]
  ds_read_b64_tr_b16 a[64:65], v227 offset:32768
  v_mfma_f32_16x16x32_bf16 v[64:67], a[84:87], a[48:51], v[64:67]
  v_mfma_f32_16x16x32_bf16 v[68:71], a[84:87], a[52:55], v[68:71]
  ds_read_b64_tr_b16 a[66:67], v227 offset:36864
  v_mfma_f32_16x16x32_bf16 v[68:71], a[80:83], a[36:39], v[68:71]
  v_mfma_f32_16x16x32_bf16 v[72:75], a[80:83], a[40:43], v[72:75]
  ds_read_b64_tr_b16 a[68:69], v227 offset:40960
  v_mfma_f32_16x16x32_bf16 v[72:75], a[84:87], a[56:59], v[72:75]
  v_mfma_f32_16x16x32_bf16 v[76:79], a[84:87], a[60:63], v[76:79]
  ds_read_b64_tr_b16 a[70:71], v227 offset:45056
  buffer_load_dwordx4 a[24:27], v231, s[4:7], s74 offen offset:1024 sc1
  v_mfma_f32_16x16x32_bf16 v[76:79], a[80:83], a[44:47], v[76:79]
  s_waitcnt lgkmcnt(4)
  v_mfma_f32_16x16x32_bf16 v[92:95], a[88:91], a[44:47], v[92:95]
  ds_read_b64_tr_b16 a[72:73], v227 offset:49152
  v_mfma_f32_16x16x32_bf16 v[92:95], a[92:95], a[60:63], v[92:95]
  v_mfma_f32_16x16x32_bf16 v[88:91], a[92:95], a[56:59], v[88:91]
  ds_read_b64_tr_b16 a[74:75], v227 offset:53248
  v_mfma_f32_16x16x32_bf16 v[88:91], a[88:91], a[40:43], v[88:91]
  v_mfma_f32_16x16x32_bf16 v[84:87], a[88:91], a[36:39], v[84:87]
  ds_read_b64_tr_b16 a[76:77], v227 offset:57344
  v_mfma_f32_16x16x32_bf16 v[84:87], a[92:95], a[52:55], v[84:87]
  buffer_load_dwordx4 a[12:15], v231, s[4:7], s75 offen offset:0 sc1
  v_mfma_f32_16x16x32_bf16 v[80:83], a[92:95], a[48:51], v[80:83]
  ds_read_b64_tr_b16 a[78:79], v227 offset:61440
  v_xor_b32 v227, 0x10000, v227
  v_mfma_f32_16x16x32_bf16 v[80:83], a[88:91], a[32:35], v[80:83]
  s_waitcnt lgkmcnt(4)
  v_mfma_f32_16x16x32_bf16 v[96:99], a[64:67], a[32:35], v[96:99]
  ds_read_b64_tr_b16 a[80:81], v228 offset:32768
  v_mfma_f32_16x16x32_bf16 v[96:99], a[68:71], a[48:51], v[96:99]
  v_mfma_f32_16x16x32_bf16 v[100:103], a[68:71], a[52:55], v[100:103]
  ds_read_b64_tr_b16 a[82:83], v228 offset:36864
  v_mfma_f32_16x16x32_bf16 v[100:103], a[64:67], a[36:39], v[100:103]
  v_mfma_f32_16x16x32_bf16 v[104:107], a[64:67], a[40:43], v[104:107]
  ds_read_b64_tr_b16 a[84:85], v228 offset:40960
  buffer_load_dwordx4 a[28:31], v231, s[4:7], s75 offen offset:1024 sc1
  v_mfma_f32_16x16x32_bf16 v[104:107], a[68:71], a[56:59], v[104:107]
  v_mfma_f32_16x16x32_bf16 v[108:111], a[68:71], a[60:63], v[108:111]
  ds_read_b64_tr_b16 a[86:87], v228 offset:45056
  v_mfma_f32_16x16x32_bf16 v[108:111], a[64:67], a[44:47], v[108:111]
  s_waitcnt lgkmcnt(4)
  v_mfma_f32_16x16x32_bf16 v[124:127], a[72:75], a[44:47], v[124:127]
  ds_read_b64_tr_b16 a[88:89], v228 offset:49152
  v_mfma_f32_16x16x32_bf16 v[124:127], a[76:79], a[60:63], v[124:127]
  v_mfma_f32_16x16x32_bf16 v[120:123], a[76:79], a[56:59], v[120:123]
  ds_read_b64_tr_b16 a[90:91], v228 offset:53248
  s_add_u32 m0, s68, 32768
  v_mfma_f32_16x16x32_bf16 v[120:123], a[72:75], a[40:43], v[120:123]
  buffer_load_dwordx4 v232, s[16:19], s67 offen offset:0  lds
  v_mfma_f32_16x16x32_bf16 v[116:119], a[72:75], a[36:39], v[116:119]
  ds_read_b64_tr_b16 a[92:93], v228 offset:57344
  v_mfma_f32_16x16x32_bf16 v[116:119], a[76:79], a[52:55], v[116:119]
  v_mfma_f32_16x16x32_bf16 v[112:115], a[76:79], a[48:51], v[112:115]
  ds_read_b64_tr_b16 a[94:95], v228 offset:61440
  v_xor_b32 v228, 0x10000, v228
  v_mfma_f32_16x16x32_bf16 v[112:115], a[72:75], a[32:35], v[112:115]
  s_waitcnt lgkmcnt(4)
  v_mfma_f32_16x16x32_bf16 v[128:131], a[80:83], a[32:35], v[128:131]
  ds_read_b64_tr_b16 a[64:65], v229 offset:32768
  v_mfma_f32_16x16x32_bf16 v[128:131], a[84:87], a[48:51], v[128:131]
  v_mfma_f32_16x16x32_bf16 v[132:135], a[84:87], a[52:55], v[132:135]
  ds_read_b64_tr_b16 a[66:67], v229 offset:36864
  buffer_load_dwordx4 v233, s[16:19], s67 offen offset:1024  lds
  v_mfma_f32_16x16x32_bf16 v[132:135], a[80:83], a[36:39], v[132:135]
  v_mfma_f32_16x16x32_bf16 v[136:139], a[80:83], a[40:43], v[136:139]
  ds_read_b64_tr_b16 a[68:69], v229 offset:40960
  v_mfma_f32_16x16x32_bf16 v[136:139], a[84:87], a[56:59], v[136:139]
  v_mfma_f32_16x16x32_bf16 v[140:143], a[84:87], a[60:63], v[140:143]
  ds_read_b64_tr_b16 a[70:71], v229 offset:45056
  v_mfma_f32_16x16x32_bf16 v[140:143], a[80:83], a[44:47], v[140:143]
  s_waitcnt lgkmcnt(4)
  v_mfma_f32_16x16x32_bf16 v[156:159], a[88:91], a[44:47], v[156:159]
  ds_read_b64_tr_b16 a[72:73], v229 offset:49152
  v_mfma_f32_16x16x32_bf16 v[156:159], a[92:95], a[60:63], v[156:159]
  buffer_load_dwordx4 v234, s[16:19], s67 offen offset:2048  lds
  v_mfma_f32_16x16x32_bf16 v[152:155], a[92:95], a[56:59], v[152:155]
  ds_read_b64_tr_b16 a[74:75], v229 offset:53248
  v_mfma_f32_16x16x32_bf16 v[152:155], a[88:91], a[40:43], v[152:155]
  v_mfma_f32_16x16x32_bf16 v[148:151], a[88:91], a[36:39], v[148:151]
  ds_read_b64_tr_b16 a[76:77], v229 offset:57344
  v_mfma_f32_16x16x32_bf16 v[148:151], a[92:95], a[52:55], v[148:151]
  v_mfma_f32_16x16x32_bf16 v[144:147], a[92:95], a[48:51], v[144:147]
  ds_read_b64_tr_b16 a[78:79], v229 offset:61440
  v_xor_b32 v229, 0x10000, v229
  v_mfma_f32_16x16x32_bf16 v[144:147], a[88:91], a[32:35], v[144:147]
  s_waitcnt lgkmcnt(4)
  v_mfma_f32_16x16x32_bf16 v[160:163], a[64:67], a[32:35], v[160:163]
  ds_read_b64_tr_b16 a[80:81], v230 offset:32768
  buffer_load_dwordx4 v235, s[16:19], s67 offen offset:3072  lds
  v_mfma_f32_16x16x32_bf16 v[160:163], a[68:71], a[48:51], v[160:163]
  v_mfma_f32_16x16x32_bf16 v[164:167], a[68:71], a[52:55], v[164:167]
  ds_read_b64_tr_b16 a[82:83], v230 offset:36864
  v_mfma_f32_16x16x32_bf16 v[164:167], a[64:67], a[36:39], v[164:167]
  v_mfma_f32_16x16x32_bf16 v[168:171], a[64:67], a[40:43], v[168:171]
  ds_read_b64_tr_b16 a[84:85], v230 offset:40960
  v_mfma_f32_16x16x32_bf16 v[168:171], a[68:71], a[56:59], v[168:171]
  v_mfma_f32_16x16x32_bf16 v[172:175], a[68:71], a[60:63], v[172:175]
  ds_read_b64_tr_b16 a[86:87], v230 offset:45056
  s_add_u32 m0, s68, 49152
  v_mfma_f32_16x16x32_bf16 v[172:175], a[64:67], a[44:47], v[172:175]
  buffer_load_dwordx4 v232, s[20:23], s67 offen offset:0  lds
  s_waitcnt lgkmcnt(4)
  v_mfma_f32_16x16x32_bf16 v[188:191], a[72:75], a[44:47], v[188:191]
  ds_read_b64_tr_b16 a[88:89], v230 offset:49152
  v_mfma_f32_16x16x32_bf16 v[188:191], a[76:79], a[60:63], v[188:191]
  v_mfma_f32_16x16x32_bf16 v[184:187], a[76:79], a[56:59], v[184:187]
  ds_read_b64_tr_b16 a[90:91], v230 offset:53248
  v_mfma_f32_16x16x32_bf16 v[184:187], a[72:75], a[40:43], v[184:187]
  v_mfma_f32_16x16x32_bf16 v[180:183], a[72:75], a[36:39], v[180:183]
  ds_read_b64_tr_b16 a[92:93], v230 offset:57344
  v_mfma_f32_16x16x32_bf16 v[180:183], a[76:79], a[52:55], v[180:183]
  v_mfma_f32_16x16x32_bf16 v[176:179], a[76:79], a[48:51], v[176:179]
  ds_read_b64_tr_b16 a[94:95], v230 offset:61440
  buffer_load_dwordx4 v233, s[20:23], s67 offen offset:1024  lds
  v_xor_b32 v230, 0x10000, v230
  v_mfma_f32_16x16x32_bf16 v[176:179], a[72:75], a[32:35], v[176:179]
  s_waitcnt lgkmcnt(4)
  v_mfma_f32_16x16x32_bf16 v[192:195], a[80:83], a[32:35], v[192:195]
  s_waitcnt vmcnt(14)
  s_barrier
  ds_read_b64_tr_b16 a[64:65], v224 offset:0
  v_mfma_f32_16x16x32_bf16 v[192:195], a[84:87], a[48:51], v[192:195]
  v_mfma_f32_16x16x32_bf16 v[196:199], a[84:87], a[52:55], v[196:199]
  ds_read_b64_tr_b16 a[66:67], v224 offset:4096
  v_mfma_f32_16x16x32_bf16 v[196:199], a[80:83], a[36:39], v[196:199]
  v_mfma_f32_16x16x32_bf16 v[200:203], a[80:83], a[40:43], v[200:203]
  ds_read_b64_tr_b16 a[68:69], v224 offset:8192
  v_mfma_f32_16x16x32_bf16 v[200:203], a[84:87], a[56:59], v[200:203]
  buffer_load_dwordx4 v234, s[20:23], s67 offen offset:2048  lds
  v_mfma_f32_16x16x32_bf16 v[204:207], a[84:87], a[60:63], v[204:207]
  ds_read_b64_tr_b16 a[70:71], v224 offset:12288
  v_mfma_f32_16x16x32_bf16 v[204:207], a[80:83], a[44:47], v[204:207]
  s_waitcnt lgkmcnt(4)
  v_mfma_f32_16x16x32_bf16 v[220:223], a[88:91], a[44:47], v[220:223]
  ds_read_b64_tr_b16 a[72:73], v224 offset:16384
  v_mfma_f32_16x16x32_bf16 v[220:223], a[92:95], a[60:63], v[220:223]
  v_mfma_f32_16x16x32_bf16 v[216:219], a[92:95], a[56:59], v[216:219]
  ds_read_b64_tr_b16 a[74:75], v224 offset:20480
  v_mfma_f32_16x16x32_bf16 v[216:219], a[88:91], a[40:43], v[216:219]
  v_mfma_f32_16x16x32_bf16 v[212:215], a[88:91], a[36:39], v[212:215]
  ds_read_b64_tr_b16 a[76:77], v224 offset:24576
  buffer_load_dwordx4 v235, s[20:23], s67 offen offset:3072  lds
  v_mfma_f32_16x16x32_bf16 v[212:215], a[92:95], a[52:55], v[212:215]
  s_add_u32 s67, s67, 458752
  s_xor_b32 s68, s68, 0x10000
  v_mfma_f32_16x16x32_bf16 v[208:211], a[92:95], a[48:51], v[208:211]
  ds_read_b64_tr_b16 a[78:79], v224 offset:28672
  v_mfma_f32_16x16x32_bf16 v[208:211], a[88:91], a[32:35], v[208:211]
  s_sub_u32 s56, s56, 1
  s_cmp_lg_u32 s56, 0
  s_cbranch_scc1 Lp3_loop
Lmk_Lp3_loop_tail:
  s_waitcnt vmcnt(8) lgkmcnt(4)
  v_mfma_f32_16x16x32_bf16 v[0:3], a[64:67], a[0:3], v[0:3]
  ds_read_b64_tr_b16 a[80:81], v225 offset:0
  v_add_f32 v242, v242, v246
  v_mfma_f32_16x16x32_bf16 v[0:3], a[68:71], a[16:19], v[0:3]
  v_add_f32 v243, v243, v247
  v_add_f32 v244, v244, v248
  v_mfma_f32_16x16x32_bf16 v[4:7], a[68:71], a[20:23], v[4:7]
  ds_read_b64_tr_b16 a[82:83], v225 offset:4096
  v_add_f32 v245, v245, v249
  v_mfma_f32_16x16x32_bf16 v[4:7], a[64:67], a[4:7], v[4:7]
  buffer_load_dwordx4 a[32:35], v231, s[4:7], s72 offen offset:2048 sc1
  ds_write_b128 v250, v[242:245]
  v_mfma_f32_16x16x32_bf16 v[8:11], a[64:67], a[8:11], v[8:11]
  ds_read_b64_tr_b16 a[84:85], v225 offset:8192
  v_mfma_f32_16x16x32_bf16 v[8:11], a[68:71], a[24:27], v[8:11]
  v_mfma_f32_16x16x32_bf16 v[12:15], a[68:71], a[28:31], v[12:15]
  ds_read_b64_tr_b16 a[86:87], v225 offset:12288
  v_mfma_f32_16x16x32_bf16 v[12:15], a[64:67], a[12:15], v[12:15]
  buffer_load_dwordx4 a[48:51], v231, s[4:7], s72 offen offset:3072 sc1
  s_waitcnt lgkmcnt(5)
  v_mfma_f32_16x16x32_bf16 v[28:31], a[72:75], a[12:15], v[28:31]
  s_add_u32 s72, s72, 4096
  ds_read_b64_tr_b16 a[88:89], v225 offset:16384
  v_mfma_f32_16x16x32_bf16 v[28:31], a[76:79], a[28:31], v[28:31]
  ds_read_b128 v[246:249], v237 offset:384
  v_mfma_f32_16x16x32_bf16 v[24:27], a[76:79], a[24:27], v[24:27]
  ds_read_b64_tr_b16 a[90:91], v225 offset:20480
  v_mfma_f32_16x16x32_bf16 v[24:27], a[72:75], a[8:11], v[24:27]
  v_mfma_f32_16x16x32_bf16 v[20:23], a[72:75], a[4:7], v[20:23]
  ds_read_b64_tr_b16 a[92:93], v225 offset:24576
  v_mfma_f32_16x16x32_bf16 v[20:23], a[76:79], a[20:23], v[20:23]
  buffer_load_dwordx4 a[36:39], v231, s[4:7], s73 offen offset:2048 sc1
  v_mfma_f32_16x16x32_bf16 v[16:19], a[76:79], a[16:19], v[16:19]
  ds_read_b64_tr_b16 a[94:95], v225 offset:28672
  v_mfma_f32_16x16x32_bf16 v[16:19], a[72:75], a[0:3], v[16:19]
  s_waitcnt lgkmcnt(5)
  v_mfma_f32_16x16x32_bf16 v[32:35], a[80:83], a[0:3], v[32:35]
  s_waitcnt lgkmcnt(3)
  ds_read_b64_tr_b16 a[64:65], v226 offset:0
  v_fmac_f32 v96, v246, v238
  v_mfma_f32_16x16x32_bf16 v[32:35], a[84:87], a[16:19], v[32:35]
  buffer_load_dwordx4 a[52:55], v231, s[4:7], s73 offen offset:3072 sc1
  ds_read_b128 v[242:245], v237 offset:0
  v_mfma_f32_16x16x32_bf16 v[36:39], a[84:87], a[20:23], v[36:39]
  s_add_u32 s73, s73, 4096
  ds_read_b64_tr_b16 a[66:67], v226 offset:4096
  v_fmac_f32 v97, v247, v238
  v_mfma_f32_16x16x32_bf16 v[36:39], a[80:83], a[4:7], v[36:39]
  v_fmac_f32 v98, v248, v238
  v_fmac_f32 v99, v249, v238
  v_mfma_f32_16x16x32_bf16 v[40:43], a[80:83], a[8:11], v[40:43]
  s_xor_b32 s93, s53, 1
  ds_read_b64_tr_b16 a[68:69], v226 offset:8192
  v_fmac_f32 v100, v246, v239
  v_mfma_f32_16x16x32_bf16 v[40:43], a[84:87], a[24:27], v[40:43]
  s_lshl_b32 s93, s93, 7
  v_fmac_f32 v101, v247, v239
  v_fmac_f32 v102, v248, v239
  v_mfma_f32_16x16x32_bf16 v[44:47], a[84:87], a[28:31], v[44:47]
  s_add_u32 s80, s24, s93
  s_addc_u32 s81, s25, 0
  ds_read_b64_tr_b16 a[70:71], v226 offset:12288
  v_fmac_f32 v103, v249, v239
  v_mfma_f32_16x16x32_bf16 v[44:47], a[80:83], a[12:15], v[44:47]
  s_sub_u32 s82, 7340032, s93
  buffer_load_dwordx4 a[40:43], v231, s[4:7], s74 offen offset:2048 sc1
  v_fmac_f32 v104, v246, v240
  s_waitcnt lgkmcnt(5)
  v_mfma_f32_16x16x32_bf16 v[60:63], a[88:91], a[12:15], v[60:63]
  s_mov_b32 s83, 0x20000
  ds_read_b64_tr_b16 a[72:73], v226 offset:16384
  v_fmac_f32 v105, v247, v240
  v_mfma_f32_16x16x32_bf16 v[60:63], a[92:95], a[28:31], v[60:63]
  s_lshl_b32 s93, s53, 7
  v_fmac_f32 v106, v248, v240
  v_fmac_f32 v107, v249, v240
  v_mfma_f32_16x16x32_bf16 v[56:59], a[92:95], a[24:27], v[56:59]
  s_add_u32 s84, s24, s93
  s_addc_u32 s85, s25, 0
  ds_read_b64_tr_b16 a[74:75], v226 offset:20480
  v_fmac_f32 v108, v246, v241
  v_mfma_f32_16x16x32_bf16 v[56:59], a[88:91], a[8:11], v[56:59]
  s_sub_u32 s84, s84, 1024
  s_subb_u32 s85, s85, 0
  buffer_load_dwordx4 a[56:59], v231, s[4:7], s74 offen offset:3072 sc1
  v_fmac_f32 v109, v247, v241
  v_mfma_f32_16x16x32_bf16 v[52:55], a[88:91], a[4:7], v[52:55]
  s_add_u32 s74, s74, 4096
  ds_read_b64_tr_b16 a[76:77], v226 offset:24576
  v_fmac_f32 v110, v248, v241
  v_mfma_f32_16x16x32_bf16 v[52:55], a[92:95], a[20:23], v[52:55]
  s_sub_u32 s86, 7341056, s93
  v_fmac_f32 v111, v249, v241
  v_mfma_f32_16x16x32_bf16 v[48:51], a[92:95], a[16:19], v[48:51]
  s_mov_b32 s87, 0x20000
  ds_read_b64_tr_b16 a[78:79], v226 offset:28672
  v_mfma_f32_16x16x32_bf16 v[48:51], a[88:91], a[0:3], v[48:51]
  s_and_b32 s93, s53, 1
  s_waitcnt lgkmcnt(4)
  v_mfma_f32_16x16x32_bf16 v[64:67], a[64:67], a[0:3], v[64:67]
  ds_read_b64_tr_b16 a[80:81], v227 offset:0
  v_fmac_f32 v0, v242, v238
  v_mfma_f32_16x16x32_bf16 v[64:67], a[68:71], a[16:19], v[64:67]
  s_mul_i32 s92, s93, 3670016
  buffer_load_dwordx4 a[44:47], v231, s[4:7], s75 offen offset:2048 sc1
  ds_read_b128 v[246:249], v237 offset:64
  v_mfma_f32_16x16x32_bf16 v[68:71], a[68:71], a[20:23], v[68:71]
  s_lshl_b32 s93, s40, 14
  ds_read_b64_tr_b16 a[82:83], v227 offset:4096
  v_fmac_f32 v1, v243, v238
  v_mfma_f32_16x16x32_bf16 v[68:71], a[64:67], a[4:7], v[68:71]
  s_add_u32 s92, s92, s93
  v_fmac_f32 v2, v244, v238
  v_fmac_f32 v3, v245, v238
  v_mfma_f32_16x16x32_bf16 v[72:75], a[64:67], a[8:11], v[72:75]
  s_lshl_b32 s79, s40, 11
  ds_read_b64_tr_b16 a[84:85], v227 offset:8192
  v_fmac_f32 v4, v242, v239
  v_mfma_f32_16x16x32_bf16 v[72:75], a[68:71], a[24:27], v[72:75]
  s_lshr_b32 s93, s53, 1
  buffer_load_dwordx4 a[60:63], v231, s[4:7], s75 offen offset:3072 sc1
  v_fmac_f32 v5, v243, v239
  v_mfma_f32_16x16x32_bf16 v[76:79], a[68:71], a[28:31], v[76:79]
  s_add_u32 s75, s75, 4096
  ds_read_b64_tr_b16 a[86:87], v227 offset:12288
  v_fmac_f32 v6, v244, v239
  v_mfma_f32_16x16x32_bf16 v[76:79], a[64:67], a[12:15], v[76:79]
  s_add_u32 s93, s93, s52
  v_fmac_f32 v7, v245, v239
  v_fmac_f32 v8, v242, v240
  s_waitcnt lgkmcnt(5)
  v_mfma_f32_16x16x32_bf16 v[92:95], a[72:75], a[12:15], v[92:95]
  s_and_b32 s93, s93, 3
  ds_read_b64_tr_b16 a[88:89], v227 offset:16384
  v_fmac_f32 v9, v243, v240
  v_mfma_f32_16x16x32_bf16 v[92:95], a[76:79], a[28:31], v[92:95]
  s_cmp_eq_u32 s93, 0
  s_cselect_b32 s88, 917504, 0
  v_fmac_f32 v10, v244, v240
  v_fmac_f32 v11, v245, v240
  v_mfma_f32_16x16x32_bf16 v[88:91], a[76:79], a[24:27], v[88:91]
  s_add_u32 m0, s68, 0
  ds_read_b64_tr_b16 a[90:91], v227 offset:20480
  v_fmac_f32 v12, v242, v241
  v_mfma_f32_16x16x32_bf16 v[88:91], a[72:75], a[8:11], v[88:91]
  s_cmp_eq_u32 s93, 1
  s_cselect_b32 s89, 917504, 0
  buffer_load_dwordx4 v232, s[16:19], s67 offen offset:0  lds
  v_fmac_f32 v13, v243, v241
  v_mfma_f32_16x16x32_bf16 v[84:87], a[72:75], a[4:7], v[84:87]
  s_cmp_eq_u32 s93, 2
  s_cselect_b32 s90, 917504, 0
  ds_read_b64_tr_b16 a[92:93], v227 offset:24576
  v_fmac_f32 v14, v244, v241
  v_mfma_f32_16x16x32_bf16 v[84:87], a[76:79], a[20:23], v[84:87]
  s_cmp_eq_u32 s93, 3
  s_cselect_b32 s91, 917504, 0
  v_fmac_f32 v15, v245, v241
  v_mfma_f32_16x16x32_bf16 v[80:83], a[76:79], a[16:19], v[80:83]
  s_cmp_eq_u32 s40, 1
  s_cselect_b32 s78, 16384, 0
  ds_read_b64_tr_b16 a[94:95], v227 offset:28672
  v_mfma_f32_16x16x32_bf16 v[80:83], a[72:75], a[0:3], v[80:83]
  s_cmp_eq_u32 s40, 2
  s_cselect_b32 s78, -16384, s78
  buffer_load_dwordx4 v233, s[16:19], s67 offen offset:1024  lds
  s_waitcnt lgkmcnt(4)
  v_mfma_f32_16x16x32_bf16 v[96:99], a[80:83], a[0:3], v[96:99]
  ds_read_b64_tr_b16 a[64:65], v228 offset:0
  v_fmac_f32 v16, v246, v238
  v_mfma_f32_16x16x32_bf16 v[96:99], a[84:87], a[16:19], v[96:99]
  s_mul_i32 s43, s69, 458752
  ds_read_b128 v[242:245], v237 offset:128
  v_fmac_f32 v17, v247, v238
  v_mfma_f32_16x16x32_bf16 v[100:103], a[84:87], a[20:23], v[100:103]
  s_lshr_b32 s45, s55, 4
  ds_read_b64_tr_b16 a[66:67], v228 offset:4096
  v_fmac_f32 v18, v248, v238
  v_mfma_f32_16x16x32_bf16 v[100:103], a[80:83], a[4:7], v[100:103]
  s_mul_i32 s45, s45, 57344
  v_fmac_f32 v19, v249, v238
  v_fmac_f32 v20, v246, v239
  v_mfma_f32_16x16x32_bf16 v[104:107], a[80:83], a[8:11], v[104:107]
  s_add_u32 s43, s43, s45
  ds_read_b64_tr_b16 a[68:69], v228 offset:8192
  v_fmac_f32 v21, v247, v239
  v_mfma_f32_16x16x32_bf16 v[104:107], a[84:87], a[24:27], v[104:107]
  s_add_u32 s43, s43, s42
  buffer_load_dwordx4 v234, s[16:19], s67 offen offset:2048  lds
  v_fmac_f32 v22, v248, v239
  v_mfma_f32_16x16x32_bf16 v[108:111], a[84:87], a[28:31], v[108:111]
  s_add_u32 s43, s43, 12582912
  ds_read_b64_tr_b16 a[70:71], v228 offset:12288
  v_fmac_f32 v23, v249, v239
  v_mfma_f32_16x16x32_bf16 v[108:111], a[80:83], a[12:15], v[108:111]
  s_and_b32 s44, s55, 15
  v_fmac_f32 v24, v246, v240
  v_fmac_f32 v25, v247, v240
  s_waitcnt lgkmcnt(5)
  v_mfma_f32_16x16x32_bf16 v[124:127], a[88:91], a[12:15], v[124:127]
  s_lshl_b32 s45, s44, 10
  ds_read_b64_tr_b16 a[72:73], v228 offset:16384
  v_fmac_f32 v26, v248, v240
  v_mfma_f32_16x16x32_bf16 v[124:127], a[92:95], a[28:31], v[124:127]
  s_add_u32 s57, s43, s45
  buffer_load_dwordx4 v235, s[16:19], s67 offen offset:3072  lds
  v_fmac_f32 v27, v249, v240
  v_mfma_f32_16x16x32_bf16 v[120:123], a[92:95], a[24:27], v[120:123]
  s_lshl_b32 s45, s44, 9
  ds_read_b64_tr_b16 a[74:75], v228 offset:20480
  v_fmac_f32 v28, v246, v241
  v_mfma_f32_16x16x32_bf16 v[120:123], a[88:91], a[8:11], v[120:123]
  s_add_u32 s61, s43, s45
  v_fmac_f32 v29, v247, v241
  v_fmac_f32 v30, v248, v241
  v_mfma_f32_16x16x32_bf16 v[116:119], a[88:91], a[4:7], v[116:119]
  s_add_u32 s61, s61, 49152
  ds_read_b64_tr_b16 a[76:77], v228 offset:24576
  v_fmac_f32 v31, v249, v241
  v_mfma_f32_16x16x32_bf16 v[116:119], a[92:95], a[20:23], v[116:119]
  s_add_u32 s62, s61, 229376
  v_mfma_f32_16x16x32_bf16 v[112:115], a[92:95], a[16:19], v[112:115]
  s_add_u32 m0, s68, 16384
  ds_read_b64_tr_b16 a[78:79], v228 offset:28672
  v_mfma_f32_16x16x32_bf16 v[112:115], a[88:91], a[0:3], v[112:115]
  s_add_u32 s58, s57, 114688
  buffer_load_dwordx4 v232, s[20:23], s67 offen offset:0  lds
  s_waitcnt lgkmcnt(4)
  v_mfma_f32_16x16x32_bf16 v[128:131], a[64:67], a[0:3], v[128:131]
  ds_read_b64_tr_b16 a[80:81], v229 offset:0
  v_fmac_f32 v32, v242, v238
  v_mfma_f32_16x16x32_bf16 v[128:131], a[68:71], a[16:19], v[128:131]
  s_add_u32 s59, s58, 114688
  ds_read_b128 v[246:249], v237 offset:192
  v_fmac_f32 v33, v243, v238
  v_mfma_f32_16x16x32_bf16 v[132:135], a[68:71], a[20:23], v[132:135]
  s_add_u32 s60, s59, 114688
  ds_read_b64_tr_b16 a[82:83], v229 offset:4096
  v_fmac_f32 v34, v244, v238
  v_mfma_f32_16x16x32_bf16 v[132:135], a[64:67], a[4:7], v[132:135]
  s_lshl_b32 s77, s54, 1
  buffer_load_dwordx4 v233, s[20:23], s67 offen offset:1024  lds
  v_fmac_f32 v35, v245, v238
  v_mfma_f32_16x16x32_bf16 v[136:139], a[64:67], a[8:11], v[136:139]
  s_lshr_b32 s43, s55, 4
  ds_read_b64_tr_b16 a[84:85], v229 offset:8192
  v_fmac_f32 v36, v242, v239
  v_mfma_f32_16x16x32_bf16 v[136:139], a[68:71], a[24:27], v[136:139]
  s_add_u32 s77, s77, s43
  v_fmac_f32 v37, v243, v239
  v_fmac_f32 v38, v244, v239
  v_mfma_f32_16x16x32_bf16 v[140:143], a[68:71], a[28:31], v[140:143]
  s_lshl_b32 s77, s77, 7
  ds_read_b64_tr_b16 a[86:87], v229 offset:12288
  v_fmac_f32 v39, v245, v239
  v_mfma_f32_16x16x32_bf16 v[140:143], a[64:67], a[12:15], v[140:143]
  s_add_u32 s77, s77, s42
  v_fmac_f32 v40, v242, v240
  v_fmac_f32 v41, v243, v240
  s_waitcnt lgkmcnt(5)
  v_mfma_f32_16x16x32_bf16 v[156:159], a[72:75], a[12:15], v[156:159]
  s_add_u32 s77, s77, 27795456
  ds_read_b64_tr_b16 a[88:89], v229 offset:16384
  v_fmac_f32 v42, v244, v240
  v_mfma_f32_16x16x32_bf16 v[156:159], a[76:79], a[28:31], v[156:159]
  s_and_b32 s43, s53, 1
  buffer_load_dwordx4 v234, s[20:23], s67 offen offset:2048  lds
  v_fmac_f32 v43, v245, v240
  v_mfma_f32_16x16x32_bf16 v[152:155], a[76:79], a[24:27], v[152:155]
  s_and_b32 s64, s52, 14
  ds_read_b64_tr_b16 a[90:91], v229 offset:20480
  v_fmac_f32 v44, v242, v241
  v_mfma_f32_16x16x32_bf16 v[152:155], a[72:75], a[8:11], v[152:155]
  s_add_u32 s64, s64, s43
  v_fmac_f32 v45, v243, v241
  v_fmac_f32 v46, v244, v241
  v_mfma_f32_16x16x32_bf16 v[148:151], a[72:75], a[4:7], v[148:151]
  s_lshl_b32 s64, s64, 7
  ds_read_b64_tr_b16 a[92:93], v229 offset:24576
  v_fmac_f32 v47, v245, v241
  v_mfma_f32_16x16x32_bf16 v[148:151], a[76:79], a[20:23], v[148:151]
  s_add_u32 s64, s64, s42
  buffer_load_dwordx4 v235, s[20:23], s67 offen offset:3072  lds
  v_mfma_f32_16x16x32_bf16 v[144:147], a[76:79], a[16:19], v[144:147]
  s_add_u32 s67, s67, 458752
  ds_read_b64_tr_b16 a[94:95], v229 offset:28672
  v_mfma_f32_16x16x32_bf16 v[144:147], a[72:75], a[0:3], v[144:147]
  s_add_u32 s64, s64, 27795456
  s_waitcnt lgkmcnt(4)
  v_mfma_f32_16x16x32_bf16 v[160:163], a[80:83], a[0:3], v[160:163]
  ds_read_b64_tr_b16 a[64:65], v230 offset:0
  v_fmac_f32 v48, v246, v238
  v_mfma_f32_16x16x32_bf16 v[160:163], a[84:87], a[16:19], v[160:163]
  s_lshl_b32 s49, s52, 3
  ds_read_b128 v[242:245], v237 offset:256
  v_fmac_f32 v49, v247, v238
  v_mfma_f32_16x16x32_bf16 v[164:167], a[84:87], a[20:23], v[164:167]
  s_lshl_b32 s43, s40, 1
  ds_read_b64_tr_b16 a[66:67], v230 offset:4096
  v_fmac_f32 v50, v248, v238
  v_mfma_f32_16x16x32_bf16 v[164:167], a[80:83], a[4:7], v[164:167]
  s_add_u32 s49, s49, s43
  buffer_load_dwordx4 a[192:195], v231, s[4:7], s72 offen offset:0 sc1
  v_fmac_f32 v51, v249, v238
  v_mfma_f32_16x16x32_bf16 v[168:171], a[80:83], a[8:11], v[168:171]
  s_lshl_b32 s76, s49, 15
  ds_read_b64_tr_b16 a[68:69], v230 offset:8192
  v_fmac_f32 v52, v246, v239
  v_mfma_f32_16x16x32_bf16 v[168:171], a[84:87], a[24:27], v[168:171]
  s_lshl_b32 s43, s53, 11
  v_fmac_f32 v53, v247, v239
  v_fmac_f32 v54, v248, v239
  v_mfma_f32_16x16x32_bf16 v[172:175], a[84:87], a[28:31], v[172:175]
  s_add_u32 s76, s76, s43
  ds_read_b64_tr_b16 a[70:71], v230 offset:12288
  v_fmac_f32 v55, v249, v239
  v_mfma_f32_16x16x32_bf16 v[172:175], a[80:83], a[12:15], v[172:175]
  s_add_u32 s76, s76, s42
  buffer_load_dwordx4 a[208:211], v231, s[4:7], s72 offen offset:1024 sc1
  v_fmac_f32 v56, v246, v240
  s_waitcnt lgkmcnt(5)
  v_mfma_f32_16x16x32_bf16 v[188:191], a[88:91], a[12:15], v[188:191]
  s_add_u32 s46, s76, 4194304
  ds_read_b64_tr_b16 a[72:73], v230 offset:16384
  v_fmac_f32 v57, v247, v240
  v_mfma_f32_16x16x32_bf16 v[188:191], a[92:95], a[28:31], v[188:191]
  s_add_u32 s47, s46, 32768
  v_fmac_f32 v58, v248, v240
  v_fmac_f32 v59, v249, v240
  v_mfma_f32_16x16x32_bf16 v[184:187], a[92:95], a[24:27], v[184:187]
  s_mul_i32 s48, s49, 114688
  ds_read_b64_tr_b16 a[74:75], v230 offset:20480
  v_fmac_f32 v60, v246, v241
  v_mfma_f32_16x16x32_bf16 v[184:187], a[88:91], a[8:11], v[184:187]
  s_and_b32 s43, s53, 1
  v_fmac_f32 v61, v247, v241
  v_fmac_f32 v62, v248, v241
  v_mfma_f32_16x16x32_bf16 v[180:183], a[88:91], a[4:7], v[180:183]
  s_mul_i32 s44, s43, 57344
  ds_read_b64_tr_b16 a[76:77], v230 offset:24576
  v_fmac_f32 v63, v249, v241
  v_mfma_f32_16x16x32_bf16 v[180:183], a[92:95], a[20:23], v[180:183]
  s_add_u32 s48, s48, s44
  buffer_load_dwordx4 a[196:199], v231, s[4:7], s73 offen offset:0 sc1
  v_mfma_f32_16x16x32_bf16 v[176:179], a[92:95], a[16:19], v[176:179]
  s_add_u32 s48, s48, s42
  ds_read_b64_tr_b16 a[78:79], v230 offset:28672
  v_mfma_f32_16x16x32_bf16 v[176:179], a[88:91], a[0:3], v[176:179]
  s_add_u32 s48, s48, 12582912
  s_waitcnt lgkmcnt(4)
  v_mfma_f32_16x16x32_bf16 v[192:195], a[64:67], a[0:3], v[192:195]
  s_waitcnt vmcnt(19)
  s_barrier
  ds_read_b64_tr_b16 a[80:81], v224 offset:32768
  v_mfma_f32_16x16x32_bf16 v[192:195], a[68:71], a[16:19], v[192:195]
  buffer_load_dwordx4 a[212:215], v231, s[4:7], s73 offen offset:1024 sc1
  ds_read_b128 v[246:249], v237 offset:320
  v_mfma_f32_16x16x32_bf16 v[196:199], a[68:71], a[20:23], v[196:199]
  ds_read_b64_tr_b16 a[82:83], v224 offset:36864
  v_fmac_f32 v64, v242, v238
  v_mfma_f32_16x16x32_bf16 v[196:199], a[64:67], a[4:7], v[196:199]
  v_fmac_f32 v65, v243, v238
  v_fmac_f32 v66, v244, v238
  v_mfma_f32_16x16x32_bf16 v[200:203], a[64:67], a[8:11], v[200:203]
  ds_read_b64_tr_b16 a[84:85], v224 offset:40960
  v_fmac_f32 v67, v245, v238
  v_mfma_f32_16x16x32_bf16 v[200:203], a[68:71], a[24:27], v[200:203]
  v_fmac_f32 v68, v242, v239
  v_fmac_f32 v69, v243, v239
  v_mfma_f32_16x16x32_bf16 v[204:207], a[68:71], a[28:31], v[204:207]
  ds_read_b64_tr_b16 a[86:87], v224 offset:45056
  v_fmac_f32 v70, v244, v239
  v_mfma_f32_16x16x32_bf16 v[204:207], a[64:67], a[12:15], v[204:207]
  s_waitcnt lgkmcnt(5)
  buffer_load_dwordx4 a[200:203], v231, s[4:7], s74 offen offset:0 sc1
  v_fmac_f32 v71, v245, v239
  v_mfma_f32_16x16x32_bf16 v[220:223], a[72:75], a[12:15], v[220:223]
  ds_read_b64_tr_b16 a[88:89], v224 offset:49152
  v_fmac_f32 v72, v242, v240
  v_mfma_f32_16x16x32_bf16 v[220:223], a[76:79], a[28:31], v[220:223]
  v_fmac_f32 v73, v243, v240
  v_fmac_f32 v74, v244, v240
  v_mfma_f32_16x16x32_bf16 v[216:219], a[76:79], a[24:27], v[216:219]
  ds_read_b64_tr_b16 a[90:91], v224 offset:53248
  v_fmac_f32 v75, v245, v240
  v_mfma_f32_16x16x32_bf16 v[216:219], a[72:75], a[8:11], v[216:219]
  buffer_load_dwordx4 a[216:219], v231, s[4:7], s74 offen offset:1024 sc1
  v_fmac_f32 v76, v242, v241
  v_mfma_f32_16x16x32_bf16 v[212:215], a[72:75], a[4:7], v[212:215]
  ds_read_b64_tr_b16 a[92:93], v224 offset:57344
  v_fmac_f32 v77, v243, v241
  v_mfma_f32_16x16x32_bf16 v[212:215], a[76:79], a[20:23], v[212:215]
  v_fmac_f32 v78, v244, v241
  v_fmac_f32 v79, v245, v241
  v_mfma_f32_16x16x32_bf16 v[208:211], a[76:79], a[16:19], v[208:211]
  ds_read_b64_tr_b16 a[94:95], v224 offset:61440
  v_xor_b32 v224, 0x10000, v224
  v_mfma_f32_16x16x32_bf16 v[208:211], a[72:75], a[0:3], v[208:211]
  s_waitcnt vmcnt(20) lgkmcnt(4)
  v_mfma_f32_16x16x32_bf16 v[0:3], a[80:83], a[32:35], v[0:3]
  ds_read_b64_tr_b16 a[64:65], v225 offset:32768
  v_fmac_f32 v80, v246, v238
  v_mfma_f32_16x16x32_bf16 v[0:3], a[84:87], a[48:51], v[0:3]
  s_waitcnt vmcnt(18)
  buffer_load_dwordx4 a[204:207], v231, s[4:7], s75 offen offset:0 sc1
  ds_read_b128 v[242:245], v237 offset:448
  v_mfma_f32_16x16x32_bf16 v[4:7], a[84:87], a[52:55], v[4:7]
  ds_read_b64_tr_b16 a[66:67], v225 offset:36864
  v_fmac_f32 v81, v247, v238
  v_mfma_f32_16x16x32_bf16 v[4:7], a[80:83], a[36:39], v[4:7]
  s_waitcnt vmcnt(17)
  v_fmac_f32 v82, v248, v238
  v_fmac_f32 v83, v249, v238
  v_mfma_f32_16x16x32_bf16 v[8:11], a[80:83], a[40:43], v[8:11]
  ds_read_b64_tr_b16 a[68:69], v225 offset:40960
  v_fmac_f32 v84, v246, v239
  v_mfma_f32_16x16x32_bf16 v[8:11], a[84:87], a[56:59], v[8:11]
  s_waitcnt vmcnt(15)
  buffer_load_dwordx4 a[220:223], v231, s[4:7], s75 offen offset:1024 sc1
  v_fmac_f32 v85, v247, v239
  v_mfma_f32_16x16x32_bf16 v[12:15], a[84:87], a[60:63], v[12:15]
  ds_read_b64_tr_b16 a[70:71], v225 offset:45056
  v_fmac_f32 v86, v248, v239
  v_mfma_f32_16x16x32_bf16 v[12:15], a[80:83], a[44:47], v[12:15]
  s_waitcnt lgkmcnt(5)
  v_fmac_f32 v87, v249, v239
  v_fmac_f32 v88, v246, v240
  v_mfma_f32_16x16x32_bf16 v[28:31], a[88:91], a[44:47], v[28:31]
  ds_read_b64_tr_b16 a[72:73], v225 offset:49152
  v_fmac_f32 v89, v247, v240
  v_mfma_f32_16x16x32_bf16 v[28:31], a[92:95], a[60:63], v[28:31]
  v_fmac_f32 v90, v248, v240
  v_fmac_f32 v91, v249, v240
  v_mfma_f32_16x16x32_bf16 v[24:27], a[92:95], a[56:59], v[24:27]
  s_add_u32 m0, s68, 32768
  ds_read_b64_tr_b16 a[74:75], v225 offset:53248
  v_fmac_f32 v92, v246, v241
  v_mfma_f32_16x16x32_bf16 v[24:27], a[88:91], a[40:43], v[24:27]
  buffer_load_dwordx4 v232, s[16:19], s67 offen offset:0  lds
  v_fmac_f32 v93, v247, v241
  v_mfma_f32_16x16x32_bf16 v[20:23], a[88:91], a[36:39], v[20:23]
  ds_read_b64_tr_b16 a[76:77], v225 offset:57344
  v_fmac_f32 v94, v248, v241
  v_mfma_f32_16x16x32_bf16 v[20:23], a[92:95], a[52:55], v[20:23]
  v_fmac_f32 v95, v249, v241
  v_mfma_f32_16x16x32_bf16 v[16:19], a[92:95], a[48:51], v[16:19]
  ds_read_b64_tr_b16 a[78:79], v225 offset:61440
  v_xor_b32 v225, 0x10000, v225
  v_mfma_f32_16x16x32_bf16 v[16:19], a[88:91], a[32:35], v[16:19]
  buffer_load_dwordx4 v233, s[16:19], s67 offen offset:1024  lds
  s_waitcnt lgkmcnt(4)
  v_mfma_f32_16x16x32_bf16 v[32:35], a[64:67], a[32:35], v[32:35]
  ds_read_b64_tr_b16 a[80:81], v226 offset:32768
  v_fmac_f32 v112, v242, v238
  v_mfma_f32_16x16x32_bf16 v[32:35], a[68:71], a[48:51], v[32:35]
  ds_read_b128 v[246:249], v237 offset:512
  v_fmac_f32 v113, v243, v238
  v_mfma_f32_16x16x32_bf16 v[36:39], a[68:71], a[52:55], v[36:39]
  ds_read_b64_tr_b16 a[82:83], v226 offset:36864
  v_fmac_f32 v114, v244, v238
  v_mfma_f32_16x16x32_bf16 v[36:39], a[64:67], a[36:39], v[36:39]
  v_fmac_f32 v115, v245, v238
  v_fmac_f32 v116, v242, v239
  v_mfma_f32_16x16x32_bf16 v[40:43], a[64:67], a[40:43], v[40:43]
  ds_read_b64_tr_b16 a[84:85], v226 offset:40960
  v_fmac_f32 v117, v243, v239
  v_mfma_f32_16x16x32_bf16 v[40:43], a[68:71], a[56:59], v[40:43]
  buffer_load_dwordx4 v234, s[16:19], s67 offen offset:2048  lds
  v_fmac_f32 v118, v244, v239
  v_mfma_f32_16x16x32_bf16 v[44:47], a[68:71], a[60:63], v[44:47]
  ds_read_b64_tr_b16 a[86:87], v226 offset:45056
  v_fmac_f32 v119, v245, v239
  v_mfma_f32_16x16x32_bf16 v[44:47], a[64:67], a[44:47], v[44:47]
  s_waitcnt lgkmcnt(5)
  v_fmac_f32 v120, v242, v240
  v_fmac_f32 v121, v243, v240
  v_mfma_f32_16x16x32_bf16 v[60:63], a[72:75], a[44:47], v[60:63]
  ds_read_b64_tr_b16 a[88:89], v226 offset:49152
  v_fmac_f32 v122, v244, v240
  v_mfma_f32_16x16x32_bf16 v[60:63], a[76:79], a[60:63], v[60:63]
  buffer_load_dwordx4 v235, s[16:19], s67 offen offset:3072  lds
  v_fmac_f32 v123, v245, v240
  v_mfma_f32_16x16x32_bf16 v[56:59], a[76:79], a[56:59], v[56:59]
  ds_read_b64_tr_b16 a[90:91], v226 offset:53248
  v_fmac_f32 v124, v242, v241
  v_mfma_f32_16x16x32_bf16 v[56:59], a[72:75], a[40:43], v[56:59]
  v_fmac_f32 v125, v243, v241
  v_fmac_f32 v126, v244, v241
  v_mfma_f32_16x16x32_bf16 v[52:55], a[72:75], a[36:39], v[52:55]
  ds_read_b64_tr_b16 a[92:93], v226 offset:57344
  v_fmac_f32 v127, v245, v241
  v_mfma_f32_16x16x32_bf16 v[52:55], a[76:79], a[52:55], v[52:55]
  v_mfma_f32_16x16x32_bf16 v[48:51], a[76:79], a[48:51], v[48:51]
  s_add_u32 m0, s68, 49152
  ds_read_b64_tr_b16 a[94:95], v226 offset:61440
  v_xor_b32 v226, 0x10000, v226
  v_mfma_f32_16x16x32_bf16 v[48:51], a[72:75], a[32:35], v[48:51]
  buffer_load_dwordx4 v232, s[20:23], s67 offen offset:0  lds
  s_waitcnt lgkmcnt(4)
  v_mfma_f32_16x16x32_bf16 v[64:67], a[80:83], a[32:35], v[64:67]
  ds_read_b64_tr_b16 a[64:65], v227 offset:32768
  v_fmac_f32 v128, v246, v238
  v_mfma_f32_16x16x32_bf16 v[64:67], a[84:87], a[48:51], v[64:67]
  ds_read_b128 v[242:245], v237 offset:576
  v_fmac_f32 v129, v247, v238
  v_mfma_f32_16x16x32_bf16 v[68:71], a[84:87], a[52:55], v[68:71]
  ds_read_b64_tr_b16 a[66:67], v227 offset:36864
  v_fmac_f32 v130, v248, v238
  v_mfma_f32_16x16x32_bf16 v[68:71], a[80:83], a[36:39], v[68:71]
  buffer_load_dwordx4 v233, s[20:23], s67 offen offset:1024  lds
  v_fmac_f32 v131, v249, v238
  v_mfma_f32_16x16x32_bf16 v[72:75], a[80:83], a[40:43], v[72:75]
  ds_read_b64_tr_b16 a[68:69], v227 offset:40960
  v_fmac_f32 v132, v246, v239
  v_mfma_f32_16x16x32_bf16 v[72:75], a[84:87], a[56:59], v[72:75]
  v_fmac_f32 v133, v247, v239
  v_fmac_f32 v134, v248, v239
  v_mfma_f32_16x16x32_bf16 v[76:79], a[84:87], a[60:63], v[76:79]
  ds_read_b64_tr_b16 a[70:71], v227 offset:45056
  v_fmac_f32 v135, v249, v239
  v_mfma_f32_16x16x32_bf16 v[76:79], a[80:83], a[44:47], v[76:79]
  s_waitcnt lgkmcnt(5)
  v_fmac_f32 v136, v246, v240
  v_fmac_f32 v137, v247, v240
  v_mfma_f32_16x16x32_bf16 v[92:95], a[88:91], a[44:47], v[92:95]
  ds_read_b64_tr_b16 a[72:73], v227 offset:49152
  v_fmac_f32 v138, v248, v240
  v_mfma_f32_16x16x32_bf16 v[92:95], a[92:95], a[60:63], v[92:95]
  buffer_load_dwordx4 v234, s[20:23], s67 offen offset:2048  lds
  v_fmac_f32 v139, v249, v240
  v_mfma_f32_16x16x32_bf16 v[88:91], a[92:95], a[56:59], v[88:91]
  ds_read_b64_tr_b16 a[74:75], v227 offset:53248
  v_fmac_f32 v140, v246, v241
  v_mfma_f32_16x16x32_bf16 v[88:91], a[88:91], a[40:43], v[88:91]
  v_fmac_f32 v141, v247, v241
  v_fmac_f32 v142, v248, v241
  v_mfma_f32_16x16x32_bf16 v[84:87], a[88:91], a[36:39], v[84:87]
  ds_read_b64_tr_b16 a[76:77], v227 offset:57344
  v_fmac_f32 v143, v249, v241
  v_mfma_f32_16x16x32_bf16 v[84:87], a[92:95], a[52:55], v[84:87]
  buffer_load_dwordx4 v235, s[20:23], s67 offen offset:3072  lds
  v_mfma_f32_16x16x32_bf16 v[80:83], a[92:95], a[48:51], v[80:83]
  s_add_u32 s67, s67, 458752
  s_xor_b32 s68, s68, 0x10000
  ds_read_b64_tr_b16 a[78:79], v227 offset:61440
  v_xor_b32 v227, 0x10000, v227
  v_mfma_f32_16x16x32_bf16 v[80:83], a[88:91], a[32:35], v[80:83]
  s_waitcnt lgkmcnt(4)
  v_mfma_f32_16x16x32_bf16 v[96:99], a[64:67], a[32:35], v[96:99]
  s_waitcnt vmcnt(16)
  s_barrier
  ds_read_b64_tr_b16 a[80:81], v224 offset:0
  v_mfma_f32_16x16x32_bf16 v[96:99], a[68:71], a[48:51], v[96:99]
  ds_read_b128 v[246:249], v237 offset:640
  v_fmac_f32 v144, v242, v238
  v_mfma_f32_16x16x32_bf16 v[100:103], a[68:71], a[52:55], v[100:103]
  ds_read_b64_tr_b16 a[82:83], v224 offset:4096
  v_fmac_f32 v145, v243, v238
  v_mfma_f32_16x16x32_bf16 v[100:103], a[64:67], a[36:39], v[100:103]
  buffer_load_dwordx4 a[224:227], v231, s[4:7], s72 offen offset:2048 sc1
  v_fmac_f32 v146, v244, v238
  v_mfma_f32_16x16x32_bf16 v[104:107], a[64:67], a[40:43], v[104:107]
  ds_read_b64_tr_b16 a[84:85], v224 offset:8192
  v_fmac_f32 v147, v245, v238
  v_mfma_f32_16x16x32_bf16 v[104:107], a[68:71], a[56:59], v[104:107]
  v_fmac_f32 v148, v242, v239
  v_fmac_f32 v149, v243, v239
  v_mfma_f32_16x16x32_bf16 v[108:111], a[68:71], a[60:63], v[108:111]
  ds_read_b64_tr_b16 a[86:87], v224 offset:12288
  v_fmac_f32 v150, v244, v239
  v_mfma_f32_16x16x32_bf16 v[108:111], a[64:67], a[44:47], v[108:111]
  s_waitcnt lgkmcnt(5)
  buffer_load_dwordx4 a[240:243], v231, s[4:7], s72 offen offset:3072 sc1
  v_fmac_f32 v151, v245, v239
  v_mfma_f32_16x16x32_bf16 v[124:127], a[72:75], a[44:47], v[124:127]
  s_add_u32 s72, s72, 4096
  ds_read_b64_tr_b16 a[88:89], v224 offset:16384
  v_fmac_f32 v152, v242, v240
  v_mfma_f32_16x16x32_bf16 v[124:127], a[76:79], a[60:63], v[124:127]
  v_fmac_f32 v153, v243, v240
  v_fmac_f32 v154, v244, v240
  v_mfma_f32_16x16x32_bf16 v[120:123], a[76:79], a[56:59], v[120:123]
  ds_read_b64_tr_b16 a[90:91], v224 offset:20480
  v_fmac_f32 v155, v245, v240
  v_mfma_f32_16x16x32_bf16 v[120:123], a[72:75], a[40:43], v[120:123]
  v_fmac_f32 v156, v242, v241
  v_fmac_f32 v157, v243, v241
  v_mfma_f32_16x16x32_bf16 v[116:119], a[72:75], a[36:39], v[116:119]
  ds_read_b64_tr_b16 a[92:93], v224 offset:24576
  v_fmac_f32 v158, v244, v241
  v_mfma_f32_16x16x32_bf16 v[116:119], a[76:79], a[52:55], v[116:119]
  buffer_load_dwordx4 a[228:231], v231, s[4:7], s73 offen offset:2048 sc1
  v_fmac_f32 v159, v245, v241
  v_mfma_f32_16x16x32_bf16 v[112:115], a[76:79], a[48:51], v[112:115]
  ds_read_b64_tr_b16 a[94:95], v224 offset:28672
  v_mfma_f32_16x16x32_bf16 v[112:115], a[72:75], a[32:35], v[112:115]
  s_waitcnt vmcnt(17) lgkmcnt(4)
  v_mfma_f32_16x16x32_bf16 v[0:3], a[80:83], a[192:195], v[0:3]
  ds_read_b64_tr_b16 a[64:65], v225 offset:0
  v_fmac_f32 v160, v246, v238
  v_mfma_f32_16x16x32_bf16 v[0:3], a[84:87], a[208:211], v[0:3]
  s_waitcnt vmcnt(15)
  buffer_load_dwordx4 a[244:247], v231, s[4:7], s73 offen offset:3072 sc1
  ds_read_b128 v[242:245], v237 offset:704
  v_mfma_f32_16x16x32_bf16 v[4:7], a[84:87], a[212:215], v[4:7]
  s_add_u32 s73, s73, 4096
  ds_read_b64_tr_b16 a[66:67], v225 offset:4096
  v_fmac_f32 v161, v247, v238
  v_mfma_f32_16x16x32_bf16 v[4:7], a[80:83], a[196:199], v[4:7]
  s_waitcnt vmcnt(14)
  v_fmac_f32 v162, v248, v238
  v_fmac_f32 v163, v249, v238
  v_mfma_f32_16x16x32_bf16 v[8:11], a[80:83], a[200:203], v[8:11]
  ds_read_b64_tr_b16 a[68:69], v225 offset:8192
  v_fmac_f32 v164, v246, v239
  v_mfma_f32_16x16x32_bf16 v[8:11], a[84:87], a[216:219], v[8:11]
  s_waitcnt vmcnt(12)
  v_fmac_f32 v165, v247, v239
  v_fmac_f32 v166, v248, v239
  v_mfma_f32_16x16x32_bf16 v[12:15], a[84:87], a[220:223], v[12:15]
  ds_read_b64_tr_b16 a[70:71], v225 offset:12288
  v_fmac_f32 v167, v249, v239
  v_mfma_f32_16x16x32_bf16 v[12:15], a[80:83], a[204:207], v[12:15]
  s_waitcnt lgkmcnt(5)
  buffer_load_dwordx4 a[232:235], v231, s[4:7], s74 offen offset:2048 sc1
  v_fmac_f32 v168, v246, v240
  v_mfma_f32_16x16x32_bf16 v[28:31], a[88:91], a[204:207], v[28:31]
  ds_read_b64_tr_b16 a[72:73], v225 offset:16384
  v_fmac_f32 v169, v247, v240
  v_mfma_f32_16x16x32_bf16 v[28:31], a[92:95], a[220:223], v[28:31]
  v_fmac_f32 v170, v248, v240
  v_fmac_f32 v171, v249, v240
  v_mfma_f32_16x16x32_bf16 v[24:27], a[92:95], a[216:219], v[24:27]
  ds_read_b64_tr_b16 a[74:75], v225 offset:20480
  v_fmac_f32 v172, v246, v241
  v_mfma_f32_16x16x32_bf16 v[24:27], a[88:91], a[200:203], v[24:27]
  buffer_load_dwordx4 a[248:251], v231, s[4:7], s74 offen offset:3072 sc1
  v_fmac_f32 v173, v247, v241
  v_mfma_f32_16x16x32_bf16 v[20:23], a[88:91], a[196:199], v[20:23]
  s_add_u32 s74, s74, 4096
  ds_read_b64_tr_b16 a[76:77], v225 offset:24576
  v_fmac_f32 v174, v248, v241
  v_mfma_f32_16x16x32_bf16 v[20:23], a[92:95], a[212:215], v[20:23]
  v_fmac_f32 v175, v249, v241
  v_mfma_f32_16x16x32_bf16 v[16:19], a[92:95], a[208:211], v[16:19]
  ds_read_b64_tr_b16 a[78:79], v225 offset:28672
  v_mfma_f32_16x16x32_bf16 v[16:19], a[88:91], a[192:195], v[16:19]
  s_waitcnt lgkmcnt(4)
  v_mfma_f32_16x16x32_bf16 v[32:35], a[64:67], a[192:195], v[32:35]
  ds_read_b64_tr_b16 a[80:81], v226 offset:0
  v_fmac_f32 v176, v242, v238
  v_mfma_f32_16x16x32_bf16 v[32:35], a[68:71], a[208:211], v[32:35]
  buffer_load_dwordx4 a[236:239], v231, s[4:7], s75 offen offset:2048 sc1
  ds_read_b128 v[246:249], v237 offset:768
  v_mfma_f32_16x16x32_bf16 v[36:39], a[68:71], a[212:215], v[36:39]
  ds_read_b64_tr_b16 a[82:83], v226 offset:4096
  v_fmac_f32 v177, v243, v238
  v_mfma_f32_16x16x32_bf16 v[36:39], a[64:67], a[196:199], v[36:39]
  v_fmac_f32 v178, v244, v238
  v_fmac_f32 v179, v245, v238
  v_mfma_f32_16x16x32_bf16 v[40:43], a[64:67], a[200:203], v[40:43]
  ds_read_b64_tr_b16 a[84:85], v226 offset:8192
  v_fmac_f32 v180, v242, v239
  v_mfma_f32_16x16x32_bf16 v[40:43], a[68:71], a[216:219], v[40:43]
  buffer_load_dwordx4 a[252:255], v231, s[4:7], s75 offen offset:3072 sc1
  v_fmac_f32 v181, v243, v239
  v_mfma_f32_16x16x32_bf16 v[44:47], a[68:71], a[220:223], v[44:47]
  s_add_u32 s75, s75, 4096
  ds_read_b64_tr_b16 a[86:87], v226 offset:12288
  v_fmac_f32 v182, v244, v239
  v_mfma_f32_16x16x32_bf16 v[44:47], a[64:67], a[204:207], v[44:47]
  s_waitcnt lgkmcnt(5)
  v_fmac_f32 v183, v245, v239
  v_fmac_f32 v184, v242, v240
  v_mfma_f32_16x16x32_bf16 v[60:63], a[72:75], a[204:207], v[60:63]
  ds_read_b64_tr_b16 a[88:89], v226 offset:16384
  v_fmac_f32 v185, v243, v240
  v_mfma_f32_16x16x32_bf16 v[60:63], a[76:79], a[220:223], v[60:63]
  v_fmac_f32 v186, v244, v240
  v_fmac_f32 v187, v245, v240
  v_mfma_f32_16x16x32_bf16 v[56:59], a[76:79], a[216:219], v[56:59]
  ds_read_b64_tr_b16 a[90:91], v226 offset:20480
  v_fmac_f32 v188, v242, v241
  v_mfma_f32_16x16x32_bf16 v[56:59], a[72:75], a[200:203], v[56:59]
  s_add_u32 m0, s79, 0
  v_fmac_f32 v189, v243, v241
  v_fmac_f32 v190, v244, v241
  v_mfma_f32_16x16x32_bf16 v[52:55], a[72:75], a[196:199], v[52:55]
  s_add_u32 s92, s92, 0
  s_add_u32 s93, s92, s88
  ds_read_b64_tr_b16 a[92:93], v226 offset:24576
  v_fmac_f32 v191, v245, v241
  v_mfma_f32_16x16x32_bf16 v[52:55], a[76:79], a[212:215], v[52:55]
  buffer_load_dwordx4 v252, s[80:83], s93 offen lds
  v_mfma_f32_16x16x32_bf16 v[48:51], a[76:79], a[208:211], v[48:51]
  ds_read_b64_tr_b16 a[94:95], v226 offset:28672
  v_mfma_f32_16x16x32_bf16 v[48:51], a[72:75], a[192:195], v[48:51]
  s_waitcnt lgkmcnt(4)
  v_mfma_f32_16x16x32_bf16 v[64:67], a[80:83], a[192:195], v[64:67]
  ds_read_b64_tr_b16 a[64:65], v228 offset:32768
  v_fmac_f32 v192, v246, v238
  v_mfma_f32_16x16x32_bf16 v[64:67], a[84:87], a[208:211], v[64:67]
  ds_read_b128 v[242:245], v237 offset:832
  v_fmac_f32 v193, v247, v238
  v_mfma_f32_16x16x32_bf16 v[68:71], a[84:87], a[212:215], v[68:71]
  ds_read_b64_tr_b16 a[66:67], v228 offset:36864
  v_fmac_f32 v194, v248, v238
  v_mfma_f32_16x16x32_bf16 v[68:71], a[80:83], a[196:199], v[68:71]
  buffer_load_dwordx4 v252, s[84:87], s93 offen offset:1024 lds
  v_fmac_f32 v195, v249, v238
  v_fmac_f32 v196, v246, v239
  v_mfma_f32_16x16x32_bf16 v[72:75], a[80:83], a[200:203], v[72:75]
  ds_read_b64_tr_b16 a[68:69], v228 offset:40960
  v_fmac_f32 v197, v247, v239
  v_mfma_f32_16x16x32_bf16 v[72:75], a[84:87], a[216:219], v[72:75]
  v_fmac_f32 v198, v248, v239
  v_fmac_f32 v199, v249, v239
  v_mfma_f32_16x16x32_bf16 v[76:79], a[84:87], a[220:223], v[76:79]
  ds_read_b64_tr_b16 a[70:71], v228 offset:45056
  v_fmac_f32 v200, v246, v240
  v_mfma_f32_16x16x32_bf16 v[76:79], a[80:83], a[204:207], v[76:79]
  s_add_u32 m0, s79, 8192
  v_fmac_f32 v201, v247, v240
  v_fmac_f32 v202, v248, v240
  s_waitcnt lgkmcnt(5)
  v_mfma_f32_16x16x32_bf16 v[92:95], a[88:91], a[204:207], v[92:95]
  s_add_u32 s92, s92, 262144
  s_add_u32 s93, s92, s89
  ds_read_b64_tr_b16 a[72:73], v228 offset:49152
  v_fmac_f32 v203, v249, v240
  v_mfma_f32_16x16x32_bf16 v[92:95], a[92:95], a[220:223], v[92:95]
  buffer_load_dwordx4 v252, s[80:83], s93 offen lds
  v_fmac_f32 v204, v246, v241
  v_fmac_f32 v205, v247, v241
  v_mfma_f32_16x16x32_bf16 v[88:91], a[92:95], a[216:219], v[88:91]
  ds_read_b64_tr_b16 a[74:75], v228 offset:53248
  v_fmac_f32 v206, v248, v241
  v_mfma_f32_16x16x32_bf16 v[88:91], a[88:91], a[200:203], v[88:91]
  v_fmac_f32 v207, v249, v241
  v_mfma_f32_16x16x32_bf16 v[84:87], a[88:91], a[196:199], v[84:87]
  ds_read_b64_tr_b16 a[76:77], v228 offset:57344
  v_mfma_f32_16x16x32_bf16 v[84:87], a[92:95], a[212:215], v[84:87]
  v_mfma_f32_16x16x32_bf16 v[80:83], a[92:95], a[208:211], v[80:83]
  ds_read_b64_tr_b16 a[78:79], v228 offset:61440
  v_xor_b32 v228, 0x10000, v228
  v_mfma_f32_16x16x32_bf16 v[80:83], a[88:91], a[192:195], v[80:83]
  buffer_load_dwordx4 v252, s[84:87], s93 offen offset:1024 lds
  s_waitcnt lgkmcnt(4)
  v_mfma_f32_16x16x32_bf16 v[128:131], a[64:67], a[32:35], v[128:131]
  s_waitcnt vmcnt(12)
  s_barrier
  ds_read_b64_tr_b16 a[80:81], v224 offset:32768
  v_mfma_f32_16x16x32_bf16 v[128:131], a[68:71], a[48:51], v[128:131]
  v_fmac_f32 v208, v242, v238
  v_fmac_f32 v209, v243, v238
  v_mfma_f32_16x16x32_bf16 v[132:135], a[68:71], a[52:55], v[132:135]
  ds_read_b64_tr_b16 a[82:83], v224 offset:36864
  v_fmac_f32 v210, v244, v238
  v_mfma_f32_16x16x32_bf16 v[132:135], a[64:67], a[36:39], v[132:135]
  s_add_u32 m0, s79, 16384
  v_fmac_f32 v211, v245, v238
  v_fmac_f32 v212, v242, v239
  v_mfma_f32_16x16x32_bf16 v[136:139], a[64:67], a[40:43], v[136:139]
  s_add_u32 s92, s92, 196608
  s_add_u32 s93, s92, s90
  ds_read_b64_tr_b16 a[84:85], v224 offset:40960
  v_fmac_f32 v213, v243, v239
  v_mfma_f32_16x16x32_bf16 v[136:139], a[68:71], a[56:59], v[136:139]
  buffer_load_dwordx4 v252, s[80:83], s93 offen lds
  v_fmac_f32 v214, v244, v239
  v_fmac_f32 v215, v245, v239
  v_mfma_f32_16x16x32_bf16 v[140:143], a[68:71], a[60:63], v[140:143]
  ds_read_b64_tr_b16 a[86:87], v224 offset:45056
  v_fmac_f32 v216, v242, v240
  v_mfma_f32_16x16x32_bf16 v[140:143], a[64:67], a[44:47], v[140:143]
  s_waitcnt lgkmcnt(4)
  v_fmac_f32 v217, v243, v240
  v_fmac_f32 v218, v244, v240
  v_mfma_f32_16x16x32_bf16 v[156:159], a[72:75], a[44:47], v[156:159]
  ds_read_b64_tr_b16 a[88:89], v224 offset:49152
  v_fmac_f32 v219, v245, v240
  v_mfma_f32_16x16x32_bf16 v[156:159], a[76:79], a[60:63], v[156:159]
  v_fmac_f32 v220, v242, v241
  v_fmac_f32 v221, v243, v241
  v_mfma_f32_16x16x32_bf16 v[152:155], a[76:79], a[56:59], v[152:155]
  ds_read_b64_tr_b16 a[90:91], v224 offset:53248
  v_fmac_f32 v222, v244, v241
  v_mfma_f32_16x16x32_bf16 v[152:155], a[72:75], a[40:43], v[152:155]
  buffer_load_dwordx4 v252, s[84:87], s93 offen offset:1024 lds
  v_fmac_f32 v223, v245, v241
  v_mfma_f32_16x16x32_bf16 v[148:151], a[72:75], a[36:39], v[148:151]
  ds_read_b64_tr_b16 a[92:93], v224 offset:57344
  v_mfma_f32_16x16x32_bf16 v[148:151], a[76:79], a[52:55], v[148:151]
  v_mfma_f32_16x16x32_bf16 v[144:147], a[76:79], a[48:51], v[144:147]
  ds_read_b64_tr_b16 a[94:95], v224 offset:61440
  v_mfma_f32_16x16x32_bf16 v[144:147], a[72:75], a[32:35], v[144:147]
  s_add_u32 m0, s79, 24576
  s_waitcnt vmcnt(12) lgkmcnt(4)
  v_mfma_f32_16x16x32_bf16 v[0:3], a[80:83], a[224:227], v[0:3]
  s_add_u32 s92, s92, 262144
  s_add_u32 s93, s92, s91
  ds_read_b64_tr_b16 a[64:65], v229 offset:32768
  v_and_b32 v236, 31, v253
  v_mfma_f32_16x16x32_bf16 v[0:3], a[84:87], a[240:243], v[0:3]
  s_waitcnt vmcnt(10)
  buffer_load_dwordx4 v252, s[80:83], s93 offen lds
  v_lshlrev_b32 v236, 4, v236
  v_mfma_f32_16x16x32_bf16 v[4:7], a[84:87], a[244:247], v[4:7]
  ds_read_b64_tr_b16 a[66:67], v229 offset:36864
  v_lshrrev_b32 v250, 5, v253
  v_mfma_f32_16x16x32_bf16 v[4:7], a[80:83], a[228:231], v[4:7]
  s_mov_b32 s43, 114688
  v_mad_u32_u24 v236, v250, s43, v236
  v_and_b32 v250, 15, v253
  s_waitcnt vmcnt(9)
  v_mfma_f32_16x16x32_bf16 v[8:11], a[80:83], a[232:235], v[8:11]
  s_add_u32 s43, s71, 1024
  ds_read_b64_tr_b16 a[68:69], v229 offset:40960
  v_lshl_add_u32 v250, v250, 2, s43
  v_mfma_f32_16x16x32_bf16 v[8:11], a[84:87], a[248:251], v[8:11]
  s_waitcnt vmcnt(7)
  ds_read2_b32 v[238:239], v250 offset0:64 offset1:80
  ds_read2_b32 v[240:241], v250 offset0:96 offset1:112
  v_mfma_f32_16x16x32_bf16 v[12:15], a[84:87], a[252:255], v[12:15]
  ds_read_b64_tr_b16 a[70:71], v229 offset:45056
  ds_read2_b32 v[232:233], v250 offset0:128 offset1:144
  v_mfma_f32_16x16x32_bf16 v[12:15], a[80:83], a[236:239], v[12:15]
  s_waitcnt lgkmcnt(7)
  buffer_load_dwordx4 v252, s[84:87], s93 offen offset:1024 lds
  ds_read2_b32 v[234:235], v250 offset0:160 offset1:176
  v_mfma_f32_16x16x32_bf16 v[28:31], a[88:91], a[236:239], v[28:31]
  ds_read_b64_tr_b16 a[72:73], v229 offset:49152
  v_mfma_f32_16x16x32_bf16 v[28:31], a[92:95], a[252:255], v[28:31]
  v_mfma_f32_16x16x32_bf16 v[24:27], a[92:95], a[248:251], v[24:27]
  ds_read_b64_tr_b16 a[74:75], v229 offset:53248
  v_mfma_f32_16x16x32_bf16 v[24:27], a[88:91], a[232:235], v[24:27]
  v_mfma_f32_16x16x32_bf16 v[20:23], a[88:91], a[228:231], v[20:23]
  ds_read_b64_tr_b16 a[76:77], v229 offset:57344
  v_mfma_f32_16x16x32_bf16 v[20:23], a[92:95], a[244:247], v[20:23]
  v_mfma_f32_16x16x32_bf16 v[16:19], a[92:95], a[240:243], v[16:19]
  ds_read_b64_tr_b16 a[78:79], v229 offset:61440
  v_xor_b32 v229, 0x10000, v229
  v_mfma_f32_16x16x32_bf16 v[16:19], a[88:91], a[224:227], v[16:19]
  s_waitcnt lgkmcnt(6)
  v_mfma_f32_16x16x32_bf16 v[160:163], a[64:67], a[32:35], v[160:163]
  ds_read_b64_tr_b16 a[80:81], v225 offset:32768
  v_mfma_f32_16x16x32_bf16 v[160:163], a[68:71], a[48:51], v[160:163]
  v_mfma_f32_16x16x32_bf16 v[164:167], a[68:71], a[52:55], v[164:167]
  s_waitcnt lgkmcnt(5)
  ds_read_b64_tr_b16 a[82:83], v225 offset:36864
  v_mfma_f32_16x16x32_bf16 v[164:167], a[64:67], a[36:39], v[164:167]
  v_pk_mul_f32 v[242:243], v[0:1], v[238:239] op_sel:[0,0] op_sel_hi:[1,0]
  v_pk_mul_f32 v[244:245], v[2:3], v[238:239] op_sel:[0,0] op_sel_hi:[1,0]
  v_pk_mul_f32 v[0:1], v[0:1], v[16:17]
  v_pk_mul_f32 v[2:3], v[2:3], v[18:19]
  v_mfma_f32_16x16x32_bf16 v[168:171], a[64:67], a[40:43], v[168:171]
  ds_read_b64_tr_b16 a[84:85], v225 offset:40960
  v_mfma_f32_16x16x32_bf16 v[168:171], a[68:71], a[56:59], v[168:171]
  v_mfma_f32_16x16x32_bf16 v[172:175], a[68:71], a[60:63], v[172:175]
  ds_read_b64_tr_b16 a[86:87], v225 offset:45056
  v_mfma_f32_16x16x32_bf16 v[172:175], a[64:67], a[44:47], v[172:175]
  s_waitcnt lgkmcnt(4)
  v_mfma_f32_16x16x32_bf16 v[188:191], a[72:75], a[44:47], v[188:191]
  v_exp_f32 v242, v242
  v_mfma_f32_16x16x32_bf16 v[188:191], a[76:79], a[60:63], v[188:191]
  v_exp_f32 v243, v243
  v_mfma_f32_16x16x32_bf16 v[184:187], a[76:79], a[56:59], v[184:187]
  ds_read_b64_tr_b16 a[88:89], v225 offset:49152
  ds_read_b64_tr_b16 a[90:91], v225 offset:53248
  v_mfma_f32_16x16x32_bf16 v[184:187], a[72:75], a[40:43], v[184:187]
  v_exp_f32 v244, v244
  v_exp_f32 v245, v245
  s_nop 0
  v_pk_fma_f32 v[242:243], v[242:243], v[232:233], v[232:233] op_sel:[0,0,0] op_sel_hi:[1,0,0]
  v_pk_fma_f32 v[244:245], v[244:245], v[232:233], v[232:233] op_sel:[0,0,0] op_sel_hi:[1,0,0]
  v_pk_mul_f32 v[246:247], v[4:5], v[238:239] op_sel:[0,1] op_sel_hi:[1,1]
  v_pk_mul_f32 v[248:249], v[6:7], v[238:239] op_sel:[0,1] op_sel_hi:[1,1]
  v_pk_mul_f32 v[4:5], v[4:5], v[20:21]
  v_pk_mul_f32 v[6:7], v[6:7], v[22:23]
  v_rcp_f32 v242, v242
  v_mfma_f32_16x16x32_bf16 v[180:183], a[72:75], a[36:39], v[180:183]
  v_rcp_f32 v243, v243
  v_mfma_f32_16x16x32_bf16 v[180:183], a[76:79], a[52:55], v[180:183]
  v_rcp_f32 v244, v244
  v_mfma_f32_16x16x32_bf16 v[176:179], a[76:79], a[48:51], v[176:179]
  ds_read_b64_tr_b16 a[92:93], v225 offset:57344
  v_mfma_f32_16x16x32_bf16 v[176:179], a[72:75], a[32:35], v[176:179]
  ds_read_b64_tr_b16 a[94:95], v225 offset:61440
  s_waitcnt lgkmcnt(4)
  v_mfma_f32_16x16x32_bf16 v[32:35], a[80:83], a[224:227], v[32:35]
  v_exp_f32 v246, v246
  v_mfma_f32_16x16x32_bf16 v[32:35], a[84:87], a[240:243], v[32:35]
  v_exp_f32 v247, v247
  v_mfma_f32_16x16x32_bf16 v[36:39], a[84:87], a[244:247], v[36:39]
  ds_read_b64_tr_b16 a[64:65], v230 offset:32768
  ds_read_b64_tr_b16 a[66:67], v230 offset:36864
  v_mfma_f32_16x16x32_bf16 v[36:39], a[80:83], a[228:231], v[36:39]
  v_exp_f32 v248, v248
  v_exp_f32 v249, v249
  v_rcp_f32 v245, v245
  v_pk_fma_f32 v[246:247], v[246:247], v[232:233], v[232:233] op_sel:[0,1,1] op_sel_hi:[1,1,1]
  v_pk_fma_f32 v[248:249], v[248:249], v[232:233], v[232:233] op_sel:[0,1,1] op_sel_hi:[1,1,1]
  v_pk_mul_f32 v[0:1], v[0:1], v[242:243]
  v_pk_mul_f32 v[2:3], v[2:3], v[244:245]
  v_pk_mul_f32 v[242:243], v[8:9], v[240:241] op_sel:[0,0] op_sel_hi:[1,0]
  v_pk_mul_f32 v[244:245], v[10:11], v[240:241] op_sel:[0,0] op_sel_hi:[1,0]
  v_pk_mul_f32 v[8:9], v[8:9], v[24:25]
  v_pk_mul_f32 v[10:11], v[10:11], v[26:27]
  v_rcp_f32 v246, v246
  v_mfma_f32_16x16x32_bf16 v[40:43], a[80:83], a[232:235], v[40:43]
  v_rcp_f32 v247, v247
  v_mfma_f32_16x16x32_bf16 v[40:43], a[84:87], a[248:251], v[40:43]
  v_rcp_f32 v248, v248
  v_mfma_f32_16x16x32_bf16 v[44:47], a[84:87], a[252:255], v[44:47]
  ds_read_b64_tr_b16 a[68:69], v230 offset:40960
  v_cvt_pk_bf16_f32 v16, v0, v1
  v_mfma_f32_16x16x32_bf16 v[44:47], a[80:83], a[236:239], v[44:47]
  s_waitcnt lgkmcnt(3)
  ds_read_b64_tr_b16 a[70:71], v230 offset:45056
  v_cvt_pk_bf16_f32 v17, v2, v3
  v_mfma_f32_16x16x32_bf16 v[60:63], a[88:91], a[236:239], v[60:63]
  v_exp_f32 v242, v242
  v_mfma_f32_16x16x32_bf16 v[60:63], a[92:95], a[252:255], v[60:63]
  v_exp_f32 v243, v243
  v_mfma_f32_16x16x32_bf16 v[56:59], a[92:95], a[248:251], v[56:59]
  ds_read_b64_tr_b16 a[72:73], v230 offset:49152
  ds_read_b64_tr_b16 a[74:75], v230 offset:53248
  v_mfma_f32_16x16x32_bf16 v[56:59], a[88:91], a[232:235], v[56:59]
  v_exp_f32 v244, v244
  v_exp_f32 v245, v245
  v_rcp_f32 v249, v249
  v_pk_fma_f32 v[242:243], v[242:243], v[234:235], v[234:235] op_sel:[0,0,0] op_sel_hi:[1,0,0]
  v_pk_fma_f32 v[244:245], v[244:245], v[234:235], v[234:235] op_sel:[0,0,0] op_sel_hi:[1,0,0]
  v_pk_mul_f32 v[4:5], v[4:5], v[246:247]
  v_pk_mul_f32 v[6:7], v[6:7], v[248:249]
  v_pk_mul_f32 v[246:247], v[12:13], v[240:241] op_sel:[0,1] op_sel_hi:[1,1]
  v_pk_mul_f32 v[248:249], v[14:15], v[240:241] op_sel:[0,1] op_sel_hi:[1,1]
  v_pk_mul_f32 v[12:13], v[12:13], v[28:29]
  v_pk_mul_f32 v[14:15], v[14:15], v[30:31]
  v_rcp_f32 v242, v242
  v_mfma_f32_16x16x32_bf16 v[52:55], a[88:91], a[228:231], v[52:55]
  v_rcp_f32 v243, v243
  v_mfma_f32_16x16x32_bf16 v[52:55], a[92:95], a[244:247], v[52:55]
  v_rcp_f32 v244, v244
  v_mfma_f32_16x16x32_bf16 v[48:51], a[92:95], a[240:243], v[48:51]
  ds_read_b64_tr_b16 a[76:77], v230 offset:57344
  v_cvt_pk_bf16_f32 v20, v4, v5
  v_mfma_f32_16x16x32_bf16 v[48:51], a[88:91], a[224:227], v[48:51]
  s_waitcnt lgkmcnt(3)
  ds_read_b64_tr_b16 a[78:79], v230 offset:61440
  v_xor_b32 v230, 0x10000, v230
  v_cvt_pk_bf16_f32 v21, v6, v7
  v_mfma_f32_16x16x32_bf16 v[192:195], a[64:67], a[32:35], v[192:195]
  v_exp_f32 v246, v246
  v_mfma_f32_16x16x32_bf16 v[192:195], a[68:71], a[48:51], v[192:195]
  v_exp_f32 v247, v247
  v_mfma_f32_16x16x32_bf16 v[196:199], a[68:71], a[52:55], v[196:199]
  ds_read_b64_tr_b16 a[80:81], v226 offset:32768
  ds_read_b64_tr_b16 a[82:83], v226 offset:36864
  v_mfma_f32_16x16x32_bf16 v[196:199], a[64:67], a[36:39], v[196:199]
  v_exp_f32 v248, v248
  v_exp_f32 v249, v249
  v_rcp_f32 v245, v245
  v_pk_fma_f32 v[246:247], v[246:247], v[234:235], v[234:235] op_sel:[0,1,1] op_sel_hi:[1,1,1]
  v_pk_fma_f32 v[248:249], v[248:249], v[234:235], v[234:235] op_sel:[0,1,1] op_sel_hi:[1,1,1]
  v_pk_mul_f32 v[8:9], v[8:9], v[242:243]
  v_pk_mul_f32 v[10:11], v[10:11], v[244:245]
  v_pk_mul_f32 v[242:243], v[32:33], v[238:239] op_sel:[0,0] op_sel_hi:[1,0]
  v_pk_mul_f32 v[244:245], v[34:35], v[238:239] op_sel:[0,0] op_sel_hi:[1,0]
  v_pk_mul_f32 v[32:33], v[32:33], v[48:49]
  v_pk_mul_f32 v[34:35], v[34:35], v[50:51]
  v_rcp_f32 v246, v246
  v_mfma_f32_16x16x32_bf16 v[200:203], a[64:67], a[40:43], v[200:203]
  v_rcp_f32 v247, v247
  v_mfma_f32_16x16x32_bf16 v[200:203], a[68:71], a[56:59], v[200:203]
  v_rcp_f32 v248, v248
  v_mfma_f32_16x16x32_bf16 v[204:207], a[68:71], a[60:63], v[204:207]
  ds_read_b64_tr_b16 a[84:85], v226 offset:40960
  v_cvt_pk_bf16_f32 v24, v8, v9
  v_mfma_f32_16x16x32_bf16 v[204:207], a[64:67], a[44:47], v[204:207]
  s_waitcnt lgkmcnt(3)
  ds_read_b64_tr_b16 a[86:87], v226 offset:45056
  v_cvt_pk_bf16_f32 v25, v10, v11
  v_mfma_f32_16x16x32_bf16 v[220:223], a[72:75], a[44:47], v[220:223]
  v_exp_f32 v242, v242
  v_mfma_f32_16x16x32_bf16 v[220:223], a[76:79], a[60:63], v[220:223]
  v_exp_f32 v243, v243
  v_mfma_f32_16x16x32_bf16 v[216:219], a[76:79], a[56:59], v[216:219]
  ds_read_b64_tr_b16 a[88:89], v226 offset:49152
  ds_read_b64_tr_b16 a[90:91], v226 offset:53248
  v_mfma_f32_16x16x32_bf16 v[216:219], a[72:75], a[40:43], v[216:219]
  v_exp_f32 v244, v244
  v_exp_f32 v245, v245
  v_rcp_f32 v249, v249
  v_pk_fma_f32 v[242:243], v[242:243], v[232:233], v[232:233] op_sel:[0,0,0] op_sel_hi:[1,0,0]
  v_pk_fma_f32 v[244:245], v[244:245], v[232:233], v[232:233] op_sel:[0,0,0] op_sel_hi:[1,0,0]
  v_pk_mul_f32 v[12:13], v[12:13], v[246:247]
  v_pk_mul_f32 v[14:15], v[14:15], v[248:249]
  v_pk_mul_f32 v[246:247], v[36:37], v[238:239] op_sel:[0,1] op_sel_hi:[1,1]
  v_pk_mul_f32 v[248:249], v[38:39], v[238:239] op_sel:[0,1] op_sel_hi:[1,1]
  v_pk_mul_f32 v[36:37], v[36:37], v[52:53]
  v_pk_mul_f32 v[38:39], v[38:39], v[54:55]
  v_rcp_f32 v242, v242
  v_mfma_f32_16x16x32_bf16 v[212:215], a[72:75], a[36:39], v[212:215]
  v_rcp_f32 v243, v243
  v_mfma_f32_16x16x32_bf16 v[212:215], a[76:79], a[52:55], v[212:215]
  v_rcp_f32 v244, v244
  v_mfma_f32_16x16x32_bf16 v[208:211], a[76:79], a[48:51], v[208:211]
  ds_read_b64_tr_b16 a[92:93], v226 offset:57344
  v_cvt_pk_bf16_f32 v28, v12, v13
  v_mfma_f32_16x16x32_bf16 v[208:211], a[72:75], a[32:35], v[208:211]
  s_waitcnt lgkmcnt(3)
  ds_read_b64_tr_b16 a[94:95], v226 offset:61440
  v_cvt_pk_bf16_f32 v29, v14, v15
  v_mfma_f32_16x16x32_bf16 v[64:67], a[80:83], a[224:227], v[64:67]
  v_exp_f32 v246, v246
  v_mfma_f32_16x16x32_bf16 v[64:67], a[84:87], a[240:243], v[64:67]
  v_exp_f32 v247, v247
  v_mfma_f32_16x16x32_bf16 v[68:71], a[84:87], a[244:247], v[68:71]
  ds_read_b64_tr_b16 a[64:65], v227 offset:0
  ds_read_b64_tr_b16 a[66:67], v227 offset:4096
  v_mfma_f32_16x16x32_bf16 v[68:71], a[80:83], a[228:231], v[68:71]
  v_exp_f32 v248, v248
  v_exp_f32 v249, v249
  v_rcp_f32 v245, v245
  v_pk_fma_f32 v[246:247], v[246:247], v[232:233], v[232:233] op_sel:[0,1,1] op_sel_hi:[1,1,1]
  v_pk_fma_f32 v[248:249], v[248:249], v[232:233], v[232:233] op_sel:[0,1,1] op_sel_hi:[1,1,1]
  v_pk_mul_f32 v[32:33], v[32:33], v[242:243]
  v_pk_mul_f32 v[34:35], v[34:35], v[244:245]
  v_pk_mul_f32 v[242:243], v[40:41], v[240:241] op_sel:[0,0] op_sel_hi:[1,0]
  v_pk_mul_f32 v[244:245], v[42:43], v[240:241] op_sel:[0,0] op_sel_hi:[1,0]
  v_pk_mul_f32 v[40:41], v[40:41], v[56:57]
  v_pk_mul_f32 v[42:43], v[42:43], v[58:59]
  v_rcp_f32 v246, v246
  v_mfma_f32_16x16x32_bf16 v[72:75], a[80:83], a[232:235], v[72:75]
  v_rcp_f32 v247, v247
  v_mfma_f32_16x16x32_bf16 v[72:75], a[84:87], a[248:251], v[72:75]
  v_rcp_f32 v248, v248
  v_mfma_f32_16x16x32_bf16 v[76:79], a[84:87], a[252:255], v[76:79]
  ds_read_b64_tr_b16 a[68:69], v227 offset:8192
  v_cvt_pk_bf16_f32 v18, v32, v33
  v_mfma_f32_16x16x32_bf16 v[76:79], a[80:83], a[236:239], v[76:79]
  s_waitcnt lgkmcnt(3)
  ds_read_b64_tr_b16 a[70:71], v227 offset:12288
  v_cvt_pk_bf16_f32 v19, v34, v35
  v_mfma_f32_16x16x32_bf16 v[92:95], a[88:91], a[236:239], v[92:95]
  buffer_store_dwordx4 v[16:19], v231, s[4:7], s57 offen sc1
  s_add_u32 s57, s57, 16384
  v_exp_f32 v242, v242
  v_mfma_f32_16x16x32_bf16 v[92:95], a[92:95], a[252:255], v[92:95]
  v_exp_f32 v243, v243
  v_mfma_f32_16x16x32_bf16 v[88:91], a[92:95], a[248:251], v[88:91]
  ds_read_b64_tr_b16 a[72:73], v227 offset:16384
  ds_read_b64_tr_b16 a[74:75], v227 offset:20480
  v_mfma_f32_16x16x32_bf16 v[88:91], a[88:91], a[232:235], v[88:91]
  v_exp_f32 v244, v244
  v_exp_f32 v245, v245
  v_rcp_f32 v249, v249
  v_pk_fma_f32 v[242:243], v[242:243], v[234:235], v[234:235] op_sel:[0,0,0] op_sel_hi:[1,0,0]
  v_pk_fma_f32 v[244:245], v[244:245], v[234:235], v[234:235] op_sel:[0,0,0] op_sel_hi:[1,0,0]
  v_pk_mul_f32 v[36:37], v[36:37], v[246:247]
  v_pk_mul_f32 v[38:39], v[38:39], v[248:249]
  v_pk_mul_f32 v[246:247], v[44:45], v[240:241] op_sel:[0,1] op_sel_hi:[1,1]
  v_pk_mul_f32 v[248:249], v[46:47], v[240:241] op_sel:[0,1] op_sel_hi:[1,1]
  v_pk_mul_f32 v[44:45], v[44:45], v[60:61]
  v_pk_mul_f32 v[46:47], v[46:47], v[62:63]
  v_rcp_f32 v242, v242
  v_mfma_f32_16x16x32_bf16 v[84:87], a[88:91], a[228:231], v[84:87]
  v_rcp_f32 v243, v243
  v_mfma_f32_16x16x32_bf16 v[84:87], a[92:95], a[244:247], v[84:87]
  v_rcp_f32 v244, v244
  v_mfma_f32_16x16x32_bf16 v[80:83], a[92:95], a[240:243], v[80:83]
  ds_read_b64_tr_b16 a[76:77], v227 offset:24576
  v_cvt_pk_bf16_f32 v22, v36, v37
  v_mfma_f32_16x16x32_bf16 v[80:83], a[88:91], a[224:227], v[80:83]
  s_waitcnt lgkmcnt(3)
  ds_read_b64_tr_b16 a[78:79], v227 offset:28672
  v_cvt_pk_bf16_f32 v23, v38, v39
  v_mfma_f32_16x16x32_bf16 v[96:99], a[64:67], a[192:195], v[96:99]
  buffer_store_dwordx4 v[20:23], v231, s[4:7], s58 offen sc1
  s_add_u32 s58, s58, 16384
  v_exp_f32 v246, v246
  v_mfma_f32_16x16x32_bf16 v[96:99], a[68:71], a[208:211], v[96:99]
  v_exp_f32 v247, v247
  v_mfma_f32_16x16x32_bf16 v[100:103], a[68:71], a[212:215], v[100:103]
  ds_read_b64_tr_b16 a[80:81], v227 offset:32768
  ds_read_b64_tr_b16 a[82:83], v227 offset:36864
  v_mfma_f32_16x16x32_bf16 v[100:103], a[64:67], a[196:199], v[100:103]
  v_exp_f32 v248, v248
  v_exp_f32 v249, v249
  v_rcp_f32 v245, v245
  v_pk_fma_f32 v[246:247], v[246:247], v[234:235], v[234:235] op_sel:[0,1,1] op_sel_hi:[1,1,1]
  v_pk_fma_f32 v[248:249], v[248:249], v[234:235], v[234:235] op_sel:[0,1,1] op_sel_hi:[1,1,1]
  v_pk_mul_f32 v[40:41], v[40:41], v[242:243]
  v_pk_mul_f32 v[42:43], v[42:43], v[244:245]
  v_pk_mul_f32 v[242:243], v[64:65], v[238:239] op_sel:[0,0] op_sel_hi:[1,0]
  v_pk_mul_f32 v[244:245], v[66:67], v[238:239] op_sel:[0,0] op_sel_hi:[1,0]
  v_pk_mul_f32 v[64:65], v[64:65], v[80:81]
  v_pk_mul_f32 v[66:67], v[66:67], v[82:83]
  v_rcp_f32 v246, v246
  v_mfma_f32_16x16x32_bf16 v[104:107], a[64:67], a[200:203], v[104:107]
  v_rcp_f32 v247, v247
  v_mfma_f32_16x16x32_bf16 v[104:107], a[68:71], a[216:219], v[104:107]
  v_rcp_f32 v248, v248
  v_mfma_f32_16x16x32_bf16 v[108:111], a[68:71], a[220:223], v[108:111]
  ds_read_b64_tr_b16 a[84:85], v227 offset:40960
  v_cvt_pk_bf16_f32 v26, v40, v41
  v_mfma_f32_16x16x32_bf16 v[108:111], a[64:67], a[204:207], v[108:111]
  s_waitcnt lgkmcnt(3)
  ds_read_b64_tr_b16 a[86:87], v227 offset:45056
  v_cvt_pk_bf16_f32 v27, v42, v43
  v_mfma_f32_16x16x32_bf16 v[124:127], a[72:75], a[204:207], v[124:127]
  buffer_store_dwordx4 v[24:27], v231, s[4:7], s59 offen sc1
  s_add_u32 s59, s59, 16384
  v_exp_f32 v242, v242
  v_mfma_f32_16x16x32_bf16 v[124:127], a[76:79], a[220:223], v[124:127]
  v_exp_f32 v243, v243
  v_mfma_f32_16x16x32_bf16 v[120:123], a[76:79], a[216:219], v[120:123]
  ds_read_b64_tr_b16 a[88:89], v227 offset:49152
  ds_read_b64_tr_b16 a[90:91], v227 offset:53248
  v_mfma_f32_16x16x32_bf16 v[120:123], a[72:75], a[200:203], v[120:123]
  v_exp_f32 v244, v244
  v_exp_f32 v245, v245
  v_rcp_f32 v249, v249
  v_pk_fma_f32 v[242:243], v[242:243], v[232:233], v[232:233] op_sel:[0,0,0] op_sel_hi:[1,0,0]
  v_pk_fma_f32 v[244:245], v[244:245], v[232:233], v[232:233] op_sel:[0,0,0] op_sel_hi:[1,0,0]
  v_pk_mul_f32 v[44:45], v[44:45], v[246:247]
  v_pk_mul_f32 v[46:47], v[46:47], v[248:249]
  v_pk_mul_f32 v[246:247], v[68:69], v[238:239] op_sel:[0,1] op_sel_hi:[1,1]
  v_pk_mul_f32 v[248:249], v[70:71], v[238:239] op_sel:[0,1] op_sel_hi:[1,1]
  v_pk_mul_f32 v[68:69], v[68:69], v[84:85]
  v_pk_mul_f32 v[70:71], v[70:71], v[86:87]
  v_rcp_f32 v242, v242
  v_mfma_f32_16x16x32_bf16 v[116:119], a[72:75], a[196:199], v[116:119]
  v_rcp_f32 v243, v243
  v_mfma_f32_16x16x32_bf16 v[116:119], a[76:79], a[212:215], v[116:119]
  v_rcp_f32 v244, v244
  v_mfma_f32_16x16x32_bf16 v[112:115], a[76:79], a[208:211], v[112:115]
  ds_read_b64_tr_b16 a[92:93], v227 offset:57344
  v_cvt_pk_bf16_f32 v30, v44, v45
  v_mfma_f32_16x16x32_bf16 v[112:115], a[72:75], a[192:195], v[112:115]
  s_waitcnt lgkmcnt(3)
  ds_read_b64_tr_b16 a[94:95], v227 offset:61440
  v_cvt_pk_bf16_f32 v31, v46, v47
  v_mfma_f32_16x16x32_bf16 v[96:99], a[80:83], a[224:227], v[96:99]
  buffer_store_dwordx4 v[28:31], v231, s[4:7], s60 offen sc1
  s_add_u32 s60, s60, 16384
  v_exp_f32 v246, v246
  v_mfma_f32_16x16x32_bf16 v[96:99], a[84:87], a[240:243], v[96:99]
  v_exp_f32 v247, v247
  v_mfma_f32_16x16x32_bf16 v[100:103], a[84:87], a[244:247], v[100:103]
  ds_read_b64_tr_b16 a[64:65], v228 offset:0
  ds_read_b64_tr_b16 a[66:67], v228 offset:4096
  v_mfma_f32_16x16x32_bf16 v[100:103], a[80:83], a[228:231], v[100:103]
  v_exp_f32 v248, v248
  v_exp_f32 v249, v249
  v_rcp_f32 v245, v245
  v_pk_fma_f32 v[246:247], v[246:247], v[232:233], v[232:233] op_sel:[0,1,1] op_sel_hi:[1,1,1]
  v_pk_fma_f32 v[248:249], v[248:249], v[232:233], v[232:233] op_sel:[0,1,1] op_sel_hi:[1,1,1]
  v_pk_mul_f32 v[64:65], v[64:65], v[242:243]
  v_pk_mul_f32 v[66:67], v[66:67], v[244:245]
  v_pk_mul_f32 v[242:243], v[72:73], v[240:241] op_sel:[0,0] op_sel_hi:[1,0]
  v_pk_mul_f32 v[244:245], v[74:75], v[240:241] op_sel:[0,0] op_sel_hi:[1,0]
  v_pk_mul_f32 v[72:73], v[72:73], v[88:89]
  v_pk_mul_f32 v[74:75], v[74:75], v[90:91]
  v_rcp_f32 v246, v246
  v_mfma_f32_16x16x32_bf16 v[104:107], a[80:83], a[232:235], v[104:107]
  v_rcp_f32 v247, v247
  v_lshlrev_b32 v8, 4, v253
  v_mfma_f32_16x16x32_bf16 v[104:107], a[84:87], a[248:251], v[104:107]
  v_rcp_f32 v248, v248
  v_add_u32 v9, 114688, v8
  v_mfma_f32_16x16x32_bf16 v[108:111], a[84:87], a[252:255], v[108:111]
  ds_read_b64_tr_b16 a[68:69], v228 offset:8192
  v_cvt_pk_bf16_f32 v80, v64, v65
  v_mfma_f32_16x16x32_bf16 v[108:111], a[80:83], a[236:239], v[108:111]
  s_waitcnt lgkmcnt(3)
  ds_read_b64_tr_b16 a[70:71], v228 offset:12288
  v_cvt_pk_bf16_f32 v81, v66, v67
  v_mfma_f32_16x16x32_bf16 v[124:127], a[88:91], a[236:239], v[124:127]
  buffer_load_dwordx4 v[16:19], v8, s[4:7], s46 offen offset:0 sc1
  v_exp_f32 v242, v242
  v_mfma_f32_16x16x32_bf16 v[124:127], a[92:95], a[252:255], v[124:127]
  buffer_load_dwordx4 v[20:23], v8, s[4:7], s46 offen offset:1024 sc1
  v_exp_f32 v243, v243
  v_mfma_f32_16x16x32_bf16 v[120:123], a[92:95], a[248:251], v[120:123]
  ds_read_b64_tr_b16 a[72:73], v228 offset:16384
  ds_read_b64_tr_b16 a[74:75], v228 offset:20480
  v_mfma_f32_16x16x32_bf16 v[120:123], a[88:91], a[232:235], v[120:123]
  v_exp_f32 v244, v244
  v_exp_f32 v245, v245
  v_rcp_f32 v249, v249
  v_pk_fma_f32 v[242:243], v[242:243], v[234:235], v[234:235] op_sel:[0,0,0] op_sel_hi:[1,0,0]
  v_pk_fma_f32 v[244:245], v[244:245], v[234:235], v[234:235] op_sel:[0,0,0] op_sel_hi:[1,0,0]
  v_pk_mul_f32 v[68:69], v[68:69], v[246:247]
  v_pk_mul_f32 v[70:71], v[70:71], v[248:249]
  v_pk_mul_f32 v[246:247], v[76:77], v[240:241] op_sel:[0,1] op_sel_hi:[1,1]
  v_pk_mul_f32 v[248:249], v[78:79], v[240:241] op_sel:[0,1] op_sel_hi:[1,1]
  v_pk_mul_f32 v[76:77], v[76:77], v[92:93]
  v_pk_mul_f32 v[78:79], v[78:79], v[94:95]
  v_rcp_f32 v242, v242
  v_mfma_f32_16x16x32_bf16 v[116:119], a[88:91], a[228:231], v[116:119]
  buffer_load_dwordx4 v[24:27], v8, s[4:7], s47 offen offset:0 sc1
  v_rcp_f32 v243, v243
  v_mfma_f32_16x16x32_bf16 v[116:119], a[92:95], a[244:247], v[116:119]
  buffer_load_dwordx4 v[28:31], v8, s[4:7], s47 offen offset:1024 sc1
  v_rcp_f32 v244, v244
  v_mfma_f32_16x16x32_bf16 v[112:115], a[92:95], a[240:243], v[112:115]
  ds_read_b64_tr_b16 a[76:77], v228 offset:24576
  v_cvt_pk_bf16_f32 v84, v68, v69
  v_mfma_f32_16x16x32_bf16 v[112:115], a[88:91], a[224:227], v[112:115]
  s_waitcnt lgkmcnt(3)
  ds_read_b64_tr_b16 a[78:79], v228 offset:28672
  v_cvt_pk_bf16_f32 v85, v70, v71
  v_mfma_f32_16x16x32_bf16 v[128:131], a[64:67], a[192:195], v[128:131]
  v_exp_f32 v246, v246
  v_bfe_u32 v11, v253, 2, 3
  v_mfma_f32_16x16x32_bf16 v[128:131], a[68:71], a[208:211], v[128:131]
  v_exp_f32 v247, v247
  v_bfe_u32 v12, v253, 3, 2
  v_mfma_f32_16x16x32_bf16 v[132:135], a[68:71], a[212:215], v[132:135]
  ds_read_b64_tr_b16 a[80:81], v228 offset:32768
  ds_read_b64_tr_b16 a[82:83], v228 offset:36864
  v_mfma_f32_16x16x32_bf16 v[132:135], a[64:67], a[196:199], v[132:135]
  v_exp_f32 v248, v248
  v_exp_f32 v249, v249
  v_rcp_f32 v245, v245
  v_pk_fma_f32 v[246:247], v[246:247], v[234:235], v[234:235] op_sel:[0,1,1] op_sel_hi:[1,1,1]
  v_pk_fma_f32 v[248:249], v[248:249], v[234:235], v[234:235] op_sel:[0,1,1] op_sel_hi:[1,1,1]
  v_pk_mul_f32 v[72:73], v[72:73], v[242:243]
  v_pk_mul_f32 v[74:75], v[74:75], v[244:245]
  v_pk_mul_f32 v[242:243], v[96:97], v[238:239] op_sel:[0,0] op_sel_hi:[1,0]
  v_pk_mul_f32 v[244:245], v[98:99], v[238:239] op_sel:[0,0] op_sel_hi:[1,0]
  v_pk_mul_f32 v[96:97], v[96:97], v[112:113]
  v_pk_mul_f32 v[98:99], v[98:99], v[114:115]
  v_rcp_f32 v246, v246
  v_mfma_f32_16x16x32_bf16 v[136:139], a[64:67], a[200:203], v[136:139]
  v_rcp_f32 v247, v247
  v_and_b32 v13, 3, v253
  v_mfma_f32_16x16x32_bf16 v[136:139], a[68:71], a[216:219], v[136:139]
  v_rcp_f32 v248, v248
  v_lshlrev_b32 v13, 3, v13
  v_mfma_f32_16x16x32_bf16 v[140:143], a[68:71], a[220:223], v[140:143]
  ds_read_b64_tr_b16 a[84:85], v228 offset:40960
  v_cvt_pk_bf16_f32 v88, v72, v73
  v_mfma_f32_16x16x32_bf16 v[140:143], a[64:67], a[204:207], v[140:143]
  s_waitcnt lgkmcnt(3)
  ds_read_b64_tr_b16 a[86:87], v228 offset:45056
  v_cvt_pk_bf16_f32 v89, v74, v75
  v_mfma_f32_16x16x32_bf16 v[156:159], a[72:75], a[204:207], v[156:159]
  v_exp_f32 v242, v242
  v_lshl_add_u32 v13, v11, 7, v13
  v_mfma_f32_16x16x32_bf16 v[156:159], a[76:79], a[220:223], v[156:159]
  v_exp_f32 v243, v243
  v_lshrrev_b32 v11, 5, v253
  v_mfma_f32_16x16x32_bf16 v[152:155], a[76:79], a[216:219], v[152:155]
  ds_read_b64_tr_b16 a[88:89], v228 offset:49152
  ds_read_b64_tr_b16 a[90:91], v228 offset:53248
  v_mfma_f32_16x16x32_bf16 v[152:155], a[72:75], a[200:203], v[152:155]
  v_exp_f32 v244, v244
  v_exp_f32 v245, v245
  v_rcp_f32 v249, v249
  v_pk_fma_f32 v[242:243], v[242:243], v[232:233], v[232:233] op_sel:[0,0,0] op_sel_hi:[1,0,0]
  v_pk_fma_f32 v[244:245], v[244:245], v[232:233], v[232:233] op_sel:[0,0,0] op_sel_hi:[1,0,0]
  v_pk_mul_f32 v[76:77], v[76:77], v[246:247]
  v_pk_mul_f32 v[78:79], v[78:79], v[248:249]
  v_pk_mul_f32 v[246:247], v[100:101], v[238:239] op_sel:[0,1] op_sel_hi:[1,1]
  v_pk_mul_f32 v[248:249], v[102:103], v[238:239] op_sel:[0,1] op_sel_hi:[1,1]
  v_pk_mul_f32 v[100:101], v[100:101], v[116:117]
  v_pk_mul_f32 v[102:103], v[102:103], v[118:119]
  v_rcp_f32 v242, v242
  v_mfma_f32_16x16x32_bf16 v[148:151], a[72:75], a[196:199], v[148:151]
  s_waitcnt vmcnt(4)
  s_barrier
  s_cmp_lg_u32 s40, 0
  s_cbranch_scc1 Lsgf17
  v_mov_b32 v250, 1
  s_mov_b64 exec, 1
  buffer_atomic_add v250, v251, s[4:7], s77 offen sc1
  s_mov_b64 exec, -1
Lsgf17:
  s_add_u32 s77, s77, 4096
  v_rcp_f32 v243, v243
  v_lshl_add_u32 v13, v11, 11, v13
  v_mfma_f32_16x16x32_bf16 v[148:151], a[76:79], a[212:215], v[148:151]
  s_add_u32 m0, s79, 32768
  v_rcp_f32 v244, v244
  v_xor_b32 v11, 0, v12
  v_mfma_f32_16x16x32_bf16 v[144:147], a[76:79], a[208:211], v[144:147]
  s_add_u32 s92, s92, 196608
  s_add_u32 s93, s92, s88
  ds_read_b64_tr_b16 a[92:93], v228 offset:57344
  v_cvt_pk_bf16_f32 v92, v76, v77
  v_mfma_f32_16x16x32_bf16 v[144:147], a[72:75], a[192:195], v[144:147]
  s_waitcnt lgkmcnt(3)
  ds_read_b64_tr_b16 a[94:95], v228 offset:61440
  v_cvt_pk_bf16_f32 v93, v78, v79
  v_mfma_f32_16x16x32_bf16 v[128:131], a[80:83], a[224:227], v[128:131]
  buffer_load_dwordx4 v252, s[80:83], s93 offen lds
  v_exp_f32 v246, v246
  v_mfma_f32_16x16x32_bf16 v[128:131], a[84:87], a[240:243], v[128:131]
  buffer_load_dwordx4 v252, s[84:87], s93 offen offset:1024 lds
  v_exp_f32 v247, v247
  v_mfma_f32_16x16x32_bf16 v[132:135], a[84:87], a[244:247], v[132:135]
  ds_read_b64_tr_b16 a[64:65], v229 offset:0
  ds_read_b64_tr_b16 a[66:67], v229 offset:4096
  v_mfma_f32_16x16x32_bf16 v[132:135], a[80:83], a[228:231], v[132:135]
  v_exp_f32 v248, v248
  v_exp_f32 v249, v249
  v_rcp_f32 v245, v245
  v_pk_fma_f32 v[246:247], v[246:247], v[232:233], v[232:233] op_sel:[0,1,1] op_sel_hi:[1,1,1]
  v_pk_fma_f32 v[248:249], v[248:249], v[232:233], v[232:233] op_sel:[0,1,1] op_sel_hi:[1,1,1]
  v_pk_mul_f32 v[96:97], v[96:97], v[242:243]
  v_pk_mul_f32 v[98:99], v[98:99], v[244:245]
  v_pk_mul_f32 v[242:243], v[104:105], v[240:241] op_sel:[0,0] op_sel_hi:[1,0]
  v_pk_mul_f32 v[244:245], v[106:107], v[240:241] op_sel:[0,0] op_sel_hi:[1,0]
  v_pk_mul_f32 v[104:105], v[104:105], v[120:121]
  v_pk_mul_f32 v[106:107], v[106:107], v[122:123]
  v_rcp_f32 v246, v246
  v_mfma_f32_16x16x32_bf16 v[136:139], a[80:83], a[232:235], v[136:139]
  s_add_u32 m0, s79, 40960
  v_rcp_f32 v247, v247
  v_lshl_add_u32 v0, v11, 5, v13
  v_mfma_f32_16x16x32_bf16 v[136:139], a[84:87], a[248:251], v[136:139]
  s_add_u32 s92, s92, 262144
  s_add_u32 s93, s92, s89
  buffer_load_dwordx4 v252, s[80:83], s93 offen lds
  v_rcp_f32 v248, v248
  v_mfma_f32_16x16x32_bf16 v[140:143], a[84:87], a[252:255], v[140:143]
  ds_read_b64_tr_b16 a[68:69], v229 offset:8192
  v_cvt_pk_bf16_f32 v82, v96, v97
  v_mfma_f32_16x16x32_bf16 v[140:143], a[80:83], a[236:239], v[140:143]
  s_waitcnt lgkmcnt(3)
  ds_read_b64_tr_b16 a[70:71], v229 offset:12288
  v_cvt_pk_bf16_f32 v83, v98, v99
  v_mfma_f32_16x16x32_bf16 v[156:159], a[88:91], a[236:239], v[156:159]
  buffer_load_dwordx4 v252, s[84:87], s93 offen offset:1024 lds
  buffer_store_dwordx4 v[80:83], v231, s[4:7], s57 offen sc1
  s_add_u32 s57, s57, 16384
  v_exp_f32 v242, v242
  v_mfma_f32_16x16x32_bf16 v[156:159], a[92:95], a[252:255], v[156:159]
  v_exp_f32 v243, v243
  v_add_u32 v4, 0x10000, v0
  v_mfma_f32_16x16x32_bf16 v[152:155], a[92:95], a[248:251], v[152:155]
  ds_read_b64_tr_b16 a[72:73], v229 offset:16384
  ds_read_b64_tr_b16 a[74:75], v229 offset:20480
  v_mfma_f32_16x16x32_bf16 v[152:155], a[88:91], a[232:235], v[152:155]
  v_exp_f32 v244, v244
  v_exp_f32 v245, v245
  v_rcp_f32 v249, v249
  v_pk_fma_f32 v[242:243], v[242:243], v[234:235], v[234:235] op_sel:[0,0,0] op_sel_hi:[1,0,0]
  v_pk_fma_f32 v[244:245], v[244:245], v[234:235], v[234:235] op_sel:[0,0,0] op_sel_hi:[1,0,0]
  v_pk_mul_f32 v[100:101], v[100:101], v[246:247]
  v_pk_mul_f32 v[102:103], v[102:103], v[248:249]
  v_pk_mul_f32 v[246:247], v[108:109], v[240:241] op_sel:[0,1] op_sel_hi:[1,1]
  v_pk_mul_f32 v[248:249], v[110:111], v[240:241] op_sel:[0,1] op_sel_hi:[1,1]
  v_pk_mul_f32 v[108:109], v[108:109], v[124:125]
  v_pk_mul_f32 v[110:111], v[110:111], v[126:127]
  v_rcp_f32 v242, v242
  v_mfma_f32_16x16x32_bf16 v[148:151], a[88:91], a[228:231], v[148:151]
  s_add_u32 m0, s79, 49152
  v_rcp_f32 v243, v243
  v_xor_b32 v11, 1, v12
  v_mfma_f32_16x16x32_bf16 v[148:151], a[92:95], a[244:247], v[148:151]
  s_add_u32 s92, s92, 196608
  s_add_u32 s93, s92, s90
  buffer_load_dwordx4 v252, s[80:83], s93 offen lds
  v_rcp_f32 v244, v244
  v_mfma_f32_16x16x32_bf16 v[144:147], a[92:95], a[240:243], v[144:147]
  ds_read_b64_tr_b16 a[76:77], v229 offset:24576
  v_cvt_pk_bf16_f32 v86, v100, v101
  v_mfma_f32_16x16x32_bf16 v[144:147], a[88:91], a[224:227], v[144:147]
  s_waitcnt lgkmcnt(3)
  ds_read_b64_tr_b16 a[78:79], v229 offset:28672
  v_cvt_pk_bf16_f32 v87, v102, v103
  v_mfma_f32_16x16x32_bf16 v[160:163], a[64:67], a[192:195], v[160:163]
  buffer_load_dwordx4 v252, s[84:87], s93 offen offset:1024 lds
  buffer_store_dwordx4 v[84:87], v231, s[4:7], s58 offen sc1
  s_add_u32 s58, s58, 16384
  v_exp_f32 v246, v246
  v_mfma_f32_16x16x32_bf16 v[160:163], a[68:71], a[208:211], v[160:163]
  v_exp_f32 v247, v247
  v_lshl_add_u32 v1, v11, 5, v13
  v_mfma_f32_16x16x32_bf16 v[164:167], a[68:71], a[212:215], v[164:167]
  ds_read_b64_tr_b16 a[80:81], v229 offset:32768
  ds_read_b64_tr_b16 a[82:83], v229 offset:36864
  v_mfma_f32_16x16x32_bf16 v[164:167], a[64:67], a[196:199], v[164:167]
  v_exp_f32 v248, v248
  v_exp_f32 v249, v249
  v_rcp_f32 v245, v245
  v_pk_fma_f32 v[246:247], v[246:247], v[234:235], v[234:235] op_sel:[0,1,1] op_sel_hi:[1,1,1]
  v_pk_fma_f32 v[248:249], v[248:249], v[234:235], v[234:235] op_sel:[0,1,1] op_sel_hi:[1,1,1]
  v_pk_mul_f32 v[104:105], v[104:105], v[242:243]
  v_pk_mul_f32 v[106:107], v[106:107], v[244:245]
  v_pk_mul_f32 v[242:243], v[128:129], v[238:239] op_sel:[0,0] op_sel_hi:[1,0]
  v_pk_mul_f32 v[244:245], v[130:131], v[238:239] op_sel:[0,0] op_sel_hi:[1,0]
  v_pk_mul_f32 v[128:129], v[128:129], v[144:145]
  v_pk_mul_f32 v[130:131], v[130:131], v[146:147]
  v_rcp_f32 v246, v246
  v_mfma_f32_16x16x32_bf16 v[168:171], a[64:67], a[200:203], v[168:171]
  s_add_u32 m0, s79, 57344
  v_rcp_f32 v247, v247
  v_add_u32 v5, 0x10000, v1
  v_mfma_f32_16x16x32_bf16 v[168:171], a[68:71], a[216:219], v[168:171]
  s_add_u32 s92, s92, 262144
  s_add_u32 s93, s92, s91
  buffer_load_dwordx4 v252, s[80:83], s93 offen lds
  v_rcp_f32 v248, v248
  v_mfma_f32_16x16x32_bf16 v[172:175], a[68:71], a[220:223], v[172:175]
  ds_read_b64_tr_b16 a[84:85], v229 offset:40960
  v_cvt_pk_bf16_f32 v90, v104, v105
  v_mfma_f32_16x16x32_bf16 v[172:175], a[64:67], a[204:207], v[172:175]
  s_waitcnt lgkmcnt(3)
  ds_read_b64_tr_b16 a[86:87], v229 offset:45056
  v_cvt_pk_bf16_f32 v91, v106, v107
  v_mfma_f32_16x16x32_bf16 v[188:191], a[72:75], a[204:207], v[188:191]
  buffer_load_dwordx4 v252, s[84:87], s93 offen offset:1024 lds
  buffer_store_dwordx4 v[88:91], v231, s[4:7], s59 offen sc1
  s_add_u32 s59, s59, 16384
  v_exp_f32 v242, v242
  v_mfma_f32_16x16x32_bf16 v[188:191], a[76:79], a[220:223], v[188:191]
  v_exp_f32 v243, v243
  v_xor_b32 v11, 2, v12
  v_mfma_f32_16x16x32_bf16 v[184:187], a[76:79], a[216:219], v[184:187]
  ds_read_b64_tr_b16 a[88:89], v229 offset:49152
  ds_read_b64_tr_b16 a[90:91], v229 offset:53248
  v_mfma_f32_16x16x32_bf16 v[184:187], a[72:75], a[200:203], v[184:187]
  v_exp_f32 v244, v244
  v_exp_f32 v245, v245
  v_rcp_f32 v249, v249
  v_pk_fma_f32 v[242:243], v[242:243], v[232:233], v[232:233] op_sel:[0,0,0] op_sel_hi:[1,0,0]
  v_pk_fma_f32 v[244:245], v[244:245], v[232:233], v[232:233] op_sel:[0,0,0] op_sel_hi:[1,0,0]
  v_pk_mul_f32 v[108:109], v[108:109], v[246:247]
  v_pk_mul_f32 v[110:111], v[110:111], v[248:249]
  v_pk_mul_f32 v[246:247], v[132:133], v[238:239] op_sel:[0,1] op_sel_hi:[1,1]
  v_pk_mul_f32 v[248:249], v[134:135], v[238:239] op_sel:[0,1] op_sel_hi:[1,1]
  v_pk_mul_f32 v[132:133], v[132:133], v[148:149]
  v_pk_mul_f32 v[134:135], v[134:135], v[150:151]
  v_rcp_f32 v242, v242
  v_mfma_f32_16x16x32_bf16 v[180:183], a[72:75], a[196:199], v[180:183]
  buffer_load_dword v10, v251, s[4:7], s64 offen sc1
  v_rcp_f32 v243, v243
  v_mfma_f32_16x16x32_bf16 v[180:183], a[76:79], a[212:215], v[180:183]
  v_rcp_f32 v244, v244
  v_lshl_add_u32 v2, v11, 5, v13
  v_mfma_f32_16x16x32_bf16 v[176:179], a[76:79], a[208:211], v[176:179]
  ds_read_b64_tr_b16 a[92:93], v229 offset:57344
  v_cvt_pk_bf16_f32 v94, v108, v109
  v_mfma_f32_16x16x32_bf16 v[176:179], a[72:75], a[192:195], v[176:179]
  s_waitcnt lgkmcnt(3)
  ds_read_b64_tr_b16 a[94:95], v229 offset:61440
  v_cvt_pk_bf16_f32 v95, v110, v111
  v_mfma_f32_16x16x32_bf16 v[160:163], a[80:83], a[224:227], v[160:163]
  buffer_store_dwordx4 v[92:95], v231, s[4:7], s60 offen sc1
  s_add_u32 s60, s60, 16384
  v_exp_f32 v246, v246
  v_mfma_f32_16x16x32_bf16 v[160:163], a[84:87], a[240:243], v[160:163]
  v_exp_f32 v247, v247
  v_add_u32 v6, 0x10000, v2
  v_mfma_f32_16x16x32_bf16 v[164:167], a[84:87], a[244:247], v[164:167]
  ds_read_b64_tr_b16 a[64:65], v230 offset:0
  ds_read_b64_tr_b16 a[66:67], v230 offset:4096
  v_mfma_f32_16x16x32_bf16 v[164:167], a[80:83], a[228:231], v[164:167]
  v_exp_f32 v248, v248
  v_exp_f32 v249, v249
  v_rcp_f32 v245, v245
  v_pk_fma_f32 v[246:247], v[246:247], v[232:233], v[232:233] op_sel:[0,1,1] op_sel_hi:[1,1,1]
  v_pk_fma_f32 v[248:249], v[248:249], v[232:233], v[232:233] op_sel:[0,1,1] op_sel_hi:[1,1,1]
  v_pk_mul_f32 v[128:129], v[128:129], v[242:243]
  v_pk_mul_f32 v[130:131], v[130:131], v[244:245]
  v_pk_mul_f32 v[242:243], v[136:137], v[240:241] op_sel:[0,0] op_sel_hi:[1,0]
  v_pk_mul_f32 v[244:245], v[138:139], v[240:241] op_sel:[0,0] op_sel_hi:[1,0]
  v_pk_mul_f32 v[136:137], v[136:137], v[152:153]
  v_pk_mul_f32 v[138:139], v[138:139], v[154:155]
  v_rcp_f32 v246, v246
  v_mfma_f32_16x16x32_bf16 v[168:171], a[80:83], a[232:235], v[168:171]
  v_rcp_f32 v247, v247
  v_xor_b32 v11, 3, v12
  v_mfma_f32_16x16x32_bf16 v[168:171], a[84:87], a[248:251], v[168:171]
  v_rcp_f32 v248, v248
  v_lshl_add_u32 v3, v11, 5, v13
  v_mfma_f32_16x16x32_bf16 v[172:175], a[84:87], a[252:255], v[172:175]
  ds_read_b64_tr_b16 a[68:69], v230 offset:8192
  v_cvt_pk_bf16_f32 v144, v128, v129
  v_mfma_f32_16x16x32_bf16 v[172:175], a[80:83], a[236:239], v[172:175]
  s_waitcnt lgkmcnt(3)
  ds_read_b64_tr_b16 a[70:71], v230 offset:12288
  v_cvt_pk_bf16_f32 v145, v130, v131
  v_mfma_f32_16x16x32_bf16 v[188:191], a[88:91], a[236:239], v[188:191]
  v_exp_f32 v242, v242
  v_add_u32 v7, 0x10000, v3
  v_mfma_f32_16x16x32_bf16 v[188:191], a[92:95], a[252:255], v[188:191]
  v_exp_f32 v243, v243
  v_mfma_f32_16x16x32_bf16 v[184:187], a[92:95], a[248:251], v[184:187]
  ds_read_b64_tr_b16 a[72:73], v230 offset:16384
  ds_read_b64_tr_b16 a[74:75], v230 offset:20480
  v_mfma_f32_16x16x32_bf16 v[184:187], a[88:91], a[232:235], v[184:187]
  v_exp_f32 v244, v244
  v_exp_f32 v245, v245
  v_rcp_f32 v249, v249
  v_pk_fma_f32 v[242:243], v[242:243], v[234:235], v[234:235] op_sel:[0,0,0] op_sel_hi:[1,0,0]
  v_pk_fma_f32 v[244:245], v[244:245], v[234:235], v[234:235] op_sel:[0,0,0] op_sel_hi:[1,0,0]
  v_pk_mul_f32 v[132:133], v[132:133], v[246:247]
  v_pk_mul_f32 v[134:135], v[134:135], v[248:249]
  v_pk_mul_f32 v[246:247], v[140:141], v[240:241] op_sel:[0,1] op_sel_hi:[1,1]
  v_pk_mul_f32 v[248:249], v[142:143], v[240:241] op_sel:[0,1] op_sel_hi:[1,1]
  v_pk_mul_f32 v[140:141], v[140:141], v[156:157]
  v_pk_mul_f32 v[142:143], v[142:143], v[158:159]
  v_rcp_f32 v242, v242
  v_mfma_f32_16x16x32_bf16 v[180:183], a[88:91], a[228:231], v[180:183]
  v_rcp_f32 v243, v243
  v_mfma_f32_16x16x32_bf16 v[180:183], a[92:95], a[244:247], v[180:183]
  v_rcp_f32 v244, v244
  v_mfma_f32_16x16x32_bf16 v[176:179], a[92:95], a[240:243], v[176:179]
  ds_read_b64_tr_b16 a[76:77], v230 offset:24576
  v_cvt_pk_bf16_f32 v148, v132, v133
  v_mfma_f32_16x16x32_bf16 v[176:179], a[88:91], a[224:227], v[176:179]
  s_waitcnt lgkmcnt(3)
  ds_read_b64_tr_b16 a[78:79], v230 offset:28672
  v_cvt_pk_bf16_f32 v149, v134, v135
  v_mfma_f32_16x16x32_bf16 v[192:195], a[64:67], a[192:195], v[192:195]
  v_exp_f32 v246, v246
  v_mfma_f32_16x16x32_bf16 v[192:195], a[68:71], a[208:211], v[192:195]
  v_exp_f32 v247, v247
  v_mfma_f32_16x16x32_bf16 v[196:199], a[68:71], a[212:215], v[196:199]
  ds_read_b64_tr_b16 a[80:81], v230 offset:32768
  ds_read_b64_tr_b16 a[82:83], v230 offset:36864
  v_mfma_f32_16x16x32_bf16 v[196:199], a[64:67], a[196:199], v[196:199]
  v_exp_f32 v248, v248
  v_exp_f32 v249, v249
  v_rcp_f32 v245, v245
  v_pk_fma_f32 v[246:247], v[246:247], v[234:235], v[234:235] op_sel:[0,1,1] op_sel_hi:[1,1,1]
  v_pk_fma_f32 v[248:249], v[248:249], v[234:235], v[234:235] op_sel:[0,1,1] op_sel_hi:[1,1,1]
  v_pk_mul_f32 v[136:137], v[136:137], v[242:243]
  v_pk_mul_f32 v[138:139], v[138:139], v[244:245]
  v_pk_mul_f32 v[242:243], v[160:161], v[238:239] op_sel:[0,0] op_sel_hi:[1,0]
  v_pk_mul_f32 v[244:245], v[162:163], v[238:239] op_sel:[0,0] op_sel_hi:[1,0]
  v_pk_mul_f32 v[160:161], v[160:161], v[176:177]
  v_pk_mul_f32 v[162:163], v[162:163], v[178:179]
  v_rcp_f32 v246, v246
  v_mfma_f32_16x16x32_bf16 v[200:203], a[64:67], a[200:203], v[200:203]
  s_waitcnt vmcnt(1)
  v_cmp_gt_u32 vcc, 16, v10
  s_cbranch_vccz Lp4a_ok
  s_mov_b32 s43, 0x40000
Lp4a_sp:
  s_sleep 10
  buffer_load_dword v10, v251, s[4:7], s64 offen sc1
  s_waitcnt vmcnt(0)
  v_cmp_gt_u32 vcc, 16, v10
  s_cbranch_vccz Lp4a_ok
  s_sub_u32 s43, s43, 1
  s_cmp_lg_u32 s43, 0
  s_cbranch_scc1 Lp4a_sp
Lp4a_ok:
  s_add_u32 s64, s64, 4096
  v_rcp_f32 v247, v247
  v_mfma_f32_16x16x32_bf16 v[200:203], a[68:71], a[216:219], v[200:203]
  s_min_u32 s63, s88, 4096
  s_add_u32 s63, s63, s48
  buffer_load_dwordx4 a[128:131], v8, s[4:7], s63 offen offset:0 sc1
  v_rcp_f32 v248, v248
  v_mfma_f32_16x16x32_bf16 v[204:207], a[68:71], a[220:223], v[204:207]
  ds_read_b64_tr_b16 a[84:85], v230 offset:40960
  v_cvt_pk_bf16_f32 v152, v136, v137
  v_mfma_f32_16x16x32_bf16 v[204:207], a[64:67], a[204:207], v[204:207]
  s_waitcnt lgkmcnt(3)
  ds_read_b64_tr_b16 a[86:87], v230 offset:45056
  v_cvt_pk_bf16_f32 v153, v138, v139
  v_mfma_f32_16x16x32_bf16 v[220:223], a[72:75], a[204:207], v[220:223]
  buffer_load_dwordx4 a[132:135], v9, s[4:7], s63 offen offset:0 sc1
  v_exp_f32 v242, v242
  v_mfma_f32_16x16x32_bf16 v[220:223], a[76:79], a[220:223], v[220:223]
  s_min_u32 s63, s89, 4096
  s_add_u32 s63, s63, s48
  buffer_load_dwordx4 a[136:139], v8, s[4:7], s63 offen offset:1024 sc1
  v_exp_f32 v243, v243
  v_mfma_f32_16x16x32_bf16 v[216:219], a[76:79], a[216:219], v[216:219]
  ds_read_b64_tr_b16 a[88:89], v230 offset:49152
  ds_read_b64_tr_b16 a[90:91], v230 offset:53248
  v_mfma_f32_16x16x32_bf16 v[216:219], a[72:75], a[200:203], v[216:219]
  buffer_load_dwordx4 a[140:143], v9, s[4:7], s63 offen offset:1024 sc1
  v_exp_f32 v244, v244
  v_exp_f32 v245, v245
  v_rcp_f32 v249, v249
  v_pk_fma_f32 v[242:243], v[242:243], v[232:233], v[232:233] op_sel:[0,0,0] op_sel_hi:[1,0,0]
  v_pk_fma_f32 v[244:245], v[244:245], v[232:233], v[232:233] op_sel:[0,0,0] op_sel_hi:[1,0,0]
  v_pk_mul_f32 v[140:141], v[140:141], v[246:247]
  v_pk_mul_f32 v[142:143], v[142:143], v[248:249]
  v_pk_mul_f32 v[246:247], v[164:165], v[238:239] op_sel:[0,1] op_sel_hi:[1,1]
  v_pk_mul_f32 v[248:249], v[166:167], v[238:239] op_sel:[0,1] op_sel_hi:[1,1]
  v_pk_mul_f32 v[164:165], v[164:165], v[180:181]
  v_pk_mul_f32 v[166:167], v[166:167], v[182:183]
  v_rcp_f32 v242, v242
  v_mfma_f32_16x16x32_bf16 v[212:215], a[72:75], a[196:199], v[212:215]
  s_min_u32 s63, s90, 4096
  s_add_u32 s63, s63, s48
  buffer_load_dwordx4 a[144:147], v8, s[4:7], s63 offen offset:2048 sc1
  v_rcp_f32 v243, v243
  v_mfma_f32_16x16x32_bf16 v[212:215], a[76:79], a[212:215], v[212:215]
  buffer_load_dwordx4 a[148:151], v9, s[4:7], s63 offen offset:2048 sc1
  v_rcp_f32 v244, v244
  v_mfma_f32_16x16x32_bf16 v[208:211], a[76:79], a[208:211], v[208:211]
  s_min_u32 s63, s91, 4096
  s_add_u32 s63, s63, s48
  ds_read_b64_tr_b16 a[92:93], v230 offset:57344
  v_cvt_pk_bf16_f32 v156, v140, v141
  v_mfma_f32_16x16x32_bf16 v[208:211], a[72:75], a[192:195], v[208:211]
  s_waitcnt lgkmcnt(3)
  ds_read_b64_tr_b16 a[94:95], v230 offset:61440
  v_cvt_pk_bf16_f32 v157, v142, v143
  v_mfma_f32_16x16x32_bf16 v[192:195], a[80:83], a[224:227], v[192:195]
  buffer_load_dwordx4 a[152:155], v8, s[4:7], s63 offen offset:3072 sc1
  v_exp_f32 v246, v246
  v_mfma_f32_16x16x32_bf16 v[192:195], a[84:87], a[240:243], v[192:195]
  buffer_load_dwordx4 a[156:159], v9, s[4:7], s63 offen offset:3072 sc1
  v_exp_f32 v247, v247
  v_mfma_f32_16x16x32_bf16 v[196:199], a[84:87], a[244:247], v[196:199]
  v_mfma_f32_16x16x32_bf16 v[196:199], a[80:83], a[228:231], v[196:199]
  v_exp_f32 v248, v248
  v_exp_f32 v249, v249
  v_rcp_f32 v245, v245
  v_pk_fma_f32 v[246:247], v[246:247], v[232:233], v[232:233] op_sel:[0,1,1] op_sel_hi:[1,1,1]
  v_pk_fma_f32 v[248:249], v[248:249], v[232:233], v[232:233] op_sel:[0,1,1] op_sel_hi:[1,1,1]
  v_pk_mul_f32 v[160:161], v[160:161], v[242:243]
  v_pk_mul_f32 v[162:163], v[162:163], v[244:245]
  v_pk_mul_f32 v[242:243], v[168:169], v[240:241] op_sel:[0,0] op_sel_hi:[1,0]
  v_pk_mul_f32 v[244:245], v[170:171], v[240:241] op_sel:[0,0] op_sel_hi:[1,0]
  v_pk_mul_f32 v[168:169], v[168:169], v[184:185]
  v_pk_mul_f32 v[170:171], v[170:171], v[186:187]
  v_rcp_f32 v246, v246
  v_mfma_f32_16x16x32_bf16 v[200:203], a[80:83], a[232:235], v[200:203]
  s_waitcnt vmcnt(8)
  s_barrier
  s_cmp_lg_u32 s40, 0
  s_cbranch_scc1 Lsgf18
  v_mov_b32 v250, 1
  s_mov_b64 exec, 1
  buffer_atomic_add v250, v251, s[4:7], s77 offen sc1
  s_mov_b64 exec, -1
Lsgf18:
  s_add_u32 s77, s77, 4096
  v_rcp_f32 v247, v247
  v_mfma_f32_16x16x32_bf16 v[200:203], a[84:87], a[248:251], v[200:203]
  s_add_u32 s48, s48, 4096
  s_min_u32 s63, s88, 4096
  s_add_u32 s63, s63, s48
  buffer_load_dwordx4 a[160:163], v8, s[4:7], s63 offen offset:0 sc1
  v_rcp_f32 v248, v248
  v_mfma_f32_16x16x32_bf16 v[204:207], a[84:87], a[252:255], v[204:207]
  v_cvt_pk_bf16_f32 v146, v160, v161
  v_mfma_f32_16x16x32_bf16 v[204:207], a[80:83], a[236:239], v[204:207]
  v_cvt_pk_bf16_f32 v147, v162, v163
  s_waitcnt lgkmcnt(0)
  v_mfma_f32_16x16x32_bf16 v[220:223], a[88:91], a[236:239], v[220:223]
  buffer_load_dwordx4 a[164:167], v9, s[4:7], s63 offen offset:0 sc1
  buffer_store_dwordx4 v[144:147], v231, s[4:7], s57 offen sc1
  s_add_u32 s57, s57, 16384
  v_exp_f32 v242, v242
  v_mfma_f32_16x16x32_bf16 v[220:223], a[92:95], a[252:255], v[220:223]
  s_min_u32 s63, s89, 4096
  s_add_u32 s63, s63, s48
  buffer_load_dwordx4 a[168:171], v8, s[4:7], s63 offen offset:1024 sc1
  v_exp_f32 v243, v243
  v_mfma_f32_16x16x32_bf16 v[216:219], a[92:95], a[248:251], v[216:219]
  v_mfma_f32_16x16x32_bf16 v[216:219], a[88:91], a[232:235], v[216:219]
  buffer_load_dwordx4 a[172:175], v9, s[4:7], s63 offen offset:1024 sc1
  v_exp_f32 v244, v244
  v_exp_f32 v245, v245
  v_rcp_f32 v249, v249
  v_pk_fma_f32 v[242:243], v[242:243], v[234:235], v[234:235] op_sel:[0,0,0] op_sel_hi:[1,0,0]
  v_pk_fma_f32 v[244:245], v[244:245], v[234:235], v[234:235] op_sel:[0,0,0] op_sel_hi:[1,0,0]
  v_pk_mul_f32 v[164:165], v[164:165], v[246:247]
  v_pk_mul_f32 v[166:167], v[166:167], v[248:249]
  v_pk_mul_f32 v[246:247], v[172:173], v[240:241] op_sel:[0,1] op_sel_hi:[1,1]
  v_pk_mul_f32 v[248:249], v[174:175], v[240:241] op_sel:[0,1] op_sel_hi:[1,1]
  v_pk_mul_f32 v[172:173], v[172:173], v[188:189]
  v_pk_mul_f32 v[174:175], v[174:175], v[190:191]
  v_rcp_f32 v242, v242
  v_mfma_f32_16x16x32_bf16 v[212:215], a[88:91], a[228:231], v[212:215]
  v_mfma_f32_16x16x32_bf16 v[212:215], a[92:95], a[244:247], v[212:215]
  v_mfma_f32_16x16x32_bf16 v[208:211], a[92:95], a[240:243], v[208:211]
  v_mfma_f32_16x16x32_bf16 v[208:211], a[88:91], a[224:227], v[208:211]
  ds_read_b64_tr_b16 a[0:1], v0 offset:0
  ds_read_b64_tr_b16 a[2:3], v0 offset:4096
  ds_read_b64_tr_b16 a[16:17], v0 offset:8192
  ds_read_b64_tr_b16 a[18:19], v0 offset:12288
  ds_read_b64_tr_b16 a[4:5], v1 offset:0
  ds_read_b64_tr_b16 a[6:7], v1 offset:4096
  ds_read_b64_tr_b16 a[20:21], v1 offset:8192
  ds_read_b64_tr_b16 a[22:23], v1 offset:12288
  ds_read_b64_tr_b16 a[8:9], v2 offset:0
  ds_read_b64_tr_b16 a[10:11], v2 offset:4096
  ds_read_b64_tr_b16 a[24:25], v2 offset:8192
  ds_read_b64_tr_b16 a[26:27], v2 offset:12288
  ds_read_b64_tr_b16 a[12:13], v3 offset:0
  ds_read_b64_tr_b16 a[14:15], v3 offset:4096
  ds_read_b64_tr_b16 a[28:29], v3 offset:8192
  ds_read_b64_tr_b16 a[30:31], v3 offset:12288
  s_min_u32 s63, s90, 4096
  s_add_u32 s63, s63, s48
  buffer_load_dwordx4 a[176:179], v8, s[4:7], s63 offen offset:2048 sc1
  buffer_load_dwordx4 a[180:183], v9, s[4:7], s63 offen offset:2048 sc1
  v_rcp_f32 v243, v243
  v_rcp_f32 v244, v244
  v_cvt_pk_bf16_f32 v150, v164, v165
  v_cvt_pk_bf16_f32 v151, v166, v167
  s_min_u32 s63, s91, 4096
  s_add_u32 s63, s63, s48
  buffer_load_dwordx4 a[184:187], v8, s[4:7], s63 offen offset:3072 sc1
  buffer_load_dwordx4 a[188:191], v9, s[4:7], s63 offen offset:3072 sc1
  buffer_store_dwordx4 v[148:151], v231, s[4:7], s58 offen sc1
  s_add_u32 s58, s58, 16384
  v_exp_f32 v246, v246
  v_exp_f32 v247, v247
  v_exp_f32 v248, v248
  v_exp_f32 v249, v249
  v_rcp_f32 v245, v245
  v_pk_fma_f32 v[246:247], v[246:247], v[234:235], v[234:235] op_sel:[0,1,1] op_sel_hi:[1,1,1]
  v_pk_fma_f32 v[248:249], v[248:249], v[234:235], v[234:235] op_sel:[0,1,1] op_sel_hi:[1,1,1]
  v_pk_mul_f32 v[168:169], v[168:169], v[242:243]
  v_pk_mul_f32 v[170:171], v[170:171], v[244:245]
  v_pk_mul_f32 v[242:243], v[192:193], v[238:239] op_sel:[0,0] op_sel_hi:[1,0]
  v_pk_mul_f32 v[244:245], v[194:195], v[238:239] op_sel:[0,0] op_sel_hi:[1,0]
  v_pk_mul_f32 v[192:193], v[192:193], v[208:209]
  v_pk_mul_f32 v[194:195], v[194:195], v[210:211]
  v_rcp_f32 v246, v246
  s_add_u32 m0, s79, 65536
  s_add_u32 s92, s92, 196608
  s_add_u32 s93, s92, s88
  v_rcp_f32 v247, v247
  v_rcp_f32 v248, v248
  v_cvt_pk_bf16_f32 v154, v168, v169
  v_cvt_pk_bf16_f32 v155, v170, v171
  buffer_load_dwordx4 v252, s[80:83], s93 offen lds
  buffer_load_dwordx4 v252, s[84:87], s93 offen offset:1024 lds
  buffer_store_dwordx4 v[152:155], v231, s[4:7], s59 offen sc1
  s_add_u32 s59, s59, 16384
  v_exp_f32 v242, v242
  v_exp_f32 v243, v243
  v_exp_f32 v244, v244
  v_exp_f32 v245, v245
  v_rcp_f32 v249, v249
  v_pk_fma_f32 v[242:243], v[242:243], v[232:233], v[232:233] op_sel:[0,0,0] op_sel_hi:[1,0,0]
  v_pk_fma_f32 v[244:245], v[244:245], v[232:233], v[232:233] op_sel:[0,0,0] op_sel_hi:[1,0,0]
  v_pk_mul_f32 v[172:173], v[172:173], v[246:247]
  v_pk_mul_f32 v[174:175], v[174:175], v[248:249]
  v_pk_mul_f32 v[246:247], v[196:197], v[238:239] op_sel:[0,1] op_sel_hi:[1,1]
  v_pk_mul_f32 v[248:249], v[198:199], v[238:239] op_sel:[0,1] op_sel_hi:[1,1]
  v_pk_mul_f32 v[196:197], v[196:197], v[212:213]
  v_pk_mul_f32 v[198:199], v[198:199], v[214:215]
  v_rcp_f32 v242, v242
  s_add_u32 m0, s79, 73728
  s_add_u32 s92, s92, 262144
  s_add_u32 s93, s92, s89
  v_rcp_f32 v243, v243
  v_rcp_f32 v244, v244
  v_cvt_pk_bf16_f32 v158, v172, v173
  v_cvt_pk_bf16_f32 v159, v174, v175
  buffer_load_dwordx4 v252, s[80:83], s93 offen lds
  buffer_load_dwordx4 v252, s[84:87], s93 offen offset:1024 lds
  buffer_store_dwordx4 v[156:159], v231, s[4:7], s60 offen sc1
  s_add_u32 s60, s60, 16384
  v_exp_f32 v246, v246
  v_exp_f32 v247, v247
  v_exp_f32 v248, v248
  v_exp_f32 v249, v249
  v_rcp_f32 v245, v245
  v_pk_fma_f32 v[246:247], v[246:247], v[232:233], v[232:233] op_sel:[0,1,1] op_sel_hi:[1,1,1]
  v_pk_fma_f32 v[248:249], v[248:249], v[232:233], v[232:233] op_sel:[0,1,1] op_sel_hi:[1,1,1]
  v_pk_mul_f32 v[192:193], v[192:193], v[242:243]
  v_pk_mul_f32 v[194:195], v[194:195], v[244:245]
  v_pk_mul_f32 v[242:243], v[200:201], v[240:241] op_sel:[0,0] op_sel_hi:[1,0]
  v_pk_mul_f32 v[244:245], v[202:203], v[240:241] op_sel:[0,0] op_sel_hi:[1,0]
  v_pk_mul_f32 v[200:201], v[200:201], v[216:217]
  v_pk_mul_f32 v[202:203], v[202:203], v[218:219]
  v_rcp_f32 v246, v246
  s_add_u32 m0, s79, 81920
  s_add_u32 s92, s92, 196608
  s_add_u32 s93, s92, s90
  v_rcp_f32 v247, v247
  v_rcp_f32 v248, v248
  v_cvt_pk_bf16_f32 v208, v192, v193
  v_cvt_pk_bf16_f32 v209, v194, v195
  buffer_load_dwordx4 v252, s[80:83], s93 offen lds
  buffer_load_dwordx4 v252, s[84:87], s93 offen offset:1024 lds
  v_exp_f32 v242, v242
  v_exp_f32 v243, v243
  v_exp_f32 v244, v244
  v_exp_f32 v245, v245
  v_rcp_f32 v249, v249
  v_pk_fma_f32 v[242:243], v[242:243], v[234:235], v[234:235] op_sel:[0,0,0] op_sel_hi:[1,0,0]
  v_pk_fma_f32 v[244:245], v[244:245], v[234:235], v[234:235] op_sel:[0,0,0] op_sel_hi:[1,0,0]
  v_pk_mul_f32 v[196:197], v[196:197], v[246:247]
  v_pk_mul_f32 v[198:199], v[198:199], v[248:249]
  v_pk_mul_f32 v[246:247], v[204:205], v[240:241] op_sel:[0,1] op_sel_hi:[1,1]
  v_pk_mul_f32 v[248:249], v[206:207], v[240:241] op_sel:[0,1] op_sel_hi:[1,1]
  v_pk_mul_f32 v[204:205], v[204:205], v[220:221]
  v_pk_mul_f32 v[206:207], v[206:207], v[222:223]
  v_rcp_f32 v242, v242
  s_add_u32 m0, s79, 90112
  s_add_u32 s92, s92, 262144
  s_add_u32 s93, s92, s91
  v_rcp_f32 v243, v243
  v_rcp_f32 v244, v244
  v_cvt_pk_bf16_f32 v210, v196, v197
  v_cvt_pk_bf16_f32 v211, v198, v199
  buffer_load_dwordx4 v252, s[80:83], s93 offen lds
  buffer_load_dwordx4 v252, s[84:87], s93 offen offset:1024 lds
  s_nop 1
  v_permlane32_swap_b32 v208, v210
  v_permlane32_swap_b32 v209, v211
  buffer_store_dwordx4 v[208:211], v236, s[4:7], s61 offen sc1
  v_exp_f32 v246, v246
  v_exp_f32 v247, v247
  v_exp_f32 v248, v248
  v_exp_f32 v249, v249
  v_rcp_f32 v245, v245
  v_pk_fma_f32 v[246:247], v[246:247], v[234:235], v[234:235] op_sel:[0,1,1] op_sel_hi:[1,1,1]
  v_pk_fma_f32 v[248:249], v[248:249], v[234:235], v[234:235] op_sel:[0,1,1] op_sel_hi:[1,1,1]
  v_pk_mul_f32 v[200:201], v[200:201], v[242:243]
  v_pk_mul_f32 v[202:203], v[202:203], v[244:245]
  v_rcp_f32 v246, v246
  v_rcp_f32 v247, v247
  v_rcp_f32 v248, v248
  v_cvt_pk_bf16_f32 v216, v200, v201
  v_cvt_pk_bf16_f32 v217, v202, v203
  v_rcp_f32 v249, v249
  s_nop 0
  v_pk_mul_f32 v[204:205], v[204:205], v[246:247]
  v_pk_mul_f32 v[206:207], v[206:207], v[248:249]
  v_cvt_pk_bf16_f32 v218, v204, v205
  v_cvt_pk_bf16_f32 v219, v206, v207
  s_nop 1
  v_permlane32_swap_b32 v216, v218
  v_permlane32_swap_b32 v217, v219
  buffer_store_dwordx4 v[216:219], v236, s[4:7], s62 offen sc1
  v_pk_mul_f32 v[32:33], v[250:251], 0 op_sel:[1,0] op_sel_hi:[1,0]
  v_pk_mul_f32 v[34:35], v[250:251], 0 op_sel:[1,0] op_sel_hi:[1,0]
  v_pk_mul_f32 v[36:37], v[250:251], 0 op_sel:[1,0] op_sel_hi:[1,0]
  v_pk_mul_f32 v[38:39], v[250:251], 0 op_sel:[1,0] op_sel_hi:[1,0]
  v_pk_mul_f32 v[40:41], v[250:251], 0 op_sel:[1,0] op_sel_hi:[1,0]
  v_pk_mul_f32 v[42:43], v[250:251], 0 op_sel:[1,0] op_sel_hi:[1,0]
  v_pk_mul_f32 v[44:45], v[250:251], 0 op_sel:[1,0] op_sel_hi:[1,0]
  v_pk_mul_f32 v[46:47], v[250:251], 0 op_sel:[1,0] op_sel_hi:[1,0]
  v_pk_mul_f32 v[48:49], v[250:251], 0 op_sel:[1,0] op_sel_hi:[1,0]
  v_pk_mul_f32 v[50:51], v[250:251], 0 op_sel:[1,0] op_sel_hi:[1,0]
  v_pk_mul_f32 v[52:53], v[250:251], 0 op_sel:[1,0] op_sel_hi:[1,0]
  v_pk_mul_f32 v[54:55], v[250:251], 0 op_sel:[1,0] op_sel_hi:[1,0]
  v_pk_mul_f32 v[56:57], v[250:251], 0 op_sel:[1,0] op_sel_hi:[1,0]
  v_pk_mul_f32 v[58:59], v[250:251], 0 op_sel:[1,0] op_sel_hi:[1,0]
  v_pk_mul_f32 v[60:61], v[250:251], 0 op_sel:[1,0] op_sel_hi:[1,0]
  v_pk_mul_f32 v[62:63], v[250:251], 0 op_sel:[1,0] op_sel_hi:[1,0]
  v_lshlrev_b32 v64, 16, v16
  v_and_b32 v65, 0xffff0000, v16
  v_lshlrev_b32 v66, 16, v17
  v_and_b32 v67, 0xffff0000, v17
  v_lshlrev_b32 v72, 16, v18
  v_and_b32 v73, 0xffff0000, v18
  v_lshlrev_b32 v74, 16, v19
  v_and_b32 v75, 0xffff0000, v19
  v_lshlrev_b32 v80, 16, v20
  v_and_b32 v81, 0xffff0000, v20
  v_lshlrev_b32 v82, 16, v21
  v_and_b32 v83, 0xffff0000, v21
  v_lshlrev_b32 v88, 16, v22
  v_and_b32 v89, 0xffff0000, v22
  v_lshlrev_b32 v90, 16, v23
  v_and_b32 v91, 0xffff0000, v23
  v_lshlrev_b32 v68, 16, v24
  v_and_b32 v69, 0xffff0000, v24
  v_lshlrev_b32 v70, 16, v25
  v_and_b32 v71, 0xffff0000, v25
  v_lshlrev_b32 v76, 16, v26
  v_and_b32 v77, 0xffff0000, v26
  v_lshlrev_b32 v78, 16, v27
  v_and_b32 v79, 0xffff0000, v27
  v_lshlrev_b32 v84, 16, v28
  v_and_b32 v85, 0xffff0000, v28
  v_lshlrev_b32 v86, 16, v29
  v_and_b32 v87, 0xffff0000, v29
  v_lshlrev_b32 v92, 16, v30
  v_and_b32 v93, 0xffff0000, v30
  v_lshlrev_b32 v94, 16, v31
  v_and_b32 v95, 0xffff0000, v31
  s_mov_b32 s56, 2
.p2align 3
Lp4_loop:
  s_waitcnt vmcnt(24) lgkmcnt(8)
  v_mfma_f32_16x16x32_bf16 v[32:35], a[0:3], a[128:131], v[32:35]
  s_waitcnt vmcnt(26)
  s_barrier
  ds_read_b64_tr_b16 a[32:33], v0 offset:1024
  s_add_u32 m0, s79, 98304
  s_add_u32 s92, s92, 196608
  s_cmp_lg_u32 s88, 0
  v_mfma_f32_16x16x32_bf16 v[32:35], a[16:19], a[136:139], v[32:35]
  s_cselect_b32 s93, -2686976, 0
  ds_read_b64_tr_b16 a[34:35], v0 offset:5120
  s_add_u32 s93, s93, s92
  v_mfma_f32_16x16x32_bf16 v[36:39], a[16:19], a[140:143], v[36:39]
  ds_read_b64_tr_b16 a[48:49], v0 offset:9216
  buffer_load_dwordx4 v252, s[80:83], s93 offen lds
  v_mfma_f32_16x16x32_bf16 v[36:39], a[0:3], a[132:135], v[36:39]
  ds_read_b64_tr_b16 a[50:51], v0 offset:13312
  v_mfma_f32_16x16x32_bf16 v[44:47], a[4:7], a[132:135], v[44:47]
  ds_read_b64_tr_b16 a[36:37], v1 offset:1024
  v_mfma_f32_16x16x32_bf16 v[44:47], a[20:23], a[140:143], v[44:47]
  ds_read_b64_tr_b16 a[38:39], v1 offset:5120
  v_mfma_f32_16x16x32_bf16 v[40:43], a[20:23], a[136:139], v[40:43]
  ds_read_b64_tr_b16 a[52:53], v1 offset:9216
  buffer_load_dwordx4 v252, s[84:87], s93 offen offset:1024 lds
  v_mfma_f32_16x16x32_bf16 v[40:43], a[4:7], a[128:131], v[40:43]
  ds_read_b64_tr_b16 a[54:55], v1 offset:13312
  s_waitcnt lgkmcnt(8)
  v_mfma_f32_16x16x32_bf16 v[48:51], a[8:11], a[128:131], v[48:51]
  ds_read_b64_tr_b16 a[40:41], v2 offset:1024
  v_mfma_f32_16x16x32_bf16 v[48:51], a[24:27], a[136:139], v[48:51]
  s_add_u32 s48, s48, 4096
  ds_read_b64_tr_b16 a[42:43], v2 offset:5120
  s_min_u32 s63, s88, 4096
  v_mfma_f32_16x16x32_bf16 v[52:55], a[24:27], a[140:143], v[52:55]
  s_add_u32 s63, s63, s48
  ds_read_b64_tr_b16 a[56:57], v2 offset:9216
  buffer_load_dwordx4 a[192:195], v8, s[4:7], s63 offen offset:0 sc1
  v_mfma_f32_16x16x32_bf16 v[52:55], a[8:11], a[132:135], v[52:55]
  ds_read_b64_tr_b16 a[58:59], v2 offset:13312
  v_mfma_f32_16x16x32_bf16 v[60:63], a[12:15], a[132:135], v[60:63]
  ds_read_b64_tr_b16 a[44:45], v3 offset:1024
  v_mfma_f32_16x16x32_bf16 v[60:63], a[28:31], a[140:143], v[60:63]
  ds_read_b64_tr_b16 a[46:47], v3 offset:5120
  v_mfma_f32_16x16x32_bf16 v[56:59], a[28:31], a[136:139], v[56:59]
  ds_read_b64_tr_b16 a[60:61], v3 offset:9216
  buffer_load_dwordx4 a[196:199], v9, s[4:7], s63 offen offset:0 sc1
  v_mfma_f32_16x16x32_bf16 v[56:59], a[12:15], a[128:131], v[56:59]
  ds_read_b64_tr_b16 a[62:63], v3 offset:13312
  s_waitcnt lgkmcnt(8)
  v_mfma_f32_16x16x32_bf16 v[64:67], a[32:35], a[128:131], v[64:67]
  s_add_u32 m0, s79, 106496
  ds_read_b64_tr_b16 a[0:1], v0 offset:16384
  buffer_load_dword v10, v251, s[4:7], s64 offen sc1
  s_add_u32 s92, s92, 262144
  s_cmp_lg_u32 s89, 0
  v_mfma_f32_16x16x32_bf16 v[64:67], a[48:51], a[136:139], v[64:67]
  s_cselect_b32 s93, -2686976, 0
  ds_read_b64_tr_b16 a[2:3], v0 offset:20480
  s_add_u32 s93, s93, s92
  v_mfma_f32_16x16x32_bf16 v[68:71], a[48:51], a[140:143], v[68:71]
  ds_read_b64_tr_b16 a[16:17], v0 offset:24576
  buffer_load_dwordx4 v252, s[80:83], s93 offen lds
  v_mfma_f32_16x16x32_bf16 v[68:71], a[32:35], a[132:135], v[68:71]
  ds_read_b64_tr_b16 a[18:19], v0 offset:28672
  v_mfma_f32_16x16x32_bf16 v[76:79], a[36:39], a[132:135], v[76:79]
  ds_read_b64_tr_b16 a[4:5], v1 offset:16384
  v_mfma_f32_16x16x32_bf16 v[76:79], a[52:55], a[140:143], v[76:79]
  ds_read_b64_tr_b16 a[6:7], v1 offset:20480
  v_mfma_f32_16x16x32_bf16 v[72:75], a[52:55], a[136:139], v[72:75]
  ds_read_b64_tr_b16 a[20:21], v1 offset:24576
  buffer_load_dwordx4 v252, s[84:87], s93 offen offset:1024 lds
  v_mfma_f32_16x16x32_bf16 v[72:75], a[36:39], a[128:131], v[72:75]
  ds_read_b64_tr_b16 a[22:23], v1 offset:28672
  s_waitcnt lgkmcnt(8)
  v_mfma_f32_16x16x32_bf16 v[80:83], a[40:43], a[128:131], v[80:83]
  ds_read_b64_tr_b16 a[8:9], v2 offset:16384
  v_mfma_f32_16x16x32_bf16 v[80:83], a[56:59], a[136:139], v[80:83]
  s_min_u32 s63, s89, 4096
  ds_read_b64_tr_b16 a[10:11], v2 offset:20480
  s_add_u32 s63, s63, s48
  v_mfma_f32_16x16x32_bf16 v[84:87], a[56:59], a[140:143], v[84:87]
  ds_read_b64_tr_b16 a[24:25], v2 offset:24576
  buffer_load_dwordx4 a[200:203], v8, s[4:7], s63 offen offset:1024 sc1
  v_mfma_f32_16x16x32_bf16 v[84:87], a[40:43], a[132:135], v[84:87]
  ds_read_b64_tr_b16 a[26:27], v2 offset:28672
  v_mfma_f32_16x16x32_bf16 v[92:95], a[44:47], a[132:135], v[92:95]
  ds_read_b64_tr_b16 a[12:13], v3 offset:16384
  v_mfma_f32_16x16x32_bf16 v[92:95], a[60:63], a[140:143], v[92:95]
  ds_read_b64_tr_b16 a[14:15], v3 offset:20480
  v_mfma_f32_16x16x32_bf16 v[88:91], a[60:63], a[136:139], v[88:91]
  ds_read_b64_tr_b16 a[28:29], v3 offset:24576
  buffer_load_dwordx4 a[204:207], v9, s[4:7], s63 offen offset:1024 sc1
  v_mfma_f32_16x16x32_bf16 v[88:91], a[44:47], a[128:131], v[88:91]
  ds_read_b64_tr_b16 a[30:31], v3 offset:28672
  s_waitcnt vmcnt(25) lgkmcnt(8)
  v_mfma_f32_16x16x32_bf16 v[32:35], a[0:3], a[144:147], v[32:35]
  s_add_u32 m0, s79, 114688
  ds_read_b64_tr_b16 a[32:33], v0 offset:17408
  s_add_u32 s92, s92, 196608
  s_cmp_lg_u32 s90, 0
  v_mfma_f32_16x16x32_bf16 v[32:35], a[16:19], a[152:155], v[32:35]
  s_cselect_b32 s93, -2686976, 0
  ds_read_b64_tr_b16 a[34:35], v0 offset:21504
  s_add_u32 s93, s93, s92
  v_mfma_f32_16x16x32_bf16 v[36:39], a[16:19], a[156:159], v[36:39]
  ds_read_b64_tr_b16 a[48:49], v0 offset:25600
  buffer_load_dwordx4 v252, s[80:83], s93 offen lds
  v_mfma_f32_16x16x32_bf16 v[36:39], a[0:3], a[148:151], v[36:39]
  ds_read_b64_tr_b16 a[50:51], v0 offset:29696
  v_mfma_f32_16x16x32_bf16 v[44:47], a[4:7], a[148:151], v[44:47]
  ds_read_b64_tr_b16 a[36:37], v1 offset:17408
  v_mfma_f32_16x16x32_bf16 v[44:47], a[20:23], a[156:159], v[44:47]
  ds_read_b64_tr_b16 a[38:39], v1 offset:21504
  v_mfma_f32_16x16x32_bf16 v[40:43], a[20:23], a[152:155], v[40:43]
  ds_read_b64_tr_b16 a[52:53], v1 offset:25600
  buffer_load_dwordx4 v252, s[84:87], s93 offen offset:1024 lds
  v_mfma_f32_16x16x32_bf16 v[40:43], a[4:7], a[144:147], v[40:43]
  ds_read_b64_tr_b16 a[54:55], v1 offset:29696
  s_waitcnt lgkmcnt(8)
  v_mfma_f32_16x16x32_bf16 v[48:51], a[8:11], a[144:147], v[48:51]
  ds_read_b64_tr_b16 a[40:41], v2 offset:17408
  v_mfma_f32_16x16x32_bf16 v[48:51], a[24:27], a[152:155], v[48:51]
  s_min_u32 s63, s90, 4096
  ds_read_b64_tr_b16 a[42:43], v2 offset:21504
  s_add_u32 s63, s63, s48
  v_mfma_f32_16x16x32_bf16 v[52:55], a[24:27], a[156:159], v[52:55]
  ds_read_b64_tr_b16 a[56:57], v2 offset:25600
  buffer_load_dwordx4 a[208:211], v8, s[4:7], s63 offen offset:2048 sc1
  v_mfma_f32_16x16x32_bf16 v[52:55], a[8:11], a[148:151], v[52:55]
  ds_read_b64_tr_b16 a[58:59], v2 offset:29696
  v_mfma_f32_16x16x32_bf16 v[60:63], a[12:15], a[148:151], v[60:63]
  ds_read_b64_tr_b16 a[44:45], v3 offset:17408
  v_mfma_f32_16x16x32_bf16 v[60:63], a[28:31], a[156:159], v[60:63]
  ds_read_b64_tr_b16 a[46:47], v3 offset:21504
  v_mfma_f32_16x16x32_bf16 v[56:59], a[28:31], a[152:155], v[56:59]
  ds_read_b64_tr_b16 a[60:61], v3 offset:25600
  buffer_load_dwordx4 a[212:215], v9, s[4:7], s63 offen offset:2048 sc1
  v_mfma_f32_16x16x32_bf16 v[56:59], a[12:15], a[144:147], v[56:59]
  ds_read_b64_tr_b16 a[62:63], v3 offset:29696
  s_waitcnt lgkmcnt(8)
  v_mfma_f32_16x16x32_bf16 v[64:67], a[32:35], a[144:147], v[64:67]
  s_add_u32 m0, s79, 122880
  ds_read_b64_tr_b16 a[0:1], v0 offset:32768
  s_add_u32 s92, s92, 262144
  s_cmp_lg_u32 s91, 0
  v_mfma_f32_16x16x32_bf16 v[64:67], a[48:51], a[152:155], v[64:67]
  s_cselect_b32 s93, -2686976, 0
  ds_read_b64_tr_b16 a[2:3], v0 offset:36864
  s_add_u32 s93, s93, s92
  v_mfma_f32_16x16x32_bf16 v[68:71], a[48:51], a[156:159], v[68:71]
  ds_read_b64_tr_b16 a[16:17], v0 offset:40960
  buffer_load_dwordx4 v252, s[80:83], s93 offen lds
  v_mfma_f32_16x16x32_bf16 v[68:71], a[32:35], a[148:151], v[68:71]
  ds_read_b64_tr_b16 a[18:19], v0 offset:45056
  v_mfma_f32_16x16x32_bf16 v[76:79], a[36:39], a[148:151], v[76:79]
  ds_read_b64_tr_b16 a[4:5], v1 offset:32768
  v_mfma_f32_16x16x32_bf16 v[76:79], a[52:55], a[156:159], v[76:79]
  ds_read_b64_tr_b16 a[6:7], v1 offset:36864
  v_mfma_f32_16x16x32_bf16 v[72:75], a[52:55], a[152:155], v[72:75]
  ds_read_b64_tr_b16 a[20:21], v1 offset:40960
  buffer_load_dwordx4 v252, s[84:87], s93 offen offset:1024 lds
  v_mfma_f32_16x16x32_bf16 v[72:75], a[36:39], a[144:147], v[72:75]
  ds_read_b64_tr_b16 a[22:23], v1 offset:45056
  s_waitcnt lgkmcnt(8)
  v_mfma_f32_16x16x32_bf16 v[80:83], a[40:43], a[144:147], v[80:83]
  ds_read_b64_tr_b16 a[8:9], v2 offset:32768
  v_mfma_f32_16x16x32_bf16 v[80:83], a[56:59], a[152:155], v[80:83]
  s_min_u32 s63, s91, 4096
  ds_read_b64_tr_b16 a[10:11], v2 offset:36864
  s_add_u32 s63, s63, s48
  v_mfma_f32_16x16x32_bf16 v[84:87], a[56:59], a[156:159], v[84:87]
  ds_read_b64_tr_b16 a[24:25], v2 offset:40960
  buffer_load_dwordx4 a[216:219], v8, s[4:7], s63 offen offset:3072 sc1
  v_mfma_f32_16x16x32_bf16 v[84:87], a[40:43], a[148:151], v[84:87]
  ds_read_b64_tr_b16 a[26:27], v2 offset:45056
  v_mfma_f32_16x16x32_bf16 v[92:95], a[44:47], a[148:151], v[92:95]
  ds_read_b64_tr_b16 a[12:13], v3 offset:32768
  v_mfma_f32_16x16x32_bf16 v[92:95], a[60:63], a[156:159], v[92:95]
  ds_read_b64_tr_b16 a[14:15], v3 offset:36864
  v_mfma_f32_16x16x32_bf16 v[88:91], a[60:63], a[152:155], v[88:91]
  ds_read_b64_tr_b16 a[28:29], v3 offset:40960
  buffer_load_dwordx4 a[220:223], v9, s[4:7], s63 offen offset:3072 sc1
  v_mfma_f32_16x16x32_bf16 v[88:91], a[44:47], a[144:147], v[88:91]
  ds_read_b64_tr_b16 a[30:31], v3 offset:45056
  s_waitcnt vmcnt(25) lgkmcnt(8)
  v_mfma_f32_16x16x32_bf16 v[32:35], a[0:3], a[160:163], v[32:35]
  s_waitcnt vmcnt(24)
  s_barrier
  ds_read_b64_tr_b16 a[32:33], v0 offset:33792
  s_waitcnt vmcnt(12)
  v_cmp_gt_u32 vcc, 16, v10
  s_cbranch_vccz Lp4b_ok
  s_mov_b32 s43, 0x40000
Lp4b_sp:
  s_sleep 10
  buffer_load_dword v10, v251, s[4:7], s64 offen sc1
  s_waitcnt vmcnt(0)
  v_cmp_gt_u32 vcc, 16, v10
  s_cbranch_vccz Lp4b_ok
  s_sub_u32 s43, s43, 1
  s_cmp_lg_u32 s43, 0
  s_cbranch_scc1 Lp4b_sp
Lp4b_ok:
  s_add_u32 s64, s64, 4096
  v_mfma_f32_16x16x32_bf16 v[32:35], a[16:19], a[168:171], v[32:35]
  s_add_u32 m0, s79, 0
  ds_read_b64_tr_b16 a[34:35], v0 offset:37888
  s_add_u32 s92, s92, -3407872
  v_mfma_f32_16x16x32_bf16 v[36:39], a[16:19], a[172:175], v[36:39]
  s_add_u32 s93, s92, s88
  ds_read_b64_tr_b16 a[48:49], v0 offset:41984
  buffer_load_dwordx4 v252, s[80:83], s93 offen lds
  v_mfma_f32_16x16x32_bf16 v[36:39], a[0:3], a[164:167], v[36:39]
  ds_read_b64_tr_b16 a[50:51], v0 offset:46080
  v_mfma_f32_16x16x32_bf16 v[44:47], a[4:7], a[164:167], v[44:47]
  ds_read_b64_tr_b16 a[36:37], v1 offset:33792
  v_mfma_f32_16x16x32_bf16 v[44:47], a[20:23], a[172:175], v[44:47]
  ds_read_b64_tr_b16 a[38:39], v1 offset:37888
  v_mfma_f32_16x16x32_bf16 v[40:43], a[20:23], a[168:171], v[40:43]
  ds_read_b64_tr_b16 a[52:53], v1 offset:41984
  buffer_load_dwordx4 v252, s[84:87], s93 offen offset:1024 lds
  v_mfma_f32_16x16x32_bf16 v[40:43], a[4:7], a[160:163], v[40:43]
  ds_read_b64_tr_b16 a[54:55], v1 offset:46080
  s_waitcnt lgkmcnt(8)
  v_mfma_f32_16x16x32_bf16 v[48:51], a[8:11], a[160:163], v[48:51]
  ds_read_b64_tr_b16 a[40:41], v2 offset:33792
  v_mfma_f32_16x16x32_bf16 v[48:51], a[24:27], a[168:171], v[48:51]
  s_add_u32 s48, s48, 4096
  ds_read_b64_tr_b16 a[42:43], v2 offset:37888
  s_min_u32 s63, s88, 4096
  v_mfma_f32_16x16x32_bf16 v[52:55], a[24:27], a[172:175], v[52:55]
  s_add_u32 s63, s63, s48
  ds_read_b64_tr_b16 a[56:57], v2 offset:41984
  buffer_load_dwordx4 a[224:227], v8, s[4:7], s63 offen offset:0 sc1
  v_mfma_f32_16x16x32_bf16 v[52:55], a[8:11], a[164:167], v[52:55]
  ds_read_b64_tr_b16 a[58:59], v2 offset:46080
  v_mfma_f32_16x16x32_bf16 v[60:63], a[12:15], a[164:167], v[60:63]
  ds_read_b64_tr_b16 a[44:45], v3 offset:33792
  v_mfma_f32_16x16x32_bf16 v[60:63], a[28:31], a[172:175], v[60:63]
  ds_read_b64_tr_b16 a[46:47], v3 offset:37888
  v_mfma_f32_16x16x32_bf16 v[56:59], a[28:31], a[168:171], v[56:59]
  ds_read_b64_tr_b16 a[60:61], v3 offset:41984
  buffer_load_dwordx4 a[228:231], v9, s[4:7], s63 offen offset:0 sc1
  v_mfma_f32_16x16x32_bf16 v[56:59], a[12:15], a[160:163], v[56:59]
  ds_read_b64_tr_b16 a[62:63], v3 offset:46080
  s_waitcnt lgkmcnt(8)
  v_mfma_f32_16x16x32_bf16 v[64:67], a[32:35], a[160:163], v[64:67]
  ds_read_b64_tr_b16 a[0:1], v0 offset:49152
  s_add_u32 m0, s79, 8192
  v_mfma_f32_16x16x32_bf16 v[64:67], a[48:51], a[168:171], v[64:67]
  s_add_u32 s92, s92, 262144
  ds_read_b64_tr_b16 a[2:3], v0 offset:53248
  s_add_u32 s93, s92, s89
  v_mfma_f32_16x16x32_bf16 v[68:71], a[48:51], a[172:175], v[68:71]
  ds_read_b64_tr_b16 a[16:17], v0 offset:57344
  buffer_load_dwordx4 v252, s[80:83], s93 offen lds
  v_mfma_f32_16x16x32_bf16 v[68:71], a[32:35], a[164:167], v[68:71]
  ds_read_b64_tr_b16 a[18:19], v0 offset:61440
  v_mfma_f32_16x16x32_bf16 v[76:79], a[36:39], a[164:167], v[76:79]
  ds_read_b64_tr_b16 a[4:5], v1 offset:49152
  v_mfma_f32_16x16x32_bf16 v[76:79], a[52:55], a[172:175], v[76:79]
  ds_read_b64_tr_b16 a[6:7], v1 offset:53248
  v_mfma_f32_16x16x32_bf16 v[72:75], a[52:55], a[168:171], v[72:75]
  ds_read_b64_tr_b16 a[20:21], v1 offset:57344
  buffer_load_dwordx4 v252, s[84:87], s93 offen offset:1024 lds
  v_mfma_f32_16x16x32_bf16 v[72:75], a[36:39], a[160:163], v[72:75]
  ds_read_b64_tr_b16 a[22:23], v1 offset:61440
  s_waitcnt lgkmcnt(8)
  v_mfma_f32_16x16x32_bf16 v[80:83], a[40:43], a[160:163], v[80:83]
  ds_read_b64_tr_b16 a[8:9], v2 offset:49152
  v_mfma_f32_16x16x32_bf16 v[80:83], a[56:59], a[168:171], v[80:83]
  s_min_u32 s63, s89, 4096
  ds_read_b64_tr_b16 a[10:11], v2 offset:53248
  s_add_u32 s63, s63, s48
  v_mfma_f32_16x16x32_bf16 v[84:87], a[56:59], a[172:175], v[84:87]
  ds_read_b64_tr_b16 a[24:25], v2 offset:57344
  buffer_load_dwordx4 a[232:235], v8, s[4:7], s63 offen offset:1024 sc1
  v_mfma_f32_16x16x32_bf16 v[84:87], a[40:43], a[164:167], v[84:87]
  ds_read_b64_tr_b16 a[26:27], v2 offset:61440
  v_mfma_f32_16x16x32_bf16 v[92:95], a[44:47], a[164:167], v[92:95]
  ds_read_b64_tr_b16 a[12:13], v3 offset:49152
  v_mfma_f32_16x16x32_bf16 v[92:95], a[60:63], a[172:175], v[92:95]
  ds_read_b64_tr_b16 a[14:15], v3 offset:53248
  v_mfma_f32_16x16x32_bf16 v[88:91], a[60:63], a[168:171], v[88:91]
  ds_read_b64_tr_b16 a[28:29], v3 offset:57344
  buffer_load_dwordx4 a[236:239], v9, s[4:7], s63 offen offset:1024 sc1
  v_mfma_f32_16x16x32_bf16 v[88:91], a[44:47], a[160:163], v[88:91]
  ds_read_b64_tr_b16 a[30:31], v3 offset:61440
  s_waitcnt vmcnt(25) lgkmcnt(8)
  v_mfma_f32_16x16x32_bf16 v[32:35], a[0:3], a[176:179], v[32:35]
  ds_read_b64_tr_b16 a[32:33], v0 offset:50176
  s_add_u32 m0, s79, 16384
  v_mfma_f32_16x16x32_bf16 v[32:35], a[16:19], a[184:187], v[32:35]
  s_add_u32 s92, s92, 196608
  ds_read_b64_tr_b16 a[34:35], v0 offset:54272
  s_add_u32 s93, s92, s90
  v_mfma_f32_16x16x32_bf16 v[36:39], a[16:19], a[188:191], v[36:39]
  ds_read_b64_tr_b16 a[48:49], v0 offset:58368
  buffer_load_dwordx4 v252, s[80:83], s93 offen lds
  v_mfma_f32_16x16x32_bf16 v[36:39], a[0:3], a[180:183], v[36:39]
  ds_read_b64_tr_b16 a[50:51], v0 offset:62464
  v_mfma_f32_16x16x32_bf16 v[44:47], a[4:7], a[180:183], v[44:47]
  ds_read_b64_tr_b16 a[36:37], v1 offset:50176
  v_mfma_f32_16x16x32_bf16 v[44:47], a[20:23], a[188:191], v[44:47]
  ds_read_b64_tr_b16 a[38:39], v1 offset:54272
  v_mfma_f32_16x16x32_bf16 v[40:43], a[20:23], a[184:187], v[40:43]
  ds_read_b64_tr_b16 a[52:53], v1 offset:58368
  buffer_load_dwordx4 v252, s[84:87], s93 offen offset:1024 lds
  v_mfma_f32_16x16x32_bf16 v[40:43], a[4:7], a[176:179], v[40:43]
  ds_read_b64_tr_b16 a[54:55], v1 offset:62464
  s_waitcnt lgkmcnt(8)
  v_mfma_f32_16x16x32_bf16 v[48:51], a[8:11], a[176:179], v[48:51]
  ds_read_b64_tr_b16 a[40:41], v2 offset:50176
  v_mfma_f32_16x16x32_bf16 v[48:51], a[24:27], a[184:187], v[48:51]
  s_min_u32 s63, s90, 4096
  ds_read_b64_tr_b16 a[42:43], v2 offset:54272
  s_add_u32 s63, s63, s48
  v_mfma_f32_16x16x32_bf16 v[52:55], a[24:27], a[188:191], v[52:55]
  ds_read_b64_tr_b16 a[56:57], v2 offset:58368
  buffer_load_dwordx4 a[240:243], v8, s[4:7], s63 offen offset:2048 sc1
  v_mfma_f32_16x16x32_bf16 v[52:55], a[8:11], a[180:183], v[52:55]
  ds_read_b64_tr_b16 a[58:59], v2 offset:62464
  v_mfma_f32_16x16x32_bf16 v[60:63], a[12:15], a[180:183], v[60:63]
  ds_read_b64_tr_b16 a[44:45], v3 offset:50176
  v_mfma_f32_16x16x32_bf16 v[60:63], a[28:31], a[188:191], v[60:63]
  ds_read_b64_tr_b16 a[46:47], v3 offset:54272
  v_mfma_f32_16x16x32_bf16 v[56:59], a[28:31], a[184:187], v[56:59]
  ds_read_b64_tr_b16 a[60:61], v3 offset:58368
  buffer_load_dwordx4 a[244:247], v9, s[4:7], s63 offen offset:2048 sc1
  v_mfma_f32_16x16x32_bf16 v[56:59], a[12:15], a[176:179], v[56:59]
  ds_read_b64_tr_b16 a[62:63], v3 offset:62464
  s_waitcnt lgkmcnt(8)
  v_mfma_f32_16x16x32_bf16 v[64:67], a[32:35], a[176:179], v[64:67]
  ds_read_b64_tr_b16 a[0:1], v4 offset:0
  s_add_u32 m0, s79, 24576
  v_mfma_f32_16x16x32_bf16 v[64:67], a[48:51], a[184:187], v[64:67]
  s_add_u32 s92, s92, 262144
  ds_read_b64_tr_b16 a[2:3], v4 offset:4096
  s_add_u32 s93, s92, s91
  v_mfma_f32_16x16x32_bf16 v[68:71], a[48:51], a[188:191], v[68:71]
  ds_read_b64_tr_b16 a[16:17], v4 offset:8192
  buffer_load_dwordx4 v252, s[80:83], s93 offen lds
  v_mfma_f32_16x16x32_bf16 v[68:71], a[32:35], a[180:183], v[68:71]
  ds_read_b64_tr_b16 a[18:19], v4 offset:12288
  v_mfma_f32_16x16x32_bf16 v[76:79], a[36:39], a[180:183], v[76:79]
  ds_read_b64_tr_b16 a[4:5], v5 offset:0
  v_mfma_f32_16x16x32_bf16 v[76:79], a[52:55], a[188:191], v[76:79]
  ds_read_b64_tr_b16 a[6:7], v5 offset:4096
  v_mfma_f32_16x16x32_bf16 v[72:75], a[52:55], a[184:187], v[72:75]
  ds_read_b64_tr_b16 a[20:21], v5 offset:8192
  buffer_load_dwordx4 v252, s[84:87], s93 offen offset:1024 lds
  v_mfma_f32_16x16x32_bf16 v[72:75], a[36:39], a[176:179], v[72:75]
  ds_read_b64_tr_b16 a[22:23], v5 offset:12288
  s_waitcnt lgkmcnt(8)
  v_mfma_f32_16x16x32_bf16 v[80:83], a[40:43], a[176:179], v[80:83]
  ds_read_b64_tr_b16 a[8:9], v6 offset:0
  v_mfma_f32_16x16x32_bf16 v[80:83], a[56:59], a[184:187], v[80:83]
  s_min_u32 s63, s91, 4096
  ds_read_b64_tr_b16 a[10:11], v6 offset:4096
  s_add_u32 s63, s63, s48
  v_mfma_f32_16x16x32_bf16 v[84:87], a[56:59], a[188:191], v[84:87]
  ds_read_b64_tr_b16 a[24:25], v6 offset:8192
  buffer_load_dwordx4 a[248:251], v8, s[4:7], s63 offen offset:3072 sc1
  v_mfma_f32_16x16x32_bf16 v[84:87], a[40:43], a[180:183], v[84:87]
  ds_read_b64_tr_b16 a[26:27], v6 offset:12288
  v_mfma_f32_16x16x32_bf16 v[92:95], a[44:47], a[180:183], v[92:95]
  ds_read_b64_tr_b16 a[12:13], v7 offset:0
  v_mfma_f32_16x16x32_bf16 v[92:95], a[60:63], a[188:191], v[92:95]
  ds_read_b64_tr_b16 a[14:15], v7 offset:4096
  v_mfma_f32_16x16x32_bf16 v[88:91], a[60:63], a[184:187], v[88:91]
  ds_read_b64_tr_b16 a[28:29], v7 offset:8192
  buffer_load_dwordx4 a[252:255], v9, s[4:7], s63 offen offset:3072 sc1
  v_mfma_f32_16x16x32_bf16 v[88:91], a[44:47], a[176:179], v[88:91]
  ds_read_b64_tr_b16 a[30:31], v7 offset:12288
  s_waitcnt vmcnt(24) lgkmcnt(8)
  v_mfma_f32_16x16x32_bf16 v[32:35], a[0:3], a[192:195], v[32:35]
  s_waitcnt vmcnt(26)
  s_barrier
  s_xor_b32 s43, s56, 2
  s_or_b32 s43, s43, s40
  s_cbranch_scc1 Lp3_sgl
  v_mov_b32 v250, 1
  s_mov_b64 exec, 1
  buffer_atomic_add v250, v251, s[4:7], s77 offen sc1
  s_mov_b64 exec, -1
Lp3_sgl:
  ds_read_b64_tr_b16 a[32:33], v4 offset:1024
  v_mfma_f32_16x16x32_bf16 v[32:35], a[16:19], a[200:203], v[32:35]
  s_add_u32 m0, s79, 32768
  ds_read_b64_tr_b16 a[34:35], v4 offset:5120
  s_add_u32 s92, s92, 196608
  v_mfma_f32_16x16x32_bf16 v[36:39], a[16:19], a[204:207], v[36:39]
  s_add_u32 s93, s92, s88
  ds_read_b64_tr_b16 a[48:49], v4 offset:9216
  buffer_load_dwordx4 v252, s[80:83], s93 offen lds
  v_mfma_f32_16x16x32_bf16 v[36:39], a[0:3], a[196:199], v[36:39]
  ds_read_b64_tr_b16 a[50:51], v4 offset:13312
  v_mfma_f32_16x16x32_bf16 v[44:47], a[4:7], a[196:199], v[44:47]
  ds_read_b64_tr_b16 a[36:37], v5 offset:1024
  v_mfma_f32_16x16x32_bf16 v[44:47], a[20:23], a[204:207], v[44:47]
  ds_read_b64_tr_b16 a[38:39], v5 offset:5120
  v_mfma_f32_16x16x32_bf16 v[40:43], a[20:23], a[200:203], v[40:43]
  ds_read_b64_tr_b16 a[52:53], v5 offset:9216
  buffer_load_dwordx4 v252, s[84:87], s93 offen offset:1024 lds
  v_mfma_f32_16x16x32_bf16 v[40:43], a[4:7], a[192:195], v[40:43]
  ds_read_b64_tr_b16 a[54:55], v5 offset:13312
  s_waitcnt lgkmcnt(8)
  v_mfma_f32_16x16x32_bf16 v[48:51], a[8:11], a[192:195], v[48:51]
  ds_read_b64_tr_b16 a[40:41], v6 offset:1024
  v_mfma_f32_16x16x32_bf16 v[48:51], a[24:27], a[200:203], v[48:51]
  s_add_u32 s48, s48, 4096
  ds_read_b64_tr_b16 a[42:43], v6 offset:5120
  s_min_u32 s63, s88, 4096
  v_mfma_f32_16x16x32_bf16 v[52:55], a[24:27], a[204:207], v[52:55]
  s_add_u32 s63, s63, s48
  ds_read_b64_tr_b16 a[56:57], v6 offset:9216
  buffer_load_dwordx4 a[128:131], v8, s[4:7], s63 offen offset:0 sc1
  v_mfma_f32_16x16x32_bf16 v[52:55], a[8:11], a[196:199], v[52:55]
  ds_read_b64_tr_b16 a[58:59], v6 offset:13312
  v_mfma_f32_16x16x32_bf16 v[60:63], a[12:15], a[196:199], v[60:63]
  ds_read_b64_tr_b16 a[44:45], v7 offset:1024
  v_mfma_f32_16x16x32_bf16 v[60:63], a[28:31], a[204:207], v[60:63]
  ds_read_b64_tr_b16 a[46:47], v7 offset:5120
  v_mfma_f32_16x16x32_bf16 v[56:59], a[28:31], a[200:203], v[56:59]
  ds_read_b64_tr_b16 a[60:61], v7 offset:9216
  buffer_load_dwordx4 a[132:135], v9, s[4:7], s63 offen offset:0 sc1
  v_mfma_f32_16x16x32_bf16 v[56:59], a[12:15], a[192:195], v[56:59]
  ds_read_b64_tr_b16 a[62:63], v7 offset:13312
  s_waitcnt lgkmcnt(8)
  v_mfma_f32_16x16x32_bf16 v[64:67], a[32:35], a[192:195], v[64:67]
  ds_read_b64_tr_b16 a[0:1], v4 offset:16384
  s_add_u32 m0, s79, 40960
  v_mfma_f32_16x16x32_bf16 v[64:67], a[48:51], a[200:203], v[64:67]
  s_add_u32 s92, s92, 262144
  ds_read_b64_tr_b16 a[2:3], v4 offset:20480
  s_add_u32 s93, s92, s89
  v_mfma_f32_16x16x32_bf16 v[68:71], a[48:51], a[204:207], v[68:71]
  ds_read_b64_tr_b16 a[16:17], v4 offset:24576
  buffer_load_dwordx4 v252, s[80:83], s93 offen lds
  v_mfma_f32_16x16x32_bf16 v[68:71], a[32:35], a[196:199], v[68:71]
  ds_read_b64_tr_b16 a[18:19], v4 offset:28672
  v_mfma_f32_16x16x32_bf16 v[76:79], a[36:39], a[196:199], v[76:79]
  ds_read_b64_tr_b16 a[4:5], v5 offset:16384
  v_mfma_f32_16x16x32_bf16 v[76:79], a[52:55], a[204:207], v[76:79]
  ds_read_b64_tr_b16 a[6:7], v5 offset:20480
  v_mfma_f32_16x16x32_bf16 v[72:75], a[52:55], a[200:203], v[72:75]
  ds_read_b64_tr_b16 a[20:21], v5 offset:24576
  buffer_load_dwordx4 v252, s[84:87], s93 offen offset:1024 lds
  v_mfma_f32_16x16x32_bf16 v[72:75], a[36:39], a[192:195], v[72:75]
  ds_read_b64_tr_b16 a[22:23], v5 offset:28672
  s_waitcnt lgkmcnt(8)
  v_mfma_f32_16x16x32_bf16 v[80:83], a[40:43], a[192:195], v[80:83]
  ds_read_b64_tr_b16 a[8:9], v6 offset:16384
  v_mfma_f32_16x16x32_bf16 v[80:83], a[56:59], a[200:203], v[80:83]
  s_min_u32 s63, s89, 4096
  ds_read_b64_tr_b16 a[10:11], v6 offset:20480
  s_add_u32 s63, s63, s48
  v_mfma_f32_16x16x32_bf16 v[84:87], a[56:59], a[204:207], v[84:87]
  ds_read_b64_tr_b16 a[24:25], v6 offset:24576
  buffer_load_dwordx4 a[136:139], v8, s[4:7], s63 offen offset:1024 sc1
  v_mfma_f32_16x16x32_bf16 v[84:87], a[40:43], a[196:199], v[84:87]
  ds_read_b64_tr_b16 a[26:27], v6 offset:28672
  v_mfma_f32_16x16x32_bf16 v[92:95], a[44:47], a[196:199], v[92:95]
  ds_read_b64_tr_b16 a[12:13], v7 offset:16384
  v_mfma_f32_16x16x32_bf16 v[92:95], a[60:63], a[204:207], v[92:95]
  ds_read_b64_tr_b16 a[14:15], v7 offset:20480
  v_mfma_f32_16x16x32_bf16 v[88:91], a[60:63], a[200:203], v[88:91]
  ds_read_b64_tr_b16 a[28:29], v7 offset:24576
  buffer_load_dwordx4 a[140:143], v9, s[4:7], s63 offen offset:1024 sc1
  v_mfma_f32_16x16x32_bf16 v[88:91], a[44:47], a[192:195], v[88:91]
  ds_read_b64_tr_b16 a[30:31], v7 offset:28672
  s_waitcnt vmcnt(24) lgkmcnt(8)
  v_mfma_f32_16x16x32_bf16 v[32:35], a[0:3], a[208:211], v[32:35]
  ds_read_b64_tr_b16 a[32:33], v4 offset:17408
  s_add_u32 m0, s79, 49152
  v_mfma_f32_16x16x32_bf16 v[32:35], a[16:19], a[216:219], v[32:35]
  s_add_u32 s92, s92, 196608
  ds_read_b64_tr_b16 a[34:35], v4 offset:21504
  s_add_u32 s93, s92, s90
  v_mfma_f32_16x16x32_bf16 v[36:39], a[16:19], a[220:223], v[36:39]
  ds_read_b64_tr_b16 a[48:49], v4 offset:25600
  buffer_load_dwordx4 v252, s[80:83], s93 offen lds
  v_mfma_f32_16x16x32_bf16 v[36:39], a[0:3], a[212:215], v[36:39]
  ds_read_b64_tr_b16 a[50:51], v4 offset:29696
  v_mfma_f32_16x16x32_bf16 v[44:47], a[4:7], a[212:215], v[44:47]
  ds_read_b64_tr_b16 a[36:37], v5 offset:17408
  v_mfma_f32_16x16x32_bf16 v[44:47], a[20:23], a[220:223], v[44:47]
  ds_read_b64_tr_b16 a[38:39], v5 offset:21504
  v_mfma_f32_16x16x32_bf16 v[40:43], a[20:23], a[216:219], v[40:43]
  ds_read_b64_tr_b16 a[52:53], v5 offset:25600
  buffer_load_dwordx4 v252, s[84:87], s93 offen offset:1024 lds
  v_mfma_f32_16x16x32_bf16 v[40:43], a[4:7], a[208:211], v[40:43]
  ds_read_b64_tr_b16 a[54:55], v5 offset:29696
  s_waitcnt lgkmcnt(8)
  v_mfma_f32_16x16x32_bf16 v[48:51], a[8:11], a[208:211], v[48:51]
  ds_read_b64_tr_b16 a[40:41], v6 offset:17408
  v_mfma_f32_16x16x32_bf16 v[48:51], a[24:27], a[216:219], v[48:51]
  s_min_u32 s63, s90, 4096
  ds_read_b64_tr_b16 a[42:43], v6 offset:21504
  s_add_u32 s63, s63, s48
  v_mfma_f32_16x16x32_bf16 v[52:55], a[24:27], a[220:223], v[52:55]
  ds_read_b64_tr_b16 a[56:57], v6 offset:25600
  buffer_load_dwordx4 a[144:147], v8, s[4:7], s63 offen offset:2048 sc1
  v_mfma_f32_16x16x32_bf16 v[52:55], a[8:11], a[212:215], v[52:55]
  ds_read_b64_tr_b16 a[58:59], v6 offset:29696
  v_mfma_f32_16x16x32_bf16 v[60:63], a[12:15], a[212:215], v[60:63]
  ds_read_b64_tr_b16 a[44:45], v7 offset:17408
  v_mfma_f32_16x16x32_bf16 v[60:63], a[28:31], a[220:223], v[60:63]
  ds_read_b64_tr_b16 a[46:47], v7 offset:21504
  v_mfma_f32_16x16x32_bf16 v[56:59], a[28:31], a[216:219], v[56:59]
  ds_read_b64_tr_b16 a[60:61], v7 offset:25600
  buffer_load_dwordx4 a[148:151], v9, s[4:7], s63 offen offset:2048 sc1
  v_mfma_f32_16x16x32_bf16 v[56:59], a[12:15], a[208:211], v[56:59]
  ds_read_b64_tr_b16 a[62:63], v7 offset:29696
  s_waitcnt lgkmcnt(8)
  v_mfma_f32_16x16x32_bf16 v[64:67], a[32:35], a[208:211], v[64:67]
  ds_read_b64_tr_b16 a[0:1], v4 offset:32768
  s_add_u32 m0, s79, 57344
  v_mfma_f32_16x16x32_bf16 v[64:67], a[48:51], a[216:219], v[64:67]
  s_add_u32 s92, s92, 262144
  ds_read_b64_tr_b16 a[2:3], v4 offset:36864
  s_add_u32 s93, s92, s91
  v_mfma_f32_16x16x32_bf16 v[68:71], a[48:51], a[220:223], v[68:71]
  ds_read_b64_tr_b16 a[16:17], v4 offset:40960
  buffer_load_dwordx4 v252, s[80:83], s93 offen lds
  v_mfma_f32_16x16x32_bf16 v[68:71], a[32:35], a[212:215], v[68:71]
  ds_read_b64_tr_b16 a[18:19], v4 offset:45056
  v_mfma_f32_16x16x32_bf16 v[76:79], a[36:39], a[212:215], v[76:79]
  ds_read_b64_tr_b16 a[4:5], v5 offset:32768
  v_mfma_f32_16x16x32_bf16 v[76:79], a[52:55], a[220:223], v[76:79]
  ds_read_b64_tr_b16 a[6:7], v5 offset:36864
  v_mfma_f32_16x16x32_bf16 v[72:75], a[52:55], a[216:219], v[72:75]
  ds_read_b64_tr_b16 a[20:21], v5 offset:40960
  buffer_load_dwordx4 v252, s[84:87], s93 offen offset:1024 lds
  v_mfma_f32_16x16x32_bf16 v[72:75], a[36:39], a[208:211], v[72:75]
  ds_read_b64_tr_b16 a[22:23], v5 offset:45056
  s_waitcnt lgkmcnt(8)
  v_mfma_f32_16x16x32_bf16 v[80:83], a[40:43], a[208:211], v[80:83]
  ds_read_b64_tr_b16 a[8:9], v6 offset:32768
  v_mfma_f32_16x16x32_bf16 v[80:83], a[56:59], a[216:219], v[80:83]
  s_min_u32 s63, s91, 4096
  ds_read_b64_tr_b16 a[10:11], v6 offset:36864
  s_add_u32 s63, s63, s48
  v_mfma_f32_16x16x32_bf16 v[84:87], a[56:59], a[220:223], v[84:87]
  ds_read_b64_tr_b16 a[24:25], v6 offset:40960
  buffer_load_dwordx4 a[152:155], v8, s[4:7], s63 offen offset:3072 sc1
  v_mfma_f32_16x16x32_bf16 v[84:87], a[40:43], a[212:215], v[84:87]
  ds_read_b64_tr_b16 a[26:27], v6 offset:45056
  v_mfma_f32_16x16x32_bf16 v[92:95], a[44:47], a[212:215], v[92:95]
  ds_read_b64_tr_b16 a[12:13], v7 offset:32768
  v_mfma_f32_16x16x32_bf16 v[92:95], a[60:63], a[220:223], v[92:95]
  ds_read_b64_tr_b16 a[14:15], v7 offset:36864
  v_mfma_f32_16x16x32_bf16 v[88:91], a[60:63], a[216:219], v[88:91]
  ds_read_b64_tr_b16 a[28:29], v7 offset:40960
  buffer_load_dwordx4 a[156:159], v9, s[4:7], s63 offen offset:3072 sc1
  v_mfma_f32_16x16x32_bf16 v[88:91], a[44:47], a[208:211], v[88:91]
  ds_read_b64_tr_b16 a[30:31], v7 offset:45056
  s_waitcnt vmcnt(24) lgkmcnt(8)
  v_mfma_f32_16x16x32_bf16 v[32:35], a[0:3], a[224:227], v[32:35]
  s_waitcnt vmcnt(26)
  s_barrier
  ds_read_b64_tr_b16 a[32:33], v4 offset:33792
  v_mfma_f32_16x16x32_bf16 v[32:35], a[16:19], a[232:235], v[32:35]
  s_add_u32 m0, s79, 65536
  ds_read_b64_tr_b16 a[34:35], v4 offset:37888
  s_add_u32 s92, s92, 196608
  v_mfma_f32_16x16x32_bf16 v[36:39], a[16:19], a[236:239], v[36:39]
  s_add_u32 s93, s92, s88
  ds_read_b64_tr_b16 a[48:49], v4 offset:41984
  buffer_load_dwordx4 v252, s[80:83], s93 offen lds
  v_mfma_f32_16x16x32_bf16 v[36:39], a[0:3], a[228:231], v[36:39]
  ds_read_b64_tr_b16 a[50:51], v4 offset:46080
  v_mfma_f32_16x16x32_bf16 v[44:47], a[4:7], a[228:231], v[44:47]
  ds_read_b64_tr_b16 a[36:37], v5 offset:33792
  v_mfma_f32_16x16x32_bf16 v[44:47], a[20:23], a[236:239], v[44:47]
  ds_read_b64_tr_b16 a[38:39], v5 offset:37888
  v_mfma_f32_16x16x32_bf16 v[40:43], a[20:23], a[232:235], v[40:43]
  ds_read_b64_tr_b16 a[52:53], v5 offset:41984
  buffer_load_dwordx4 v252, s[84:87], s93 offen offset:1024 lds
  v_mfma_f32_16x16x32_bf16 v[40:43], a[4:7], a[224:227], v[40:43]
  ds_read_b64_tr_b16 a[54:55], v5 offset:46080
  s_waitcnt lgkmcnt(8)
  v_mfma_f32_16x16x32_bf16 v[48:51], a[8:11], a[224:227], v[48:51]
  ds_read_b64_tr_b16 a[40:41], v6 offset:33792
  v_mfma_f32_16x16x32_bf16 v[48:51], a[24:27], a[232:235], v[48:51]
  s_add_u32 s48, s48, 4096
  ds_read_b64_tr_b16 a[42:43], v6 offset:37888
  s_min_u32 s63, s88, 4096
  v_mfma_f32_16x16x32_bf16 v[52:55], a[24:27], a[236:239], v[52:55]
  s_add_u32 s63, s63, s48
  ds_read_b64_tr_b16 a[56:57], v6 offset:41984
  buffer_load_dwordx4 a[160:163], v8, s[4:7], s63 offen offset:0 sc1
  v_mfma_f32_16x16x32_bf16 v[52:55], a[8:11], a[228:231], v[52:55]
  ds_read_b64_tr_b16 a[58:59], v6 offset:46080
  v_mfma_f32_16x16x32_bf16 v[60:63], a[12:15], a[228:231], v[60:63]
  ds_read_b64_tr_b16 a[44:45], v7 offset:33792
  v_mfma_f32_16x16x32_bf16 v[60:63], a[28:31], a[236:239], v[60:63]
  ds_read_b64_tr_b16 a[46:47], v7 offset:37888
  v_mfma_f32_16x16x32_bf16 v[56:59], a[28:31], a[232:235], v[56:59]
  ds_read_b64_tr_b16 a[60:61], v7 offset:41984
  buffer_load_dwordx4 a[164:167], v9, s[4:7], s63 offen offset:0 sc1
  v_mfma_f32_16x16x32_bf16 v[56:59], a[12:15], a[224:227], v[56:59]
  ds_read_b64_tr_b16 a[62:63], v7 offset:46080
  s_waitcnt lgkmcnt(8)
  v_mfma_f32_16x16x32_bf16 v[64:67], a[32:35], a[224:227], v[64:67]
  ds_read_b64_tr_b16 a[0:1], v4 offset:49152
  s_add_u32 m0, s79, 73728
  v_mfma_f32_16x16x32_bf16 v[64:67], a[48:51], a[232:235], v[64:67]
  s_add_u32 s92, s92, 262144
  ds_read_b64_tr_b16 a[2:3], v4 offset:53248
  s_add_u32 s93, s92, s89
  v_mfma_f32_16x16x32_bf16 v[68:71], a[48:51], a[236:239], v[68:71]
  ds_read_b64_tr_b16 a[16:17], v4 offset:57344
  buffer_load_dwordx4 v252, s[80:83], s93 offen lds
  v_mfma_f32_16x16x32_bf16 v[68:71], a[32:35], a[228:231], v[68:71]
  ds_read_b64_tr_b16 a[18:19], v4 offset:61440
  v_mfma_f32_16x16x32_bf16 v[76:79], a[36:39], a[228:231], v[76:79]
  ds_read_b64_tr_b16 a[4:5], v5 offset:49152
  v_mfma_f32_16x16x32_bf16 v[76:79], a[52:55], a[236:239], v[76:79]
  ds_read_b64_tr_b16 a[6:7], v5 offset:53248
  v_mfma_f32_16x16x32_bf16 v[72:75], a[52:55], a[232:235], v[72:75]
  ds_read_b64_tr_b16 a[20:21], v5 offset:57344
  buffer_load_dwordx4 v252, s[84:87], s93 offen offset:1024 lds
  v_mfma_f32_16x16x32_bf16 v[72:75], a[36:39], a[224:227], v[72:75]
  ds_read_b64_tr_b16 a[22:23], v5 offset:61440
  s_waitcnt lgkmcnt(8)
  v_mfma_f32_16x16x32_bf16 v[80:83], a[40:43], a[224:227], v[80:83]
  ds_read_b64_tr_b16 a[8:9], v6 offset:49152
  v_mfma_f32_16x16x32_bf16 v[80:83], a[56:59], a[232:235], v[80:83]
  s_min_u32 s63, s89, 4096
  ds_read_b64_tr_b16 a[10:11], v6 offset:53248
  s_add_u32 s63, s63, s48
  v_mfma_f32_16x16x32_bf16 v[84:87], a[56:59], a[236:239], v[84:87]
  ds_read_b64_tr_b16 a[24:25], v6 offset:57344
  buffer_load_dwordx4 a[168:171], v8, s[4:7], s63 offen offset:1024 sc1
  v_mfma_f32_16x16x32_bf16 v[84:87], a[40:43], a[228:231], v[84:87]
  ds_read_b64_tr_b16 a[26:27], v6 offset:61440
  v_mfma_f32_16x16x32_bf16 v[92:95], a[44:47], a[228:231], v[92:95]
  ds_read_b64_tr_b16 a[12:13], v7 offset:49152
  v_mfma_f32_16x16x32_bf16 v[92:95], a[60:63], a[236:239], v[92:95]
  ds_read_b64_tr_b16 a[14:15], v7 offset:53248
  v_mfma_f32_16x16x32_bf16 v[88:91], a[60:63], a[232:235], v[88:91]
  ds_read_b64_tr_b16 a[28:29], v7 offset:57344
  buffer_load_dwordx4 a[172:175], v9, s[4:7], s63 offen offset:1024 sc1
  v_mfma_f32_16x16x32_bf16 v[88:91], a[44:47], a[224:227], v[88:91]
  ds_read_b64_tr_b16 a[30:31], v7 offset:61440
  s_waitcnt vmcnt(24) lgkmcnt(8)
  v_mfma_f32_16x16x32_bf16 v[32:35], a[0:3], a[240:243], v[32:35]
  ds_read_b64_tr_b16 a[32:33], v4 offset:50176
  s_add_u32 m0, s79, 81920
  v_mfma_f32_16x16x32_bf16 v[32:35], a[16:19], a[248:251], v[32:35]
  s_add_u32 s92, s92, 196608
  ds_read_b64_tr_b16 a[34:35], v4 offset:54272
  s_add_u32 s93, s92, s90
  v_mfma_f32_16x16x32_bf16 v[36:39], a[16:19], a[252:255], v[36:39]
  ds_read_b64_tr_b16 a[48:49], v4 offset:58368
  buffer_load_dwordx4 v252, s[80:83], s93 offen lds
  v_mfma_f32_16x16x32_bf16 v[36:39], a[0:3], a[244:247], v[36:39]
  ds_read_b64_tr_b16 a[50:51], v4 offset:62464
  v_mfma_f32_16x16x32_bf16 v[44:47], a[4:7], a[244:247], v[44:47]
  ds_read_b64_tr_b16 a[36:37], v5 offset:50176
  v_mfma_f32_16x16x32_bf16 v[44:47], a[20:23], a[252:255], v[44:47]
  ds_read_b64_tr_b16 a[38:39], v5 offset:54272
  v_mfma_f32_16x16x32_bf16 v[40:43], a[20:23], a[248:251], v[40:43]
  ds_read_b64_tr_b16 a[52:53], v5 offset:58368
  buffer_load_dwordx4 v252, s[84:87], s93 offen offset:1024 lds
  v_mfma_f32_16x16x32_bf16 v[40:43], a[4:7], a[240:243], v[40:43]
  ds_read_b64_tr_b16 a[54:55], v5 offset:62464
  s_waitcnt lgkmcnt(8)
  v_mfma_f32_16x16x32_bf16 v[48:51], a[8:11], a[240:243], v[48:51]
  ds_read_b64_tr_b16 a[40:41], v6 offset:50176
  v_mfma_f32_16x16x32_bf16 v[48:51], a[24:27], a[248:251], v[48:51]
  s_min_u32 s63, s90, 4096
  ds_read_b64_tr_b16 a[42:43], v6 offset:54272
  s_add_u32 s63, s63, s48
  v_mfma_f32_16x16x32_bf16 v[52:55], a[24:27], a[252:255], v[52:55]
  ds_read_b64_tr_b16 a[56:57], v6 offset:58368
  buffer_load_dwordx4 a[176:179], v8, s[4:7], s63 offen offset:2048 sc1
  v_mfma_f32_16x16x32_bf16 v[52:55], a[8:11], a[244:247], v[52:55]
  ds_read_b64_tr_b16 a[58:59], v6 offset:62464
  v_mfma_f32_16x16x32_bf16 v[60:63], a[12:15], a[244:247], v[60:63]
  ds_read_b64_tr_b16 a[44:45], v7 offset:50176
  v_mfma_f32_16x16x32_bf16 v[60:63], a[28:31], a[252:255], v[60:63]
  ds_read_b64_tr_b16 a[46:47], v7 offset:54272
  v_mfma_f32_16x16x32_bf16 v[56:59], a[28:31], a[248:251], v[56:59]
  ds_read_b64_tr_b16 a[60:61], v7 offset:58368
  buffer_load_dwordx4 a[180:183], v9, s[4:7], s63 offen offset:2048 sc1
  v_mfma_f32_16x16x32_bf16 v[56:59], a[12:15], a[240:243], v[56:59]
  ds_read_b64_tr_b16 a[62:63], v7 offset:62464
  s_waitcnt lgkmcnt(8)
  v_mfma_f32_16x16x32_bf16 v[64:67], a[32:35], a[240:243], v[64:67]
  ds_read_b64_tr_b16 a[0:1], v0 offset:0
  s_add_u32 m0, s79, 90112
  v_mfma_f32_16x16x32_bf16 v[64:67], a[48:51], a[248:251], v[64:67]
  s_add_u32 s92, s92, 262144
  ds_read_b64_tr_b16 a[2:3], v0 offset:4096
  s_add_u32 s93, s92, s91
  v_mfma_f32_16x16x32_bf16 v[68:71], a[48:51], a[252:255], v[68:71]
  ds_read_b64_tr_b16 a[16:17], v0 offset:8192
  buffer_load_dwordx4 v252, s[80:83], s93 offen lds
  v_mfma_f32_16x16x32_bf16 v[68:71], a[32:35], a[244:247], v[68:71]
  ds_read_b64_tr_b16 a[18:19], v0 offset:12288
  v_mfma_f32_16x16x32_bf16 v[76:79], a[36:39], a[244:247], v[76:79]
  ds_read_b64_tr_b16 a[4:5], v1 offset:0
  v_mfma_f32_16x16x32_bf16 v[76:79], a[52:55], a[252:255], v[76:79]
  ds_read_b64_tr_b16 a[6:7], v1 offset:4096
  v_mfma_f32_16x16x32_bf16 v[72:75], a[52:55], a[248:251], v[72:75]
  ds_read_b64_tr_b16 a[20:21], v1 offset:8192
  buffer_load_dwordx4 v252, s[84:87], s93 offen offset:1024 lds
  v_mfma_f32_16x16x32_bf16 v[72:75], a[36:39], a[240:243], v[72:75]
  ds_read_b64_tr_b16 a[22:23], v1 offset:12288
  s_waitcnt lgkmcnt(8)
  v_mfma_f32_16x16x32_bf16 v[80:83], a[40:43], a[240:243], v[80:83]
  ds_read_b64_tr_b16 a[8:9], v2 offset:0
  v_mfma_f32_16x16x32_bf16 v[80:83], a[56:59], a[248:251], v[80:83]
  s_min_u32 s63, s91, 4096
  ds_read_b64_tr_b16 a[10:11], v2 offset:4096
  s_add_u32 s63, s63, s48
  v_mfma_f32_16x16x32_bf16 v[84:87], a[56:59], a[252:255], v[84:87]
  ds_read_b64_tr_b16 a[24:25], v2 offset:8192
  buffer_load_dwordx4 a[184:187], v8, s[4:7], s63 offen offset:3072 sc1
  v_mfma_f32_16x16x32_bf16 v[84:87], a[40:43], a[244:247], v[84:87]
  ds_read_b64_tr_b16 a[26:27], v2 offset:12288
  v_mfma_f32_16x16x32_bf16 v[92:95], a[44:47], a[244:247], v[92:95]
  ds_read_b64_tr_b16 a[12:13], v3 offset:0
  v_mfma_f32_16x16x32_bf16 v[92:95], a[60:63], a[252:255], v[92:95]
  ds_read_b64_tr_b16 a[14:15], v3 offset:4096
  v_mfma_f32_16x16x32_bf16 v[88:91], a[60:63], a[248:251], v[88:91]
  ds_read_b64_tr_b16 a[28:29], v3 offset:8192
  buffer_load_dwordx4 a[188:191], v9, s[4:7], s63 offen offset:3072 sc1
  v_mfma_f32_16x16x32_bf16 v[88:91], a[44:47], a[240:243], v[88:91]
  s_sub_u32 s56, s56, 1
  ds_read_b64_tr_b16 a[30:31], v3 offset:12288
  s_cmp_lg_u32 s56, 0
  s_cbranch_scc1 Lp4_loop
Lmk_Lp4_loop_tail:
  s_waitcnt vmcnt(24) lgkmcnt(8)
  v_mfma_f32_16x16x32_bf16 v[32:35], a[0:3], a[128:131], v[32:35]
  s_waitcnt vmcnt(26)
  s_barrier
  ds_read_b64_tr_b16 a[32:33], v0 offset:1024
  s_add_u32 m0, s79, 98304
  s_add_u32 s92, s92, 196608
  s_cmp_lg_u32 s88, 0
  s_cselect_b32 s93, -2686976, 0
  s_cselect_b32 s43, s78, 0
  v_mfma_f32_16x16x32_bf16 v[32:35], a[16:19], a[136:139], v[32:35]
  s_add_u32 s93, s93, s43
  ds_read_b64_tr_b16 a[34:35], v0 offset:5120
  s_add_u32 s93, s93, s92
  v_mfma_f32_16x16x32_bf16 v[36:39], a[16:19], a[140:143], v[36:39]
  ds_read_b64_tr_b16 a[48:49], v0 offset:9216
  buffer_load_dwordx4 v252, s[80:83], s93 offen lds
  v_mfma_f32_16x16x32_bf16 v[36:39], a[0:3], a[132:135], v[36:39]
  ds_read_b64_tr_b16 a[50:51], v0 offset:13312
  v_mfma_f32_16x16x32_bf16 v[44:47], a[4:7], a[132:135], v[44:47]
  ds_read_b64_tr_b16 a[36:37], v1 offset:1024
  v_mfma_f32_16x16x32_bf16 v[44:47], a[20:23], a[140:143], v[44:47]
  ds_read_b64_tr_b16 a[38:39], v1 offset:5120
  v_mfma_f32_16x16x32_bf16 v[40:43], a[20:23], a[136:139], v[40:43]
  ds_read_b64_tr_b16 a[52:53], v1 offset:9216
  buffer_load_dwordx4 v252, s[84:87], s93 offen offset:1024 lds
  v_mfma_f32_16x16x32_bf16 v[40:43], a[4:7], a[128:131], v[40:43]
  ds_read_b64_tr_b16 a[54:55], v1 offset:13312
  s_waitcnt lgkmcnt(8)
  v_mfma_f32_16x16x32_bf16 v[48:51], a[8:11], a[128:131], v[48:51]
  ds_read_b64_tr_b16 a[40:41], v2 offset:1024
  v_mfma_f32_16x16x32_bf16 v[48:51], a[24:27], a[136:139], v[48:51]
  s_add_u32 s48, s48, 4096
  ds_read_b64_tr_b16 a[42:43], v2 offset:5120
  s_min_u32 s63, s88, 4096
  v_mfma_f32_16x16x32_bf16 v[52:55], a[24:27], a[140:143], v[52:55]
  s_add_u32 s63, s63, s48
  ds_read_b64_tr_b16 a[56:57], v2 offset:9216
  buffer_load_dwordx4 a[192:195], v8, s[4:7], s63 offen offset:0 sc1
  v_mfma_f32_16x16x32_bf16 v[52:55], a[8:11], a[132:135], v[52:55]
  ds_read_b64_tr_b16 a[58:59], v2 offset:13312
  v_mfma_f32_16x16x32_bf16 v[60:63], a[12:15], a[132:135], v[60:63]
  ds_read_b64_tr_b16 a[44:45], v3 offset:1024
  v_mfma_f32_16x16x32_bf16 v[60:63], a[28:31], a[140:143], v[60:63]
  ds_read_b64_tr_b16 a[46:47], v3 offset:5120
  v_mfma_f32_16x16x32_bf16 v[56:59], a[28:31], a[136:139], v[56:59]
  ds_read_b64_tr_b16 a[60:61], v3 offset:9216
  buffer_load_dwordx4 a[196:199], v9, s[4:7], s63 offen offset:0 sc1
  v_mfma_f32_16x16x32_bf16 v[56:59], a[12:15], a[128:131], v[56:59]
  ds_read_b64_tr_b16 a[62:63], v3 offset:13312
  s_waitcnt lgkmcnt(8)
  v_mfma_f32_16x16x32_bf16 v[64:67], a[32:35], a[128:131], v[64:67]
  s_add_u32 m0, s79, 106496
  ds_read_b64_tr_b16 a[0:1], v0 offset:16384
  s_add_u32 s92, s92, 262144
  s_cmp_lg_u32 s89, 0
  s_cselect_b32 s93, -2490368, 0
  s_cselect_b32 s43, s78, 0
  v_mfma_f32_16x16x32_bf16 v[64:67], a[48:51], a[136:139], v[64:67]
  s_add_u32 s93, s93, s43
  ds_read_b64_tr_b16 a[2:3], v0 offset:20480
  s_add_u32 s93, s93, s92
  v_mfma_f32_16x16x32_bf16 v[68:71], a[48:51], a[140:143], v[68:71]
  ds_read_b64_tr_b16 a[16:17], v0 offset:24576
  buffer_load_dwordx4 v252, s[80:83], s93 offen lds
  v_mfma_f32_16x16x32_bf16 v[68:71], a[32:35], a[132:135], v[68:71]
  ds_read_b64_tr_b16 a[18:19], v0 offset:28672
  v_mfma_f32_16x16x32_bf16 v[76:79], a[36:39], a[132:135], v[76:79]
  ds_read_b64_tr_b16 a[4:5], v1 offset:16384
  v_mfma_f32_16x16x32_bf16 v[76:79], a[52:55], a[140:143], v[76:79]
  ds_read_b64_tr_b16 a[6:7], v1 offset:20480
  v_mfma_f32_16x16x32_bf16 v[72:75], a[52:55], a[136:139], v[72:75]
  ds_read_b64_tr_b16 a[20:21], v1 offset:24576
  buffer_load_dwordx4 v252, s[84:87], s93 offen offset:1024 lds
  v_mfma_f32_16x16x32_bf16 v[72:75], a[36:39], a[128:131], v[72:75]
  ds_read_b64_tr_b16 a[22:23], v1 offset:28672
  s_waitcnt lgkmcnt(8)
  v_mfma_f32_16x16x32_bf16 v[80:83], a[40:43], a[128:131], v[80:83]
  ds_read_b64_tr_b16 a[8:9], v2 offset:16384
  v_mfma_f32_16x16x32_bf16 v[80:83], a[56:59], a[136:139], v[80:83]
  s_min_u32 s63, s89, 4096
  ds_read_b64_tr_b16 a[10:11], v2 offset:20480
  s_add_u32 s63, s63, s48
  v_mfma_f32_16x16x32_bf16 v[84:87], a[56:59], a[140:143], v[84:87]
  ds_read_b64_tr_b16 a[24:25], v2 offset:24576
  buffer_load_dwordx4 a[200:203], v8, s[4:7], s63 offen offset:1024 sc1
  v_mfma_f32_16x16x32_bf16 v[84:87], a[40:43], a[132:135], v[84:87]
  ds_read_b64_tr_b16 a[26:27], v2 offset:28672
  v_mfma_f32_16x16x32_bf16 v[92:95], a[44:47], a[132:135], v[92:95]
  ds_read_b64_tr_b16 a[12:13], v3 offset:16384
  v_mfma_f32_16x16x32_bf16 v[92:95], a[60:63], a[140:143], v[92:95]
  ds_read_b64_tr_b16 a[14:15], v3 offset:20480
  v_mfma_f32_16x16x32_bf16 v[88:91], a[60:63], a[136:139], v[88:91]
  ds_read_b64_tr_b16 a[28:29], v3 offset:24576
  buffer_load_dwordx4 a[204:207], v9, s[4:7], s63 offen offset:1024 sc1
  v_mfma_f32_16x16x32_bf16 v[88:91], a[44:47], a[128:131], v[88:91]
  ds_read_b64_tr_b16 a[30:31], v3 offset:28672
  s_waitcnt vmcnt(24) lgkmcnt(8)
  v_mfma_f32_16x16x32_bf16 v[32:35], a[0:3], a[144:147], v[32:35]
  s_add_u32 m0, s79, 114688
  ds_read_b64_tr_b16 a[32:33], v0 offset:17408
  s_add_u32 s92, s92, 196608
  s_cmp_lg_u32 s90, 0
  s_cselect_b32 s93, -2228224, 0
  s_cselect_b32 s43, s78, 0
  v_mfma_f32_16x16x32_bf16 v[32:35], a[16:19], a[152:155], v[32:35]
  s_add_u32 s93, s93, s43
  ds_read_b64_tr_b16 a[34:35], v0 offset:21504
  s_add_u32 s93, s93, s92
  v_mfma_f32_16x16x32_bf16 v[36:39], a[16:19], a[156:159], v[36:39]
  ds_read_b64_tr_b16 a[48:49], v0 offset:25600
  buffer_load_dwordx4 v252, s[80:83], s93 offen lds
  v_mfma_f32_16x16x32_bf16 v[36:39], a[0:3], a[148:151], v[36:39]
  ds_read_b64_tr_b16 a[50:51], v0 offset:29696
  v_mfma_f32_16x16x32_bf16 v[44:47], a[4:7], a[148:151], v[44:47]
  ds_read_b64_tr_b16 a[36:37], v1 offset:17408
  v_mfma_f32_16x16x32_bf16 v[44:47], a[20:23], a[156:159], v[44:47]
  ds_read_b64_tr_b16 a[38:39], v1 offset:21504
  v_mfma_f32_16x16x32_bf16 v[40:43], a[20:23], a[152:155], v[40:43]
  ds_read_b64_tr_b16 a[52:53], v1 offset:25600
  buffer_load_dwordx4 v252, s[84:87], s93 offen offset:1024 lds
  v_mfma_f32_16x16x32_bf16 v[40:43], a[4:7], a[144:147], v[40:43]
  ds_read_b64_tr_b16 a[54:55], v1 offset:29696
  s_waitcnt lgkmcnt(8)
  v_mfma_f32_16x16x32_bf16 v[48:51], a[8:11], a[144:147], v[48:51]
  ds_read_b64_tr_b16 a[40:41], v2 offset:17408
  v_mfma_f32_16x16x32_bf16 v[48:51], a[24:27], a[152:155], v[48:51]
  s_min_u32 s63, s90, 4096
  ds_read_b64_tr_b16 a[42:43], v2 offset:21504
  s_add_u32 s63, s63, s48
  v_mfma_f32_16x16x32_bf16 v[52:55], a[24:27], a[156:159], v[52:55]
  ds_read_b64_tr_b16 a[56:57], v2 offset:25600
  buffer_load_dwordx4 a[208:211], v8, s[4:7], s63 offen offset:2048 sc1
  v_mfma_f32_16x16x32_bf16 v[52:55], a[8:11], a[148:151], v[52:55]
  ds_read_b64_tr_b16 a[58:59], v2 offset:29696
  v_mfma_f32_16x16x32_bf16 v[60:63], a[12:15], a[148:151], v[60:63]
  ds_read_b64_tr_b16 a[44:45], v3 offset:17408
  v_mfma_f32_16x16x32_bf16 v[60:63], a[28:31], a[156:159], v[60:63]
  ds_read_b64_tr_b16 a[46:47], v3 offset:21504
  v_mfma_f32_16x16x32_bf16 v[56:59], a[28:31], a[152:155], v[56:59]
  ds_read_b64_tr_b16 a[60:61], v3 offset:25600
  buffer_load_dwordx4 a[212:215], v9, s[4:7], s63 offen offset:2048 sc1
  v_mfma_f32_16x16x32_bf16 v[56:59], a[12:15], a[144:147], v[56:59]
  ds_read_b64_tr_b16 a[62:63], v3 offset:29696
  s_waitcnt lgkmcnt(8)
  v_mfma_f32_16x16x32_bf16 v[64:67], a[32:35], a[144:147], v[64:67]
  s_add_u32 m0, s79, 122880
  ds_read_b64_tr_b16 a[0:1], v0 offset:32768
  s_add_u32 s92, s92, 262144
  s_cmp_lg_u32 s91, 0
  s_cselect_b32 s93, -2031616, 0
  s_cselect_b32 s43, s78, 0
  v_mfma_f32_16x16x32_bf16 v[64:67], a[48:51], a[152:155], v[64:67]
  s_add_u32 s93, s93, s43
  ds_read_b64_tr_b16 a[2:3], v0 offset:36864
  s_add_u32 s93, s93, s92
  v_mfma_f32_16x16x32_bf16 v[68:71], a[48:51], a[156:159], v[68:71]
  ds_read_b64_tr_b16 a[16:17], v0 offset:40960
  buffer_load_dwordx4 v252, s[80:83], s93 offen lds
  v_mfma_f32_16x16x32_bf16 v[68:71], a[32:35], a[148:151], v[68:71]
  ds_read_b64_tr_b16 a[18:19], v0 offset:45056
  v_mfma_f32_16x16x32_bf16 v[76:79], a[36:39], a[148:151], v[76:79]
  ds_read_b64_tr_b16 a[4:5], v1 offset:32768
  v_mfma_f32_16x16x32_bf16 v[76:79], a[52:55], a[156:159], v[76:79]
  ds_read_b64_tr_b16 a[6:7], v1 offset:36864
  v_mfma_f32_16x16x32_bf16 v[72:75], a[52:55], a[152:155], v[72:75]
  ds_read_b64_tr_b16 a[20:21], v1 offset:40960
  buffer_load_dwordx4 v252, s[84:87], s93 offen offset:1024 lds
  v_mfma_f32_16x16x32_bf16 v[72:75], a[36:39], a[144:147], v[72:75]
  ds_read_b64_tr_b16 a[22:23], v1 offset:45056
  s_waitcnt lgkmcnt(8)
  v_mfma_f32_16x16x32_bf16 v[80:83], a[40:43], a[144:147], v[80:83]
  ds_read_b64_tr_b16 a[8:9], v2 offset:32768
  v_mfma_f32_16x16x32_bf16 v[80:83], a[56:59], a[152:155], v[80:83]
  s_min_u32 s63, s91, 4096
  ds_read_b64_tr_b16 a[10:11], v2 offset:36864
  s_add_u32 s63, s63, s48
  v_mfma_f32_16x16x32_bf16 v[84:87], a[56:59], a[156:159], v[84:87]
  ds_read_b64_tr_b16 a[24:25], v2 offset:40960
  buffer_load_dwordx4 a[216:219], v8, s[4:7], s63 offen offset:3072 sc1
  v_mfma_f32_16x16x32_bf16 v[84:87], a[40:43], a[148:151], v[84:87]
  ds_read_b64_tr_b16 a[26:27], v2 offset:45056
  v_mfma_f32_16x16x32_bf16 v[92:95], a[44:47], a[148:151], v[92:95]
  ds_read_b64_tr_b16 a[12:13], v3 offset:32768
  v_mfma_f32_16x16x32_bf16 v[92:95], a[60:63], a[156:159], v[92:95]
  ds_read_b64_tr_b16 a[14:15], v3 offset:36864
  v_mfma_f32_16x16x32_bf16 v[88:91], a[60:63], a[152:155], v[88:91]
  ds_read_b64_tr_b16 a[28:29], v3 offset:40960
  buffer_load_dwordx4 a[220:223], v9, s[4:7], s63 offen offset:3072 sc1
  v_mfma_f32_16x16x32_bf16 v[88:91], a[44:47], a[144:147], v[88:91]
  ds_read_b64_tr_b16 a[30:31], v3 offset:45056
  s_waitcnt vmcnt(24) lgkmcnt(8)
  v_mfma_f32_16x16x32_bf16 v[32:35], a[0:3], a[160:163], v[32:35]
  s_waitcnt vmcnt(26)
  s_barrier
  ds_read_b64_tr_b16 a[32:33], v0 offset:33792
  s_add_u32 m0, s79, 0
  s_add_u32 s92, s92, -3407872
  s_add_u32 s92, s92, s78
  s_cmp_lg_u32 s88, 0
  v_mfma_f32_16x16x32_bf16 v[32:35], a[16:19], a[168:171], v[32:35]
  s_cselect_b32 s93, 1835008, 0
  ds_read_b64_tr_b16 a[34:35], v0 offset:37888
  s_add_u32 s93, s93, s92
  v_mfma_f32_16x16x32_bf16 v[36:39], a[16:19], a[172:175], v[36:39]
  ds_read_b64_tr_b16 a[48:49], v0 offset:41984
  buffer_load_dwordx4 v252, s[80:83], s93 offen lds
  v_mfma_f32_16x16x32_bf16 v[36:39], a[0:3], a[164:167], v[36:39]
  ds_read_b64_tr_b16 a[50:51], v0 offset:46080
  v_mfma_f32_16x16x32_bf16 v[44:47], a[4:7], a[164:167], v[44:47]
  ds_read_b64_tr_b16 a[36:37], v1 offset:33792
  v_mfma_f32_16x16x32_bf16 v[44:47], a[20:23], a[172:175], v[44:47]
  ds_read_b64_tr_b16 a[38:39], v1 offset:37888
  v_mfma_f32_16x16x32_bf16 v[40:43], a[20:23], a[168:171], v[40:43]
  ds_read_b64_tr_b16 a[52:53], v1 offset:41984
  buffer_load_dwordx4 v252, s[84:87], s93 offen offset:1024 lds
  v_mfma_f32_16x16x32_bf16 v[40:43], a[4:7], a[160:163], v[40:43]
  ds_read_b64_tr_b16 a[54:55], v1 offset:46080
  s_waitcnt lgkmcnt(8)
  v_mfma_f32_16x16x32_bf16 v[48:51], a[8:11], a[160:163], v[48:51]
  ds_read_b64_tr_b16 a[40:41], v2 offset:33792
  v_mfma_f32_16x16x32_bf16 v[48:51], a[24:27], a[168:171], v[48:51]
  s_add_u32 s48, s48, 4096
  ds_read_b64_tr_b16 a[42:43], v2 offset:37888
  s_min_u32 s63, s88, 4096
  v_mfma_f32_16x16x32_bf16 v[52:55], a[24:27], a[172:175], v[52:55]
  s_add_u32 s63, s63, s48
  ds_read_b64_tr_b16 a[56:57], v2 offset:41984
  buffer_load_dwordx4 a[224:227], v8, s[4:7], s63 offen offset:0 sc1
  v_mfma_f32_16x16x32_bf16 v[52:55], a[8:11], a[164:167], v[52:55]
  ds_read_b64_tr_b16 a[58:59], v2 offset:46080
  v_mfma_f32_16x16x32_bf16 v[60:63], a[12:15], a[164:167], v[60:63]
  ds_read_b64_tr_b16 a[44:45], v3 offset:33792
  v_mfma_f32_16x16x32_bf16 v[60:63], a[28:31], a[172:175], v[60:63]
  ds_read_b64_tr_b16 a[46:47], v3 offset:37888
  v_mfma_f32_16x16x32_bf16 v[56:59], a[28:31], a[168:171], v[56:59]
  ds_read_b64_tr_b16 a[60:61], v3 offset:41984
  buffer_load_dwordx4 a[228:231], v9, s[4:7], s63 offen offset:0 sc1
  v_mfma_f32_16x16x32_bf16 v[56:59], a[12:15], a[160:163], v[56:59]
  ds_read_b64_tr_b16 a[62:63], v3 offset:46080
  s_waitcnt lgkmcnt(8)
  v_mfma_f32_16x16x32_bf16 v[64:67], a[32:35], a[160:163], v[64:67]
  s_add_u32 m0, s79, 8192
  ds_read_b64_tr_b16 a[0:1], v0 offset:49152
  s_add_u32 s92, s92, 458752
  s_cmp_lg_u32 s89, 0
  v_mfma_f32_16x16x32_bf16 v[64:67], a[48:51], a[168:171], v[64:67]
  s_cselect_b32 s93, 1835008, 0
  ds_read_b64_tr_b16 a[2:3], v0 offset:53248
  s_add_u32 s93, s93, s92
  v_mfma_f32_16x16x32_bf16 v[68:71], a[48:51], a[172:175], v[68:71]
  ds_read_b64_tr_b16 a[16:17], v0 offset:57344
  buffer_load_dwordx4 v252, s[80:83], s93 offen lds
  v_mfma_f32_16x16x32_bf16 v[68:71], a[32:35], a[164:167], v[68:71]
  ds_read_b64_tr_b16 a[18:19], v0 offset:61440
  v_mfma_f32_16x16x32_bf16 v[76:79], a[36:39], a[164:167], v[76:79]
  ds_read_b64_tr_b16 a[4:5], v1 offset:49152
  v_mfma_f32_16x16x32_bf16 v[76:79], a[52:55], a[172:175], v[76:79]
  ds_read_b64_tr_b16 a[6:7], v1 offset:53248
  v_mfma_f32_16x16x32_bf16 v[72:75], a[52:55], a[168:171], v[72:75]
  ds_read_b64_tr_b16 a[20:21], v1 offset:57344
  buffer_load_dwordx4 v252, s[84:87], s93 offen offset:1024 lds
  v_mfma_f32_16x16x32_bf16 v[72:75], a[36:39], a[160:163], v[72:75]
  ds_read_b64_tr_b16 a[22:23], v1 offset:61440
  s_waitcnt lgkmcnt(8)
  v_mfma_f32_16x16x32_bf16 v[80:83], a[40:43], a[160:163], v[80:83]
  ds_read_b64_tr_b16 a[8:9], v2 offset:49152
  v_mfma_f32_16x16x32_bf16 v[80:83], a[56:59], a[168:171], v[80:83]
  s_min_u32 s63, s89, 4096
  ds_read_b64_tr_b16 a[10:11], v2 offset:53248
  s_add_u32 s63, s63, s48
  v_mfma_f32_16x16x32_bf16 v[84:87], a[56:59], a[172:175], v[84:87]
  ds_read_b64_tr_b16 a[24:25], v2 offset:57344
  buffer_load_dwordx4 a[232:235], v8, s[4:7], s63 offen offset:1024 sc1
  v_mfma_f32_16x16x32_bf16 v[84:87], a[40:43], a[164:167], v[84:87]
  ds_read_b64_tr_b16 a[26:27], v2 offset:61440
  v_mfma_f32_16x16x32_bf16 v[92:95], a[44:47], a[164:167], v[92:95]
  ds_read_b64_tr_b16 a[12:13], v3 offset:49152
  v_mfma_f32_16x16x32_bf16 v[92:95], a[60:63], a[172:175], v[92:95]
  ds_read_b64_tr_b16 a[14:15], v3 offset:53248
  v_mfma_f32_16x16x32_bf16 v[88:91], a[60:63], a[168:171], v[88:91]
  ds_read_b64_tr_b16 a[28:29], v3 offset:57344
  buffer_load_dwordx4 a[236:239], v9, s[4:7], s63 offen offset:1024 sc1
  v_mfma_f32_16x16x32_bf16 v[88:91], a[44:47], a[160:163], v[88:91]
  ds_read_b64_tr_b16 a[30:31], v3 offset:61440
  s_waitcnt vmcnt(24) lgkmcnt(8)
  v_mfma_f32_16x16x32_bf16 v[32:35], a[0:3], a[176:179], v[32:35]
  s_add_u32 m0, s79, 16384
  ds_read_b64_tr_b16 a[32:33], v0 offset:50176
  s_add_u32 s92, s92, 458752
  s_cmp_lg_u32 s90, 0
  v_mfma_f32_16x16x32_bf16 v[32:35], a[16:19], a[184:187], v[32:35]
  s_cselect_b32 s93, 1835008, 0
  ds_read_b64_tr_b16 a[34:35], v0 offset:54272
  s_add_u32 s93, s93, s92
  v_mfma_f32_16x16x32_bf16 v[36:39], a[16:19], a[188:191], v[36:39]
  ds_read_b64_tr_b16 a[48:49], v0 offset:58368
  buffer_load_dwordx4 v252, s[80:83], s93 offen lds
  v_mfma_f32_16x16x32_bf16 v[36:39], a[0:3], a[180:183], v[36:39]
  ds_read_b64_tr_b16 a[50:51], v0 offset:62464
  v_mfma_f32_16x16x32_bf16 v[44:47], a[4:7], a[180:183], v[44:47]
  ds_read_b64_tr_b16 a[36:37], v1 offset:50176
  v_mfma_f32_16x16x32_bf16 v[44:47], a[20:23], a[188:191], v[44:47]
  ds_read_b64_tr_b16 a[38:39], v1 offset:54272
  v_mfma_f32_16x16x32_bf16 v[40:43], a[20:23], a[184:187], v[40:43]
  ds_read_b64_tr_b16 a[52:53], v1 offset:58368
  buffer_load_dwordx4 v252, s[84:87], s93 offen offset:1024 lds
  v_mfma_f32_16x16x32_bf16 v[40:43], a[4:7], a[176:179], v[40:43]
  ds_read_b64_tr_b16 a[54:55], v1 offset:62464
  s_waitcnt lgkmcnt(8)
  v_mfma_f32_16x16x32_bf16 v[48:51], a[8:11], a[176:179], v[48:51]
  ds_read_b64_tr_b16 a[40:41], v2 offset:50176
  v_mfma_f32_16x16x32_bf16 v[48:51], a[24:27], a[184:187], v[48:51]
  s_min_u32 s63, s90, 4096
  ds_read_b64_tr_b16 a[42:43], v2 offset:54272
  s_add_u32 s63, s63, s48
  v_mfma_f32_16x16x32_bf16 v[52:55], a[24:27], a[188:191], v[52:55]
  ds_read_b64_tr_b16 a[56:57], v2 offset:58368
  buffer_load_dwordx4 a[240:243], v8, s[4:7], s63 offen offset:2048 sc1
  v_mfma_f32_16x16x32_bf16 v[52:55], a[8:11], a[180:183], v[52:55]
  ds_read_b64_tr_b16 a[58:59], v2 offset:62464
  v_mfma_f32_16x16x32_bf16 v[60:63], a[12:15], a[180:183], v[60:63]
  ds_read_b64_tr_b16 a[44:45], v3 offset:50176
  v_mfma_f32_16x16x32_bf16 v[60:63], a[28:31], a[188:191], v[60:63]
  ds_read_b64_tr_b16 a[46:47], v3 offset:54272
  v_mfma_f32_16x16x32_bf16 v[56:59], a[28:31], a[184:187], v[56:59]
  ds_read_b64_tr_b16 a[60:61], v3 offset:58368
  buffer_load_dwordx4 a[244:247], v9, s[4:7], s63 offen offset:2048 sc1
  v_mfma_f32_16x16x32_bf16 v[56:59], a[12:15], a[176:179], v[56:59]
  ds_read_b64_tr_b16 a[62:63], v3 offset:62464
  s_waitcnt lgkmcnt(8)
  v_mfma_f32_16x16x32_bf16 v[64:67], a[32:35], a[176:179], v[64:67]
  s_add_u32 m0, s79, 24576
  ds_read_b64_tr_b16 a[0:1], v4 offset:0
  s_add_u32 s92, s92, 458752
  s_cmp_lg_u32 s91, 0
  v_mfma_f32_16x16x32_bf16 v[64:67], a[48:51], a[184:187], v[64:67]
  s_cselect_b32 s93, 1835008, 0
  ds_read_b64_tr_b16 a[2:3], v4 offset:4096
  s_add_u32 s93, s93, s92
  v_mfma_f32_16x16x32_bf16 v[68:71], a[48:51], a[188:191], v[68:71]
  ds_read_b64_tr_b16 a[16:17], v4 offset:8192
  buffer_load_dwordx4 v252, s[80:83], s93 offen lds
  v_mfma_f32_16x16x32_bf16 v[68:71], a[32:35], a[180:183], v[68:71]
  ds_read_b64_tr_b16 a[18:19], v4 offset:12288
  v_mfma_f32_16x16x32_bf16 v[76:79], a[36:39], a[180:183], v[76:79]
  ds_read_b64_tr_b16 a[4:5], v5 offset:0
  v_mfma_f32_16x16x32_bf16 v[76:79], a[52:55], a[188:191], v[76:79]
  ds_read_b64_tr_b16 a[6:7], v5 offset:4096
  v_mfma_f32_16x16x32_bf16 v[72:75], a[52:55], a[184:187], v[72:75]
  ds_read_b64_tr_b16 a[20:21], v5 offset:8192
  buffer_load_dwordx4 v252, s[84:87], s93 offen offset:1024 lds
  v_mfma_f32_16x16x32_bf16 v[72:75], a[36:39], a[176:179], v[72:75]
  ds_read_b64_tr_b16 a[22:23], v5 offset:12288
  s_waitcnt lgkmcnt(8)
  v_mfma_f32_16x16x32_bf16 v[80:83], a[40:43], a[176:179], v[80:83]
  ds_read_b64_tr_b16 a[8:9], v6 offset:0
  v_mfma_f32_16x16x32_bf16 v[80:83], a[56:59], a[184:187], v[80:83]
  s_min_u32 s63, s91, 4096
  ds_read_b64_tr_b16 a[10:11], v6 offset:4096
  s_add_u32 s63, s63, s48
  v_mfma_f32_16x16x32_bf16 v[84:87], a[56:59], a[188:191], v[84:87]
  ds_read_b64_tr_b16 a[24:25], v6 offset:8192
  buffer_load_dwordx4 a[248:251], v8, s[4:7], s63 offen offset:3072 sc1
  v_mfma_f32_16x16x32_bf16 v[84:87], a[40:43], a[180:183], v[84:87]
  ds_read_b64_tr_b16 a[26:27], v6 offset:12288
  v_mfma_f32_16x16x32_bf16 v[92:95], a[44:47], a[180:183], v[92:95]
  ds_read_b64_tr_b16 a[12:13], v7 offset:0
  v_mfma_f32_16x16x32_bf16 v[92:95], a[60:63], a[188:191], v[92:95]
  ds_read_b64_tr_b16 a[14:15], v7 offset:4096
  v_mfma_f32_16x16x32_bf16 v[88:91], a[60:63], a[184:187], v[88:91]
  ds_read_b64_tr_b16 a[28:29], v7 offset:8192
  buffer_load_dwordx4 a[252:255], v9, s[4:7], s63 offen offset:3072 sc1
  v_mfma_f32_16x16x32_bf16 v[88:91], a[44:47], a[176:179], v[88:91]
  ds_read_b64_tr_b16 a[30:31], v7 offset:12288
  s_waitcnt vmcnt(24) lgkmcnt(8)
  v_mfma_f32_16x16x32_bf16 v[32:35], a[0:3], a[192:195], v[32:35]
  s_waitcnt vmcnt(26)
  s_barrier
  ds_read_b64_tr_b16 a[32:33], v4 offset:16384
  s_add_u32 m0, s79, 32768
  s_add_u32 s92, s92, 458752
  s_cmp_lg_u32 s88, 0
  s_cselect_b32 s93, -2031616, 0
  s_cselect_b32 s43, s78, 0
  v_mfma_f32_16x16x32_bf16 v[32:35], a[16:19], a[200:203], v[32:35]
  s_sub_u32 s93, s93, s43
  ds_read_b64_tr_b16 a[34:35], v4 offset:20480
  s_add_u32 s93, s93, s92
  v_mfma_f32_16x16x32_bf16 v[36:39], a[16:19], a[204:207], v[36:39]
  ds_read_b64_tr_b16 a[48:49], v4 offset:24576
  buffer_load_dwordx4 v252, s[80:83], s93 offen lds
  v_mfma_f32_16x16x32_bf16 v[36:39], a[0:3], a[196:199], v[36:39]
  ds_read_b64_tr_b16 a[50:51], v4 offset:28672
  v_mfma_f32_16x16x32_bf16 v[44:47], a[4:7], a[196:199], v[44:47]
  ds_read_b64_tr_b16 a[36:37], v5 offset:16384
  buffer_load_dwordx4 v252, s[84:87], s93 offen offset:1024 lds
  v_mfma_f32_16x16x32_bf16 v[44:47], a[20:23], a[204:207], v[44:47]
  s_add_u32 s48, s48, 4096
  ds_read_b64_tr_b16 a[38:39], v5 offset:20480
  s_min_u32 s63, s88, 4096
  v_mfma_f32_16x16x32_bf16 v[40:43], a[20:23], a[200:203], v[40:43]
  s_add_u32 s63, s63, s48
  ds_read_b64_tr_b16 a[52:53], v5 offset:24576
  buffer_load_dwordx4 a[128:131], v8, s[4:7], s63 offen offset:0 sc1
  v_mfma_f32_16x16x32_bf16 v[40:43], a[4:7], a[192:195], v[40:43]
  ds_read_b64_tr_b16 a[54:55], v5 offset:28672
  s_waitcnt lgkmcnt(8)
  v_mfma_f32_16x16x32_bf16 v[48:51], a[8:11], a[192:195], v[48:51]
  s_add_u32 m0, s79, 40960
  ds_read_b64_tr_b16 a[40:41], v6 offset:16384
  buffer_load_dwordx4 a[132:135], v9, s[4:7], s63 offen offset:0 sc1
  s_add_u32 s92, s92, 458752
  s_cmp_lg_u32 s89, 0
  s_cselect_b32 s93, -2228224, 0
  s_cselect_b32 s43, s78, 0
  v_mfma_f32_16x16x32_bf16 v[48:51], a[24:27], a[200:203], v[48:51]
  s_sub_u32 s93, s93, s43
  ds_read_b64_tr_b16 a[42:43], v6 offset:20480
  s_add_u32 s93, s93, s92
  v_mfma_f32_16x16x32_bf16 v[52:55], a[24:27], a[204:207], v[52:55]
  ds_read_b64_tr_b16 a[56:57], v6 offset:24576
  buffer_load_dwordx4 v252, s[80:83], s93 offen lds
  v_mfma_f32_16x16x32_bf16 v[52:55], a[8:11], a[196:199], v[52:55]
  ds_read_b64_tr_b16 a[58:59], v6 offset:28672
  v_mfma_f32_16x16x32_bf16 v[60:63], a[12:15], a[196:199], v[60:63]
  ds_read_b64_tr_b16 a[44:45], v7 offset:16384
  buffer_load_dwordx4 v252, s[84:87], s93 offen offset:1024 lds
  v_mfma_f32_16x16x32_bf16 v[60:63], a[28:31], a[204:207], v[60:63]
  s_min_u32 s63, s89, 4096
  ds_read_b64_tr_b16 a[46:47], v7 offset:20480
  s_add_u32 s63, s63, s48
  v_mfma_f32_16x16x32_bf16 v[56:59], a[28:31], a[200:203], v[56:59]
  ds_read_b64_tr_b16 a[60:61], v7 offset:24576
  buffer_load_dwordx4 a[136:139], v8, s[4:7], s63 offen offset:1024 sc1
  v_mfma_f32_16x16x32_bf16 v[56:59], a[12:15], a[192:195], v[56:59]
  s_waitcnt vmcnt(23) lgkmcnt(7)
  ds_read_b64_tr_b16 a[62:63], v7 offset:28672
  buffer_load_dwordx4 a[140:143], v9, s[4:7], s63 offen offset:1024 sc1
  v_mfma_f32_16x16x32_bf16 v[32:35], a[32:35], a[208:211], v[32:35]
  s_add_u32 m0, s79, 49152
  ds_read_b64_tr_b16 a[0:1], v4 offset:32768
  s_add_u32 s92, s92, 458752
  s_cmp_lg_u32 s90, 0
  s_cselect_b32 s93, -2490368, 0
  s_cselect_b32 s43, s78, 0
  v_mfma_f32_16x16x32_bf16 v[32:35], a[48:51], a[216:219], v[32:35]
  s_sub_u32 s93, s93, s43
  ds_read_b64_tr_b16 a[2:3], v4 offset:36864
  s_add_u32 s93, s93, s92
  v_mfma_f32_16x16x32_bf16 v[36:39], a[48:51], a[220:223], v[36:39]
  ds_read_b64_tr_b16 a[16:17], v4 offset:40960
  buffer_load_dwordx4 v252, s[80:83], s93 offen lds
  v_mfma_f32_16x16x32_bf16 v[36:39], a[32:35], a[212:215], v[36:39]
  ds_read_b64_tr_b16 a[18:19], v4 offset:45056
  v_mfma_f32_16x16x32_bf16 v[44:47], a[36:39], a[212:215], v[44:47]
  ds_read_b64_tr_b16 a[4:5], v5 offset:32768
  buffer_load_dwordx4 v252, s[84:87], s93 offen offset:1024 lds
  v_mfma_f32_16x16x32_bf16 v[44:47], a[52:55], a[220:223], v[44:47]
  s_min_u32 s63, s90, 4096
  ds_read_b64_tr_b16 a[6:7], v5 offset:36864
  s_add_u32 s63, s63, s48
  v_mfma_f32_16x16x32_bf16 v[40:43], a[52:55], a[216:219], v[40:43]
  ds_read_b64_tr_b16 a[20:21], v5 offset:40960
  buffer_load_dwordx4 a[144:147], v8, s[4:7], s63 offen offset:2048 sc1
  v_mfma_f32_16x16x32_bf16 v[40:43], a[36:39], a[208:211], v[40:43]
  ds_read_b64_tr_b16 a[22:23], v5 offset:45056
  s_waitcnt lgkmcnt(8)
  v_mfma_f32_16x16x32_bf16 v[48:51], a[40:43], a[208:211], v[48:51]
  s_add_u32 m0, s79, 57344
  ds_read_b64_tr_b16 a[8:9], v6 offset:32768
  buffer_load_dwordx4 a[148:151], v9, s[4:7], s63 offen offset:2048 sc1
  s_add_u32 s92, s92, 458752
  s_cmp_lg_u32 s91, 0
  s_cselect_b32 s93, -2686976, 0
  s_cselect_b32 s43, s78, 0
  v_mfma_f32_16x16x32_bf16 v[48:51], a[56:59], a[216:219], v[48:51]
  s_sub_u32 s93, s93, s43
  ds_read_b64_tr_b16 a[10:11], v6 offset:36864
  s_add_u32 s93, s93, s92
  v_mfma_f32_16x16x32_bf16 v[52:55], a[56:59], a[220:223], v[52:55]
  ds_read_b64_tr_b16 a[24:25], v6 offset:40960
  buffer_load_dwordx4 v252, s[80:83], s93 offen lds
  v_mfma_f32_16x16x32_bf16 v[52:55], a[40:43], a[212:215], v[52:55]
  ds_read_b64_tr_b16 a[26:27], v6 offset:45056
  v_mfma_f32_16x16x32_bf16 v[60:63], a[44:47], a[212:215], v[60:63]
  ds_read_b64_tr_b16 a[12:13], v7 offset:32768
  buffer_load_dwordx4 v252, s[84:87], s93 offen offset:1024 lds
  v_mfma_f32_16x16x32_bf16 v[60:63], a[60:63], a[220:223], v[60:63]
  s_min_u32 s63, s91, 4096
  ds_read_b64_tr_b16 a[14:15], v7 offset:36864
  s_add_u32 s63, s63, s48
  v_mfma_f32_16x16x32_bf16 v[56:59], a[60:63], a[216:219], v[56:59]
  ds_read_b64_tr_b16 a[28:29], v7 offset:40960
  buffer_load_dwordx4 a[152:155], v8, s[4:7], s63 offen offset:3072 sc1
  v_mfma_f32_16x16x32_bf16 v[56:59], a[44:47], a[208:211], v[56:59]
  s_waitcnt vmcnt(23) lgkmcnt(7)
  ds_read_b64_tr_b16 a[30:31], v7 offset:45056
  buffer_load_dwordx4 a[156:159], v9, s[4:7], s63 offen offset:3072 sc1
  v_mfma_f32_16x16x32_bf16 v[32:35], a[0:3], a[224:227], v[32:35]
  s_waitcnt vmcnt(26)
  s_barrier
  ds_read_b64_tr_b16 a[32:33], v4 offset:49152
  v_mfma_f32_16x16x32_bf16 v[32:35], a[16:19], a[232:235], v[32:35]
  s_add_u32 s48, s48, 4096
  ds_read_b64_tr_b16 a[34:35], v4 offset:53248
  s_min_u32 s63, s88, 4096
  s_mul_i32 s63, s63, -13
  v_mfma_f32_16x16x32_bf16 v[36:39], a[16:19], a[236:239], v[36:39]
  s_add_u32 s63, s63, s48
  ds_read_b64_tr_b16 a[48:49], v4 offset:57344
  buffer_load_dwordx4 a[160:163], v8, s[4:7], s63 offen offset:0 sc1
  v_mfma_f32_16x16x32_bf16 v[36:39], a[0:3], a[228:231], v[36:39]
  ds_read_b64_tr_b16 a[50:51], v4 offset:61440
  v_mfma_f32_16x16x32_bf16 v[44:47], a[4:7], a[228:231], v[44:47]
  ds_read_b64_tr_b16 a[36:37], v5 offset:49152
  v_mfma_f32_16x16x32_bf16 v[44:47], a[20:23], a[236:239], v[44:47]
  ds_read_b64_tr_b16 a[38:39], v5 offset:53248
  v_mfma_f32_16x16x32_bf16 v[40:43], a[20:23], a[232:235], v[40:43]
  ds_read_b64_tr_b16 a[52:53], v5 offset:57344
  buffer_load_dwordx4 a[164:167], v9, s[4:7], s63 offen offset:0 sc1
  v_mfma_f32_16x16x32_bf16 v[40:43], a[4:7], a[224:227], v[40:43]
  ds_read_b64_tr_b16 a[54:55], v5 offset:61440
  s_waitcnt lgkmcnt(8)
  v_mfma_f32_16x16x32_bf16 v[48:51], a[8:11], a[224:227], v[48:51]
  ds_read_b64_tr_b16 a[40:41], v6 offset:49152
  v_mfma_f32_16x16x32_bf16 v[48:51], a[24:27], a[232:235], v[48:51]
  s_min_u32 s63, s89, 4096
  ds_read_b64_tr_b16 a[42:43], v6 offset:53248
  s_mul_i32 s63, s63, -13
  v_mfma_f32_16x16x32_bf16 v[52:55], a[24:27], a[236:239], v[52:55]
  s_add_u32 s63, s63, s48
  ds_read_b64_tr_b16 a[56:57], v6 offset:57344
  buffer_load_dwordx4 a[168:171], v8, s[4:7], s63 offen offset:1024 sc1
  v_mfma_f32_16x16x32_bf16 v[52:55], a[8:11], a[228:231], v[52:55]
  ds_read_b64_tr_b16 a[58:59], v6 offset:61440
  v_mfma_f32_16x16x32_bf16 v[60:63], a[12:15], a[228:231], v[60:63]
  ds_read_b64_tr_b16 a[44:45], v7 offset:49152
  v_mfma_f32_16x16x32_bf16 v[60:63], a[28:31], a[236:239], v[60:63]
  ds_read_b64_tr_b16 a[46:47], v7 offset:53248
  v_mfma_f32_16x16x32_bf16 v[56:59], a[28:31], a[232:235], v[56:59]
  ds_read_b64_tr_b16 a[60:61], v7 offset:57344
  buffer_load_dwordx4 a[172:175], v9, s[4:7], s63 offen offset:1024 sc1
  v_mfma_f32_16x16x32_bf16 v[56:59], a[12:15], a[224:227], v[56:59]
  ds_read_b64_tr_b16 a[62:63], v7 offset:61440
  s_waitcnt vmcnt(20) lgkmcnt(8)
  v_mfma_f32_16x16x32_bf16 v[32:35], a[32:35], a[240:243], v[32:35]
  ds_read_b64_tr_b16 a[0:1], v0 offset:0
  v_mfma_f32_16x16x32_bf16 v[32:35], a[48:51], a[248:251], v[32:35]
  s_min_u32 s63, s90, 4096
  ds_read_b64_tr_b16 a[2:3], v0 offset:4096
  s_mul_i32 s63, s63, -13
  v_mfma_f32_16x16x32_bf16 v[36:39], a[48:51], a[252:255], v[36:39]
  s_add_u32 s63, s63, s48
  ds_read_b64_tr_b16 a[16:17], v0 offset:8192
  buffer_load_dwordx4 a[176:179], v8, s[4:7], s63 offen offset:2048 sc1
  v_mfma_f32_16x16x32_bf16 v[36:39], a[32:35], a[244:247], v[36:39]
  ds_read_b64_tr_b16 a[18:19], v0 offset:12288
  v_mfma_f32_16x16x32_bf16 v[44:47], a[36:39], a[244:247], v[44:47]
  ds_read_b64_tr_b16 a[4:5], v1 offset:0
  v_mfma_f32_16x16x32_bf16 v[44:47], a[52:55], a[252:255], v[44:47]
  ds_read_b64_tr_b16 a[6:7], v1 offset:4096
  v_mfma_f32_16x16x32_bf16 v[40:43], a[52:55], a[248:251], v[40:43]
  ds_read_b64_tr_b16 a[20:21], v1 offset:8192
  buffer_load_dwordx4 a[180:183], v9, s[4:7], s63 offen offset:2048 sc1
  v_mfma_f32_16x16x32_bf16 v[40:43], a[36:39], a[240:243], v[40:43]
  ds_read_b64_tr_b16 a[22:23], v1 offset:12288
  s_waitcnt lgkmcnt(8)
  v_mfma_f32_16x16x32_bf16 v[48:51], a[40:43], a[240:243], v[48:51]
  ds_read_b64_tr_b16 a[8:9], v2 offset:0
  v_mfma_f32_16x16x32_bf16 v[48:51], a[56:59], a[248:251], v[48:51]
  s_min_u32 s63, s91, 4096
  ds_read_b64_tr_b16 a[10:11], v2 offset:4096
  s_mul_i32 s63, s63, -13
  v_mfma_f32_16x16x32_bf16 v[52:55], a[56:59], a[252:255], v[52:55]
  s_add_u32 s63, s63, s48
  ds_read_b64_tr_b16 a[24:25], v2 offset:8192
  buffer_load_dwordx4 a[184:187], v8, s[4:7], s63 offen offset:3072 sc1
  v_mfma_f32_16x16x32_bf16 v[52:55], a[40:43], a[244:247], v[52:55]
  ds_read_b64_tr_b16 a[26:27], v2 offset:12288
  v_mfma_f32_16x16x32_bf16 v[60:63], a[44:47], a[244:247], v[60:63]
  ds_read_b64_tr_b16 a[12:13], v3 offset:0
  v_mfma_f32_16x16x32_bf16 v[60:63], a[60:63], a[252:255], v[60:63]
  ds_read_b64_tr_b16 a[14:15], v3 offset:4096
  v_mfma_f32_16x16x32_bf16 v[56:59], a[60:63], a[248:251], v[56:59]
  ds_read_b64_tr_b16 a[28:29], v3 offset:8192
  buffer_load_dwordx4 a[188:191], v9, s[4:7], s63 offen offset:3072 sc1
  v_mfma_f32_16x16x32_bf16 v[56:59], a[44:47], a[240:243], v[56:59]
  ds_read_b64_tr_b16 a[30:31], v3 offset:12288
  s_waitcnt vmcnt(16) lgkmcnt(8)
  v_mfma_f32_16x16x32_bf16 v[32:35], a[0:3], a[128:131], v[32:35]
  s_waitcnt vmcnt(18)
  s_barrier
  ds_read_b64_tr_b16 a[32:33], v0 offset:16384
  v_mfma_f32_16x16x32_bf16 v[32:35], a[16:19], a[136:139], v[32:35]
  ds_read_b64_tr_b16 a[34:35], v0 offset:20480
  v_mfma_f32_16x16x32_bf16 v[36:39], a[16:19], a[140:143], v[36:39]
  ds_read_b64_tr_b16 a[48:49], v0 offset:24576
  v_mfma_f32_16x16x32_bf16 v[36:39], a[0:3], a[132:135], v[36:39]
  ds_read_b64_tr_b16 a[50:51], v0 offset:28672
  v_mfma_f32_16x16x32_bf16 v[44:47], a[4:7], a[132:135], v[44:47]
  ds_read_b64_tr_b16 a[36:37], v1 offset:16384
  v_mfma_f32_16x16x32_bf16 v[44:47], a[20:23], a[140:143], v[44:47]
  ds_read_b64_tr_b16 a[38:39], v1 offset:20480
  v_mfma_f32_16x16x32_bf16 v[40:43], a[20:23], a[136:139], v[40:43]
  ds_read_b64_tr_b16 a[52:53], v1 offset:24576
  v_mfma_f32_16x16x32_bf16 v[40:43], a[4:7], a[128:131], v[40:43]
  ds_read_b64_tr_b16 a[54:55], v1 offset:28672
  s_waitcnt lgkmcnt(8)
  v_mfma_f32_16x16x32_bf16 v[48:51], a[8:11], a[128:131], v[48:51]
  ds_read_b64_tr_b16 a[40:41], v2 offset:16384
  v_mfma_f32_16x16x32_bf16 v[48:51], a[24:27], a[136:139], v[48:51]
  ds_read_b64_tr_b16 a[42:43], v2 offset:20480
  v_mfma_f32_16x16x32_bf16 v[52:55], a[24:27], a[140:143], v[52:55]
  ds_read_b64_tr_b16 a[56:57], v2 offset:24576
  v_mfma_f32_16x16x32_bf16 v[52:55], a[8:11], a[132:135], v[52:55]
  ds_read_b64_tr_b16 a[58:59], v2 offset:28672
  v_mfma_f32_16x16x32_bf16 v[60:63], a[12:15], a[132:135], v[60:63]
  ds_read_b64_tr_b16 a[44:45], v3 offset:16384
  v_mfma_f32_16x16x32_bf16 v[60:63], a[28:31], a[140:143], v[60:63]
  ds_read_b64_tr_b16 a[46:47], v3 offset:20480
  v_mfma_f32_16x16x32_bf16 v[56:59], a[28:31], a[136:139], v[56:59]
  ds_read_b64_tr_b16 a[60:61], v3 offset:24576
  v_mfma_f32_16x16x32_bf16 v[56:59], a[12:15], a[128:131], v[56:59]
  ds_read_b64_tr_b16 a[62:63], v3 offset:28672
  s_waitcnt vmcnt(8) lgkmcnt(8)
  v_mfma_f32_16x16x32_bf16 v[32:35], a[32:35], a[144:147], v[32:35]
  ds_read_b64_tr_b16 a[0:1], v0 offset:32768
  v_mfma_f32_16x16x32_bf16 v[32:35], a[48:51], a[152:155], v[32:35]
  ds_read_b64_tr_b16 a[2:3], v0 offset:36864
  v_mfma_f32_16x16x32_bf16 v[36:39], a[48:51], a[156:159], v[36:39]
  ds_read_b64_tr_b16 a[16:17], v0 offset:40960
  v_mfma_f32_16x16x32_bf16 v[36:39], a[32:35], a[148:151], v[36:39]
  ds_read_b64_tr_b16 a[18:19], v0 offset:45056
  v_mfma_f32_16x16x32_bf16 v[44:47], a[36:39], a[148:151], v[44:47]
  ds_read_b64_tr_b16 a[4:5], v1 offset:32768
  v_mfma_f32_16x16x32_bf16 v[44:47], a[52:55], a[156:159], v[44:47]
  ds_read_b64_tr_b16 a[6:7], v1 offset:36864
  v_mfma_f32_16x16x32_bf16 v[40:43], a[52:55], a[152:155], v[40:43]
  ds_read_b64_tr_b16 a[20:21], v1 offset:40960
  v_mfma_f32_16x16x32_bf16 v[40:43], a[36:39], a[144:147], v[40:43]
  ds_read_b64_tr_b16 a[22:23], v1 offset:45056
  s_waitcnt lgkmcnt(8)
  v_mfma_f32_16x16x32_bf16 v[48:51], a[40:43], a[144:147], v[48:51]
  ds_read_b64_tr_b16 a[8:9], v2 offset:32768
  v_mfma_f32_16x16x32_bf16 v[48:51], a[56:59], a[152:155], v[48:51]
  ds_read_b64_tr_b16 a[10:11], v2 offset:36864
  v_mfma_f32_16x16x32_bf16 v[52:55], a[56:59], a[156:159], v[52:55]
  ds_read_b64_tr_b16 a[24:25], v2 offset:40960
  v_mfma_f32_16x16x32_bf16 v[52:55], a[40:43], a[148:151], v[52:55]
  ds_read_b64_tr_b16 a[26:27], v2 offset:45056
  v_mfma_f32_16x16x32_bf16 v[60:63], a[44:47], a[148:151], v[60:63]
  ds_read_b64_tr_b16 a[12:13], v3 offset:32768
  v_mfma_f32_16x16x32_bf16 v[60:63], a[60:63], a[156:159], v[60:63]
  ds_read_b64_tr_b16 a[14:15], v3 offset:36864
  v_mfma_f32_16x16x32_bf16 v[56:59], a[60:63], a[152:155], v[56:59]
  ds_read_b64_tr_b16 a[28:29], v3 offset:40960
  v_mfma_f32_16x16x32_bf16 v[56:59], a[44:47], a[144:147], v[56:59]
  ds_read_b64_tr_b16 a[30:31], v3 offset:45056
  s_waitcnt vmcnt(4) lgkmcnt(8)
  v_mfma_f32_16x16x32_bf16 v[32:35], a[0:3], a[160:163], v[32:35]
  s_waitcnt vmcnt(10)
  s_barrier
  ds_read_b64_tr_b16 a[32:33], v0 offset:49152
  v_mfma_f32_16x16x32_bf16 v[32:35], a[16:19], a[168:171], v[32:35]
  ds_read_b64_tr_b16 a[34:35], v0 offset:53248
  v_mfma_f32_16x16x32_bf16 v[36:39], a[16:19], a[172:175], v[36:39]
  ds_read_b64_tr_b16 a[48:49], v0 offset:57344
  v_mfma_f32_16x16x32_bf16 v[36:39], a[0:3], a[164:167], v[36:39]
  ds_read_b64_tr_b16 a[50:51], v0 offset:61440
  v_mfma_f32_16x16x32_bf16 v[44:47], a[4:7], a[164:167], v[44:47]
  ds_read_b64_tr_b16 a[36:37], v1 offset:49152
  v_mfma_f32_16x16x32_bf16 v[44:47], a[20:23], a[172:175], v[44:47]
  ds_read_b64_tr_b16 a[38:39], v1 offset:53248
  v_mfma_f32_16x16x32_bf16 v[40:43], a[20:23], a[168:171], v[40:43]
  ds_read_b64_tr_b16 a[52:53], v1 offset:57344
  v_mfma_f32_16x16x32_bf16 v[40:43], a[4:7], a[160:163], v[40:43]
  ds_read_b64_tr_b16 a[54:55], v1 offset:61440
  s_waitcnt lgkmcnt(8)
  v_mfma_f32_16x16x32_bf16 v[48:51], a[8:11], a[160:163], v[48:51]
  ds_read_b64_tr_b16 a[40:41], v2 offset:49152
  v_mfma_f32_16x16x32_bf16 v[48:51], a[24:27], a[168:171], v[48:51]
  ds_read_b64_tr_b16 a[42:43], v2 offset:53248
  v_mfma_f32_16x16x32_bf16 v[52:55], a[24:27], a[172:175], v[52:55]
  ds_read_b64_tr_b16 a[56:57], v2 offset:57344
  v_mfma_f32_16x16x32_bf16 v[52:55], a[8:11], a[164:167], v[52:55]
  ds_read_b64_tr_b16 a[58:59], v2 offset:61440
  v_mfma_f32_16x16x32_bf16 v[60:63], a[12:15], a[164:167], v[60:63]
  ds_read_b64_tr_b16 a[44:45], v3 offset:49152
  v_mfma_f32_16x16x32_bf16 v[60:63], a[28:31], a[172:175], v[60:63]
  ds_read_b64_tr_b16 a[46:47], v3 offset:53248
  v_mfma_f32_16x16x32_bf16 v[56:59], a[28:31], a[168:171], v[56:59]
  ds_read_b64_tr_b16 a[60:61], v3 offset:57344
  v_mfma_f32_16x16x32_bf16 v[56:59], a[12:15], a[160:163], v[56:59]
  ds_read_b64_tr_b16 a[62:63], v3 offset:61440
  s_waitcnt vmcnt(0) lgkmcnt(8)
  v_mfma_f32_16x16x32_bf16 v[32:35], a[32:35], a[176:179], v[32:35]
  ds_read_b64_tr_b16 a[0:1], v4 offset:1024
  v_mfma_f32_16x16x32_bf16 v[32:35], a[48:51], a[184:187], v[32:35]
  ds_read_b64_tr_b16 a[2:3], v4 offset:5120
  v_mfma_f32_16x16x32_bf16 v[36:39], a[48:51], a[188:191], v[36:39]
  ds_read_b64_tr_b16 a[16:17], v4 offset:9216
  v_mfma_f32_16x16x32_bf16 v[36:39], a[32:35], a[180:183], v[36:39]
  ds_read_b64_tr_b16 a[18:19], v4 offset:13312
  v_mfma_f32_16x16x32_bf16 v[44:47], a[36:39], a[180:183], v[44:47]
  ds_read_b64_tr_b16 a[4:5], v5 offset:1024
  v_mfma_f32_16x16x32_bf16 v[44:47], a[52:55], a[188:191], v[44:47]
  ds_read_b64_tr_b16 a[6:7], v5 offset:5120
  v_mfma_f32_16x16x32_bf16 v[40:43], a[52:55], a[184:187], v[40:43]
  ds_read_b64_tr_b16 a[20:21], v5 offset:9216
  v_mfma_f32_16x16x32_bf16 v[40:43], a[36:39], a[176:179], v[40:43]
  ds_read_b64_tr_b16 a[22:23], v5 offset:13312
  s_waitcnt lgkmcnt(8)
  v_mfma_f32_16x16x32_bf16 v[48:51], a[40:43], a[176:179], v[48:51]
  ds_read_b64_tr_b16 a[8:9], v6 offset:1024
  v_mfma_f32_16x16x32_bf16 v[48:51], a[56:59], a[184:187], v[48:51]
  ds_read_b64_tr_b16 a[10:11], v6 offset:5120
  v_mfma_f32_16x16x32_bf16 v[52:55], a[56:59], a[188:191], v[52:55]
  ds_read_b64_tr_b16 a[24:25], v6 offset:9216
  v_mfma_f32_16x16x32_bf16 v[52:55], a[40:43], a[180:183], v[52:55]
  ds_read_b64_tr_b16 a[26:27], v6 offset:13312
  v_mfma_f32_16x16x32_bf16 v[60:63], a[44:47], a[180:183], v[60:63]
  ds_read_b64_tr_b16 a[12:13], v7 offset:1024
  v_mfma_f32_16x16x32_bf16 v[60:63], a[60:63], a[188:191], v[60:63]
  ds_read_b64_tr_b16 a[14:15], v7 offset:5120
  v_mfma_f32_16x16x32_bf16 v[56:59], a[60:63], a[184:187], v[56:59]
  ds_read_b64_tr_b16 a[28:29], v7 offset:9216
  v_mfma_f32_16x16x32_bf16 v[56:59], a[44:47], a[176:179], v[56:59]
  ds_read_b64_tr_b16 a[30:31], v7 offset:13312
  s_waitcnt lgkmcnt(8)
  v_mfma_f32_16x16x32_bf16 v[64:67], a[0:3], a[192:195], v[64:67]
  s_lshl_b32 s45, s2, 2
  ds_read_b64_tr_b16 a[32:33], v4 offset:17408
  s_add_u32 s45, s45, s40
  v_mfma_f32_16x16x32_bf16 v[64:67], a[16:19], a[200:203], v[64:67]
  s_lshl_b32 s45, s45, 12
  ds_read_b64_tr_b16 a[34:35], v4 offset:21504
  s_xor_b32 s44, s45, 32768
  v_mfma_f32_16x16x32_bf16 v[68:71], a[16:19], a[204:207], v[68:71]
  s_add_u32 s43, s42, 28311552
  ds_read_b64_tr_b16 a[48:49], v4 offset:25600
  s_add_u32 s44, s44, s43
  v_mfma_f32_16x16x32_bf16 v[68:71], a[0:3], a[196:199], v[68:71]
  s_add_u32 s45, s45, s43
  ds_read_b64_tr_b16 a[50:51], v4 offset:29696
  v_cvt_pk_bf16_f32 v16, v32, v33
  v_mfma_f32_16x16x32_bf16 v[76:79], a[4:7], a[196:199], v[76:79]
  ds_read_b64_tr_b16 a[36:37], v5 offset:17408
  v_cvt_pk_bf16_f32 v17, v34, v35
  v_cvt_pk_bf16_f32 v18, v40, v41
  v_mfma_f32_16x16x32_bf16 v[76:79], a[20:23], a[204:207], v[76:79]
  ds_read_b64_tr_b16 a[38:39], v5 offset:21504
  v_cvt_pk_bf16_f32 v19, v42, v43
  buffer_store_dwordx4 v[16:19], v8, s[4:7], s44 offen offset:0 sc1
  v_mfma_f32_16x16x32_bf16 v[72:75], a[20:23], a[200:203], v[72:75]
  ds_read_b64_tr_b16 a[52:53], v5 offset:25600
  v_cvt_pk_bf16_f32 v24, v36, v37
  v_cvt_pk_bf16_f32 v25, v38, v39
  v_mfma_f32_16x16x32_bf16 v[72:75], a[4:7], a[192:195], v[72:75]
  s_waitcnt lgkmcnt(7)
  ds_read_b64_tr_b16 a[54:55], v5 offset:29696
  v_cvt_pk_bf16_f32 v26, v44, v45
  v_cvt_pk_bf16_f32 v27, v46, v47
  v_mfma_f32_16x16x32_bf16 v[80:83], a[8:11], a[192:195], v[80:83]
  ds_read_b64_tr_b16 a[40:41], v6 offset:17408
  buffer_store_dwordx4 v[24:27], v8, s[4:7], s44 offen offset:2048 sc1
  v_cvt_pk_bf16_f32 v20, v48, v49
  v_mfma_f32_16x16x32_bf16 v[80:83], a[24:27], a[200:203], v[80:83]
  ds_read_b64_tr_b16 a[42:43], v6 offset:21504
  v_cvt_pk_bf16_f32 v21, v50, v51
  v_cvt_pk_bf16_f32 v22, v56, v57
  v_mfma_f32_16x16x32_bf16 v[84:87], a[24:27], a[204:207], v[84:87]
  ds_read_b64_tr_b16 a[56:57], v6 offset:25600
  v_cvt_pk_bf16_f32 v23, v58, v59
  buffer_store_dwordx4 v[20:23], v8, s[4:7], s44 offen offset:1024 sc1
  v_mfma_f32_16x16x32_bf16 v[84:87], a[8:11], a[196:199], v[84:87]
  ds_read_b64_tr_b16 a[58:59], v6 offset:29696
  v_cvt_pk_bf16_f32 v28, v52, v53
  v_cvt_pk_bf16_f32 v29, v54, v55
  v_mfma_f32_16x16x32_bf16 v[92:95], a[12:15], a[196:199], v[92:95]
  ds_read_b64_tr_b16 a[44:45], v7 offset:17408
  v_cvt_pk_bf16_f32 v30, v60, v61
  v_cvt_pk_bf16_f32 v31, v62, v63
  v_mfma_f32_16x16x32_bf16 v[92:95], a[28:31], a[204:207], v[92:95]
  ds_read_b64_tr_b16 a[46:47], v7 offset:21504
  buffer_store_dwordx4 v[28:31], v8, s[4:7], s44 offen offset:3072 sc1
  v_mfma_f32_16x16x32_bf16 v[88:91], a[28:31], a[200:203], v[88:91]
  ds_read_b64_tr_b16 a[60:61], v7 offset:25600
  v_mfma_f32_16x16x32_bf16 v[88:91], a[12:15], a[192:195], v[88:91]
  ds_read_b64_tr_b16 a[62:63], v7 offset:29696
  s_waitcnt lgkmcnt(8)
  v_mfma_f32_16x16x32_bf16 v[64:67], a[32:35], a[208:211], v[64:67]
  ds_read_b64_tr_b16 a[0:1], v4 offset:33792
  v_and_b32 v148, 15, v253
  v_mfma_f32_16x16x32_bf16 v[64:67], a[48:51], a[216:219], v[64:67]
  ds_read_b64_tr_b16 a[2:3], v4 offset:37888
  v_lshrrev_b32 v149, 4, v253
  v_mfma_f32_16x16x32_bf16 v[68:71], a[48:51], a[220:223], v[68:71]
  ds_read_b64_tr_b16 a[16:17], v4 offset:41984
  v_lshrrev_b32 v128, 2, v148
  v_mfma_f32_16x16x32_bf16 v[68:71], a[32:35], a[212:215], v[68:71]
  ds_read_b64_tr_b16 a[18:19], v4 offset:46080
  v_cmp_eq_u32 vcc, v128, v149
  v_mfma_f32_16x16x32_bf16 v[76:79], a[36:39], a[212:215], v[76:79]
  ds_read_b64_tr_b16 a[4:5], v5 offset:33792
  v_and_b32 v128, 3, v148
  v_mfma_f32_16x16x32_bf16 v[76:79], a[52:55], a[220:223], v[76:79]
  ds_read_b64_tr_b16 a[6:7], v5 offset:37888
  v_lshlrev_b32 v148, 3, v148
  v_mfma_f32_16x16x32_bf16 v[72:75], a[52:55], a[216:219], v[72:75]
  ds_read_b64_tr_b16 a[20:21], v5 offset:41984
  v_mov_b32 v149, 0x7ffffff0
  v_mfma_f32_16x16x32_bf16 v[72:75], a[36:39], a[208:211], v[72:75]
  s_waitcnt lgkmcnt(7)
  ds_read_b64_tr_b16 a[22:23], v5 offset:46080
  v_cndmask_b32 v148, v149, v148, vcc
  v_mfma_f32_16x16x32_bf16 v[80:83], a[40:43], a[208:211], v[80:83]
  ds_read_b64_tr_b16 a[8:9], v6 offset:33792
  v_cmp_eq_u32 s[66:67], 1, v128
  v_mfma_f32_16x16x32_bf16 v[80:83], a[56:59], a[216:219], v[80:83]
  ds_read_b64_tr_b16 a[10:11], v6 offset:37888
  v_cmp_eq_u32 s[68:69], 2, v128
  v_mfma_f32_16x16x32_bf16 v[84:87], a[56:59], a[220:223], v[84:87]
  ds_read_b64_tr_b16 a[24:25], v6 offset:41984
  v_cmp_eq_u32 s[70:71], 3, v128
  v_mfma_f32_16x16x32_bf16 v[84:87], a[40:43], a[212:215], v[84:87]
  ds_read_b64_tr_b16 a[26:27], v6 offset:46080
  v_mov_b32 v128, 0x3f803f80
  v_mfma_f32_16x16x32_bf16 v[92:95], a[44:47], a[212:215], v[92:95]
  ds_read_b64_tr_b16 a[12:13], v7 offset:33792
  v_mov_b32 v129, 0x3f803f80
  v_mfma_f32_16x16x32_bf16 v[92:95], a[60:63], a[220:223], v[92:95]
  ds_read_b64_tr_b16 a[14:15], v7 offset:37888
  v_mov_b32 v130, 0x3f803f80
  v_mfma_f32_16x16x32_bf16 v[88:91], a[60:63], a[216:219], v[88:91]
  ds_read_b64_tr_b16 a[28:29], v7 offset:41984
  v_mov_b32 v131, 0x3f803f80
  v_mfma_f32_16x16x32_bf16 v[88:91], a[44:47], a[208:211], v[88:91]
  ds_read_b64_tr_b16 a[30:31], v7 offset:46080
  s_waitcnt lgkmcnt(8)
  v_mfma_f32_16x16x32_bf16 v[64:67], a[0:3], a[224:227], v[64:67]
  ds_read_b64_tr_b16 a[32:33], v4 offset:50176
  v_and_b32 v152, 15, v253
  v_lshrrev_b32 v153, 4, v253
  v_mfma_f32_16x16x32_bf16 v[64:67], a[16:19], a[232:235], v[64:67]
  ds_read_b64_tr_b16 a[34:35], v4 offset:54272
  v_lshrrev_b32 v155, 1, v153
  v_and_b32 v153, 1, v153
  v_mfma_f32_16x16x32_bf16 v[68:71], a[16:19], a[236:239], v[68:71]
  ds_read_b64_tr_b16 a[48:49], v4 offset:58368
  v_lshl_add_u32 v153, v153, 1, v155
  v_and_b32 v155, 7, v253
  v_mfma_f32_16x16x32_bf16 v[68:71], a[0:3], a[228:231], v[68:71]
  ds_read_b64_tr_b16 a[50:51], v4 offset:62464
  v_xor_b32 v153, v153, v155
  v_lshlrev_b32 v153, 4, v153
  v_mfma_f32_16x16x32_bf16 v[76:79], a[4:7], a[228:231], v[76:79]
  s_lshl_b32 s43, s40, 12
  ds_read_b64_tr_b16 a[36:37], v5 offset:50176
  v_lshl_add_u32 v152, v152, 7, v153
  v_mfma_f32_16x16x32_bf16 v[76:79], a[20:23], a[236:239], v[76:79]
  ds_read_b64_tr_b16 a[38:39], v5 offset:54272
  v_add_u32 v152, s43, v152
  v_xor_b32 v153, 64, v152
  v_mfma_f32_16x16x32_bf16 v[72:75], a[20:23], a[232:235], v[72:75]
  ds_read_b64_tr_b16 a[52:53], v5 offset:58368
  v_lshrrev_b32 v156, 3, v253
  v_xor_b32 v154, v156, v155
  v_mfma_f32_16x16x32_bf16 v[72:75], a[4:7], a[224:227], v[72:75]
  s_waitcnt lgkmcnt(7)
  ds_read_b64_tr_b16 a[54:55], v5 offset:62464
  v_lshlrev_b32 v154, 4, v154
  v_lshl_add_u32 v154, v156, 7, v154
  v_mfma_f32_16x16x32_bf16 v[80:83], a[8:11], a[224:227], v[80:83]
  ds_read_b64_tr_b16 a[40:41], v6 offset:50176
  v_add_u32 v154, s43, v154
  v_lshlrev_b32 v155, 4, v155
  v_mfma_f32_16x16x32_bf16 v[80:83], a[24:27], a[232:235], v[80:83]
  ds_read_b64_tr_b16 a[42:43], v6 offset:54272
  v_lshl_add_u32 v155, v156, 12, v155
  v_mfma_f32_16x16x32_bf16 v[84:87], a[24:27], a[236:239], v[84:87]
  ds_read_b64_tr_b16 a[56:57], v6 offset:58368
  v_mfma_f32_16x16x32_bf16 v[84:87], a[8:11], a[228:231], v[84:87]
  ds_read_b64_tr_b16 a[58:59], v6 offset:62464
  v_mfma_f32_16x16x32_bf16 v[92:95], a[12:15], a[228:231], v[92:95]
  ds_read_b64_tr_b16 a[44:45], v7 offset:50176
  v_mfma_f32_16x16x32_bf16 v[92:95], a[28:31], a[236:239], v[92:95]
  ds_read_b64_tr_b16 a[46:47], v7 offset:54272
  v_mfma_f32_16x16x32_bf16 v[88:91], a[28:31], a[232:235], v[88:91]
  ds_read_b64_tr_b16 a[60:61], v7 offset:58368
  v_mfma_f32_16x16x32_bf16 v[88:91], a[12:15], a[224:227], v[88:91]
  ds_read_b64_tr_b16 a[62:63], v7 offset:62464
  s_waitcnt lgkmcnt(8)
  v_mfma_f32_16x16x32_bf16 v[64:67], a[32:35], a[240:243], v[64:67]
  s_add_u32 s46, s76, 41943040
  ds_read_b64_tr_b16 a[0:1], v0 offset:1024
  s_add_u32 s47, s46, 32768
  v_mfma_f32_16x16x32_bf16 v[64:67], a[48:51], a[248:251], v[64:67]
  s_lshl_b32 s48, s49, 11
  ds_read_b64_tr_b16 a[2:3], v0 offset:5120
  s_lshl_b32 s43, s53, 7
  v_mfma_f32_16x16x32_bf16 v[68:71], a[48:51], a[252:255], v[68:71]
  s_add_u32 s48, s48, s43
  ds_read_b64_tr_b16 a[16:17], v0 offset:9216
  s_add_u32 s48, s48, 69206016
  v_mfma_f32_16x16x32_bf16 v[68:71], a[32:35], a[244:247], v[68:71]
  s_and_b32 s57, s49, 63
  ds_read_b64_tr_b16 a[18:19], v0 offset:13312
  s_lshl_b32 s57, s57, 16
  v_mfma_f32_16x16x32_bf16 v[76:79], a[36:39], a[244:247], v[76:79]
  s_add_u32 s57, s57, s43
  ds_read_b64_tr_b16 a[4:5], v1 offset:1024
  s_lshr_b32 s43, s49, 6
  v_mfma_f32_16x16x32_bf16 v[76:79], a[52:55], a[252:255], v[76:79]
  s_lshl_b32 s43, s43, 11
  ds_read_b64_tr_b16 a[6:7], v1 offset:5120
  s_add_u32 s57, s57, s43
  v_mfma_f32_16x16x32_bf16 v[72:75], a[52:55], a[248:251], v[72:75]
  s_and_b32 s43, s53, 1
  ds_read_b64_tr_b16 a[20:21], v1 offset:9216
  s_mul_i32 s77, s52, 2
  v_mfma_f32_16x16x32_bf16 v[72:75], a[36:39], a[240:243], v[72:75]
  s_add_u32 s77, s77, s43
  ds_read_b64_tr_b16 a[22:23], v1 offset:13312
  s_lshl_b32 s77, s77, 7
  s_waitcnt lgkmcnt(8)
  v_mfma_f32_16x16x32_bf16 v[80:83], a[40:43], a[240:243], v[80:83]
  ds_read_b64_tr_b16 a[8:9], v2 offset:1024
  s_add_u32 s77, s77, 27811840
  v_mfma_f32_16x16x32_bf16 v[80:83], a[56:59], a[248:251], v[80:83]
  ds_read_b64_tr_b16 a[10:11], v2 offset:5120
  v_mfma_f32_16x16x32_bf16 v[84:87], a[56:59], a[252:255], v[84:87]
  ds_read_b64_tr_b16 a[24:25], v2 offset:9216
  v_mfma_f32_16x16x32_bf16 v[84:87], a[40:43], a[244:247], v[84:87]
  ds_read_b64_tr_b16 a[26:27], v2 offset:13312
  v_mfma_f32_16x16x32_bf16 v[92:95], a[44:47], a[244:247], v[92:95]
  ds_read_b64_tr_b16 a[12:13], v3 offset:1024
  v_mfma_f32_16x16x32_bf16 v[92:95], a[60:63], a[252:255], v[92:95]
  ds_read_b64_tr_b16 a[14:15], v3 offset:5120
  v_mfma_f32_16x16x32_bf16 v[88:91], a[60:63], a[248:251], v[88:91]
  ds_read_b64_tr_b16 a[28:29], v3 offset:9216
  v_mfma_f32_16x16x32_bf16 v[88:91], a[44:47], a[240:243], v[88:91]
  ds_read_b64_tr_b16 a[30:31], v3 offset:13312
  s_waitcnt lgkmcnt(8)
  v_mfma_f32_16x16x32_bf16 v[64:67], a[0:3], a[128:131], v[64:67]
  ds_read_b64_tr_b16 a[32:33], v0 offset:17408
  v_mfma_f32_16x16x32_bf16 v[64:67], a[16:19], a[136:139], v[64:67]
  ds_read_b64_tr_b16 a[34:35], v0 offset:21504
  v_mfma_f32_16x16x32_bf16 v[68:71], a[16:19], a[140:143], v[68:71]
  ds_read_b64_tr_b16 a[48:49], v0 offset:25600
  v_mfma_f32_16x16x32_bf16 v[68:71], a[0:3], a[132:135], v[68:71]
  ds_read_b64_tr_b16 a[50:51], v0 offset:29696
  v_mfma_f32_16x16x32_bf16 v[76:79], a[4:7], a[132:135], v[76:79]
  ds_read_b64_tr_b16 a[36:37], v1 offset:17408
  v_mfma_f32_16x16x32_bf16 v[76:79], a[20:23], a[140:143], v[76:79]
  ds_read_b64_tr_b16 a[38:39], v1 offset:21504
  v_mfma_f32_16x16x32_bf16 v[72:75], a[20:23], a[136:139], v[72:75]
  ds_read_b64_tr_b16 a[52:53], v1 offset:25600
  v_mfma_f32_16x16x32_bf16 v[72:75], a[4:7], a[128:131], v[72:75]
  ds_read_b64_tr_b16 a[54:55], v1 offset:29696
  s_waitcnt lgkmcnt(8)
  v_mfma_f32_16x16x32_bf16 v[80:83], a[8:11], a[128:131], v[80:83]
  ds_read_b64_tr_b16 a[40:41], v2 offset:17408
  v_mfma_f32_16x16x32_bf16 v[80:83], a[24:27], a[136:139], v[80:83]
  ds_read_b64_tr_b16 a[42:43], v2 offset:21504
  v_mfma_f32_16x16x32_bf16 v[84:87], a[24:27], a[140:143], v[84:87]
  ds_read_b64_tr_b16 a[56:57], v2 offset:25600
  v_mfma_f32_16x16x32_bf16 v[84:87], a[8:11], a[132:135], v[84:87]
  ds_read_b64_tr_b16 a[58:59], v2 offset:29696
  v_mfma_f32_16x16x32_bf16 v[92:95], a[12:15], a[132:135], v[92:95]
  ds_read_b64_tr_b16 a[44:45], v3 offset:17408
  v_mfma_f32_16x16x32_bf16 v[92:95], a[28:31], a[140:143], v[92:95]
  ds_read_b64_tr_b16 a[46:47], v3 offset:21504
  v_mfma_f32_16x16x32_bf16 v[88:91], a[28:31], a[136:139], v[88:91]
  ds_read_b64_tr_b16 a[60:61], v3 offset:25600
  v_mfma_f32_16x16x32_bf16 v[88:91], a[12:15], a[128:131], v[88:91]
  ds_read_b64_tr_b16 a[62:63], v3 offset:29696
  s_waitcnt lgkmcnt(8)
  v_mfma_f32_16x16x32_bf16 v[64:67], a[32:35], a[144:147], v[64:67]
  ds_read_b64_tr_b16 a[0:1], v0 offset:33792
  v_mfma_f32_16x16x32_bf16 v[64:67], a[48:51], a[152:155], v[64:67]
  ds_read_b64_tr_b16 a[2:3], v0 offset:37888
  v_mfma_f32_16x16x32_bf16 v[68:71], a[48:51], a[156:159], v[68:71]
  ds_read_b64_tr_b16 a[16:17], v0 offset:41984
  v_mfma_f32_16x16x32_bf16 v[68:71], a[32:35], a[148:151], v[68:71]
  ds_read_b64_tr_b16 a[18:19], v0 offset:46080
  v_mfma_f32_16x16x32_bf16 v[76:79], a[36:39], a[148:151], v[76:79]
  ds_read_b64_tr_b16 a[4:5], v1 offset:33792
  buffer_load_dwordx4 v[96:99], v8, s[4:7], s45 offen offset:0 sc1
  buffer_load_dwordx4 v[100:103], v8, s[4:7], s45 offen offset:1024 sc1
  v_mfma_f32_16x16x32_bf16 v[76:79], a[52:55], a[156:159], v[76:79]
  ds_read_b64_tr_b16 a[6:7], v1 offset:37888
  v_mfma_f32_16x16x32_bf16 v[72:75], a[52:55], a[152:155], v[72:75]
  ds_read_b64_tr_b16 a[20:21], v1 offset:41984
  buffer_load_dwordx4 v[104:107], v8, s[4:7], s45 offen offset:2048 sc1
  buffer_load_dwordx4 v[108:111], v8, s[4:7], s45 offen offset:3072 sc1
  v_mfma_f32_16x16x32_bf16 v[72:75], a[36:39], a[144:147], v[72:75]
  ds_read_b64_tr_b16 a[22:23], v1 offset:46080
  s_waitcnt lgkmcnt(8)
  v_mfma_f32_16x16x32_bf16 v[80:83], a[40:43], a[144:147], v[80:83]
  ds_read_b64_tr_b16 a[8:9], v2 offset:33792
  v_mfma_f32_16x16x32_bf16 v[80:83], a[56:59], a[152:155], v[80:83]
  ds_read_b64_tr_b16 a[10:11], v2 offset:37888
  v_mfma_f32_16x16x32_bf16 v[84:87], a[56:59], a[156:159], v[84:87]
  ds_read_b64_tr_b16 a[24:25], v2 offset:41984
  v_mfma_f32_16x16x32_bf16 v[84:87], a[40:43], a[148:151], v[84:87]
  ds_read_b64_tr_b16 a[26:27], v2 offset:46080
  v_mfma_f32_16x16x32_bf16 v[92:95], a[44:47], a[148:151], v[92:95]
  ds_read_b64_tr_b16 a[12:13], v3 offset:33792
  v_mfma_f32_16x16x32_bf16 v[92:95], a[60:63], a[156:159], v[92:95]
  ds_read_b64_tr_b16 a[14:15], v3 offset:37888
  v_mfma_f32_16x16x32_bf16 v[88:91], a[60:63], a[152:155], v[88:91]
  ds_read_b64_tr_b16 a[28:29], v3 offset:41984
  v_mfma_f32_16x16x32_bf16 v[88:91], a[44:47], a[144:147], v[88:91]
  ds_read_b64_tr_b16 a[30:31], v3 offset:46080
  s_waitcnt lgkmcnt(8)
  v_mfma_f32_16x16x32_bf16 v[64:67], a[0:3], a[160:163], v[64:67]
  ds_read_b64_tr_b16 a[32:33], v0 offset:50176
  v_mfma_f32_16x16x32_bf16 v[64:67], a[16:19], a[168:171], v[64:67]
  ds_read_b64_tr_b16 a[34:35], v0 offset:54272
  v_mfma_f32_16x16x32_bf16 v[68:71], a[16:19], a[172:175], v[68:71]
  ds_read_b64_tr_b16 a[48:49], v0 offset:58368
  v_mfma_f32_16x16x32_bf16 v[68:71], a[0:3], a[164:167], v[68:71]
  ds_read_b64_tr_b16 a[50:51], v0 offset:62464
  v_mfma_f32_16x16x32_bf16 v[76:79], a[4:7], a[164:167], v[76:79]
  ds_read_b64_tr_b16 a[36:37], v1 offset:50176
  v_mfma_f32_16x16x32_bf16 v[76:79], a[20:23], a[172:175], v[76:79]
  ds_read_b64_tr_b16 a[38:39], v1 offset:54272
  v_mfma_f32_16x16x32_bf16 v[72:75], a[20:23], a[168:171], v[72:75]
  ds_read_b64_tr_b16 a[52:53], v1 offset:58368
  v_mfma_f32_16x16x32_bf16 v[72:75], a[4:7], a[160:163], v[72:75]
  ds_read_b64_tr_b16 a[54:55], v1 offset:62464
  s_waitcnt lgkmcnt(8)
  v_mfma_f32_16x16x32_bf16 v[80:83], a[8:11], a[160:163], v[80:83]
  ds_read_b64_tr_b16 a[40:41], v2 offset:50176
  v_mfma_f32_16x16x32_bf16 v[80:83], a[24:27], a[168:171], v[80:83]
  ds_read_b64_tr_b16 a[42:43], v2 offset:54272
  v_mfma_f32_16x16x32_bf16 v[84:87], a[24:27], a[172:175], v[84:87]
  ds_read_b64_tr_b16 a[56:57], v2 offset:58368
  v_mfma_f32_16x16x32_bf16 v[84:87], a[8:11], a[164:167], v[84:87]
  ds_read_b64_tr_b16 a[58:59], v2 offset:62464
  v_mfma_f32_16x16x32_bf16 v[92:95], a[12:15], a[164:167], v[92:95]
  ds_read_b64_tr_b16 a[44:45], v3 offset:50176
  v_mfma_f32_16x16x32_bf16 v[92:95], a[28:31], a[172:175], v[92:95]
  ds_read_b64_tr_b16 a[46:47], v3 offset:54272
  v_mfma_f32_16x16x32_bf16 v[88:91], a[28:31], a[168:171], v[88:91]
  ds_read_b64_tr_b16 a[60:61], v3 offset:58368
  v_mfma_f32_16x16x32_bf16 v[88:91], a[12:15], a[160:163], v[88:91]
  ds_read_b64_tr_b16 a[62:63], v3 offset:62464
  s_mov_b32 s43, 0x40000
Lp4_mb:
  s_waitcnt vmcnt(0)
  v_max3_u32 v112, v96, v97, v98
  v_max3_u32 v113, v99, v100, v101
  v_max3_u32 v112, v112, v102, v103
  v_max3_u32 v113, v113, v104, v105
  v_max3_u32 v112, v112, v106, v107
  v_max3_u32 v113, v113, v108, v109
  v_max3_u32 v112, v112, v110, v111
  v_max_u32 v112, v112, v113
  v_cmp_eq_u32 vcc, -1, v112
  s_cbranch_vccz Lp4_mbok
  buffer_load_dwordx4 v[96:99], v8, s[4:7], s45 offen offset:0 sc1
  buffer_load_dwordx4 v[100:103], v8, s[4:7], s45 offen offset:1024 sc1
  buffer_load_dwordx4 v[104:107], v8, s[4:7], s45 offen offset:2048 sc1
  buffer_load_dwordx4 v[108:111], v8, s[4:7], s45 offen offset:3072 sc1
  s_sub_u32 s43, s43, 1
  s_cmp_lg_u32 s43, 0
  s_cbranch_scc1 Lp4_mb
  s_waitcnt vmcnt(0)
Lp4_mbok:
  s_waitcnt lgkmcnt(8)
  v_mfma_f32_16x16x32_bf16 v[64:67], a[32:35], a[176:179], v[64:67]
  v_lshlrev_b32 v32, 16, v96
  v_and_b32 v33, 0xffff0000, v96
  v_mfma_f32_16x16x32_bf16 v[64:67], a[48:51], a[184:187], v[64:67]
  v_lshlrev_b32 v34, 16, v97
  v_and_b32 v35, 0xffff0000, v97
  v_mfma_f32_16x16x32_bf16 v[68:71], a[48:51], a[188:191], v[68:71]
  v_lshlrev_b32 v40, 16, v98
  v_and_b32 v41, 0xffff0000, v98
  v_mfma_f32_16x16x32_bf16 v[68:71], a[32:35], a[180:183], v[68:71]
  v_lshlrev_b32 v42, 16, v99
  v_and_b32 v43, 0xffff0000, v99
  v_mfma_f32_16x16x32_bf16 v[76:79], a[36:39], a[180:183], v[76:79]
  v_lshlrev_b32 v36, 16, v104
  v_and_b32 v37, 0xffff0000, v104
  v_mfma_f32_16x16x32_bf16 v[76:79], a[52:55], a[188:191], v[76:79]
  v_lshlrev_b32 v38, 16, v105
  v_and_b32 v39, 0xffff0000, v105
  v_mfma_f32_16x16x32_bf16 v[72:75], a[52:55], a[184:187], v[72:75]
  v_lshlrev_b32 v44, 16, v106
  v_and_b32 v45, 0xffff0000, v106
  v_mfma_f32_16x16x32_bf16 v[72:75], a[36:39], a[176:179], v[72:75]
  s_waitcnt lgkmcnt(0)
  v_lshlrev_b32 v46, 16, v107
  v_and_b32 v47, 0xffff0000, v107
  v_mfma_f32_16x16x32_bf16 v[80:83], a[40:43], a[176:179], v[80:83]
  v_lshlrev_b32 v48, 16, v100
  v_and_b32 v49, 0xffff0000, v100
  v_mfma_f32_16x16x32_bf16 v[80:83], a[56:59], a[184:187], v[80:83]
  s_barrier
  v_lshlrev_b32 v50, 16, v101
  v_mfma_f32_16x16x32_bf16 v[84:87], a[56:59], a[188:191], v[84:87]
  v_and_b32 v51, 0xffff0000, v101
  v_lshlrev_b32 v56, 16, v102
  v_mfma_f32_16x16x32_bf16 v[84:87], a[40:43], a[180:183], v[84:87]
  v_and_b32 v57, 0xffff0000, v102
  v_lshlrev_b32 v58, 16, v103
  v_mfma_f32_16x16x32_bf16 v[92:95], a[44:47], a[180:183], v[92:95]
  v_and_b32 v59, 0xffff0000, v103
  v_lshlrev_b32 v52, 16, v108
  v_mfma_f32_16x16x32_bf16 v[92:95], a[60:63], a[188:191], v[92:95]
  v_and_b32 v53, 0xffff0000, v108
  v_lshlrev_b32 v54, 16, v109
  v_mfma_f32_16x16x32_bf16 v[88:91], a[60:63], a[184:187], v[88:91]
  v_and_b32 v55, 0xffff0000, v109
  v_lshlrev_b32 v60, 16, v110
  v_mfma_f32_16x16x32_bf16 v[88:91], a[44:47], a[176:179], v[88:91]
  v_and_b32 v61, 0xffff0000, v110
  v_lshlrev_b32 v62, 16, v111
  v_and_b32 v63, 0xffff0000, v111
  v_pk_add_f32 v[68:69], v[68:69], v[36:37]
  v_pk_add_f32 v[70:71], v[70:71], v[38:39]
  v_pk_add_f32 v[76:77], v[76:77], v[44:45]
  v_pk_add_f32 v[78:79], v[78:79], v[46:47]
  v_cvt_pk_bf16_f32 v24, v68, v69
  v_cvt_pk_bf16_f32 v25, v70, v71
  v_cvt_pk_bf16_f32 v26, v76, v77
  v_cvt_pk_bf16_f32 v27, v78, v79
  v_pk_add_f32 v[64:65], v[64:65], v[32:33]
  v_pk_add_f32 v[66:67], v[66:67], v[34:35]
  v_pk_add_f32 v[72:73], v[72:73], v[40:41]
  v_pk_add_f32 v[74:75], v[74:75], v[42:43]
  v_cvt_pk_bf16_f32 v16, v64, v65
  v_cvt_pk_bf16_f32 v17, v66, v67
  v_cvt_pk_bf16_f32 v18, v72, v73
  v_cvt_pk_bf16_f32 v19, v74, v75
  v_pk_add_f32 v[84:85], v[84:85], v[52:53]
  v_pk_add_f32 v[86:87], v[86:87], v[54:55]
  v_pk_add_f32 v[92:93], v[92:93], v[60:61]
  v_pk_add_f32 v[94:95], v[94:95], v[62:63]
  v_cvt_pk_bf16_f32 v28, v84, v85
  v_cvt_pk_bf16_f32 v29, v86, v87
  v_cvt_pk_bf16_f32 v30, v92, v93
  v_cvt_pk_bf16_f32 v31, v94, v95
  v_pk_add_f32 v[80:81], v[80:81], v[48:49]
  v_pk_add_f32 v[82:83], v[82:83], v[50:51]
  v_pk_add_f32 v[88:89], v[88:89], v[56:57]
  v_pk_add_f32 v[90:91], v[90:91], v[58:59]
  v_cvt_pk_bf16_f32 v20, v80, v81
  v_cvt_pk_bf16_f32 v21, v82, v83
  v_cvt_pk_bf16_f32 v22, v88, v89
  v_cvt_pk_bf16_f32 v23, v90, v91
  s_cmp_eq_u32 s41, 0
  s_cbranch_scc1 Lp4_mid
  v_permlane16_swap_b32 v16, v18
  v_permlane16_swap_b32 v17, v19
  v_permlane16_swap_b32 v20, v22
  v_permlane16_swap_b32 v21, v23
  ds_write_b128 v152, v[16:19] offset:0
  ds_write_b128 v153, v[20:23] offset:0
  ds_read_b128 v[96:99], v154 offset:0
  ds_read_b128 v[100:103], v154 offset:1024
  v_permlane16_swap_b32 v24, v26
  v_permlane16_swap_b32 v25, v27
  v_permlane16_swap_b32 v28, v30
  v_permlane16_swap_b32 v29, v31
  ds_write_b128 v152, v[24:27] offset:2048
  ds_write_b128 v153, v[28:31] offset:2048
  ds_read_b128 v[104:107], v154 offset:2048
  ds_read_b128 v[108:111], v154 offset:3072
  s_waitcnt lgkmcnt(5)
  buffer_store_dwordx4 v[96:99], v155, s[32:35], s57 offen nt
  s_add_u32 s57, s57, 32768
  s_waitcnt lgkmcnt(4)
  buffer_store_dwordx4 v[100:103], v155, s[32:35], s57 offen nt
  s_add_u32 s57, s57, 32768
  s_waitcnt lgkmcnt(1)
  buffer_store_dwordx4 v[104:107], v155, s[32:35], s57 offen nt
  s_add_u32 s57, s57, 32768
  s_waitcnt lgkmcnt(0)
  buffer_store_dwordx4 v[108:111], v155, s[32:35], s57 offen nt
  s_add_u32 s57, s57, 32768
  s_endpgm
Lp4_mid:
  buffer_store_dwordx4 v[16:19], v8, s[4:7], s46 offen offset:0 sc1
  buffer_store_dwordx4 v[24:27], v8, s[4:7], s47 offen offset:0 sc1
  v_mfma_f32_16x16x32_bf16 v[144:147], v[24:27], v[24:27], 0
  v_mfma_f32_16x16x32_bf16 v[140:143], v[128:131], v[24:27], 0
  v_mfma_f32_16x16x32_bf16 v[136:139], v[16:19], v[16:19], 0
  v_mfma_f32_16x16x32_bf16 v[132:135], v[128:131], v[16:19], 0
  buffer_store_dwordx4 v[20:23], v8, s[4:7], s46 offen offset:1024 sc1
  buffer_store_dwordx4 v[28:31], v8, s[4:7], s47 offen offset:1024 sc1
  v_mfma_f32_16x16x32_bf16 v[144:147], v[28:31], v[28:31], v[144:147]
  v_mfma_f32_16x16x32_bf16 v[140:143], v[128:131], v[28:31], v[140:143]
  v_mfma_f32_16x16x32_bf16 v[136:139], v[20:23], v[20:23], v[136:139]
  v_mfma_f32_16x16x32_bf16 v[132:135], v[128:131], v[20:23], v[132:135]
  s_nop 5
  v_cndmask_b32 v141, v144, v145, s[66:67]
  v_cndmask_b32 v141, v141, v146, s[68:69]
  v_cndmask_b32 v141, v141, v147, s[70:71]
  buffer_store_dwordx2 v[140:141], v148, s[4:7], s48 offen offset:2048 sc1
  v_cndmask_b32 v133, v136, v137, s[66:67]
  v_cndmask_b32 v133, v133, v138, s[68:69]
  v_cndmask_b32 v133, v133, v139, s[70:71]
  buffer_store_dwordx2 v[132:133], v148, s[4:7], s48 offen offset:0 sc1
  s_mov_b32 s41, 1
  s_mov_b32 s42, 0x2800000
  s_mov_b32 s28, s4
  s_mov_b32 s29, s5
  s_mov_b32 s30, 0x10000000
  s_lshr_b32 s57, s40, 1
  s_and_b32 s58, s40, 1
  s_lshl_b32 s71, s50, 3
  s_add_u32 s67, s50, s51
  s_and_b32 s67, s67, 0
  s_lshl_b32 s67, s67, 3
  s_lshl_b32 s62, s40, 12
  s_mul_i32 s63, s40, 6144
  s_add_u32 s76, s63, 139264
  s_and_b32 s43, s50, 7
  s_cmp_lg_u32 s43, 0
  s_cselect_b32 s43, 1, 0
  s_sub_u32 s72, s71, s43
  v_lshrrev_b32 v2, 3, v253
  v_bfe_u32 v3, v253, 1, 2
  v_lshrrev_b32 v4, 4, v253
  v_xor_b32 v3, v3, v4
  v_and_b32 v5, 1, v253
  v_mov_b32 v6, v2
  s_lshl_b32 s43, s40, 4
  v_mul_u32_u24 v6, 6144, v6
  v_lshl_add_u32 v6, v3, 5, v6
  v_lshl_add_u32 v124, v5, 4, v6
  v_add_u32 v125, 48128, v124
  s_mul_i32 s43, s43, 6144
  s_lshl_b32 s60, s51, 7
  s_add_u32 s60, s60, s43
  v_and_b32 v3, 7, v253
  s_lshl_b32 s43, s40, 1
  s_add_u32 s43, s43, s71
  v_lshlrev_b32 v120, 4, v253
  v_mov_b32 v121, v120
  v_add_u32 v122, 30720, v120
  v_add_u32 v123, 30720, v120
  v_lshlrev_b32 v5, 8, v2
  v_lshl_add_u32 v5, v3, 4, v5
  v_add_u32 v126, 128, v5
  s_lshl_b32 s43, s43, 15
  s_mov_b32 s44, 41943040
  s_add_u32 s59, s43, s44
  s_lshl_b32 s43, s72, 15
  s_add_u32 s73, s43, s44
  s_movk_i32 s61, 2048
  v_and_b32 v2, 15, v253
  v_lshrrev_b32 v3, 4, v253
  v_and_b32 v4, 7, v253
  v_lshlrev_b32 v6, 4, v253
  v_add_u32 v7, 1024, v6
  v_lshlrev_b32 v5, 7, v3
  v_lshl_add_u32 v8, v4, 4, v5
  v_add_u32 v9, 512, v8
  s_lshl_b32 s43, s57, 13
  s_add_u32 s43, s43, 73728
  v_add_u32 v112, s43, v6
  v_add_u32 v113, s43, v7
  v_add_u32 v114, 122880, v8
  v_add_u32 v115, 122880, v9
  s_lshl_b32 s43, s52, 3
  s_lshl_b32 s44, s40, 1
  s_add_u32 s43, s43, s44
  v_mov_b32 v187, v6
  s_lshl_b32 s43, s43, 15
  s_lshl_b32 s44, s53, 11
  s_add_u32 s43, s43, s44
  s_add_u32 s64, s43, 41943040
  v_lshrrev_b32 v2, 2, v253
  v_bfe_u32 v3, v253, 3, 2
  v_and_b32 v4, 3, v253
  v_lshlrev_b32 v4, 3, v4
  v_lshl_add_u32 v4, v2, 7, v4
  s_lshl_b32 s43, s58, 1
  s_or_b32 s43, s43, s57
  v_xor_b32 v5, s43, v3
  v_lshl_add_u32 v116, v5, 5, v4
  v_xor_b32 v5, 1, v5
  v_lshl_add_u32 v117, v5, 5, v4
  v_add_u32 v118, 49152, v116
  v_add_u32 v119, 49152, v117
  s_mov_b32 s84, s16
  s_mov_b32 s85, s17
  s_mov_b32 s86, 7340032
  s_mov_b32 s87, 0x20000
  s_mov_b32 s3, 0
  s_mov_b32 s88, 63
  s_mov_b32 s100, 0
  v_mov_b32 v238, 0x40000000
  s_waitcnt vmcnt(0)
  s_barrier
  s_cmp_lg_u32 s40, 0
  s_cbranch_scc1 Lsig19
  v_mov_b32 v250, 1
  s_mov_b64 exec, 1
  buffer_atomic_add v250, v251, s[4:7], s77 offen sc1
  s_mov_b64 exec, -1
Lsig19:
  s_add_u32 s44, s67, 0
  s_and_b32 s44, s44, 15
  s_mul_i32 s45, s44, 393216
  s_add_u32 s69, s45, s60
  s_add_u32 s70, s69, 4096
  s_add_u32 m0, s63, 0
  s_nop 0
  buffer_load_dwordx4 v124, s[8:11], s69 offen offset:0  lds
  buffer_load_dwordx4 v125, s[8:11], s69 offen offset:1024  lds
  buffer_load_dwordx4 v124, s[8:11], s69 offen offset:2048  lds
  buffer_load_dwordx4 v125, s[8:11], s69 offen offset:3072  lds
  s_add_u32 m0, s63, 4096
  s_nop 0
  buffer_load_dwordx4 v124, s[8:11], s70 offen offset:0  lds
  buffer_load_dwordx4 v125, s[8:11], s70 offen offset:1024  lds
  s_add_u32 s44, s67, 1
  s_and_b32 s44, s44, 15
  s_mul_i32 s45, s44, 393216
  s_add_u32 s69, s45, s60
  s_add_u32 s70, s69, 4096
  s_add_u32 m0, s63, 24576
  s_nop 0
  buffer_load_dwordx4 v124, s[8:11], s69 offen offset:0  lds
  buffer_load_dwordx4 v125, s[8:11], s69 offen offset:1024  lds
  buffer_load_dwordx4 v124, s[8:11], s69 offen offset:2048  lds
  buffer_load_dwordx4 v125, s[8:11], s69 offen offset:3072  lds
  s_add_u32 m0, s63, 28672
  s_nop 0
  buffer_load_dwordx4 v124, s[8:11], s70 offen offset:0  lds
  buffer_load_dwordx4 v125, s[8:11], s70 offen offset:1024  lds
  s_add_u32 s44, s67, 2
  s_and_b32 s44, s44, 15
  s_mul_i32 s45, s44, 393216
  s_add_u32 s69, s45, s60
  s_add_u32 s70, s69, 4096
  s_add_u32 m0, s63, 49152
  s_nop 0
  buffer_load_dwordx4 v124, s[8:11], s69 offen offset:0  lds
  buffer_load_dwordx4 v125, s[8:11], s69 offen offset:1024  lds
  buffer_load_dwordx4 v124, s[8:11], s69 offen offset:2048  lds
  buffer_load_dwordx4 v125, s[8:11], s69 offen offset:3072  lds
  s_add_u32 m0, s63, 53248
  s_nop 0
  buffer_load_dwordx4 v124, s[8:11], s70 offen offset:0  lds
  buffer_load_dwordx4 v125, s[8:11], s70 offen offset:1024  lds
  v_mov_b32 v0, 0
  v_mov_b32 v1, 0
  v_mov_b32 v2, 0
  v_mov_b32 v3, 0
  v_mov_b32 v4, 0
  v_mov_b32 v5, 0
  v_mov_b32 v6, 0
  v_mov_b32 v7, 0
  v_mov_b32 v8, 0
  v_mov_b32 v9, 0
  v_mov_b32 v10, 0
  v_mov_b32 v11, 0
  v_mov_b32 v12, 0
  v_mov_b32 v13, 0
  v_mov_b32 v14, 0
  v_mov_b32 v15, 0
  v_mov_b32 v16, 0
  v_mov_b32 v17, 0
  v_mov_b32 v18, 0
  v_mov_b32 v19, 0
  v_mov_b32 v20, 0
  v_mov_b32 v21, 0
  v_mov_b32 v22, 0
  v_mov_b32 v23, 0
  v_mov_b32 v24, 0
  v_mov_b32 v25, 0
  v_mov_b32 v26, 0
  v_mov_b32 v27, 0
  v_mov_b32 v28, 0
  v_mov_b32 v29, 0
  v_mov_b32 v30, 0
  v_mov_b32 v31, 0
  v_mov_b32 v32, 0
  v_mov_b32 v33, 0
  v_mov_b32 v34, 0
  v_mov_b32 v35, 0
  v_mov_b32 v36, 0
  v_mov_b32 v37, 0
  v_mov_b32 v38, 0
  v_mov_b32 v39, 0
  v_mov_b32 v40, 0
  v_mov_b32 v41, 0
  v_mov_b32 v42, 0
  v_mov_b32 v43, 0
  v_mov_b32 v44, 0
  v_mov_b32 v45, 0
  v_mov_b32 v46, 0
  v_mov_b32 v47, 0
  v_mov_b32 v48, 0
  v_mov_b32 v49, 0
  v_mov_b32 v50, 0
  v_mov_b32 v51, 0
  v_mov_b32 v52, 0
  v_mov_b32 v53, 0
  v_mov_b32 v54, 0
  v_mov_b32 v55, 0
  v_mov_b32 v56, 0
  v_mov_b32 v57, 0
  v_mov_b32 v58, 0
  v_mov_b32 v59, 0
  v_mov_b32 v60, 0
  v_mov_b32 v61, 0
  v_mov_b32 v62, 0
  v_mov_b32 v63, 0
  v_mov_b32 v64, 0
  v_mov_b32 v65, 0
  v_mov_b32 v66, 0
  v_mov_b32 v67, 0
  v_mov_b32 v68, 0
  v_mov_b32 v69, 0
  v_mov_b32 v70, 0
  v_mov_b32 v71, 0
  v_mov_b32 v72, 0
  v_mov_b32 v73, 0
  v_mov_b32 v74, 0
  v_mov_b32 v75, 0
  v_mov_b32 v76, 0
  v_mov_b32 v77, 0
  v_mov_b32 v78, 0
  v_mov_b32 v79, 0
  v_mov_b32 v80, 0
  v_mov_b32 v81, 0
  v_mov_b32 v82, 0
  v_mov_b32 v83, 0
  v_mov_b32 v84, 0
  v_mov_b32 v85, 0
  v_mov_b32 v86, 0
  v_mov_b32 v87, 0
  v_mov_b32 v88, 0
  v_mov_b32 v89, 0
  v_mov_b32 v90, 0
  v_mov_b32 v91, 0
  v_mov_b32 v92, 0
  v_mov_b32 v93, 0
  v_mov_b32 v94, 0
  v_mov_b32 v95, 0
  v_mov_b32 v96, 0
  v_mov_b32 v97, 0
  v_mov_b32 v98, 0
  v_mov_b32 v99, 0
  v_mov_b32 v100, 0
  v_mov_b32 v101, 0
  v_mov_b32 v102, 0
  v_mov_b32 v103, 0
  s_mul_i32 s77, s50, 256
  s_add_u32 s77, s77, 27811584
  s_and_b32 s43, s50, 7
  s_cmp_eq_u32 s43, 0
  s_cselect_b32 s43, 256, 0
  v_lshlrev_b32 v249, 7, v253
  v_or_b32 v249, s43, v249
  s_branch Llayer
Lend:
  s_endpgm
Lside_sub:
  s_cmp_eq_u32 s90, 1
  s_cbranch_scc0 Lside_l
  s_cmp_lg_u32 s40, 0
  s_cbranch_scc1 Lside_a
  s_and_b32 s43, s2, 1
  s_lshl_b32 s43, s43, 7
  v_mov_b32 v250, 1
  s_mov_b64 exec, 1
  buffer_atomic_add v250, v251, s[36:39], s43 offen sc1
  s_mov_b64 exec, -1
Lside_a:
  s_add_u32 s88, s88, 3
  s_add_u32 s90, s90, 1
  s_setpc_b64 s[78:79]
Lside_l:
  buffer_load_dwordx4 a[240:243], v239, s[12:15], s89 offen
  s_add_u32 s89, s89, 1024
  s_cmp_eq_u32 s90, 0
  s_cbranch_scc0 Lside_b
  buffer_load_dwordx4 a[176:179], v238, s[84:87], s100 offen
  s_add_u32 s100, s100, 57344
  buffer_load_dwordx4 a[180:183], v238, s[84:87], s100 offen
  s_add_u32 s100, s100, 57344
  buffer_load_dwordx4 a[184:187], v238, s[84:87], s100 offen
  s_add_u32 s100, s100, 57344
  buffer_load_dwordx4 a[188:191], v238, s[84:87], s100 offen
  s_add_u32 s100, s100, 57344
  buffer_load_dwordx4 a[192:195], v238, s[84:87], s100 offen
  s_add_u32 s100, s100, 57344
  buffer_load_dwordx4 a[196:199], v238, s[84:87], s100 offen
  s_add_u32 s100, s100, 57344
  buffer_load_dwordx4 a[200:203], v238, s[84:87], s100 offen
  s_add_u32 s100, s100, 57344
  buffer_load_dwordx4 a[204:207], v238, s[84:87], s100 offen
  s_add_u32 s100, s100, 57344
  s_add_u32 s100, s100, 3211264
  s_add_u32 s88, s88, 3
  s_add_u32 s90, s90, 1
  s_setpc_b64 s[78:79]
Lside_b:
  buffer_load_dwordx4 a[208:211], v238, s[84:87], s100 offen
  s_add_u32 s100, s100, 57344
  buffer_load_dwordx4 a[212:215], v238, s[84:87], s100 offen
  s_add_u32 s100, s100, 57344
  buffer_load_dwordx4 a[216:219], v238, s[84:87], s100 offen
  s_add_u32 s100, s100, 57344
  buffer_load_dwordx4 a[220:223], v238, s[84:87], s100 offen
  s_add_u32 s100, s100, 57344
  buffer_load_dwordx4 a[224:227], v238, s[84:87], s100 offen
  s_add_u32 s100, s100, 57344
  buffer_load_dwordx4 a[228:231], v238, s[84:87], s100 offen
  s_add_u32 s100, s100, 57344
  buffer_load_dwordx4 a[232:235], v238, s[84:87], s100 offen
  s_add_u32 s100, s100, 57344
  buffer_load_dwordx4 a[236:239], v238, s[84:87], s100 offen
  s_add_u32 s100, s100, 57344
  s_mov_b32 s88, 63
  s_setpc_b64 s[78:79]
Lcode_end:
.fill (Lpc0 + 69632 - Lcode_end)/4, 4, 0xbf810000
.section .rodata,"a"
.p2align 6
.amdhsa_kernel interleave_layers__sliding_local_dilated__swiglu_ffn__prompt_kernel
  .amdhsa_next_free_vgpr 512
  .amdhsa_next_free_sgpr 102
  .amdhsa_accum_offset 256
  .amdhsa_group_segment_fixed_size 0
  .amdhsa_kernarg_size 80
  .amdhsa_user_sgpr_count 2
  .amdhsa_user_sgpr_kernarg_segment_ptr 1
  .amdhsa_system_sgpr_workgroup_id_x 1
  .amdhsa_float_denorm_mode_32 3
.end_amdhsa_kernel
```

```asm
; @launch grid=(256,1,1) block=(256,1,1) lds=163840
.amdgcn_target "amdgcn-amd-amdhsa--gfx950"
.text
.globl interleave_layers__sliding_local_dilated__swiglu_ffn__prompt_kernel
.p2align 8
.type interleave_layers__sliding_local_dilated__swiglu_ffn__prompt_kernel,@function
interleave_layers__sliding_local_dilated__swiglu_ffn__prompt_kernel:
  s_cmp_lt_u32 s2, 256
  s_cbranch_scc1 Lgo
  s_endpgm
Lgo:
  s_load_dwordx2 s[28:29], s[0:1], 0
  s_load_dwordx2 s[8:9], s[0:1], 8
  s_getpc_b64 s[44:45]
Lpc0:
  s_bfe_u32 s43, s2, 0x40003
  s_lshl_b32 s43, s43, 12
  v_lshl_add_u32 v2, v0, 4, s43
  s_and_b32 s44, s44, 0xffffff80
  global_load_dwordx4 a[240:243], v2, s[44:45]
  v_lshrrev_b32 v1, 6, v0
  v_and_b32 v253, 63, v0
  v_readfirstlane_b32 s40, v1
  v_mov_b32 v251, 0
  s_mov_b32 s30, 0x400000
  s_mov_b32 s31, 0x20000
  s_mov_b32 s10, 0x600000
  s_mov_b32 s11, 0x20000
  s_and_b32 s44, s2, 1
  s_bfe_u32 s45, s2, 0x20001
  s_lshr_b32 s46, s2, 3
  s_lshl_b32 s47, s44, 3
  s_and_b32 s43, s46, 7
  s_add_u32 s50, s47, s43
  s_lshl_b32 s43, s45, 2
  s_lshr_b32 s51, s46, 3
  s_add_u32 s51, s51, s43
  s_lshr_b32 s57, s40, 1
  s_and_b32 s58, s40, 1
  s_lshl_b32 s71, s50, 3
  s_add_u32 s67, s50, s51
  s_and_b32 s67, s67, 15
  s_lshl_b32 s62, s40, 12
  s_mul_i32 s63, s40, 6144
  s_add_u32 s76, s63, 139264
  s_and_b32 s43, s50, 7
  s_cmp_lg_u32 s43, 0
  s_cselect_b32 s43, 1, 0
  s_sub_u32 s72, s71, s43
  v_lshrrev_b32 v2, 3, v253
  v_bfe_u32 v3, v253, 1, 2
  v_lshrrev_b32 v4, 4, v253
  v_xor_b32 v3, v3, v4
  v_and_b32 v5, 1, v253
  v_lshrrev_b32 v6, 5, v253
  v_lshl_add_u32 v6, v6, 2, v2
  s_lshl_b32 s43, s57, 5
  s_lshl_b32 s44, s58, 2
  s_add_u32 s43, s43, s44
  v_mul_u32_u24 v6, 6144, v6
  v_lshl_add_u32 v6, v3, 5, v6
  v_lshl_add_u32 v124, v5, 4, v6
  v_add_u32 v125, 97280, v124
  s_mul_i32 s43, s43, 6144
  s_lshl_b32 s60, s51, 7
  s_add_u32 s60, s60, s43
  v_and_b32 v3, 7, v253
  s_lshl_b32 s43, s40, 1
  s_add_u32 s43, s43, s71
  v_add_u32 v5, 0, v4
  v_xor_b32 v5, v5, v3
  v_lshlrev_b32 v5, 4, v5
  v_lshl_add_u32 v5, v2, 12, v5
  v_add_u32 v120, 0, v5
  v_add_u32 v5, 4, v4
  v_xor_b32 v5, v5, v3
  v_lshlrev_b32 v5, 4, v5
  v_lshl_add_u32 v5, v2, 12, v5
  v_add_u32 v121, 31744, v5
  v_add_u32 v5, 0, v4
  v_xor_b32 v5, v5, v3
  v_lshlrev_b32 v5, 4, v5
  v_lshl_add_u32 v5, v2, 12, v5
  v_add_u32 v122, 63488, v5
  v_add_u32 v5, 4, v4
  v_xor_b32 v5, v5, v3
  v_lshlrev_b32 v5, 4, v5
  v_lshl_add_u32 v5, v2, 12, v5
  v_add_u32 v123, 95232, v5
  v_and_b32 v5, 6, v2
  v_xor_b32 v5, v5, v3
  v_lshlrev_b32 v5, 4, v5
  v_lshl_add_u32 v5, v2, 12, v5
  v_add_u32 v126, 32768, v5
  s_lshr_b32 s44, s50, 3
  s_lshl_b32 s44, s44, 11
  s_and_b32 s43, s43, 63
  s_lshl_b32 s43, s43, 16
  s_add_u32 s59, s43, s44
  s_and_b32 s43, s72, 63
  s_lshl_b32 s43, s43, 16
  s_add_u32 s73, s43, s44
  s_movk_i32 s61, 128
  s_waitcnt lgkmcnt(0)
  s_add_u32 s44, s67, 0
  s_and_b32 s44, s44, 15
  s_mul_i32 s45, s44, s61
  s_add_u32 s68, s45, s59
  s_add_u32 m0, s62, 73728
  s_nop 0
  buffer_load_dwordx4 v120, s[28:31], s68 offen offset:0 sc1  lds
  buffer_load_dwordx4 v121, s[28:31], s68 offen offset:1024 sc1  lds
  buffer_load_dwordx4 v122, s[28:31], s68 offen offset:2048 sc1  lds
  buffer_load_dwordx4 v123, s[28:31], s68 offen offset:3072 sc1  lds
  s_add_u32 s44, s67, 0
  s_and_b32 s44, s44, 15
  s_mul_i32 s45, s44, 393216
  s_add_u32 s69, s45, s60
  s_add_u32 s70, s69, 4096
  s_add_u32 m0, s63, 0
  s_nop 0
  buffer_load_dwordx4 v124, s[8:11], s69 offen offset:0  lds
  buffer_load_dwordx4 v125, s[8:11], s69 offen offset:1024  lds
  buffer_load_dwordx4 v124, s[8:11], s69 offen offset:2048  lds
  buffer_load_dwordx4 v125, s[8:11], s69 offen offset:3072  lds
  s_add_u32 m0, s63, 4096
  s_nop 0
  buffer_load_dwordx4 v124, s[8:11], s70 offen offset:0  lds
  buffer_load_dwordx4 v125, s[8:11], s70 offen offset:1024  lds
  s_add_u32 s44, s67, s40
  s_add_u32 s44, s44, 0
  s_and_b32 s44, s44, 15
  s_mul_i32 s44, s44, s61
  s_lshl_b32 s45, s40, 10
  s_add_u32 m0, s45, 122880
  s_add_u32 s44, s44, s73
  buffer_load_dwordx4 v126, s[28:31], s44 offen sc1 lds
  s_load_dwordx2 s[4:5], s[0:1], 72
  s_load_dwordx2 s[12:13], s[0:1], 16
  s_load_dwordx2 s[16:17], s[0:1], 32
  s_load_dwordx2 s[20:21], s[0:1], 40
  s_load_dwordx2 s[24:25], s[0:1], 48
  s_load_dwordx2 s[32:33], s[0:1], 56
  s_load_dwordx2 s[36:37], s[0:1], 64
  s_mov_b32 s6, 0x10000000
  s_mov_b32 s7, 0x20000
  s_mov_b32 s14, 0x200000
  s_mov_b32 s15, 0x20000
  s_mov_b32 s18, 0x700000
  s_mov_b32 s19, 0x20000
  s_mov_b32 s22, 0x700000
  s_mov_b32 s23, 0x20000
  s_mov_b32 s26, 0x700000
  s_mov_b32 s27, 0x20000
  s_mov_b32 s34, 0x400000
  s_mov_b32 s35, 0x20000
  s_mov_b32 s38, 0x100
  s_mov_b32 s39, 0x20000
  s_mov_b32 s41, 0
  s_mov_b32 s42, 0
  s_and_b32 s44, s2, 1
  s_bfe_u32 s45, s2, 0x20001
  s_lshr_b32 s46, s2, 3
  s_lshl_b32 s47, s44, 3
  s_lshr_b32 s43, s45, 1
  s_lshl_b32 s43, s43, 2
  s_add_u32 s52, s47, s43
  s_and_b32 s48, s46, 3
  s_add_u32 s52, s52, s48
  s_and_b32 s43, s45, 1
  s_lshr_b32 s49, s46, 2
  s_lshl_b32 s53, s49, 1
  s_add_u32 s53, s53, s43
  s_lshl_b32 s43, s44, 2
  s_add_u32 s54, s43, s48
  s_lshl_b32 s43, s45, 3
  s_add_u32 s55, s43, s49
  v_lshrrev_b32 v2, 3, v253
  v_bfe_u32 v3, v253, 1, 2
  v_lshrrev_b32 v4, 4, v253
  v_xor_b32 v3, v3, v4
  v_and_b32 v4, 1, v253
  v_lshlrev_b32 v2, 11, v2
  v_lshl_add_u32 v2, v3, 5, v2
  v_lshl_add_u32 v252, v4, 4, v2
  s_waitcnt lgkmcnt(0)
  s_and_b32 s43, s40, 1
  s_mul_i32 s43, s43, 41943040
  s_lshl_b32 s44, s2, 7
  s_add_u32 s43, s43, s44
  s_add_u32 s43, s43, 27787264
  buffer_store_dword v251, v251, s[4:7], s43 offen sc1
  v_and_b32 v2, 15, v253
  v_lshrrev_b32 v3, 4, v253
  v_and_b32 v4, 7, v253
  v_lshrrev_b32 v5, 1, v2
  v_xor_b32 v5, v5, v3
  v_lshlrev_b32 v5, 4, v5
  v_lshl_add_u32 v6, v2, 7, v5
  v_xor_b32 v7, 64, v6
  v_and_b32 v5, 6, v4
  v_xor_b32 v5, v5, v3
  v_lshlrev_b32 v5, 4, v5
  v_lshl_add_u32 v8, v4, 7, v5
  v_xor_b32 v9, 64, v8
  s_lshl_b32 s43, s57, 13
  s_add_u32 s43, s43, 73728
  v_add_u32 v112, s43, v6
  v_add_u32 v113, s43, v7
  v_add_u32 v114, 122880, v8
  v_add_u32 v115, 122880, v9
  s_lshl_b32 s43, s52, 3
  s_lshl_b32 s44, s40, 1
  s_add_u32 s43, s43, s44
  v_lshrrev_b32 v5, 1, v3
  v_lshrrev_b32 v187, 1, v2
  v_xor_b32 v5, v5, v187
  v_lshlrev_b32 v5, 4, v5
  v_lshl_add_u32 v187, v2, 7, v5
  v_and_b32 v5, 1, v3
  v_lshl_add_u32 v187, v5, 3, v187
  s_lshr_b32 s44, s43, 6
  s_lshl_b32 s44, s44, 11
  s_and_b32 s43, s43, 63
  s_lshl_b32 s43, s43, 16
  s_add_u32 s43, s43, s44
  s_lshl_b32 s44, s53, 7
  s_add_u32 s64, s43, s44
  v_lshrrev_b32 v2, 2, v253
  v_bfe_u32 v3, v253, 3, 2
  v_and_b32 v4, 3, v253
  v_lshlrev_b32 v4, 3, v4
  v_lshl_add_u32 v4, v2, 7, v4
  s_lshl_b32 s43, s58, 1
  s_or_b32 s43, s43, s57
  v_xor_b32 v5, s43, v3
  v_lshl_add_u32 v116, v5, 5, v4
  v_xor_b32 v5, 1, v5
  v_lshl_add_u32 v117, v5, 5, v4
  v_add_u32 v118, 49152, v116
  v_add_u32 v119, 49152, v117
  v_and_b32 v235, 15, v253
  v_lshrrev_b32 v236, 4, v253
  v_lshlrev_b32 v236, 2, v236
  v_sub_u32 v235, v235, v236
  v_mov_b32 v237, 0xf149f2ca
  v_subrev_u32 v238, 0, v235
  v_cmp_gt_u32 vcc, 8, v238
  v_add_u32 v238, 16, v238
  v_cmp_gt_u32 s[78:79], 8, v238
  v_cndmask_b32 v132, v237, 0, vcc
  s_nop 0
  v_cndmask_b32 v136, v237, 0, s[78:79]
  v_subrev_u32 v238, 1, v235
  v_cmp_gt_u32 vcc, 8, v238
  v_add_u32 v238, 16, v238
  v_cmp_gt_u32 s[78:79], 8, v238
  v_cndmask_b32 v133, v237, 0, vcc
  s_nop 0
  v_cndmask_b32 v137, v237, 0, s[78:79]
  v_subrev_u32 v238, 2, v235
  v_cmp_gt_u32 vcc, 8, v238
  v_add_u32 v238, 16, v238
  v_cmp_gt_u32 s[78:79], 8, v238
  v_cndmask_b32 v134, v237, 0, vcc
  s_nop 0
  v_cndmask_b32 v138, v237, 0, s[78:79]
  v_subrev_u32 v238, 3, v235
  v_cmp_gt_u32 vcc, 8, v238
  v_add_u32 v238, 16, v238
  v_cmp_gt_u32 s[78:79], 8, v238
  v_cndmask_b32 v135, v237, 0, vcc
  s_nop 0
  v_cndmask_b32 v139, v237, 0, s[78:79]
  v_lshlrev_b32 v232, 4, v253
  v_add_u32 v232, 149504, v232
  ds_write_b128 v232, v[132:135]
  ds_write_b128 v232, v[136:139] offset:1024
  s_lshr_b32 s46, s2, 3
  s_cmp_ge_u32 s46, 14
  s_cselect_b32 s44, 14, 0
  s_cselect_b32 s45, 1, 0
  s_cselect_b32 s84, s20, s16
  s_cselect_b32 s85, s21, s17
  s_mov_b32 s86, 7340032
  s_mov_b32 s87, 0x20000
  s_sub_u32 s44, s46, s44
  s_bfe_u32 s47, s2, 0x20001
  s_mul_i32 s47, s47, 14
  s_add_u32 s44, s44, s47
  s_and_b32 s47, s2, 1
  s_lshl_b32 s48, s47, 1
  s_add_u32 s48, s48, s45
  s_mul_i32 s48, s48, 14336
  s_lshl_b32 s49, s44, 8
  s_add_u32 s48, s48, s49
  s_add_u32 s101, s48, 27918336
  s_lshl_b32 s47, s47, 2
  s_add_u32 s47, s47, s40
  s_mul_i32 s47, s47, 458752
  s_lshl_b32 s44, s44, 7
  s_add_u32 s100, s47, s44
  s_cmp_lt_u32 s46, 28
  s_cselect_b32 s3, 1, 0
  s_cmp_eq_u32 s41, 0
  s_cselect_b32 s3, s3, 0
  v_lshrrev_b32 v238, 3, v253
  v_mul_u32_u24 v238, 7168, v238
  v_and_b32 v239, 7, v253
  v_lshl_add_u32 v238, v239, 4, v238
  s_cmp_eq_u32 s3, 0
  s_cselect_b32 s43, 0x40000000, 0
  v_or_b32 v238, s43, v238
  v_lshlrev_b32 v239, 4, v253
  s_lshl_b32 s43, s2, 2
  s_add_u32 s43, s43, s40
  s_lshl_b32 s89, s43, 11
  s_mul_i32 s43, s46, 43
  s_lshr_b32 s43, s43, 8
  s_mul_i32 s43, s43, 6
  s_sub_u32 s43, s46, s43
  s_add_u32 s43, s43, 5
  s_cmp_eq_u32 s41, 0
  s_cselect_b32 s88, s43, 63
  s_mov_b32 s90, 0
  s_lshl_b32 s43, s58, 12
  v_add_u32 v132, s43, v112
  v_add_u32 v133, s43, v113
  v_and_b32 v128, 15, v253
  v_lshrrev_b32 v129, 4, v253
  v_cmp_eq_u32 vcc, 0, v128
  v_lshlrev_b32 v129, 4, v129
  v_mov_b32 v130, 0x40000000
  v_cndmask_b32 v136, v130, v129, vcc
  v_mov_b32 v156, 0x3f803f80
  v_mov_b32 v157, 0x3f803f80
  v_mov_b32 v158, 0x3f803f80
  v_mov_b32 v159, 0x3f803f80
  s_lshl_b32 s43, s40, 1
  s_add_u32 s43, s43, s71
  s_lshl_b32 s48, s43, 11
  s_lshl_b32 s43, s67, 7
  s_add_u32 s48, s48, s43
  s_add_u32 s48, s48, 27262976
  s_lshl_b32 s43, s51, 2
  s_lshl_b32 s44, s58, 1
  s_add_u32 s43, s43, s44
  s_add_u32 s43, s43, s57
  s_lshl_b32 s43, s43, 6
  s_mul_i32 s49, s67, 12288
  s_add_u32 s49, s49, s43
  s_add_u32 s49, s49, 27983872
  v_and_b32 v212, 15, v253
  v_lshrrev_b32 v213, 4, v253
  v_lshrrev_b32 v192, 2, v212
  v_cmp_eq_u32 vcc, v192, v213
  v_and_b32 v192, 3, v212
  v_lshlrev_b32 v212, 3, v212
  v_mov_b32 v213, 0x7ffffff0
  v_cndmask_b32 v212, v213, v212, vcc
  v_cmp_eq_u32 s[78:79], 1, v192
  v_cmp_eq_u32 s[80:81], 2, v192
  v_cmp_eq_u32 s[82:83], 3, v192
  v_mov_b32 v192, 0x3f803f80
  v_mov_b32 v193, 0x3f803f80
  v_mov_b32 v194, 0x3f803f80
  v_mov_b32 v195, 0x3f803f80
  s_add_u32 s44, s67, 1
  s_and_b32 s44, s44, 15
  s_mul_i32 s45, s44, s61
  s_add_u32 s68, s45, s59
  s_add_u32 m0, s62, 90112
  s_nop 0
  buffer_load_dwordx4 v120, s[28:31], s68 offen offset:0 sc1  lds
  buffer_load_dwordx4 v121, s[28:31], s68 offen offset:1024 sc1  lds
  buffer_load_dwordx4 v122, s[28:31], s68 offen offset:2048 sc1  lds
  buffer_load_dwordx4 v123, s[28:31], s68 offen offset:3072 sc1  lds
  s_waitcnt vmcnt(5)
  s_barrier
  ds_read_b64_tr_b16 a[40:41], v116 offset:0
  ds_read_b64_tr_b16 a[42:43], v116 offset:6144
  ds_read_b64_tr_b16 a[64:65], v116 offset:12288
  ds_read_b64_tr_b16 a[66:67], v116 offset:18432
  ds_read_b128 a[4:7], v112 offset:0
  ds_read_b128 a[24:27], v113 offset:0
  ds_read_b128 a[8:11], v112 offset:2048
  ds_read_b128 a[28:31], v113 offset:2048
  ds_read_b128 a[12:15], v112 offset:4096
  ds_read_b128 a[32:35], v113 offset:4096
  ds_read_b128 a[16:19], v112 offset:6144
  ds_read_b128 a[36:39], v113 offset:6144
  ds_read_b64_tr_b16 a[44:45], v117 offset:0
  ds_read_b64_tr_b16 a[46:47], v117 offset:6144
  ds_read_b64_tr_b16 a[68:69], v117 offset:12288
  ds_read_b64_tr_b16 a[70:71], v117 offset:18432
  ds_read_b128 a[0:3], v114 offset:0
  ds_read_b128 a[20:23], v115 offset:0
  ds_read_b64_tr_b16 a[48:49], v116 offset:2048
  ds_read_b64_tr_b16 a[50:51], v116 offset:8192
  ds_read_b64_tr_b16 a[72:73], v116 offset:14336
  ds_read_b64_tr_b16 a[74:75], v116 offset:20480
  ds_read_b64_tr_b16 a[52:53], v117 offset:2048
  ds_read_b64_tr_b16 a[54:55], v117 offset:8192
  ds_read_b64_tr_b16 a[76:77], v117 offset:14336
  ds_read_b64_tr_b16 a[78:79], v117 offset:20480
  ds_read_b64_tr_b16 a[56:57], v116 offset:4096
  ds_read_b64_tr_b16 a[58:59], v116 offset:10240
  ds_read_b64_tr_b16 a[80:81], v116 offset:16384
  ds_read_b64_tr_b16 a[82:83], v116 offset:22528
  ds_read_b64_tr_b16 a[60:61], v117 offset:4096
  ds_read_b64_tr_b16 a[62:63], v117 offset:10240
  ds_read_b64_tr_b16 a[84:85], v117 offset:16384
  ds_read_b64_tr_b16 a[86:87], v117 offset:22528
  ds_read_b128 v[140:143], v132 offset:0
  ds_read_b128 v[144:147], v133 offset:0
  ds_read_b128 v[148:151], v132 offset:2048
  ds_read_b128 v[152:155], v133 offset:2048
  s_add_u32 s44, s67, 1
  s_and_b32 s44, s44, 15
  s_mul_i32 s45, s44, 393216
  s_add_u32 s69, s45, s60
  s_add_u32 s70, s69, 4096
  s_add_u32 m0, s63, 24576
  s_nop 0
  buffer_load_dwordx4 v124, s[8:11], s69 offen offset:0  lds
  buffer_load_dwordx4 v125, s[8:11], s69 offen offset:1024  lds
  buffer_load_dwordx4 v124, s[8:11], s69 offen offset:2048  lds
  buffer_load_dwordx4 v125, s[8:11], s69 offen offset:3072  lds
  s_add_u32 m0, s63, 28672
  s_nop 0
  buffer_load_dwordx4 v124, s[8:11], s70 offen offset:0  lds
  buffer_load_dwordx4 v125, s[8:11], s70 offen offset:1024  lds
  s_waitcnt lgkmcnt(15)
  v_mfma_f32_16x16x32_bf16 v[0:3], a[40:43], a[4:7], 0
  s_add_u32 s44, s67, 2
  s_and_b32 s44, s44, 15
  s_mul_i32 s45, s44, 393216
  s_add_u32 s69, s45, s60
  s_add_u32 s70, s69, 4096
  s_add_u32 m0, s63, 49152
  s_nop 0
  v_mfma_f32_16x16x32_bf16 v[0:3], a[64:67], a[24:27], v[0:3]
  buffer_load_dwordx4 v124, s[8:11], s69 offen offset:0  lds
  v_mfma_f32_16x16x32_bf16 v[4:7], a[64:67], a[28:31], 0
  v_mfma_f32_16x16x32_bf16 v[4:7], a[40:43], a[8:11], v[4:7]
  buffer_load_dwordx4 v125, s[8:11], s69 offen offset:1024  lds
  v_mfma_f32_16x16x32_bf16 v[8:11], a[40:43], a[12:15], 0
  v_mfma_f32_16x16x32_bf16 v[8:11], a[64:67], a[32:35], v[8:11]
  v_mfma_f32_16x16x32_bf16 v[12:15], a[64:67], a[36:39], 0
  buffer_load_dwordx4 v124, s[8:11], s69 offen offset:2048  lds
  v_mfma_f32_16x16x32_bf16 v[12:15], a[40:43], a[16:19], v[12:15]
  v_mfma_f32_16x16x32_bf16 v[28:31], a[44:47], a[16:19], 0
  v_mfma_f32_16x16x32_bf16 v[28:31], a[68:71], a[36:39], v[28:31]
  buffer_load_dwordx4 v125, s[8:11], s69 offen offset:3072  lds
  s_add_u32 m0, s63, 53248
  s_nop 0
  v_mfma_f32_16x16x32_bf16 v[24:27], a[68:71], a[32:35], 0
  v_mfma_f32_16x16x32_bf16 v[24:27], a[44:47], a[12:15], v[24:27]
  buffer_load_dwordx4 v124, s[8:11], s70 offen offset:0  lds
  v_mfma_f32_16x16x32_bf16 v[20:23], a[44:47], a[8:11], 0
  v_mfma_f32_16x16x32_bf16 v[20:23], a[68:71], a[28:31], v[20:23]
  v_mfma_f32_16x16x32_bf16 v[16:19], a[68:71], a[24:27], 0
  s_add_u32 s44, s67, 2
  buffer_load_dwordx4 v125, s[8:11], s70 offen offset:1024  lds
  s_and_b32 s44, s44, 15
  s_mul_i32 s45, s44, s61
  s_add_u32 s68, s45, s59
  s_add_u32 m0, s62, 106496
  s_nop 0
  v_mfma_f32_16x16x32_bf16 v[16:19], a[44:47], a[4:7], v[16:19]
  v_mfma_f32_16x16x32_bf16 v[96:99], a[48:51], a[0:3], 0
  s_waitcnt vmcnt(6) lgkmcnt(0)
  s_barrier
  ds_read_b64_tr_b16 a[128:129], v116 offset:24576
  v_mfma_f32_16x16x32_bf16 v[96:99], a[72:75], a[20:23], v[96:99]
  ds_read_b64_tr_b16 a[130:131], v116 offset:30720
  buffer_load_dwordx4 v120, s[28:31], s68 offen offset:0 sc1  lds
  v_mfma_f32_16x16x32_bf16 v[32:35], a[72:75], a[24:27], 0
  ds_read_b64_tr_b16 a[152:153], v116 offset:36864
  v_mfma_f32_16x16x32_bf16 v[32:35], a[48:51], a[4:7], v[32:35]
  ds_read_b64_tr_b16 a[154:155], v116 offset:43008
  v_mfma_f32_16x16x32_bf16 v[36:39], a[48:51], a[8:11], 0
  ds_read_b128 a[92:95], v112 offset:16384
  buffer_load_dwordx4 v121, s[28:31], s68 offen offset:1024 sc1  lds
  v_mfma_f32_16x16x32_bf16 v[36:39], a[72:75], a[28:31], v[36:39]
  ds_read_b128 a[112:115], v113 offset:16384
  v_mfma_f32_16x16x32_bf16 v[40:43], a[72:75], a[32:35], 0
  ds_read_b128 a[96:99], v112 offset:18432
  buffer_load_dwordx4 v122, s[28:31], s68 offen offset:2048 sc1  lds
  v_mfma_f32_16x16x32_bf16 v[40:43], a[48:51], a[12:15], v[40:43]
  ds_read_b128 a[116:119], v113 offset:18432
  v_mfma_f32_16x16x32_bf16 v[44:47], a[48:51], a[16:19], 0
  ds_read_b128 a[100:103], v112 offset:20480
  v_mfma_f32_16x16x32_bf16 v[44:47], a[72:75], a[36:39], v[44:47]
  s_add_u32 s44, s67, s40
  ds_read_b128 a[120:123], v113 offset:20480
  buffer_load_dwordx4 v123, s[28:31], s68 offen offset:3072 sc1  lds
  s_add_u32 s44, s44, 4
  s_and_b32 s44, s44, 15
  s_mul_i32 s44, s44, s61
  s_lshl_b32 s45, s40, 10
  v_mfma_f32_16x16x32_bf16 v[60:63], a[76:79], a[36:39], 0
  s_add_u32 m0, s45, 126976
  s_add_u32 s44, s44, s73
  ds_read_b128 a[104:107], v112 offset:22528
  v_mfma_f32_16x16x32_bf16 v[60:63], a[52:55], a[16:19], v[60:63]
  ds_read_b128 a[124:127], v113 offset:22528
  v_mfma_f32_16x16x32_bf16 v[56:59], a[52:55], a[12:15], 0
  ds_read_b64_tr_b16 a[132:133], v117 offset:24576
  buffer_load_dwordx4 v126, s[28:31], s44 offen sc1 lds
  s_add_u32 s44, s67, s40
  s_add_u32 s44, s44, 8
  s_and_b32 s44, s44, 15
  s_mul_i32 s44, s44, s61
  s_lshl_b32 s45, s40, 10
  v_mfma_f32_16x16x32_bf16 v[56:59], a[76:79], a[32:35], v[56:59]
  s_add_u32 m0, s45, 131072
  s_add_u32 s44, s44, s73
  ds_read_b64_tr_b16 a[134:135], v117 offset:30720
  v_mfma_f32_16x16x32_bf16 v[160:163], a[40:43], v[156:159], 0
  ds_read_b64_tr_b16 a[156:157], v117 offset:36864
  v_mfma_f32_16x16x32_bf16 v[164:167], a[48:51], v[156:159], 0
  ds_read_b64_tr_b16 a[158:159], v117 offset:43008
  buffer_load_dwordx4 v126, s[28:31], s44 offen sc1 lds
  s_add_u32 s44, s67, s40
  s_add_u32 s44, s44, 12
  s_and_b32 s44, s44, 15
  s_mul_i32 s44, s44, s61
  s_lshl_b32 s45, s40, 10
  v_mfma_f32_16x16x32_bf16 v[168:171], a[56:59], v[156:159], 0
  s_add_u32 m0, s45, 135168
  s_add_u32 s44, s44, s73
  ds_read_b128 a[88:91], v114 offset:1024
  v_mfma_f32_16x16x32_bf16 v[160:163], a[64:67], v[156:159], v[160:163]
  ds_read_b128 a[108:111], v115 offset:1024
  buffer_load_dwordx4 v126, s[28:31], s44 offen sc1 lds
  s_add_u32 s44, s67, 3
  s_and_b32 s44, s44, 15
  s_mul_i32 s45, s44, s61
  s_add_u32 s68, s45, s59
  s_add_u32 m0, s62, 73728
  s_nop 0
  v_mfma_f32_16x16x32_bf16 v[164:167], a[72:75], v[156:159], v[164:167]
  ds_read_b64_tr_b16 a[136:137], v116 offset:26624
  v_mfma_f32_16x16x32_bf16 v[168:171], a[80:83], v[156:159], v[168:171]
  ds_read_b64_tr_b16 a[138:139], v116 offset:32768
  v_mfma_f32_16x16x32_bf16 v[208:211], v[148:151], v[148:151], 0
  ds_read_b64_tr_b16 a[160:161], v116 offset:38912
  buffer_load_dwordx4 v120, s[28:31], s68 offen offset:0 sc1  lds
  v_mfma_f32_16x16x32_bf16 v[204:207], v[192:195], v[148:151], 0
  ds_read_b64_tr_b16 a[162:163], v116 offset:45056
  v_mfma_f32_16x16x32_bf16 v[200:203], v[140:143], v[140:143], 0
  ds_read_b64_tr_b16 a[140:141], v117 offset:26624
  v_mfma_f32_16x16x32_bf16 v[196:199], v[192:195], v[140:143], 0
  ds_read_b64_tr_b16 a[142:143], v117 offset:32768
  buffer_load_dwordx4 v121, s[28:31], s68 offen offset:1024 sc1  lds
  v_mfma_f32_16x16x32_bf16 v[208:211], v[152:155], v[152:155], v[208:211]
  ds_read_b64_tr_b16 a[164:165], v117 offset:38912
  v_mfma_f32_16x16x32_bf16 v[204:207], v[192:195], v[152:155], v[204:207]
  ds_read_b64_tr_b16 a[166:167], v117 offset:45056
  v_mfma_f32_16x16x32_bf16 v[200:203], v[144:147], v[144:147], v[200:203]
  ds_read_b64_tr_b16 a[144:145], v116 offset:28672
  buffer_load_dwordx4 v122, s[28:31], s68 offen offset:2048 sc1  lds
  v_mfma_f32_16x16x32_bf16 v[196:199], v[192:195], v[144:147], v[196:199]
  ds_read_b64_tr_b16 a[146:147], v116 offset:34816
  v_mfma_f32_16x16x32_bf16 v[52:55], a[76:79], a[28:31], 0
  s_add_u32 s44, s67, 3
  ds_read_b64_tr_b16 a[168:169], v116 offset:40960
  buffer_load_dwordx4 v123, s[28:31], s68 offen offset:3072 sc1  lds
  s_and_b32 s44, s44, 15
  s_mul_i32 s45, s44, 393216
  s_add_u32 s69, s45, s60
  s_add_u32 s70, s69, 4096
  s_add_u32 m0, s63, 0
  s_nop 0
  v_mfma_f32_16x16x32_bf16 v[52:55], a[52:55], a[8:11], v[52:55]
  ds_read_b64_tr_b16 a[170:171], v116 offset:47104
  v_mfma_f32_16x16x32_bf16 v[48:51], a[52:55], a[4:7], 0
  ds_read_b64_tr_b16 a[148:149], v117 offset:28672
  v_mfma_f32_16x16x32_bf16 v[48:51], a[76:79], a[24:27], v[48:51]
  ds_read_b64_tr_b16 a[150:151], v117 offset:34816
  buffer_load_dwordx4 v124, s[8:11], s69 offen offset:0  lds
  v_mfma_f32_16x16x32_bf16 v[100:103], a[20:23], a[80:83], 0
  ds_read_b64_tr_b16 a[172:173], v117 offset:40960
  v_mfma_f32_16x16x32_bf16 v[100:103], a[0:3], a[56:59], v[100:103]
  ds_read_b64_tr_b16 a[174:175], v117 offset:47104
  v_mfma_f32_16x16x32_bf16 v[64:67], a[4:7], a[56:59], 0
  buffer_load_dwordx4 v125, s[8:11], s69 offen offset:1024  lds
  v_mfma_f32_16x16x32_bf16 v[64:67], a[24:27], a[80:83], v[64:67]
  v_cndmask_b32 v205, v208, v209, s[78:79]
  v_cndmask_b32 v205, v205, v210, s[80:81]
  v_cndmask_b32 v205, v205, v211, s[82:83]
  v_mfma_f32_16x16x32_bf16 v[68:71], a[28:31], a[80:83], 0
  buffer_store_dwordx2 v[204:205], v212, s[4:7], s48 offen offset:2048 sc1
  v_cndmask_b32 v197, v200, v201, s[78:79]
  v_cndmask_b32 v197, v197, v202, s[80:81]
  v_mfma_f32_16x16x32_bf16 v[68:71], a[8:11], a[56:59], v[68:71]
  buffer_load_dwordx4 v124, s[8:11], s69 offen offset:2048  lds
  v_cndmask_b32 v197, v197, v203, s[82:83]
  buffer_store_dwordx2 v[196:197], v212, s[4:7], s48 offen offset:0 sc1
  v_mfma_f32_16x16x32_bf16 v[72:75], a[12:15], a[56:59], 0
  buffer_store_dwordx4 v[160:163], v136, s[4:7], s49 offen sc1
  v_mfma_f32_16x16x32_bf16 v[72:75], a[32:35], a[80:83], v[72:75]
  s_add_u32 s49, s49, 4096
  buffer_load_dwordx4 v125, s[8:11], s69 offen offset:3072  lds
  s_add_u32 m0, s63, 4096
  s_nop 0
  v_mfma_f32_16x16x32_bf16 v[76:79], a[36:39], a[80:83], 0
  buffer_store_dwordx4 v[164:167], v136, s[4:7], s49 offen sc1
  v_mfma_f32_16x16x32_bf16 v[76:79], a[16:19], a[56:59], v[76:79]
  s_add_u32 s49, s49, 4096
  buffer_store_dwordx4 v[168:171], v136, s[4:7], s49 offen sc1
  v_mfma_f32_16x16x32_bf16 v[92:95], a[16:19], a[60:63], 0
  s_add_u32 s49, s49, 4096
  buffer_load_dwordx4 v124, s[8:11], s70 offen offset:0  lds
  v_mfma_f32_16x16x32_bf16 v[92:95], a[36:39], a[84:87], v[92:95]
  v_mfma_f32_16x16x32_bf16 v[88:91], a[32:35], a[84:87], 0
  v_mfma_f32_16x16x32_bf16 v[88:91], a[12:15], a[60:63], v[88:91]
  buffer_load_dwordx4 v125, s[8:11], s70 offen offset:1024  lds
  v_mfma_f32_16x16x32_bf16 v[84:87], a[8:11], a[60:63], 0
  v_mfma_f32_16x16x32_bf16 v[84:87], a[28:31], a[84:87], v[84:87]
  v_mfma_f32_16x16x32_bf16 v[80:83], a[24:27], a[84:87], 0
  v_mfma_f32_16x16x32_bf16 v[80:83], a[4:7], a[60:63], v[80:83]
  s_add_u32 s44, s67, 4
  s_and_b32 s44, s44, 15
  s_mul_i32 s45, s44, s61
  s_add_u32 s68, s45, s59
  s_mov_b32 s66, 5
  s_mov_b32 s56, 2
  s_cmp_eq_u32 s66, s88
  s_cbranch_scc0 Lside_skip9
  s_call_b64 s[78:79], Lside_sub
Lside_skip9:
  s_branch Lp1_u1
  s_branch Lp1_common
Llayer:
  s_cmp_lg_u32 s40, 0
  s_cbranch_scc1 Lpdn2
  s_mov_b32 s43, 0x40000
  s_mov_b64 exec, 15
Lpol1:
  buffer_load_dword v250, v249, s[4:7], s77 offen sc1
  s_waitcnt vmcnt(0)
  v_cmp_gt_u32 vcc, 8, v250
  s_cbranch_vccz Lpdn2x
  s_sub_u32 s43, s43, 1
  s_cmp_lg_u32 s43, 0
  s_cbranch_scc1 Lpol1
Lpdn2x:
  s_mov_b64 exec, -1
Lpdn2:
  s_waitcnt vmcnt(0) lgkmcnt(0)
  s_barrier
  s_add_u32 s44, s67, 0
  s_and_b32 s44, s44, 15
  s_mul_i32 s45, s44, s61
  s_add_u32 s68, s45, s59
  s_add_u32 m0, s62, 73728
  s_nop 0
  buffer_load_dwordx4 v120, s[28:31], s68 offen offset:0 sc1  lds
  buffer_load_dwordx4 v121, s[28:31], s68 offen offset:1024 sc1  lds
  buffer_load_dwordx4 v122, s[28:31], s68 offen offset:2048 sc1  lds
  buffer_load_dwordx4 v123, s[28:31], s68 offen offset:3072 sc1  lds
  s_add_u32 s44, s67, s40
  s_add_u32 s44, s44, 0
  s_and_b32 s44, s44, 15
  s_mul_i32 s44, s44, s61
  s_lshl_b32 s45, s40, 10
  s_add_u32 m0, s45, 122880
  s_add_u32 s44, s44, s73
  buffer_load_dwordx4 v126, s[28:31], s44 offen sc1 lds
  s_add_u32 s44, s67, 1
  s_and_b32 s44, s44, 15
  s_mul_i32 s45, s44, s61
  s_add_u32 s68, s45, s59
  s_add_u32 m0, s62, 90112
  s_nop 0
  buffer_load_dwordx4 v120, s[28:31], s68 offen offset:0 sc1  lds
  buffer_load_dwordx4 v121, s[28:31], s68 offen offset:1024 sc1  lds
  buffer_load_dwordx4 v122, s[28:31], s68 offen offset:2048 sc1  lds
  buffer_load_dwordx4 v123, s[28:31], s68 offen offset:3072 sc1  lds
  ds_read_b64_tr_b16 a[40:41], v116 offset:0
  ds_read_b64_tr_b16 a[42:43], v116 offset:6144
  ds_read_b64_tr_b16 a[64:65], v116 offset:12288
  ds_read_b64_tr_b16 a[66:67], v116 offset:18432
  ds_read_b64_tr_b16 a[44:45], v117 offset:0
  ds_read_b64_tr_b16 a[46:47], v117 offset:6144
  ds_read_b64_tr_b16 a[68:69], v117 offset:12288
  ds_read_b64_tr_b16 a[70:71], v117 offset:18432
  ds_read_b64_tr_b16 a[48:49], v116 offset:2048
  ds_read_b64_tr_b16 a[50:51], v116 offset:8192
  ds_read_b64_tr_b16 a[72:73], v116 offset:14336
  ds_read_b64_tr_b16 a[74:75], v116 offset:20480
  ds_read_b64_tr_b16 a[52:53], v117 offset:2048
  ds_read_b64_tr_b16 a[54:55], v117 offset:8192
  ds_read_b64_tr_b16 a[76:77], v117 offset:14336
  ds_read_b64_tr_b16 a[78:79], v117 offset:20480
  ds_read_b64_tr_b16 a[56:57], v116 offset:4096
  ds_read_b64_tr_b16 a[58:59], v116 offset:10240
  ds_read_b64_tr_b16 a[80:81], v116 offset:16384
  ds_read_b64_tr_b16 a[82:83], v116 offset:22528
  ds_read_b64_tr_b16 a[60:61], v117 offset:4096
  ds_read_b64_tr_b16 a[62:63], v117 offset:10240
  ds_read_b64_tr_b16 a[84:85], v117 offset:16384
  ds_read_b64_tr_b16 a[86:87], v117 offset:22528
  s_waitcnt vmcnt(4)
  s_barrier
  ds_read_b128 a[4:7], v112 offset:0
  ds_read_b128 a[24:27], v113 offset:0
  ds_read_b128 a[8:11], v112 offset:2048
  ds_read_b128 a[28:31], v113 offset:2048
  ds_read_b128 a[12:15], v112 offset:4096
  ds_read_b128 a[32:35], v113 offset:4096
  ds_read_b128 a[16:19], v112 offset:6144
  ds_read_b128 a[36:39], v113 offset:6144
  ds_read_b128 a[0:3], v114 offset:0
  ds_read_b128 a[20:23], v115 offset:0
  s_add_u32 s44, s67, s40
  s_add_u32 s44, s44, 4
  s_and_b32 s44, s44, 15
  s_mul_i32 s44, s44, s61
  s_lshl_b32 s45, s40, 10
  s_add_u32 m0, s45, 126976
  s_add_u32 s44, s44, s73
  buffer_load_dwordx4 v126, s[28:31], s44 offen sc1 lds
  s_add_u32 s44, s67, s40
  s_add_u32 s44, s44, 8
  s_and_b32 s44, s44, 15
  s_mul_i32 s44, s44, s61
  s_lshl_b32 s45, s40, 10
  s_add_u32 m0, s45, 131072
  s_add_u32 s44, s44, s73
  buffer_load_dwordx4 v126, s[28:31], s44 offen sc1 lds
  s_add_u32 s44, s67, s40
  s_add_u32 s44, s44, 12
  s_and_b32 s44, s44, 15
  s_mul_i32 s44, s44, s61
  s_lshl_b32 s45, s40, 10
  s_add_u32 m0, s45, 135168
  s_add_u32 s44, s44, s73
  buffer_load_dwordx4 v126, s[28:31], s44 offen sc1 lds
  s_add_u32 s44, s67, 2
  s_and_b32 s44, s44, 15
  s_mul_i32 s45, s44, s61
  s_add_u32 s68, s45, s59
  s_add_u32 m0, s62, 106496
  s_nop 0
  buffer_load_dwordx4 v120, s[28:31], s68 offen offset:0 sc1  lds
  buffer_load_dwordx4 v121, s[28:31], s68 offen offset:1024 sc1  lds
  buffer_load_dwordx4 v122, s[28:31], s68 offen offset:2048 sc1  lds
  buffer_load_dwordx4 v123, s[28:31], s68 offen offset:3072 sc1  lds
  s_waitcnt lgkmcnt(0)
Lp1_common:
  s_mov_b32 s66, 4
  s_add_u32 s44, s67, 3
  s_and_b32 s44, s44, 15
  s_mul_i32 s45, s44, s61
  s_add_u32 s68, s45, s59
  s_mov_b32 s56, 2
.p2align 3
Lp1_loop:
  s_waitcnt lgkmcnt(15)
  v_mfma_f32_16x16x32_bf16 v[0:3], a[40:43], a[4:7], v[0:3]
  s_mul_i32 s45, s44, 393216
  v_mfma_f32_16x16x32_bf16 v[0:3], a[64:67], a[24:27], v[0:3]
  s_add_u32 s69, s45, s60
  v_mfma_f32_16x16x32_bf16 v[4:7], a[64:67], a[28:31], v[4:7]
  s_add_u32 s70, s69, 4096
  v_mfma_f32_16x16x32_bf16 v[4:7], a[40:43], a[8:11], v[4:7]
  v_mfma_f32_16x16x32_bf16 v[8:11], a[40:43], a[12:15], v[8:11]
  v_mfma_f32_16x16x32_bf16 v[8:11], a[64:67], a[32:35], v[8:11]
  v_mfma_f32_16x16x32_bf16 v[12:15], a[64:67], a[36:39], v[12:15]
  v_mfma_f32_16x16x32_bf16 v[12:15], a[40:43], a[16:19], v[12:15]
  v_mfma_f32_16x16x32_bf16 v[28:31], a[44:47], a[16:19], v[28:31]
  v_mfma_f32_16x16x32_bf16 v[28:31], a[68:71], a[36:39], v[28:31]
  v_mfma_f32_16x16x32_bf16 v[24:27], a[68:71], a[32:35], v[24:27]
  s_waitcnt vmcnt(7) lgkmcnt(0)
  s_barrier
  ds_read_b64_tr_b16 a[128:129], v116 offset:24576
  v_mfma_f32_16x16x32_bf16 v[24:27], a[44:47], a[12:15], v[24:27]
  s_add_u32 m0, s62, 73728
  ds_read_b64_tr_b16 a[130:131], v116 offset:30720
  v_mfma_f32_16x16x32_bf16 v[20:23], a[44:47], a[8:11], v[20:23]
  ds_read_b64_tr_b16 a[152:153], v116 offset:36864
  buffer_load_dwordx4 v120, s[28:31], s68 offen offset:0 sc1  lds
  v_mfma_f32_16x16x32_bf16 v[20:23], a[68:71], a[28:31], v[20:23]
  ds_read_b64_tr_b16 a[154:155], v116 offset:43008
  v_mfma_f32_16x16x32_bf16 v[16:19], a[68:71], a[24:27], v[16:19]
  ds_read_b128 a[92:95], v112 offset:16384
  v_mfma_f32_16x16x32_bf16 v[16:19], a[44:47], a[4:7], v[16:19]
  ds_read_b128 a[112:115], v113 offset:16384
  v_mfma_f32_16x16x32_bf16 v[96:99], a[48:51], a[0:3], v[96:99]
  ds_read_b128 a[96:99], v112 offset:18432
  buffer_load_dwordx4 v121, s[28:31], s68 offen offset:1024 sc1  lds
  v_mfma_f32_16x16x32_bf16 v[96:99], a[72:75], a[20:23], v[96:99]
  ds_read_b128 a[116:119], v113 offset:18432
  v_mfma_f32_16x16x32_bf16 v[32:35], a[72:75], a[24:27], v[32:35]
  ds_read_b128 a[100:103], v112 offset:20480
  v_mfma_f32_16x16x32_bf16 v[32:35], a[48:51], a[4:7], v[32:35]
  ds_read_b128 a[120:123], v113 offset:20480
  v_mfma_f32_16x16x32_bf16 v[36:39], a[48:51], a[8:11], v[36:39]
  ds_read_b128 a[104:107], v112 offset:22528
  buffer_load_dwordx4 v122, s[28:31], s68 offen offset:2048 sc1  lds
  v_mfma_f32_16x16x32_bf16 v[36:39], a[72:75], a[28:31], v[36:39]
  ds_read_b128 a[124:127], v113 offset:22528
  v_mfma_f32_16x16x32_bf16 v[40:43], a[72:75], a[32:35], v[40:43]
  ds_read_b64_tr_b16 a[132:133], v117 offset:24576
  v_mfma_f32_16x16x32_bf16 v[40:43], a[48:51], a[12:15], v[40:43]
  ds_read_b64_tr_b16 a[134:135], v117 offset:30720
  v_mfma_f32_16x16x32_bf16 v[44:47], a[48:51], a[16:19], v[44:47]
  ds_read_b64_tr_b16 a[156:157], v117 offset:36864
  buffer_load_dwordx4 v123, s[28:31], s68 offen offset:3072 sc1  lds
  v_mfma_f32_16x16x32_bf16 v[44:47], a[72:75], a[36:39], v[44:47]
  ds_read_b64_tr_b16 a[158:159], v117 offset:43008
  v_mfma_f32_16x16x32_bf16 v[60:63], a[76:79], a[36:39], v[60:63]
  ds_read_b128 a[88:91], v114 offset:1024
  v_mfma_f32_16x16x32_bf16 v[60:63], a[52:55], a[16:19], v[60:63]
  s_add_u32 m0, s63, 0
  ds_read_b128 a[108:111], v115 offset:1024
  v_mfma_f32_16x16x32_bf16 v[56:59], a[52:55], a[12:15], v[56:59]
  ds_read_b64_tr_b16 a[136:137], v116 offset:26624
  buffer_load_dwordx4 v124, s[8:11], s69 offen offset:0  lds
  v_mfma_f32_16x16x32_bf16 v[56:59], a[76:79], a[32:35], v[56:59]
  ds_read_b64_tr_b16 a[138:139], v116 offset:32768
  v_mfma_f32_16x16x32_bf16 v[52:55], a[76:79], a[28:31], v[52:55]
  s_add_u32 s44, s44, 1
  ds_read_b64_tr_b16 a[160:161], v116 offset:38912
  v_mfma_f32_16x16x32_bf16 v[52:55], a[52:55], a[8:11], v[52:55]
  s_and_b32 s44, s44, 15
  ds_read_b64_tr_b16 a[162:163], v116 offset:45056
  v_mfma_f32_16x16x32_bf16 v[48:51], a[52:55], a[4:7], v[48:51]
  s_add_u32 s66, s66, 1
  ds_read_b64_tr_b16 a[140:141], v117 offset:26624
  buffer_load_dwordx4 v125, s[8:11], s69 offen offset:1024  lds
  v_mfma_f32_16x16x32_bf16 v[48:51], a[76:79], a[24:27], v[48:51]
  s_mul_i32 s45, s44, s61
  ds_read_b64_tr_b16 a[142:143], v117 offset:32768
  v_mfma_f32_16x16x32_bf16 v[100:103], a[20:23], a[80:83], v[100:103]
  s_add_u32 s68, s45, s59
  ds_read_b64_tr_b16 a[164:165], v117 offset:38912
  v_mfma_f32_16x16x32_bf16 v[100:103], a[0:3], a[56:59], v[100:103]
  ds_read_b64_tr_b16 a[166:167], v117 offset:45056
  v_mfma_f32_16x16x32_bf16 v[64:67], a[4:7], a[56:59], v[64:67]
  ds_read_b64_tr_b16 a[144:145], v116 offset:28672
  buffer_load_dwordx4 v124, s[8:11], s69 offen offset:2048  lds
  v_mfma_f32_16x16x32_bf16 v[64:67], a[24:27], a[80:83], v[64:67]
  ds_read_b64_tr_b16 a[146:147], v116 offset:34816
  v_mfma_f32_16x16x32_bf16 v[68:71], a[28:31], a[80:83], v[68:71]
  ds_read_b64_tr_b16 a[168:169], v116 offset:40960
  v_mfma_f32_16x16x32_bf16 v[68:71], a[8:11], a[56:59], v[68:71]
  ds_read_b64_tr_b16 a[170:171], v116 offset:47104
  v_mfma_f32_16x16x32_bf16 v[72:75], a[12:15], a[56:59], v[72:75]
  ds_read_b64_tr_b16 a[148:149], v117 offset:28672
  buffer_load_dwordx4 v125, s[8:11], s69 offen offset:3072  lds
  v_mfma_f32_16x16x32_bf16 v[72:75], a[32:35], a[80:83], v[72:75]
  ds_read_b64_tr_b16 a[150:151], v117 offset:34816
  v_mfma_f32_16x16x32_bf16 v[76:79], a[36:39], a[80:83], v[76:79]
  ds_read_b64_tr_b16 a[172:173], v117 offset:40960
  v_mfma_f32_16x16x32_bf16 v[76:79], a[16:19], a[56:59], v[76:79]
  s_add_u32 m0, s63, 4096
  ds_read_b64_tr_b16 a[174:175], v117 offset:47104
  v_mfma_f32_16x16x32_bf16 v[92:95], a[16:19], a[60:63], v[92:95]
  buffer_load_dwordx4 v124, s[8:11], s70 offen offset:0  lds
  v_mfma_f32_16x16x32_bf16 v[92:95], a[36:39], a[84:87], v[92:95]
  v_mfma_f32_16x16x32_bf16 v[88:91], a[32:35], a[84:87], v[88:91]
  v_mfma_f32_16x16x32_bf16 v[88:91], a[12:15], a[60:63], v[88:91]
  v_mfma_f32_16x16x32_bf16 v[84:87], a[8:11], a[60:63], v[84:87]
  buffer_load_dwordx4 v125, s[8:11], s70 offen offset:1024  lds
  v_mfma_f32_16x16x32_bf16 v[84:87], a[28:31], a[84:87], v[84:87]
  v_mfma_f32_16x16x32_bf16 v[80:83], a[24:27], a[84:87], v[80:83]
  v_mfma_f32_16x16x32_bf16 v[80:83], a[4:7], a[60:63], v[80:83]
  s_cmp_eq_u32 s66, s88
  s_cbranch_scc0 Lside_skip0
  s_call_b64 s[78:79], Lside_sub
Lside_skip0:
Lp1_u1:
  s_waitcnt lgkmcnt(15)
  v_mfma_f32_16x16x32_bf16 v[0:3], a[128:131], a[92:95], v[0:3]
  s_mul_i32 s45, s44, 393216
  v_mfma_f32_16x16x32_bf16 v[0:3], a[152:155], a[112:115], v[0:3]
  s_add_u32 s69, s45, s60
  v_mfma_f32_16x16x32_bf16 v[4:7], a[152:155], a[116:119], v[4:7]
  s_add_u32 s70, s69, 4096
  v_mfma_f32_16x16x32_bf16 v[4:7], a[128:131], a[96:99], v[4:7]
  v_mfma_f32_16x16x32_bf16 v[8:11], a[128:131], a[100:103], v[8:11]
  v_mfma_f32_16x16x32_bf16 v[8:11], a[152:155], a[120:123], v[8:11]
  v_mfma_f32_16x16x32_bf16 v[12:15], a[152:155], a[124:127], v[12:15]
  v_mfma_f32_16x16x32_bf16 v[12:15], a[128:131], a[104:107], v[12:15]
  v_mfma_f32_16x16x32_bf16 v[28:31], a[132:135], a[104:107], v[28:31]
  v_mfma_f32_16x16x32_bf16 v[28:31], a[156:159], a[124:127], v[28:31]
  v_mfma_f32_16x16x32_bf16 v[24:27], a[156:159], a[120:123], v[24:27]
  s_waitcnt vmcnt(10) lgkmcnt(0)
  s_barrier
  ds_read_b64_tr_b16 a[40:41], v118 offset:0
  v_mfma_f32_16x16x32_bf16 v[24:27], a[132:135], a[100:103], v[24:27]
  s_add_u32 m0, s62, 90112
  ds_read_b64_tr_b16 a[42:43], v118 offset:6144
  v_mfma_f32_16x16x32_bf16 v[20:23], a[132:135], a[96:99], v[20:23]
  ds_read_b64_tr_b16 a[64:65], v118 offset:12288
  buffer_load_dwordx4 v120, s[28:31], s68 offen offset:0 sc1  lds
  v_mfma_f32_16x16x32_bf16 v[20:23], a[156:159], a[116:119], v[20:23]
  ds_read_b64_tr_b16 a[66:67], v118 offset:18432
  v_mfma_f32_16x16x32_bf16 v[16:19], a[156:159], a[112:115], v[16:19]
  ds_read_b128 a[4:7], v112 offset:32768
  v_mfma_f32_16x16x32_bf16 v[16:19], a[132:135], a[92:95], v[16:19]
  ds_read_b128 a[24:27], v113 offset:32768
  v_mfma_f32_16x16x32_bf16 v[96:99], a[136:139], a[88:91], v[96:99]
  ds_read_b128 a[8:11], v112 offset:34816
  buffer_load_dwordx4 v121, s[28:31], s68 offen offset:1024 sc1  lds
  v_mfma_f32_16x16x32_bf16 v[96:99], a[160:163], a[108:111], v[96:99]
  ds_read_b128 a[28:31], v113 offset:34816
  v_mfma_f32_16x16x32_bf16 v[32:35], a[160:163], a[112:115], v[32:35]
  ds_read_b128 a[12:15], v112 offset:36864
  v_mfma_f32_16x16x32_bf16 v[32:35], a[136:139], a[92:95], v[32:35]
  ds_read_b128 a[32:35], v113 offset:36864
  v_mfma_f32_16x16x32_bf16 v[36:39], a[136:139], a[96:99], v[36:39]
  ds_read_b128 a[16:19], v112 offset:38912
  buffer_load_dwordx4 v122, s[28:31], s68 offen offset:2048 sc1  lds
  v_mfma_f32_16x16x32_bf16 v[36:39], a[160:163], a[116:119], v[36:39]
  ds_read_b128 a[36:39], v113 offset:38912
  v_mfma_f32_16x16x32_bf16 v[40:43], a[160:163], a[120:123], v[40:43]
  ds_read_b64_tr_b16 a[44:45], v119 offset:0
  v_mfma_f32_16x16x32_bf16 v[40:43], a[136:139], a[100:103], v[40:43]
  ds_read_b64_tr_b16 a[46:47], v119 offset:6144
  v_mfma_f32_16x16x32_bf16 v[44:47], a[136:139], a[104:107], v[44:47]
  ds_read_b64_tr_b16 a[68:69], v119 offset:12288
  buffer_load_dwordx4 v123, s[28:31], s68 offen offset:3072 sc1  lds
  v_mfma_f32_16x16x32_bf16 v[44:47], a[160:163], a[124:127], v[44:47]
  ds_read_b64_tr_b16 a[70:71], v119 offset:18432
  v_mfma_f32_16x16x32_bf16 v[60:63], a[164:167], a[124:127], v[60:63]
  ds_read_b128 a[0:3], v114 offset:2048
  v_mfma_f32_16x16x32_bf16 v[60:63], a[140:143], a[104:107], v[60:63]
  s_add_u32 m0, s63, 24576
  ds_read_b128 a[20:23], v115 offset:2048
  v_mfma_f32_16x16x32_bf16 v[56:59], a[140:143], a[100:103], v[56:59]
  ds_read_b64_tr_b16 a[48:49], v118 offset:2048
  buffer_load_dwordx4 v124, s[8:11], s69 offen offset:0  lds
  v_mfma_f32_16x16x32_bf16 v[56:59], a[164:167], a[120:123], v[56:59]
  ds_read_b64_tr_b16 a[50:51], v118 offset:8192
  v_mfma_f32_16x16x32_bf16 v[52:55], a[164:167], a[116:119], v[52:55]
  s_add_u32 s44, s44, 1
  ds_read_b64_tr_b16 a[72:73], v118 offset:14336
  v_mfma_f32_16x16x32_bf16 v[52:55], a[140:143], a[96:99], v[52:55]
  s_and_b32 s44, s44, 15
  ds_read_b64_tr_b16 a[74:75], v118 offset:20480
  v_mfma_f32_16x16x32_bf16 v[48:51], a[140:143], a[92:95], v[48:51]
  s_add_u32 s66, s66, 1
  ds_read_b64_tr_b16 a[52:53], v119 offset:2048
  buffer_load_dwordx4 v125, s[8:11], s69 offen offset:1024  lds
  v_mfma_f32_16x16x32_bf16 v[48:51], a[164:167], a[112:115], v[48:51]
  s_mul_i32 s45, s44, s61
  ds_read_b64_tr_b16 a[54:55], v119 offset:8192
  v_mfma_f32_16x16x32_bf16 v[100:103], a[108:111], a[168:171], v[100:103]
  s_add_u32 s68, s45, s59
  ds_read_b64_tr_b16 a[76:77], v119 offset:14336
  v_mfma_f32_16x16x32_bf16 v[100:103], a[88:91], a[144:147], v[100:103]
  ds_read_b64_tr_b16 a[78:79], v119 offset:20480
  v_mfma_f32_16x16x32_bf16 v[64:67], a[92:95], a[144:147], v[64:67]
  ds_read_b64_tr_b16 a[56:57], v118 offset:4096
  buffer_load_dwordx4 v124, s[8:11], s69 offen offset:2048  lds
  v_mfma_f32_16x16x32_bf16 v[64:67], a[112:115], a[168:171], v[64:67]
  ds_read_b64_tr_b16 a[58:59], v118 offset:10240
  v_mfma_f32_16x16x32_bf16 v[68:71], a[116:119], a[168:171], v[68:71]
  ds_read_b64_tr_b16 a[80:81], v118 offset:16384
  v_mfma_f32_16x16x32_bf16 v[68:71], a[96:99], a[144:147], v[68:71]
  ds_read_b64_tr_b16 a[82:83], v118 offset:22528
  v_mfma_f32_16x16x32_bf16 v[72:75], a[100:103], a[144:147], v[72:75]
  ds_read_b64_tr_b16 a[60:61], v119 offset:4096
  buffer_load_dwordx4 v125, s[8:11], s69 offen offset:3072  lds
  v_mfma_f32_16x16x32_bf16 v[72:75], a[120:123], a[168:171], v[72:75]
  ds_read_b64_tr_b16 a[62:63], v119 offset:10240
  v_mfma_f32_16x16x32_bf16 v[76:79], a[124:127], a[168:171], v[76:79]
  ds_read_b64_tr_b16 a[84:85], v119 offset:16384
  v_mfma_f32_16x16x32_bf16 v[76:79], a[104:107], a[144:147], v[76:79]
  s_add_u32 m0, s63, 28672
  ds_read_b64_tr_b16 a[86:87], v119 offset:22528
  v_mfma_f32_16x16x32_bf16 v[92:95], a[104:107], a[148:151], v[92:95]
  buffer_load_dwordx4 v124, s[8:11], s70 offen offset:0  lds
  v_mfma_f32_16x16x32_bf16 v[92:95], a[124:127], a[172:175], v[92:95]
  v_mfma_f32_16x16x32_bf16 v[88:91], a[120:123], a[172:175], v[88:91]
  v_mfma_f32_16x16x32_bf16 v[88:91], a[100:103], a[148:151], v[88:91]
  v_mfma_f32_16x16x32_bf16 v[84:87], a[96:99], a[148:151], v[84:87]
  buffer_load_dwordx4 v125, s[8:11], s70 offen offset:1024  lds
  v_mfma_f32_16x16x32_bf16 v[84:87], a[116:119], a[172:175], v[84:87]
  v_mfma_f32_16x16x32_bf16 v[80:83], a[112:115], a[172:175], v[80:83]
  v_mfma_f32_16x16x32_bf16 v[80:83], a[92:95], a[148:151], v[80:83]
  s_cmp_eq_u32 s66, s88
  s_cbranch_scc0 Lside_skip1
  s_call_b64 s[78:79], Lside_sub
Lside_skip1:
  s_waitcnt lgkmcnt(15)
  v_mfma_f32_16x16x32_bf16 v[0:3], a[40:43], a[4:7], v[0:3]
  s_mul_i32 s45, s44, 393216
  v_mfma_f32_16x16x32_bf16 v[0:3], a[64:67], a[24:27], v[0:3]
  s_add_u32 s69, s45, s60
  v_mfma_f32_16x16x32_bf16 v[4:7], a[64:67], a[28:31], v[4:7]
  s_add_u32 s70, s69, 4096
  v_mfma_f32_16x16x32_bf16 v[4:7], a[40:43], a[8:11], v[4:7]
  v_mfma_f32_16x16x32_bf16 v[8:11], a[40:43], a[12:15], v[8:11]
  v_mfma_f32_16x16x32_bf16 v[8:11], a[64:67], a[32:35], v[8:11]
  v_mfma_f32_16x16x32_bf16 v[12:15], a[64:67], a[36:39], v[12:15]
  v_mfma_f32_16x16x32_bf16 v[12:15], a[40:43], a[16:19], v[12:15]
  v_mfma_f32_16x16x32_bf16 v[28:31], a[44:47], a[16:19], v[28:31]
  v_mfma_f32_16x16x32_bf16 v[28:31], a[68:71], a[36:39], v[28:31]
  v_mfma_f32_16x16x32_bf16 v[24:27], a[68:71], a[32:35], v[24:27]
  s_waitcnt vmcnt(10) lgkmcnt(0)
  s_barrier
  ds_read_b64_tr_b16 a[128:129], v116 offset:0
  v_mfma_f32_16x16x32_bf16 v[24:27], a[44:47], a[12:15], v[24:27]
  s_add_u32 m0, s62, 106496
  ds_read_b64_tr_b16 a[130:131], v116 offset:6144
  v_mfma_f32_16x16x32_bf16 v[20:23], a[44:47], a[8:11], v[20:23]
  ds_read_b64_tr_b16 a[152:153], v116 offset:12288
  buffer_load_dwordx4 v120, s[28:31], s68 offen offset:0 sc1  lds
  v_mfma_f32_16x16x32_bf16 v[20:23], a[68:71], a[28:31], v[20:23]
  ds_read_b64_tr_b16 a[154:155], v116 offset:18432
  v_mfma_f32_16x16x32_bf16 v[16:19], a[68:71], a[24:27], v[16:19]
  ds_read_b128 a[92:95], v112 offset:0
  v_mfma_f32_16x16x32_bf16 v[16:19], a[44:47], a[4:7], v[16:19]
  ds_read_b128 a[112:115], v113 offset:0
  v_mfma_f32_16x16x32_bf16 v[96:99], a[48:51], a[0:3], v[96:99]
  ds_read_b128 a[96:99], v112 offset:2048
  buffer_load_dwordx4 v121, s[28:31], s68 offen offset:1024 sc1  lds
  v_mfma_f32_16x16x32_bf16 v[96:99], a[72:75], a[20:23], v[96:99]
  ds_read_b128 a[116:119], v113 offset:2048
  v_mfma_f32_16x16x32_bf16 v[32:35], a[72:75], a[24:27], v[32:35]
  ds_read_b128 a[100:103], v112 offset:4096
  v_mfma_f32_16x16x32_bf16 v[32:35], a[48:51], a[4:7], v[32:35]
  ds_read_b128 a[120:123], v113 offset:4096
  v_mfma_f32_16x16x32_bf16 v[36:39], a[48:51], a[8:11], v[36:39]
  ds_read_b128 a[104:107], v112 offset:6144
  buffer_load_dwordx4 v122, s[28:31], s68 offen offset:2048 sc1  lds
  v_mfma_f32_16x16x32_bf16 v[36:39], a[72:75], a[28:31], v[36:39]
  ds_read_b128 a[124:127], v113 offset:6144
  v_mfma_f32_16x16x32_bf16 v[40:43], a[72:75], a[32:35], v[40:43]
  ds_read_b64_tr_b16 a[132:133], v117 offset:0
  v_mfma_f32_16x16x32_bf16 v[40:43], a[48:51], a[12:15], v[40:43]
  ds_read_b64_tr_b16 a[134:135], v117 offset:6144
  v_mfma_f32_16x16x32_bf16 v[44:47], a[48:51], a[16:19], v[44:47]
  ds_read_b64_tr_b16 a[156:157], v117 offset:12288
  buffer_load_dwordx4 v123, s[28:31], s68 offen offset:3072 sc1  lds
  v_mfma_f32_16x16x32_bf16 v[44:47], a[72:75], a[36:39], v[44:47]
  ds_read_b64_tr_b16 a[158:159], v117 offset:18432
  v_mfma_f32_16x16x32_bf16 v[60:63], a[76:79], a[36:39], v[60:63]
  ds_read_b128 a[88:91], v114 offset:3072
  v_mfma_f32_16x16x32_bf16 v[60:63], a[52:55], a[16:19], v[60:63]
  s_add_u32 m0, s63, 49152
  ds_read_b128 a[108:111], v115 offset:3072
  v_mfma_f32_16x16x32_bf16 v[56:59], a[52:55], a[12:15], v[56:59]
  ds_read_b64_tr_b16 a[136:137], v116 offset:2048
  buffer_load_dwordx4 v124, s[8:11], s69 offen offset:0  lds
  v_mfma_f32_16x16x32_bf16 v[56:59], a[76:79], a[32:35], v[56:59]
  ds_read_b64_tr_b16 a[138:139], v116 offset:8192
  v_mfma_f32_16x16x32_bf16 v[52:55], a[76:79], a[28:31], v[52:55]
  s_add_u32 s44, s44, 1
  ds_read_b64_tr_b16 a[160:161], v116 offset:14336
  v_mfma_f32_16x16x32_bf16 v[52:55], a[52:55], a[8:11], v[52:55]
  s_and_b32 s44, s44, 15
  ds_read_b64_tr_b16 a[162:163], v116 offset:20480
  v_mfma_f32_16x16x32_bf16 v[48:51], a[52:55], a[4:7], v[48:51]
  s_add_u32 s66, s66, 1
  ds_read_b64_tr_b16 a[140:141], v117 offset:2048
  buffer_load_dwordx4 v125, s[8:11], s69 offen offset:1024  lds
  v_mfma_f32_16x16x32_bf16 v[48:51], a[76:79], a[24:27], v[48:51]
  s_mul_i32 s45, s44, s61
  ds_read_b64_tr_b16 a[142:143], v117 offset:8192
  v_mfma_f32_16x16x32_bf16 v[100:103], a[20:23], a[80:83], v[100:103]
  s_add_u32 s68, s45, s59
  ds_read_b64_tr_b16 a[164:165], v117 offset:14336
  v_mfma_f32_16x16x32_bf16 v[100:103], a[0:3], a[56:59], v[100:103]
  ds_read_b64_tr_b16 a[166:167], v117 offset:20480
  v_mfma_f32_16x16x32_bf16 v[64:67], a[4:7], a[56:59], v[64:67]
  ds_read_b64_tr_b16 a[144:145], v116 offset:4096
  buffer_load_dwordx4 v124, s[8:11], s69 offen offset:2048  lds
  v_mfma_f32_16x16x32_bf16 v[64:67], a[24:27], a[80:83], v[64:67]
  ds_read_b64_tr_b16 a[146:147], v116 offset:10240
  v_mfma_f32_16x16x32_bf16 v[68:71], a[28:31], a[80:83], v[68:71]
  ds_read_b64_tr_b16 a[168:169], v116 offset:16384
  v_mfma_f32_16x16x32_bf16 v[68:71], a[8:11], a[56:59], v[68:71]
  ds_read_b64_tr_b16 a[170:171], v116 offset:22528
  v_mfma_f32_16x16x32_bf16 v[72:75], a[12:15], a[56:59], v[72:75]
  ds_read_b64_tr_b16 a[148:149], v117 offset:4096
  buffer_load_dwordx4 v125, s[8:11], s69 offen offset:3072  lds
  v_mfma_f32_16x16x32_bf16 v[72:75], a[32:35], a[80:83], v[72:75]
  ds_read_b64_tr_b16 a[150:151], v117 offset:10240
  v_mfma_f32_16x16x32_bf16 v[76:79], a[36:39], a[80:83], v[76:79]
  ds_read_b64_tr_b16 a[172:173], v117 offset:16384
  v_mfma_f32_16x16x32_bf16 v[76:79], a[16:19], a[56:59], v[76:79]
  s_add_u32 m0, s63, 53248
  ds_read_b64_tr_b16 a[174:175], v117 offset:22528
  v_mfma_f32_16x16x32_bf16 v[92:95], a[16:19], a[60:63], v[92:95]
  buffer_load_dwordx4 v124, s[8:11], s70 offen offset:0  lds
  v_mfma_f32_16x16x32_bf16 v[92:95], a[36:39], a[84:87], v[92:95]
  v_mfma_f32_16x16x32_bf16 v[88:91], a[32:35], a[84:87], v[88:91]
  v_mfma_f32_16x16x32_bf16 v[88:91], a[12:15], a[60:63], v[88:91]
  v_mfma_f32_16x16x32_bf16 v[84:87], a[8:11], a[60:63], v[84:87]
  buffer_load_dwordx4 v125, s[8:11], s70 offen offset:1024  lds
  v_mfma_f32_16x16x32_bf16 v[84:87], a[28:31], a[84:87], v[84:87]
  v_mfma_f32_16x16x32_bf16 v[80:83], a[24:27], a[84:87], v[80:83]
  v_mfma_f32_16x16x32_bf16 v[80:83], a[4:7], a[60:63], v[80:83]
  s_cmp_eq_u32 s66, s88
  s_cbranch_scc0 Lside_skip2
  s_call_b64 s[78:79], Lside_sub
Lside_skip2:
  s_waitcnt lgkmcnt(15)
  v_mfma_f32_16x16x32_bf16 v[0:3], a[128:131], a[92:95], v[0:3]
  s_mul_i32 s45, s44, 393216
  v_mfma_f32_16x16x32_bf16 v[0:3], a[152:155], a[112:115], v[0:3]
  s_add_u32 s69, s45, s60
  v_mfma_f32_16x16x32_bf16 v[4:7], a[152:155], a[116:119], v[4:7]
  s_add_u32 s70, s69, 4096
  v_mfma_f32_16x16x32_bf16 v[4:7], a[128:131], a[96:99], v[4:7]
  v_mfma_f32_16x16x32_bf16 v[8:11], a[128:131], a[100:103], v[8:11]
  v_mfma_f32_16x16x32_bf16 v[8:11], a[152:155], a[120:123], v[8:11]
  v_mfma_f32_16x16x32_bf16 v[12:15], a[152:155], a[124:127], v[12:15]
  v_mfma_f32_16x16x32_bf16 v[12:15], a[128:131], a[104:107], v[12:15]
  v_mfma_f32_16x16x32_bf16 v[28:31], a[132:135], a[104:107], v[28:31]
  v_mfma_f32_16x16x32_bf16 v[28:31], a[156:159], a[124:127], v[28:31]
  v_mfma_f32_16x16x32_bf16 v[24:27], a[156:159], a[120:123], v[24:27]
  s_waitcnt vmcnt(10) lgkmcnt(0)
  s_barrier
  ds_read_b64_tr_b16 a[40:41], v116 offset:24576
  v_mfma_f32_16x16x32_bf16 v[24:27], a[132:135], a[100:103], v[24:27]
  s_add_u32 m0, s62, 73728
  ds_read_b64_tr_b16 a[42:43], v116 offset:30720
  v_mfma_f32_16x16x32_bf16 v[20:23], a[132:135], a[96:99], v[20:23]
  ds_read_b64_tr_b16 a[64:65], v116 offset:36864
  buffer_load_dwordx4 v120, s[28:31], s68 offen offset:0 sc1  lds
  v_mfma_f32_16x16x32_bf16 v[20:23], a[156:159], a[116:119], v[20:23]
  ds_read_b64_tr_b16 a[66:67], v116 offset:43008
  v_mfma_f32_16x16x32_bf16 v[16:19], a[156:159], a[112:115], v[16:19]
  ds_read_b128 a[4:7], v112 offset:16384
  v_mfma_f32_16x16x32_bf16 v[16:19], a[132:135], a[92:95], v[16:19]
  ds_read_b128 a[24:27], v113 offset:16384
  v_mfma_f32_16x16x32_bf16 v[96:99], a[136:139], a[88:91], v[96:99]
  ds_read_b128 a[8:11], v112 offset:18432
  buffer_load_dwordx4 v121, s[28:31], s68 offen offset:1024 sc1  lds
  v_mfma_f32_16x16x32_bf16 v[96:99], a[160:163], a[108:111], v[96:99]
  ds_read_b128 a[28:31], v113 offset:18432
  v_mfma_f32_16x16x32_bf16 v[32:35], a[160:163], a[112:115], v[32:35]
  ds_read_b128 a[12:15], v112 offset:20480
  v_mfma_f32_16x16x32_bf16 v[32:35], a[136:139], a[92:95], v[32:35]
  ds_read_b128 a[32:35], v113 offset:20480
  v_mfma_f32_16x16x32_bf16 v[36:39], a[136:139], a[96:99], v[36:39]
  ds_read_b128 a[16:19], v112 offset:22528
  buffer_load_dwordx4 v122, s[28:31], s68 offen offset:2048 sc1  lds
  v_mfma_f32_16x16x32_bf16 v[36:39], a[160:163], a[116:119], v[36:39]
  ds_read_b128 a[36:39], v113 offset:22528
  v_mfma_f32_16x16x32_bf16 v[40:43], a[160:163], a[120:123], v[40:43]
  ds_read_b64_tr_b16 a[44:45], v117 offset:24576
  v_mfma_f32_16x16x32_bf16 v[40:43], a[136:139], a[100:103], v[40:43]
  ds_read_b64_tr_b16 a[46:47], v117 offset:30720
  v_mfma_f32_16x16x32_bf16 v[44:47], a[136:139], a[104:107], v[44:47]
  ds_read_b64_tr_b16 a[68:69], v117 offset:36864
  buffer_load_dwordx4 v123, s[28:31], s68 offen offset:3072 sc1  lds
  v_mfma_f32_16x16x32_bf16 v[44:47], a[160:163], a[124:127], v[44:47]
  ds_read_b64_tr_b16 a[70:71], v117 offset:43008
  v_mfma_f32_16x16x32_bf16 v[60:63], a[164:167], a[124:127], v[60:63]
  ds_read_b128 a[0:3], v114 offset:4096
  v_mfma_f32_16x16x32_bf16 v[60:63], a[140:143], a[104:107], v[60:63]
  s_add_u32 m0, s63, 0
  ds_read_b128 a[20:23], v115 offset:4096
  v_mfma_f32_16x16x32_bf16 v[56:59], a[140:143], a[100:103], v[56:59]
  ds_read_b64_tr_b16 a[48:49], v116 offset:26624
  buffer_load_dwordx4 v124, s[8:11], s69 offen offset:0  lds
  v_mfma_f32_16x16x32_bf16 v[56:59], a[164:167], a[120:123], v[56:59]
  ds_read_b64_tr_b16 a[50:51], v116 offset:32768
  v_mfma_f32_16x16x32_bf16 v[52:55], a[164:167], a[116:119], v[52:55]
  s_add_u32 s44, s44, 1
  ds_read_b64_tr_b16 a[72:73], v116 offset:38912
  v_mfma_f32_16x16x32_bf16 v[52:55], a[140:143], a[96:99], v[52:55]
  s_and_b32 s44, s44, 15
  ds_read_b64_tr_b16 a[74:75], v116 offset:45056
  v_mfma_f32_16x16x32_bf16 v[48:51], a[140:143], a[92:95], v[48:51]
  s_add_u32 s66, s66, 1
  ds_read_b64_tr_b16 a[52:53], v117 offset:26624
  buffer_load_dwordx4 v125, s[8:11], s69 offen offset:1024  lds
  v_mfma_f32_16x16x32_bf16 v[48:51], a[164:167], a[112:115], v[48:51]
  s_mul_i32 s45, s44, s61
  ds_read_b64_tr_b16 a[54:55], v117 offset:32768
  v_mfma_f32_16x16x32_bf16 v[100:103], a[108:111], a[168:171], v[100:103]
  s_add_u32 s68, s45, s59
  ds_read_b64_tr_b16 a[76:77], v117 offset:38912
  v_mfma_f32_16x16x32_bf16 v[100:103], a[88:91], a[144:147], v[100:103]
  ds_read_b64_tr_b16 a[78:79], v117 offset:45056
  v_mfma_f32_16x16x32_bf16 v[64:67], a[92:95], a[144:147], v[64:67]
  ds_read_b64_tr_b16 a[56:57], v116 offset:28672
  buffer_load_dwordx4 v124, s[8:11], s69 offen offset:2048  lds
  v_mfma_f32_16x16x32_bf16 v[64:67], a[112:115], a[168:171], v[64:67]
  ds_read_b64_tr_b16 a[58:59], v116 offset:34816
  v_mfma_f32_16x16x32_bf16 v[68:71], a[116:119], a[168:171], v[68:71]
  ds_read_b64_tr_b16 a[80:81], v116 offset:40960
  v_mfma_f32_16x16x32_bf16 v[68:71], a[96:99], a[144:147], v[68:71]
  ds_read_b64_tr_b16 a[82:83], v116 offset:47104
  v_mfma_f32_16x16x32_bf16 v[72:75], a[100:103], a[144:147], v[72:75]
  ds_read_b64_tr_b16 a[60:61], v117 offset:28672
  buffer_load_dwordx4 v125, s[8:11], s69 offen offset:3072  lds
  v_mfma_f32_16x16x32_bf16 v[72:75], a[120:123], a[168:171], v[72:75]
  ds_read_b64_tr_b16 a[62:63], v117 offset:34816
  v_mfma_f32_16x16x32_bf16 v[76:79], a[124:127], a[168:171], v[76:79]
  ds_read_b64_tr_b16 a[84:85], v117 offset:40960
  v_mfma_f32_16x16x32_bf16 v[76:79], a[104:107], a[144:147], v[76:79]
  s_add_u32 m0, s63, 4096
  ds_read_b64_tr_b16 a[86:87], v117 offset:47104
  v_mfma_f32_16x16x32_bf16 v[92:95], a[104:107], a[148:151], v[92:95]
  buffer_load_dwordx4 v124, s[8:11], s70 offen offset:0  lds
  v_mfma_f32_16x16x32_bf16 v[92:95], a[124:127], a[172:175], v[92:95]
  v_mfma_f32_16x16x32_bf16 v[88:91], a[120:123], a[172:175], v[88:91]
  v_mfma_f32_16x16x32_bf16 v[88:91], a[100:103], a[148:151], v[88:91]
  v_mfma_f32_16x16x32_bf16 v[84:87], a[96:99], a[148:151], v[84:87]
  buffer_load_dwordx4 v125, s[8:11], s70 offen offset:1024  lds
  v_mfma_f32_16x16x32_bf16 v[84:87], a[116:119], a[172:175], v[84:87]
  v_mfma_f32_16x16x32_bf16 v[80:83], a[112:115], a[172:175], v[80:83]
  v_mfma_f32_16x16x32_bf16 v[80:83], a[92:95], a[148:151], v[80:83]
  s_cmp_eq_u32 s66, s88
  s_cbranch_scc0 Lside_skip3
  s_call_b64 s[78:79], Lside_sub
Lside_skip3:
  s_waitcnt lgkmcnt(15)
  v_mfma_f32_16x16x32_bf16 v[0:3], a[40:43], a[4:7], v[0:3]
  s_mul_i32 s45, s44, 393216
  v_mfma_f32_16x16x32_bf16 v[0:3], a[64:67], a[24:27], v[0:3]
  s_add_u32 s69, s45, s60
  v_mfma_f32_16x16x32_bf16 v[4:7], a[64:67], a[28:31], v[4:7]
  s_add_u32 s70, s69, 4096
  v_mfma_f32_16x16x32_bf16 v[4:7], a[40:43], a[8:11], v[4:7]
  v_mfma_f32_16x16x32_bf16 v[8:11], a[40:43], a[12:15], v[8:11]
  v_mfma_f32_16x16x32_bf16 v[8:11], a[64:67], a[32:35], v[8:11]
  v_mfma_f32_16x16x32_bf16 v[12:15], a[64:67], a[36:39], v[12:15]
  v_mfma_f32_16x16x32_bf16 v[12:15], a[40:43], a[16:19], v[12:15]
  v_mfma_f32_16x16x32_bf16 v[28:31], a[44:47], a[16:19], v[28:31]
  v_mfma_f32_16x16x32_bf16 v[28:31], a[68:71], a[36:39], v[28:31]
  v_mfma_f32_16x16x32_bf16 v[24:27], a[68:71], a[32:35], v[24:27]
  s_waitcnt vmcnt(10) lgkmcnt(0)
  s_barrier
  ds_read_b64_tr_b16 a[128:129], v118 offset:0
  v_mfma_f32_16x16x32_bf16 v[24:27], a[44:47], a[12:15], v[24:27]
  s_add_u32 m0, s62, 90112
  ds_read_b64_tr_b16 a[130:131], v118 offset:6144
  v_mfma_f32_16x16x32_bf16 v[20:23], a[44:47], a[8:11], v[20:23]
  ds_read_b64_tr_b16 a[152:153], v118 offset:12288
  buffer_load_dwordx4 v120, s[28:31], s68 offen offset:0 sc1  lds
  v_mfma_f32_16x16x32_bf16 v[20:23], a[68:71], a[28:31], v[20:23]
  ds_read_b64_tr_b16 a[154:155], v118 offset:18432
  v_mfma_f32_16x16x32_bf16 v[16:19], a[68:71], a[24:27], v[16:19]
  ds_read_b128 a[92:95], v112 offset:32768
  v_mfma_f32_16x16x32_bf16 v[16:19], a[44:47], a[4:7], v[16:19]
  ds_read_b128 a[112:115], v113 offset:32768
  v_mfma_f32_16x16x32_bf16 v[96:99], a[48:51], a[0:3], v[96:99]
  ds_read_b128 a[96:99], v112 offset:34816
  buffer_load_dwordx4 v121, s[28:31], s68 offen offset:1024 sc1  lds
  v_mfma_f32_16x16x32_bf16 v[96:99], a[72:75], a[20:23], v[96:99]
  ds_read_b128 a[116:119], v113 offset:34816
  v_mfma_f32_16x16x32_bf16 v[32:35], a[72:75], a[24:27], v[32:35]
  ds_read_b128 a[100:103], v112 offset:36864
  v_mfma_f32_16x16x32_bf16 v[32:35], a[48:51], a[4:7], v[32:35]
  ds_read_b128 a[120:123], v113 offset:36864
  v_mfma_f32_16x16x32_bf16 v[36:39], a[48:51], a[8:11], v[36:39]
  ds_read_b128 a[104:107], v112 offset:38912
  buffer_load_dwordx4 v122, s[28:31], s68 offen offset:2048 sc1  lds
  v_mfma_f32_16x16x32_bf16 v[36:39], a[72:75], a[28:31], v[36:39]
  ds_read_b128 a[124:127], v113 offset:38912
  v_mfma_f32_16x16x32_bf16 v[40:43], a[72:75], a[32:35], v[40:43]
  ds_read_b64_tr_b16 a[132:133], v119 offset:0
  v_mfma_f32_16x16x32_bf16 v[40:43], a[48:51], a[12:15], v[40:43]
  ds_read_b64_tr_b16 a[134:135], v119 offset:6144
  v_mfma_f32_16x16x32_bf16 v[44:47], a[48:51], a[16:19], v[44:47]
  ds_read_b64_tr_b16 a[156:157], v119 offset:12288
  buffer_load_dwordx4 v123, s[28:31], s68 offen offset:3072 sc1  lds
  v_mfma_f32_16x16x32_bf16 v[44:47], a[72:75], a[36:39], v[44:47]
  ds_read_b64_tr_b16 a[158:159], v119 offset:18432
  v_mfma_f32_16x16x32_bf16 v[60:63], a[76:79], a[36:39], v[60:63]
  ds_read_b128 a[88:91], v114 offset:5120
  v_mfma_f32_16x16x32_bf16 v[60:63], a[52:55], a[16:19], v[60:63]
  s_add_u32 m0, s63, 24576
  ds_read_b128 a[108:111], v115 offset:5120
  v_mfma_f32_16x16x32_bf16 v[56:59], a[52:55], a[12:15], v[56:59]
  ds_read_b64_tr_b16 a[136:137], v118 offset:2048
  buffer_load_dwordx4 v124, s[8:11], s69 offen offset:0  lds
  v_mfma_f32_16x16x32_bf16 v[56:59], a[76:79], a[32:35], v[56:59]
  ds_read_b64_tr_b16 a[138:139], v118 offset:8192
  v_mfma_f32_16x16x32_bf16 v[52:55], a[76:79], a[28:31], v[52:55]
  s_add_u32 s44, s44, 1
  ds_read_b64_tr_b16 a[160:161], v118 offset:14336
  v_mfma_f32_16x16x32_bf16 v[52:55], a[52:55], a[8:11], v[52:55]
  s_and_b32 s44, s44, 15
  ds_read_b64_tr_b16 a[162:163], v118 offset:20480
  v_mfma_f32_16x16x32_bf16 v[48:51], a[52:55], a[4:7], v[48:51]
  s_add_u32 s66, s66, 1
  ds_read_b64_tr_b16 a[140:141], v119 offset:2048
  buffer_load_dwordx4 v125, s[8:11], s69 offen offset:1024  lds
  v_mfma_f32_16x16x32_bf16 v[48:51], a[76:79], a[24:27], v[48:51]
  s_mul_i32 s45, s44, s61
  ds_read_b64_tr_b16 a[142:143], v119 offset:8192
  v_mfma_f32_16x16x32_bf16 v[100:103], a[20:23], a[80:83], v[100:103]
  s_add_u32 s68, s45, s59
  ds_read_b64_tr_b16 a[164:165], v119 offset:14336
  v_mfma_f32_16x16x32_bf16 v[100:103], a[0:3], a[56:59], v[100:103]
  ds_read_b64_tr_b16 a[166:167], v119 offset:20480
  v_mfma_f32_16x16x32_bf16 v[64:67], a[4:7], a[56:59], v[64:67]
  ds_read_b64_tr_b16 a[144:145], v118 offset:4096
  buffer_load_dwordx4 v124, s[8:11], s69 offen offset:2048  lds
  v_mfma_f32_16x16x32_bf16 v[64:67], a[24:27], a[80:83], v[64:67]
  ds_read_b64_tr_b16 a[146:147], v118 offset:10240
  v_mfma_f32_16x16x32_bf16 v[68:71], a[28:31], a[80:83], v[68:71]
  ds_read_b64_tr_b16 a[168:169], v118 offset:16384
  v_mfma_f32_16x16x32_bf16 v[68:71], a[8:11], a[56:59], v[68:71]
  ds_read_b64_tr_b16 a[170:171], v118 offset:22528
  v_mfma_f32_16x16x32_bf16 v[72:75], a[12:15], a[56:59], v[72:75]
  ds_read_b64_tr_b16 a[148:149], v119 offset:4096
  buffer_load_dwordx4 v125, s[8:11], s69 offen offset:3072  lds
  v_mfma_f32_16x16x32_bf16 v[72:75], a[32:35], a[80:83], v[72:75]
  ds_read_b64_tr_b16 a[150:151], v119 offset:10240
  v_mfma_f32_16x16x32_bf16 v[76:79], a[36:39], a[80:83], v[76:79]
  ds_read_b64_tr_b16 a[172:173], v119 offset:16384
  v_mfma_f32_16x16x32_bf16 v[76:79], a[16:19], a[56:59], v[76:79]
  s_add_u32 m0, s63, 28672
  ds_read_b64_tr_b16 a[174:175], v119 offset:22528
  v_mfma_f32_16x16x32_bf16 v[92:95], a[16:19], a[60:63], v[92:95]
  buffer_load_dwordx4 v124, s[8:11], s70 offen offset:0  lds
  v_mfma_f32_16x16x32_bf16 v[92:95], a[36:39], a[84:87], v[92:95]
  v_mfma_f32_16x16x32_bf16 v[88:91], a[32:35], a[84:87], v[88:91]
  v_mfma_f32_16x16x32_bf16 v[88:91], a[12:15], a[60:63], v[88:91]
  v_mfma_f32_16x16x32_bf16 v[84:87], a[8:11], a[60:63], v[84:87]
  buffer_load_dwordx4 v125, s[8:11], s70 offen offset:1024  lds
  v_mfma_f32_16x16x32_bf16 v[84:87], a[28:31], a[84:87], v[84:87]
  v_mfma_f32_16x16x32_bf16 v[80:83], a[24:27], a[84:87], v[80:83]
  v_mfma_f32_16x16x32_bf16 v[80:83], a[4:7], a[60:63], v[80:83]
  s_cmp_eq_u32 s66, s88
  s_cbranch_scc0 Lside_skip4
  s_call_b64 s[78:79], Lside_sub
Lside_skip4:
  s_waitcnt lgkmcnt(15)
  v_mfma_f32_16x16x32_bf16 v[0:3], a[128:131], a[92:95], v[0:3]
  s_mul_i32 s45, s44, 393216
  v_mfma_f32_16x16x32_bf16 v[0:3], a[152:155], a[112:115], v[0:3]
  s_add_u32 s69, s45, s60
  v_mfma_f32_16x16x32_bf16 v[4:7], a[152:155], a[116:119], v[4:7]
  s_add_u32 s70, s69, 4096
  v_mfma_f32_16x16x32_bf16 v[4:7], a[128:131], a[96:99], v[4:7]
  v_mfma_f32_16x16x32_bf16 v[8:11], a[128:131], a[100:103], v[8:11]
  v_mfma_f32_16x16x32_bf16 v[8:11], a[152:155], a[120:123], v[8:11]
  v_mfma_f32_16x16x32_bf16 v[12:15], a[152:155], a[124:127], v[12:15]
  v_mfma_f32_16x16x32_bf16 v[12:15], a[128:131], a[104:107], v[12:15]
  v_mfma_f32_16x16x32_bf16 v[28:31], a[132:135], a[104:107], v[28:31]
  v_mfma_f32_16x16x32_bf16 v[28:31], a[156:159], a[124:127], v[28:31]
  v_mfma_f32_16x16x32_bf16 v[24:27], a[156:159], a[120:123], v[24:27]
  s_waitcnt vmcnt(10) lgkmcnt(0)
  s_barrier
  ds_read_b64_tr_b16 a[40:41], v116 offset:0
  v_mfma_f32_16x16x32_bf16 v[24:27], a[132:135], a[100:103], v[24:27]
  s_add_u32 m0, s62, 106496
  ds_read_b64_tr_b16 a[42:43], v116 offset:6144
  v_mfma_f32_16x16x32_bf16 v[20:23], a[132:135], a[96:99], v[20:23]
  ds_read_b64_tr_b16 a[64:65], v116 offset:12288
  buffer_load_dwordx4 v120, s[28:31], s68 offen offset:0 sc1  lds
  v_mfma_f32_16x16x32_bf16 v[20:23], a[156:159], a[116:119], v[20:23]
  ds_read_b64_tr_b16 a[66:67], v116 offset:18432
  v_mfma_f32_16x16x32_bf16 v[16:19], a[156:159], a[112:115], v[16:19]
  ds_read_b128 a[4:7], v112 offset:0
  v_mfma_f32_16x16x32_bf16 v[16:19], a[132:135], a[92:95], v[16:19]
  ds_read_b128 a[24:27], v113 offset:0
  v_mfma_f32_16x16x32_bf16 v[96:99], a[136:139], a[88:91], v[96:99]
  ds_read_b128 a[8:11], v112 offset:2048
  buffer_load_dwordx4 v121, s[28:31], s68 offen offset:1024 sc1  lds
  v_mfma_f32_16x16x32_bf16 v[96:99], a[160:163], a[108:111], v[96:99]
  ds_read_b128 a[28:31], v113 offset:2048
  v_mfma_f32_16x16x32_bf16 v[32:35], a[160:163], a[112:115], v[32:35]
  ds_read_b128 a[12:15], v112 offset:4096
  v_mfma_f32_16x16x32_bf16 v[32:35], a[136:139], a[92:95], v[32:35]
  ds_read_b128 a[32:35], v113 offset:4096
  v_mfma_f32_16x16x32_bf16 v[36:39], a[136:139], a[96:99], v[36:39]
  ds_read_b128 a[16:19], v112 offset:6144
  buffer_load_dwordx4 v122, s[28:31], s68 offen offset:2048 sc1  lds
  v_mfma_f32_16x16x32_bf16 v[36:39], a[160:163], a[116:119], v[36:39]
  ds_read_b128 a[36:39], v113 offset:6144
  v_mfma_f32_16x16x32_bf16 v[40:43], a[160:163], a[120:123], v[40:43]
  ds_read_b64_tr_b16 a[44:45], v117 offset:0
  v_mfma_f32_16x16x32_bf16 v[40:43], a[136:139], a[100:103], v[40:43]
  ds_read_b64_tr_b16 a[46:47], v117 offset:6144
  v_mfma_f32_16x16x32_bf16 v[44:47], a[136:139], a[104:107], v[44:47]
  ds_read_b64_tr_b16 a[68:69], v117 offset:12288
  buffer_load_dwordx4 v123, s[28:31], s68 offen offset:3072 sc1  lds
  v_mfma_f32_16x16x32_bf16 v[44:47], a[160:163], a[124:127], v[44:47]
  ds_read_b64_tr_b16 a[70:71], v117 offset:18432
  v_mfma_f32_16x16x32_bf16 v[60:63], a[164:167], a[124:127], v[60:63]
  ds_read_b128 a[0:3], v114 offset:6144
  v_add_u32 v114, 6144, v114
  v_mfma_f32_16x16x32_bf16 v[60:63], a[140:143], a[104:107], v[60:63]
  s_add_u32 m0, s63, 49152
  ds_read_b128 a[20:23], v115 offset:6144
  v_add_u32 v115, 6144, v115
  v_mfma_f32_16x16x32_bf16 v[56:59], a[140:143], a[100:103], v[56:59]
  ds_read_b64_tr_b16 a[48:49], v116 offset:2048
  buffer_load_dwordx4 v124, s[8:11], s69 offen offset:0  lds
  v_mfma_f32_16x16x32_bf16 v[56:59], a[164:167], a[120:123], v[56:59]
  ds_read_b64_tr_b16 a[50:51], v116 offset:8192
  v_mfma_f32_16x16x32_bf16 v[52:55], a[164:167], a[116:119], v[52:55]
  s_add_u32 s44, s44, 1
  ds_read_b64_tr_b16 a[72:73], v116 offset:14336
  v_mfma_f32_16x16x32_bf16 v[52:55], a[140:143], a[96:99], v[52:55]
  s_and_b32 s44, s44, 15
  ds_read_b64_tr_b16 a[74:75], v116 offset:20480
  v_mfma_f32_16x16x32_bf16 v[48:51], a[140:143], a[92:95], v[48:51]
  s_add_u32 s66, s66, 1
  ds_read_b64_tr_b16 a[52:53], v117 offset:2048
  buffer_load_dwordx4 v125, s[8:11], s69 offen offset:1024  lds
  v_mfma_f32_16x16x32_bf16 v[48:51], a[164:167], a[112:115], v[48:51]
  s_mul_i32 s45, s44, s61
  ds_read_b64_tr_b16 a[54:55], v117 offset:8192
  v_mfma_f32_16x16x32_bf16 v[100:103], a[108:111], a[168:171], v[100:103]
  s_add_u32 s68, s45, s59
  ds_read_b64_tr_b16 a[76:77], v117 offset:14336
  v_mfma_f32_16x16x32_bf16 v[100:103], a[88:91], a[144:147], v[100:103]
  ds_read_b64_tr_b16 a[78:79], v117 offset:20480
  v_mfma_f32_16x16x32_bf16 v[64:67], a[92:95], a[144:147], v[64:67]
  ds_read_b64_tr_b16 a[56:57], v116 offset:4096
  buffer_load_dwordx4 v124, s[8:11], s69 offen offset:2048  lds
  v_mfma_f32_16x16x32_bf16 v[64:67], a[112:115], a[168:171], v[64:67]
  ds_read_b64_tr_b16 a[58:59], v116 offset:10240
  v_mfma_f32_16x16x32_bf16 v[68:71], a[116:119], a[168:171], v[68:71]
  ds_read_b64_tr_b16 a[80:81], v116 offset:16384
  v_mfma_f32_16x16x32_bf16 v[68:71], a[96:99], a[144:147], v[68:71]
  ds_read_b64_tr_b16 a[82:83], v116 offset:22528
  v_mfma_f32_16x16x32_bf16 v[72:75], a[100:103], a[144:147], v[72:75]
  ds_read_b64_tr_b16 a[60:61], v117 offset:4096
  buffer_load_dwordx4 v125, s[8:11], s69 offen offset:3072  lds
  v_mfma_f32_16x16x32_bf16 v[72:75], a[120:123], a[168:171], v[72:75]
  ds_read_b64_tr_b16 a[62:63], v117 offset:10240
  v_mfma_f32_16x16x32_bf16 v[76:79], a[124:127], a[168:171], v[76:79]
  ds_read_b64_tr_b16 a[84:85], v117 offset:16384
  v_mfma_f32_16x16x32_bf16 v[76:79], a[104:107], a[144:147], v[76:79]
  s_add_u32 m0, s63, 53248
  ds_read_b64_tr_b16 a[86:87], v117 offset:22528
  v_mfma_f32_16x16x32_bf16 v[92:95], a[104:107], a[148:151], v[92:95]
  buffer_load_dwordx4 v124, s[8:11], s70 offen offset:0  lds
  v_mfma_f32_16x16x32_bf16 v[92:95], a[124:127], a[172:175], v[92:95]
  v_mfma_f32_16x16x32_bf16 v[88:91], a[120:123], a[172:175], v[88:91]
  v_mfma_f32_16x16x32_bf16 v[88:91], a[100:103], a[148:151], v[88:91]
  v_mfma_f32_16x16x32_bf16 v[84:87], a[96:99], a[148:151], v[84:87]
  buffer_load_dwordx4 v125, s[8:11], s70 offen offset:1024  lds
  v_mfma_f32_16x16x32_bf16 v[84:87], a[116:119], a[172:175], v[84:87]
  v_mfma_f32_16x16x32_bf16 v[80:83], a[112:115], a[172:175], v[80:83]
  v_mfma_f32_16x16x32_bf16 v[80:83], a[92:95], a[148:151], v[80:83]
  s_cmp_eq_u32 s66, s88
  s_cbranch_scc0 Lside_skip5
  s_call_b64 s[78:79], Lside_sub
Lside_skip5:
  s_sub_u32 s56, s56, 1
  s_cmp_lg_u32 s56, 0
  s_cbranch_scc1 Lp1_loop
Lmk_Lp1_loop_tail:
  s_waitcnt lgkmcnt(15)
  v_mfma_f32_16x16x32_bf16 v[0:3], a[40:43], a[4:7], v[0:3]
  s_mul_i32 s45, s44, 393216
  v_and_b32 v240, 1, v253
  v_lshlrev_b32 v240, 7, v240
  v_mfma_f32_16x16x32_bf16 v[0:3], a[64:67], a[24:27], v[0:3]
  s_add_u32 s69, s45, s60
  v_mfma_f32_16x16x32_bf16 v[4:7], a[64:67], a[28:31], v[4:7]
  s_add_u32 s70, s69, 4096
  buffer_load_dword v127, v240, s[36:39], 0 offen sc1
  v_mfma_f32_16x16x32_bf16 v[4:7], a[40:43], a[8:11], v[4:7]
  s_lshl_b32 s43, s57, 2
  v_mfma_f32_16x16x32_bf16 v[8:11], a[40:43], a[12:15], v[8:11]
  s_add_u32 s74, s71, s43
  v_mfma_f32_16x16x32_bf16 v[8:11], a[64:67], a[32:35], v[8:11]
  s_add_u32 s45, s42, 27262976
  v_mfma_f32_16x16x32_bf16 v[12:15], a[64:67], a[36:39], v[12:15]
  s_lshl_b32 s44, s72, 11
  v_mfma_f32_16x16x32_bf16 v[12:15], a[40:43], a[16:19], v[12:15]
  s_add_u32 s77, s44, s45
  v_mfma_f32_16x16x32_bf16 v[28:31], a[44:47], a[16:19], v[28:31]
  s_lshl_b32 s44, s40, 1
  v_mfma_f32_16x16x32_bf16 v[28:31], a[68:71], a[36:39], v[28:31]
  s_add_u32 s44, s44, s71
  v_mfma_f32_16x16x32_bf16 v[24:27], a[68:71], a[32:35], v[24:27]
  s_waitcnt vmcnt(11) lgkmcnt(0)
  s_barrier
  ds_read_b64_tr_b16 a[128:129], v116 offset:24576
  v_mfma_f32_16x16x32_bf16 v[24:27], a[44:47], a[12:15], v[24:27]
  s_add_u32 m0, s62, 73728
  ds_read_b64_tr_b16 a[130:131], v116 offset:30720
  v_mfma_f32_16x16x32_bf16 v[20:23], a[44:47], a[8:11], v[20:23]
  s_lshl_b32 s44, s44, 11
  ds_read_b64_tr_b16 a[152:153], v116 offset:36864
  buffer_load_dwordx4 v120, s[28:31], s68 offen offset:0 sc1  lds
  v_mfma_f32_16x16x32_bf16 v[20:23], a[68:71], a[28:31], v[20:23]
  s_add_u32 s78, s44, s45
  ds_read_b64_tr_b16 a[154:155], v116 offset:43008
  v_mfma_f32_16x16x32_bf16 v[16:19], a[68:71], a[24:27], v[16:19]
  s_lshl_b32 s43, s51, 1
  ds_read_b128 a[92:95], v112 offset:16384
  v_mfma_f32_16x16x32_bf16 v[16:19], a[44:47], a[4:7], v[16:19]
  s_add_u32 s75, s43, s58
  ds_read_b128 a[112:115], v113 offset:16384
  v_mfma_f32_16x16x32_bf16 v[96:99], a[48:51], a[0:3], v[96:99]
  s_lshl_b32 s43, s75, 7
  ds_read_b128 a[96:99], v112 offset:18432
  buffer_load_dwordx4 v121, s[28:31], s68 offen offset:1024 sc1  lds
  v_mfma_f32_16x16x32_bf16 v[96:99], a[72:75], a[20:23], v[96:99]
  s_add_u32 s46, s43, 27983872
  ds_read_b128 a[116:119], v113 offset:18432
  v_mfma_f32_16x16x32_bf16 v[32:35], a[72:75], a[24:27], v[32:35]
  s_lshl_b32 s43, s57, 6
  ds_read_b128 a[100:103], v112 offset:20480
  v_mfma_f32_16x16x32_bf16 v[32:35], a[48:51], a[4:7], v[32:35]
  ds_read_b128 a[120:123], v113 offset:20480
  v_mfma_f32_16x16x32_bf16 v[36:39], a[48:51], a[8:11], v[36:39]
  ds_read_b128 a[104:107], v112 offset:22528
  buffer_load_dwordx4 v122, s[28:31], s68 offen offset:2048 sc1  lds
  v_mfma_f32_16x16x32_bf16 v[36:39], a[72:75], a[28:31], v[36:39]
  ds_read_b128 a[124:127], v113 offset:22528
  v_mfma_f32_16x16x32_bf16 v[40:43], a[72:75], a[32:35], v[40:43]
  ds_read_b64_tr_b16 a[132:133], v117 offset:24576
  v_mfma_f32_16x16x32_bf16 v[40:43], a[48:51], a[12:15], v[40:43]
  ds_read_b64_tr_b16 a[134:135], v117 offset:30720
  v_mfma_f32_16x16x32_bf16 v[44:47], a[48:51], a[16:19], v[44:47]
  ds_read_b64_tr_b16 a[156:157], v117 offset:36864
  buffer_load_dwordx4 v123, s[28:31], s68 offen offset:3072 sc1  lds
  v_mfma_f32_16x16x32_bf16 v[44:47], a[72:75], a[36:39], v[44:47]
  ds_read_b64_tr_b16 a[158:159], v117 offset:43008
  v_mfma_f32_16x16x32_bf16 v[60:63], a[76:79], a[36:39], v[60:63]
  ds_read_b128 a[88:91], v114 offset:1024
  v_mfma_f32_16x16x32_bf16 v[60:63], a[52:55], a[16:19], v[60:63]
  s_add_u32 m0, s63, 0
  ds_read_b128 a[108:111], v115 offset:1024
  v_mfma_f32_16x16x32_bf16 v[56:59], a[52:55], a[12:15], v[56:59]
  ds_read_b64_tr_b16 a[136:137], v116 offset:26624
  buffer_load_dwordx4 v124, s[8:11], s69 offen offset:0  lds
  v_mfma_f32_16x16x32_bf16 v[56:59], a[76:79], a[32:35], v[56:59]
  ds_read_b64_tr_b16 a[138:139], v116 offset:32768
  v_mfma_f32_16x16x32_bf16 v[52:55], a[76:79], a[28:31], v[52:55]
  ds_read_b64_tr_b16 a[160:161], v116 offset:38912
  v_lshlrev_b32 v105, 3, v253
  v_mfma_f32_16x16x32_bf16 v[52:55], a[52:55], a[8:11], v[52:55]
  ds_read_b64_tr_b16 a[162:163], v116 offset:45056
  v_lshlrev_b32 v104, 4, v253
  v_mfma_f32_16x16x32_bf16 v[48:51], a[52:55], a[4:7], v[48:51]
  ds_read_b64_tr_b16 a[140:141], v117 offset:26624
  buffer_load_dwordx4 v125, s[8:11], s69 offen offset:1024  lds
  v_mfma_f32_16x16x32_bf16 v[48:51], a[76:79], a[24:27], v[48:51]
  ds_read_b64_tr_b16 a[142:143], v117 offset:32768
  v_xor_b32 v126, s43, v104
  v_mfma_f32_16x16x32_bf16 v[100:103], a[20:23], a[80:83], v[100:103]
  ds_read_b64_tr_b16 a[164:165], v117 offset:38912
  v_add_u32 v126, s76, v126
  v_mfma_f32_16x16x32_bf16 v[100:103], a[0:3], a[56:59], v[100:103]
  ds_read_b64_tr_b16 a[166:167], v117 offset:45056
  v_bfe_u32 v106, v253, 3, 2
  v_mfma_f32_16x16x32_bf16 v[64:67], a[4:7], a[56:59], v[64:67]
  ds_read_b64_tr_b16 a[144:145], v116 offset:28672
  buffer_load_dwordx4 v124, s[8:11], s69 offen offset:2048  lds
  v_mfma_f32_16x16x32_bf16 v[64:67], a[24:27], a[80:83], v[64:67]
  ds_read_b64_tr_b16 a[146:147], v116 offset:34816
  v_lshrrev_b32 v107, 5, v253
  v_mfma_f32_16x16x32_bf16 v[68:71], a[28:31], a[80:83], v[68:71]
  ds_read_b64_tr_b16 a[168:169], v116 offset:40960
  v_mad_u32_u24 v106, v107, 3, v106
  v_mfma_f32_16x16x32_bf16 v[68:71], a[8:11], a[56:59], v[68:71]
  ds_read_b64_tr_b16 a[170:171], v116 offset:47104
  v_and_b32 v107, 7, v253
  v_mfma_f32_16x16x32_bf16 v[72:75], a[12:15], a[56:59], v[72:75]
  ds_read_b64_tr_b16 a[148:149], v117 offset:28672
  buffer_load_dwordx4 v125, s[8:11], s69 offen offset:3072  lds
  v_mfma_f32_16x16x32_bf16 v[72:75], a[32:35], a[80:83], v[72:75]
  ds_read_b64_tr_b16 a[150:151], v117 offset:34816
  v_lshlrev_b32 v107, 4, v107
  v_mfma_f32_16x16x32_bf16 v[76:79], a[36:39], a[80:83], v[76:79]
  ds_read_b64_tr_b16 a[172:173], v117 offset:40960
  v_lshl_add_u32 v106, v106, 12, v107
  v_mfma_f32_16x16x32_bf16 v[76:79], a[16:19], a[56:59], v[76:79]
  s_add_u32 m0, s63, 4096
  ds_read_b64_tr_b16 a[174:175], v117 offset:47104
  v_mfma_f32_16x16x32_bf16 v[92:95], a[16:19], a[60:63], v[92:95]
  buffer_load_dwordx4 v124, s[8:11], s70 offen offset:0  lds
  v_mfma_f32_16x16x32_bf16 v[92:95], a[36:39], a[84:87], v[92:95]
  v_mfma_f32_16x16x32_bf16 v[88:91], a[32:35], a[84:87], v[88:91]
  v_mfma_f32_16x16x32_bf16 v[88:91], a[12:15], a[60:63], v[88:91]
  s_waitcnt vmcnt(9)
  v_cmp_gt_u32 vcc, 128, v127
  s_cbranch_vccz Lcdn4
  s_mov_b32 s43, 0x40000
Lchk3:
  buffer_load_dword v127, v240, s[36:39], 0 offen sc1
  s_waitcnt vmcnt(0)
  v_cmp_gt_u32 vcc, 128, v127
  s_cbranch_vccz Lcdn4
  s_sub_u32 s43, s43, 1
  s_cmp_lg_u32 s43, 0
  s_cbranch_scc1 Lchk3
Lcdn4:
  v_mfma_f32_16x16x32_bf16 v[84:87], a[8:11], a[60:63], v[84:87]
  buffer_load_dwordx4 v125, s[8:11], s70 offen offset:1024  lds
  v_mfma_f32_16x16x32_bf16 v[84:87], a[28:31], a[84:87], v[84:87]
  v_mfma_f32_16x16x32_bf16 v[80:83], a[24:27], a[84:87], v[80:83]
  v_mfma_f32_16x16x32_bf16 v[80:83], a[4:7], a[60:63], v[80:83]
  s_waitcnt lgkmcnt(15)
  v_mfma_f32_16x16x32_bf16 v[0:3], a[128:131], a[92:95], v[0:3]
  s_cmp_lg_u32 s41, 0
  s_cbranch_scc1 Lp1_csl0
  buffer_load_dwordx4 v[200:203], v106, s[4:7], s46 offen sc1
  s_add_u32 s46, s46, 24576
  buffer_load_dwordx4 v[204:207], v106, s[4:7], s46 offen sc1
  s_add_u32 s46, s46, 24576
Lp1_csl0:
  v_mfma_f32_16x16x32_bf16 v[0:3], a[152:155], a[112:115], v[0:3]
  s_lshl_b32 s92, s53, 7
  s_lshl_b32 s93, s40, 14
  s_add_u32 s92, s92, s93
  v_mfma_f32_16x16x32_bf16 v[4:7], a[152:155], a[116:119], v[4:7]
  s_lshl_b32 s89, s40, 10
  v_add_u32 v186, s92, v252
  s_bfe_u32 s88, s2, 0x5
  v_mfma_f32_16x16x32_bf16 v[4:7], a[128:131], a[96:99], v[4:7]
  s_lshl_b32 s88, s88, 21
  buffer_load_dwordx2 v[128:129], v105, s[4:7], s78 offen offset:0 sc1
  v_mfma_f32_16x16x32_bf16 v[8:11], a[128:131], a[100:103], v[8:11]
  v_mfma_f32_16x16x32_bf16 v[8:11], a[152:155], a[120:123], v[8:11]
  v_mfma_f32_16x16x32_bf16 v[12:15], a[152:155], a[124:127], v[12:15]
  s_cmp_lg_u32 s41, 0
  s_cbranch_scc1 Lp1_csl1
  buffer_load_dwordx4 v[208:211], v106, s[4:7], s46 offen sc1
  s_add_u32 s46, s46, 24576
  buffer_load_dwordx4 v[212:215], v106, s[4:7], s46 offen sc1
  s_add_u32 s46, s46, 24576
Lp1_csl1:
  v_mfma_f32_16x16x32_bf16 v[12:15], a[128:131], a[104:107], v[12:15]
  buffer_load_dwordx2 v[130:131], v105, s[4:7], s78 offen offset:512 sc1
  v_mfma_f32_16x16x32_bf16 v[28:31], a[132:135], a[104:107], v[28:31]
  v_mfma_f32_16x16x32_bf16 v[28:31], a[156:159], a[124:127], v[28:31]
  v_mfma_f32_16x16x32_bf16 v[24:27], a[156:159], a[120:123], v[24:27]
  s_waitcnt lgkmcnt(0)
  s_barrier
  ds_read_b64_tr_b16 a[40:41], v118 offset:0
  v_mfma_f32_16x16x32_bf16 v[24:27], a[132:135], a[100:103], v[24:27]
  ds_read_b64_tr_b16 a[42:43], v118 offset:6144
  buffer_load_dwordx2 v[132:133], v105, s[4:7], s78 offen offset:1024 sc1
  v_mfma_f32_16x16x32_bf16 v[20:23], a[132:135], a[96:99], v[20:23]
  s_cmp_lg_u32 s41, 0
  s_cbranch_scc1 Lp1_csl2
  buffer_load_dwordx4 v[216:219], v106, s[4:7], s46 offen sc1
  s_add_u32 s46, s46, 24576
  buffer_load_dwordx4 v[220:223], v106, s[4:7], s46 offen sc1
  s_add_u32 s46, s46, 24576
Lp1_csl2:
  ds_read_b64_tr_b16 a[64:65], v118 offset:12288
  v_mfma_f32_16x16x32_bf16 v[20:23], a[156:159], a[116:119], v[20:23]
  ds_read_b64_tr_b16 a[66:67], v118 offset:18432
  v_mfma_f32_16x16x32_bf16 v[16:19], a[156:159], a[112:115], v[16:19]
  ds_read_b128 a[4:7], v112 offset:32768
  v_mfma_f32_16x16x32_bf16 v[16:19], a[132:135], a[92:95], v[16:19]
  ds_read_b128 a[24:27], v113 offset:32768
  buffer_load_dwordx2 v[134:135], v105, s[4:7], s78 offen offset:1536 sc1
  v_mfma_f32_16x16x32_bf16 v[96:99], a[136:139], a[88:91], v[96:99]
  ds_read_b128 a[8:11], v112 offset:34816
  v_mfma_f32_16x16x32_bf16 v[96:99], a[160:163], a[108:111], v[96:99]
  ds_read_b128 a[28:31], v113 offset:34816
  v_mfma_f32_16x16x32_bf16 v[32:35], a[160:163], a[112:115], v[32:35]
  s_cmp_lg_u32 s41, 0
  s_cbranch_scc1 Lp1_csl3
  buffer_load_dwordx4 v[224:227], v106, s[4:7], s46 offen sc1
  s_add_u32 s46, s46, 24576
  buffer_load_dwordx4 v[228:231], v106, s[4:7], s46 offen sc1
  s_add_u32 s46, s46, 24576
Lp1_csl3:
  ds_read_b128 a[12:15], v112 offset:36864
  v_mfma_f32_16x16x32_bf16 v[32:35], a[136:139], a[92:95], v[32:35]
  ds_read_b128 a[32:35], v113 offset:36864
  buffer_load_dwordx2 v[136:137], v105, s[4:7], s78 offen offset:2048 sc1
  v_mfma_f32_16x16x32_bf16 v[36:39], a[136:139], a[96:99], v[36:39]
  ds_read_b128 a[16:19], v112 offset:38912
  v_mfma_f32_16x16x32_bf16 v[36:39], a[160:163], a[116:119], v[36:39]
  ds_read_b128 a[36:39], v113 offset:38912
  v_mfma_f32_16x16x32_bf16 v[40:43], a[160:163], a[120:123], v[40:43]
  ds_read_b64_tr_b16 a[44:45], v119 offset:0
  v_mfma_f32_16x16x32_bf16 v[40:43], a[136:139], a[100:103], v[40:43]
  ds_read_b64_tr_b16 a[46:47], v119 offset:6144
  buffer_load_dwordx2 v[138:139], v105, s[4:7], s78 offen offset:2560 sc1
  v_mfma_f32_16x16x32_bf16 v[44:47], a[136:139], a[104:107], v[44:47]
  ds_read_b64_tr_b16 a[68:69], v119 offset:12288
  v_lshrrev_b32 v240, 4, v253
  v_mfma_f32_16x16x32_bf16 v[44:47], a[160:163], a[124:127], v[44:47]
  ds_read_b64_tr_b16 a[70:71], v119 offset:18432
  v_lshlrev_b32 v124, 4, v240
  v_mfma_f32_16x16x32_bf16 v[60:63], a[164:167], a[124:127], v[60:63]
  ds_read_b128 a[0:3], v114 offset:2048
  v_and_b32 v125, 15, v253
  v_mfma_f32_16x16x32_bf16 v[60:63], a[140:143], a[104:107], v[60:63]
  ds_read_b128 a[20:23], v115 offset:2048
  buffer_load_dwordx2 v[140:141], v105, s[4:7], s78 offen offset:3072 sc1
  v_mfma_f32_16x16x32_bf16 v[56:59], a[140:143], a[100:103], v[56:59]
  ds_read_b64_tr_b16 a[48:49], v118 offset:2048
  v_lshlrev_b32 v125, 2, v125
  v_mfma_f32_16x16x32_bf16 v[56:59], a[164:167], a[120:123], v[56:59]
  s_lshl_b32 s43, s57, 9
  ds_read_b64_tr_b16 a[50:51], v118 offset:8192
  v_add_u32 v164, 155648, v124
  v_mfma_f32_16x16x32_bf16 v[52:55], a[164:167], a[116:119], v[52:55]
  ds_read_b64_tr_b16 a[72:73], v118 offset:14336
  v_add_u32 v166, 155648, v125
  v_mfma_f32_16x16x32_bf16 v[52:55], a[140:143], a[96:99], v[52:55]
  ds_read_b64_tr_b16 a[74:75], v118 offset:20480
  buffer_load_dwordx2 v[142:143], v105, s[4:7], s78 offen offset:3584 sc1
  v_mfma_f32_16x16x32_bf16 v[48:51], a[140:143], a[92:95], v[48:51]
  ds_read_b64_tr_b16 a[52:53], v119 offset:2048
  v_add_u32 v165, s43, v164
  v_mfma_f32_16x16x32_bf16 v[48:51], a[164:167], a[112:115], v[48:51]
  ds_read_b64_tr_b16 a[54:55], v119 offset:8192
  v_add_u32 v167, s43, v166
  v_mfma_f32_16x16x32_bf16 v[100:103], a[108:111], a[168:171], v[100:103]
  s_lshl_b32 s43, s40, 1
  ds_read_b64_tr_b16 a[76:77], v119 offset:14336
  v_mfma_f32_16x16x32_bf16 v[100:103], a[88:91], a[144:147], v[100:103]
  s_add_u32 s43, s43, 1
  ds_read_b64_tr_b16 a[78:79], v119 offset:20480
  buffer_load_dwordx2 v[144:145], v105, s[4:7], s77 offen offset:0 sc1
  v_mfma_f32_16x16x32_bf16 v[64:67], a[92:95], a[144:147], v[64:67]
  ds_read_b64_tr_b16 a[56:57], v118 offset:4096
  v_add_u32 v241, s43, v240
  v_mfma_f32_16x16x32_bf16 v[64:67], a[112:115], a[168:171], v[64:67]
  ds_read_b64_tr_b16 a[58:59], v118 offset:10240
  v_cmp_gt_u32 vcc, 2, v240
  v_mfma_f32_16x16x32_bf16 v[68:71], a[116:119], a[168:171], v[68:71]
  ds_read_b64_tr_b16 a[80:81], v118 offset:16384
  v_and_b32 v240, 1, v240
  v_mfma_f32_16x16x32_bf16 v[68:71], a[96:99], a[144:147], v[68:71]
  ds_read_b64_tr_b16 a[82:83], v118 offset:22528
  buffer_load_dwordx2 v[146:147], v105, s[4:7], s77 offen offset:512 sc1
  v_mfma_f32_16x16x32_bf16 v[72:75], a[100:103], a[144:147], v[72:75]
  ds_read_b64_tr_b16 a[60:61], v119 offset:4096
  v_mul_u32_u24 v240, 9, v240
  v_mfma_f32_16x16x32_bf16 v[72:75], a[120:123], a[168:171], v[72:75]
  ds_read_b64_tr_b16 a[62:63], v119 offset:10240
  v_cndmask_b32 v240, v240, v241, vcc
  v_mfma_f32_16x16x32_bf16 v[76:79], a[124:127], a[168:171], v[76:79]
  ds_read_b64_tr_b16 a[84:85], v119 offset:16384
  v_lshl_add_u32 v106, v240, 7, v166
  v_mfma_f32_16x16x32_bf16 v[76:79], a[104:107], a[144:147], v[76:79]
  ds_read_b64_tr_b16 a[86:87], v119 offset:22528
  buffer_load_dwordx2 v[148:149], v105, s[4:7], s77 offen offset:1024 sc1
  v_mfma_f32_16x16x32_bf16 v[92:95], a[104:107], a[148:151], v[92:95]
  v_add_u32 v124, s76, v124
  v_add_u32 v125, s76, v125
  v_mfma_f32_16x16x32_bf16 v[92:95], a[124:127], a[172:175], v[92:95]
  v_add_u32 v107, 149504, v104
  v_mfma_f32_16x16x32_bf16 v[88:91], a[120:123], a[172:175], v[88:91]
  v_mfma_f32_16x16x32_bf16 v[88:91], a[100:103], a[148:151], v[88:91]
  buffer_load_dwordx2 v[150:151], v105, s[4:7], s77 offen offset:1536 sc1
  v_mfma_f32_16x16x32_bf16 v[84:87], a[96:99], a[148:151], v[84:87]
  v_mfma_f32_16x16x32_bf16 v[84:87], a[116:119], a[172:175], v[84:87]
  v_mfma_f32_16x16x32_bf16 v[80:83], a[112:115], a[172:175], v[80:83]
  v_mfma_f32_16x16x32_bf16 v[80:83], a[92:95], a[148:151], v[80:83]
  s_waitcnt lgkmcnt(15)
  v_mfma_f32_16x16x32_bf16 v[0:3], a[40:43], a[4:7], v[0:3]
  s_lshl_b32 s44, s2, 2
  s_add_u32 s44, s44, s40
  s_lshl_b32 s44, s44, 12
  v_mfma_f32_16x16x32_bf16 v[0:3], a[64:67], a[24:27], v[0:3]
  s_add_u32 s44, s44, s42
  v_mfma_f32_16x16x32_bf16 v[4:7], a[64:67], a[28:31], v[4:7]
  s_add_u32 s44, s44, 28311552
  v_mov_b32 v246, -1
  v_mov_b32 v247, -1
  v_mfma_f32_16x16x32_bf16 v[4:7], a[40:43], a[8:11], v[4:7]
  v_mov_b32 v248, -1
  v_mov_b32 v249, -1
  v_mfma_f32_16x16x32_bf16 v[8:11], a[40:43], a[12:15], v[8:11]
  v_mfma_f32_16x16x32_bf16 v[8:11], a[64:67], a[32:35], v[8:11]
  v_mfma_f32_16x16x32_bf16 v[12:15], a[64:67], a[36:39], v[12:15]
  s_waitcnt vmcnt(8)
  v_add_u32 v198, 1024, v125
  v_add_f32 v128, v128, v130
  v_mfma_f32_16x16x32_bf16 v[12:15], a[40:43], a[16:19], v[12:15]
  v_add_f32 v129, v129, v131
  v_add_f32 v132, v132, v134
  v_mfma_f32_16x16x32_bf16 v[28:31], a[44:47], a[16:19], v[28:31]
  buffer_store_dwordx4 v[246:249], v104, s[4:7], s44 offen offset:0 sc1
  v_add_f32 v133, v133, v135
  v_mfma_f32_16x16x32_bf16 v[28:31], a[68:71], a[36:39], v[28:31]
  v_add_f32 v128, v128, v132
  v_add_f32 v129, v129, v133
  v_mfma_f32_16x16x32_bf16 v[24:27], a[68:71], a[32:35], v[24:27]
  s_waitcnt lgkmcnt(0)
  s_barrier
  ds_read_b64_tr_b16 a[128:129], v116 offset:0
  s_waitcnt vmcnt(5)
  s_cmp_lg_u32 s41, 0
  s_cbranch_scc1 Lp1_css
  v_pk_add_f32 v[200:201], v[200:201], v[216:217]
  v_pk_add_f32 v[202:203], v[202:203], v[218:219]
  v_pk_add_f32 v[204:205], v[204:205], v[220:221]
  v_pk_add_f32 v[206:207], v[206:207], v[222:223]
  v_pk_add_f32 v[208:209], v[208:209], v[224:225]
  v_pk_add_f32 v[210:211], v[210:211], v[226:227]
  v_pk_add_f32 v[212:213], v[212:213], v[228:229]
  v_pk_add_f32 v[214:215], v[214:215], v[230:231]
  v_pk_add_f32 v[200:201], v[200:201], v[208:209]
  v_pk_add_f32 v[202:203], v[202:203], v[210:211]
  v_pk_add_f32 v[204:205], v[204:205], v[212:213]
  v_pk_add_f32 v[206:207], v[206:207], v[214:215]
  v_pk_add_f32 v[200:201], v[200:201], v[204:205]
  v_pk_add_f32 v[202:203], v[202:203], v[206:207]
  v_mov_b32 v204, v200
  v_mov_b32 v205, v201
  v_mov_b32 v206, v202
  v_mov_b32 v207, v203
  v_permlane32_swap_b32 v200, v204
  v_permlane32_swap_b32 v201, v205
  v_permlane32_swap_b32 v202, v206
  v_permlane32_swap_b32 v203, v207
  v_add_f32 v200, v200, v204
  v_add_f32 v201, v201, v205
  v_add_f32 v202, v202, v206
  v_add_f32 v203, v203, v207
  ds_write_b128 v126, v[200:203] offset:1024
Lp1_css:
  v_mfma_f32_16x16x32_bf16 v[24:27], a[44:47], a[12:15], v[24:27]
  ds_read_b64_tr_b16 a[130:131], v116 offset:6144
  ds_read_b128 v[168:171], v124 offset:1024
  v_mfma_f32_16x16x32_bf16 v[20:23], a[44:47], a[8:11], v[20:23]
  ds_read_b64_tr_b16 a[152:153], v116 offset:12288
  buffer_store_dwordx4 v[246:249], v104, s[4:7], s44 offen offset:1024 sc1
  v_mfma_f32_16x16x32_bf16 v[20:23], a[68:71], a[28:31], v[20:23]
  ds_read_b64_tr_b16 a[154:155], v116 offset:18432
  ds_read_b128 v[172:175], v124 offset:1088
  v_mfma_f32_16x16x32_bf16 v[16:19], a[68:71], a[24:27], v[16:19]
  ds_read_b128 a[92:95], v112 offset:0
  ds_read_b128 v[176:179], v124 offset:1152
  v_mfma_f32_16x16x32_bf16 v[16:19], a[44:47], a[4:7], v[16:19]
  ds_read_b128 a[112:115], v113 offset:0
  ds_read_b128 v[180:183], v124 offset:1216
  v_mfma_f32_16x16x32_bf16 v[96:99], a[48:51], a[0:3], v[96:99]
  ds_read_b128 a[96:99], v112 offset:2048
  buffer_store_dwordx4 v[246:249], v104, s[4:7], s44 offen offset:2048 sc1
  v_mfma_f32_16x16x32_bf16 v[96:99], a[72:75], a[20:23], v[96:99]
  ds_read_b128 a[116:119], v113 offset:2048
  ds_read2_b32 v[184:185], v198 offset0:64 offset1:80
  v_mfma_f32_16x16x32_bf16 v[32:35], a[72:75], a[24:27], v[32:35]
  s_xor_b32 s47, s40, 2
  ds_read_b128 a[100:103], v112 offset:4096
  s_mul_i32 s47, s47, 6144
  v_mfma_f32_16x16x32_bf16 v[32:35], a[48:51], a[4:7], v[32:35]
  s_add_u32 s47, s47, 139264
  ds_read_b128 a[120:123], v113 offset:4096
  s_add_u32 s49, s47, 3072
  v_mfma_f32_16x16x32_bf16 v[36:39], a[48:51], a[8:11], v[36:39]
  s_add_u32 s79, s47, 2048
  ds_read_b128 a[104:107], v112 offset:6144
  buffer_store_dwordx4 v[246:249], v104, s[4:7], s44 offen offset:3072 sc1
  v_mfma_f32_16x16x32_bf16 v[36:39], a[72:75], a[28:31], v[36:39]
  s_cmp_eq_u32 s57, 0
  s_cselect_b32 s49, s76, s49
  s_cselect_b32 s79, s47, s79
  ds_read_b128 a[124:127], v113 offset:6144
  v_add_u32 v198, s49, v105
  v_mfma_f32_16x16x32_bf16 v[40:43], a[72:75], a[32:35], v[40:43]
  ds_read_b64_tr_b16 a[132:133], v117 offset:0
  v_add_u32 v199, s79, v105
  v_mfma_f32_16x16x32_bf16 v[40:43], a[48:51], a[12:15], v[40:43]
  s_add_u32 m0, s62, 90112
  ds_read_b64_tr_b16 a[134:135], v117 offset:6144
  v_add_u32 v105, s76, v105
  v_mfma_f32_16x16x32_bf16 v[44:47], a[48:51], a[16:19], v[44:47]
  ds_read_b64_tr_b16 a[156:157], v117 offset:12288
  buffer_load_dwordx4 v120, s[28:31], s64 offen offset:0 sc1 lds
  v_mfma_f32_16x16x32_bf16 v[44:47], a[72:75], a[36:39], v[44:47]
  ds_read_b64_tr_b16 a[158:159], v117 offset:18432
  v_add_f32 v136, v136, v138
  v_mfma_f32_16x16x32_bf16 v[60:63], a[76:79], a[36:39], v[60:63]
  ds_read_b128 a[88:91], v114 offset:3072
  v_add_f32 v137, v137, v139
  v_mfma_f32_16x16x32_bf16 v[60:63], a[52:55], a[16:19], v[60:63]
  ds_read_b128 a[108:111], v115 offset:3072
  v_add_f32 v140, v140, v142
  v_mfma_f32_16x16x32_bf16 v[56:59], a[52:55], a[12:15], v[56:59]
  ds_read_b64_tr_b16 a[136:137], v116 offset:2048
  v_add_f32 v141, v141, v143
  v_mfma_f32_16x16x32_bf16 v[56:59], a[76:79], a[32:35], v[56:59]
  ds_read_b64_tr_b16 a[138:139], v116 offset:8192
  v_add_f32 v136, v136, v140
  v_mfma_f32_16x16x32_bf16 v[52:55], a[76:79], a[28:31], v[52:55]
  ds_read_b64_tr_b16 a[160:161], v116 offset:14336
  v_add_f32 v137, v137, v141
  v_mfma_f32_16x16x32_bf16 v[52:55], a[52:55], a[8:11], v[52:55]
  s_waitcnt vmcnt(5)
  ds_read_b64_tr_b16 a[162:163], v116 offset:20480
  v_add_f32 v144, v144, v146
  v_mfma_f32_16x16x32_bf16 v[48:51], a[52:55], a[4:7], v[48:51]
  ds_read_b64_tr_b16 a[140:141], v117 offset:2048
  buffer_load_dwordx4 v121, s[28:31], s64 offen offset:1024 sc1 lds
  v_mfma_f32_16x16x32_bf16 v[48:51], a[76:79], a[24:27], v[48:51]
  ds_read_b64_tr_b16 a[142:143], v117 offset:8192
  v_add_f32 v145, v145, v147
  v_mfma_f32_16x16x32_bf16 v[100:103], a[20:23], a[80:83], v[100:103]
  ds_read_b64_tr_b16 a[164:165], v117 offset:14336
  v_add_f32 v148, v148, v150
  v_mfma_f32_16x16x32_bf16 v[100:103], a[0:3], a[56:59], v[100:103]
  ds_read_b64_tr_b16 a[166:167], v117 offset:20480
  v_add_f32 v149, v149, v151
  v_mfma_f32_16x16x32_bf16 v[64:67], a[4:7], a[56:59], v[64:67]
  ds_read_b64_tr_b16 a[144:145], v116 offset:4096
  v_add_f32 v144, v144, v148
  v_mfma_f32_16x16x32_bf16 v[64:67], a[24:27], a[80:83], v[64:67]
  ds_read_b64_tr_b16 a[146:147], v116 offset:10240
  v_add_f32 v145, v145, v149
  v_mfma_f32_16x16x32_bf16 v[68:71], a[28:31], a[80:83], v[68:71]
  s_mov_b32 s48, 0x3a800000
  ds_read_b64_tr_b16 a[168:169], v116 offset:16384
  v_mov_b32 v240, 0x3727c5ac
  v_mfma_f32_16x16x32_bf16 v[68:71], a[8:11], a[56:59], v[68:71]
  ds_read_b64_tr_b16 a[170:171], v116 offset:22528
  v_permlane32_swap_b32 v136, v130
  v_mfma_f32_16x16x32_bf16 v[72:75], a[12:15], a[56:59], v[72:75]
  ds_read_b64_tr_b16 a[148:149], v117 offset:4096
  buffer_load_dwordx4 v122, s[28:31], s64 offen offset:2048 sc1 lds
  v_mfma_f32_16x16x32_bf16 v[72:75], a[32:35], a[80:83], v[72:75]
  ds_read_b64_tr_b16 a[150:151], v117 offset:10240
  v_permlane32_swap_b32 v137, v131
  v_mfma_f32_16x16x32_bf16 v[76:79], a[36:39], a[80:83], v[76:79]
  ds_read_b64_tr_b16 a[172:173], v117 offset:16384
  v_permlane32_swap_b32 v128, v144
  v_mfma_f32_16x16x32_bf16 v[76:79], a[16:19], a[56:59], v[76:79]
  ds_read_b64_tr_b16 a[174:175], v117 offset:22528
  v_permlane32_swap_b32 v129, v145
  v_mfma_f32_16x16x32_bf16 v[92:95], a[16:19], a[60:63], v[92:95]
  v_add_f32 v136, v136, v130
  v_add_f32 v128, v128, v144
  v_mfma_f32_16x16x32_bf16 v[92:95], a[36:39], a[84:87], v[92:95]
  v_add_f32 v137, v137, v131
  v_add_f32 v129, v129, v145
  v_mfma_f32_16x16x32_bf16 v[88:91], a[32:35], a[84:87], v[88:91]
  v_permlane16_swap_b32 v128, v136
  v_mfma_f32_16x16x32_bf16 v[88:91], a[12:15], a[60:63], v[88:91]
  s_nop 0
  v_permlane16_swap_b32 v129, v137
  v_add_f32 v128, v128, v136
  v_mfma_f32_16x16x32_bf16 v[84:87], a[8:11], a[60:63], v[84:87]
  buffer_load_dwordx4 v123, s[28:31], s64 offen offset:3072 sc1 lds
  v_add_f32 v129, v129, v137
  v_mfma_f32_16x16x32_bf16 v[84:87], a[28:31], a[84:87], v[84:87]
  v_mul_f32 v128, 0xba800000, v128
  v_fma_f32 v129, v129, s48, v240
  v_mfma_f32_16x16x32_bf16 v[80:83], a[24:27], a[84:87], v[80:83]
  v_fma_f32 v129, -v128, v128, v129
  v_max_f32 v129, v129, v240
  v_mfma_f32_16x16x32_bf16 v[80:83], a[4:7], a[60:63], v[80:83]
  v_rsq_f32 v129, v129
  s_nop 0
  s_waitcnt lgkmcnt(15)
  v_mfma_f32_16x16x32_bf16 v[0:3], a[128:131], a[92:95], v[0:3]
  ds_write2_b32 v106, v128, v129 offset0:0 offset1:16
  v_mfma_f32_16x16x32_bf16 v[0:3], a[152:155], a[112:115], v[0:3]
  s_add_u32 m0, s89, 40960
  v_mfma_f32_16x16x32_bf16 v[4:7], a[152:155], a[116:119], v[4:7]
  s_xor_b32 s92, s88, 655360
  v_mfma_f32_16x16x32_bf16 v[4:7], a[128:131], a[96:99], v[4:7]
  buffer_load_dwordx4 v186, s[12:15], s92 offen lds
  v_mfma_f32_16x16x32_bf16 v[8:11], a[128:131], a[100:103], v[8:11]
  v_mfma_f32_16x16x32_bf16 v[8:11], a[152:155], a[120:123], v[8:11]
  v_mfma_f32_16x16x32_bf16 v[12:15], a[152:155], a[124:127], v[12:15]
  v_mfma_f32_16x16x32_bf16 v[12:15], a[128:131], a[104:107], v[12:15]
  s_add_u32 m0, s89, 45056
  v_mfma_f32_16x16x32_bf16 v[28:31], a[132:135], a[104:107], v[28:31]
  s_xor_b32 s92, s88, 720896
  v_mfma_f32_16x16x32_bf16 v[28:31], a[156:159], a[124:127], v[28:31]
  buffer_load_dwordx4 v186, s[12:15], s92 offen lds
  v_mfma_f32_16x16x32_bf16 v[24:27], a[156:159], a[120:123], v[24:27]
  s_waitcnt lgkmcnt(0)
  s_barrier
  ds_read2_b32 v[190:191], v167 offset0:32 offset1:48
  ds_read2_b32 v[192:193], v167 offset0:64 offset1:80
  v_mfma_f32_16x16x32_bf16 v[24:27], a[132:135], a[100:103], v[24:27]
  ds_read2_b32 v[194:195], v167 offset0:96 offset1:112
  ds_read2_b32 v[196:197], v167 offset0:128 offset1:144
  v_mfma_f32_16x16x32_bf16 v[20:23], a[132:135], a[96:99], v[20:23]
  ds_read2_b32 v[188:189], v166 offset0:0 offset1:16
  ds_read_b128 v[128:131], v107
  v_mfma_f32_16x16x32_bf16 v[20:23], a[156:159], a[116:119], v[20:23]
  s_add_u32 m0, s89, 49152
  ds_read_b128 v[132:135], v107 offset:1024
  ds_read_b128 v[200:203], v164 offset:0
  v_mfma_f32_16x16x32_bf16 v[16:19], a[156:159], a[112:115], v[16:19]
  s_xor_b32 s92, s88, 786432
  ds_read_b128 v[220:223], v164 offset:64
  ds_read_b128 v[216:219], v165 offset:512
  v_mfma_f32_16x16x32_bf16 v[16:19], a[132:135], a[92:95], v[16:19]
  buffer_load_dwordx4 v186, s[12:15], s92 offen lds
  ds_read_b128 v[236:239], v165 offset:576
  v_mfma_f32_16x16x32_bf16 v[96:99], a[136:139], a[88:91], v[96:99]
  ds_read_b128 v[204:207], v165 offset:128
  ds_read_b128 v[224:227], v165 offset:192
  v_mfma_f32_16x16x32_bf16 v[96:99], a[160:163], a[108:111], v[96:99]
  ds_read_b128 v[208:211], v165 offset:256
  ds_read_b128 v[228:231], v165 offset:320
  v_mfma_f32_16x16x32_bf16 v[32:35], a[160:163], a[112:115], v[32:35]
  ds_read_b128 v[212:215], v165 offset:384
  ds_read_b128 v[232:235], v165 offset:448
  v_mfma_f32_16x16x32_bf16 v[32:35], a[136:139], a[92:95], v[32:35]
  s_add_u32 m0, s89, 53248
  s_and_b32 s43, s50, 7
  s_or_b32 s43, s43, s57
  v_mfma_f32_16x16x32_bf16 v[36:39], a[136:139], a[96:99], v[36:39]
  s_cselect_b64 s[46:47], -1, 0
  s_xor_b32 s92, s88, 851968
  v_mov_b32 v245, 0xf149f2ca
  v_mfma_f32_16x16x32_bf16 v[36:39], a[160:163], a[116:119], v[36:39]
  s_waitcnt lgkmcnt(10)
  buffer_load_dwordx4 v186, s[12:15], s92 offen lds
  v_fmac_f32 v12, v168, v196
  v_mfma_f32_16x16x32_bf16 v[40:43], a[160:163], a[120:123], v[40:43]
  v_fmac_f32 v13, v169, v196
  v_fmac_f32 v14, v170, v196
  v_mfma_f32_16x16x32_bf16 v[40:43], a[136:139], a[100:103], v[40:43]
  v_fmac_f32 v15, v171, v196
  v_fmac_f32 v28, v172, v196
  v_mfma_f32_16x16x32_bf16 v[44:47], a[136:139], a[104:107], v[44:47]
  v_fmac_f32 v29, v173, v196
  v_fmac_f32 v30, v174, v196
  v_mfma_f32_16x16x32_bf16 v[44:47], a[160:163], a[124:127], v[44:47]
  s_add_u32 m0, s89, 57344
  v_fmac_f32 v31, v175, v196
  v_cvt_pk_bf16_f32 v12, v12, v13
  v_mfma_f32_16x16x32_bf16 v[60:63], a[164:167], a[124:127], v[60:63]
  s_xor_b32 s92, s88, 917504
  v_cvt_pk_bf16_f32 v13, v14, v15
  v_cvt_pk_bf16_f32 v14, v28, v29
  v_mfma_f32_16x16x32_bf16 v[60:63], a[140:143], a[104:107], v[60:63]
  buffer_load_dwordx4 v186, s[12:15], s92 offen lds
  v_cvt_pk_bf16_f32 v15, v30, v31
  v_mfma_f32_16x16x32_bf16 v[56:59], a[140:143], a[100:103], v[56:59]
  v_fmac_f32 v8, v168, v194
  v_fmac_f32 v9, v169, v194
  v_mfma_f32_16x16x32_bf16 v[56:59], a[164:167], a[120:123], v[56:59]
  v_fmac_f32 v10, v170, v194
  v_fmac_f32 v11, v171, v194
  v_mfma_f32_16x16x32_bf16 v[52:55], a[164:167], a[116:119], v[52:55]
  v_fmac_f32 v24, v172, v194
  v_fmac_f32 v25, v173, v194
  v_mfma_f32_16x16x32_bf16 v[52:55], a[140:143], a[96:99], v[52:55]
  s_add_u32 m0, s89, 61440
  v_fmac_f32 v26, v174, v194
  v_fmac_f32 v27, v175, v194
  v_mfma_f32_16x16x32_bf16 v[48:51], a[140:143], a[92:95], v[48:51]
  s_xor_b32 s92, s88, 983040
  v_cvt_pk_bf16_f32 v8, v8, v9
  v_cvt_pk_bf16_f32 v9, v10, v11
  v_mfma_f32_16x16x32_bf16 v[48:51], a[164:167], a[112:115], v[48:51]
  buffer_load_dwordx4 v186, s[12:15], s92 offen lds
  v_cvt_pk_bf16_f32 v10, v24, v25
  v_mfma_f32_16x16x32_bf16 v[100:103], a[108:111], a[168:171], v[100:103]
  v_cvt_pk_bf16_f32 v11, v26, v27
  v_fmac_f32 v4, v168, v192
  v_mfma_f32_16x16x32_bf16 v[100:103], a[88:91], a[144:147], v[100:103]
  v_fmac_f32 v5, v169, v192
  v_fmac_f32 v6, v170, v192
  v_mfma_f32_16x16x32_bf16 v[64:67], a[92:95], a[144:147], v[64:67]
  v_fmac_f32 v7, v171, v192
  v_fmac_f32 v20, v172, v192
  v_mfma_f32_16x16x32_bf16 v[64:67], a[112:115], a[168:171], v[64:67]
  s_add_u32 m0, s89, 65536
  v_fmac_f32 v21, v173, v192
  v_fmac_f32 v22, v174, v192
  v_mfma_f32_16x16x32_bf16 v[68:71], a[116:119], a[168:171], v[68:71]
  s_xor_b32 s92, s88, 1048576
  v_fmac_f32 v23, v175, v192
  v_cvt_pk_bf16_f32 v4, v4, v5
  v_mfma_f32_16x16x32_bf16 v[68:71], a[96:99], a[144:147], v[68:71]
  buffer_load_dwordx4 v186, s[12:15], s92 offen lds
  v_cvt_pk_bf16_f32 v5, v6, v7
  v_mfma_f32_16x16x32_bf16 v[72:75], a[100:103], a[144:147], v[72:75]
  v_cvt_pk_bf16_f32 v6, v20, v21
  v_cvt_pk_bf16_f32 v7, v22, v23
  v_mfma_f32_16x16x32_bf16 v[72:75], a[120:123], a[168:171], v[72:75]
  v_fmac_f32 v0, v168, v190
  v_fmac_f32 v1, v169, v190
  v_mfma_f32_16x16x32_bf16 v[76:79], a[124:127], a[168:171], v[76:79]
  v_fmac_f32 v2, v170, v190
  v_fmac_f32 v3, v171, v190
  v_mfma_f32_16x16x32_bf16 v[76:79], a[104:107], a[144:147], v[76:79]
  s_add_u32 m0, s89, 69632
  v_fmac_f32 v16, v172, v190
  v_fmac_f32 v17, v173, v190
  v_mfma_f32_16x16x32_bf16 v[92:95], a[104:107], a[148:151], v[92:95]
  s_xor_b32 s92, s88, 1114112
  v_fmac_f32 v18, v174, v190
  v_fmac_f32 v19, v175, v190
  v_mfma_f32_16x16x32_bf16 v[92:95], a[124:127], a[172:175], v[92:95]
  buffer_load_dwordx4 v186, s[12:15], s92 offen lds
  v_cvt_pk_bf16_f32 v0, v0, v1
  v_mfma_f32_16x16x32_bf16 v[88:91], a[120:123], a[172:175], v[88:91]
  v_cvt_pk_bf16_f32 v1, v2, v3
  v_cvt_pk_bf16_f32 v2, v16, v17
  v_mfma_f32_16x16x32_bf16 v[88:91], a[100:103], a[148:151], v[88:91]
  v_cvt_pk_bf16_f32 v3, v18, v19
  v_cndmask_b32 v136, v245, v132, s[46:47]
  v_mfma_f32_16x16x32_bf16 v[84:87], a[96:99], a[148:151], v[84:87]
  v_mov_b32 v160, 0x3f803f80
  v_mul_f32 v108, 0x3e8293ee, v191
  v_mfma_f32_16x16x32_bf16 v[84:87], a[116:119], a[172:175], v[84:87]
  v_cndmask_b32 v137, v245, v133, s[46:47]
  v_mov_b32 v161, 0x3f803f80
  v_mfma_f32_16x16x32_bf16 v[80:83], a[112:115], a[172:175], v[80:83]
  v_mul_f32 v109, 0x3e8293ee, v193
  v_cndmask_b32 v138, v245, v134, s[46:47]
  v_mfma_f32_16x16x32_bf16 v[80:83], a[92:95], a[148:151], v[80:83]
  v_mov_b32 v162, 0x3f803f80
  v_mul_f32 v110, 0x3e8293ee, v195
Lmk_p1epi:
  v_cndmask_b32 v139, v245, v135, s[46:47]
  v_mov_b32 v163, 0x3f803f80
  v_mul_f32 v111, 0x3e8293ee, v197
  s_waitcnt lgkmcnt(0)
  v_pk_fma_f32 v[96:97], v[176:177], v[188:189], v[96:97] op_sel:[0,0,0] op_sel_hi:[1,0,1]
  v_pk_fma_f32 v[98:99], v[178:179], v[188:189], v[98:99] op_sel:[0,0,0] op_sel_hi:[1,0,1]
  v_pk_mul_f32 v[96:97], v[96:97], v[188:189] op_sel:[0,1] op_sel_hi:[1,1]
  v_pk_mul_f32 v[98:99], v[98:99], v[188:189] op_sel:[0,1] op_sel_hi:[1,1]
  v_cvt_pk_bf16_f32 v96, v96, v97
  v_cvt_pk_bf16_f32 v97, v98, v99
  v_pk_fma_f32 v[44:45], v[176:177], v[196:197], v[44:45] op_sel:[0,0,0] op_sel_hi:[1,0,1]
  v_pk_fma_f32 v[46:47], v[178:179], v[196:197], v[46:47] op_sel:[0,0,0] op_sel_hi:[1,0,1]
  v_pk_fma_f32 v[60:61], v[180:181], v[196:197], v[60:61] op_sel:[0,0,0] op_sel_hi:[1,0,1]
  v_pk_fma_f32 v[62:63], v[182:183], v[196:197], v[62:63] op_sel:[0,0,0] op_sel_hi:[1,0,1]
  v_pk_mul_f32 v[44:45], v[44:45], v[196:197] op_sel:[0,1] op_sel_hi:[1,1]
  v_pk_mul_f32 v[46:47], v[46:47], v[196:197] op_sel:[0,1] op_sel_hi:[1,1]
  v_pk_mul_f32 v[60:61], v[60:61], v[196:197] op_sel:[0,1] op_sel_hi:[1,1]
  v_pk_mul_f32 v[62:63], v[62:63], v[196:197] op_sel:[0,1] op_sel_hi:[1,1]
  v_cvt_pk_bf16_f32 v44, v44, v45
  v_cvt_pk_bf16_f32 v45, v46, v47
  v_cvt_pk_bf16_f32 v46, v60, v61
  v_cvt_pk_bf16_f32 v47, v62, v63
  v_pk_fma_f32 v[100:101], v[200:201], v[184:185], v[100:101] op_sel:[0,0,0] op_sel_hi:[1,0,1]
  v_pk_fma_f32 v[102:103], v[202:203], v[184:185], v[102:103] op_sel:[0,0,0] op_sel_hi:[1,0,1]
  v_pk_mul_f32 v[100:101], v[100:101], v[220:221]
  v_pk_mul_f32 v[102:103], v[102:103], v[222:223]
  v_cvt_pk_bf16_f32 v100, v100, v101
  v_cvt_pk_bf16_f32 v101, v102, v103
  v_pk_fma_f32 v[76:77], v[216:217], v[184:185], v[76:77] op_sel:[0,0,0] op_sel_hi:[1,0,1]
  v_pk_fma_f32 v[78:79], v[218:219], v[184:185], v[78:79] op_sel:[0,0,0] op_sel_hi:[1,0,1]
  v_pk_fma_f32 v[92:93], v[216:217], v[184:185], v[92:93] op_sel:[0,1,0] op_sel_hi:[1,1,1]
  v_pk_fma_f32 v[94:95], v[218:219], v[184:185], v[94:95] op_sel:[0,1,0] op_sel_hi:[1,1,1]
  v_pk_mul_f32 v[76:77], v[76:77], v[236:237]
  v_pk_mul_f32 v[78:79], v[78:79], v[238:239]
  v_pk_mul_f32 v[92:93], v[92:93], v[236:237]
  v_pk_mul_f32 v[94:95], v[94:95], v[238:239]
  v_cvt_pk_bf16_f32 v148, v76, v77
  v_cvt_pk_bf16_f32 v149, v78, v79
  v_cvt_pk_bf16_f32 v158, v92, v93
  v_cvt_pk_bf16_f32 v159, v94, v95
  ds_write2st64_b64 v105, v[96:97], v[100:101] offset0:0 offset1:1
  ds_write2st64_b64 v105, v[44:45], v[148:149] offset0:4 offset1:5
  ds_write2st64_b64 v105, v[46:47], v[158:159] offset0:6 offset1:7
  s_add_u32 m0, s89, 0
  s_xor_b32 s92, s88, 0
  buffer_load_dwordx4 v186, s[12:15], s92 offen lds
  v_pk_fma_f32 v[40:41], v[176:177], v[194:195], v[40:41] op_sel:[0,0,0] op_sel_hi:[1,0,1]
  v_pk_fma_f32 v[42:43], v[178:179], v[194:195], v[42:43] op_sel:[0,0,0] op_sel_hi:[1,0,1]
  v_pk_fma_f32 v[56:57], v[180:181], v[194:195], v[56:57] op_sel:[0,0,0] op_sel_hi:[1,0,1]
  v_pk_fma_f32 v[58:59], v[182:183], v[194:195], v[58:59] op_sel:[0,0,0] op_sel_hi:[1,0,1]
  v_pk_mul_f32 v[40:41], v[40:41], v[194:195] op_sel:[0,1] op_sel_hi:[1,1]
  v_pk_mul_f32 v[42:43], v[42:43], v[194:195] op_sel:[0,1] op_sel_hi:[1,1]
  v_pk_mul_f32 v[56:57], v[56:57], v[194:195] op_sel:[0,1] op_sel_hi:[1,1]
  v_pk_mul_f32 v[58:59], v[58:59], v[194:195] op_sel:[0,1] op_sel_hi:[1,1]
  v_cvt_pk_bf16_f32 v40, v40, v41
  v_cvt_pk_bf16_f32 v41, v42, v43
  v_cvt_pk_bf16_f32 v42, v56, v57
  v_cvt_pk_bf16_f32 v43, v58, v59
  s_add_u32 m0, s89, 4096
  s_xor_b32 s92, s88, 65536
  buffer_load_dwordx4 v186, s[12:15], s92 offen lds
  v_pk_fma_f32 v[36:37], v[176:177], v[192:193], v[36:37] op_sel:[0,0,0] op_sel_hi:[1,0,1]
  v_pk_fma_f32 v[38:39], v[178:179], v[192:193], v[38:39] op_sel:[0,0,0] op_sel_hi:[1,0,1]
  v_pk_fma_f32 v[52:53], v[180:181], v[192:193], v[52:53] op_sel:[0,0,0] op_sel_hi:[1,0,1]
  v_pk_fma_f32 v[54:55], v[182:183], v[192:193], v[54:55] op_sel:[0,0,0] op_sel_hi:[1,0,1]
  v_pk_mul_f32 v[36:37], v[36:37], v[192:193] op_sel:[0,1] op_sel_hi:[1,1]
  v_pk_mul_f32 v[38:39], v[38:39], v[192:193] op_sel:[0,1] op_sel_hi:[1,1]
  v_pk_mul_f32 v[52:53], v[52:53], v[192:193] op_sel:[0,1] op_sel_hi:[1,1]
  v_pk_mul_f32 v[54:55], v[54:55], v[192:193] op_sel:[0,1] op_sel_hi:[1,1]
  v_cvt_pk_bf16_f32 v36, v36, v37
  v_cvt_pk_bf16_f32 v37, v38, v39
  v_cvt_pk_bf16_f32 v38, v52, v53
  v_cvt_pk_bf16_f32 v39, v54, v55
  s_add_u32 m0, s89, 8192
  s_xor_b32 s92, s88, 131072
  buffer_load_dwordx4 v186, s[12:15], s92 offen lds
  v_pk_fma_f32 v[32:33], v[176:177], v[190:191], v[32:33] op_sel:[0,0,0] op_sel_hi:[1,0,1]
  v_pk_fma_f32 v[34:35], v[178:179], v[190:191], v[34:35] op_sel:[0,0,0] op_sel_hi:[1,0,1]
  v_pk_fma_f32 v[48:49], v[180:181], v[190:191], v[48:49] op_sel:[0,0,0] op_sel_hi:[1,0,1]
  v_pk_fma_f32 v[50:51], v[182:183], v[190:191], v[50:51] op_sel:[0,0,0] op_sel_hi:[1,0,1]
  v_pk_mul_f32 v[32:33], v[32:33], v[190:191] op_sel:[0,1] op_sel_hi:[1,1]
  v_pk_mul_f32 v[34:35], v[34:35], v[190:191] op_sel:[0,1] op_sel_hi:[1,1]
  v_pk_mul_f32 v[48:49], v[48:49], v[190:191] op_sel:[0,1] op_sel_hi:[1,1]
  v_pk_mul_f32 v[50:51], v[50:51], v[190:191] op_sel:[0,1] op_sel_hi:[1,1]
  v_cvt_pk_bf16_f32 v32, v32, v33
  v_cvt_pk_bf16_f32 v33, v34, v35
  v_cvt_pk_bf16_f32 v34, v48, v49
  v_cvt_pk_bf16_f32 v35, v50, v51
  s_waitcnt lgkmcnt(0)
  s_barrier
  ds_read_b64 v[120:121], v198
  ds_read_b64 v[122:123], v199
  ds_read_b64 v[140:141], v198 offset:512
  ds_read_b64 v[150:151], v199 offset:512
  v_mfma_f32_16x16x32_bf16 v[60:63], v[44:47], v[12:15], v[128:131]
  v_mfma_f32_16x16x32_bf16 v[28:31], v[40:43], v[12:15], v[132:135]
  v_mfma_f32_16x16x32_bf16 v[56:59], v[40:43], v[8:11], v[128:131]
  v_mfma_f32_16x16x32_bf16 v[24:27], v[36:39], v[8:11], v[132:135]
  v_mfma_f32_16x16x32_bf16 v[52:55], v[36:39], v[4:7], v[128:131]
  v_mfma_f32_16x16x32_bf16 v[20:23], v[32:35], v[4:7], v[132:135]
  v_mfma_f32_16x16x32_bf16 v[48:51], v[32:35], v[0:3], v[128:131]
  s_waitcnt lgkmcnt(0)
  v_mfma_f32_16x16x32_bf16 v[16:19], v[120:123], v[0:3], v[136:139]
  s_add_u32 m0, s89, 12288
  s_xor_b32 s92, s88, 196608
  buffer_load_dwordx4 v186, s[12:15], s92 offen lds
  v_pk_fma_f32 v[64:65], v[204:205], v[184:185], v[64:65] op_sel:[0,0,0] op_sel_hi:[1,0,1]
  v_pk_fma_f32 v[66:67], v[206:207], v[184:185], v[66:67] op_sel:[0,0,0] op_sel_hi:[1,0,1]
  v_pk_fma_f32 v[80:81], v[204:205], v[184:185], v[80:81] op_sel:[0,1,0] op_sel_hi:[1,1,1]
  v_pk_fma_f32 v[82:83], v[206:207], v[184:185], v[82:83] op_sel:[0,1,0] op_sel_hi:[1,1,1]
  v_pk_mul_f32 v[64:65], v[64:65], v[224:225]
  v_pk_mul_f32 v[66:67], v[66:67], v[226:227]
  v_pk_mul_f32 v[80:81], v[80:81], v[224:225]
  v_pk_mul_f32 v[82:83], v[82:83], v[226:227]
  v_cvt_pk_bf16_f32 v142, v64, v65
  v_cvt_pk_bf16_f32 v143, v66, v67
  v_cvt_pk_bf16_f32 v152, v80, v81
  v_cvt_pk_bf16_f32 v153, v82, v83
  s_add_u32 m0, s89, 16384
  s_xor_b32 s92, s88, 262144
  buffer_load_dwordx4 v186, s[12:15], s92 offen lds
  v_pk_fma_f32 v[68:69], v[208:209], v[184:185], v[68:69] op_sel:[0,0,0] op_sel_hi:[1,0,1]
  v_pk_fma_f32 v[70:71], v[210:211], v[184:185], v[70:71] op_sel:[0,0,0] op_sel_hi:[1,0,1]
  v_pk_fma_f32 v[84:85], v[208:209], v[184:185], v[84:85] op_sel:[0,1,0] op_sel_hi:[1,1,1]
  v_pk_fma_f32 v[86:87], v[210:211], v[184:185], v[86:87] op_sel:[0,1,0] op_sel_hi:[1,1,1]
  v_pk_mul_f32 v[68:69], v[68:69], v[228:229]
  v_pk_mul_f32 v[70:71], v[70:71], v[230:231]
  v_pk_mul_f32 v[84:85], v[84:85], v[228:229]
  v_pk_mul_f32 v[86:87], v[86:87], v[230:231]
  v_cvt_pk_bf16_f32 v144, v68, v69
  v_cvt_pk_bf16_f32 v145, v70, v71
  v_cvt_pk_bf16_f32 v154, v84, v85
  v_cvt_pk_bf16_f32 v155, v86, v87
  s_add_u32 m0, s89, 20480
  s_xor_b32 s92, s88, 327680
  buffer_load_dwordx4 v186, s[12:15], s92 offen lds
  v_pk_fma_f32 v[72:73], v[212:213], v[184:185], v[72:73] op_sel:[0,0,0] op_sel_hi:[1,0,1]
  v_pk_fma_f32 v[74:75], v[214:215], v[184:185], v[74:75] op_sel:[0,0,0] op_sel_hi:[1,0,1]
  v_pk_fma_f32 v[88:89], v[212:213], v[184:185], v[88:89] op_sel:[0,1,0] op_sel_hi:[1,1,1]
  v_pk_fma_f32 v[90:91], v[214:215], v[184:185], v[90:91] op_sel:[0,1,0] op_sel_hi:[1,1,1]
  v_pk_mul_f32 v[72:73], v[72:73], v[232:233]
  v_pk_mul_f32 v[74:75], v[74:75], v[234:235]
  v_pk_mul_f32 v[88:89], v[88:89], v[232:233]
  v_pk_mul_f32 v[90:91], v[90:91], v[234:235]
  v_cvt_pk_bf16_f32 v146, v72, v73
  v_cvt_pk_bf16_f32 v147, v74, v75
  v_cvt_pk_bf16_f32 v156, v88, v89
  v_cvt_pk_bf16_f32 v157, v90, v91
  s_add_u32 m0, s89, 24576
  s_xor_b32 s92, s88, 393216
  buffer_load_dwordx4 v186, s[12:15], s92 offen lds
  s_cmp_eq_u32 s57, 0
  s_cbranch_scc1 Lp1_nsw
  v_swap_b32 v140, v150
  v_swap_b32 v141, v151
  v_swap_b32 v142, v152
  v_swap_b32 v143, v153
  v_swap_b32 v144, v154
  v_swap_b32 v145, v155
  v_swap_b32 v146, v156
  v_swap_b32 v147, v157
  v_swap_b32 v148, v158
  v_swap_b32 v149, v159
Lp1_nsw:
  v_max3_f32 v240, v16, v17, v18
  v_max3_f32 v241, v20, v21, v22
  v_max3_f32 v242, v24, v25, v26
  v_max3_f32 v243, v28, v29, v30
  v_max3_f32 v240, v240, v19, v48
  v_max3_f32 v241, v241, v23, v52
  v_max3_f32 v242, v242, v27, v56
  v_max3_f32 v243, v243, v31, v60
  v_max3_f32 v240, v240, v49, v50
  v_max3_f32 v241, v241, v53, v54
  v_max3_f32 v242, v242, v57, v58
  v_max3_f32 v243, v243, v61, v62
  v_max_f32 v240, v240, v51
  v_max_f32 v241, v241, v55
  v_max_f32 v242, v242, v59
  v_max_f32 v243, v243, v63
  v_mov_b32 v244, v240
  v_mov_b32 v245, v241
  v_mov_b32 v246, v242
  v_mov_b32 v247, v243
  v_permlane32_swap_b32 v240, v244
  v_permlane32_swap_b32 v241, v245
  v_permlane32_swap_b32 v242, v246
  v_permlane32_swap_b32 v243, v247
  v_max_f32 v240, v240, v244
  v_max_f32 v241, v241, v245
  v_max_f32 v242, v242, v246
  v_max_f32 v243, v243, v247
  v_mov_b32 v244, v240
  v_mov_b32 v245, v241
  v_mov_b32 v246, v242
  v_mov_b32 v247, v243
  v_permlane16_swap_b32 v240, v244
  v_permlane16_swap_b32 v241, v245
  v_permlane16_swap_b32 v242, v246
  v_permlane16_swap_b32 v243, v247
  v_max_f32 v240, v240, v244
  v_max_f32 v241, v241, v245
  v_max_f32 v242, v242, v246
  v_max_f32 v243, v243, v247
  v_pk_mul_f32 v[240:241], v[240:241], v[108:109] neg_lo:[0,1] neg_hi:[0,1]
  v_pk_mul_f32 v[242:243], v[242:243], v[110:111] neg_lo:[0,1] neg_hi:[0,1]
  v_pk_fma_f32 v[16:17], v[16:17], v[108:109], v[240:241] op_sel:[0,0,0] op_sel_hi:[1,0,0]
  v_pk_fma_f32 v[18:19], v[18:19], v[108:109], v[240:241] op_sel:[0,0,0] op_sel_hi:[1,0,0]
  v_pk_fma_f32 v[48:49], v[48:49], v[108:109], v[240:241] op_sel:[0,0,0] op_sel_hi:[1,0,0]
  v_pk_fma_f32 v[50:51], v[50:51], v[108:109], v[240:241] op_sel:[0,0,0] op_sel_hi:[1,0,0]
  v_exp_f32 v16, v16
  v_exp_f32 v17, v17
  v_exp_f32 v18, v18
  v_exp_f32 v19, v19
  v_exp_f32 v48, v48
  v_exp_f32 v49, v49
  v_exp_f32 v50, v50
  v_exp_f32 v51, v51
  v_cvt_pk_bf16_f32 v0, v16, v17
  v_cvt_pk_bf16_f32 v1, v18, v19
  v_cvt_pk_bf16_f32 v2, v48, v49
  v_cvt_pk_bf16_f32 v3, v50, v51
  s_add_u32 m0, s89, 28672
  s_xor_b32 s92, s88, 458752
  buffer_load_dwordx4 v186, s[12:15], s92 offen lds
  v_pk_fma_f32 v[20:21], v[20:21], v[108:109], v[240:241] op_sel:[0,1,1] op_sel_hi:[1,1,1]
  v_pk_fma_f32 v[22:23], v[22:23], v[108:109], v[240:241] op_sel:[0,1,1] op_sel_hi:[1,1,1]
  v_pk_fma_f32 v[52:53], v[52:53], v[108:109], v[240:241] op_sel:[0,1,1] op_sel_hi:[1,1,1]
  v_pk_fma_f32 v[54:55], v[54:55], v[108:109], v[240:241] op_sel:[0,1,1] op_sel_hi:[1,1,1]
  v_exp_f32 v20, v20
  v_exp_f32 v21, v21
  v_exp_f32 v22, v22
  v_exp_f32 v23, v23
  v_exp_f32 v52, v52
  v_exp_f32 v53, v53
  v_exp_f32 v54, v54
  v_exp_f32 v55, v55
  v_cvt_pk_bf16_f32 v4, v20, v21
  v_cvt_pk_bf16_f32 v5, v22, v23
  v_cvt_pk_bf16_f32 v6, v52, v53
  v_cvt_pk_bf16_f32 v7, v54, v55
  s_add_u32 m0, s89, 32768
  s_xor_b32 s92, s88, 524288
  buffer_load_dwordx4 v186, s[12:15], s92 offen lds
  v_pk_fma_f32 v[24:25], v[24:25], v[110:111], v[242:243] op_sel:[0,0,0] op_sel_hi:[1,0,0]
  v_pk_fma_f32 v[26:27], v[26:27], v[110:111], v[242:243] op_sel:[0,0,0] op_sel_hi:[1,0,0]
  v_pk_fma_f32 v[56:57], v[56:57], v[110:111], v[242:243] op_sel:[0,0,0] op_sel_hi:[1,0,0]
  v_pk_fma_f32 v[58:59], v[58:59], v[110:111], v[242:243] op_sel:[0,0,0] op_sel_hi:[1,0,0]
  v_exp_f32 v24, v24
  v_exp_f32 v25, v25
  v_exp_f32 v26, v26
  v_exp_f32 v27, v27
  v_exp_f32 v56, v56
  v_exp_f32 v57, v57
  v_exp_f32 v58, v58
  v_exp_f32 v59, v59
  v_cvt_pk_bf16_f32 v8, v24, v25
  v_cvt_pk_bf16_f32 v9, v26, v27
  v_cvt_pk_bf16_f32 v10, v56, v57
  v_cvt_pk_bf16_f32 v11, v58, v59
  v_pk_fma_f32 v[28:29], v[28:29], v[110:111], v[242:243] op_sel:[0,1,1] op_sel_hi:[1,1,1]
  v_pk_fma_f32 v[30:31], v[30:31], v[110:111], v[242:243] op_sel:[0,1,1] op_sel_hi:[1,1,1]
  v_pk_fma_f32 v[60:61], v[60:61], v[110:111], v[242:243] op_sel:[0,1,1] op_sel_hi:[1,1,1]
  v_pk_fma_f32 v[62:63], v[62:63], v[110:111], v[242:243] op_sel:[0,1,1] op_sel_hi:[1,1,1]
  v_exp_f32 v28, v28
  v_exp_f32 v29, v29
  v_exp_f32 v30, v30
  v_exp_f32 v31, v31
  v_exp_f32 v60, v60
  v_exp_f32 v61, v61
  v_exp_f32 v62, v62
  v_exp_f32 v63, v63
  v_cvt_pk_bf16_f32 v12, v28, v29
  v_cvt_pk_bf16_f32 v13, v30, v31
  v_cvt_pk_bf16_f32 v14, v60, v61
  v_cvt_pk_bf16_f32 v15, v62, v63
  s_add_u32 m0, s89, 36864
  s_xor_b32 s92, s88, 589824
  buffer_load_dwordx4 v186, s[12:15], s92 offen lds
  v_mfma_f32_16x16x32_bf16 v[32:35], v[160:163], v[0:3], 0
  s_lshl_b32 s43, s74, 15
  s_lshl_b32 s44, s75, 10
  v_mfma_f32_16x16x32_bf16 v[36:39], v[160:163], v[4:7], 0
  s_add_u32 s43, s43, s44
  s_add_u32 s43, s43, s42
  v_mfma_f32_16x16x32_bf16 v[40:43], v[160:163], v[8:11], 0
  s_add_u32 s46, s43, 8388608
  s_add_u32 s47, s46, 32768
  v_mfma_f32_16x16x32_bf16 v[44:47], v[160:163], v[12:15], 0
  s_add_u32 s48, s47, 32768
  s_add_u32 s49, s48, 32768
  v_mfma_f32_16x16x32_bf16 v[64:67], v[140:143], v[0:3], 0
  s_lshl_b32 s77, s50, 1
  v_mfma_f32_16x16x32_bf16 v[80:83], v[150:153], v[0:3], 0
  s_lshr_b32 s43, s51, 3
  v_mfma_f32_16x16x32_bf16 v[68:71], v[142:145], v[4:7], 0
  s_add_u32 s77, s77, s43
  v_mfma_f32_16x16x32_bf16 v[84:87], v[152:155], v[4:7], 0
  s_lshl_b32 s77, s77, 7
  v_mfma_f32_16x16x32_bf16 v[72:75], v[144:147], v[8:11], 0
  s_add_u32 s77, s77, s42
  v_rcp_f32 v32, v32
  v_mfma_f32_16x16x32_bf16 v[88:91], v[154:157], v[8:11], 0
  s_add_u32 s77, s77, 27787264
  v_rcp_f32 v36, v36
  v_mfma_f32_16x16x32_bf16 v[76:79], v[146:149], v[12:15], 0
  v_rcp_f32 v40, v40
  v_mfma_f32_16x16x32_bf16 v[92:95], v[156:159], v[12:15], 0
  v_rcp_f32 v44, v44
  v_pk_mul_f32 v[64:65], v[64:65], v[32:33] op_sel:[0,0] op_sel_hi:[1,0]
  v_pk_mul_f32 v[66:67], v[66:67], v[32:33] op_sel:[0,0] op_sel_hi:[1,0]
  v_pk_mul_f32 v[80:81], v[80:81], v[32:33] op_sel:[0,0] op_sel_hi:[1,0]
  v_pk_mul_f32 v[82:83], v[82:83], v[32:33] op_sel:[0,0] op_sel_hi:[1,0]
  v_cvt_pk_bf16_f32 v16, v64, v65
  v_cvt_pk_bf16_f32 v17, v66, v67
  v_cvt_pk_bf16_f32 v18, v80, v81
  v_cvt_pk_bf16_f32 v19, v82, v83
  buffer_store_dwordx4 v[16:19], v104, s[4:7], s46 offen sc1
  v_pk_mul_f32 v[68:69], v[68:69], v[36:37] op_sel:[0,0] op_sel_hi:[1,0]
  v_pk_mul_f32 v[70:71], v[70:71], v[36:37] op_sel:[0,0] op_sel_hi:[1,0]
  v_pk_mul_f32 v[84:85], v[84:85], v[36:37] op_sel:[0,0] op_sel_hi:[1,0]
  v_pk_mul_f32 v[86:87], v[86:87], v[36:37] op_sel:[0,0] op_sel_hi:[1,0]
  v_cvt_pk_bf16_f32 v20, v68, v69
  v_cvt_pk_bf16_f32 v21, v70, v71
  v_cvt_pk_bf16_f32 v22, v84, v85
  v_cvt_pk_bf16_f32 v23, v86, v87
  buffer_store_dwordx4 v[20:23], v104, s[4:7], s47 offen sc1
  v_pk_mul_f32 v[72:73], v[72:73], v[40:41] op_sel:[0,0] op_sel_hi:[1,0]
  v_pk_mul_f32 v[74:75], v[74:75], v[40:41] op_sel:[0,0] op_sel_hi:[1,0]
  v_pk_mul_f32 v[88:89], v[88:89], v[40:41] op_sel:[0,0] op_sel_hi:[1,0]
  v_pk_mul_f32 v[90:91], v[90:91], v[40:41] op_sel:[0,0] op_sel_hi:[1,0]
  v_cvt_pk_bf16_f32 v24, v72, v73
  v_cvt_pk_bf16_f32 v25, v74, v75
  v_cvt_pk_bf16_f32 v26, v88, v89
  v_cvt_pk_bf16_f32 v27, v90, v91
  buffer_store_dwordx4 v[24:27], v104, s[4:7], s48 offen sc1
  v_pk_mul_f32 v[76:77], v[76:77], v[44:45] op_sel:[0,0] op_sel_hi:[1,0]
  v_pk_mul_f32 v[78:79], v[78:79], v[44:45] op_sel:[0,0] op_sel_hi:[1,0]
  v_pk_mul_f32 v[92:93], v[92:93], v[44:45] op_sel:[0,0] op_sel_hi:[1,0]
  v_pk_mul_f32 v[94:95], v[94:95], v[44:45] op_sel:[0,0] op_sel_hi:[1,0]
  v_cvt_pk_bf16_f32 v28, v76, v77
  v_cvt_pk_bf16_f32 v29, v78, v79
  v_cvt_pk_bf16_f32 v30, v92, v93
  v_cvt_pk_bf16_f32 v31, v94, v95
  buffer_store_dwordx4 v[28:31], v104, s[4:7], s49 offen sc1
Lmk_p1end:
  s_lshl_b32 s44, s52, 3
  s_lshl_b32 s43, s40, 1
  s_add_u32 s44, s44, s43
  s_lshl_b32 s45, s44, 15
  s_add_u32 s57, s45, s42
  s_add_u32 s57, s57, 8388608
  s_lshl_b32 s43, s53, 11
  s_add_u32 s45, s45, s43
  s_add_u32 s45, s45, s42
  s_add_u32 s58, s45, 4194304
  s_add_u32 s59, s58, 32768
  s_lshl_b32 s44, s44, 11
  s_lshl_b32 s43, s53, 7
  s_add_u32 s44, s44, s43
  s_add_u32 s44, s44, s42
  s_add_u32 s60, s44, 27525120
  v_lshlrev_b32 v48, 4, v253
  v_add_u32 v49, 32768, v48
  s_cmp_eq_u32 s41, 0
  s_cselect_b32 s44, 32, 8
  s_cselect_b32 s45, 64, 0x400
  s_lshl_b32 s43, s40, 12
  s_add_u32 s43, s43, 90112
  v_xor_b32 v3, s44, v187
  v_xor_b32 v4, s45, v187
  v_xor_b32 v5, s45, v3
  v_add_u32 v2, s43, v187
  v_add_u32 v3, s43, v3
  v_add_u32 v4, s43, v4
  v_add_u32 v5, s43, v5
  s_waitcnt vmcnt(22)
  ds_read_b64 v[52:53], v2 offset:0
  ds_read_b64 v[54:55], v3 offset:0
  ds_read_b64 v[56:57], v4 offset:0
  ds_read_b64 v[58:59], v5 offset:0
  ds_read_b64 v[60:61], v2 offset:2048
  ds_read_b64 v[62:63], v3 offset:2048
  ds_read_b64 v[64:65], v4 offset:2048
  ds_read_b64 v[66:67], v5 offset:2048
  v_lshrrev_b32 v2, 2, v253
  v_bfe_u32 v3, v253, 3, 2
  v_and_b32 v4, 3, v253
  v_lshlrev_b32 v4, 3, v4
  v_lshl_add_u32 v4, v2, 7, v4
  v_xor_b32 v5, 0, v3
  v_lshl_add_u32 v40, v5, 5, v4
  v_xor_b32 v5, 1, v3
  v_lshl_add_u32 v41, v5, 5, v4
  v_xor_b32 v5, 2, v3
  v_lshl_add_u32 v42, v5, 5, v4
  v_xor_b32 v5, 3, v3
  v_lshl_add_u32 v43, v5, 5, v4
  s_cmp_eq_u32 s3, 0
  s_cbranch_scc1 Lsd6
  v_accvgpr_read_b32 v236, a176
  v_accvgpr_read_b32 v237, a177
  v_accvgpr_read_b32 v238, a178
  v_accvgpr_read_b32 v239, a179
  v_lshlrev_b32 v224, 16, v236
  v_and_b32 v225, 0xffff0000, v236
  v_lshlrev_b32 v226, 16, v237
  v_and_b32 v227, 0xffff0000, v237
  v_lshlrev_b32 v228, 16, v238
  v_and_b32 v229, 0xffff0000, v238
  v_lshlrev_b32 v230, 16, v239
  v_and_b32 v231, 0xffff0000, v239
  v_accvgpr_read_b32 v236, a180
  v_accvgpr_read_b32 v237, a181
  v_accvgpr_read_b32 v238, a182
  v_accvgpr_read_b32 v239, a183
  v_lshlrev_b32 v232, 16, v236
  v_and_b32 v233, 0xffff0000, v236
  v_pk_add_f32 v[224:225], v[224:225], v[232:233]
  v_lshlrev_b32 v232, 16, v237
  v_and_b32 v233, 0xffff0000, v237
  v_pk_add_f32 v[226:227], v[226:227], v[232:233]
  v_lshlrev_b32 v232, 16, v238
  v_and_b32 v233, 0xffff0000, v238
  v_pk_add_f32 v[228:229], v[228:229], v[232:233]
  v_lshlrev_b32 v232, 16, v239
  v_and_b32 v233, 0xffff0000, v239
  v_pk_add_f32 v[230:231], v[230:231], v[232:233]
  v_accvgpr_read_b32 v236, a184
  v_accvgpr_read_b32 v237, a185
  v_accvgpr_read_b32 v238, a186
  v_accvgpr_read_b32 v239, a187
  v_lshlrev_b32 v232, 16, v236
  v_and_b32 v233, 0xffff0000, v236
  v_pk_add_f32 v[224:225], v[224:225], v[232:233]
  v_lshlrev_b32 v232, 16, v237
  v_and_b32 v233, 0xffff0000, v237
  v_pk_add_f32 v[226:227], v[226:227], v[232:233]
  v_lshlrev_b32 v232, 16, v238
  v_and_b32 v233, 0xffff0000, v238
  v_pk_add_f32 v[228:229], v[228:229], v[232:233]
  v_lshlrev_b32 v232, 16, v239
  v_and_b32 v233, 0xffff0000, v239
  v_pk_add_f32 v[230:231], v[230:231], v[232:233]
  v_accvgpr_read_b32 v236, a188
  v_accvgpr_read_b32 v237, a189
  v_accvgpr_read_b32 v238, a190
  v_accvgpr_read_b32 v239, a191
  v_lshlrev_b32 v232, 16, v236
  v_and_b32 v233, 0xffff0000, v236
  v_pk_add_f32 v[224:225], v[224:225], v[232:233]
  v_lshlrev_b32 v232, 16, v237
  v_and_b32 v233, 0xffff0000, v237
  v_pk_add_f32 v[226:227], v[226:227], v[232:233]
  v_lshlrev_b32 v232, 16, v238
  v_and_b32 v233, 0xffff0000, v238
  v_pk_add_f32 v[228:229], v[228:229], v[232:233]
  v_lshlrev_b32 v232, 16, v239
  v_and_b32 v233, 0xffff0000, v239
  v_pk_add_f32 v[230:231], v[230:231], v[232:233]
  v_accvgpr_read_b32 v236, a192
  v_accvgpr_read_b32 v237, a193
  v_accvgpr_read_b32 v238, a194
  v_accvgpr_read_b32 v239, a195
  v_lshlrev_b32 v232, 16, v236
  v_and_b32 v233, 0xffff0000, v236
  v_pk_add_f32 v[224:225], v[224:225], v[232:233]
  v_lshlrev_b32 v232, 16, v237
  v_and_b32 v233, 0xffff0000, v237
  v_pk_add_f32 v[226:227], v[226:227], v[232:233]
  v_lshlrev_b32 v232, 16, v238
  v_and_b32 v233, 0xffff0000, v238
  v_pk_add_f32 v[228:229], v[228:229], v[232:233]
  v_lshlrev_b32 v232, 16, v239
  v_and_b32 v233, 0xffff0000, v239
  v_pk_add_f32 v[230:231], v[230:231], v[232:233]
  v_accvgpr_read_b32 v236, a196
  v_accvgpr_read_b32 v237, a197
  v_accvgpr_read_b32 v238, a198
  v_accvgpr_read_b32 v239, a199
  v_lshlrev_b32 v232, 16, v236
  v_and_b32 v233, 0xffff0000, v236
  v_pk_add_f32 v[224:225], v[224:225], v[232:233]
  v_lshlrev_b32 v232, 16, v237
  v_and_b32 v233, 0xffff0000, v237
  v_pk_add_f32 v[226:227], v[226:227], v[232:233]
  v_lshlrev_b32 v232, 16, v238
  v_and_b32 v233, 0xffff0000, v238
  v_pk_add_f32 v[228:229], v[228:229], v[232:233]
  v_lshlrev_b32 v232, 16, v239
  v_and_b32 v233, 0xffff0000, v239
  v_pk_add_f32 v[230:231], v[230:231], v[232:233]
  v_accvgpr_read_b32 v236, a200
  v_accvgpr_read_b32 v237, a201
  v_accvgpr_read_b32 v238, a202
  v_accvgpr_read_b32 v239, a203
  v_lshlrev_b32 v232, 16, v236
  v_and_b32 v233, 0xffff0000, v236
  v_pk_add_f32 v[224:225], v[224:225], v[232:233]
  v_lshlrev_b32 v232, 16, v237
  v_and_b32 v233, 0xffff0000, v237
  v_pk_add_f32 v[226:227], v[226:227], v[232:233]
  v_lshlrev_b32 v232, 16, v238
  v_and_b32 v233, 0xffff0000, v238
  v_pk_add_f32 v[228:229], v[228:229], v[232:233]
  v_lshlrev_b32 v232, 16, v239
  v_and_b32 v233, 0xffff0000, v239
  v_pk_add_f32 v[230:231], v[230:231], v[232:233]
  v_accvgpr_read_b32 v236, a204
  v_accvgpr_read_b32 v237, a205
  v_accvgpr_read_b32 v238, a206
  v_accvgpr_read_b32 v239, a207
  v_lshlrev_b32 v232, 16, v236
  v_and_b32 v233, 0xffff0000, v236
  v_pk_add_f32 v[224:225], v[224:225], v[232:233]
  v_lshlrev_b32 v232, 16, v237
  v_and_b32 v233, 0xffff0000, v237
  v_pk_add_f32 v[226:227], v[226:227], v[232:233]
  v_lshlrev_b32 v232, 16, v238
  v_and_b32 v233, 0xffff0000, v238
  v_pk_add_f32 v[228:229], v[228:229], v[232:233]
  v_lshlrev_b32 v232, 16, v239
  v_and_b32 v233, 0xffff0000, v239
  v_pk_add_f32 v[230:231], v[230:231], v[232:233]
Lsd6:
  s_waitcnt lgkmcnt(0)
  s_waitcnt vmcnt(0)
  s_barrier
  s_cmp_lg_u32 s40, 0
  s_cbranch_scc1 Lsig5
  v_mov_b32 v250, 1
  s_mov_b64 exec, 1
  buffer_atomic_add v250, v251, s[4:7], s77 offen sc1
  s_mov_b64 exec, -1
Lsig5:
  s_add_u32 m0, s89, 73728
  s_xor_b32 s92, s88, 1179648
  buffer_load_dwordx4 v186, s[12:15], s92 offen lds
  s_add_u32 m0, s89, 77824
  s_xor_b32 s92, s88, 1245184
  buffer_load_dwordx4 v186, s[12:15], s92 offen lds
  s_add_u32 m0, s89, 81920
  s_xor_b32 s92, s88, 1310720
  buffer_load_dwordx4 v186, s[12:15], s92 offen lds
  s_add_u32 m0, s89, 86016
  s_xor_b32 s92, s88, 1376256
  buffer_load_dwordx4 v186, s[12:15], s92 offen lds
  s_add_u32 m0, s89, 90112
  s_xor_b32 s92, s88, 1441792
  buffer_load_dwordx4 v186, s[12:15], s92 offen lds
  s_add_u32 m0, s89, 94208
  s_xor_b32 s92, s88, 1507328
  buffer_load_dwordx4 v186, s[12:15], s92 offen lds
  s_add_u32 m0, s89, 98304
  s_xor_b32 s92, s88, 1572864
  buffer_load_dwordx4 v186, s[12:15], s92 offen lds
  s_add_u32 m0, s89, 102400
  s_xor_b32 s92, s88, 1638400
  buffer_load_dwordx4 v186, s[12:15], s92 offen lds
  s_add_u32 m0, s89, 106496
  s_xor_b32 s92, s88, 1703936
  buffer_load_dwordx4 v186, s[12:15], s92 offen lds
  s_add_u32 m0, s89, 110592
  s_xor_b32 s92, s88, 1769472
  buffer_load_dwordx4 v186, s[12:15], s92 offen lds
  s_add_u32 m0, s89, 114688
  s_xor_b32 s92, s88, 1835008
  buffer_load_dwordx4 v186, s[12:15], s92 offen lds
  s_add_u32 m0, s89, 118784
  s_xor_b32 s92, s88, 1900544
  buffer_load_dwordx4 v186, s[12:15], s92 offen lds
  s_add_u32 m0, s89, 122880
  s_xor_b32 s92, s88, 1966080
  buffer_load_dwordx4 v186, s[12:15], s92 offen lds
  s_add_u32 m0, s89, 126976
  s_xor_b32 s92, s88, 2031616
  buffer_load_dwordx4 v186, s[12:15], s92 offen lds
  v_lshlrev_b32 v0, 16, v52
  v_and_b32 v1, 0xffff0000, v52
  v_lshlrev_b32 v2, 16, v53
  v_and_b32 v3, 0xffff0000, v53
  v_lshlrev_b32 v8, 16, v54
  v_and_b32 v9, 0xffff0000, v54
  v_lshlrev_b32 v10, 16, v55
  v_and_b32 v11, 0xffff0000, v55
  v_lshlrev_b32 v16, 16, v56
  v_and_b32 v17, 0xffff0000, v56
  v_lshlrev_b32 v18, 16, v57
  v_and_b32 v19, 0xffff0000, v57
  v_lshlrev_b32 v24, 16, v58
  v_and_b32 v25, 0xffff0000, v58
  v_lshlrev_b32 v26, 16, v59
  v_and_b32 v27, 0xffff0000, v59
  v_lshlrev_b32 v4, 16, v60
  v_and_b32 v5, 0xffff0000, v60
  v_lshlrev_b32 v6, 16, v61
  v_and_b32 v7, 0xffff0000, v61
  v_lshlrev_b32 v12, 16, v62
  v_and_b32 v13, 0xffff0000, v62
  v_lshlrev_b32 v14, 16, v63
  v_and_b32 v15, 0xffff0000, v63
  v_lshlrev_b32 v20, 16, v64
  v_and_b32 v21, 0xffff0000, v64
  v_lshlrev_b32 v22, 16, v65
  v_and_b32 v23, 0xffff0000, v65
  v_lshlrev_b32 v28, 16, v66
  v_and_b32 v29, 0xffff0000, v66
  v_lshlrev_b32 v30, 16, v67
  v_and_b32 v31, 0xffff0000, v67
  v_and_b32 v92, 15, v253
  v_lshrrev_b32 v93, 4, v253
  v_lshrrev_b32 v72, 2, v92
  v_cmp_eq_u32 vcc, v72, v93
  v_and_b32 v72, 3, v92
  v_lshlrev_b32 v92, 3, v92
  v_mov_b32 v93, 0x7ffffff0
  v_cndmask_b32 v92, v93, v92, vcc
  v_cmp_eq_u32 s[64:65], 1, v72
  v_cmp_eq_u32 s[66:67], 2, v72
  v_cmp_eq_u32 s[68:69], 3, v72
  v_mov_b32 v72, 0x3f803f80
  v_mov_b32 v73, 0x3f803f80
  v_mov_b32 v74, 0x3f803f80
  v_mov_b32 v75, 0x3f803f80
  s_cmp_eq_u32 s3, 0
  s_cbranch_scc1 Lsd7
  v_accvgpr_read_b32 v236, a208
  v_accvgpr_read_b32 v237, a209
  v_accvgpr_read_b32 v238, a210
  v_accvgpr_read_b32 v239, a211
  v_lshlrev_b32 v232, 16, v236
  v_and_b32 v233, 0xffff0000, v236
  v_pk_add_f32 v[224:225], v[224:225], v[232:233]
  v_lshlrev_b32 v232, 16, v237
  v_and_b32 v233, 0xffff0000, v237
  v_pk_add_f32 v[226:227], v[226:227], v[232:233]
  v_lshlrev_b32 v232, 16, v238
  v_and_b32 v233, 0xffff0000, v238
  v_pk_add_f32 v[228:229], v[228:229], v[232:233]
  v_lshlrev_b32 v232, 16, v239
  v_and_b32 v233, 0xffff0000, v239
  v_pk_add_f32 v[230:231], v[230:231], v[232:233]
  v_accvgpr_read_b32 v236, a212
  v_accvgpr_read_b32 v237, a213
  v_accvgpr_read_b32 v238, a214
  v_accvgpr_read_b32 v239, a215
  v_lshlrev_b32 v232, 16, v236
  v_and_b32 v233, 0xffff0000, v236
  v_pk_add_f32 v[224:225], v[224:225], v[232:233]
  v_lshlrev_b32 v232, 16, v237
  v_and_b32 v233, 0xffff0000, v237
  v_pk_add_f32 v[226:227], v[226:227], v[232:233]
  v_lshlrev_b32 v232, 16, v238
  v_and_b32 v233, 0xffff0000, v238
  v_pk_add_f32 v[228:229], v[228:229], v[232:233]
  v_lshlrev_b32 v232, 16, v239
  v_and_b32 v233, 0xffff0000, v239
  v_pk_add_f32 v[230:231], v[230:231], v[232:233]
  v_accvgpr_read_b32 v236, a216
  v_accvgpr_read_b32 v237, a217
  v_accvgpr_read_b32 v238, a218
  v_accvgpr_read_b32 v239, a219
  v_lshlrev_b32 v232, 16, v236
  v_and_b32 v233, 0xffff0000, v236
  v_pk_add_f32 v[224:225], v[224:225], v[232:233]
  v_lshlrev_b32 v232, 16, v237
  v_and_b32 v233, 0xffff0000, v237
  v_pk_add_f32 v[226:227], v[226:227], v[232:233]
  v_lshlrev_b32 v232, 16, v238
  v_and_b32 v233, 0xffff0000, v238
  v_pk_add_f32 v[228:229], v[228:229], v[232:233]
  v_lshlrev_b32 v232, 16, v239
  v_and_b32 v233, 0xffff0000, v239
  v_pk_add_f32 v[230:231], v[230:231], v[232:233]
  v_accvgpr_read_b32 v236, a220
  v_accvgpr_read_b32 v237, a221
  v_accvgpr_read_b32 v238, a222
  v_accvgpr_read_b32 v239, a223
  v_lshlrev_b32 v232, 16, v236
  v_and_b32 v233, 0xffff0000, v236
  v_pk_add_f32 v[224:225], v[224:225], v[232:233]
  v_lshlrev_b32 v232, 16, v237
  v_and_b32 v233, 0xffff0000, v237
  v_pk_add_f32 v[226:227], v[226:227], v[232:233]
  v_lshlrev_b32 v232, 16, v238
  v_and_b32 v233, 0xffff0000, v238
  v_pk_add_f32 v[228:229], v[228:229], v[232:233]
  v_lshlrev_b32 v232, 16, v239
  v_and_b32 v233, 0xffff0000, v239
  v_pk_add_f32 v[230:231], v[230:231], v[232:233]
  v_accvgpr_read_b32 v236, a224
  v_accvgpr_read_b32 v237, a225
  v_accvgpr_read_b32 v238, a226
  v_accvgpr_read_b32 v239, a227
  v_lshlrev_b32 v232, 16, v236
  v_and_b32 v233, 0xffff0000, v236
  v_pk_add_f32 v[224:225], v[224:225], v[232:233]
  v_lshlrev_b32 v232, 16, v237
  v_and_b32 v233, 0xffff0000, v237
  v_pk_add_f32 v[226:227], v[226:227], v[232:233]
  v_lshlrev_b32 v232, 16, v238
  v_and_b32 v233, 0xffff0000, v238
  v_pk_add_f32 v[228:229], v[228:229], v[232:233]
  v_lshlrev_b32 v232, 16, v239
  v_and_b32 v233, 0xffff0000, v239
  v_pk_add_f32 v[230:231], v[230:231], v[232:233]
  v_accvgpr_read_b32 v236, a228
  v_accvgpr_read_b32 v237, a229
  v_accvgpr_read_b32 v238, a230
  v_accvgpr_read_b32 v239, a231
  v_lshlrev_b32 v232, 16, v236
  v_and_b32 v233, 0xffff0000, v236
  v_pk_add_f32 v[224:225], v[224:225], v[232:233]
  v_lshlrev_b32 v232, 16, v237
  v_and_b32 v233, 0xffff0000, v237
  v_pk_add_f32 v[226:227], v[226:227], v[232:233]
  v_lshlrev_b32 v232, 16, v238
  v_and_b32 v233, 0xffff0000, v238
  v_pk_add_f32 v[228:229], v[228:229], v[232:233]
  v_lshlrev_b32 v232, 16, v239
  v_and_b32 v233, 0xffff0000, v239
  v_pk_add_f32 v[230:231], v[230:231], v[232:233]
  v_accvgpr_read_b32 v236, a232
  v_accvgpr_read_b32 v237, a233
  v_accvgpr_read_b32 v238, a234
  v_accvgpr_read_b32 v239, a235
  v_lshlrev_b32 v232, 16, v236
  v_and_b32 v233, 0xffff0000, v236
  v_pk_add_f32 v[224:225], v[224:225], v[232:233]
  v_lshlrev_b32 v232, 16, v237
  v_and_b32 v233, 0xffff0000, v237
  v_pk_add_f32 v[226:227], v[226:227], v[232:233]
  v_lshlrev_b32 v232, 16, v238
  v_and_b32 v233, 0xffff0000, v238
  v_pk_add_f32 v[228:229], v[228:229], v[232:233]
  v_lshlrev_b32 v232, 16, v239
  v_and_b32 v233, 0xffff0000, v239
  v_pk_add_f32 v[230:231], v[230:231], v[232:233]
  v_accvgpr_read_b32 v236, a236
  v_accvgpr_read_b32 v237, a237
  v_accvgpr_read_b32 v238, a238
  v_accvgpr_read_b32 v239, a239
  v_lshlrev_b32 v232, 16, v236
  v_and_b32 v233, 0xffff0000, v236
  v_pk_add_f32 v[224:225], v[224:225], v[232:233]
  v_lshlrev_b32 v232, 16, v237
  v_and_b32 v233, 0xffff0000, v237
  v_pk_add_f32 v[226:227], v[226:227], v[232:233]
  v_lshlrev_b32 v232, 16, v238
  v_and_b32 v233, 0xffff0000, v238
  v_pk_add_f32 v[228:229], v[228:229], v[232:233]
  v_lshlrev_b32 v232, 16, v239
  v_and_b32 v233, 0xffff0000, v239
  v_pk_add_f32 v[230:231], v[230:231], v[232:233]
  v_mov_b32 v232, v224
  v_mov_b32 v233, v225
  v_mov_b32 v234, v226
  v_mov_b32 v235, v227
  v_mov_b32 v236, v228
  v_mov_b32 v237, v229
  v_mov_b32 v238, v230
  v_mov_b32 v239, v231
  v_permlane32_swap_b32 v224, v232
  v_permlane32_swap_b32 v225, v233
  v_permlane32_swap_b32 v226, v234
  v_permlane32_swap_b32 v227, v235
  v_permlane32_swap_b32 v228, v236
  v_permlane32_swap_b32 v229, v237
  v_permlane32_swap_b32 v230, v238
  v_permlane32_swap_b32 v231, v239
  v_add_f32 v224, v224, v232
  v_add_f32 v225, v225, v233
  v_add_f32 v226, v226, v234
  v_add_f32 v227, v227, v235
  v_add_f32 v228, v228, v236
  v_add_f32 v229, v229, v237
  v_add_f32 v230, v230, v238
  v_add_f32 v231, v231, v239
  v_mov_b32 v232, v224
  v_mov_b32 v233, v225
  v_mov_b32 v234, v226
  v_mov_b32 v235, v227
  v_mov_b32 v236, v228
  v_mov_b32 v237, v229
  v_mov_b32 v238, v230
  v_mov_b32 v239, v231
  v_permlane16_swap_b32 v224, v232
  v_permlane16_swap_b32 v225, v233
  v_permlane16_swap_b32 v226, v234
  v_permlane16_swap_b32 v227, v235
  v_permlane16_swap_b32 v228, v236
  v_permlane16_swap_b32 v229, v237
  v_permlane16_swap_b32 v230, v238
  v_permlane16_swap_b32 v231, v239
  v_add_f32 v224, v224, v232
  v_add_f32 v225, v225, v233
  v_add_f32 v226, v226, v234
  v_add_f32 v227, v227, v235
  v_add_f32 v228, v228, v236
  v_add_f32 v229, v229, v237
  v_add_f32 v230, v230, v238
  v_add_f32 v231, v231, v239
  v_and_b32 v232, 7, v253
  s_lshl_b32 s43, s40, 8
  s_add_u32 s43, s43, 143360
  v_add_f32_dpp v224, v224, v224 row_ror:8 row_mask:0xf bank_mask:0xf
  v_add_f32_dpp v225, v225, v225 row_ror:8 row_mask:0xf bank_mask:0xf
  v_add_f32_dpp v226, v226, v226 row_ror:8 row_mask:0xf bank_mask:0xf
  v_add_f32_dpp v227, v227, v227 row_ror:8 row_mask:0xf bank_mask:0xf
  v_add_f32_dpp v228, v228, v228 row_ror:8 row_mask:0xf bank_mask:0xf
  v_add_f32_dpp v229, v229, v229 row_ror:8 row_mask:0xf bank_mask:0xf
  v_add_f32_dpp v230, v230, v230 row_ror:8 row_mask:0xf bank_mask:0xf
  v_add_f32_dpp v231, v231, v231 row_ror:8 row_mask:0xf bank_mask:0xf
  v_lshl_add_u32 v232, v232, 5, s43
  ds_write_b128 v232, v[224:227]
  ds_write_b128 v232, v[228:231] offset:16
Lsd7:
  s_lshl_b32 s77, s52, 8
  s_add_u32 s77, s77, 27787264
  v_lshlrev_b32 v249, 7, v253
  s_add_u32 s77, s77, s42
  s_cmp_lg_u32 s40, 0
  s_cbranch_scc1 Lpdn9
  s_mov_b32 s43, 0x40000
  s_mov_b64 exec, 3
Lpol8:
  buffer_load_dword v250, v249, s[4:7], s77 offen sc1
  s_waitcnt vmcnt(0)
  v_cmp_gt_u32 vcc, 8, v250
  s_cbranch_vccz Lpdn9x
  s_sub_u32 s43, s43, 1
  s_cmp_lg_u32 s43, 0
  s_cbranch_scc1 Lpol8
Lpdn9x:
  s_mov_b64 exec, -1
Lpdn9:
  s_waitcnt vmcnt(0) lgkmcnt(0)
  s_barrier
  s_lshr_b32 s88, s88, 6
  s_xor_b32 s93, s57, s88
  buffer_load_dwordx4 a[0:3], v48, s[4:7], s93 offen offset:0 sc1
  buffer_load_dwordx4 a[4:7], v49, s[4:7], s93 offen offset:0 sc1
  buffer_load_dwordx4 a[8:11], v48, s[4:7], s93 offen offset:1024 sc1
  buffer_load_dwordx4 a[12:15], v49, s[4:7], s93 offen offset:1024 sc1
  buffer_load_dwordx4 a[16:19], v48, s[4:7], s93 offen offset:2048 sc1
  buffer_load_dwordx4 a[20:23], v49, s[4:7], s93 offen offset:2048 sc1
  buffer_load_dwordx4 a[24:27], v48, s[4:7], s93 offen offset:3072 sc1
  buffer_load_dwordx4 a[28:31], v49, s[4:7], s93 offen offset:3072 sc1
  s_add_u32 s57, s57, 4096
  s_xor_b32 s93, s57, s88
  buffer_load_dwordx4 a[32:35], v48, s[4:7], s93 offen offset:0 sc1
  buffer_load_dwordx4 a[36:39], v49, s[4:7], s93 offen offset:0 sc1
  buffer_load_dwordx4 a[40:43], v48, s[4:7], s93 offen offset:1024 sc1
  buffer_load_dwordx4 a[44:47], v49, s[4:7], s93 offen offset:1024 sc1
  s_cmp_eq_u32 s40, 1
  s_cselect_b32 s3, s3, 0
  s_cmp_eq_u32 s3, 0
  s_cbranch_scc1 Lsd10
  v_lshlrev_b32 v232, 2, v253
  v_add_u32 v233, 143360, v232
  ds_read_b32 v234, v233 offset:0
  ds_read_b32 v235, v233 offset:256
  ds_read_b32 v236, v233 offset:512
  ds_read_b32 v237, v233 offset:768
  s_waitcnt lgkmcnt(0)
  v_add_f32 v234, v234, v235
  v_add_f32 v236, v236, v237
  v_add_f32 v234, v234, v236
  buffer_store_dword v234, v232, s[4:7], s101 offen sc1
Lsd10:
  ds_read_b64_tr_b16 a[128:129], v40 offset:0
  ds_read_b64_tr_b16 a[130:131], v40 offset:2048
  ds_read_b64_tr_b16 a[144:145], v40 offset:4096
  ds_read_b64_tr_b16 a[146:147], v40 offset:6144
  ds_read_b64_tr_b16 a[132:133], v41 offset:0
  ds_read_b64_tr_b16 a[134:135], v41 offset:2048
  ds_read_b64_tr_b16 a[148:149], v41 offset:4096
  ds_read_b64_tr_b16 a[150:151], v41 offset:6144
  ds_read_b64_tr_b16 a[136:137], v42 offset:0
  ds_read_b64_tr_b16 a[138:139], v42 offset:2048
  ds_read_b64_tr_b16 a[152:153], v42 offset:4096
  ds_read_b64_tr_b16 a[154:155], v42 offset:6144
  ds_read_b64_tr_b16 a[140:141], v43 offset:0
  ds_read_b64_tr_b16 a[142:143], v43 offset:2048
  ds_read_b64_tr_b16 a[156:157], v43 offset:4096
  ds_read_b64_tr_b16 a[158:159], v43 offset:6144
  s_and_b32 s43, s53, 1
  s_mul_i32 s77, s52, 2
  s_add_u32 s77, s77, s43
  s_lshl_b32 s77, s77, 7
  s_add_u32 s77, s77, s42
  s_add_u32 s77, s77, 27807744
  s_mov_b32 s56, 3
.p2align 3
Lp2_loop:
  s_waitcnt vmcnt(8) lgkmcnt(8)
  v_mfma_f32_16x16x32_bf16 v[0:3], a[128:131], a[0:3], v[0:3]
  ds_read_b64_tr_b16 a[160:161], v40 offset:8192
  v_mfma_f32_16x16x32_bf16 v[0:3], a[144:147], a[8:11], v[0:3]
  ds_read_b64_tr_b16 a[162:163], v40 offset:10240
  buffer_load_dwordx4 a[48:51], v48, s[4:7], s93 offen offset:2048 sc1
  v_mfma_f32_16x16x32_bf16 v[4:7], a[144:147], a[12:15], v[4:7]
  ds_read_b64_tr_b16 a[176:177], v40 offset:12288
  v_mfma_f32_16x16x32_bf16 v[4:7], a[128:131], a[4:7], v[4:7]
  ds_read_b64_tr_b16 a[178:179], v40 offset:14336
  v_mfma_f32_16x16x32_bf16 v[12:15], a[132:135], a[4:7], v[12:15]
  ds_read_b64_tr_b16 a[164:165], v41 offset:8192
  v_mfma_f32_16x16x32_bf16 v[12:15], a[148:151], a[12:15], v[12:15]
  ds_read_b64_tr_b16 a[166:167], v41 offset:10240
  buffer_load_dwordx4 a[52:55], v49, s[4:7], s93 offen offset:2048 sc1
  v_mfma_f32_16x16x32_bf16 v[8:11], a[148:151], a[8:11], v[8:11]
  ds_read_b64_tr_b16 a[180:181], v41 offset:12288
  v_mfma_f32_16x16x32_bf16 v[8:11], a[132:135], a[0:3], v[8:11]
  ds_read_b64_tr_b16 a[182:183], v41 offset:14336
  s_waitcnt lgkmcnt(8)
  v_mfma_f32_16x16x32_bf16 v[16:19], a[136:139], a[0:3], v[16:19]
  ds_read_b64_tr_b16 a[168:169], v42 offset:8192
  v_mfma_f32_16x16x32_bf16 v[16:19], a[152:155], a[8:11], v[16:19]
  ds_read_b64_tr_b16 a[170:171], v42 offset:10240
  buffer_load_dwordx4 a[56:59], v48, s[4:7], s93 offen offset:3072 sc1
  v_mfma_f32_16x16x32_bf16 v[20:23], a[152:155], a[12:15], v[20:23]
  ds_read_b64_tr_b16 a[184:185], v42 offset:12288
  v_mfma_f32_16x16x32_bf16 v[20:23], a[136:139], a[4:7], v[20:23]
  ds_read_b64_tr_b16 a[186:187], v42 offset:14336
  v_mfma_f32_16x16x32_bf16 v[28:31], a[140:143], a[4:7], v[28:31]
  ds_read_b64_tr_b16 a[172:173], v43 offset:8192
  v_mfma_f32_16x16x32_bf16 v[28:31], a[156:159], a[12:15], v[28:31]
  ds_read_b64_tr_b16 a[174:175], v43 offset:10240
  buffer_load_dwordx4 a[60:63], v49, s[4:7], s93 offen offset:3072 sc1
  v_mfma_f32_16x16x32_bf16 v[24:27], a[156:159], a[8:11], v[24:27]
  ds_read_b64_tr_b16 a[188:189], v43 offset:12288
  v_mfma_f32_16x16x32_bf16 v[24:27], a[140:143], a[0:3], v[24:27]
  ds_read_b64_tr_b16 a[190:191], v43 offset:14336
  s_waitcnt vmcnt(8) lgkmcnt(8)
  v_mfma_f32_16x16x32_bf16 v[0:3], a[160:163], a[16:19], v[0:3]
  ds_read_b64_tr_b16 a[128:129], v40 offset:16384
  v_mfma_f32_16x16x32_bf16 v[0:3], a[176:179], a[24:27], v[0:3]
  s_add_u32 s57, s57, 4096
  s_xor_b32 s93, s57, s88
  ds_read_b64_tr_b16 a[130:131], v40 offset:18432
  buffer_load_dwordx4 a[0:3], v48, s[4:7], s93 offen offset:0 sc1
  v_mfma_f32_16x16x32_bf16 v[4:7], a[176:179], a[28:31], v[4:7]
  ds_read_b64_tr_b16 a[144:145], v40 offset:20480
  v_mfma_f32_16x16x32_bf16 v[4:7], a[160:163], a[20:23], v[4:7]
  ds_read_b64_tr_b16 a[146:147], v40 offset:22528
  v_mfma_f32_16x16x32_bf16 v[12:15], a[164:167], a[20:23], v[12:15]
  ds_read_b64_tr_b16 a[132:133], v41 offset:16384
  v_mfma_f32_16x16x32_bf16 v[12:15], a[180:183], a[28:31], v[12:15]
  ds_read_b64_tr_b16 a[134:135], v41 offset:18432
  buffer_load_dwordx4 a[4:7], v49, s[4:7], s93 offen offset:0 sc1
  v_mfma_f32_16x16x32_bf16 v[8:11], a[180:183], a[24:27], v[8:11]
  ds_read_b64_tr_b16 a[148:149], v41 offset:20480
  v_mfma_f32_16x16x32_bf16 v[8:11], a[164:167], a[16:19], v[8:11]
  ds_read_b64_tr_b16 a[150:151], v41 offset:22528
  s_waitcnt lgkmcnt(8)
  v_mfma_f32_16x16x32_bf16 v[16:19], a[168:171], a[16:19], v[16:19]
  ds_read_b64_tr_b16 a[136:137], v42 offset:16384
  v_mfma_f32_16x16x32_bf16 v[16:19], a[184:187], a[24:27], v[16:19]
  ds_read_b64_tr_b16 a[138:139], v42 offset:18432
  buffer_load_dwordx4 a[8:11], v48, s[4:7], s93 offen offset:1024 sc1
  v_mfma_f32_16x16x32_bf16 v[20:23], a[184:187], a[28:31], v[20:23]
  ds_read_b64_tr_b16 a[152:153], v42 offset:20480
  v_mfma_f32_16x16x32_bf16 v[20:23], a[168:171], a[20:23], v[20:23]
  ds_read_b64_tr_b16 a[154:155], v42 offset:22528
  v_mfma_f32_16x16x32_bf16 v[28:31], a[172:175], a[20:23], v[28:31]
  ds_read_b64_tr_b16 a[140:141], v43 offset:16384
  v_mfma_f32_16x16x32_bf16 v[28:31], a[188:191], a[28:31], v[28:31]
  ds_read_b64_tr_b16 a[142:143], v43 offset:18432
  buffer_load_dwordx4 a[12:15], v49, s[4:7], s93 offen offset:1024 sc1
  v_mfma_f32_16x16x32_bf16 v[24:27], a[188:191], a[24:27], v[24:27]
  ds_read_b64_tr_b16 a[156:157], v43 offset:20480
  v_mfma_f32_16x16x32_bf16 v[24:27], a[172:175], a[16:19], v[24:27]
  ds_read_b64_tr_b16 a[158:159], v43 offset:22528
  s_waitcnt vmcnt(8) lgkmcnt(8)
  v_mfma_f32_16x16x32_bf16 v[0:3], a[128:131], a[32:35], v[0:3]
  ds_read_b64_tr_b16 a[160:161], v40 offset:24576
  v_mfma_f32_16x16x32_bf16 v[0:3], a[144:147], a[40:43], v[0:3]
  ds_read_b64_tr_b16 a[162:163], v40 offset:26624
  buffer_load_dwordx4 a[16:19], v48, s[4:7], s93 offen offset:2048 sc1
  v_mfma_f32_16x16x32_bf16 v[4:7], a[144:147], a[44:47], v[4:7]
  ds_read_b64_tr_b16 a[176:177], v40 offset:28672
  v_mfma_f32_16x16x32_bf16 v[4:7], a[128:131], a[36:39], v[4:7]
  ds_read_b64_tr_b16 a[178:179], v40 offset:30720
  v_add_u32 v40, 32768, v40
  v_mfma_f32_16x16x32_bf16 v[12:15], a[132:135], a[36:39], v[12:15]
  ds_read_b64_tr_b16 a[164:165], v41 offset:24576
  v_mfma_f32_16x16x32_bf16 v[12:15], a[148:151], a[44:47], v[12:15]
  ds_read_b64_tr_b16 a[166:167], v41 offset:26624
  buffer_load_dwordx4 a[20:23], v49, s[4:7], s93 offen offset:2048 sc1
  v_mfma_f32_16x16x32_bf16 v[8:11], a[148:151], a[40:43], v[8:11]
  ds_read_b64_tr_b16 a[180:181], v41 offset:28672
  v_mfma_f32_16x16x32_bf16 v[8:11], a[132:135], a[32:35], v[8:11]
  s_waitcnt lgkmcnt(7)
  ds_read_b64_tr_b16 a[182:183], v41 offset:30720
  v_add_u32 v41, 32768, v41
  v_mfma_f32_16x16x32_bf16 v[16:19], a[136:139], a[32:35], v[16:19]
  ds_read_b64_tr_b16 a[168:169], v42 offset:24576
  v_mfma_f32_16x16x32_bf16 v[16:19], a[152:155], a[40:43], v[16:19]
  ds_read_b64_tr_b16 a[170:171], v42 offset:26624
  buffer_load_dwordx4 a[24:27], v48, s[4:7], s93 offen offset:3072 sc1
  v_mfma_f32_16x16x32_bf16 v[20:23], a[152:155], a[44:47], v[20:23]
  ds_read_b64_tr_b16 a[184:185], v42 offset:28672
  v_mfma_f32_16x16x32_bf16 v[20:23], a[136:139], a[36:39], v[20:23]
  ds_read_b64_tr_b16 a[186:187], v42 offset:30720
  v_add_u32 v42, 32768, v42
  v_mfma_f32_16x16x32_bf16 v[28:31], a[140:143], a[36:39], v[28:31]
  ds_read_b64_tr_b16 a[172:173], v43 offset:24576
  v_mfma_f32_16x16x32_bf16 v[28:31], a[156:159], a[44:47], v[28:31]
  ds_read_b64_tr_b16 a[174:175], v43 offset:26624
  buffer_load_dwordx4 a[28:31], v49, s[4:7], s93 offen offset:3072 sc1
  v_mfma_f32_16x16x32_bf16 v[24:27], a[156:159], a[40:43], v[24:27]
  ds_read_b64_tr_b16 a[188:189], v43 offset:28672
  v_mfma_f32_16x16x32_bf16 v[24:27], a[140:143], a[32:35], v[24:27]
  s_waitcnt vmcnt(8) lgkmcnt(7)
  ds_read_b64_tr_b16 a[190:191], v43 offset:30720
  v_add_u32 v43, 32768, v43
  v_mfma_f32_16x16x32_bf16 v[0:3], a[160:163], a[48:51], v[0:3]
  ds_read_b64_tr_b16 a[128:129], v40 offset:0
  v_mfma_f32_16x16x32_bf16 v[0:3], a[176:179], a[56:59], v[0:3]
  s_add_u32 s57, s57, 4096
  s_xor_b32 s93, s57, s88
  ds_read_b64_tr_b16 a[130:131], v40 offset:2048
  buffer_load_dwordx4 a[32:35], v48, s[4:7], s93 offen offset:0 sc1
  v_mfma_f32_16x16x32_bf16 v[4:7], a[176:179], a[60:63], v[4:7]
  ds_read_b64_tr_b16 a[144:145], v40 offset:4096
  v_mfma_f32_16x16x32_bf16 v[4:7], a[160:163], a[52:55], v[4:7]
  ds_read_b64_tr_b16 a[146:147], v40 offset:6144
  v_mfma_f32_16x16x32_bf16 v[12:15], a[164:167], a[52:55], v[12:15]
  ds_read_b64_tr_b16 a[132:133], v41 offset:0
  v_mfma_f32_16x16x32_bf16 v[12:15], a[180:183], a[60:63], v[12:15]
  ds_read_b64_tr_b16 a[134:135], v41 offset:2048
  buffer_load_dwordx4 a[36:39], v49, s[4:7], s93 offen offset:0 sc1
  v_mfma_f32_16x16x32_bf16 v[8:11], a[180:183], a[56:59], v[8:11]
  ds_read_b64_tr_b16 a[148:149], v41 offset:4096
  v_mfma_f32_16x16x32_bf16 v[8:11], a[164:167], a[48:51], v[8:11]
  ds_read_b64_tr_b16 a[150:151], v41 offset:6144
  s_waitcnt lgkmcnt(8)
  v_mfma_f32_16x16x32_bf16 v[16:19], a[168:171], a[48:51], v[16:19]
  ds_read_b64_tr_b16 a[136:137], v42 offset:0
  v_mfma_f32_16x16x32_bf16 v[16:19], a[184:187], a[56:59], v[16:19]
  ds_read_b64_tr_b16 a[138:139], v42 offset:2048
  buffer_load_dwordx4 a[40:43], v48, s[4:7], s93 offen offset:1024 sc1
  v_mfma_f32_16x16x32_bf16 v[20:23], a[184:187], a[60:63], v[20:23]
  ds_read_b64_tr_b16 a[152:153], v42 offset:4096
  v_mfma_f32_16x16x32_bf16 v[20:23], a[168:171], a[52:55], v[20:23]
  ds_read_b64_tr_b16 a[154:155], v42 offset:6144
  v_mfma_f32_16x16x32_bf16 v[28:31], a[172:175], a[52:55], v[28:31]
  ds_read_b64_tr_b16 a[140:141], v43 offset:0
  v_mfma_f32_16x16x32_bf16 v[28:31], a[188:191], a[60:63], v[28:31]
  ds_read_b64_tr_b16 a[142:143], v43 offset:2048
  buffer_load_dwordx4 a[44:47], v49, s[4:7], s93 offen offset:1024 sc1
  v_mfma_f32_16x16x32_bf16 v[24:27], a[188:191], a[56:59], v[24:27]
  ds_read_b64_tr_b16 a[156:157], v43 offset:4096
  v_mfma_f32_16x16x32_bf16 v[24:27], a[172:175], a[48:51], v[24:27]
  s_sub_u32 s56, s56, 1
  ds_read_b64_tr_b16 a[158:159], v43 offset:6144
  s_cmp_lg_u32 s56, 0
  s_cbranch_scc1 Lp2_loop
Lmk_Lp2_loop_tail:
  s_waitcnt vmcnt(8) lgkmcnt(8)
  v_mfma_f32_16x16x32_bf16 v[0:3], a[128:131], a[0:3], v[0:3]
  ds_read_b64_tr_b16 a[160:161], v40 offset:8192
  v_mfma_f32_16x16x32_bf16 v[0:3], a[144:147], a[8:11], v[0:3]
  ds_read_b64_tr_b16 a[162:163], v40 offset:10240
  buffer_load_dwordx4 a[48:51], v48, s[4:7], s93 offen offset:2048 sc1
  v_mfma_f32_16x16x32_bf16 v[4:7], a[144:147], a[12:15], v[4:7]
  ds_read_b64_tr_b16 a[176:177], v40 offset:12288
  v_mfma_f32_16x16x32_bf16 v[4:7], a[128:131], a[4:7], v[4:7]
  ds_read_b64_tr_b16 a[178:179], v40 offset:14336
  v_mfma_f32_16x16x32_bf16 v[12:15], a[132:135], a[4:7], v[12:15]
  ds_read_b64_tr_b16 a[164:165], v41 offset:8192
  v_mfma_f32_16x16x32_bf16 v[12:15], a[148:151], a[12:15], v[12:15]
  ds_read_b64_tr_b16 a[166:167], v41 offset:10240
  buffer_load_dwordx4 a[52:55], v49, s[4:7], s93 offen offset:2048 sc1
  v_mfma_f32_16x16x32_bf16 v[8:11], a[148:151], a[8:11], v[8:11]
  ds_read_b64_tr_b16 a[180:181], v41 offset:12288
  v_mfma_f32_16x16x32_bf16 v[8:11], a[132:135], a[0:3], v[8:11]
  ds_read_b64_tr_b16 a[182:183], v41 offset:14336
  s_waitcnt lgkmcnt(8)
  v_mfma_f32_16x16x32_bf16 v[16:19], a[136:139], a[0:3], v[16:19]
  ds_read_b64_tr_b16 a[168:169], v42 offset:8192
  v_mfma_f32_16x16x32_bf16 v[16:19], a[152:155], a[8:11], v[16:19]
  ds_read_b64_tr_b16 a[170:171], v42 offset:10240
  buffer_load_dwordx4 a[56:59], v48, s[4:7], s93 offen offset:3072 sc1
  v_mfma_f32_16x16x32_bf16 v[20:23], a[152:155], a[12:15], v[20:23]
  ds_read_b64_tr_b16 a[184:185], v42 offset:12288
  v_mfma_f32_16x16x32_bf16 v[20:23], a[136:139], a[4:7], v[20:23]
  ds_read_b64_tr_b16 a[186:187], v42 offset:14336
  v_mfma_f32_16x16x32_bf16 v[28:31], a[140:143], a[4:7], v[28:31]
  ds_read_b64_tr_b16 a[172:173], v43 offset:8192
  v_mfma_f32_16x16x32_bf16 v[28:31], a[156:159], a[12:15], v[28:31]
  ds_read_b64_tr_b16 a[174:175], v43 offset:10240
  buffer_load_dwordx4 a[60:63], v49, s[4:7], s93 offen offset:3072 sc1
  v_mfma_f32_16x16x32_bf16 v[24:27], a[156:159], a[8:11], v[24:27]
  ds_read_b64_tr_b16 a[188:189], v43 offset:12288
  v_mfma_f32_16x16x32_bf16 v[24:27], a[140:143], a[0:3], v[24:27]
  ds_read_b64_tr_b16 a[190:191], v43 offset:14336
  s_waitcnt vmcnt(8) lgkmcnt(8)
  v_mfma_f32_16x16x32_bf16 v[0:3], a[160:163], a[16:19], v[0:3]
  ds_read_b64_tr_b16 a[128:129], v40 offset:16384
  v_mfma_f32_16x16x32_bf16 v[0:3], a[176:179], a[24:27], v[0:3]
  ds_read_b64_tr_b16 a[130:131], v40 offset:18432
  v_mfma_f32_16x16x32_bf16 v[4:7], a[176:179], a[28:31], v[4:7]
  ds_read_b64_tr_b16 a[144:145], v40 offset:20480
  v_mfma_f32_16x16x32_bf16 v[4:7], a[160:163], a[20:23], v[4:7]
  ds_read_b64_tr_b16 a[146:147], v40 offset:22528
  v_mfma_f32_16x16x32_bf16 v[12:15], a[164:167], a[20:23], v[12:15]
  ds_read_b64_tr_b16 a[132:133], v41 offset:16384
  v_mfma_f32_16x16x32_bf16 v[12:15], a[180:183], a[28:31], v[12:15]
  ds_read_b64_tr_b16 a[134:135], v41 offset:18432
  v_mfma_f32_16x16x32_bf16 v[8:11], a[180:183], a[24:27], v[8:11]
  ds_read_b64_tr_b16 a[148:149], v41 offset:20480
  v_mfma_f32_16x16x32_bf16 v[8:11], a[164:167], a[16:19], v[8:11]
  ds_read_b64_tr_b16 a[150:151], v41 offset:22528
  s_waitcnt lgkmcnt(8)
  v_mfma_f32_16x16x32_bf16 v[16:19], a[168:171], a[16:19], v[16:19]
  ds_read_b64_tr_b16 a[136:137], v42 offset:16384
  v_mfma_f32_16x16x32_bf16 v[16:19], a[184:187], a[24:27], v[16:19]
  ds_read_b64_tr_b16 a[138:139], v42 offset:18432
  v_mfma_f32_16x16x32_bf16 v[20:23], a[184:187], a[28:31], v[20:23]
  ds_read_b64_tr_b16 a[152:153], v42 offset:20480
  v_mfma_f32_16x16x32_bf16 v[20:23], a[168:171], a[20:23], v[20:23]
  ds_read_b64_tr_b16 a[154:155], v42 offset:22528
  v_mfma_f32_16x16x32_bf16 v[28:31], a[172:175], a[20:23], v[28:31]
  ds_read_b64_tr_b16 a[140:141], v43 offset:16384
  v_mfma_f32_16x16x32_bf16 v[28:31], a[188:191], a[28:31], v[28:31]
  ds_read_b64_tr_b16 a[142:143], v43 offset:18432
  v_mfma_f32_16x16x32_bf16 v[24:27], a[188:191], a[24:27], v[24:27]
  ds_read_b64_tr_b16 a[156:157], v43 offset:20480
  v_mfma_f32_16x16x32_bf16 v[24:27], a[172:175], a[16:19], v[24:27]
  ds_read_b64_tr_b16 a[158:159], v43 offset:22528
  s_waitcnt vmcnt(4) lgkmcnt(8)
  v_mfma_f32_16x16x32_bf16 v[0:3], a[128:131], a[32:35], v[0:3]
  ds_read_b64_tr_b16 a[160:161], v40 offset:24576
  v_mfma_f32_16x16x32_bf16 v[0:3], a[144:147], a[40:43], v[0:3]
  ds_read_b64_tr_b16 a[162:163], v40 offset:26624
  v_mfma_f32_16x16x32_bf16 v[4:7], a[144:147], a[44:47], v[4:7]
  ds_read_b64_tr_b16 a[176:177], v40 offset:28672
  v_mfma_f32_16x16x32_bf16 v[4:7], a[128:131], a[36:39], v[4:7]
  ds_read_b64_tr_b16 a[178:179], v40 offset:30720
  v_add_u32 v40, 32768, v40
  v_mfma_f32_16x16x32_bf16 v[12:15], a[132:135], a[36:39], v[12:15]
  ds_read_b64_tr_b16 a[164:165], v41 offset:24576
  v_mfma_f32_16x16x32_bf16 v[12:15], a[148:151], a[44:47], v[12:15]
  ds_read_b64_tr_b16 a[166:167], v41 offset:26624
  v_mfma_f32_16x16x32_bf16 v[8:11], a[148:151], a[40:43], v[8:11]
  ds_read_b64_tr_b16 a[180:181], v41 offset:28672
  v_mfma_f32_16x16x32_bf16 v[8:11], a[132:135], a[32:35], v[8:11]
  s_waitcnt lgkmcnt(7)
  ds_read_b64_tr_b16 a[182:183], v41 offset:30720
  v_add_u32 v41, 32768, v41
  v_mfma_f32_16x16x32_bf16 v[16:19], a[136:139], a[32:35], v[16:19]
  ds_read_b64_tr_b16 a[168:169], v42 offset:24576
  v_mfma_f32_16x16x32_bf16 v[16:19], a[152:155], a[40:43], v[16:19]
  ds_read_b64_tr_b16 a[170:171], v42 offset:26624
  v_mfma_f32_16x16x32_bf16 v[20:23], a[152:155], a[44:47], v[20:23]
  ds_read_b64_tr_b16 a[184:185], v42 offset:28672
  v_mfma_f32_16x16x32_bf16 v[20:23], a[136:139], a[36:39], v[20:23]
  ds_read_b64_tr_b16 a[186:187], v42 offset:30720
  v_add_u32 v42, 32768, v42
  v_mfma_f32_16x16x32_bf16 v[28:31], a[140:143], a[36:39], v[28:31]
  ds_read_b64_tr_b16 a[172:173], v43 offset:24576
  v_mfma_f32_16x16x32_bf16 v[28:31], a[156:159], a[44:47], v[28:31]
  ds_read_b64_tr_b16 a[174:175], v43 offset:26624
  v_mfma_f32_16x16x32_bf16 v[24:27], a[156:159], a[40:43], v[24:27]
  ds_read_b64_tr_b16 a[188:189], v43 offset:28672
  v_mfma_f32_16x16x32_bf16 v[24:27], a[140:143], a[32:35], v[24:27]
  s_waitcnt vmcnt(0) lgkmcnt(7)
  ds_read_b64_tr_b16 a[190:191], v43 offset:30720
  v_add_u32 v43, 32768, v43
  v_mfma_f32_16x16x32_bf16 v[0:3], a[160:163], a[48:51], v[0:3]
  v_mfma_f32_16x16x32_bf16 v[0:3], a[176:179], a[56:59], v[0:3]
  v_mfma_f32_16x16x32_bf16 v[4:7], a[176:179], a[60:63], v[4:7]
  v_mfma_f32_16x16x32_bf16 v[4:7], a[160:163], a[52:55], v[4:7]
  v_mfma_f32_16x16x32_bf16 v[12:15], a[164:167], a[52:55], v[12:15]
  v_mfma_f32_16x16x32_bf16 v[12:15], a[180:183], a[60:63], v[12:15]
  v_mfma_f32_16x16x32_bf16 v[8:11], a[180:183], a[56:59], v[8:11]
  v_mfma_f32_16x16x32_bf16 v[8:11], a[164:167], a[48:51], v[8:11]
  s_waitcnt lgkmcnt(0)
  v_mfma_f32_16x16x32_bf16 v[16:19], a[168:171], a[48:51], v[16:19]
  s_nop 0
  v_mfma_f32_16x16x32_bf16 v[16:19], a[184:187], a[56:59], v[16:19]
  s_nop 0
  v_mfma_f32_16x16x32_bf16 v[20:23], a[184:187], a[60:63], v[20:23]
  s_nop 0
  v_mfma_f32_16x16x32_bf16 v[20:23], a[168:171], a[52:55], v[20:23]
  v_cvt_pk_bf16_f32 v60, v4, v5
  v_cvt_pk_bf16_f32 v61, v6, v7
  v_mfma_f32_16x16x32_bf16 v[28:31], a[172:175], a[52:55], v[28:31]
  v_cvt_pk_bf16_f32 v62, v12, v13
  v_cvt_pk_bf16_f32 v63, v14, v15
  v_mfma_f32_16x16x32_bf16 v[28:31], a[188:191], a[60:63], v[28:31]
  buffer_store_dwordx4 v[60:63], v48, s[4:7], s59 offen offset:0 sc1
  v_cvt_pk_bf16_f32 v52, v0, v1
  v_mfma_f32_16x16x32_bf16 v[24:27], a[188:191], a[56:59], v[24:27]
  v_cvt_pk_bf16_f32 v53, v2, v3
  v_cvt_pk_bf16_f32 v54, v8, v9
  v_mfma_f32_16x16x32_bf16 v[24:27], a[172:175], a[48:51], v[24:27]
  v_cvt_pk_bf16_f32 v55, v10, v11
  buffer_store_dwordx4 v[52:55], v48, s[4:7], s58 offen offset:0 sc1
  v_mfma_f32_16x16x32_bf16 v[88:91], v[60:63], v[60:63], 0
  v_mfma_f32_16x16x32_bf16 v[84:87], v[72:75], v[60:63], 0
  v_mfma_f32_16x16x32_bf16 v[80:83], v[52:55], v[52:55], 0
  v_mfma_f32_16x16x32_bf16 v[76:79], v[72:75], v[52:55], 0
  v_cvt_pk_bf16_f32 v64, v20, v21
  v_cvt_pk_bf16_f32 v65, v22, v23
  v_cvt_pk_bf16_f32 v66, v28, v29
  v_cvt_pk_bf16_f32 v67, v30, v31
  buffer_store_dwordx4 v[64:67], v48, s[4:7], s59 offen offset:1024 sc1
  v_cvt_pk_bf16_f32 v56, v16, v17
  v_cvt_pk_bf16_f32 v57, v18, v19
  v_cvt_pk_bf16_f32 v58, v24, v25
  v_cvt_pk_bf16_f32 v59, v26, v27
  buffer_store_dwordx4 v[56:59], v48, s[4:7], s58 offen offset:1024 sc1
  s_nop 0
  v_mfma_f32_16x16x32_bf16 v[88:91], v[64:67], v[64:67], v[88:91]
  v_mfma_f32_16x16x32_bf16 v[84:87], v[72:75], v[64:67], v[84:87]
  v_mfma_f32_16x16x32_bf16 v[80:83], v[56:59], v[56:59], v[80:83]
  v_mfma_f32_16x16x32_bf16 v[76:79], v[72:75], v[56:59], v[76:79]
  s_nop 5
  v_cndmask_b32 v85, v88, v89, s[64:65]
  v_cndmask_b32 v85, v85, v90, s[66:67]
  v_cndmask_b32 v85, v85, v91, s[68:69]
  buffer_store_dwordx2 v[84:85], v92, s[4:7], s60 offen offset:2048 sc1
  v_cndmask_b32 v77, v80, v81, s[64:65]
  v_cndmask_b32 v77, v77, v82, s[66:67]
  v_cndmask_b32 v77, v77, v83, s[68:69]
  buffer_store_dwordx2 v[76:77], v92, s[4:7], s60 offen offset:0 sc1
  s_and_b32 s66, s55, 1
  v_lshrrev_b32 v2, 4, v253
  v_bfe_u32 v3, v253, 1, 3
  v_and_b32 v4, 1, v253
  v_lshlrev_b32 v4, 4, v4
  v_mul_u32_u24 v5, 7168, v2
  v_add_u32 v5, v5, v4
  s_cmp_eq_u32 s66, 0
  s_cselect_b32 s44, 7, 0
  v_mov_b32 v7, 0x40000000
  v_add_u32 v6, 0, v2
  v_xor_b32 v6, v6, v3
  v_cmp_eq_u32 vcc, s44, v6
  v_lshl_add_u32 v6, v6, 5, v5
  v_add_u32 v6, 0, v6
  v_cndmask_b32 v232, v6, v7, vcc
  v_add_u32 v6, 4, v2
  v_xor_b32 v6, v6, v3
  v_cmp_eq_u32 vcc, s44, v6
  v_lshl_add_u32 v6, v6, 5, v5
  v_add_u32 v6, 27648, v6
  v_cndmask_b32 v233, v6, v7, vcc
  v_add_u32 v6, 0, v2
  v_xor_b32 v6, v6, v3
  v_cmp_eq_u32 vcc, s44, v6
  v_lshl_add_u32 v6, v6, 5, v5
  v_add_u32 v6, 55296, v6
  v_cndmask_b32 v234, v6, v7, vcc
  v_add_u32 v6, 4, v2
  v_xor_b32 v6, v6, v3
  v_cmp_eq_u32 vcc, s44, v6
  v_lshl_add_u32 v6, v6, 5, v5
  v_add_u32 v6, 82944, v6
  v_cndmask_b32 v235, v6, v7, vcc
  s_mul_i32 s67, s55, 224
  s_and_b32 s67, s67, 0xffffffc0
  s_mul_i32 s43, s40, 114688
  s_add_u32 s67, s67, s43
  s_lshl_b32 s68, s40, 12
  v_lshlrev_b32 v231, 4, v253
  s_lshl_b32 s43, s41, 30
  v_or_b32 v236, s43, v231
  s_lshl_b32 s43, s2, 2
  s_add_u32 s43, s43, s40
  s_mul_i32 s70, s43, 7168
  s_lshl_b32 s69, s54, 2
  s_add_u32 s69, s69, s40
  s_lshl_b32 s72, s69, 17
  s_add_u32 s72, s72, s42
  s_add_u32 s72, s72, 4194304
  s_add_u32 s73, s72, 32768
  s_add_u32 s74, s73, 32768
  s_add_u32 s75, s74, 32768
  s_lshl_b32 s71, s40, 11
  s_add_u32 s71, s71, 131072
  v_lshrrev_b32 v2, 2, v253
  v_and_b32 v3, 7, v2
  v_and_b32 v4, 3, v253
  v_lshlrev_b32 v5, 3, v4
  v_lshl_add_u32 v5, v2, 8, v5
  s_lshl_b32 s43, s66, 1
  s_cmp_eq_u32 s66, 0
  s_cselect_b32 s45, 6, 1
  s_add_u32 s46, s43, 0
  v_xor_b32 v6, s46, v3
  v_lshl_add_u32 v224, v6, 5, v5
  s_add_u32 s46, s43, 1
  v_xor_b32 v6, s46, v3
  v_lshl_add_u32 v225, v6, 5, v5
  s_add_u32 s46, s43, 2
  v_xor_b32 v6, s46, v3
  v_lshl_add_u32 v226, v6, 5, v5
  s_add_u32 s46, s43, 3
  v_xor_b32 v6, s46, v3
  v_lshl_add_u32 v227, v6, 5, v5
  s_add_u32 s46, s43, 4
  v_xor_b32 v6, s46, v3
  v_lshl_add_u32 v228, v6, 5, v5
  s_add_u32 s46, s43, 5
  v_xor_b32 v6, s46, v3
  v_lshl_add_u32 v229, v6, 5, v5
  v_xor_b32 v6, s45, v3
  v_lshl_add_u32 v230, v6, 5, v5
  s_mul_i32 s46, s55, 448
  s_add_u32 s46, s46, 27918336
  s_add_u32 s47, s46, 28672
  s_lshr_b32 s48, s55, 3
  s_lshl_b32 s48, s48, 7
  s_add_u32 s48, s48, 27794432
  s_lshl_b32 s44, s69, 13
  s_add_u32 s44, s44, s42
  s_add_u32 s44, s44, 27525120
  s_add_u32 s45, s44, 4096
  s_waitcnt vmcnt(0)
  s_barrier
  s_cmp_lg_u32 s40, 0
  s_cbranch_scc1 Lsig11
  v_mov_b32 v250, 1
  s_mov_b64 exec, 1
  buffer_atomic_add v250, v251, s[4:7], s77 offen sc1
  s_mov_b64 exec, -1
Lsig11:
  s_cmp_eq_u32 s3, 0
  s_cbranch_scc1 Lsd12
  s_bfe_u32 s43, s2, 0x20001
  s_lshl_b32 s43, s43, 7
  s_add_u32 s43, s43, 27794432
  v_mov_b32 v250, 1
  s_mov_b64 exec, 1
  buffer_atomic_add v250, v251, s[4:7], s43 offen sc1
  s_mov_b64 exec, -1
Lsd12:
  s_add_u32 m0, s68, 0
  s_nop 0
  buffer_load_dwordx4 v232, s[16:19], s67 offen offset:0  lds
  buffer_load_dwordx4 v233, s[16:19], s67 offen offset:1024  lds
  buffer_load_dwordx4 v234, s[16:19], s67 offen offset:2048  lds
  buffer_load_dwordx4 v235, s[16:19], s67 offen offset:3072  lds
  s_add_u32 m0, s68, 16384
  s_nop 0
  buffer_load_dwordx4 v232, s[20:23], s67 offen offset:0  lds
  buffer_load_dwordx4 v233, s[20:23], s67 offen offset:1024  lds
  buffer_load_dwordx4 v234, s[20:23], s67 offen offset:2048  lds
  buffer_load_dwordx4 v235, s[20:23], s67 offen offset:3072  lds
  s_add_u32 s67, s67, 458752
  s_add_u32 m0, s68, 32768
  s_nop 0
  buffer_load_dwordx4 v232, s[16:19], s67 offen offset:0  lds
  buffer_load_dwordx4 v233, s[16:19], s67 offen offset:1024  lds
  buffer_load_dwordx4 v234, s[16:19], s67 offen offset:2048  lds
  buffer_load_dwordx4 v235, s[16:19], s67 offen offset:3072  lds
  s_add_u32 m0, s68, 49152
  s_nop 0
  buffer_load_dwordx4 v232, s[20:23], s67 offen offset:0  lds
  buffer_load_dwordx4 v233, s[20:23], s67 offen offset:1024  lds
  buffer_load_dwordx4 v234, s[20:23], s67 offen offset:2048  lds
  buffer_load_dwordx4 v235, s[20:23], s67 offen offset:3072  lds
  s_add_u32 s67, s67, 458752
  s_xor_b32 s68, s68, 0x10000
  s_mul_i32 s77, s54, 512
  s_add_u32 s77, s77, s42
  s_add_u32 s77, s77, 27807744
  v_lshlrev_b32 v249, 7, v253
  s_cmp_lg_u32 s40, 0
  s_cbranch_scc1 Lpdn14
  s_mov_b32 s43, 0x40000
  s_mov_b64 exec, 15
Lpol13:
  buffer_load_dword v250, v249, s[4:7], s77 offen sc1
  s_waitcnt vmcnt(0)
  v_cmp_gt_u32 vcc, 8, v250
  s_cbranch_vccz Lpdn14x
  s_sub_u32 s43, s43, 1
  s_cmp_lg_u32 s43, 0
  s_cbranch_scc1 Lpol13
Lpdn14x:
  s_mov_b64 exec, -1
Lpdn14:
  s_waitcnt vmcnt(0) lgkmcnt(0)
  s_barrier
  buffer_load_dwordx4 a[0:3], v231, s[4:7], s72 offen offset:0 sc1
  buffer_load_dwordx4 a[16:19], v231, s[4:7], s72 offen offset:1024 sc1
  buffer_load_dwordx4 a[4:7], v231, s[4:7], s73 offen offset:0 sc1
  buffer_load_dwordx4 a[20:23], v231, s[4:7], s73 offen offset:1024 sc1
  buffer_load_dwordx4 a[8:11], v231, s[4:7], s74 offen offset:0 sc1
  buffer_load_dwordx4 a[24:27], v231, s[4:7], s74 offen offset:1024 sc1
  buffer_load_dwordx4 a[12:15], v231, s[4:7], s75 offen offset:0 sc1
  buffer_load_dwordx4 a[28:31], v231, s[4:7], s75 offen offset:1024 sc1
  ds_read_b64_tr_b16 a[64:65], v224 offset:0
  ds_read_b64_tr_b16 a[66:67], v224 offset:4096
  ds_read_b64_tr_b16 a[68:69], v224 offset:8192
  ds_read_b64_tr_b16 a[70:71], v224 offset:12288
  ds_read_b64_tr_b16 a[72:73], v224 offset:16384
  ds_read_b64_tr_b16 a[74:75], v224 offset:20480
  ds_read_b64_tr_b16 a[76:77], v224 offset:24576
  ds_read_b64_tr_b16 a[78:79], v224 offset:28672
Lmk_p3s0:
  s_waitcnt vmcnt(6) lgkmcnt(4)
  v_mfma_f32_16x16x32_bf16 v[0:3], a[64:67], a[0:3], 0
  ds_read_b64_tr_b16 a[80:81], v225 offset:0
  v_mfma_f32_16x16x32_bf16 v[0:3], a[68:71], a[16:19], v[0:3]
  s_waitcnt vmcnt(4)
  v_mfma_f32_16x16x32_bf16 v[4:7], a[68:71], a[20:23], 0
  ds_read_b64_tr_b16 a[82:83], v225 offset:4096
  v_mfma_f32_16x16x32_bf16 v[4:7], a[64:67], a[4:7], v[4:7]
  s_waitcnt vmcnt(2)
  v_mfma_f32_16x16x32_bf16 v[8:11], a[64:67], a[8:11], 0
  ds_read_b64_tr_b16 a[84:85], v225 offset:8192
  v_mfma_f32_16x16x32_bf16 v[8:11], a[68:71], a[24:27], v[8:11]
  s_waitcnt vmcnt(0)
  v_mfma_f32_16x16x32_bf16 v[12:15], a[68:71], a[28:31], 0
  ds_read_b64_tr_b16 a[86:87], v225 offset:12288
  v_mfma_f32_16x16x32_bf16 v[12:15], a[64:67], a[12:15], v[12:15]
  s_waitcnt lgkmcnt(4)
  v_mfma_f32_16x16x32_bf16 v[28:31], a[72:75], a[12:15], 0
  ds_read_b64_tr_b16 a[88:89], v225 offset:16384
  v_mfma_f32_16x16x32_bf16 v[28:31], a[76:79], a[28:31], v[28:31]
  buffer_load_dwordx4 a[32:35], v231, s[4:7], s72 offen offset:2048 sc1
  v_mfma_f32_16x16x32_bf16 v[24:27], a[76:79], a[24:27], 0
  ds_read_b64_tr_b16 a[90:91], v225 offset:20480
  v_mfma_f32_16x16x32_bf16 v[24:27], a[72:75], a[8:11], v[24:27]
  v_mfma_f32_16x16x32_bf16 v[20:23], a[72:75], a[4:7], 0
  ds_read_b64_tr_b16 a[92:93], v225 offset:24576
  v_mfma_f32_16x16x32_bf16 v[20:23], a[76:79], a[20:23], v[20:23]
  buffer_load_dwordx4 a[48:51], v231, s[4:7], s72 offen offset:3072 sc1
  v_mfma_f32_16x16x32_bf16 v[16:19], a[76:79], a[16:19], 0
  ds_read_b64_tr_b16 a[94:95], v225 offset:28672
  s_add_u32 s72, s72, 4096
  v_mfma_f32_16x16x32_bf16 v[16:19], a[72:75], a[0:3], v[16:19]
  s_waitcnt lgkmcnt(4)
  v_mfma_f32_16x16x32_bf16 v[32:35], a[80:83], a[0:3], 0
  ds_read_b64_tr_b16 a[64:65], v226 offset:0
  v_mfma_f32_16x16x32_bf16 v[32:35], a[84:87], a[16:19], v[32:35]
  buffer_load_dwordx4 a[36:39], v231, s[4:7], s73 offen offset:2048 sc1
  v_mfma_f32_16x16x32_bf16 v[36:39], a[84:87], a[20:23], 0
  ds_read_b64_tr_b16 a[66:67], v226 offset:4096
  v_mfma_f32_16x16x32_bf16 v[36:39], a[80:83], a[4:7], v[36:39]
  v_mfma_f32_16x16x32_bf16 v[40:43], a[80:83], a[8:11], 0
  ds_read_b64_tr_b16 a[68:69], v226 offset:8192
  v_mfma_f32_16x16x32_bf16 v[40:43], a[84:87], a[24:27], v[40:43]
  buffer_load_dwordx4 a[52:55], v231, s[4:7], s73 offen offset:3072 sc1
  v_mfma_f32_16x16x32_bf16 v[44:47], a[84:87], a[28:31], 0
  ds_read_b64_tr_b16 a[70:71], v226 offset:12288
  s_add_u32 s73, s73, 4096
  v_mfma_f32_16x16x32_bf16 v[44:47], a[80:83], a[12:15], v[44:47]
  s_waitcnt lgkmcnt(4)
  v_mfma_f32_16x16x32_bf16 v[60:63], a[88:91], a[12:15], 0
  ds_read_b64_tr_b16 a[72:73], v226 offset:16384
  v_mfma_f32_16x16x32_bf16 v[60:63], a[92:95], a[28:31], v[60:63]
  buffer_load_dwordx4 a[40:43], v231, s[4:7], s74 offen offset:2048 sc1
  v_mfma_f32_16x16x32_bf16 v[56:59], a[92:95], a[24:27], 0
  ds_read_b64_tr_b16 a[74:75], v226 offset:20480
  v_mfma_f32_16x16x32_bf16 v[56:59], a[88:91], a[8:11], v[56:59]
  v_mfma_f32_16x16x32_bf16 v[52:55], a[88:91], a[4:7], 0
  ds_read_b64_tr_b16 a[76:77], v226 offset:24576
  v_mfma_f32_16x16x32_bf16 v[52:55], a[92:95], a[20:23], v[52:55]
  buffer_load_dwordx4 a[56:59], v231, s[4:7], s74 offen offset:3072 sc1
  v_mfma_f32_16x16x32_bf16 v[48:51], a[92:95], a[16:19], 0
  ds_read_b64_tr_b16 a[78:79], v226 offset:28672
  s_add_u32 s74, s74, 4096
  v_mfma_f32_16x16x32_bf16 v[48:51], a[88:91], a[0:3], v[48:51]
  s_waitcnt lgkmcnt(4)
  v_mfma_f32_16x16x32_bf16 v[64:67], a[64:67], a[0:3], 0
  ds_read_b64_tr_b16 a[80:81], v227 offset:0
  v_mfma_f32_16x16x32_bf16 v[64:67], a[68:71], a[16:19], v[64:67]
  buffer_load_dwordx4 a[44:47], v231, s[4:7], s75 offen offset:2048 sc1
  v_mfma_f32_16x16x32_bf16 v[68:71], a[68:71], a[20:23], 0
  ds_read_b64_tr_b16 a[82:83], v227 offset:4096
  v_mfma_f32_16x16x32_bf16 v[68:71], a[64:67], a[4:7], v[68:71]
  v_mfma_f32_16x16x32_bf16 v[72:75], a[64:67], a[8:11], 0
  ds_read_b64_tr_b16 a[84:85], v227 offset:8192
  v_mfma_f32_16x16x32_bf16 v[72:75], a[68:71], a[24:27], v[72:75]
  buffer_load_dwordx4 a[60:63], v231, s[4:7], s75 offen offset:3072 sc1
  v_mfma_f32_16x16x32_bf16 v[76:79], a[68:71], a[28:31], 0
  ds_read_b64_tr_b16 a[86:87], v227 offset:12288
  s_add_u32 s75, s75, 4096
  v_mfma_f32_16x16x32_bf16 v[76:79], a[64:67], a[12:15], v[76:79]
  s_waitcnt lgkmcnt(4)
  v_mfma_f32_16x16x32_bf16 v[92:95], a[72:75], a[12:15], 0
  ds_read_b64_tr_b16 a[88:89], v227 offset:16384
  s_add_u32 m0, s68, 32768
  v_mfma_f32_16x16x32_bf16 v[92:95], a[76:79], a[28:31], v[92:95]
  buffer_load_dwordx4 v231, s[4:7], s44 offen offset:0 sc1 lds
  v_mfma_f32_16x16x32_bf16 v[88:91], a[76:79], a[24:27], 0
  ds_read_b64_tr_b16 a[90:91], v227 offset:20480
  v_mfma_f32_16x16x32_bf16 v[88:91], a[72:75], a[8:11], v[88:91]
  v_mfma_f32_16x16x32_bf16 v[84:87], a[72:75], a[4:7], 0
  ds_read_b64_tr_b16 a[92:93], v227 offset:24576
  v_mfma_f32_16x16x32_bf16 v[84:87], a[76:79], a[20:23], v[84:87]
  buffer_load_dwordx4 v231, s[4:7], s44 offen offset:1024 sc1 lds
  v_mfma_f32_16x16x32_bf16 v[80:83], a[76:79], a[16:19], 0
  ds_read_b64_tr_b16 a[94:95], v227 offset:28672
  v_mfma_f32_16x16x32_bf16 v[80:83], a[72:75], a[0:3], v[80:83]
  s_waitcnt lgkmcnt(4)
  v_mfma_f32_16x16x32_bf16 v[96:99], a[80:83], a[0:3], 0
  ds_read_b64_tr_b16 a[64:65], v228 offset:0
  v_mfma_f32_16x16x32_bf16 v[96:99], a[84:87], a[16:19], v[96:99]
  buffer_load_dwordx4 v231, s[4:7], s44 offen offset:2048 sc1 lds
  v_mfma_f32_16x16x32_bf16 v[100:103], a[84:87], a[20:23], 0
  ds_read_b64_tr_b16 a[66:67], v228 offset:4096
  v_mfma_f32_16x16x32_bf16 v[100:103], a[80:83], a[4:7], v[100:103]
  v_mfma_f32_16x16x32_bf16 v[104:107], a[80:83], a[8:11], 0
  ds_read_b64_tr_b16 a[68:69], v228 offset:8192
  v_mfma_f32_16x16x32_bf16 v[104:107], a[84:87], a[24:27], v[104:107]
  buffer_load_dwordx4 v231, s[4:7], s44 offen offset:3072 sc1 lds
  v_mfma_f32_16x16x32_bf16 v[108:111], a[84:87], a[28:31], 0
  ds_read_b64_tr_b16 a[70:71], v228 offset:12288
  v_mfma_f32_16x16x32_bf16 v[108:111], a[80:83], a[12:15], v[108:111]
  s_waitcnt lgkmcnt(4)
  v_mfma_f32_16x16x32_bf16 v[124:127], a[88:91], a[12:15], 0
  ds_read_b64_tr_b16 a[72:73], v228 offset:16384
  s_add_u32 m0, s68, 49152
  v_mfma_f32_16x16x32_bf16 v[124:127], a[92:95], a[28:31], v[124:127]
  buffer_load_dwordx4 v231, s[4:7], s45 offen offset:0 sc1 lds
  v_mfma_f32_16x16x32_bf16 v[120:123], a[92:95], a[24:27], 0
  ds_read_b64_tr_b16 a[74:75], v228 offset:20480
  v_mfma_f32_16x16x32_bf16 v[120:123], a[88:91], a[8:11], v[120:123]
  v_mfma_f32_16x16x32_bf16 v[116:119], a[88:91], a[4:7], 0
  ds_read_b64_tr_b16 a[76:77], v228 offset:24576
  v_mfma_f32_16x16x32_bf16 v[116:119], a[92:95], a[20:23], v[116:119]
  buffer_load_dwordx4 v231, s[4:7], s45 offen offset:1024 sc1 lds
  v_mfma_f32_16x16x32_bf16 v[112:115], a[92:95], a[16:19], 0
  ds_read_b64_tr_b16 a[78:79], v228 offset:28672
  v_mfma_f32_16x16x32_bf16 v[112:115], a[88:91], a[0:3], v[112:115]
  s_waitcnt lgkmcnt(4)
  v_mfma_f32_16x16x32_bf16 v[128:131], a[64:67], a[0:3], 0
  ds_read_b64_tr_b16 a[80:81], v229 offset:0
  v_mfma_f32_16x16x32_bf16 v[128:131], a[68:71], a[16:19], v[128:131]
  buffer_load_dwordx4 v231, s[4:7], s45 offen offset:2048 sc1 lds
  v_mfma_f32_16x16x32_bf16 v[132:135], a[68:71], a[20:23], 0
  ds_read_b64_tr_b16 a[82:83], v229 offset:4096
  v_mfma_f32_16x16x32_bf16 v[132:135], a[64:67], a[4:7], v[132:135]
  v_mfma_f32_16x16x32_bf16 v[136:139], a[64:67], a[8:11], 0
  ds_read_b64_tr_b16 a[84:85], v229 offset:8192
  v_mfma_f32_16x16x32_bf16 v[136:139], a[68:71], a[24:27], v[136:139]
  buffer_load_dwordx4 v231, s[4:7], s45 offen offset:3072 sc1 lds
  v_mfma_f32_16x16x32_bf16 v[140:143], a[68:71], a[28:31], 0
  ds_read_b64_tr_b16 a[86:87], v229 offset:12288
  v_mfma_f32_16x16x32_bf16 v[140:143], a[64:67], a[12:15], v[140:143]
  s_waitcnt lgkmcnt(4)
  v_mfma_f32_16x16x32_bf16 v[156:159], a[72:75], a[12:15], 0
  ds_read_b64_tr_b16 a[88:89], v229 offset:16384
  v_mfma_f32_16x16x32_bf16 v[156:159], a[76:79], a[28:31], v[156:159]
  v_mfma_f32_16x16x32_bf16 v[152:155], a[76:79], a[24:27], 0
  ds_read_b64_tr_b16 a[90:91], v229 offset:20480
  s_add_u32 m0, s68, 0
  v_mfma_f32_16x16x32_bf16 v[152:155], a[72:75], a[8:11], v[152:155]
  buffer_load_dwordx4 v232, s[16:19], s67 offen offset:0  lds
  v_mfma_f32_16x16x32_bf16 v[148:151], a[72:75], a[4:7], 0
  ds_read_b64_tr_b16 a[92:93], v229 offset:24576
  v_mfma_f32_16x16x32_bf16 v[148:151], a[76:79], a[20:23], v[148:151]
  v_mfma_f32_16x16x32_bf16 v[144:147], a[76:79], a[16:19], 0
  ds_read_b64_tr_b16 a[94:95], v229 offset:28672
  v_mfma_f32_16x16x32_bf16 v[144:147], a[72:75], a[0:3], v[144:147]
  buffer_load_dwordx4 v233, s[16:19], s67 offen offset:1024  lds
  s_waitcnt lgkmcnt(4)
  v_mfma_f32_16x16x32_bf16 v[160:163], a[80:83], a[0:3], 0
  ds_read_b64_tr_b16 a[64:65], v230 offset:0
  v_mfma_f32_16x16x32_bf16 v[160:163], a[84:87], a[16:19], v[160:163]
  v_mfma_f32_16x16x32_bf16 v[164:167], a[84:87], a[20:23], 0
  ds_read_b64_tr_b16 a[66:67], v230 offset:4096
  v_mfma_f32_16x16x32_bf16 v[164:167], a[80:83], a[4:7], v[164:167]
  buffer_load_dwordx4 v234, s[16:19], s67 offen offset:2048  lds
  v_mfma_f32_16x16x32_bf16 v[168:171], a[80:83], a[8:11], 0
  ds_read_b64_tr_b16 a[68:69], v230 offset:8192
  v_mfma_f32_16x16x32_bf16 v[168:171], a[84:87], a[24:27], v[168:171]
  v_mfma_f32_16x16x32_bf16 v[172:175], a[84:87], a[28:31], 0
  ds_read_b64_tr_b16 a[70:71], v230 offset:12288
  v_mfma_f32_16x16x32_bf16 v[172:175], a[80:83], a[12:15], v[172:175]
  buffer_load_dwordx4 v235, s[16:19], s67 offen offset:3072  lds
  s_waitcnt lgkmcnt(4)
  v_mfma_f32_16x16x32_bf16 v[188:191], a[88:91], a[12:15], 0
  ds_read_b64_tr_b16 a[72:73], v230 offset:16384
  v_mfma_f32_16x16x32_bf16 v[188:191], a[92:95], a[28:31], v[188:191]
  v_mfma_f32_16x16x32_bf16 v[184:187], a[92:95], a[24:27], 0
  ds_read_b64_tr_b16 a[74:75], v230 offset:20480
  s_add_u32 m0, s68, 16384
  v_mfma_f32_16x16x32_bf16 v[184:187], a[88:91], a[8:11], v[184:187]
  buffer_load_dwordx4 v232, s[20:23], s67 offen offset:0  lds
  v_mfma_f32_16x16x32_bf16 v[180:183], a[88:91], a[4:7], 0
  ds_read_b64_tr_b16 a[76:77], v230 offset:24576
  v_mfma_f32_16x16x32_bf16 v[180:183], a[92:95], a[20:23], v[180:183]
  v_mfma_f32_16x16x32_bf16 v[176:179], a[92:95], a[16:19], 0
  ds_read_b64_tr_b16 a[78:79], v230 offset:28672
  v_mfma_f32_16x16x32_bf16 v[176:179], a[88:91], a[0:3], v[176:179]
  buffer_load_dwordx4 v233, s[20:23], s67 offen offset:1024  lds
  s_waitcnt lgkmcnt(4)
  v_mfma_f32_16x16x32_bf16 v[192:195], a[64:67], a[0:3], 0
  s_barrier
  ds_read_b64_tr_b16 a[80:81], v224 offset:32768
  v_mfma_f32_16x16x32_bf16 v[192:195], a[68:71], a[16:19], v[192:195]
  v_mfma_f32_16x16x32_bf16 v[196:199], a[68:71], a[20:23], 0
  ds_read_b64_tr_b16 a[82:83], v224 offset:36864
  v_mfma_f32_16x16x32_bf16 v[196:199], a[64:67], a[4:7], v[196:199]
  buffer_load_dwordx4 v234, s[20:23], s67 offen offset:2048  lds
  v_mfma_f32_16x16x32_bf16 v[200:203], a[64:67], a[8:11], 0
  ds_read_b64_tr_b16 a[84:85], v224 offset:40960
  v_mfma_f32_16x16x32_bf16 v[200:203], a[68:71], a[24:27], v[200:203]
  v_mfma_f32_16x16x32_bf16 v[204:207], a[68:71], a[28:31], 0
  ds_read_b64_tr_b16 a[86:87], v224 offset:45056
  v_mfma_f32_16x16x32_bf16 v[204:207], a[64:67], a[12:15], v[204:207]
  buffer_load_dwordx4 v235, s[20:23], s67 offen offset:3072  lds
  s_waitcnt lgkmcnt(4)
  v_mfma_f32_16x16x32_bf16 v[220:223], a[72:75], a[12:15], 0
  ds_read_b64_tr_b16 a[88:89], v224 offset:49152
  s_add_u32 s67, s67, 458752
  v_mfma_f32_16x16x32_bf16 v[220:223], a[76:79], a[28:31], v[220:223]
  v_mfma_f32_16x16x32_bf16 v[216:219], a[76:79], a[24:27], 0
  ds_read_b64_tr_b16 a[90:91], v224 offset:53248
  v_mfma_f32_16x16x32_bf16 v[216:219], a[72:75], a[8:11], v[216:219]
  v_mfma_f32_16x16x32_bf16 v[212:215], a[72:75], a[4:7], 0
  ds_read_b64_tr_b16 a[92:93], v224 offset:57344
  buffer_load_dwordx4 a[96:99], v236, s[24:27], s70 offen
  v_mfma_f32_16x16x32_bf16 v[212:215], a[76:79], a[20:23], v[212:215]
  s_add_u32 s70, s70, 1024
  v_mfma_f32_16x16x32_bf16 v[208:211], a[76:79], a[16:19], 0
  ds_read_b64_tr_b16 a[94:95], v224 offset:61440
  v_xor_b32 v224, 0x10000, v224
  v_mfma_f32_16x16x32_bf16 v[208:211], a[72:75], a[0:3], v[208:211]
Lmk_p3s1:
  s_waitcnt vmcnt(17) lgkmcnt(4)
  v_mfma_f32_16x16x32_bf16 v[0:3], a[80:83], a[32:35], v[0:3]
  ds_read_b64_tr_b16 a[64:65], v225 offset:32768
  v_mfma_f32_16x16x32_bf16 v[0:3], a[84:87], a[48:51], v[0:3]
  v_mfma_f32_16x16x32_bf16 v[4:7], a[84:87], a[52:55], v[4:7]
  ds_read_b64_tr_b16 a[66:67], v225 offset:36864
  v_mfma_f32_16x16x32_bf16 v[4:7], a[80:83], a[36:39], v[4:7]
  buffer_load_dwordx4 a[0:3], v231, s[4:7], s72 offen offset:0 sc1
  v_mfma_f32_16x16x32_bf16 v[8:11], a[80:83], a[40:43], v[8:11]
  ds_read_b64_tr_b16 a[68:69], v225 offset:40960
  v_mfma_f32_16x16x32_bf16 v[8:11], a[84:87], a[56:59], v[8:11]
  s_add_u32 s43, s68, 32768
  v_lshlrev_b32 v250, 3, v253
  v_mfma_f32_16x16x32_bf16 v[12:15], a[84:87], a[60:63], v[12:15]
  ds_read_b64_tr_b16 a[70:71], v225 offset:45056
  v_add_u32 v250, s43, v250
  v_mfma_f32_16x16x32_bf16 v[12:15], a[80:83], a[44:47], v[12:15]
  s_waitcnt lgkmcnt(4)
  v_mfma_f32_16x16x32_bf16 v[28:31], a[88:91], a[44:47], v[28:31]
  ds_read_b64_tr_b16 a[72:73], v225 offset:49152
  v_mfma_f32_16x16x32_bf16 v[28:31], a[92:95], a[60:63], v[28:31]
  v_mfma_f32_16x16x32_bf16 v[24:27], a[92:95], a[56:59], v[24:27]
  ds_read_b64_tr_b16 a[74:75], v225 offset:53248
  buffer_load_dwordx4 a[16:19], v231, s[4:7], s72 offen offset:1024 sc1
  v_mfma_f32_16x16x32_bf16 v[24:27], a[88:91], a[40:43], v[24:27]
  v_mfma_f32_16x16x32_bf16 v[20:23], a[88:91], a[36:39], v[20:23]
  ds_read_b64_tr_b16 a[76:77], v225 offset:57344
  v_mfma_f32_16x16x32_bf16 v[20:23], a[92:95], a[52:55], v[20:23]
  s_waitcnt vmcnt(11)
  ds_read_b64 v[238:239], v250 offset:0
  v_mfma_f32_16x16x32_bf16 v[16:19], a[92:95], a[48:51], v[16:19]
  ds_read_b64_tr_b16 a[78:79], v225 offset:61440
  ds_read_b64 v[240:241], v250 offset:2048
  v_xor_b32 v225, 0x10000, v225
  v_mfma_f32_16x16x32_bf16 v[16:19], a[88:91], a[32:35], v[16:19]
  ds_read_b64 v[242:243], v250 offset:16384
  s_waitcnt lgkmcnt(7)
  v_mfma_f32_16x16x32_bf16 v[32:35], a[64:67], a[32:35], v[32:35]
  ds_read_b64_tr_b16 a[80:81], v226 offset:32768
  ds_read_b64 v[244:245], v250 offset:18432
  v_mfma_f32_16x16x32_bf16 v[32:35], a[68:71], a[48:51], v[32:35]
  buffer_load_dwordx4 a[4:7], v231, s[4:7], s73 offen offset:0 sc1
  ds_read_b64 v[246:247], v250 offset:512
  v_mfma_f32_16x16x32_bf16 v[36:39], a[68:71], a[52:55], v[36:39]
  ds_read_b64_tr_b16 a[82:83], v226 offset:36864
  v_mfma_f32_16x16x32_bf16 v[36:39], a[64:67], a[36:39], v[36:39]
  v_mfma_f32_16x16x32_bf16 v[40:43], a[64:67], a[40:43], v[40:43]
  ds_read_b64_tr_b16 a[84:85], v226 offset:40960
  ds_read_b64 v[248:249], v250 offset:2560
  v_mfma_f32_16x16x32_bf16 v[40:43], a[68:71], a[56:59], v[40:43]
  v_mfma_f32_16x16x32_bf16 v[44:47], a[68:71], a[60:63], v[44:47]
  s_waitcnt lgkmcnt(3)
  ds_read_b64_tr_b16 a[86:87], v226 offset:45056
  v_add_f32 v238, v238, v246
  v_add_f32 v239, v239, v247
  v_mfma_f32_16x16x32_bf16 v[44:47], a[64:67], a[44:47], v[44:47]
  ds_read_b64 v[246:247], v250 offset:16896
  v_mfma_f32_16x16x32_bf16 v[60:63], a[72:75], a[44:47], v[60:63]
  ds_read_b64_tr_b16 a[88:89], v226 offset:49152
  buffer_load_dwordx4 a[20:23], v231, s[4:7], s73 offen offset:1024 sc1
  v_mfma_f32_16x16x32_bf16 v[60:63], a[76:79], a[60:63], v[60:63]
  s_waitcnt lgkmcnt(3)
  v_add_f32 v240, v240, v248
  v_add_f32 v241, v241, v249
  v_mfma_f32_16x16x32_bf16 v[56:59], a[76:79], a[56:59], v[56:59]
  ds_read_b64_tr_b16 a[90:91], v226 offset:53248
  ds_read_b64 v[248:249], v250 offset:18944
  v_mfma_f32_16x16x32_bf16 v[56:59], a[72:75], a[40:43], v[56:59]
  v_mfma_f32_16x16x32_bf16 v[52:55], a[72:75], a[36:39], v[52:55]
  s_waitcnt lgkmcnt(3)
  ds_read_b64_tr_b16 a[92:93], v226 offset:57344
  v_add_f32 v242, v242, v246
  v_add_f32 v243, v243, v247
  v_mfma_f32_16x16x32_bf16 v[52:55], a[76:79], a[52:55], v[52:55]
  ds_read_b64 v[246:247], v250 offset:1024
  v_mfma_f32_16x16x32_bf16 v[48:51], a[76:79], a[48:51], v[48:51]
  ds_read_b64_tr_b16 a[94:95], v226 offset:61440
  v_xor_b32 v226, 0x10000, v226
  v_mfma_f32_16x16x32_bf16 v[48:51], a[72:75], a[32:35], v[48:51]
  s_waitcnt lgkmcnt(3)
  buffer_load_dwordx4 a[8:11], v231, s[4:7], s74 offen offset:0 sc1
  v_add_f32 v244, v244, v248
  v_add_f32 v245, v245, v249
  v_mfma_f32_16x16x32_bf16 v[64:67], a[80:83], a[32:35], v[64:67]
  ds_read_b64_tr_b16 a[64:65], v227 offset:32768
  ds_read_b64 v[248:249], v250 offset:3072
  v_mfma_f32_16x16x32_bf16 v[64:67], a[84:87], a[48:51], v[64:67]
  v_mfma_f32_16x16x32_bf16 v[68:71], a[84:87], a[52:55], v[68:71]
  s_waitcnt lgkmcnt(3)
  ds_read_b64_tr_b16 a[66:67], v227 offset:36864
  v_add_f32 v238, v238, v246
  v_add_f32 v239, v239, v247
  v_mfma_f32_16x16x32_bf16 v[68:71], a[80:83], a[36:39], v[68:71]
  ds_read_b64 v[246:247], v250 offset:17408
  v_mfma_f32_16x16x32_bf16 v[72:75], a[80:83], a[40:43], v[72:75]
  ds_read_b64_tr_b16 a[68:69], v227 offset:40960
  v_mfma_f32_16x16x32_bf16 v[72:75], a[84:87], a[56:59], v[72:75]
  s_waitcnt lgkmcnt(3)
  v_add_f32 v240, v240, v248
  v_add_f32 v241, v241, v249
  v_mfma_f32_16x16x32_bf16 v[76:79], a[84:87], a[60:63], v[76:79]
  ds_read_b64_tr_b16 a[70:71], v227 offset:45056
  buffer_load_dwordx4 a[24:27], v231, s[4:7], s74 offen offset:1024 sc1
  ds_read_b64 v[248:249], v250 offset:19456
  v_mfma_f32_16x16x32_bf16 v[76:79], a[80:83], a[44:47], v[76:79]
  v_mfma_f32_16x16x32_bf16 v[92:95], a[88:91], a[44:47], v[92:95]
  s_waitcnt lgkmcnt(3)
  ds_read_b64_tr_b16 a[72:73], v227 offset:49152
  v_add_f32 v242, v242, v246
  v_add_f32 v243, v243, v247
  v_mfma_f32_16x16x32_bf16 v[92:95], a[92:95], a[60:63], v[92:95]
  ds_read_b64 v[246:247], v250 offset:1536
  v_mfma_f32_16x16x32_bf16 v[88:91], a[92:95], a[56:59], v[88:91]
  ds_read_b64_tr_b16 a[74:75], v227 offset:53248
  v_mfma_f32_16x16x32_bf16 v[88:91], a[88:91], a[40:43], v[88:91]
  s_waitcnt lgkmcnt(3)
  v_add_f32 v244, v244, v248
  v_add_f32 v245, v245, v249
  v_mfma_f32_16x16x32_bf16 v[84:87], a[88:91], a[36:39], v[84:87]
  ds_read_b64_tr_b16 a[76:77], v227 offset:57344
  ds_read_b64 v[248:249], v250 offset:3584
  v_mfma_f32_16x16x32_bf16 v[84:87], a[92:95], a[52:55], v[84:87]
  buffer_load_dwordx4 a[12:15], v231, s[4:7], s75 offen offset:0 sc1
  v_mfma_f32_16x16x32_bf16 v[80:83], a[92:95], a[48:51], v[80:83]
  s_waitcnt lgkmcnt(3)
  ds_read_b64_tr_b16 a[78:79], v227 offset:61440
  v_xor_b32 v227, 0x10000, v227
  v_add_f32 v238, v238, v246
  v_add_f32 v239, v239, v247
  v_mfma_f32_16x16x32_bf16 v[80:83], a[88:91], a[32:35], v[80:83]
  ds_read_b64 v[246:247], v250 offset:17920
  buffer_load_dword v237, v251, s[4:7], s48 offen sc1
  v_mfma_f32_16x16x32_bf16 v[96:99], a[64:67], a[32:35], v[96:99]
  ds_read_b64_tr_b16 a[80:81], v228 offset:32768
  v_mfma_f32_16x16x32_bf16 v[96:99], a[68:71], a[48:51], v[96:99]
  s_waitcnt lgkmcnt(3)
  v_add_f32 v240, v240, v248
  v_add_f32 v241, v241, v249
  v_mfma_f32_16x16x32_bf16 v[100:103], a[68:71], a[52:55], v[100:103]
  ds_read_b64_tr_b16 a[82:83], v228 offset:36864
  ds_read_b64 v[248:249], v250 offset:19968
  v_mfma_f32_16x16x32_bf16 v[100:103], a[64:67], a[36:39], v[100:103]
  v_mfma_f32_16x16x32_bf16 v[104:107], a[64:67], a[40:43], v[104:107]
  s_waitcnt lgkmcnt(3)
  ds_read_b64_tr_b16 a[84:85], v228 offset:40960
  buffer_load_dwordx4 a[28:31], v231, s[4:7], s75 offen offset:1024 sc1
  v_add_f32 v242, v242, v246
  v_add_f32 v243, v243, v247
  v_mfma_f32_16x16x32_bf16 v[104:107], a[68:71], a[56:59], v[104:107]
  buffer_load_dwordx4 a[96:99], v236, s[24:27], s70 offen
  v_mfma_f32_16x16x32_bf16 v[108:111], a[68:71], a[60:63], v[108:111]
  ds_read_b64_tr_b16 a[86:87], v228 offset:45056
  s_add_u32 s70, s70, 1024
  v_mfma_f32_16x16x32_bf16 v[108:111], a[64:67], a[44:47], v[108:111]
  s_waitcnt lgkmcnt(2)
  v_add_f32 v244, v244, v248
  v_add_f32 v245, v245, v249
  v_mfma_f32_16x16x32_bf16 v[124:127], a[72:75], a[44:47], v[124:127]
  ds_read_b64_tr_b16 a[88:89], v228 offset:49152
  s_mov_b32 s43, 0x3a800000
  v_mfma_f32_16x16x32_bf16 v[124:127], a[76:79], a[60:63], v[124:127]
  v_mov_b32 v250, 0x3727c5ac
  v_lshlrev_b32 v246, 2, v253
  v_mfma_f32_16x16x32_bf16 v[120:123], a[76:79], a[56:59], v[120:123]
  ds_read_b64_tr_b16 a[90:91], v228 offset:53248
  s_add_u32 m0, s68, 32768
  v_mfma_f32_16x16x32_bf16 v[120:123], a[72:75], a[40:43], v[120:123]
  buffer_load_dwordx4 v232, s[16:19], s67 offen offset:0  lds
  v_add_u32 v246, s71, v246
  v_mfma_f32_16x16x32_bf16 v[116:119], a[72:75], a[36:39], v[116:119]
  ds_read_b64_tr_b16 a[92:93], v228 offset:57344
  v_permlane32_swap_b32 v238, v242
  v_mfma_f32_16x16x32_bf16 v[116:119], a[76:79], a[52:55], v[116:119]
  v_permlane32_swap_b32 v239, v243
  v_permlane32_swap_b32 v240, v244
  v_mfma_f32_16x16x32_bf16 v[112:115], a[76:79], a[48:51], v[112:115]
  ds_read_b64_tr_b16 a[94:95], v228 offset:61440
  v_xor_b32 v228, 0x10000, v228
  v_permlane32_swap_b32 v241, v245
  v_mfma_f32_16x16x32_bf16 v[112:115], a[72:75], a[32:35], v[112:115]
  s_waitcnt lgkmcnt(4)
  v_add_f32 v238, v238, v242
  v_add_f32 v240, v240, v244
  v_mfma_f32_16x16x32_bf16 v[128:131], a[80:83], a[32:35], v[128:131]
  ds_read_b64_tr_b16 a[64:65], v229 offset:32768
  v_add_f32 v239, v239, v243
  v_mfma_f32_16x16x32_bf16 v[128:131], a[84:87], a[48:51], v[128:131]
  v_add_f32 v241, v241, v245
  v_and_b32 v247, 0xffffff3f, v246
  v_mfma_f32_16x16x32_bf16 v[132:135], a[84:87], a[52:55], v[132:135]
  ds_read_b64_tr_b16 a[66:67], v229 offset:36864
  buffer_load_dwordx4 v233, s[16:19], s67 offen offset:1024  lds
  v_mfma_f32_16x16x32_bf16 v[132:135], a[80:83], a[36:39], v[132:135]
  v_permlane16_swap_b32 v238, v240
  v_permlane16_swap_b32 v239, v241
  v_mfma_f32_16x16x32_bf16 v[136:139], a[80:83], a[40:43], v[136:139]
  ds_read_b64_tr_b16 a[68:69], v229 offset:40960
  v_add_f32 v238, v238, v240
  v_mfma_f32_16x16x32_bf16 v[136:139], a[84:87], a[56:59], v[136:139]
  v_add_f32 v239, v239, v241
  v_add_u32 v247, 1024, v247
  v_mfma_f32_16x16x32_bf16 v[140:143], a[84:87], a[60:63], v[140:143]
  ds_read_b64_tr_b16 a[70:71], v229 offset:45056
  v_mul_f32 v238, 0xba800000, v238
  v_mfma_f32_16x16x32_bf16 v[140:143], a[80:83], a[44:47], v[140:143]
  s_waitcnt lgkmcnt(4)
  v_fma_f32 v239, v239, s43, v250
  v_fma_f32 v239, -v238, v238, v239
  v_mfma_f32_16x16x32_bf16 v[156:159], a[88:91], a[44:47], v[156:159]
  ds_read_b64_tr_b16 a[72:73], v229 offset:49152
  v_max_f32 v239, v239, v250
  v_mfma_f32_16x16x32_bf16 v[156:159], a[92:95], a[60:63], v[156:159]
  buffer_load_dwordx4 v234, s[16:19], s67 offen offset:2048  lds
  v_rsq_f32 v240, v239
  v_mfma_f32_16x16x32_bf16 v[152:155], a[92:95], a[56:59], v[152:155]
  ds_read_b64_tr_b16 a[74:75], v229 offset:53248
  ds_write_b32 v246, v238 offset:1024
  v_mfma_f32_16x16x32_bf16 v[152:155], a[88:91], a[40:43], v[152:155]
  ds_write_b32 v246, v239 offset:1536
  v_mul_f32 v240, 0xbfb8aa3b, v240
  v_mfma_f32_16x16x32_bf16 v[148:151], a[88:91], a[36:39], v[148:151]
  ds_read_b64_tr_b16 a[76:77], v229 offset:57344
  ds_write_b32 v246, v240 offset:1280
  v_mfma_f32_16x16x32_bf16 v[148:151], a[92:95], a[52:55], v[148:151]
  ds_read2_b32 v[238:239], v247 offset0:0 offset1:16
  ds_read2_b32 v[240:241], v247 offset0:32 offset1:48
  v_mfma_f32_16x16x32_bf16 v[144:147], a[92:95], a[48:51], v[144:147]
  ds_read_b64_tr_b16 a[78:79], v229 offset:61440
  v_xor_b32 v229, 0x10000, v229
  v_lshrrev_b32 v250, 3, v253
  v_mfma_f32_16x16x32_bf16 v[144:147], a[88:91], a[32:35], v[144:147]
  s_waitcnt lgkmcnt(9)
  v_add_u32 v250, s66, v250
  v_cmp_ne_u32 vcc, 7, v250
  v_mfma_f32_16x16x32_bf16 v[160:163], a[64:67], a[32:35], v[160:163]
  ds_read_b64_tr_b16 a[80:81], v230 offset:32768
  buffer_load_dwordx4 v235, s[16:19], s67 offen offset:3072  lds
  v_mfma_f32_16x16x32_bf16 v[160:163], a[68:71], a[48:51], v[160:163]
  v_bfe_u32 v242, v253, 2, 1
  v_mul_u32_u24 v242, 14336, v242
  v_mfma_f32_16x16x32_bf16 v[164:167], a[68:71], a[52:55], v[164:167]
  ds_read_b64_tr_b16 a[82:83], v230 offset:36864
  v_cndmask_b32 v250, 0, v250, vcc
  v_mfma_f32_16x16x32_bf16 v[164:167], a[64:67], a[36:39], v[164:167]
  v_lshl_add_u32 v250, v250, 6, v242
  v_and_b32 v242, 3, v253
  v_mfma_f32_16x16x32_bf16 v[168:171], a[64:67], a[40:43], v[168:171]
  ds_read_b64_tr_b16 a[84:85], v230 offset:40960
  v_lshl_add_u32 v250, v242, 4, v250
  v_mfma_f32_16x16x32_bf16 v[168:171], a[68:71], a[56:59], v[168:171]
  s_waitcnt vmcnt(6)
  v_cmp_gt_u32 vcc, 56, v237
  s_cbranch_vccz Lcdn16
  s_mov_b32 s43, 0x40000
Lchk15:
  buffer_load_dword v237, v251, s[4:7], s48 offen sc1
  s_waitcnt vmcnt(0)
  v_cmp_gt_u32 vcc, 56, v237
  s_cbranch_vccz Lcdn16
  s_sub_u32 s43, s43, 1
  s_cmp_lg_u32 s43, 0
  s_cbranch_scc1 Lchk15
Lcdn16:
  buffer_load_dwordx4 v[242:245], v250, s[4:7], s46 offen sc1
  v_mfma_f32_16x16x32_bf16 v[172:175], a[68:71], a[60:63], v[172:175]
  ds_read_b64_tr_b16 a[86:87], v230 offset:45056
  s_add_u32 m0, s68, 49152
  v_mfma_f32_16x16x32_bf16 v[172:175], a[64:67], a[44:47], v[172:175]
  s_waitcnt lgkmcnt(4)
  buffer_load_dwordx4 v232, s[20:23], s67 offen offset:0  lds
  buffer_load_dwordx4 v[246:249], v250, s[4:7], s47 offen sc1
  v_mfma_f32_16x16x32_bf16 v[188:191], a[72:75], a[44:47], v[188:191]
  ds_read_b64_tr_b16 a[88:89], v230 offset:49152
  v_lshrrev_b32 v237, 4, v253
  v_mfma_f32_16x16x32_bf16 v[188:191], a[76:79], a[60:63], v[188:191]
  v_lshlrev_b32 v237, 4, v237
  v_add_u32 v237, s71, v237
  v_mfma_f32_16x16x32_bf16 v[184:187], a[76:79], a[56:59], v[184:187]
  ds_read_b64_tr_b16 a[90:91], v230 offset:53248
  v_add_u32 v250, s71, v231
  v_mfma_f32_16x16x32_bf16 v[184:187], a[72:75], a[40:43], v[184:187]
  v_mfma_f32_16x16x32_bf16 v[180:183], a[72:75], a[36:39], v[180:183]
  ds_read_b64_tr_b16 a[92:93], v230 offset:57344
  v_mfma_f32_16x16x32_bf16 v[180:183], a[76:79], a[52:55], v[180:183]
  v_mfma_f32_16x16x32_bf16 v[176:179], a[76:79], a[48:51], v[176:179]
  ds_read_b64_tr_b16 a[94:95], v230 offset:61440
  buffer_load_dwordx4 v233, s[20:23], s67 offen offset:1024  lds
  v_xor_b32 v230, 0x10000, v230
  v_mfma_f32_16x16x32_bf16 v[176:179], a[72:75], a[32:35], v[176:179]
  s_waitcnt lgkmcnt(4)
  v_mfma_f32_16x16x32_bf16 v[192:195], a[80:83], a[32:35], v[192:195]
  s_barrier
  ds_read_b64_tr_b16 a[64:65], v224 offset:0
  v_mfma_f32_16x16x32_bf16 v[192:195], a[84:87], a[48:51], v[192:195]
  v_mfma_f32_16x16x32_bf16 v[196:199], a[84:87], a[52:55], v[196:199]
  ds_read_b64_tr_b16 a[66:67], v224 offset:4096
  v_mfma_f32_16x16x32_bf16 v[196:199], a[80:83], a[36:39], v[196:199]
  v_mfma_f32_16x16x32_bf16 v[200:203], a[80:83], a[40:43], v[200:203]
  ds_read_b64_tr_b16 a[68:69], v224 offset:8192
  v_mfma_f32_16x16x32_bf16 v[200:203], a[84:87], a[56:59], v[200:203]
  buffer_load_dwordx4 v234, s[20:23], s67 offen offset:2048  lds
  v_mfma_f32_16x16x32_bf16 v[204:207], a[84:87], a[60:63], v[204:207]
  ds_read_b64_tr_b16 a[70:71], v224 offset:12288
  v_mfma_f32_16x16x32_bf16 v[204:207], a[80:83], a[44:47], v[204:207]
  s_waitcnt lgkmcnt(4)
  v_mfma_f32_16x16x32_bf16 v[220:223], a[88:91], a[44:47], v[220:223]
  ds_read_b64_tr_b16 a[72:73], v224 offset:16384
  v_mfma_f32_16x16x32_bf16 v[220:223], a[92:95], a[60:63], v[220:223]
  v_mfma_f32_16x16x32_bf16 v[216:219], a[92:95], a[56:59], v[216:219]
  ds_read_b64_tr_b16 a[74:75], v224 offset:20480
  v_mfma_f32_16x16x32_bf16 v[216:219], a[88:91], a[40:43], v[216:219]
  v_mfma_f32_16x16x32_bf16 v[212:215], a[88:91], a[36:39], v[212:215]
  ds_read_b64_tr_b16 a[76:77], v224 offset:24576
  buffer_load_dwordx4 v235, s[20:23], s67 offen offset:3072  lds
  v_mfma_f32_16x16x32_bf16 v[212:215], a[92:95], a[52:55], v[212:215]
  s_add_u32 s67, s67, 458752
  s_xor_b32 s68, s68, 0x10000
  v_mfma_f32_16x16x32_bf16 v[208:211], a[92:95], a[48:51], v[208:211]
  ds_read_b64_tr_b16 a[78:79], v224 offset:28672
  v_mfma_f32_16x16x32_bf16 v[208:211], a[88:91], a[32:35], v[208:211]
  s_mov_b32 s56, 5
.p2align 3
Lp3_loop:
  s_waitcnt vmcnt(8) lgkmcnt(4)
  v_mfma_f32_16x16x32_bf16 v[0:3], a[64:67], a[0:3], v[0:3]
  ds_read_b64_tr_b16 a[80:81], v225 offset:0
  v_mfma_f32_16x16x32_bf16 v[0:3], a[68:71], a[16:19], v[0:3]
  v_mfma_f32_16x16x32_bf16 v[4:7], a[68:71], a[20:23], v[4:7]
  ds_read_b64_tr_b16 a[82:83], v225 offset:4096
  v_mfma_f32_16x16x32_bf16 v[4:7], a[64:67], a[4:7], v[4:7]
  buffer_load_dwordx4 a[32:35], v231, s[4:7], s72 offen offset:2048 sc1
  v_mfma_f32_16x16x32_bf16 v[8:11], a[64:67], a[8:11], v[8:11]
  ds_read_b64_tr_b16 a[84:85], v225 offset:8192
  v_mfma_f32_16x16x32_bf16 v[8:11], a[68:71], a[24:27], v[8:11]
  v_mfma_f32_16x16x32_bf16 v[12:15], a[68:71], a[28:31], v[12:15]
  ds_read_b64_tr_b16 a[86:87], v225 offset:12288
  v_mfma_f32_16x16x32_bf16 v[12:15], a[64:67], a[12:15], v[12:15]
  s_waitcnt lgkmcnt(4)
  v_mfma_f32_16x16x32_bf16 v[28:31], a[72:75], a[12:15], v[28:31]
  ds_read_b64_tr_b16 a[88:89], v225 offset:16384
  v_mfma_f32_16x16x32_bf16 v[28:31], a[76:79], a[28:31], v[28:31]
  v_mfma_f32_16x16x32_bf16 v[24:27], a[76:79], a[24:27], v[24:27]
  ds_read_b64_tr_b16 a[90:91], v225 offset:20480
  buffer_load_dwordx4 a[48:51], v231, s[4:7], s72 offen offset:3072 sc1
  v_mfma_f32_16x16x32_bf16 v[24:27], a[72:75], a[8:11], v[24:27]
  s_add_u32 s72, s72, 4096
  v_mfma_f32_16x16x32_bf16 v[20:23], a[72:75], a[4:7], v[20:23]
  ds_read_b64_tr_b16 a[92:93], v225 offset:24576
  v_mfma_f32_16x16x32_bf16 v[20:23], a[76:79], a[20:23], v[20:23]
  v_mfma_f32_16x16x32_bf16 v[16:19], a[76:79], a[16:19], v[16:19]
  ds_read_b64_tr_b16 a[94:95], v225 offset:28672
  v_mfma_f32_16x16x32_bf16 v[16:19], a[72:75], a[0:3], v[16:19]
  s_waitcnt lgkmcnt(4)
  v_mfma_f32_16x16x32_bf16 v[32:35], a[80:83], a[0:3], v[32:35]
  ds_read_b64_tr_b16 a[64:65], v226 offset:0
  v_mfma_f32_16x16x32_bf16 v[32:35], a[84:87], a[16:19], v[32:35]
  buffer_load_dwordx4 a[36:39], v231, s[4:7], s73 offen offset:2048 sc1
  v_mfma_f32_16x16x32_bf16 v[36:39], a[84:87], a[20:23], v[36:39]
  ds_read_b64_tr_b16 a[66:67], v226 offset:4096
  v_mfma_f32_16x16x32_bf16 v[36:39], a[80:83], a[4:7], v[36:39]
  v_mfma_f32_16x16x32_bf16 v[40:43], a[80:83], a[8:11], v[40:43]
  ds_read_b64_tr_b16 a[68:69], v226 offset:8192
  v_mfma_f32_16x16x32_bf16 v[40:43], a[84:87], a[24:27], v[40:43]
  v_mfma_f32_16x16x32_bf16 v[44:47], a[84:87], a[28:31], v[44:47]
  ds_read_b64_tr_b16 a[70:71], v226 offset:12288
  v_mfma_f32_16x16x32_bf16 v[44:47], a[80:83], a[12:15], v[44:47]
  s_waitcnt lgkmcnt(4)
  v_mfma_f32_16x16x32_bf16 v[60:63], a[88:91], a[12:15], v[60:63]
  ds_read_b64_tr_b16 a[72:73], v226 offset:16384
  buffer_load_dwordx4 a[52:55], v231, s[4:7], s73 offen offset:3072 sc1
  v_mfma_f32_16x16x32_bf16 v[60:63], a[92:95], a[28:31], v[60:63]
  s_add_u32 s73, s73, 4096
  v_mfma_f32_16x16x32_bf16 v[56:59], a[92:95], a[24:27], v[56:59]
  ds_read_b64_tr_b16 a[74:75], v226 offset:20480
  v_mfma_f32_16x16x32_bf16 v[56:59], a[88:91], a[8:11], v[56:59]
  v_mfma_f32_16x16x32_bf16 v[52:55], a[88:91], a[4:7], v[52:55]
  ds_read_b64_tr_b16 a[76:77], v226 offset:24576
  v_mfma_f32_16x16x32_bf16 v[52:55], a[92:95], a[20:23], v[52:55]
  v_mfma_f32_16x16x32_bf16 v[48:51], a[92:95], a[16:19], v[48:51]
  ds_read_b64_tr_b16 a[78:79], v226 offset:28672
  v_mfma_f32_16x16x32_bf16 v[48:51], a[88:91], a[0:3], v[48:51]
  buffer_load_dwordx4 a[40:43], v231, s[4:7], s74 offen offset:2048 sc1
  s_waitcnt lgkmcnt(4)
  v_mfma_f32_16x16x32_bf16 v[64:67], a[64:67], a[0:3], v[64:67]
  ds_read_b64_tr_b16 a[80:81], v227 offset:0
  v_mfma_f32_16x16x32_bf16 v[64:67], a[68:71], a[16:19], v[64:67]
  v_mfma_f32_16x16x32_bf16 v[68:71], a[68:71], a[20:23], v[68:71]
  ds_read_b64_tr_b16 a[82:83], v227 offset:4096
  v_mfma_f32_16x16x32_bf16 v[68:71], a[64:67], a[4:7], v[68:71]
  v_mfma_f32_16x16x32_bf16 v[72:75], a[64:67], a[8:11], v[72:75]
  ds_read_b64_tr_b16 a[84:85], v227 offset:8192
  v_mfma_f32_16x16x32_bf16 v[72:75], a[68:71], a[24:27], v[72:75]
  v_mfma_f32_16x16x32_bf16 v[76:79], a[68:71], a[28:31], v[76:79]
  ds_read_b64_tr_b16 a[86:87], v227 offset:12288
  buffer_load_dwordx4 a[56:59], v231, s[4:7], s74 offen offset:3072 sc1
  v_mfma_f32_16x16x32_bf16 v[76:79], a[64:67], a[12:15], v[76:79]
  s_add_u32 s74, s74, 4096
  s_waitcnt lgkmcnt(4)
  v_mfma_f32_16x16x32_bf16 v[92:95], a[72:75], a[12:15], v[92:95]
  ds_read_b64_tr_b16 a[88:89], v227 offset:16384
  v_mfma_f32_16x16x32_bf16 v[92:95], a[76:79], a[28:31], v[92:95]
  v_mfma_f32_16x16x32_bf16 v[88:91], a[76:79], a[24:27], v[88:91]
  ds_read_b64_tr_b16 a[90:91], v227 offset:20480
  v_mfma_f32_16x16x32_bf16 v[88:91], a[72:75], a[8:11], v[88:91]
  v_mfma_f32_16x16x32_bf16 v[84:87], a[72:75], a[4:7], v[84:87]
  ds_read_b64_tr_b16 a[92:93], v227 offset:24576
  v_mfma_f32_16x16x32_bf16 v[84:87], a[76:79], a[20:23], v[84:87]
  buffer_load_dwordx4 a[44:47], v231, s[4:7], s75 offen offset:2048 sc1
  v_mfma_f32_16x16x32_bf16 v[80:83], a[76:79], a[16:19], v[80:83]
  ds_read_b64_tr_b16 a[94:95], v227 offset:28672
  v_mfma_f32_16x16x32_bf16 v[80:83], a[72:75], a[0:3], v[80:83]
  s_waitcnt lgkmcnt(4)
  v_mfma_f32_16x16x32_bf16 v[96:99], a[80:83], a[0:3], v[96:99]
  ds_read_b64_tr_b16 a[64:65], v228 offset:0
  v_mfma_f32_16x16x32_bf16 v[96:99], a[84:87], a[16:19], v[96:99]
  v_mfma_f32_16x16x32_bf16 v[100:103], a[84:87], a[20:23], v[100:103]
  ds_read_b64_tr_b16 a[66:67], v228 offset:4096
  v_mfma_f32_16x16x32_bf16 v[100:103], a[80:83], a[4:7], v[100:103]
  v_mfma_f32_16x16x32_bf16 v[104:107], a[80:83], a[8:11], v[104:107]
  ds_read_b64_tr_b16 a[68:69], v228 offset:8192
  buffer_load_dwordx4 a[60:63], v231, s[4:7], s75 offen offset:3072 sc1
  v_mfma_f32_16x16x32_bf16 v[104:107], a[84:87], a[24:27], v[104:107]
  s_add_u32 s75, s75, 4096
  buffer_load_dwordx4 a[96:99], v236, s[24:27], s70 offen
  v_mfma_f32_16x16x32_bf16 v[108:111], a[84:87], a[28:31], v[108:111]
  ds_read_b64_tr_b16 a[70:71], v228 offset:12288
  s_add_u32 s70, s70, 1024
  v_mfma_f32_16x16x32_bf16 v[108:111], a[80:83], a[12:15], v[108:111]
  s_waitcnt lgkmcnt(4)
  v_mfma_f32_16x16x32_bf16 v[124:127], a[88:91], a[12:15], v[124:127]
  ds_read_b64_tr_b16 a[72:73], v228 offset:16384
  v_mfma_f32_16x16x32_bf16 v[124:127], a[92:95], a[28:31], v[124:127]
  v_mfma_f32_16x16x32_bf16 v[120:123], a[92:95], a[24:27], v[120:123]
  ds_read_b64_tr_b16 a[74:75], v228 offset:20480
  s_add_u32 m0, s68, 0
  v_mfma_f32_16x16x32_bf16 v[120:123], a[88:91], a[8:11], v[120:123]
  buffer_load_dwordx4 v232, s[16:19], s67 offen offset:0  lds
  v_mfma_f32_16x16x32_bf16 v[116:119], a[88:91], a[4:7], v[116:119]
  ds_read_b64_tr_b16 a[76:77], v228 offset:24576
  v_mfma_f32_16x16x32_bf16 v[116:119], a[92:95], a[20:23], v[116:119]
  v_mfma_f32_16x16x32_bf16 v[112:115], a[92:95], a[16:19], v[112:115]
  ds_read_b64_tr_b16 a[78:79], v228 offset:28672
  v_mfma_f32_16x16x32_bf16 v[112:115], a[88:91], a[0:3], v[112:115]
  s_waitcnt lgkmcnt(4)
  v_mfma_f32_16x16x32_bf16 v[128:131], a[64:67], a[0:3], v[128:131]
  ds_read_b64_tr_b16 a[80:81], v229 offset:0
  v_mfma_f32_16x16x32_bf16 v[128:131], a[68:71], a[16:19], v[128:131]
  v_mfma_f32_16x16x32_bf16 v[132:135], a[68:71], a[20:23], v[132:135]
  ds_read_b64_tr_b16 a[82:83], v229 offset:4096
  buffer_load_dwordx4 v233, s[16:19], s67 offen offset:1024  lds
  v_mfma_f32_16x16x32_bf16 v[132:135], a[64:67], a[4:7], v[132:135]
  v_mfma_f32_16x16x32_bf16 v[136:139], a[64:67], a[8:11], v[136:139]
  ds_read_b64_tr_b16 a[84:85], v229 offset:8192
  v_mfma_f32_16x16x32_bf16 v[136:139], a[68:71], a[24:27], v[136:139]
  v_mfma_f32_16x16x32_bf16 v[140:143], a[68:71], a[28:31], v[140:143]
  ds_read_b64_tr_b16 a[86:87], v229 offset:12288
  v_mfma_f32_16x16x32_bf16 v[140:143], a[64:67], a[12:15], v[140:143]
  s_waitcnt lgkmcnt(4)
  v_mfma_f32_16x16x32_bf16 v[156:159], a[72:75], a[12:15], v[156:159]
  ds_read_b64_tr_b16 a[88:89], v229 offset:16384
  v_mfma_f32_16x16x32_bf16 v[156:159], a[76:79], a[28:31], v[156:159]
  buffer_load_dwordx4 v234, s[16:19], s67 offen offset:2048  lds
  v_mfma_f32_16x16x32_bf16 v[152:155], a[76:79], a[24:27], v[152:155]
  ds_read_b64_tr_b16 a[90:91], v229 offset:20480
  v_mfma_f32_16x16x32_bf16 v[152:155], a[72:75], a[8:11], v[152:155]
  v_mfma_f32_16x16x32_bf16 v[148:151], a[72:75], a[4:7], v[148:151]
  ds_read_b64_tr_b16 a[92:93], v229 offset:24576
  v_mfma_f32_16x16x32_bf16 v[148:151], a[76:79], a[20:23], v[148:151]
  v_mfma_f32_16x16x32_bf16 v[144:147], a[76:79], a[16:19], v[144:147]
  ds_read_b64_tr_b16 a[94:95], v229 offset:28672
  v_mfma_f32_16x16x32_bf16 v[144:147], a[72:75], a[0:3], v[144:147]
  s_waitcnt lgkmcnt(4)
  v_mfma_f32_16x16x32_bf16 v[160:163], a[80:83], a[0:3], v[160:163]
  ds_read_b64_tr_b16 a[64:65], v230 offset:0
  buffer_load_dwordx4 v235, s[16:19], s67 offen offset:3072  lds
  v_mfma_f32_16x16x32_bf16 v[160:163], a[84:87], a[16:19], v[160:163]
  v_mfma_f32_16x16x32_bf16 v[164:167], a[84:87], a[20:23], v[164:167]
  ds_read_b64_tr_b16 a[66:67], v230 offset:4096
  v_mfma_f32_16x16x32_bf16 v[164:167], a[80:83], a[4:7], v[164:167]
  v_mfma_f32_16x16x32_bf16 v[168:171], a[80:83], a[8:11], v[168:171]
  ds_read_b64_tr_b16 a[68:69], v230 offset:8192
  v_mfma_f32_16x16x32_bf16 v[168:171], a[84:87], a[24:27], v[168:171]
  v_mfma_f32_16x16x32_bf16 v[172:175], a[84:87], a[28:31], v[172:175]
  ds_read_b64_tr_b16 a[70:71], v230 offset:12288
  s_add_u32 m0, s68, 16384
  v_mfma_f32_16x16x32_bf16 v[172:175], a[80:83], a[12:15], v[172:175]
  buffer_load_dwordx4 v232, s[20:23], s67 offen offset:0  lds
  s_waitcnt lgkmcnt(4)
  v_mfma_f32_16x16x32_bf16 v[188:191], a[88:91], a[12:15], v[188:191]
  ds_read_b64_tr_b16 a[72:73], v230 offset:16384
  v_mfma_f32_16x16x32_bf16 v[188:191], a[92:95], a[28:31], v[188:191]
  v_mfma_f32_16x16x32_bf16 v[184:187], a[92:95], a[24:27], v[184:187]
  ds_read_b64_tr_b16 a[74:75], v230 offset:20480
  v_mfma_f32_16x16x32_bf16 v[184:187], a[88:91], a[8:11], v[184:187]
  v_mfma_f32_16x16x32_bf16 v[180:183], a[88:91], a[4:7], v[180:183]
  ds_read_b64_tr_b16 a[76:77], v230 offset:24576
  v_mfma_f32_16x16x32_bf16 v[180:183], a[92:95], a[20:23], v[180:183]
  v_mfma_f32_16x16x32_bf16 v[176:179], a[92:95], a[16:19], v[176:179]
  ds_read_b64_tr_b16 a[78:79], v230 offset:28672
  buffer_load_dwordx4 v233, s[20:23], s67 offen offset:1024  lds
  v_mfma_f32_16x16x32_bf16 v[176:179], a[88:91], a[0:3], v[176:179]
  s_waitcnt lgkmcnt(4)
  v_mfma_f32_16x16x32_bf16 v[192:195], a[64:67], a[0:3], v[192:195]
  s_waitcnt vmcnt(15)
  s_barrier
  ds_read_b64_tr_b16 a[80:81], v224 offset:32768
  v_mfma_f32_16x16x32_bf16 v[192:195], a[68:71], a[16:19], v[192:195]
  v_mfma_f32_16x16x32_bf16 v[196:199], a[68:71], a[20:23], v[196:199]
  ds_read_b64_tr_b16 a[82:83], v224 offset:36864
  v_mfma_f32_16x16x32_bf16 v[196:199], a[64:67], a[4:7], v[196:199]
  v_mfma_f32_16x16x32_bf16 v[200:203], a[64:67], a[8:11], v[200:203]
  ds_read_b64_tr_b16 a[84:85], v224 offset:40960
  v_mfma_f32_16x16x32_bf16 v[200:203], a[68:71], a[24:27], v[200:203]
  buffer_load_dwordx4 v234, s[20:23], s67 offen offset:2048  lds
  v_mfma_f32_16x16x32_bf16 v[204:207], a[68:71], a[28:31], v[204:207]
  ds_read_b64_tr_b16 a[86:87], v224 offset:45056
  v_mfma_f32_16x16x32_bf16 v[204:207], a[64:67], a[12:15], v[204:207]
  s_waitcnt lgkmcnt(4)
  v_mfma_f32_16x16x32_bf16 v[220:223], a[72:75], a[12:15], v[220:223]
  ds_read_b64_tr_b16 a[88:89], v224 offset:49152
  v_mfma_f32_16x16x32_bf16 v[220:223], a[76:79], a[28:31], v[220:223]
  v_mfma_f32_16x16x32_bf16 v[216:219], a[76:79], a[24:27], v[216:219]
  ds_read_b64_tr_b16 a[90:91], v224 offset:53248
  v_mfma_f32_16x16x32_bf16 v[216:219], a[72:75], a[8:11], v[216:219]
  v_mfma_f32_16x16x32_bf16 v[212:215], a[72:75], a[4:7], v[212:215]
  ds_read_b64_tr_b16 a[92:93], v224 offset:57344
  buffer_load_dwordx4 v235, s[20:23], s67 offen offset:3072  lds
  v_mfma_f32_16x16x32_bf16 v[212:215], a[76:79], a[20:23], v[212:215]
  s_add_u32 s67, s67, 458752
  v_mfma_f32_16x16x32_bf16 v[208:211], a[76:79], a[16:19], v[208:211]
  ds_read_b64_tr_b16 a[94:95], v224 offset:61440
  v_xor_b32 v224, 0x10000, v224
  v_mfma_f32_16x16x32_bf16 v[208:211], a[72:75], a[0:3], v[208:211]
  s_waitcnt vmcnt(9) lgkmcnt(4)
  v_mfma_f32_16x16x32_bf16 v[0:3], a[80:83], a[32:35], v[0:3]
  ds_read_b64_tr_b16 a[64:65], v225 offset:32768
  v_mfma_f32_16x16x32_bf16 v[0:3], a[84:87], a[48:51], v[0:3]
  v_mfma_f32_16x16x32_bf16 v[4:7], a[84:87], a[52:55], v[4:7]
  ds_read_b64_tr_b16 a[66:67], v225 offset:36864
  v_mfma_f32_16x16x32_bf16 v[4:7], a[80:83], a[36:39], v[4:7]
  buffer_load_dwordx4 a[0:3], v231, s[4:7], s72 offen offset:0 sc1
  v_mfma_f32_16x16x32_bf16 v[8:11], a[80:83], a[40:43], v[8:11]
  ds_read_b64_tr_b16 a[68:69], v225 offset:40960
  v_mfma_f32_16x16x32_bf16 v[8:11], a[84:87], a[56:59], v[8:11]
  v_mfma_f32_16x16x32_bf16 v[12:15], a[84:87], a[60:63], v[12:15]
  ds_read_b64_tr_b16 a[70:71], v225 offset:45056
  v_mfma_f32_16x16x32_bf16 v[12:15], a[80:83], a[44:47], v[12:15]
  s_waitcnt lgkmcnt(4)
  v_mfma_f32_16x16x32_bf16 v[28:31], a[88:91], a[44:47], v[28:31]
  ds_read_b64_tr_b16 a[72:73], v225 offset:49152
  v_mfma_f32_16x16x32_bf16 v[28:31], a[92:95], a[60:63], v[28:31]
  v_mfma_f32_16x16x32_bf16 v[24:27], a[92:95], a[56:59], v[24:27]
  ds_read_b64_tr_b16 a[74:75], v225 offset:53248
  buffer_load_dwordx4 a[16:19], v231, s[4:7], s72 offen offset:1024 sc1
  v_mfma_f32_16x16x32_bf16 v[24:27], a[88:91], a[40:43], v[24:27]
  v_mfma_f32_16x16x32_bf16 v[20:23], a[88:91], a[36:39], v[20:23]
  ds_read_b64_tr_b16 a[76:77], v225 offset:57344
  v_mfma_f32_16x16x32_bf16 v[20:23], a[92:95], a[52:55], v[20:23]
  v_mfma_f32_16x16x32_bf16 v[16:19], a[92:95], a[48:51], v[16:19]
  ds_read_b64_tr_b16 a[78:79], v225 offset:61440
  v_xor_b32 v225, 0x10000, v225
  v_mfma_f32_16x16x32_bf16 v[16:19], a[88:91], a[32:35], v[16:19]
  s_waitcnt lgkmcnt(4)
  v_mfma_f32_16x16x32_bf16 v[32:35], a[64:67], a[32:35], v[32:35]
  ds_read_b64_tr_b16 a[80:81], v226 offset:32768
  v_mfma_f32_16x16x32_bf16 v[32:35], a[68:71], a[48:51], v[32:35]
  buffer_load_dwordx4 a[4:7], v231, s[4:7], s73 offen offset:0 sc1
  v_mfma_f32_16x16x32_bf16 v[36:39], a[68:71], a[52:55], v[36:39]
  ds_read_b64_tr_b16 a[82:83], v226 offset:36864
  v_mfma_f32_16x16x32_bf16 v[36:39], a[64:67], a[36:39], v[36:39]
  v_mfma_f32_16x16x32_bf16 v[40:43], a[64:67], a[40:43], v[40:43]
  ds_read_b64_tr_b16 a[84:85], v226 offset:40960
  v_mfma_f32_16x16x32_bf16 v[40:43], a[68:71], a[56:59], v[40:43]
  v_mfma_f32_16x16x32_bf16 v[44:47], a[68:71], a[60:63], v[44:47]
  ds_read_b64_tr_b16 a[86:87], v226 offset:45056
  v_mfma_f32_16x16x32_bf16 v[44:47], a[64:67], a[44:47], v[44:47]
  s_waitcnt lgkmcnt(4)
  v_mfma_f32_16x16x32_bf16 v[60:63], a[72:75], a[44:47], v[60:63]
  ds_read_b64_tr_b16 a[88:89], v226 offset:49152
  buffer_load_dwordx4 a[20:23], v231, s[4:7], s73 offen offset:1024 sc1
  v_mfma_f32_16x16x32_bf16 v[60:63], a[76:79], a[60:63], v[60:63]
  v_mfma_f32_16x16x32_bf16 v[56:59], a[76:79], a[56:59], v[56:59]
  ds_read_b64_tr_b16 a[90:91], v226 offset:53248
  v_mfma_f32_16x16x32_bf16 v[56:59], a[72:75], a[40:43], v[56:59]
  v_mfma_f32_16x16x32_bf16 v[52:55], a[72:75], a[36:39], v[52:55]
  ds_read_b64_tr_b16 a[92:93], v226 offset:57344
  v_mfma_f32_16x16x32_bf16 v[52:55], a[76:79], a[52:55], v[52:55]
  v_mfma_f32_16x16x32_bf16 v[48:51], a[76:79], a[48:51], v[48:51]
  ds_read_b64_tr_b16 a[94:95], v226 offset:61440
  v_xor_b32 v226, 0x10000, v226
  v_mfma_f32_16x16x32_bf16 v[48:51], a[72:75], a[32:35], v[48:51]
  buffer_load_dwordx4 a[8:11], v231, s[4:7], s74 offen offset:0 sc1
  s_waitcnt lgkmcnt(4)
  v_mfma_f32_16x16x32_bf16 v[64:67], a[80:83], a[32:35], v[64:67]
  ds_read_b64_tr_b16 a[64:65], v227 offset:32768
  v_mfma_f32_16x16x32_bf16 v[64:67], a[84:87], a[48:51], v[64:67]
  v_mfma_f32_16x16x32_bf16 v[68:71], a[84:87], a[52:55], v[68:71]
  ds_read_b64_tr_b16 a[66:67], v227 offset:36864
  v_mfma_f32_16x16x32_bf16 v[68:71], a[80:83], a[36:39], v[68:71]
  v_mfma_f32_16x16x32_bf16 v[72:75], a[80:83], a[40:43], v[72:75]
  ds_read_b64_tr_b16 a[68:69], v227 offset:40960
  v_mfma_f32_16x16x32_bf16 v[72:75], a[84:87], a[56:59], v[72:75]
  v_mfma_f32_16x16x32_bf16 v[76:79], a[84:87], a[60:63], v[76:79]
  ds_read_b64_tr_b16 a[70:71], v227 offset:45056
  buffer_load_dwordx4 a[24:27], v231, s[4:7], s74 offen offset:1024 sc1
  v_mfma_f32_16x16x32_bf16 v[76:79], a[80:83], a[44:47], v[76:79]
  s_waitcnt lgkmcnt(4)
  v_mfma_f32_16x16x32_bf16 v[92:95], a[88:91], a[44:47], v[92:95]
  ds_read_b64_tr_b16 a[72:73], v227 offset:49152
  v_mfma_f32_16x16x32_bf16 v[92:95], a[92:95], a[60:63], v[92:95]
  v_mfma_f32_16x16x32_bf16 v[88:91], a[92:95], a[56:59], v[88:91]
  ds_read_b64_tr_b16 a[74:75], v227 offset:53248
  v_mfma_f32_16x16x32_bf16 v[88:91], a[88:91], a[40:43], v[88:91]
  v_mfma_f32_16x16x32_bf16 v[84:87], a[88:91], a[36:39], v[84:87]
  ds_read_b64_tr_b16 a[76:77], v227 offset:57344
  v_mfma_f32_16x16x32_bf16 v[84:87], a[92:95], a[52:55], v[84:87]
  buffer_load_dwordx4 a[12:15], v231, s[4:7], s75 offen offset:0 sc1
  v_mfma_f32_16x16x32_bf16 v[80:83], a[92:95], a[48:51], v[80:83]
  ds_read_b64_tr_b16 a[78:79], v227 offset:61440
  v_xor_b32 v227, 0x10000, v227
  v_mfma_f32_16x16x32_bf16 v[80:83], a[88:91], a[32:35], v[80:83]
  s_waitcnt lgkmcnt(4)
  v_mfma_f32_16x16x32_bf16 v[96:99], a[64:67], a[32:35], v[96:99]
  ds_read_b64_tr_b16 a[80:81], v228 offset:32768
  v_mfma_f32_16x16x32_bf16 v[96:99], a[68:71], a[48:51], v[96:99]
  v_mfma_f32_16x16x32_bf16 v[100:103], a[68:71], a[52:55], v[100:103]
  ds_read_b64_tr_b16 a[82:83], v228 offset:36864
  v_mfma_f32_16x16x32_bf16 v[100:103], a[64:67], a[36:39], v[100:103]
  v_mfma_f32_16x16x32_bf16 v[104:107], a[64:67], a[40:43], v[104:107]
  ds_read_b64_tr_b16 a[84:85], v228 offset:40960
  buffer_load_dwordx4 a[28:31], v231, s[4:7], s75 offen offset:1024 sc1
  v_mfma_f32_16x16x32_bf16 v[104:107], a[68:71], a[56:59], v[104:107]
  v_mfma_f32_16x16x32_bf16 v[108:111], a[68:71], a[60:63], v[108:111]
  ds_read_b64_tr_b16 a[86:87], v228 offset:45056
  v_mfma_f32_16x16x32_bf16 v[108:111], a[64:67], a[44:47], v[108:111]
  s_waitcnt lgkmcnt(4)
  v_mfma_f32_16x16x32_bf16 v[124:127], a[72:75], a[44:47], v[124:127]
  ds_read_b64_tr_b16 a[88:89], v228 offset:49152
  v_mfma_f32_16x16x32_bf16 v[124:127], a[76:79], a[60:63], v[124:127]
  v_mfma_f32_16x16x32_bf16 v[120:123], a[76:79], a[56:59], v[120:123]
  ds_read_b64_tr_b16 a[90:91], v228 offset:53248
  s_add_u32 m0, s68, 32768
  v_mfma_f32_16x16x32_bf16 v[120:123], a[72:75], a[40:43], v[120:123]
  buffer_load_dwordx4 v232, s[16:19], s67 offen offset:0  lds
  v_mfma_f32_16x16x32_bf16 v[116:119], a[72:75], a[36:39], v[116:119]
  ds_read_b64_tr_b16 a[92:93], v228 offset:57344
  v_mfma_f32_16x16x32_bf16 v[116:119], a[76:79], a[52:55], v[116:119]
  v_mfma_f32_16x16x32_bf16 v[112:115], a[76:79], a[48:51], v[112:115]
  ds_read_b64_tr_b16 a[94:95], v228 offset:61440
  v_xor_b32 v228, 0x10000, v228
  v_mfma_f32_16x16x32_bf16 v[112:115], a[72:75], a[32:35], v[112:115]
  s_waitcnt lgkmcnt(4)
  v_mfma_f32_16x16x32_bf16 v[128:131], a[80:83], a[32:35], v[128:131]
  ds_read_b64_tr_b16 a[64:65], v229 offset:32768
  v_mfma_f32_16x16x32_bf16 v[128:131], a[84:87], a[48:51], v[128:131]
  v_mfma_f32_16x16x32_bf16 v[132:135], a[84:87], a[52:55], v[132:135]
  ds_read_b64_tr_b16 a[66:67], v229 offset:36864
  buffer_load_dwordx4 v233, s[16:19], s67 offen offset:1024  lds
  v_mfma_f32_16x16x32_bf16 v[132:135], a[80:83], a[36:39], v[132:135]
  v_mfma_f32_16x16x32_bf16 v[136:139], a[80:83], a[40:43], v[136:139]
  ds_read_b64_tr_b16 a[68:69], v229 offset:40960
  v_mfma_f32_16x16x32_bf16 v[136:139], a[84:87], a[56:59], v[136:139]
  v_mfma_f32_16x16x32_bf16 v[140:143], a[84:87], a[60:63], v[140:143]
  ds_read_b64_tr_b16 a[70:71], v229 offset:45056
  v_mfma_f32_16x16x32_bf16 v[140:143], a[80:83], a[44:47], v[140:143]
  s_waitcnt lgkmcnt(4)
  v_mfma_f32_16x16x32_bf16 v[156:159], a[88:91], a[44:47], v[156:159]
  ds_read_b64_tr_b16 a[72:73], v229 offset:49152
  v_mfma_f32_16x16x32_bf16 v[156:159], a[92:95], a[60:63], v[156:159]
  buffer_load_dwordx4 v234, s[16:19], s67 offen offset:2048  lds
  v_mfma_f32_16x16x32_bf16 v[152:155], a[92:95], a[56:59], v[152:155]
  ds_read_b64_tr_b16 a[74:75], v229 offset:53248
  v_mfma_f32_16x16x32_bf16 v[152:155], a[88:91], a[40:43], v[152:155]
  v_mfma_f32_16x16x32_bf16 v[148:151], a[88:91], a[36:39], v[148:151]
  ds_read_b64_tr_b16 a[76:77], v229 offset:57344
  v_mfma_f32_16x16x32_bf16 v[148:151], a[92:95], a[52:55], v[148:151]
  v_mfma_f32_16x16x32_bf16 v[144:147], a[92:95], a[48:51], v[144:147]
  ds_read_b64_tr_b16 a[78:79], v229 offset:61440
  v_xor_b32 v229, 0x10000, v229
  v_mfma_f32_16x16x32_bf16 v[144:147], a[88:91], a[32:35], v[144:147]
  s_waitcnt lgkmcnt(4)
  v_mfma_f32_16x16x32_bf16 v[160:163], a[64:67], a[32:35], v[160:163]
  ds_read_b64_tr_b16 a[80:81], v230 offset:32768
  buffer_load_dwordx4 v235, s[16:19], s67 offen offset:3072  lds
  v_mfma_f32_16x16x32_bf16 v[160:163], a[68:71], a[48:51], v[160:163]
  v_mfma_f32_16x16x32_bf16 v[164:167], a[68:71], a[52:55], v[164:167]
  ds_read_b64_tr_b16 a[82:83], v230 offset:36864
  v_mfma_f32_16x16x32_bf16 v[164:167], a[64:67], a[36:39], v[164:167]
  v_mfma_f32_16x16x32_bf16 v[168:171], a[64:67], a[40:43], v[168:171]
  ds_read_b64_tr_b16 a[84:85], v230 offset:40960
  v_mfma_f32_16x16x32_bf16 v[168:171], a[68:71], a[56:59], v[168:171]
  v_mfma_f32_16x16x32_bf16 v[172:175], a[68:71], a[60:63], v[172:175]
  ds_read_b64_tr_b16 a[86:87], v230 offset:45056
  s_add_u32 m0, s68, 49152
  v_mfma_f32_16x16x32_bf16 v[172:175], a[64:67], a[44:47], v[172:175]
  buffer_load_dwordx4 v232, s[20:23], s67 offen offset:0  lds
  s_waitcnt lgkmcnt(4)
  v_mfma_f32_16x16x32_bf16 v[188:191], a[72:75], a[44:47], v[188:191]
  ds_read_b64_tr_b16 a[88:89], v230 offset:49152
  v_mfma_f32_16x16x32_bf16 v[188:191], a[76:79], a[60:63], v[188:191]
  v_mfma_f32_16x16x32_bf16 v[184:187], a[76:79], a[56:59], v[184:187]
  ds_read_b64_tr_b16 a[90:91], v230 offset:53248
  v_mfma_f32_16x16x32_bf16 v[184:187], a[72:75], a[40:43], v[184:187]
  v_mfma_f32_16x16x32_bf16 v[180:183], a[72:75], a[36:39], v[180:183]
  ds_read_b64_tr_b16 a[92:93], v230 offset:57344
  v_mfma_f32_16x16x32_bf16 v[180:183], a[76:79], a[52:55], v[180:183]
  v_mfma_f32_16x16x32_bf16 v[176:179], a[76:79], a[48:51], v[176:179]
  ds_read_b64_tr_b16 a[94:95], v230 offset:61440
  buffer_load_dwordx4 v233, s[20:23], s67 offen offset:1024  lds
  v_xor_b32 v230, 0x10000, v230
  v_mfma_f32_16x16x32_bf16 v[176:179], a[72:75], a[32:35], v[176:179]
  s_waitcnt lgkmcnt(4)
  v_mfma_f32_16x16x32_bf16 v[192:195], a[80:83], a[32:35], v[192:195]
  s_waitcnt vmcnt(14)
  s_barrier
  ds_read_b64_tr_b16 a[64:65], v224 offset:0
  v_mfma_f32_16x16x32_bf16 v[192:195], a[84:87], a[48:51], v[192:195]
  v_mfma_f32_16x16x32_bf16 v[196:199], a[84:87], a[52:55], v[196:199]
  ds_read_b64_tr_b16 a[66:67], v224 offset:4096
  v_mfma_f32_16x16x32_bf16 v[196:199], a[80:83], a[36:39], v[196:199]
  v_mfma_f32_16x16x32_bf16 v[200:203], a[80:83], a[40:43], v[200:203]
  ds_read_b64_tr_b16 a[68:69], v224 offset:8192
  v_mfma_f32_16x16x32_bf16 v[200:203], a[84:87], a[56:59], v[200:203]
  buffer_load_dwordx4 v234, s[20:23], s67 offen offset:2048  lds
  v_mfma_f32_16x16x32_bf16 v[204:207], a[84:87], a[60:63], v[204:207]
  ds_read_b64_tr_b16 a[70:71], v224 offset:12288
  v_mfma_f32_16x16x32_bf16 v[204:207], a[80:83], a[44:47], v[204:207]
  s_waitcnt lgkmcnt(4)
  v_mfma_f32_16x16x32_bf16 v[220:223], a[88:91], a[44:47], v[220:223]
  ds_read_b64_tr_b16 a[72:73], v224 offset:16384
  v_mfma_f32_16x16x32_bf16 v[220:223], a[92:95], a[60:63], v[220:223]
  v_mfma_f32_16x16x32_bf16 v[216:219], a[92:95], a[56:59], v[216:219]
  ds_read_b64_tr_b16 a[74:75], v224 offset:20480
  v_mfma_f32_16x16x32_bf16 v[216:219], a[88:91], a[40:43], v[216:219]
  v_mfma_f32_16x16x32_bf16 v[212:215], a[88:91], a[36:39], v[212:215]
  ds_read_b64_tr_b16 a[76:77], v224 offset:24576
  buffer_load_dwordx4 v235, s[20:23], s67 offen offset:3072  lds
  v_mfma_f32_16x16x32_bf16 v[212:215], a[92:95], a[52:55], v[212:215]
  s_add_u32 s67, s67, 458752
  s_xor_b32 s68, s68, 0x10000
  v_mfma_f32_16x16x32_bf16 v[208:211], a[92:95], a[48:51], v[208:211]
  ds_read_b64_tr_b16 a[78:79], v224 offset:28672
  v_mfma_f32_16x16x32_bf16 v[208:211], a[88:91], a[32:35], v[208:211]
  s_sub_u32 s56, s56, 1
  s_cmp_lg_u32 s56, 0
  s_cbranch_scc1 Lp3_loop
Lmk_Lp3_loop_tail:
  s_waitcnt vmcnt(8) lgkmcnt(4)
  v_mfma_f32_16x16x32_bf16 v[0:3], a[64:67], a[0:3], v[0:3]
  ds_read_b64_tr_b16 a[80:81], v225 offset:0
  v_add_f32 v242, v242, v246
  v_mfma_f32_16x16x32_bf16 v[0:3], a[68:71], a[16:19], v[0:3]
  v_add_f32 v243, v243, v247
  v_add_f32 v244, v244, v248
  v_mfma_f32_16x16x32_bf16 v[4:7], a[68:71], a[20:23], v[4:7]
  ds_read_b64_tr_b16 a[82:83], v225 offset:4096
  v_add_f32 v245, v245, v249
  v_mfma_f32_16x16x32_bf16 v[4:7], a[64:67], a[4:7], v[4:7]
  buffer_load_dwordx4 a[32:35], v231, s[4:7], s72 offen offset:2048 sc1
  ds_write_b128 v250, v[242:245]
  v_mfma_f32_16x16x32_bf16 v[8:11], a[64:67], a[8:11], v[8:11]
  ds_read_b64_tr_b16 a[84:85], v225 offset:8192
  v_mfma_f32_16x16x32_bf16 v[8:11], a[68:71], a[24:27], v[8:11]
  v_mfma_f32_16x16x32_bf16 v[12:15], a[68:71], a[28:31], v[12:15]
  ds_read_b64_tr_b16 a[86:87], v225 offset:12288
  v_mfma_f32_16x16x32_bf16 v[12:15], a[64:67], a[12:15], v[12:15]
  buffer_load_dwordx4 a[48:51], v231, s[4:7], s72 offen offset:3072 sc1
  s_waitcnt lgkmcnt(5)
  v_mfma_f32_16x16x32_bf16 v[28:31], a[72:75], a[12:15], v[28:31]
  s_add_u32 s72, s72, 4096
  ds_read_b64_tr_b16 a[88:89], v225 offset:16384
  v_mfma_f32_16x16x32_bf16 v[28:31], a[76:79], a[28:31], v[28:31]
  ds_read_b128 v[246:249], v237 offset:384
  v_mfma_f32_16x16x32_bf16 v[24:27], a[76:79], a[24:27], v[24:27]
  ds_read_b64_tr_b16 a[90:91], v225 offset:20480
  v_mfma_f32_16x16x32_bf16 v[24:27], a[72:75], a[8:11], v[24:27]
  v_mfma_f32_16x16x32_bf16 v[20:23], a[72:75], a[4:7], v[20:23]
  ds_read_b64_tr_b16 a[92:93], v225 offset:24576
  v_mfma_f32_16x16x32_bf16 v[20:23], a[76:79], a[20:23], v[20:23]
  buffer_load_dwordx4 a[36:39], v231, s[4:7], s73 offen offset:2048 sc1
  v_mfma_f32_16x16x32_bf16 v[16:19], a[76:79], a[16:19], v[16:19]
  ds_read_b64_tr_b16 a[94:95], v225 offset:28672
  v_mfma_f32_16x16x32_bf16 v[16:19], a[72:75], a[0:3], v[16:19]
  s_waitcnt lgkmcnt(5)
  v_mfma_f32_16x16x32_bf16 v[32:35], a[80:83], a[0:3], v[32:35]
  s_waitcnt lgkmcnt(3)
  ds_read_b64_tr_b16 a[64:65], v226 offset:0
  v_fmac_f32 v96, v246, v238
  v_mfma_f32_16x16x32_bf16 v[32:35], a[84:87], a[16:19], v[32:35]
  buffer_load_dwordx4 a[52:55], v231, s[4:7], s73 offen offset:3072 sc1
  ds_read_b128 v[242:245], v237 offset:0
  v_mfma_f32_16x16x32_bf16 v[36:39], a[84:87], a[20:23], v[36:39]
  s_add_u32 s73, s73, 4096
  ds_read_b64_tr_b16 a[66:67], v226 offset:4096
  v_fmac_f32 v97, v247, v238
  v_mfma_f32_16x16x32_bf16 v[36:39], a[80:83], a[4:7], v[36:39]
  v_fmac_f32 v98, v248, v238
  v_fmac_f32 v99, v249, v238
  v_mfma_f32_16x16x32_bf16 v[40:43], a[80:83], a[8:11], v[40:43]
  s_xor_b32 s93, s53, 1
  ds_read_b64_tr_b16 a[68:69], v226 offset:8192
  v_fmac_f32 v100, v246, v239
  v_mfma_f32_16x16x32_bf16 v[40:43], a[84:87], a[24:27], v[40:43]
  s_lshl_b32 s93, s93, 7
  v_fmac_f32 v101, v247, v239
  v_fmac_f32 v102, v248, v239
  v_mfma_f32_16x16x32_bf16 v[44:47], a[84:87], a[28:31], v[44:47]
  s_add_u32 s80, s24, s93
  s_addc_u32 s81, s25, 0
  ds_read_b64_tr_b16 a[70:71], v226 offset:12288
  v_fmac_f32 v103, v249, v239
  v_mfma_f32_16x16x32_bf16 v[44:47], a[80:83], a[12:15], v[44:47]
  s_sub_u32 s82, 7340032, s93
  buffer_load_dwordx4 a[40:43], v231, s[4:7], s74 offen offset:2048 sc1
  v_fmac_f32 v104, v246, v240
  s_waitcnt lgkmcnt(5)
  v_mfma_f32_16x16x32_bf16 v[60:63], a[88:91], a[12:15], v[60:63]
  s_mov_b32 s83, 0x20000
  ds_read_b64_tr_b16 a[72:73], v226 offset:16384
  v_fmac_f32 v105, v247, v240
  v_mfma_f32_16x16x32_bf16 v[60:63], a[92:95], a[28:31], v[60:63]
  s_lshl_b32 s93, s53, 7
  v_fmac_f32 v106, v248, v240
  v_fmac_f32 v107, v249, v240
  v_mfma_f32_16x16x32_bf16 v[56:59], a[92:95], a[24:27], v[56:59]
  s_add_u32 s84, s24, s93
  s_addc_u32 s85, s25, 0
  ds_read_b64_tr_b16 a[74:75], v226 offset:20480
  v_fmac_f32 v108, v246, v241
  v_mfma_f32_16x16x32_bf16 v[56:59], a[88:91], a[8:11], v[56:59]
  s_sub_u32 s84, s84, 1024
  s_subb_u32 s85, s85, 0
  buffer_load_dwordx4 a[56:59], v231, s[4:7], s74 offen offset:3072 sc1
  v_fmac_f32 v109, v247, v241
  v_mfma_f32_16x16x32_bf16 v[52:55], a[88:91], a[4:7], v[52:55]
  s_add_u32 s74, s74, 4096
  ds_read_b64_tr_b16 a[76:77], v226 offset:24576
  v_fmac_f32 v110, v248, v241
  v_mfma_f32_16x16x32_bf16 v[52:55], a[92:95], a[20:23], v[52:55]
  s_sub_u32 s86, 7341056, s93
  v_fmac_f32 v111, v249, v241
  v_mfma_f32_16x16x32_bf16 v[48:51], a[92:95], a[16:19], v[48:51]
  s_mov_b32 s87, 0x20000
  ds_read_b64_tr_b16 a[78:79], v226 offset:28672
  v_mfma_f32_16x16x32_bf16 v[48:51], a[88:91], a[0:3], v[48:51]
  s_and_b32 s93, s53, 1
  s_waitcnt lgkmcnt(4)
  v_mfma_f32_16x16x32_bf16 v[64:67], a[64:67], a[0:3], v[64:67]
  ds_read_b64_tr_b16 a[80:81], v227 offset:0
  v_fmac_f32 v0, v242, v238
  v_mfma_f32_16x16x32_bf16 v[64:67], a[68:71], a[16:19], v[64:67]
  s_mul_i32 s92, s93, 3670016
  buffer_load_dwordx4 a[44:47], v231, s[4:7], s75 offen offset:2048 sc1
  ds_read_b128 v[246:249], v237 offset:64
  v_mfma_f32_16x16x32_bf16 v[68:71], a[68:71], a[20:23], v[68:71]
  s_lshl_b32 s93, s40, 14
  ds_read_b64_tr_b16 a[82:83], v227 offset:4096
  v_fmac_f32 v1, v243, v238
  v_mfma_f32_16x16x32_bf16 v[68:71], a[64:67], a[4:7], v[68:71]
  s_add_u32 s92, s92, s93
  v_fmac_f32 v2, v244, v238
  v_fmac_f32 v3, v245, v238
  v_mfma_f32_16x16x32_bf16 v[72:75], a[64:67], a[8:11], v[72:75]
  s_lshl_b32 s79, s40, 11
  ds_read_b64_tr_b16 a[84:85], v227 offset:8192
  v_fmac_f32 v4, v242, v239
  v_mfma_f32_16x16x32_bf16 v[72:75], a[68:71], a[24:27], v[72:75]
  s_lshr_b32 s93, s53, 1
  buffer_load_dwordx4 a[60:63], v231, s[4:7], s75 offen offset:3072 sc1
  v_fmac_f32 v5, v243, v239
  v_mfma_f32_16x16x32_bf16 v[76:79], a[68:71], a[28:31], v[76:79]
  s_add_u32 s75, s75, 4096
  ds_read_b64_tr_b16 a[86:87], v227 offset:12288
  v_fmac_f32 v6, v244, v239
  v_mfma_f32_16x16x32_bf16 v[76:79], a[64:67], a[12:15], v[76:79]
  s_add_u32 s93, s93, s52
  v_fmac_f32 v7, v245, v239
  v_fmac_f32 v8, v242, v240
  s_waitcnt lgkmcnt(5)
  v_mfma_f32_16x16x32_bf16 v[92:95], a[72:75], a[12:15], v[92:95]
  s_and_b32 s93, s93, 3
  ds_read_b64_tr_b16 a[88:89], v227 offset:16384
  v_fmac_f32 v9, v243, v240
  v_mfma_f32_16x16x32_bf16 v[92:95], a[76:79], a[28:31], v[92:95]
  s_cmp_eq_u32 s93, 0
  s_cselect_b32 s88, 917504, 0
  v_fmac_f32 v10, v244, v240
  v_fmac_f32 v11, v245, v240
  v_mfma_f32_16x16x32_bf16 v[88:91], a[76:79], a[24:27], v[88:91]
  s_add_u32 m0, s68, 0
  ds_read_b64_tr_b16 a[90:91], v227 offset:20480
  v_fmac_f32 v12, v242, v241
  v_mfma_f32_16x16x32_bf16 v[88:91], a[72:75], a[8:11], v[88:91]
  s_cmp_eq_u32 s93, 1
  s_cselect_b32 s89, 917504, 0
  buffer_load_dwordx4 v232, s[16:19], s67 offen offset:0  lds
  v_fmac_f32 v13, v243, v241
  v_mfma_f32_16x16x32_bf16 v[84:87], a[72:75], a[4:7], v[84:87]
  s_cmp_eq_u32 s93, 2
  s_cselect_b32 s90, 917504, 0
  ds_read_b64_tr_b16 a[92:93], v227 offset:24576
  v_fmac_f32 v14, v244, v241
  v_mfma_f32_16x16x32_bf16 v[84:87], a[76:79], a[20:23], v[84:87]
  s_cmp_eq_u32 s93, 3
  s_cselect_b32 s91, 917504, 0
  v_fmac_f32 v15, v245, v241
  v_mfma_f32_16x16x32_bf16 v[80:83], a[76:79], a[16:19], v[80:83]
  s_cmp_eq_u32 s40, 1
  s_cselect_b32 s78, 16384, 0
  ds_read_b64_tr_b16 a[94:95], v227 offset:28672
  v_mfma_f32_16x16x32_bf16 v[80:83], a[72:75], a[0:3], v[80:83]
  s_cmp_eq_u32 s40, 2
  s_cselect_b32 s78, -16384, s78
  buffer_load_dwordx4 v233, s[16:19], s67 offen offset:1024  lds
  s_waitcnt lgkmcnt(4)
  v_mfma_f32_16x16x32_bf16 v[96:99], a[80:83], a[0:3], v[96:99]
  ds_read_b64_tr_b16 a[64:65], v228 offset:0
  v_fmac_f32 v16, v246, v238
  v_mfma_f32_16x16x32_bf16 v[96:99], a[84:87], a[16:19], v[96:99]
  s_mul_i32 s43, s69, 458752
  ds_read_b128 v[242:245], v237 offset:128
  v_fmac_f32 v17, v247, v238
  v_mfma_f32_16x16x32_bf16 v[100:103], a[84:87], a[20:23], v[100:103]
  s_lshr_b32 s45, s55, 4
  ds_read_b64_tr_b16 a[66:67], v228 offset:4096
  v_fmac_f32 v18, v248, v238
  v_mfma_f32_16x16x32_bf16 v[100:103], a[80:83], a[4:7], v[100:103]
  s_mul_i32 s45, s45, 57344
  v_fmac_f32 v19, v249, v238
  v_fmac_f32 v20, v246, v239
  v_mfma_f32_16x16x32_bf16 v[104:107], a[80:83], a[8:11], v[104:107]
  s_add_u32 s43, s43, s45
  ds_read_b64_tr_b16 a[68:69], v228 offset:8192
  v_fmac_f32 v21, v247, v239
  v_mfma_f32_16x16x32_bf16 v[104:107], a[84:87], a[24:27], v[104:107]
  s_add_u32 s43, s43, s42
  buffer_load_dwordx4 v234, s[16:19], s67 offen offset:2048  lds
  v_fmac_f32 v22, v248, v239
  v_mfma_f32_16x16x32_bf16 v[108:111], a[84:87], a[28:31], v[108:111]
  s_add_u32 s43, s43, 12582912
  ds_read_b64_tr_b16 a[70:71], v228 offset:12288
  v_fmac_f32 v23, v249, v239
  v_mfma_f32_16x16x32_bf16 v[108:111], a[80:83], a[12:15], v[108:111]
  s_and_b32 s44, s55, 15
  v_fmac_f32 v24, v246, v240
  v_fmac_f32 v25, v247, v240
  s_waitcnt lgkmcnt(5)
  v_mfma_f32_16x16x32_bf16 v[124:127], a[88:91], a[12:15], v[124:127]
  s_lshl_b32 s45, s44, 10
  ds_read_b64_tr_b16 a[72:73], v228 offset:16384
  v_fmac_f32 v26, v248, v240
  v_mfma_f32_16x16x32_bf16 v[124:127], a[92:95], a[28:31], v[124:127]
  s_add_u32 s57, s43, s45
  buffer_load_dwordx4 v235, s[16:19], s67 offen offset:3072  lds
  v_fmac_f32 v27, v249, v240
  v_mfma_f32_16x16x32_bf16 v[120:123], a[92:95], a[24:27], v[120:123]
  s_lshl_b32 s45, s44, 9
  ds_read_b64_tr_b16 a[74:75], v228 offset:20480
  v_fmac_f32 v28, v246, v241
  v_mfma_f32_16x16x32_bf16 v[120:123], a[88:91], a[8:11], v[120:123]
  s_add_u32 s61, s43, s45
  v_fmac_f32 v29, v247, v241
  v_fmac_f32 v30, v248, v241
  v_mfma_f32_16x16x32_bf16 v[116:119], a[88:91], a[4:7], v[116:119]
  s_add_u32 s61, s61, 49152
  ds_read_b64_tr_b16 a[76:77], v228 offset:24576
  v_fmac_f32 v31, v249, v241
  v_mfma_f32_16x16x32_bf16 v[116:119], a[92:95], a[20:23], v[116:119]
  s_add_u32 s62, s61, 229376
  v_mfma_f32_16x16x32_bf16 v[112:115], a[92:95], a[16:19], v[112:115]
  s_add_u32 m0, s68, 16384
  ds_read_b64_tr_b16 a[78:79], v228 offset:28672
  v_mfma_f32_16x16x32_bf16 v[112:115], a[88:91], a[0:3], v[112:115]
  s_add_u32 s58, s57, 114688
  buffer_load_dwordx4 v232, s[20:23], s67 offen offset:0  lds
  s_waitcnt lgkmcnt(4)
  v_mfma_f32_16x16x32_bf16 v[128:131], a[64:67], a[0:3], v[128:131]
  ds_read_b64_tr_b16 a[80:81], v229 offset:0
  v_fmac_f32 v32, v242, v238
  v_mfma_f32_16x16x32_bf16 v[128:131], a[68:71], a[16:19], v[128:131]
  s_add_u32 s59, s58, 114688
  ds_read_b128 v[246:249], v237 offset:192
  v_fmac_f32 v33, v243, v238
  v_mfma_f32_16x16x32_bf16 v[132:135], a[68:71], a[20:23], v[132:135]
  s_add_u32 s60, s59, 114688
  ds_read_b64_tr_b16 a[82:83], v229 offset:4096
  v_fmac_f32 v34, v244, v238
  v_mfma_f32_16x16x32_bf16 v[132:135], a[64:67], a[4:7], v[132:135]
  s_lshl_b32 s77, s54, 1
  buffer_load_dwordx4 v233, s[20:23], s67 offen offset:1024  lds
  v_fmac_f32 v35, v245, v238
  v_mfma_f32_16x16x32_bf16 v[136:139], a[64:67], a[8:11], v[136:139]
  s_lshr_b32 s43, s55, 4
  ds_read_b64_tr_b16 a[84:85], v229 offset:8192
  v_fmac_f32 v36, v242, v239
  v_mfma_f32_16x16x32_bf16 v[136:139], a[68:71], a[24:27], v[136:139]
  s_add_u32 s77, s77, s43
  v_fmac_f32 v37, v243, v239
  v_fmac_f32 v38, v244, v239
  v_mfma_f32_16x16x32_bf16 v[140:143], a[68:71], a[28:31], v[140:143]
  s_lshl_b32 s77, s77, 7
  ds_read_b64_tr_b16 a[86:87], v229 offset:12288
  v_fmac_f32 v39, v245, v239
  v_mfma_f32_16x16x32_bf16 v[140:143], a[64:67], a[12:15], v[140:143]
  s_add_u32 s77, s77, s42
  v_fmac_f32 v40, v242, v240
  v_fmac_f32 v41, v243, v240
  s_waitcnt lgkmcnt(5)
  v_mfma_f32_16x16x32_bf16 v[156:159], a[72:75], a[12:15], v[156:159]
  s_add_u32 s77, s77, 27795456
  ds_read_b64_tr_b16 a[88:89], v229 offset:16384
  v_fmac_f32 v42, v244, v240
  v_mfma_f32_16x16x32_bf16 v[156:159], a[76:79], a[28:31], v[156:159]
  s_and_b32 s43, s53, 1
  buffer_load_dwordx4 v234, s[20:23], s67 offen offset:2048  lds
  v_fmac_f32 v43, v245, v240
  v_mfma_f32_16x16x32_bf16 v[152:155], a[76:79], a[24:27], v[152:155]
  s_and_b32 s64, s52, 14
  ds_read_b64_tr_b16 a[90:91], v229 offset:20480
  v_fmac_f32 v44, v242, v241
  v_mfma_f32_16x16x32_bf16 v[152:155], a[72:75], a[8:11], v[152:155]
  s_add_u32 s64, s64, s43
  v_fmac_f32 v45, v243, v241
  v_fmac_f32 v46, v244, v241
  v_mfma_f32_16x16x32_bf16 v[148:151], a[72:75], a[4:7], v[148:151]
  s_lshl_b32 s64, s64, 7
  ds_read_b64_tr_b16 a[92:93], v229 offset:24576
  v_fmac_f32 v47, v245, v241
  v_mfma_f32_16x16x32_bf16 v[148:151], a[76:79], a[20:23], v[148:151]
  s_add_u32 s64, s64, s42
  buffer_load_dwordx4 v235, s[20:23], s67 offen offset:3072  lds
  v_mfma_f32_16x16x32_bf16 v[144:147], a[76:79], a[16:19], v[144:147]
  s_add_u32 s67, s67, 458752
  ds_read_b64_tr_b16 a[94:95], v229 offset:28672
  v_mfma_f32_16x16x32_bf16 v[144:147], a[72:75], a[0:3], v[144:147]
  s_add_u32 s64, s64, 27795456
  s_waitcnt lgkmcnt(4)
  v_mfma_f32_16x16x32_bf16 v[160:163], a[80:83], a[0:3], v[160:163]
  ds_read_b64_tr_b16 a[64:65], v230 offset:0
  v_fmac_f32 v48, v246, v238
  v_mfma_f32_16x16x32_bf16 v[160:163], a[84:87], a[16:19], v[160:163]
  s_lshl_b32 s49, s52, 3
  ds_read_b128 v[242:245], v237 offset:256
  v_fmac_f32 v49, v247, v238
  v_mfma_f32_16x16x32_bf16 v[164:167], a[84:87], a[20:23], v[164:167]
  s_lshl_b32 s43, s40, 1
  ds_read_b64_tr_b16 a[66:67], v230 offset:4096
  v_fmac_f32 v50, v248, v238
  v_mfma_f32_16x16x32_bf16 v[164:167], a[80:83], a[4:7], v[164:167]
  s_add_u32 s49, s49, s43
  buffer_load_dwordx4 a[192:195], v231, s[4:7], s72 offen offset:0 sc1
  v_fmac_f32 v51, v249, v238
  v_mfma_f32_16x16x32_bf16 v[168:171], a[80:83], a[8:11], v[168:171]
  s_lshl_b32 s76, s49, 15
  ds_read_b64_tr_b16 a[68:69], v230 offset:8192
  v_fmac_f32 v52, v246, v239
  v_mfma_f32_16x16x32_bf16 v[168:171], a[84:87], a[24:27], v[168:171]
  s_lshl_b32 s43, s53, 11
  v_fmac_f32 v53, v247, v239
  v_fmac_f32 v54, v248, v239
  v_mfma_f32_16x16x32_bf16 v[172:175], a[84:87], a[28:31], v[172:175]
  s_add_u32 s76, s76, s43
  ds_read_b64_tr_b16 a[70:71], v230 offset:12288
  v_fmac_f32 v55, v249, v239
  v_mfma_f32_16x16x32_bf16 v[172:175], a[80:83], a[12:15], v[172:175]
  s_add_u32 s76, s76, s42
  buffer_load_dwordx4 a[208:211], v231, s[4:7], s72 offen offset:1024 sc1
  v_fmac_f32 v56, v246, v240
  s_waitcnt lgkmcnt(5)
  v_mfma_f32_16x16x32_bf16 v[188:191], a[88:91], a[12:15], v[188:191]
  s_add_u32 s46, s76, 4194304
  ds_read_b64_tr_b16 a[72:73], v230 offset:16384
  v_fmac_f32 v57, v247, v240
  v_mfma_f32_16x16x32_bf16 v[188:191], a[92:95], a[28:31], v[188:191]
  s_add_u32 s47, s46, 32768
  v_fmac_f32 v58, v248, v240
  v_fmac_f32 v59, v249, v240
  v_mfma_f32_16x16x32_bf16 v[184:187], a[92:95], a[24:27], v[184:187]
  s_mul_i32 s48, s49, 114688
  ds_read_b64_tr_b16 a[74:75], v230 offset:20480
  v_fmac_f32 v60, v246, v241
  v_mfma_f32_16x16x32_bf16 v[184:187], a[88:91], a[8:11], v[184:187]
  s_and_b32 s43, s53, 1
  v_fmac_f32 v61, v247, v241
  v_fmac_f32 v62, v248, v241
  v_mfma_f32_16x16x32_bf16 v[180:183], a[88:91], a[4:7], v[180:183]
  s_mul_i32 s44, s43, 57344
  ds_read_b64_tr_b16 a[76:77], v230 offset:24576
  v_fmac_f32 v63, v249, v241
  v_mfma_f32_16x16x32_bf16 v[180:183], a[92:95], a[20:23], v[180:183]
  s_add_u32 s48, s48, s44
  buffer_load_dwordx4 a[196:199], v231, s[4:7], s73 offen offset:0 sc1
  v_mfma_f32_16x16x32_bf16 v[176:179], a[92:95], a[16:19], v[176:179]
  s_add_u32 s48, s48, s42
  ds_read_b64_tr_b16 a[78:79], v230 offset:28672
  v_mfma_f32_16x16x32_bf16 v[176:179], a[88:91], a[0:3], v[176:179]
  s_add_u32 s48, s48, 12582912
  s_waitcnt lgkmcnt(4)
  v_mfma_f32_16x16x32_bf16 v[192:195], a[64:67], a[0:3], v[192:195]
  s_waitcnt vmcnt(19)
  s_barrier
  ds_read_b64_tr_b16 a[80:81], v224 offset:32768
  v_mfma_f32_16x16x32_bf16 v[192:195], a[68:71], a[16:19], v[192:195]
  buffer_load_dwordx4 a[212:215], v231, s[4:7], s73 offen offset:1024 sc1
  ds_read_b128 v[246:249], v237 offset:320
  v_mfma_f32_16x16x32_bf16 v[196:199], a[68:71], a[20:23], v[196:199]
  ds_read_b64_tr_b16 a[82:83], v224 offset:36864
  v_fmac_f32 v64, v242, v238
  v_mfma_f32_16x16x32_bf16 v[196:199], a[64:67], a[4:7], v[196:199]
  v_fmac_f32 v65, v243, v238
  v_fmac_f32 v66, v244, v238
  v_mfma_f32_16x16x32_bf16 v[200:203], a[64:67], a[8:11], v[200:203]
  ds_read_b64_tr_b16 a[84:85], v224 offset:40960
  v_fmac_f32 v67, v245, v238
  v_mfma_f32_16x16x32_bf16 v[200:203], a[68:71], a[24:27], v[200:203]
  v_fmac_f32 v68, v242, v239
  v_fmac_f32 v69, v243, v239
  v_mfma_f32_16x16x32_bf16 v[204:207], a[68:71], a[28:31], v[204:207]
  ds_read_b64_tr_b16 a[86:87], v224 offset:45056
  v_fmac_f32 v70, v244, v239
  v_mfma_f32_16x16x32_bf16 v[204:207], a[64:67], a[12:15], v[204:207]
  s_waitcnt lgkmcnt(5)
  buffer_load_dwordx4 a[200:203], v231, s[4:7], s74 offen offset:0 sc1
  v_fmac_f32 v71, v245, v239
  v_mfma_f32_16x16x32_bf16 v[220:223], a[72:75], a[12:15], v[220:223]
  ds_read_b64_tr_b16 a[88:89], v224 offset:49152
  v_fmac_f32 v72, v242, v240
  v_mfma_f32_16x16x32_bf16 v[220:223], a[76:79], a[28:31], v[220:223]
  v_fmac_f32 v73, v243, v240
  v_fmac_f32 v74, v244, v240
  v_mfma_f32_16x16x32_bf16 v[216:219], a[76:79], a[24:27], v[216:219]
  ds_read_b64_tr_b16 a[90:91], v224 offset:53248
  v_fmac_f32 v75, v245, v240
  v_mfma_f32_16x16x32_bf16 v[216:219], a[72:75], a[8:11], v[216:219]
  buffer_load_dwordx4 a[216:219], v231, s[4:7], s74 offen offset:1024 sc1
  v_fmac_f32 v76, v242, v241
  v_mfma_f32_16x16x32_bf16 v[212:215], a[72:75], a[4:7], v[212:215]
  ds_read_b64_tr_b16 a[92:93], v224 offset:57344
  v_fmac_f32 v77, v243, v241
  v_mfma_f32_16x16x32_bf16 v[212:215], a[76:79], a[20:23], v[212:215]
  v_fmac_f32 v78, v244, v241
  v_fmac_f32 v79, v245, v241
  v_mfma_f32_16x16x32_bf16 v[208:211], a[76:79], a[16:19], v[208:211]
  ds_read_b64_tr_b16 a[94:95], v224 offset:61440
  v_xor_b32 v224, 0x10000, v224
  v_mfma_f32_16x16x32_bf16 v[208:211], a[72:75], a[0:3], v[208:211]
  s_waitcnt vmcnt(20) lgkmcnt(4)
  v_mfma_f32_16x16x32_bf16 v[0:3], a[80:83], a[32:35], v[0:3]
  ds_read_b64_tr_b16 a[64:65], v225 offset:32768
  v_fmac_f32 v80, v246, v238
  v_mfma_f32_16x16x32_bf16 v[0:3], a[84:87], a[48:51], v[0:3]
  s_waitcnt vmcnt(18)
  buffer_load_dwordx4 a[204:207], v231, s[4:7], s75 offen offset:0 sc1
  ds_read_b128 v[242:245], v237 offset:448
  v_mfma_f32_16x16x32_bf16 v[4:7], a[84:87], a[52:55], v[4:7]
  ds_read_b64_tr_b16 a[66:67], v225 offset:36864
  v_fmac_f32 v81, v247, v238
  v_mfma_f32_16x16x32_bf16 v[4:7], a[80:83], a[36:39], v[4:7]
  s_waitcnt vmcnt(17)
  v_fmac_f32 v82, v248, v238
  v_fmac_f32 v83, v249, v238
  v_mfma_f32_16x16x32_bf16 v[8:11], a[80:83], a[40:43], v[8:11]
  ds_read_b64_tr_b16 a[68:69], v225 offset:40960
  v_fmac_f32 v84, v246, v239
  v_mfma_f32_16x16x32_bf16 v[8:11], a[84:87], a[56:59], v[8:11]
  s_waitcnt vmcnt(15)
  buffer_load_dwordx4 a[220:223], v231, s[4:7], s75 offen offset:1024 sc1
  v_fmac_f32 v85, v247, v239
  v_mfma_f32_16x16x32_bf16 v[12:15], a[84:87], a[60:63], v[12:15]
  ds_read_b64_tr_b16 a[70:71], v225 offset:45056
  v_fmac_f32 v86, v248, v239
  v_mfma_f32_16x16x32_bf16 v[12:15], a[80:83], a[44:47], v[12:15]
  s_waitcnt lgkmcnt(5)
  v_fmac_f32 v87, v249, v239
  v_fmac_f32 v88, v246, v240
  v_mfma_f32_16x16x32_bf16 v[28:31], a[88:91], a[44:47], v[28:31]
  ds_read_b64_tr_b16 a[72:73], v225 offset:49152
  v_fmac_f32 v89, v247, v240
  v_mfma_f32_16x16x32_bf16 v[28:31], a[92:95], a[60:63], v[28:31]
  v_fmac_f32 v90, v248, v240
  v_fmac_f32 v91, v249, v240
  v_mfma_f32_16x16x32_bf16 v[24:27], a[92:95], a[56:59], v[24:27]
  s_add_u32 m0, s68, 32768
  ds_read_b64_tr_b16 a[74:75], v225 offset:53248
  v_fmac_f32 v92, v246, v241
  v_mfma_f32_16x16x32_bf16 v[24:27], a[88:91], a[40:43], v[24:27]
  buffer_load_dwordx4 v232, s[16:19], s67 offen offset:0  lds
  v_fmac_f32 v93, v247, v241
  v_mfma_f32_16x16x32_bf16 v[20:23], a[88:91], a[36:39], v[20:23]
  ds_read_b64_tr_b16 a[76:77], v225 offset:57344
  v_fmac_f32 v94, v248, v241
  v_mfma_f32_16x16x32_bf16 v[20:23], a[92:95], a[52:55], v[20:23]
  v_fmac_f32 v95, v249, v241
  v_mfma_f32_16x16x32_bf16 v[16:19], a[92:95], a[48:51], v[16:19]
  ds_read_b64_tr_b16 a[78:79], v225 offset:61440
  v_xor_b32 v225, 0x10000, v225
  v_mfma_f32_16x16x32_bf16 v[16:19], a[88:91], a[32:35], v[16:19]
  buffer_load_dwordx4 v233, s[16:19], s67 offen offset:1024  lds
  s_waitcnt lgkmcnt(4)
  v_mfma_f32_16x16x32_bf16 v[32:35], a[64:67], a[32:35], v[32:35]
  ds_read_b64_tr_b16 a[80:81], v226 offset:32768
  v_fmac_f32 v112, v242, v238
  v_mfma_f32_16x16x32_bf16 v[32:35], a[68:71], a[48:51], v[32:35]
  ds_read_b128 v[246:249], v237 offset:512
  v_fmac_f32 v113, v243, v238
  v_mfma_f32_16x16x32_bf16 v[36:39], a[68:71], a[52:55], v[36:39]
  ds_read_b64_tr_b16 a[82:83], v226 offset:36864
  v_fmac_f32 v114, v244, v238
  v_mfma_f32_16x16x32_bf16 v[36:39], a[64:67], a[36:39], v[36:39]
  v_fmac_f32 v115, v245, v238
  v_fmac_f32 v116, v242, v239
  v_mfma_f32_16x16x32_bf16 v[40:43], a[64:67], a[40:43], v[40:43]
  ds_read_b64_tr_b16 a[84:85], v226 offset:40960
  v_fmac_f32 v117, v243, v239
  v_mfma_f32_16x16x32_bf16 v[40:43], a[68:71], a[56:59], v[40:43]
  buffer_load_dwordx4 v234, s[16:19], s67 offen offset:2048  lds
  v_fmac_f32 v118, v244, v239
  v_mfma_f32_16x16x32_bf16 v[44:47], a[68:71], a[60:63], v[44:47]
  ds_read_b64_tr_b16 a[86:87], v226 offset:45056
  v_fmac_f32 v119, v245, v239
  v_mfma_f32_16x16x32_bf16 v[44:47], a[64:67], a[44:47], v[44:47]
  s_waitcnt lgkmcnt(5)
  v_fmac_f32 v120, v242, v240
  v_fmac_f32 v121, v243, v240
  v_mfma_f32_16x16x32_bf16 v[60:63], a[72:75], a[44:47], v[60:63]
  ds_read_b64_tr_b16 a[88:89], v226 offset:49152
  v_fmac_f32 v122, v244, v240
  v_mfma_f32_16x16x32_bf16 v[60:63], a[76:79], a[60:63], v[60:63]
  buffer_load_dwordx4 v235, s[16:19], s67 offen offset:3072  lds
  v_fmac_f32 v123, v245, v240
  v_mfma_f32_16x16x32_bf16 v[56:59], a[76:79], a[56:59], v[56:59]
  ds_read_b64_tr_b16 a[90:91], v226 offset:53248
  v_fmac_f32 v124, v242, v241
  v_mfma_f32_16x16x32_bf16 v[56:59], a[72:75], a[40:43], v[56:59]
  v_fmac_f32 v125, v243, v241
  v_fmac_f32 v126, v244, v241
  v_mfma_f32_16x16x32_bf16 v[52:55], a[72:75], a[36:39], v[52:55]
  ds_read_b64_tr_b16 a[92:93], v226 offset:57344
  v_fmac_f32 v127, v245, v241
  v_mfma_f32_16x16x32_bf16 v[52:55], a[76:79], a[52:55], v[52:55]
  v_mfma_f32_16x16x32_bf16 v[48:51], a[76:79], a[48:51], v[48:51]
  s_add_u32 m0, s68, 49152
  ds_read_b64_tr_b16 a[94:95], v226 offset:61440
  v_xor_b32 v226, 0x10000, v226
  v_mfma_f32_16x16x32_bf16 v[48:51], a[72:75], a[32:35], v[48:51]
  buffer_load_dwordx4 v232, s[20:23], s67 offen offset:0  lds
  s_waitcnt lgkmcnt(4)
  v_mfma_f32_16x16x32_bf16 v[64:67], a[80:83], a[32:35], v[64:67]
  ds_read_b64_tr_b16 a[64:65], v227 offset:32768
  v_fmac_f32 v128, v246, v238
  v_mfma_f32_16x16x32_bf16 v[64:67], a[84:87], a[48:51], v[64:67]
  ds_read_b128 v[242:245], v237 offset:576
  v_fmac_f32 v129, v247, v238
  v_mfma_f32_16x16x32_bf16 v[68:71], a[84:87], a[52:55], v[68:71]
  ds_read_b64_tr_b16 a[66:67], v227 offset:36864
  v_fmac_f32 v130, v248, v238
  v_mfma_f32_16x16x32_bf16 v[68:71], a[80:83], a[36:39], v[68:71]
  buffer_load_dwordx4 v233, s[20:23], s67 offen offset:1024  lds
  v_fmac_f32 v131, v249, v238
  v_mfma_f32_16x16x32_bf16 v[72:75], a[80:83], a[40:43], v[72:75]
  ds_read_b64_tr_b16 a[68:69], v227 offset:40960
  v_fmac_f32 v132, v246, v239
  v_mfma_f32_16x16x32_bf16 v[72:75], a[84:87], a[56:59], v[72:75]
  v_fmac_f32 v133, v247, v239
  v_fmac_f32 v134, v248, v239
  v_mfma_f32_16x16x32_bf16 v[76:79], a[84:87], a[60:63], v[76:79]
  ds_read_b64_tr_b16 a[70:71], v227 offset:45056
  v_fmac_f32 v135, v249, v239
  v_mfma_f32_16x16x32_bf16 v[76:79], a[80:83], a[44:47], v[76:79]
  s_waitcnt lgkmcnt(5)
  v_fmac_f32 v136, v246, v240
  v_fmac_f32 v137, v247, v240
  v_mfma_f32_16x16x32_bf16 v[92:95], a[88:91], a[44:47], v[92:95]
  ds_read_b64_tr_b16 a[72:73], v227 offset:49152
  v_fmac_f32 v138, v248, v240
  v_mfma_f32_16x16x32_bf16 v[92:95], a[92:95], a[60:63], v[92:95]
  buffer_load_dwordx4 v234, s[20:23], s67 offen offset:2048  lds
  v_fmac_f32 v139, v249, v240
  v_mfma_f32_16x16x32_bf16 v[88:91], a[92:95], a[56:59], v[88:91]
  ds_read_b64_tr_b16 a[74:75], v227 offset:53248
  v_fmac_f32 v140, v246, v241
  v_mfma_f32_16x16x32_bf16 v[88:91], a[88:91], a[40:43], v[88:91]
  v_fmac_f32 v141, v247, v241
  v_fmac_f32 v142, v248, v241
  v_mfma_f32_16x16x32_bf16 v[84:87], a[88:91], a[36:39], v[84:87]
  ds_read_b64_tr_b16 a[76:77], v227 offset:57344
  v_fmac_f32 v143, v249, v241
  v_mfma_f32_16x16x32_bf16 v[84:87], a[92:95], a[52:55], v[84:87]
  buffer_load_dwordx4 v235, s[20:23], s67 offen offset:3072  lds
  v_mfma_f32_16x16x32_bf16 v[80:83], a[92:95], a[48:51], v[80:83]
  s_add_u32 s67, s67, 458752
  s_xor_b32 s68, s68, 0x10000
  ds_read_b64_tr_b16 a[78:79], v227 offset:61440
  v_xor_b32 v227, 0x10000, v227
  v_mfma_f32_16x16x32_bf16 v[80:83], a[88:91], a[32:35], v[80:83]
  s_waitcnt lgkmcnt(4)
  v_mfma_f32_16x16x32_bf16 v[96:99], a[64:67], a[32:35], v[96:99]
  s_waitcnt vmcnt(16)
  s_barrier
  ds_read_b64_tr_b16 a[80:81], v224 offset:0
  v_mfma_f32_16x16x32_bf16 v[96:99], a[68:71], a[48:51], v[96:99]
  ds_read_b128 v[246:249], v237 offset:640
  v_fmac_f32 v144, v242, v238
  v_mfma_f32_16x16x32_bf16 v[100:103], a[68:71], a[52:55], v[100:103]
  ds_read_b64_tr_b16 a[82:83], v224 offset:4096
  v_fmac_f32 v145, v243, v238
  v_mfma_f32_16x16x32_bf16 v[100:103], a[64:67], a[36:39], v[100:103]
  buffer_load_dwordx4 a[224:227], v231, s[4:7], s72 offen offset:2048 sc1
  v_fmac_f32 v146, v244, v238
  v_mfma_f32_16x16x32_bf16 v[104:107], a[64:67], a[40:43], v[104:107]
  ds_read_b64_tr_b16 a[84:85], v224 offset:8192
  v_fmac_f32 v147, v245, v238
  v_mfma_f32_16x16x32_bf16 v[104:107], a[68:71], a[56:59], v[104:107]
  v_fmac_f32 v148, v242, v239
  v_fmac_f32 v149, v243, v239
  v_mfma_f32_16x16x32_bf16 v[108:111], a[68:71], a[60:63], v[108:111]
  ds_read_b64_tr_b16 a[86:87], v224 offset:12288
  v_fmac_f32 v150, v244, v239
  v_mfma_f32_16x16x32_bf16 v[108:111], a[64:67], a[44:47], v[108:111]
  s_waitcnt lgkmcnt(5)
  buffer_load_dwordx4 a[240:243], v231, s[4:7], s72 offen offset:3072 sc1
  v_fmac_f32 v151, v245, v239
  v_mfma_f32_16x16x32_bf16 v[124:127], a[72:75], a[44:47], v[124:127]
  s_add_u32 s72, s72, 4096
  ds_read_b64_tr_b16 a[88:89], v224 offset:16384
  v_fmac_f32 v152, v242, v240
  v_mfma_f32_16x16x32_bf16 v[124:127], a[76:79], a[60:63], v[124:127]
  v_fmac_f32 v153, v243, v240
  v_fmac_f32 v154, v244, v240
  v_mfma_f32_16x16x32_bf16 v[120:123], a[76:79], a[56:59], v[120:123]
  ds_read_b64_tr_b16 a[90:91], v224 offset:20480
  v_fmac_f32 v155, v245, v240
  v_mfma_f32_16x16x32_bf16 v[120:123], a[72:75], a[40:43], v[120:123]
  v_fmac_f32 v156, v242, v241
  v_fmac_f32 v157, v243, v241
  v_mfma_f32_16x16x32_bf16 v[116:119], a[72:75], a[36:39], v[116:119]
  ds_read_b64_tr_b16 a[92:93], v224 offset:24576
  v_fmac_f32 v158, v244, v241
  v_mfma_f32_16x16x32_bf16 v[116:119], a[76:79], a[52:55], v[116:119]
  buffer_load_dwordx4 a[228:231], v231, s[4:7], s73 offen offset:2048 sc1
  v_fmac_f32 v159, v245, v241
  v_mfma_f32_16x16x32_bf16 v[112:115], a[76:79], a[48:51], v[112:115]
  ds_read_b64_tr_b16 a[94:95], v224 offset:28672
  v_mfma_f32_16x16x32_bf16 v[112:115], a[72:75], a[32:35], v[112:115]
  s_waitcnt vmcnt(17) lgkmcnt(4)
  v_mfma_f32_16x16x32_bf16 v[0:3], a[80:83], a[192:195], v[0:3]
  ds_read_b64_tr_b16 a[64:65], v225 offset:0
  v_fmac_f32 v160, v246, v238
  v_mfma_f32_16x16x32_bf16 v[0:3], a[84:87], a[208:211], v[0:3]
  s_waitcnt vmcnt(15)
  buffer_load_dwordx4 a[244:247], v231, s[4:7], s73 offen offset:3072 sc1
  ds_read_b128 v[242:245], v237 offset:704
  v_mfma_f32_16x16x32_bf16 v[4:7], a[84:87], a[212:215], v[4:7]
  s_add_u32 s73, s73, 4096
  ds_read_b64_tr_b16 a[66:67], v225 offset:4096
  v_fmac_f32 v161, v247, v238
  v_mfma_f32_16x16x32_bf16 v[4:7], a[80:83], a[196:199], v[4:7]
  s_waitcnt vmcnt(14)
  v_fmac_f32 v162, v248, v238
  v_fmac_f32 v163, v249, v238
  v_mfma_f32_16x16x32_bf16 v[8:11], a[80:83], a[200:203], v[8:11]
  ds_read_b64_tr_b16 a[68:69], v225 offset:8192
  v_fmac_f32 v164, v246, v239
  v_mfma_f32_16x16x32_bf16 v[8:11], a[84:87], a[216:219], v[8:11]
  s_waitcnt vmcnt(12)
  v_fmac_f32 v165, v247, v239
  v_fmac_f32 v166, v248, v239
  v_mfma_f32_16x16x32_bf16 v[12:15], a[84:87], a[220:223], v[12:15]
  ds_read_b64_tr_b16 a[70:71], v225 offset:12288
  v_fmac_f32 v167, v249, v239
  v_mfma_f32_16x16x32_bf16 v[12:15], a[80:83], a[204:207], v[12:15]
  s_waitcnt lgkmcnt(5)
  buffer_load_dwordx4 a[232:235], v231, s[4:7], s74 offen offset:2048 sc1
  v_fmac_f32 v168, v246, v240
  v_mfma_f32_16x16x32_bf16 v[28:31], a[88:91], a[204:207], v[28:31]
  ds_read_b64_tr_b16 a[72:73], v225 offset:16384
  v_fmac_f32 v169, v247, v240
  v_mfma_f32_16x16x32_bf16 v[28:31], a[92:95], a[220:223], v[28:31]
  v_fmac_f32 v170, v248, v240
  v_fmac_f32 v171, v249, v240
  v_mfma_f32_16x16x32_bf16 v[24:27], a[92:95], a[216:219], v[24:27]
  ds_read_b64_tr_b16 a[74:75], v225 offset:20480
  v_fmac_f32 v172, v246, v241
  v_mfma_f32_16x16x32_bf16 v[24:27], a[88:91], a[200:203], v[24:27]
  buffer_load_dwordx4 a[248:251], v231, s[4:7], s74 offen offset:3072 sc1
  v_fmac_f32 v173, v247, v241
  v_mfma_f32_16x16x32_bf16 v[20:23], a[88:91], a[196:199], v[20:23]
  s_add_u32 s74, s74, 4096
  ds_read_b64_tr_b16 a[76:77], v225 offset:24576
  v_fmac_f32 v174, v248, v241
  v_mfma_f32_16x16x32_bf16 v[20:23], a[92:95], a[212:215], v[20:23]
  v_fmac_f32 v175, v249, v241
  v_mfma_f32_16x16x32_bf16 v[16:19], a[92:95], a[208:211], v[16:19]
  ds_read_b64_tr_b16 a[78:79], v225 offset:28672
  v_mfma_f32_16x16x32_bf16 v[16:19], a[88:91], a[192:195], v[16:19]
  s_waitcnt lgkmcnt(4)
  v_mfma_f32_16x16x32_bf16 v[32:35], a[64:67], a[192:195], v[32:35]
  ds_read_b64_tr_b16 a[80:81], v226 offset:0
  v_fmac_f32 v176, v242, v238
  v_mfma_f32_16x16x32_bf16 v[32:35], a[68:71], a[208:211], v[32:35]
  buffer_load_dwordx4 a[236:239], v231, s[4:7], s75 offen offset:2048 sc1
  ds_read_b128 v[246:249], v237 offset:768
  v_mfma_f32_16x16x32_bf16 v[36:39], a[68:71], a[212:215], v[36:39]
  ds_read_b64_tr_b16 a[82:83], v226 offset:4096
  v_fmac_f32 v177, v243, v238
  v_mfma_f32_16x16x32_bf16 v[36:39], a[64:67], a[196:199], v[36:39]
  v_fmac_f32 v178, v244, v238
  v_fmac_f32 v179, v245, v238
  v_mfma_f32_16x16x32_bf16 v[40:43], a[64:67], a[200:203], v[40:43]
  ds_read_b64_tr_b16 a[84:85], v226 offset:8192
  v_fmac_f32 v180, v242, v239
  v_mfma_f32_16x16x32_bf16 v[40:43], a[68:71], a[216:219], v[40:43]
  buffer_load_dwordx4 a[252:255], v231, s[4:7], s75 offen offset:3072 sc1
  v_fmac_f32 v181, v243, v239
  v_mfma_f32_16x16x32_bf16 v[44:47], a[68:71], a[220:223], v[44:47]
  s_add_u32 s75, s75, 4096
  ds_read_b64_tr_b16 a[86:87], v226 offset:12288
  v_fmac_f32 v182, v244, v239
  v_mfma_f32_16x16x32_bf16 v[44:47], a[64:67], a[204:207], v[44:47]
  s_waitcnt lgkmcnt(5)
  v_fmac_f32 v183, v245, v239
  v_fmac_f32 v184, v242, v240
  v_mfma_f32_16x16x32_bf16 v[60:63], a[72:75], a[204:207], v[60:63]
  ds_read_b64_tr_b16 a[88:89], v226 offset:16384
  v_fmac_f32 v185, v243, v240
  v_mfma_f32_16x16x32_bf16 v[60:63], a[76:79], a[220:223], v[60:63]
  v_fmac_f32 v186, v244, v240
  v_fmac_f32 v187, v245, v240
  v_mfma_f32_16x16x32_bf16 v[56:59], a[76:79], a[216:219], v[56:59]
  ds_read_b64_tr_b16 a[90:91], v226 offset:20480
  v_fmac_f32 v188, v242, v241
  v_mfma_f32_16x16x32_bf16 v[56:59], a[72:75], a[200:203], v[56:59]
  s_add_u32 m0, s79, 0
  v_fmac_f32 v189, v243, v241
  v_fmac_f32 v190, v244, v241
  v_mfma_f32_16x16x32_bf16 v[52:55], a[72:75], a[196:199], v[52:55]
  s_add_u32 s92, s92, 0
  s_add_u32 s93, s92, s88
  ds_read_b64_tr_b16 a[92:93], v226 offset:24576
  v_fmac_f32 v191, v245, v241
  v_mfma_f32_16x16x32_bf16 v[52:55], a[76:79], a[212:215], v[52:55]
  buffer_load_dwordx4 v252, s[80:83], s93 offen lds
  v_mfma_f32_16x16x32_bf16 v[48:51], a[76:79], a[208:211], v[48:51]
  ds_read_b64_tr_b16 a[94:95], v226 offset:28672
  v_mfma_f32_16x16x32_bf16 v[48:51], a[72:75], a[192:195], v[48:51]
  s_waitcnt lgkmcnt(4)
  v_mfma_f32_16x16x32_bf16 v[64:67], a[80:83], a[192:195], v[64:67]
  ds_read_b64_tr_b16 a[64:65], v228 offset:32768
  v_fmac_f32 v192, v246, v238
  v_mfma_f32_16x16x32_bf16 v[64:67], a[84:87], a[208:211], v[64:67]
  ds_read_b128 v[242:245], v237 offset:832
  v_fmac_f32 v193, v247, v238
  v_mfma_f32_16x16x32_bf16 v[68:71], a[84:87], a[212:215], v[68:71]
  ds_read_b64_tr_b16 a[66:67], v228 offset:36864
  v_fmac_f32 v194, v248, v238
  v_mfma_f32_16x16x32_bf16 v[68:71], a[80:83], a[196:199], v[68:71]
  buffer_load_dwordx4 v252, s[84:87], s93 offen offset:1024 lds
  v_fmac_f32 v195, v249, v238
  v_fmac_f32 v196, v246, v239
  v_mfma_f32_16x16x32_bf16 v[72:75], a[80:83], a[200:203], v[72:75]
  ds_read_b64_tr_b16 a[68:69], v228 offset:40960
  v_fmac_f32 v197, v247, v239
  v_mfma_f32_16x16x32_bf16 v[72:75], a[84:87], a[216:219], v[72:75]
  v_fmac_f32 v198, v248, v239
  v_fmac_f32 v199, v249, v239
  v_mfma_f32_16x16x32_bf16 v[76:79], a[84:87], a[220:223], v[76:79]
  ds_read_b64_tr_b16 a[70:71], v228 offset:45056
  v_fmac_f32 v200, v246, v240
  v_mfma_f32_16x16x32_bf16 v[76:79], a[80:83], a[204:207], v[76:79]
  s_add_u32 m0, s79, 8192
  v_fmac_f32 v201, v247, v240
  v_fmac_f32 v202, v248, v240
  s_waitcnt lgkmcnt(5)
  v_mfma_f32_16x16x32_bf16 v[92:95], a[88:91], a[204:207], v[92:95]
  s_add_u32 s92, s92, 262144
  s_add_u32 s93, s92, s89
  ds_read_b64_tr_b16 a[72:73], v228 offset:49152
  v_fmac_f32 v203, v249, v240
  v_mfma_f32_16x16x32_bf16 v[92:95], a[92:95], a[220:223], v[92:95]
  buffer_load_dwordx4 v252, s[80:83], s93 offen lds
  v_fmac_f32 v204, v246, v241
  v_fmac_f32 v205, v247, v241
  v_mfma_f32_16x16x32_bf16 v[88:91], a[92:95], a[216:219], v[88:91]
  ds_read_b64_tr_b16 a[74:75], v228 offset:53248
  v_fmac_f32 v206, v248, v241
  v_mfma_f32_16x16x32_bf16 v[88:91], a[88:91], a[200:203], v[88:91]
  v_fmac_f32 v207, v249, v241
  v_mfma_f32_16x16x32_bf16 v[84:87], a[88:91], a[196:199], v[84:87]
  ds_read_b64_tr_b16 a[76:77], v228 offset:57344
  v_mfma_f32_16x16x32_bf16 v[84:87], a[92:95], a[212:215], v[84:87]
  v_mfma_f32_16x16x32_bf16 v[80:83], a[92:95], a[208:211], v[80:83]
  ds_read_b64_tr_b16 a[78:79], v228 offset:61440
  v_xor_b32 v228, 0x10000, v228
  v_mfma_f32_16x16x32_bf16 v[80:83], a[88:91], a[192:195], v[80:83]
  buffer_load_dwordx4 v252, s[84:87], s93 offen offset:1024 lds
  s_waitcnt lgkmcnt(4)
  v_mfma_f32_16x16x32_bf16 v[128:131], a[64:67], a[32:35], v[128:131]
  s_waitcnt vmcnt(12)
  s_barrier
  ds_read_b64_tr_b16 a[80:81], v224 offset:32768
  v_mfma_f32_16x16x32_bf16 v[128:131], a[68:71], a[48:51], v[128:131]
  v_fmac_f32 v208, v242, v238
  v_fmac_f32 v209, v243, v238
  v_mfma_f32_16x16x32_bf16 v[132:135], a[68:71], a[52:55], v[132:135]
  ds_read_b64_tr_b16 a[82:83], v224 offset:36864
  v_fmac_f32 v210, v244, v238
  v_mfma_f32_16x16x32_bf16 v[132:135], a[64:67], a[36:39], v[132:135]
  s_add_u32 m0, s79, 16384
  v_fmac_f32 v211, v245, v238
  v_fmac_f32 v212, v242, v239
  v_mfma_f32_16x16x32_bf16 v[136:139], a[64:67], a[40:43], v[136:139]
  s_add_u32 s92, s92, 196608
  s_add_u32 s93, s92, s90
  ds_read_b64_tr_b16 a[84:85], v224 offset:40960
  v_fmac_f32 v213, v243, v239
  v_mfma_f32_16x16x32_bf16 v[136:139], a[68:71], a[56:59], v[136:139]
  buffer_load_dwordx4 v252, s[80:83], s93 offen lds
  v_fmac_f32 v214, v244, v239
  v_fmac_f32 v215, v245, v239
  v_mfma_f32_16x16x32_bf16 v[140:143], a[68:71], a[60:63], v[140:143]
  ds_read_b64_tr_b16 a[86:87], v224 offset:45056
  v_fmac_f32 v216, v242, v240
  v_mfma_f32_16x16x32_bf16 v[140:143], a[64:67], a[44:47], v[140:143]
  s_waitcnt lgkmcnt(4)
  v_fmac_f32 v217, v243, v240
  v_fmac_f32 v218, v244, v240
  v_mfma_f32_16x16x32_bf16 v[156:159], a[72:75], a[44:47], v[156:159]
  ds_read_b64_tr_b16 a[88:89], v224 offset:49152
  v_fmac_f32 v219, v245, v240
  v_mfma_f32_16x16x32_bf16 v[156:159], a[76:79], a[60:63], v[156:159]
  v_fmac_f32 v220, v242, v241
  v_fmac_f32 v221, v243, v241
  v_mfma_f32_16x16x32_bf16 v[152:155], a[76:79], a[56:59], v[152:155]
  ds_read_b64_tr_b16 a[90:91], v224 offset:53248
  v_fmac_f32 v222, v244, v241
  v_mfma_f32_16x16x32_bf16 v[152:155], a[72:75], a[40:43], v[152:155]
  buffer_load_dwordx4 v252, s[84:87], s93 offen offset:1024 lds
  v_fmac_f32 v223, v245, v241
  v_mfma_f32_16x16x32_bf16 v[148:151], a[72:75], a[36:39], v[148:151]
  ds_read_b64_tr_b16 a[92:93], v224 offset:57344
  v_mfma_f32_16x16x32_bf16 v[148:151], a[76:79], a[52:55], v[148:151]
  v_mfma_f32_16x16x32_bf16 v[144:147], a[76:79], a[48:51], v[144:147]
  ds_read_b64_tr_b16 a[94:95], v224 offset:61440
  v_mfma_f32_16x16x32_bf16 v[144:147], a[72:75], a[32:35], v[144:147]
  s_add_u32 m0, s79, 24576
  s_waitcnt vmcnt(12) lgkmcnt(4)
  v_mfma_f32_16x16x32_bf16 v[0:3], a[80:83], a[224:227], v[0:3]
  s_add_u32 s92, s92, 262144
  s_add_u32 s93, s92, s91
  ds_read_b64_tr_b16 a[64:65], v229 offset:32768
  v_and_b32 v236, 31, v253
  v_mfma_f32_16x16x32_bf16 v[0:3], a[84:87], a[240:243], v[0:3]
  s_waitcnt vmcnt(10)
  buffer_load_dwordx4 v252, s[80:83], s93 offen lds
  v_lshlrev_b32 v236, 4, v236
  v_mfma_f32_16x16x32_bf16 v[4:7], a[84:87], a[244:247], v[4:7]
  ds_read_b64_tr_b16 a[66:67], v229 offset:36864
  v_lshrrev_b32 v250, 5, v253
  v_mfma_f32_16x16x32_bf16 v[4:7], a[80:83], a[228:231], v[4:7]
  s_mov_b32 s43, 114688
  v_mad_u32_u24 v236, v250, s43, v236
  v_and_b32 v250, 15, v253
  s_waitcnt vmcnt(9)
  v_mfma_f32_16x16x32_bf16 v[8:11], a[80:83], a[232:235], v[8:11]
  s_add_u32 s43, s71, 1024
  ds_read_b64_tr_b16 a[68:69], v229 offset:40960
  v_lshl_add_u32 v250, v250, 2, s43
  v_mfma_f32_16x16x32_bf16 v[8:11], a[84:87], a[248:251], v[8:11]
  s_waitcnt vmcnt(7)
  ds_read2_b32 v[238:239], v250 offset0:64 offset1:80
  ds_read2_b32 v[240:241], v250 offset0:96 offset1:112
  v_mfma_f32_16x16x32_bf16 v[12:15], a[84:87], a[252:255], v[12:15]
  ds_read_b64_tr_b16 a[70:71], v229 offset:45056
  ds_read2_b32 v[232:233], v250 offset0:128 offset1:144
  v_mfma_f32_16x16x32_bf16 v[12:15], a[80:83], a[236:239], v[12:15]
  s_waitcnt lgkmcnt(7)
  buffer_load_dwordx4 v252, s[84:87], s93 offen offset:1024 lds
  ds_read2_b32 v[234:235], v250 offset0:160 offset1:176
  v_mfma_f32_16x16x32_bf16 v[28:31], a[88:91], a[236:239], v[28:31]
  ds_read_b64_tr_b16 a[72:73], v229 offset:49152
  v_mfma_f32_16x16x32_bf16 v[28:31], a[92:95], a[252:255], v[28:31]
  v_mfma_f32_16x16x32_bf16 v[24:27], a[92:95], a[248:251], v[24:27]
  ds_read_b64_tr_b16 a[74:75], v229 offset:53248
  v_mfma_f32_16x16x32_bf16 v[24:27], a[88:91], a[232:235], v[24:27]
  v_mfma_f32_16x16x32_bf16 v[20:23], a[88:91], a[228:231], v[20:23]
  ds_read_b64_tr_b16 a[76:77], v229 offset:57344
  v_mfma_f32_16x16x32_bf16 v[20:23], a[92:95], a[244:247], v[20:23]
  v_mfma_f32_16x16x32_bf16 v[16:19], a[92:95], a[240:243], v[16:19]
  ds_read_b64_tr_b16 a[78:79], v229 offset:61440
  v_xor_b32 v229, 0x10000, v229
  v_mfma_f32_16x16x32_bf16 v[16:19], a[88:91], a[224:227], v[16:19]
  s_waitcnt lgkmcnt(6)
  v_mfma_f32_16x16x32_bf16 v[160:163], a[64:67], a[32:35], v[160:163]
  ds_read_b64_tr_b16 a[80:81], v225 offset:32768
  v_mfma_f32_16x16x32_bf16 v[160:163], a[68:71], a[48:51], v[160:163]
  v_mfma_f32_16x16x32_bf16 v[164:167], a[68:71], a[52:55], v[164:167]
  s_waitcnt lgkmcnt(5)
  ds_read_b64_tr_b16 a[82:83], v225 offset:36864
  v_mfma_f32_16x16x32_bf16 v[164:167], a[64:67], a[36:39], v[164:167]
  v_pk_mul_f32 v[242:243], v[0:1], v[238:239] op_sel:[0,0] op_sel_hi:[1,0]
  v_pk_mul_f32 v[244:245], v[2:3], v[238:239] op_sel:[0,0] op_sel_hi:[1,0]
  v_pk_mul_f32 v[0:1], v[0:1], v[16:17]
  v_pk_mul_f32 v[2:3], v[2:3], v[18:19]
  v_mfma_f32_16x16x32_bf16 v[168:171], a[64:67], a[40:43], v[168:171]
  ds_read_b64_tr_b16 a[84:85], v225 offset:40960
  v_mfma_f32_16x16x32_bf16 v[168:171], a[68:71], a[56:59], v[168:171]
  v_mfma_f32_16x16x32_bf16 v[172:175], a[68:71], a[60:63], v[172:175]
  ds_read_b64_tr_b16 a[86:87], v225 offset:45056
  v_mfma_f32_16x16x32_bf16 v[172:175], a[64:67], a[44:47], v[172:175]
  s_waitcnt lgkmcnt(4)
  v_mfma_f32_16x16x32_bf16 v[188:191], a[72:75], a[44:47], v[188:191]
  v_exp_f32 v242, v242
  v_mfma_f32_16x16x32_bf16 v[188:191], a[76:79], a[60:63], v[188:191]
  v_exp_f32 v243, v243
  v_mfma_f32_16x16x32_bf16 v[184:187], a[76:79], a[56:59], v[184:187]
  ds_read_b64_tr_b16 a[88:89], v225 offset:49152
  ds_read_b64_tr_b16 a[90:91], v225 offset:53248
  v_mfma_f32_16x16x32_bf16 v[184:187], a[72:75], a[40:43], v[184:187]
  v_exp_f32 v244, v244
  v_exp_f32 v245, v245
  s_nop 0
  v_pk_fma_f32 v[242:243], v[242:243], v[232:233], v[232:233] op_sel:[0,0,0] op_sel_hi:[1,0,0]
  v_pk_fma_f32 v[244:245], v[244:245], v[232:233], v[232:233] op_sel:[0,0,0] op_sel_hi:[1,0,0]
  v_pk_mul_f32 v[246:247], v[4:5], v[238:239] op_sel:[0,1] op_sel_hi:[1,1]
  v_pk_mul_f32 v[248:249], v[6:7], v[238:239] op_sel:[0,1] op_sel_hi:[1,1]
  v_pk_mul_f32 v[4:5], v[4:5], v[20:21]
  v_pk_mul_f32 v[6:7], v[6:7], v[22:23]
  v_rcp_f32 v242, v242
  v_mfma_f32_16x16x32_bf16 v[180:183], a[72:75], a[36:39], v[180:183]
  v_rcp_f32 v243, v243
  v_mfma_f32_16x16x32_bf16 v[180:183], a[76:79], a[52:55], v[180:183]
  v_rcp_f32 v244, v244
  v_mfma_f32_16x16x32_bf16 v[176:179], a[76:79], a[48:51], v[176:179]
  ds_read_b64_tr_b16 a[92:93], v225 offset:57344
  v_mfma_f32_16x16x32_bf16 v[176:179], a[72:75], a[32:35], v[176:179]
  ds_read_b64_tr_b16 a[94:95], v225 offset:61440
  s_waitcnt lgkmcnt(4)
  v_mfma_f32_16x16x32_bf16 v[32:35], a[80:83], a[224:227], v[32:35]
  v_exp_f32 v246, v246
  v_mfma_f32_16x16x32_bf16 v[32:35], a[84:87], a[240:243], v[32:35]
  v_exp_f32 v247, v247
  v_mfma_f32_16x16x32_bf16 v[36:39], a[84:87], a[244:247], v[36:39]
  ds_read_b64_tr_b16 a[64:65], v230 offset:32768
  ds_read_b64_tr_b16 a[66:67], v230 offset:36864
  v_mfma_f32_16x16x32_bf16 v[36:39], a[80:83], a[228:231], v[36:39]
  v_exp_f32 v248, v248
  v_exp_f32 v249, v249
  v_rcp_f32 v245, v245
  v_pk_fma_f32 v[246:247], v[246:247], v[232:233], v[232:233] op_sel:[0,1,1] op_sel_hi:[1,1,1]
  v_pk_fma_f32 v[248:249], v[248:249], v[232:233], v[232:233] op_sel:[0,1,1] op_sel_hi:[1,1,1]
  v_pk_mul_f32 v[0:1], v[0:1], v[242:243]
  v_pk_mul_f32 v[2:3], v[2:3], v[244:245]
  v_pk_mul_f32 v[242:243], v[8:9], v[240:241] op_sel:[0,0] op_sel_hi:[1,0]
  v_pk_mul_f32 v[244:245], v[10:11], v[240:241] op_sel:[0,0] op_sel_hi:[1,0]
  v_pk_mul_f32 v[8:9], v[8:9], v[24:25]
  v_pk_mul_f32 v[10:11], v[10:11], v[26:27]
  v_rcp_f32 v246, v246
  v_mfma_f32_16x16x32_bf16 v[40:43], a[80:83], a[232:235], v[40:43]
  v_rcp_f32 v247, v247
  v_mfma_f32_16x16x32_bf16 v[40:43], a[84:87], a[248:251], v[40:43]
  v_rcp_f32 v248, v248
  v_mfma_f32_16x16x32_bf16 v[44:47], a[84:87], a[252:255], v[44:47]
  ds_read_b64_tr_b16 a[68:69], v230 offset:40960
  v_cvt_pk_bf16_f32 v16, v0, v1
  v_mfma_f32_16x16x32_bf16 v[44:47], a[80:83], a[236:239], v[44:47]
  s_waitcnt lgkmcnt(3)
  ds_read_b64_tr_b16 a[70:71], v230 offset:45056
  v_cvt_pk_bf16_f32 v17, v2, v3
  v_mfma_f32_16x16x32_bf16 v[60:63], a[88:91], a[236:239], v[60:63]
  v_exp_f32 v242, v242
  v_mfma_f32_16x16x32_bf16 v[60:63], a[92:95], a[252:255], v[60:63]
  v_exp_f32 v243, v243
  v_mfma_f32_16x16x32_bf16 v[56:59], a[92:95], a[248:251], v[56:59]
  ds_read_b64_tr_b16 a[72:73], v230 offset:49152
  ds_read_b64_tr_b16 a[74:75], v230 offset:53248
  v_mfma_f32_16x16x32_bf16 v[56:59], a[88:91], a[232:235], v[56:59]
  v_exp_f32 v244, v244
  v_exp_f32 v245, v245
  v_rcp_f32 v249, v249
  v_pk_fma_f32 v[242:243], v[242:243], v[234:235], v[234:235] op_sel:[0,0,0] op_sel_hi:[1,0,0]
  v_pk_fma_f32 v[244:245], v[244:245], v[234:235], v[234:235] op_sel:[0,0,0] op_sel_hi:[1,0,0]
  v_pk_mul_f32 v[4:5], v[4:5], v[246:247]
  v_pk_mul_f32 v[6:7], v[6:7], v[248:249]
  v_pk_mul_f32 v[246:247], v[12:13], v[240:241] op_sel:[0,1] op_sel_hi:[1,1]
  v_pk_mul_f32 v[248:249], v[14:15], v[240:241] op_sel:[0,1] op_sel_hi:[1,1]
  v_pk_mul_f32 v[12:13], v[12:13], v[28:29]
  v_pk_mul_f32 v[14:15], v[14:15], v[30:31]
  v_rcp_f32 v242, v242
  v_mfma_f32_16x16x32_bf16 v[52:55], a[88:91], a[228:231], v[52:55]
  v_rcp_f32 v243, v243
  v_mfma_f32_16x16x32_bf16 v[52:55], a[92:95], a[244:247], v[52:55]
  v_rcp_f32 v244, v244
  v_mfma_f32_16x16x32_bf16 v[48:51], a[92:95], a[240:243], v[48:51]
  ds_read_b64_tr_b16 a[76:77], v230 offset:57344
  v_cvt_pk_bf16_f32 v20, v4, v5
  v_mfma_f32_16x16x32_bf16 v[48:51], a[88:91], a[224:227], v[48:51]
  s_waitcnt lgkmcnt(3)
  ds_read_b64_tr_b16 a[78:79], v230 offset:61440
  v_xor_b32 v230, 0x10000, v230
  v_cvt_pk_bf16_f32 v21, v6, v7
  v_mfma_f32_16x16x32_bf16 v[192:195], a[64:67], a[32:35], v[192:195]
  v_exp_f32 v246, v246
  v_mfma_f32_16x16x32_bf16 v[192:195], a[68:71], a[48:51], v[192:195]
  v_exp_f32 v247, v247
  v_mfma_f32_16x16x32_bf16 v[196:199], a[68:71], a[52:55], v[196:199]
  ds_read_b64_tr_b16 a[80:81], v226 offset:32768
  ds_read_b64_tr_b16 a[82:83], v226 offset:36864
  v_mfma_f32_16x16x32_bf16 v[196:199], a[64:67], a[36:39], v[196:199]
  v_exp_f32 v248, v248
  v_exp_f32 v249, v249
  v_rcp_f32 v245, v245
  v_pk_fma_f32 v[246:247], v[246:247], v[234:235], v[234:235] op_sel:[0,1,1] op_sel_hi:[1,1,1]
  v_pk_fma_f32 v[248:249], v[248:249], v[234:235], v[234:235] op_sel:[0,1,1] op_sel_hi:[1,1,1]
  v_pk_mul_f32 v[8:9], v[8:9], v[242:243]
  v_pk_mul_f32 v[10:11], v[10:11], v[244:245]
  v_pk_mul_f32 v[242:243], v[32:33], v[238:239] op_sel:[0,0] op_sel_hi:[1,0]
  v_pk_mul_f32 v[244:245], v[34:35], v[238:239] op_sel:[0,0] op_sel_hi:[1,0]
  v_pk_mul_f32 v[32:33], v[32:33], v[48:49]
  v_pk_mul_f32 v[34:35], v[34:35], v[50:51]
  v_rcp_f32 v246, v246
  v_mfma_f32_16x16x32_bf16 v[200:203], a[64:67], a[40:43], v[200:203]
  v_rcp_f32 v247, v247
  v_mfma_f32_16x16x32_bf16 v[200:203], a[68:71], a[56:59], v[200:203]
  v_rcp_f32 v248, v248
  v_mfma_f32_16x16x32_bf16 v[204:207], a[68:71], a[60:63], v[204:207]
  ds_read_b64_tr_b16 a[84:85], v226 offset:40960
  v_cvt_pk_bf16_f32 v24, v8, v9
  v_mfma_f32_16x16x32_bf16 v[204:207], a[64:67], a[44:47], v[204:207]
  s_waitcnt lgkmcnt(3)
  ds_read_b64_tr_b16 a[86:87], v226 offset:45056
  v_cvt_pk_bf16_f32 v25, v10, v11
  v_mfma_f32_16x16x32_bf16 v[220:223], a[72:75], a[44:47], v[220:223]
  v_exp_f32 v242, v242
  v_mfma_f32_16x16x32_bf16 v[220:223], a[76:79], a[60:63], v[220:223]
  v_exp_f32 v243, v243
  v_mfma_f32_16x16x32_bf16 v[216:219], a[76:79], a[56:59], v[216:219]
  ds_read_b64_tr_b16 a[88:89], v226 offset:49152
  ds_read_b64_tr_b16 a[90:91], v226 offset:53248
  v_mfma_f32_16x16x32_bf16 v[216:219], a[72:75], a[40:43], v[216:219]
  v_exp_f32 v244, v244
  v_exp_f32 v245, v245
  v_rcp_f32 v249, v249
  v_pk_fma_f32 v[242:243], v[242:243], v[232:233], v[232:233] op_sel:[0,0,0] op_sel_hi:[1,0,0]
  v_pk_fma_f32 v[244:245], v[244:245], v[232:233], v[232:233] op_sel:[0,0,0] op_sel_hi:[1,0,0]
  v_pk_mul_f32 v[12:13], v[12:13], v[246:247]
  v_pk_mul_f32 v[14:15], v[14:15], v[248:249]
  v_pk_mul_f32 v[246:247], v[36:37], v[238:239] op_sel:[0,1] op_sel_hi:[1,1]
  v_pk_mul_f32 v[248:249], v[38:39], v[238:239] op_sel:[0,1] op_sel_hi:[1,1]
  v_pk_mul_f32 v[36:37], v[36:37], v[52:53]
  v_pk_mul_f32 v[38:39], v[38:39], v[54:55]
  v_rcp_f32 v242, v242
  v_mfma_f32_16x16x32_bf16 v[212:215], a[72:75], a[36:39], v[212:215]
  v_rcp_f32 v243, v243
  v_mfma_f32_16x16x32_bf16 v[212:215], a[76:79], a[52:55], v[212:215]
  v_rcp_f32 v244, v244
  v_mfma_f32_16x16x32_bf16 v[208:211], a[76:79], a[48:51], v[208:211]
  ds_read_b64_tr_b16 a[92:93], v226 offset:57344
  v_cvt_pk_bf16_f32 v28, v12, v13
  v_mfma_f32_16x16x32_bf16 v[208:211], a[72:75], a[32:35], v[208:211]
  s_waitcnt lgkmcnt(3)
  ds_read_b64_tr_b16 a[94:95], v226 offset:61440
  v_cvt_pk_bf16_f32 v29, v14, v15
  v_mfma_f32_16x16x32_bf16 v[64:67], a[80:83], a[224:227], v[64:67]
  v_exp_f32 v246, v246
  v_mfma_f32_16x16x32_bf16 v[64:67], a[84:87], a[240:243], v[64:67]
  v_exp_f32 v247, v247
  v_mfma_f32_16x16x32_bf16 v[68:71], a[84:87], a[244:247], v[68:71]
  ds_read_b64_tr_b16 a[64:65], v227 offset:0
  ds_read_b64_tr_b16 a[66:67], v227 offset:4096
  v_mfma_f32_16x16x32_bf16 v[68:71], a[80:83], a[228:231], v[68:71]
  v_exp_f32 v248, v248
  v_exp_f32 v249, v249
  v_rcp_f32 v245, v245
  v_pk_fma_f32 v[246:247], v[246:247], v[232:233], v[232:233] op_sel:[0,1,1] op_sel_hi:[1,1,1]
  v_pk_fma_f32 v[248:249], v[248:249], v[232:233], v[232:233] op_sel:[0,1,1] op_sel_hi:[1,1,1]
  v_pk_mul_f32 v[32:33], v[32:33], v[242:243]
  v_pk_mul_f32 v[34:35], v[34:35], v[244:245]
  v_pk_mul_f32 v[242:243], v[40:41], v[240:241] op_sel:[0,0] op_sel_hi:[1,0]
  v_pk_mul_f32 v[244:245], v[42:43], v[240:241] op_sel:[0,0] op_sel_hi:[1,0]
  v_pk_mul_f32 v[40:41], v[40:41], v[56:57]
  v_pk_mul_f32 v[42:43], v[42:43], v[58:59]
  v_rcp_f32 v246, v246
  v_mfma_f32_16x16x32_bf16 v[72:75], a[80:83], a[232:235], v[72:75]
  v_rcp_f32 v247, v247
  v_mfma_f32_16x16x32_bf16 v[72:75], a[84:87], a[248:251], v[72:75]
  v_rcp_f32 v248, v248
  v_mfma_f32_16x16x32_bf16 v[76:79], a[84:87], a[252:255], v[76:79]
  ds_read_b64_tr_b16 a[68:69], v227 offset:8192
  v_cvt_pk_bf16_f32 v18, v32, v33
  v_mfma_f32_16x16x32_bf16 v[76:79], a[80:83], a[236:239], v[76:79]
  s_waitcnt lgkmcnt(3)
  ds_read_b64_tr_b16 a[70:71], v227 offset:12288
  v_cvt_pk_bf16_f32 v19, v34, v35
  v_mfma_f32_16x16x32_bf16 v[92:95], a[88:91], a[236:239], v[92:95]
  buffer_store_dwordx4 v[16:19], v231, s[4:7], s57 offen sc1
  s_add_u32 s57, s57, 16384
  v_exp_f32 v242, v242
  v_mfma_f32_16x16x32_bf16 v[92:95], a[92:95], a[252:255], v[92:95]
  v_exp_f32 v243, v243
  v_mfma_f32_16x16x32_bf16 v[88:91], a[92:95], a[248:251], v[88:91]
  ds_read_b64_tr_b16 a[72:73], v227 offset:16384
  ds_read_b64_tr_b16 a[74:75], v227 offset:20480
  v_mfma_f32_16x16x32_bf16 v[88:91], a[88:91], a[232:235], v[88:91]
  v_exp_f32 v244, v244
  v_exp_f32 v245, v245
  v_rcp_f32 v249, v249
  v_pk_fma_f32 v[242:243], v[242:243], v[234:235], v[234:235] op_sel:[0,0,0] op_sel_hi:[1,0,0]
  v_pk_fma_f32 v[244:245], v[244:245], v[234:235], v[234:235] op_sel:[0,0,0] op_sel_hi:[1,0,0]
  v_pk_mul_f32 v[36:37], v[36:37], v[246:247]
  v_pk_mul_f32 v[38:39], v[38:39], v[248:249]
  v_pk_mul_f32 v[246:247], v[44:45], v[240:241] op_sel:[0,1] op_sel_hi:[1,1]
  v_pk_mul_f32 v[248:249], v[46:47], v[240:241] op_sel:[0,1] op_sel_hi:[1,1]
  v_pk_mul_f32 v[44:45], v[44:45], v[60:61]
  v_pk_mul_f32 v[46:47], v[46:47], v[62:63]
  v_rcp_f32 v242, v242
  v_mfma_f32_16x16x32_bf16 v[84:87], a[88:91], a[228:231], v[84:87]
  v_rcp_f32 v243, v243
  v_mfma_f32_16x16x32_bf16 v[84:87], a[92:95], a[244:247], v[84:87]
  v_rcp_f32 v244, v244
  v_mfma_f32_16x16x32_bf16 v[80:83], a[92:95], a[240:243], v[80:83]
  ds_read_b64_tr_b16 a[76:77], v227 offset:24576
  v_cvt_pk_bf16_f32 v22, v36, v37
  v_mfma_f32_16x16x32_bf16 v[80:83], a[88:91], a[224:227], v[80:83]
  s_waitcnt lgkmcnt(3)
  ds_read_b64_tr_b16 a[78:79], v227 offset:28672
  v_cvt_pk_bf16_f32 v23, v38, v39
  v_mfma_f32_16x16x32_bf16 v[96:99], a[64:67], a[192:195], v[96:99]
  buffer_store_dwordx4 v[20:23], v231, s[4:7], s58 offen sc1
  s_add_u32 s58, s58, 16384
  v_exp_f32 v246, v246
  v_mfma_f32_16x16x32_bf16 v[96:99], a[68:71], a[208:211], v[96:99]
  v_exp_f32 v247, v247
  v_mfma_f32_16x16x32_bf16 v[100:103], a[68:71], a[212:215], v[100:103]
  ds_read_b64_tr_b16 a[80:81], v227 offset:32768
  ds_read_b64_tr_b16 a[82:83], v227 offset:36864
  v_mfma_f32_16x16x32_bf16 v[100:103], a[64:67], a[196:199], v[100:103]
  v_exp_f32 v248, v248
  v_exp_f32 v249, v249
  v_rcp_f32 v245, v245
  v_pk_fma_f32 v[246:247], v[246:247], v[234:235], v[234:235] op_sel:[0,1,1] op_sel_hi:[1,1,1]
  v_pk_fma_f32 v[248:249], v[248:249], v[234:235], v[234:235] op_sel:[0,1,1] op_sel_hi:[1,1,1]
  v_pk_mul_f32 v[40:41], v[40:41], v[242:243]
  v_pk_mul_f32 v[42:43], v[42:43], v[244:245]
  v_pk_mul_f32 v[242:243], v[64:65], v[238:239] op_sel:[0,0] op_sel_hi:[1,0]
  v_pk_mul_f32 v[244:245], v[66:67], v[238:239] op_sel:[0,0] op_sel_hi:[1,0]
  v_pk_mul_f32 v[64:65], v[64:65], v[80:81]
  v_pk_mul_f32 v[66:67], v[66:67], v[82:83]
  v_rcp_f32 v246, v246
  v_mfma_f32_16x16x32_bf16 v[104:107], a[64:67], a[200:203], v[104:107]
  v_rcp_f32 v247, v247
  v_mfma_f32_16x16x32_bf16 v[104:107], a[68:71], a[216:219], v[104:107]
  v_rcp_f32 v248, v248
  v_mfma_f32_16x16x32_bf16 v[108:111], a[68:71], a[220:223], v[108:111]
  ds_read_b64_tr_b16 a[84:85], v227 offset:40960
  v_cvt_pk_bf16_f32 v26, v40, v41
  v_mfma_f32_16x16x32_bf16 v[108:111], a[64:67], a[204:207], v[108:111]
  s_waitcnt lgkmcnt(3)
  ds_read_b64_tr_b16 a[86:87], v227 offset:45056
  v_cvt_pk_bf16_f32 v27, v42, v43
  v_mfma_f32_16x16x32_bf16 v[124:127], a[72:75], a[204:207], v[124:127]
  buffer_store_dwordx4 v[24:27], v231, s[4:7], s59 offen sc1
  s_add_u32 s59, s59, 16384
  v_exp_f32 v242, v242
  v_mfma_f32_16x16x32_bf16 v[124:127], a[76:79], a[220:223], v[124:127]
  v_exp_f32 v243, v243
  v_mfma_f32_16x16x32_bf16 v[120:123], a[76:79], a[216:219], v[120:123]
  ds_read_b64_tr_b16 a[88:89], v227 offset:49152
  ds_read_b64_tr_b16 a[90:91], v227 offset:53248
  v_mfma_f32_16x16x32_bf16 v[120:123], a[72:75], a[200:203], v[120:123]
  v_exp_f32 v244, v244
  v_exp_f32 v245, v245
  v_rcp_f32 v249, v249
  v_pk_fma_f32 v[242:243], v[242:243], v[232:233], v[232:233] op_sel:[0,0,0] op_sel_hi:[1,0,0]
  v_pk_fma_f32 v[244:245], v[244:245], v[232:233], v[232:233] op_sel:[0,0,0] op_sel_hi:[1,0,0]
  v_pk_mul_f32 v[44:45], v[44:45], v[246:247]
  v_pk_mul_f32 v[46:47], v[46:47], v[248:249]
  v_pk_mul_f32 v[246:247], v[68:69], v[238:239] op_sel:[0,1] op_sel_hi:[1,1]
  v_pk_mul_f32 v[248:249], v[70:71], v[238:239] op_sel:[0,1] op_sel_hi:[1,1]
  v_pk_mul_f32 v[68:69], v[68:69], v[84:85]
  v_pk_mul_f32 v[70:71], v[70:71], v[86:87]
  v_rcp_f32 v242, v242
  v_mfma_f32_16x16x32_bf16 v[116:119], a[72:75], a[196:199], v[116:119]
  v_rcp_f32 v243, v243
  v_mfma_f32_16x16x32_bf16 v[116:119], a[76:79], a[212:215], v[116:119]
  v_rcp_f32 v244, v244
  v_mfma_f32_16x16x32_bf16 v[112:115], a[76:79], a[208:211], v[112:115]
  ds_read_b64_tr_b16 a[92:93], v227 offset:57344
  v_cvt_pk_bf16_f32 v30, v44, v45
  v_mfma_f32_16x16x32_bf16 v[112:115], a[72:75], a[192:195], v[112:115]
  s_waitcnt lgkmcnt(3)
  ds_read_b64_tr_b16 a[94:95], v227 offset:61440
  v_cvt_pk_bf16_f32 v31, v46, v47
  v_mfma_f32_16x16x32_bf16 v[96:99], a[80:83], a[224:227], v[96:99]
  buffer_store_dwordx4 v[28:31], v231, s[4:7], s60 offen sc1
  s_add_u32 s60, s60, 16384
  v_exp_f32 v246, v246
  v_mfma_f32_16x16x32_bf16 v[96:99], a[84:87], a[240:243], v[96:99]
  v_exp_f32 v247, v247
  v_mfma_f32_16x16x32_bf16 v[100:103], a[84:87], a[244:247], v[100:103]
  ds_read_b64_tr_b16 a[64:65], v228 offset:0
  ds_read_b64_tr_b16 a[66:67], v228 offset:4096
  v_mfma_f32_16x16x32_bf16 v[100:103], a[80:83], a[228:231], v[100:103]
  v_exp_f32 v248, v248
  v_exp_f32 v249, v249
  v_rcp_f32 v245, v245
  v_pk_fma_f32 v[246:247], v[246:247], v[232:233], v[232:233] op_sel:[0,1,1] op_sel_hi:[1,1,1]
  v_pk_fma_f32 v[248:249], v[248:249], v[232:233], v[232:233] op_sel:[0,1,1] op_sel_hi:[1,1,1]
  v_pk_mul_f32 v[64:65], v[64:65], v[242:243]
  v_pk_mul_f32 v[66:67], v[66:67], v[244:245]
  v_pk_mul_f32 v[242:243], v[72:73], v[240:241] op_sel:[0,0] op_sel_hi:[1,0]
  v_pk_mul_f32 v[244:245], v[74:75], v[240:241] op_sel:[0,0] op_sel_hi:[1,0]
  v_pk_mul_f32 v[72:73], v[72:73], v[88:89]
  v_pk_mul_f32 v[74:75], v[74:75], v[90:91]
  v_rcp_f32 v246, v246
  v_mfma_f32_16x16x32_bf16 v[104:107], a[80:83], a[232:235], v[104:107]
  v_rcp_f32 v247, v247
  v_lshlrev_b32 v8, 4, v253
  v_mfma_f32_16x16x32_bf16 v[104:107], a[84:87], a[248:251], v[104:107]
  v_rcp_f32 v248, v248
  v_add_u32 v9, 114688, v8
  v_mfma_f32_16x16x32_bf16 v[108:111], a[84:87], a[252:255], v[108:111]
  ds_read_b64_tr_b16 a[68:69], v228 offset:8192
  v_cvt_pk_bf16_f32 v80, v64, v65
  v_mfma_f32_16x16x32_bf16 v[108:111], a[80:83], a[236:239], v[108:111]
  s_waitcnt lgkmcnt(3)
  ds_read_b64_tr_b16 a[70:71], v228 offset:12288
  v_cvt_pk_bf16_f32 v81, v66, v67
  v_mfma_f32_16x16x32_bf16 v[124:127], a[88:91], a[236:239], v[124:127]
  buffer_load_dwordx4 v[16:19], v8, s[4:7], s46 offen offset:0 sc1
  v_exp_f32 v242, v242
  v_mfma_f32_16x16x32_bf16 v[124:127], a[92:95], a[252:255], v[124:127]
  buffer_load_dwordx4 v[20:23], v8, s[4:7], s46 offen offset:1024 sc1
  v_exp_f32 v243, v243
  v_mfma_f32_16x16x32_bf16 v[120:123], a[92:95], a[248:251], v[120:123]
  ds_read_b64_tr_b16 a[72:73], v228 offset:16384
  ds_read_b64_tr_b16 a[74:75], v228 offset:20480
  v_mfma_f32_16x16x32_bf16 v[120:123], a[88:91], a[232:235], v[120:123]
  v_exp_f32 v244, v244
  v_exp_f32 v245, v245
  v_rcp_f32 v249, v249
  v_pk_fma_f32 v[242:243], v[242:243], v[234:235], v[234:235] op_sel:[0,0,0] op_sel_hi:[1,0,0]
  v_pk_fma_f32 v[244:245], v[244:245], v[234:235], v[234:235] op_sel:[0,0,0] op_sel_hi:[1,0,0]
  v_pk_mul_f32 v[68:69], v[68:69], v[246:247]
  v_pk_mul_f32 v[70:71], v[70:71], v[248:249]
  v_pk_mul_f32 v[246:247], v[76:77], v[240:241] op_sel:[0,1] op_sel_hi:[1,1]
  v_pk_mul_f32 v[248:249], v[78:79], v[240:241] op_sel:[0,1] op_sel_hi:[1,1]
  v_pk_mul_f32 v[76:77], v[76:77], v[92:93]
  v_pk_mul_f32 v[78:79], v[78:79], v[94:95]
  v_rcp_f32 v242, v242
  v_mfma_f32_16x16x32_bf16 v[116:119], a[88:91], a[228:231], v[116:119]
  buffer_load_dwordx4 v[24:27], v8, s[4:7], s47 offen offset:0 sc1
  v_rcp_f32 v243, v243
  v_mfma_f32_16x16x32_bf16 v[116:119], a[92:95], a[244:247], v[116:119]
  buffer_load_dwordx4 v[28:31], v8, s[4:7], s47 offen offset:1024 sc1
  v_rcp_f32 v244, v244
  v_mfma_f32_16x16x32_bf16 v[112:115], a[92:95], a[240:243], v[112:115]
  ds_read_b64_tr_b16 a[76:77], v228 offset:24576
  v_cvt_pk_bf16_f32 v84, v68, v69
  v_mfma_f32_16x16x32_bf16 v[112:115], a[88:91], a[224:227], v[112:115]
  s_waitcnt lgkmcnt(3)
  ds_read_b64_tr_b16 a[78:79], v228 offset:28672
  v_cvt_pk_bf16_f32 v85, v70, v71
  v_mfma_f32_16x16x32_bf16 v[128:131], a[64:67], a[192:195], v[128:131]
  v_exp_f32 v246, v246
  v_bfe_u32 v11, v253, 2, 3
  v_mfma_f32_16x16x32_bf16 v[128:131], a[68:71], a[208:211], v[128:131]
  v_exp_f32 v247, v247
  v_bfe_u32 v12, v253, 3, 2
  v_mfma_f32_16x16x32_bf16 v[132:135], a[68:71], a[212:215], v[132:135]
  ds_read_b64_tr_b16 a[80:81], v228 offset:32768
  ds_read_b64_tr_b16 a[82:83], v228 offset:36864
  v_mfma_f32_16x16x32_bf16 v[132:135], a[64:67], a[196:199], v[132:135]
  v_exp_f32 v248, v248
  v_exp_f32 v249, v249
  v_rcp_f32 v245, v245
  v_pk_fma_f32 v[246:247], v[246:247], v[234:235], v[234:235] op_sel:[0,1,1] op_sel_hi:[1,1,1]
  v_pk_fma_f32 v[248:249], v[248:249], v[234:235], v[234:235] op_sel:[0,1,1] op_sel_hi:[1,1,1]
  v_pk_mul_f32 v[72:73], v[72:73], v[242:243]
  v_pk_mul_f32 v[74:75], v[74:75], v[244:245]
  v_pk_mul_f32 v[242:243], v[96:97], v[238:239] op_sel:[0,0] op_sel_hi:[1,0]
  v_pk_mul_f32 v[244:245], v[98:99], v[238:239] op_sel:[0,0] op_sel_hi:[1,0]
  v_pk_mul_f32 v[96:97], v[96:97], v[112:113]
  v_pk_mul_f32 v[98:99], v[98:99], v[114:115]
  v_rcp_f32 v246, v246
  v_mfma_f32_16x16x32_bf16 v[136:139], a[64:67], a[200:203], v[136:139]
  v_rcp_f32 v247, v247
  v_and_b32 v13, 3, v253
  v_mfma_f32_16x16x32_bf16 v[136:139], a[68:71], a[216:219], v[136:139]
  v_rcp_f32 v248, v248
  v_lshlrev_b32 v13, 3, v13
  v_mfma_f32_16x16x32_bf16 v[140:143], a[68:71], a[220:223], v[140:143]
  ds_read_b64_tr_b16 a[84:85], v228 offset:40960
  v_cvt_pk_bf16_f32 v88, v72, v73
  v_mfma_f32_16x16x32_bf16 v[140:143], a[64:67], a[204:207], v[140:143]
  s_waitcnt lgkmcnt(3)
  ds_read_b64_tr_b16 a[86:87], v228 offset:45056
  v_cvt_pk_bf16_f32 v89, v74, v75
  v_mfma_f32_16x16x32_bf16 v[156:159], a[72:75], a[204:207], v[156:159]
  v_exp_f32 v242, v242
  v_lshl_add_u32 v13, v11, 7, v13
  v_mfma_f32_16x16x32_bf16 v[156:159], a[76:79], a[220:223], v[156:159]
  v_exp_f32 v243, v243
  v_lshrrev_b32 v11, 5, v253
  v_mfma_f32_16x16x32_bf16 v[152:155], a[76:79], a[216:219], v[152:155]
  ds_read_b64_tr_b16 a[88:89], v228 offset:49152
  ds_read_b64_tr_b16 a[90:91], v228 offset:53248
  v_mfma_f32_16x16x32_bf16 v[152:155], a[72:75], a[200:203], v[152:155]
  v_exp_f32 v244, v244
  v_exp_f32 v245, v245
  v_rcp_f32 v249, v249
  v_pk_fma_f32 v[242:243], v[242:243], v[232:233], v[232:233] op_sel:[0,0,0] op_sel_hi:[1,0,0]
  v_pk_fma_f32 v[244:245], v[244:245], v[232:233], v[232:233] op_sel:[0,0,0] op_sel_hi:[1,0,0]
  v_pk_mul_f32 v[76:77], v[76:77], v[246:247]
  v_pk_mul_f32 v[78:79], v[78:79], v[248:249]
  v_pk_mul_f32 v[246:247], v[100:101], v[238:239] op_sel:[0,1] op_sel_hi:[1,1]
  v_pk_mul_f32 v[248:249], v[102:103], v[238:239] op_sel:[0,1] op_sel_hi:[1,1]
  v_pk_mul_f32 v[100:101], v[100:101], v[116:117]
  v_pk_mul_f32 v[102:103], v[102:103], v[118:119]
  v_rcp_f32 v242, v242
  v_mfma_f32_16x16x32_bf16 v[148:151], a[72:75], a[196:199], v[148:151]
  s_waitcnt vmcnt(4)
  s_barrier
  s_cmp_lg_u32 s40, 0
  s_cbranch_scc1 Lsgf17
  v_mov_b32 v250, 1
  s_mov_b64 exec, 1
  buffer_atomic_add v250, v251, s[4:7], s77 offen sc1
  s_mov_b64 exec, -1
Lsgf17:
  s_add_u32 s77, s77, 4096
  v_rcp_f32 v243, v243
  v_lshl_add_u32 v13, v11, 11, v13
  v_mfma_f32_16x16x32_bf16 v[148:151], a[76:79], a[212:215], v[148:151]
  s_add_u32 m0, s79, 32768
  v_rcp_f32 v244, v244
  v_xor_b32 v11, 0, v12
  v_mfma_f32_16x16x32_bf16 v[144:147], a[76:79], a[208:211], v[144:147]
  s_add_u32 s92, s92, 196608
  s_add_u32 s93, s92, s88
  ds_read_b64_tr_b16 a[92:93], v228 offset:57344
  v_cvt_pk_bf16_f32 v92, v76, v77
  v_mfma_f32_16x16x32_bf16 v[144:147], a[72:75], a[192:195], v[144:147]
  s_waitcnt lgkmcnt(3)
  ds_read_b64_tr_b16 a[94:95], v228 offset:61440
  v_cvt_pk_bf16_f32 v93, v78, v79
  v_mfma_f32_16x16x32_bf16 v[128:131], a[80:83], a[224:227], v[128:131]
  buffer_load_dwordx4 v252, s[80:83], s93 offen lds
  v_exp_f32 v246, v246
  v_mfma_f32_16x16x32_bf16 v[128:131], a[84:87], a[240:243], v[128:131]
  buffer_load_dwordx4 v252, s[84:87], s93 offen offset:1024 lds
  v_exp_f32 v247, v247
  v_mfma_f32_16x16x32_bf16 v[132:135], a[84:87], a[244:247], v[132:135]
  ds_read_b64_tr_b16 a[64:65], v229 offset:0
  ds_read_b64_tr_b16 a[66:67], v229 offset:4096
  v_mfma_f32_16x16x32_bf16 v[132:135], a[80:83], a[228:231], v[132:135]
  v_exp_f32 v248, v248
  v_exp_f32 v249, v249
  v_rcp_f32 v245, v245
  v_pk_fma_f32 v[246:247], v[246:247], v[232:233], v[232:233] op_sel:[0,1,1] op_sel_hi:[1,1,1]
  v_pk_fma_f32 v[248:249], v[248:249], v[232:233], v[232:233] op_sel:[0,1,1] op_sel_hi:[1,1,1]
  v_pk_mul_f32 v[96:97], v[96:97], v[242:243]
  v_pk_mul_f32 v[98:99], v[98:99], v[244:245]
  v_pk_mul_f32 v[242:243], v[104:105], v[240:241] op_sel:[0,0] op_sel_hi:[1,0]
  v_pk_mul_f32 v[244:245], v[106:107], v[240:241] op_sel:[0,0] op_sel_hi:[1,0]
  v_pk_mul_f32 v[104:105], v[104:105], v[120:121]
  v_pk_mul_f32 v[106:107], v[106:107], v[122:123]
  v_rcp_f32 v246, v246
  v_mfma_f32_16x16x32_bf16 v[136:139], a[80:83], a[232:235], v[136:139]
  s_add_u32 m0, s79, 40960
  v_rcp_f32 v247, v247
  v_lshl_add_u32 v0, v11, 5, v13
  v_mfma_f32_16x16x32_bf16 v[136:139], a[84:87], a[248:251], v[136:139]
  s_add_u32 s92, s92, 262144
  s_add_u32 s93, s92, s89
  buffer_load_dwordx4 v252, s[80:83], s93 offen lds
  v_rcp_f32 v248, v248
  v_mfma_f32_16x16x32_bf16 v[140:143], a[84:87], a[252:255], v[140:143]
  ds_read_b64_tr_b16 a[68:69], v229 offset:8192
  v_cvt_pk_bf16_f32 v82, v96, v97
  v_mfma_f32_16x16x32_bf16 v[140:143], a[80:83], a[236:239], v[140:143]
  s_waitcnt lgkmcnt(3)
  ds_read_b64_tr_b16 a[70:71], v229 offset:12288
  v_cvt_pk_bf16_f32 v83, v98, v99
  v_mfma_f32_16x16x32_bf16 v[156:159], a[88:91], a[236:239], v[156:159]
  buffer_load_dwordx4 v252, s[84:87], s93 offen offset:1024 lds
  buffer_store_dwordx4 v[80:83], v231, s[4:7], s57 offen sc1
  s_add_u32 s57, s57, 16384
  v_exp_f32 v242, v242
  v_mfma_f32_16x16x32_bf16 v[156:159], a[92:95], a[252:255], v[156:159]
  v_exp_f32 v243, v243
  v_add_u32 v4, 0x10000, v0
  v_mfma_f32_16x16x32_bf16 v[152:155], a[92:95], a[248:251], v[152:155]
  ds_read_b64_tr_b16 a[72:73], v229 offset:16384
  ds_read_b64_tr_b16 a[74:75], v229 offset:20480
  v_mfma_f32_16x16x32_bf16 v[152:155], a[88:91], a[232:235], v[152:155]
  v_exp_f32 v244, v244
  v_exp_f32 v245, v245
  v_rcp_f32 v249, v249
  v_pk_fma_f32 v[242:243], v[242:243], v[234:235], v[234:235] op_sel:[0,0,0] op_sel_hi:[1,0,0]
  v_pk_fma_f32 v[244:245], v[244:245], v[234:235], v[234:235] op_sel:[0,0,0] op_sel_hi:[1,0,0]
  v_pk_mul_f32 v[100:101], v[100:101], v[246:247]
  v_pk_mul_f32 v[102:103], v[102:103], v[248:249]
  v_pk_mul_f32 v[246:247], v[108:109], v[240:241] op_sel:[0,1] op_sel_hi:[1,1]
  v_pk_mul_f32 v[248:249], v[110:111], v[240:241] op_sel:[0,1] op_sel_hi:[1,1]
  v_pk_mul_f32 v[108:109], v[108:109], v[124:125]
  v_pk_mul_f32 v[110:111], v[110:111], v[126:127]
  v_rcp_f32 v242, v242
  v_mfma_f32_16x16x32_bf16 v[148:151], a[88:91], a[228:231], v[148:151]
  s_add_u32 m0, s79, 49152
  v_rcp_f32 v243, v243
  v_xor_b32 v11, 1, v12
  v_mfma_f32_16x16x32_bf16 v[148:151], a[92:95], a[244:247], v[148:151]
  s_add_u32 s92, s92, 196608
  s_add_u32 s93, s92, s90
  buffer_load_dwordx4 v252, s[80:83], s93 offen lds
  v_rcp_f32 v244, v244
  v_mfma_f32_16x16x32_bf16 v[144:147], a[92:95], a[240:243], v[144:147]
  ds_read_b64_tr_b16 a[76:77], v229 offset:24576
  v_cvt_pk_bf16_f32 v86, v100, v101
  v_mfma_f32_16x16x32_bf16 v[144:147], a[88:91], a[224:227], v[144:147]
  s_waitcnt lgkmcnt(3)
  ds_read_b64_tr_b16 a[78:79], v229 offset:28672
  v_cvt_pk_bf16_f32 v87, v102, v103
  v_mfma_f32_16x16x32_bf16 v[160:163], a[64:67], a[192:195], v[160:163]
  buffer_load_dwordx4 v252, s[84:87], s93 offen offset:1024 lds
  buffer_store_dwordx4 v[84:87], v231, s[4:7], s58 offen sc1
  s_add_u32 s58, s58, 16384
  v_exp_f32 v246, v246
  v_mfma_f32_16x16x32_bf16 v[160:163], a[68:71], a[208:211], v[160:163]
  v_exp_f32 v247, v247
  v_lshl_add_u32 v1, v11, 5, v13
  v_mfma_f32_16x16x32_bf16 v[164:167], a[68:71], a[212:215], v[164:167]
  ds_read_b64_tr_b16 a[80:81], v229 offset:32768
  ds_read_b64_tr_b16 a[82:83], v229 offset:36864
  v_mfma_f32_16x16x32_bf16 v[164:167], a[64:67], a[196:199], v[164:167]
  v_exp_f32 v248, v248
  v_exp_f32 v249, v249
  v_rcp_f32 v245, v245
  v_pk_fma_f32 v[246:247], v[246:247], v[234:235], v[234:235] op_sel:[0,1,1] op_sel_hi:[1,1,1]
  v_pk_fma_f32 v[248:249], v[248:249], v[234:235], v[234:235] op_sel:[0,1,1] op_sel_hi:[1,1,1]
  v_pk_mul_f32 v[104:105], v[104:105], v[242:243]
  v_pk_mul_f32 v[106:107], v[106:107], v[244:245]
  v_pk_mul_f32 v[242:243], v[128:129], v[238:239] op_sel:[0,0] op_sel_hi:[1,0]
  v_pk_mul_f32 v[244:245], v[130:131], v[238:239] op_sel:[0,0] op_sel_hi:[1,0]
  v_pk_mul_f32 v[128:129], v[128:129], v[144:145]
  v_pk_mul_f32 v[130:131], v[130:131], v[146:147]
  v_rcp_f32 v246, v246
  v_mfma_f32_16x16x32_bf16 v[168:171], a[64:67], a[200:203], v[168:171]
  s_add_u32 m0, s79, 57344
  v_rcp_f32 v247, v247
  v_add_u32 v5, 0x10000, v1
  v_mfma_f32_16x16x32_bf16 v[168:171], a[68:71], a[216:219], v[168:171]
  s_add_u32 s92, s92, 262144
  s_add_u32 s93, s92, s91
  buffer_load_dwordx4 v252, s[80:83], s93 offen lds
  v_rcp_f32 v248, v248
  v_mfma_f32_16x16x32_bf16 v[172:175], a[68:71], a[220:223], v[172:175]
  ds_read_b64_tr_b16 a[84:85], v229 offset:40960
  v_cvt_pk_bf16_f32 v90, v104, v105
  v_mfma_f32_16x16x32_bf16 v[172:175], a[64:67], a[204:207], v[172:175]
  s_waitcnt lgkmcnt(3)
  ds_read_b64_tr_b16 a[86:87], v229 offset:45056
  v_cvt_pk_bf16_f32 v91, v106, v107
  v_mfma_f32_16x16x32_bf16 v[188:191], a[72:75], a[204:207], v[188:191]
  buffer_load_dwordx4 v252, s[84:87], s93 offen offset:1024 lds
  buffer_store_dwordx4 v[88:91], v231, s[4:7], s59 offen sc1
  s_add_u32 s59, s59, 16384
  v_exp_f32 v242, v242
  v_mfma_f32_16x16x32_bf16 v[188:191], a[76:79], a[220:223], v[188:191]
  v_exp_f32 v243, v243
  v_xor_b32 v11, 2, v12
  v_mfma_f32_16x16x32_bf16 v[184:187], a[76:79], a[216:219], v[184:187]
  ds_read_b64_tr_b16 a[88:89], v229 offset:49152
  ds_read_b64_tr_b16 a[90:91], v229 offset:53248
  v_mfma_f32_16x16x32_bf16 v[184:187], a[72:75], a[200:203], v[184:187]
  v_exp_f32 v244, v244
  v_exp_f32 v245, v245
  v_rcp_f32 v249, v249
  v_pk_fma_f32 v[242:243], v[242:243], v[232:233], v[232:233] op_sel:[0,0,0] op_sel_hi:[1,0,0]
  v_pk_fma_f32 v[244:245], v[244:245], v[232:233], v[232:233] op_sel:[0,0,0] op_sel_hi:[1,0,0]
  v_pk_mul_f32 v[108:109], v[108:109], v[246:247]
  v_pk_mul_f32 v[110:111], v[110:111], v[248:249]
  v_pk_mul_f32 v[246:247], v[132:133], v[238:239] op_sel:[0,1] op_sel_hi:[1,1]
  v_pk_mul_f32 v[248:249], v[134:135], v[238:239] op_sel:[0,1] op_sel_hi:[1,1]
  v_pk_mul_f32 v[132:133], v[132:133], v[148:149]
  v_pk_mul_f32 v[134:135], v[134:135], v[150:151]
  v_rcp_f32 v242, v242
  v_mfma_f32_16x16x32_bf16 v[180:183], a[72:75], a[196:199], v[180:183]
  buffer_load_dword v10, v251, s[4:7], s64 offen sc1
  v_rcp_f32 v243, v243
  v_mfma_f32_16x16x32_bf16 v[180:183], a[76:79], a[212:215], v[180:183]
  v_rcp_f32 v244, v244
  v_lshl_add_u32 v2, v11, 5, v13
  v_mfma_f32_16x16x32_bf16 v[176:179], a[76:79], a[208:211], v[176:179]
  ds_read_b64_tr_b16 a[92:93], v229 offset:57344
  v_cvt_pk_bf16_f32 v94, v108, v109
  v_mfma_f32_16x16x32_bf16 v[176:179], a[72:75], a[192:195], v[176:179]
  s_waitcnt lgkmcnt(3)
  ds_read_b64_tr_b16 a[94:95], v229 offset:61440
  v_cvt_pk_bf16_f32 v95, v110, v111
  v_mfma_f32_16x16x32_bf16 v[160:163], a[80:83], a[224:227], v[160:163]
  buffer_store_dwordx4 v[92:95], v231, s[4:7], s60 offen sc1
  s_add_u32 s60, s60, 16384
  v_exp_f32 v246, v246
  v_mfma_f32_16x16x32_bf16 v[160:163], a[84:87], a[240:243], v[160:163]
  v_exp_f32 v247, v247
  v_add_u32 v6, 0x10000, v2
  v_mfma_f32_16x16x32_bf16 v[164:167], a[84:87], a[244:247], v[164:167]
  ds_read_b64_tr_b16 a[64:65], v230 offset:0
  ds_read_b64_tr_b16 a[66:67], v230 offset:4096
  v_mfma_f32_16x16x32_bf16 v[164:167], a[80:83], a[228:231], v[164:167]
  v_exp_f32 v248, v248
  v_exp_f32 v249, v249
  v_rcp_f32 v245, v245
  v_pk_fma_f32 v[246:247], v[246:247], v[232:233], v[232:233] op_sel:[0,1,1] op_sel_hi:[1,1,1]
  v_pk_fma_f32 v[248:249], v[248:249], v[232:233], v[232:233] op_sel:[0,1,1] op_sel_hi:[1,1,1]
  v_pk_mul_f32 v[128:129], v[128:129], v[242:243]
  v_pk_mul_f32 v[130:131], v[130:131], v[244:245]
  v_pk_mul_f32 v[242:243], v[136:137], v[240:241] op_sel:[0,0] op_sel_hi:[1,0]
  v_pk_mul_f32 v[244:245], v[138:139], v[240:241] op_sel:[0,0] op_sel_hi:[1,0]
  v_pk_mul_f32 v[136:137], v[136:137], v[152:153]
  v_pk_mul_f32 v[138:139], v[138:139], v[154:155]
  v_rcp_f32 v246, v246
  v_mfma_f32_16x16x32_bf16 v[168:171], a[80:83], a[232:235], v[168:171]
  v_rcp_f32 v247, v247
  v_xor_b32 v11, 3, v12
  v_mfma_f32_16x16x32_bf16 v[168:171], a[84:87], a[248:251], v[168:171]
  v_rcp_f32 v248, v248
  v_lshl_add_u32 v3, v11, 5, v13
  v_mfma_f32_16x16x32_bf16 v[172:175], a[84:87], a[252:255], v[172:175]
  ds_read_b64_tr_b16 a[68:69], v230 offset:8192
  v_cvt_pk_bf16_f32 v144, v128, v129
  v_mfma_f32_16x16x32_bf16 v[172:175], a[80:83], a[236:239], v[172:175]
  s_waitcnt lgkmcnt(3)
  ds_read_b64_tr_b16 a[70:71], v230 offset:12288
  v_cvt_pk_bf16_f32 v145, v130, v131
  v_mfma_f32_16x16x32_bf16 v[188:191], a[88:91], a[236:239], v[188:191]
  v_exp_f32 v242, v242
  v_add_u32 v7, 0x10000, v3
  v_mfma_f32_16x16x32_bf16 v[188:191], a[92:95], a[252:255], v[188:191]
  v_exp_f32 v243, v243
  v_mfma_f32_16x16x32_bf16 v[184:187], a[92:95], a[248:251], v[184:187]
  ds_read_b64_tr_b16 a[72:73], v230 offset:16384
  ds_read_b64_tr_b16 a[74:75], v230 offset:20480
  v_mfma_f32_16x16x32_bf16 v[184:187], a[88:91], a[232:235], v[184:187]
  v_exp_f32 v244, v244
  v_exp_f32 v245, v245
  v_rcp_f32 v249, v249
  v_pk_fma_f32 v[242:243], v[242:243], v[234:235], v[234:235] op_sel:[0,0,0] op_sel_hi:[1,0,0]
  v_pk_fma_f32 v[244:245], v[244:245], v[234:235], v[234:235] op_sel:[0,0,0] op_sel_hi:[1,0,0]
  v_pk_mul_f32 v[132:133], v[132:133], v[246:247]
  v_pk_mul_f32 v[134:135], v[134:135], v[248:249]
  v_pk_mul_f32 v[246:247], v[140:141], v[240:241] op_sel:[0,1] op_sel_hi:[1,1]
  v_pk_mul_f32 v[248:249], v[142:143], v[240:241] op_sel:[0,1] op_sel_hi:[1,1]
  v_pk_mul_f32 v[140:141], v[140:141], v[156:157]
  v_pk_mul_f32 v[142:143], v[142:143], v[158:159]
  v_rcp_f32 v242, v242
  v_mfma_f32_16x16x32_bf16 v[180:183], a[88:91], a[228:231], v[180:183]
  v_rcp_f32 v243, v243
  v_mfma_f32_16x16x32_bf16 v[180:183], a[92:95], a[244:247], v[180:183]
  v_rcp_f32 v244, v244
  v_mfma_f32_16x16x32_bf16 v[176:179], a[92:95], a[240:243], v[176:179]
  ds_read_b64_tr_b16 a[76:77], v230 offset:24576
  v_cvt_pk_bf16_f32 v148, v132, v133
  v_mfma_f32_16x16x32_bf16 v[176:179], a[88:91], a[224:227], v[176:179]
  s_waitcnt lgkmcnt(3)
  ds_read_b64_tr_b16 a[78:79], v230 offset:28672
  v_cvt_pk_bf16_f32 v149, v134, v135
  v_mfma_f32_16x16x32_bf16 v[192:195], a[64:67], a[192:195], v[192:195]
  v_exp_f32 v246, v246
  v_mfma_f32_16x16x32_bf16 v[192:195], a[68:71], a[208:211], v[192:195]
  v_exp_f32 v247, v247
  v_mfma_f32_16x16x32_bf16 v[196:199], a[68:71], a[212:215], v[196:199]
  ds_read_b64_tr_b16 a[80:81], v230 offset:32768
  ds_read_b64_tr_b16 a[82:83], v230 offset:36864
  v_mfma_f32_16x16x32_bf16 v[196:199], a[64:67], a[196:199], v[196:199]
  v_exp_f32 v248, v248
  v_exp_f32 v249, v249
  v_rcp_f32 v245, v245
  v_pk_fma_f32 v[246:247], v[246:247], v[234:235], v[234:235] op_sel:[0,1,1] op_sel_hi:[1,1,1]
  v_pk_fma_f32 v[248:249], v[248:249], v[234:235], v[234:235] op_sel:[0,1,1] op_sel_hi:[1,1,1]
  v_pk_mul_f32 v[136:137], v[136:137], v[242:243]
  v_pk_mul_f32 v[138:139], v[138:139], v[244:245]
  v_pk_mul_f32 v[242:243], v[160:161], v[238:239] op_sel:[0,0] op_sel_hi:[1,0]
  v_pk_mul_f32 v[244:245], v[162:163], v[238:239] op_sel:[0,0] op_sel_hi:[1,0]
  v_pk_mul_f32 v[160:161], v[160:161], v[176:177]
  v_pk_mul_f32 v[162:163], v[162:163], v[178:179]
  v_rcp_f32 v246, v246
  v_mfma_f32_16x16x32_bf16 v[200:203], a[64:67], a[200:203], v[200:203]
  s_waitcnt vmcnt(1)
  v_cmp_gt_u32 vcc, 16, v10
  s_cbranch_vccz Lp4a_ok
  s_mov_b32 s43, 0x40000
Lp4a_sp:
  buffer_load_dword v10, v251, s[4:7], s64 offen sc1
  s_waitcnt vmcnt(0)
  v_cmp_gt_u32 vcc, 16, v10
  s_cbranch_vccz Lp4a_ok
  s_sub_u32 s43, s43, 1
  s_cmp_lg_u32 s43, 0
  s_cbranch_scc1 Lp4a_sp
Lp4a_ok:
  s_add_u32 s64, s64, 4096
  v_rcp_f32 v247, v247
  v_mfma_f32_16x16x32_bf16 v[200:203], a[68:71], a[216:219], v[200:203]
  s_min_u32 s63, s88, 4096
  s_add_u32 s63, s63, s48
  buffer_load_dwordx4 a[128:131], v8, s[4:7], s63 offen offset:0 sc1
  v_rcp_f32 v248, v248
  v_mfma_f32_16x16x32_bf16 v[204:207], a[68:71], a[220:223], v[204:207]
  ds_read_b64_tr_b16 a[84:85], v230 offset:40960
  v_cvt_pk_bf16_f32 v152, v136, v137
  v_mfma_f32_16x16x32_bf16 v[204:207], a[64:67], a[204:207], v[204:207]
  s_waitcnt lgkmcnt(3)
  ds_read_b64_tr_b16 a[86:87], v230 offset:45056
  v_cvt_pk_bf16_f32 v153, v138, v139
  v_mfma_f32_16x16x32_bf16 v[220:223], a[72:75], a[204:207], v[220:223]
  buffer_load_dwordx4 a[132:135], v9, s[4:7], s63 offen offset:0 sc1
  v_exp_f32 v242, v242
  v_mfma_f32_16x16x32_bf16 v[220:223], a[76:79], a[220:223], v[220:223]
  s_min_u32 s63, s89, 4096
  s_add_u32 s63, s63, s48
  buffer_load_dwordx4 a[136:139], v8, s[4:7], s63 offen offset:1024 sc1
  v_exp_f32 v243, v243
  v_mfma_f32_16x16x32_bf16 v[216:219], a[76:79], a[216:219], v[216:219]
  ds_read_b64_tr_b16 a[88:89], v230 offset:49152
  ds_read_b64_tr_b16 a[90:91], v230 offset:53248
  v_mfma_f32_16x16x32_bf16 v[216:219], a[72:75], a[200:203], v[216:219]
  buffer_load_dwordx4 a[140:143], v9, s[4:7], s63 offen offset:1024 sc1
  v_exp_f32 v244, v244
  v_exp_f32 v245, v245
  v_rcp_f32 v249, v249
  v_pk_fma_f32 v[242:243], v[242:243], v[232:233], v[232:233] op_sel:[0,0,0] op_sel_hi:[1,0,0]
  v_pk_fma_f32 v[244:245], v[244:245], v[232:233], v[232:233] op_sel:[0,0,0] op_sel_hi:[1,0,0]
  v_pk_mul_f32 v[140:141], v[140:141], v[246:247]
  v_pk_mul_f32 v[142:143], v[142:143], v[248:249]
  v_pk_mul_f32 v[246:247], v[164:165], v[238:239] op_sel:[0,1] op_sel_hi:[1,1]
  v_pk_mul_f32 v[248:249], v[166:167], v[238:239] op_sel:[0,1] op_sel_hi:[1,1]
  v_pk_mul_f32 v[164:165], v[164:165], v[180:181]
  v_pk_mul_f32 v[166:167], v[166:167], v[182:183]
  v_rcp_f32 v242, v242
  v_mfma_f32_16x16x32_bf16 v[212:215], a[72:75], a[196:199], v[212:215]
  s_min_u32 s63, s90, 4096
  s_add_u32 s63, s63, s48
  buffer_load_dwordx4 a[144:147], v8, s[4:7], s63 offen offset:2048 sc1
  v_rcp_f32 v243, v243
  v_mfma_f32_16x16x32_bf16 v[212:215], a[76:79], a[212:215], v[212:215]
  buffer_load_dwordx4 a[148:151], v9, s[4:7], s63 offen offset:2048 sc1
  v_rcp_f32 v244, v244
  v_mfma_f32_16x16x32_bf16 v[208:211], a[76:79], a[208:211], v[208:211]
  s_min_u32 s63, s91, 4096
  s_add_u32 s63, s63, s48
  ds_read_b64_tr_b16 a[92:93], v230 offset:57344
  v_cvt_pk_bf16_f32 v156, v140, v141
  v_mfma_f32_16x16x32_bf16 v[208:211], a[72:75], a[192:195], v[208:211]
  s_waitcnt lgkmcnt(3)
  ds_read_b64_tr_b16 a[94:95], v230 offset:61440
  v_cvt_pk_bf16_f32 v157, v142, v143
  v_mfma_f32_16x16x32_bf16 v[192:195], a[80:83], a[224:227], v[192:195]
  buffer_load_dwordx4 a[152:155], v8, s[4:7], s63 offen offset:3072 sc1
  v_exp_f32 v246, v246
  v_mfma_f32_16x16x32_bf16 v[192:195], a[84:87], a[240:243], v[192:195]
  buffer_load_dwordx4 a[156:159], v9, s[4:7], s63 offen offset:3072 sc1
  v_exp_f32 v247, v247
  v_mfma_f32_16x16x32_bf16 v[196:199], a[84:87], a[244:247], v[196:199]
  v_mfma_f32_16x16x32_bf16 v[196:199], a[80:83], a[228:231], v[196:199]
  v_exp_f32 v248, v248
  v_exp_f32 v249, v249
  v_rcp_f32 v245, v245
  v_pk_fma_f32 v[246:247], v[246:247], v[232:233], v[232:233] op_sel:[0,1,1] op_sel_hi:[1,1,1]
  v_pk_fma_f32 v[248:249], v[248:249], v[232:233], v[232:233] op_sel:[0,1,1] op_sel_hi:[1,1,1]
  v_pk_mul_f32 v[160:161], v[160:161], v[242:243]
  v_pk_mul_f32 v[162:163], v[162:163], v[244:245]
  v_pk_mul_f32 v[242:243], v[168:169], v[240:241] op_sel:[0,0] op_sel_hi:[1,0]
  v_pk_mul_f32 v[244:245], v[170:171], v[240:241] op_sel:[0,0] op_sel_hi:[1,0]
  v_pk_mul_f32 v[168:169], v[168:169], v[184:185]
  v_pk_mul_f32 v[170:171], v[170:171], v[186:187]
  v_rcp_f32 v246, v246
  v_mfma_f32_16x16x32_bf16 v[200:203], a[80:83], a[232:235], v[200:203]
  s_waitcnt vmcnt(8)
  s_barrier
  s_cmp_lg_u32 s40, 0
  s_cbranch_scc1 Lsgf18
  v_mov_b32 v250, 1
  s_mov_b64 exec, 1
  buffer_atomic_add v250, v251, s[4:7], s77 offen sc1
  s_mov_b64 exec, -1
Lsgf18:
  s_add_u32 s77, s77, 4096
  v_rcp_f32 v247, v247
  v_mfma_f32_16x16x32_bf16 v[200:203], a[84:87], a[248:251], v[200:203]
  s_add_u32 s48, s48, 4096
  s_min_u32 s63, s88, 4096
  s_add_u32 s63, s63, s48
  buffer_load_dwordx4 a[160:163], v8, s[4:7], s63 offen offset:0 sc1
  v_rcp_f32 v248, v248
  v_mfma_f32_16x16x32_bf16 v[204:207], a[84:87], a[252:255], v[204:207]
  v_cvt_pk_bf16_f32 v146, v160, v161
  v_mfma_f32_16x16x32_bf16 v[204:207], a[80:83], a[236:239], v[204:207]
  v_cvt_pk_bf16_f32 v147, v162, v163
  s_waitcnt lgkmcnt(0)
  v_mfma_f32_16x16x32_bf16 v[220:223], a[88:91], a[236:239], v[220:223]
  buffer_load_dwordx4 a[164:167], v9, s[4:7], s63 offen offset:0 sc1
  buffer_store_dwordx4 v[144:147], v231, s[4:7], s57 offen sc1
  s_add_u32 s57, s57, 16384
  v_exp_f32 v242, v242
  v_mfma_f32_16x16x32_bf16 v[220:223], a[92:95], a[252:255], v[220:223]
  s_min_u32 s63, s89, 4096
  s_add_u32 s63, s63, s48
  buffer_load_dwordx4 a[168:171], v8, s[4:7], s63 offen offset:1024 sc1
  v_exp_f32 v243, v243
  v_mfma_f32_16x16x32_bf16 v[216:219], a[92:95], a[248:251], v[216:219]
  v_mfma_f32_16x16x32_bf16 v[216:219], a[88:91], a[232:235], v[216:219]
  buffer_load_dwordx4 a[172:175], v9, s[4:7], s63 offen offset:1024 sc1
  v_exp_f32 v244, v244
  v_exp_f32 v245, v245
  v_rcp_f32 v249, v249
  v_pk_fma_f32 v[242:243], v[242:243], v[234:235], v[234:235] op_sel:[0,0,0] op_sel_hi:[1,0,0]
  v_pk_fma_f32 v[244:245], v[244:245], v[234:235], v[234:235] op_sel:[0,0,0] op_sel_hi:[1,0,0]
  v_pk_mul_f32 v[164:165], v[164:165], v[246:247]
  v_pk_mul_f32 v[166:167], v[166:167], v[248:249]
  v_pk_mul_f32 v[246:247], v[172:173], v[240:241] op_sel:[0,1] op_sel_hi:[1,1]
  v_pk_mul_f32 v[248:249], v[174:175], v[240:241] op_sel:[0,1] op_sel_hi:[1,1]
  v_pk_mul_f32 v[172:173], v[172:173], v[188:189]
  v_pk_mul_f32 v[174:175], v[174:175], v[190:191]
  v_rcp_f32 v242, v242
  v_mfma_f32_16x16x32_bf16 v[212:215], a[88:91], a[228:231], v[212:215]
  v_mfma_f32_16x16x32_bf16 v[212:215], a[92:95], a[244:247], v[212:215]
  v_mfma_f32_16x16x32_bf16 v[208:211], a[92:95], a[240:243], v[208:211]
  v_mfma_f32_16x16x32_bf16 v[208:211], a[88:91], a[224:227], v[208:211]
  ds_read_b64_tr_b16 a[0:1], v0 offset:0
  ds_read_b64_tr_b16 a[2:3], v0 offset:4096
  ds_read_b64_tr_b16 a[16:17], v0 offset:8192
  ds_read_b64_tr_b16 a[18:19], v0 offset:12288
  ds_read_b64_tr_b16 a[4:5], v1 offset:0
  ds_read_b64_tr_b16 a[6:7], v1 offset:4096
  ds_read_b64_tr_b16 a[20:21], v1 offset:8192
  ds_read_b64_tr_b16 a[22:23], v1 offset:12288
  ds_read_b64_tr_b16 a[8:9], v2 offset:0
  ds_read_b64_tr_b16 a[10:11], v2 offset:4096
  ds_read_b64_tr_b16 a[24:25], v2 offset:8192
  ds_read_b64_tr_b16 a[26:27], v2 offset:12288
  ds_read_b64_tr_b16 a[12:13], v3 offset:0
  ds_read_b64_tr_b16 a[14:15], v3 offset:4096
  ds_read_b64_tr_b16 a[28:29], v3 offset:8192
  ds_read_b64_tr_b16 a[30:31], v3 offset:12288
  s_min_u32 s63, s90, 4096
  s_add_u32 s63, s63, s48
  buffer_load_dwordx4 a[176:179], v8, s[4:7], s63 offen offset:2048 sc1
  buffer_load_dwordx4 a[180:183], v9, s[4:7], s63 offen offset:2048 sc1
  v_rcp_f32 v243, v243
  v_rcp_f32 v244, v244
  v_cvt_pk_bf16_f32 v150, v164, v165
  v_cvt_pk_bf16_f32 v151, v166, v167
  s_min_u32 s63, s91, 4096
  s_add_u32 s63, s63, s48
  buffer_load_dwordx4 a[184:187], v8, s[4:7], s63 offen offset:3072 sc1
  buffer_load_dwordx4 a[188:191], v9, s[4:7], s63 offen offset:3072 sc1
  buffer_store_dwordx4 v[148:151], v231, s[4:7], s58 offen sc1
  s_add_u32 s58, s58, 16384
  v_exp_f32 v246, v246
  v_exp_f32 v247, v247
  v_exp_f32 v248, v248
  v_exp_f32 v249, v249
  v_rcp_f32 v245, v245
  v_pk_fma_f32 v[246:247], v[246:247], v[234:235], v[234:235] op_sel:[0,1,1] op_sel_hi:[1,1,1]
  v_pk_fma_f32 v[248:249], v[248:249], v[234:235], v[234:235] op_sel:[0,1,1] op_sel_hi:[1,1,1]
  v_pk_mul_f32 v[168:169], v[168:169], v[242:243]
  v_pk_mul_f32 v[170:171], v[170:171], v[244:245]
  v_pk_mul_f32 v[242:243], v[192:193], v[238:239] op_sel:[0,0] op_sel_hi:[1,0]
  v_pk_mul_f32 v[244:245], v[194:195], v[238:239] op_sel:[0,0] op_sel_hi:[1,0]
  v_pk_mul_f32 v[192:193], v[192:193], v[208:209]
  v_pk_mul_f32 v[194:195], v[194:195], v[210:211]
  v_rcp_f32 v246, v246
  s_add_u32 m0, s79, 65536
  s_add_u32 s92, s92, 196608
  s_add_u32 s93, s92, s88
  v_rcp_f32 v247, v247
  v_rcp_f32 v248, v248
  v_cvt_pk_bf16_f32 v154, v168, v169
  v_cvt_pk_bf16_f32 v155, v170, v171
  buffer_load_dwordx4 v252, s[80:83], s93 offen lds
  buffer_load_dwordx4 v252, s[84:87], s93 offen offset:1024 lds
  buffer_store_dwordx4 v[152:155], v231, s[4:7], s59 offen sc1
  s_add_u32 s59, s59, 16384
  v_exp_f32 v242, v242
  v_exp_f32 v243, v243
  v_exp_f32 v244, v244
  v_exp_f32 v245, v245
  v_rcp_f32 v249, v249
  v_pk_fma_f32 v[242:243], v[242:243], v[232:233], v[232:233] op_sel:[0,0,0] op_sel_hi:[1,0,0]
  v_pk_fma_f32 v[244:245], v[244:245], v[232:233], v[232:233] op_sel:[0,0,0] op_sel_hi:[1,0,0]
  v_pk_mul_f32 v[172:173], v[172:173], v[246:247]
  v_pk_mul_f32 v[174:175], v[174:175], v[248:249]
  v_pk_mul_f32 v[246:247], v[196:197], v[238:239] op_sel:[0,1] op_sel_hi:[1,1]
  v_pk_mul_f32 v[248:249], v[198:199], v[238:239] op_sel:[0,1] op_sel_hi:[1,1]
  v_pk_mul_f32 v[196:197], v[196:197], v[212:213]
  v_pk_mul_f32 v[198:199], v[198:199], v[214:215]
  v_rcp_f32 v242, v242
  s_add_u32 m0, s79, 73728
  s_add_u32 s92, s92, 262144
  s_add_u32 s93, s92, s89
  v_rcp_f32 v243, v243
  v_rcp_f32 v244, v244
  v_cvt_pk_bf16_f32 v158, v172, v173
  v_cvt_pk_bf16_f32 v159, v174, v175
  buffer_load_dwordx4 v252, s[80:83], s93 offen lds
  buffer_load_dwordx4 v252, s[84:87], s93 offen offset:1024 lds
  buffer_store_dwordx4 v[156:159], v231, s[4:7], s60 offen sc1
  s_add_u32 s60, s60, 16384
  v_exp_f32 v246, v246
  v_exp_f32 v247, v247
  v_exp_f32 v248, v248
  v_exp_f32 v249, v249
  v_rcp_f32 v245, v245
  v_pk_fma_f32 v[246:247], v[246:247], v[232:233], v[232:233] op_sel:[0,1,1] op_sel_hi:[1,1,1]
  v_pk_fma_f32 v[248:249], v[248:249], v[232:233], v[232:233] op_sel:[0,1,1] op_sel_hi:[1,1,1]
  v_pk_mul_f32 v[192:193], v[192:193], v[242:243]
  v_pk_mul_f32 v[194:195], v[194:195], v[244:245]
  v_pk_mul_f32 v[242:243], v[200:201], v[240:241] op_sel:[0,0] op_sel_hi:[1,0]
  v_pk_mul_f32 v[244:245], v[202:203], v[240:241] op_sel:[0,0] op_sel_hi:[1,0]
  v_pk_mul_f32 v[200:201], v[200:201], v[216:217]
  v_pk_mul_f32 v[202:203], v[202:203], v[218:219]
  v_rcp_f32 v246, v246
  s_add_u32 m0, s79, 81920
  s_add_u32 s92, s92, 196608
  s_add_u32 s93, s92, s90
  v_rcp_f32 v247, v247
  v_rcp_f32 v248, v248
  v_cvt_pk_bf16_f32 v208, v192, v193
  v_cvt_pk_bf16_f32 v209, v194, v195
  buffer_load_dwordx4 v252, s[80:83], s93 offen lds
  buffer_load_dwordx4 v252, s[84:87], s93 offen offset:1024 lds
  v_exp_f32 v242, v242
  v_exp_f32 v243, v243
  v_exp_f32 v244, v244
  v_exp_f32 v245, v245
  v_rcp_f32 v249, v249
  v_pk_fma_f32 v[242:243], v[242:243], v[234:235], v[234:235] op_sel:[0,0,0] op_sel_hi:[1,0,0]
  v_pk_fma_f32 v[244:245], v[244:245], v[234:235], v[234:235] op_sel:[0,0,0] op_sel_hi:[1,0,0]
  v_pk_mul_f32 v[196:197], v[196:197], v[246:247]
  v_pk_mul_f32 v[198:199], v[198:199], v[248:249]
  v_pk_mul_f32 v[246:247], v[204:205], v[240:241] op_sel:[0,1] op_sel_hi:[1,1]
  v_pk_mul_f32 v[248:249], v[206:207], v[240:241] op_sel:[0,1] op_sel_hi:[1,1]
  v_pk_mul_f32 v[204:205], v[204:205], v[220:221]
  v_pk_mul_f32 v[206:207], v[206:207], v[222:223]
  v_rcp_f32 v242, v242
  s_add_u32 m0, s79, 90112
  s_add_u32 s92, s92, 262144
  s_add_u32 s93, s92, s91
  v_rcp_f32 v243, v243
  v_rcp_f32 v244, v244
  v_cvt_pk_bf16_f32 v210, v196, v197
  v_cvt_pk_bf16_f32 v211, v198, v199
  buffer_load_dwordx4 v252, s[80:83], s93 offen lds
  buffer_load_dwordx4 v252, s[84:87], s93 offen offset:1024 lds
  s_nop 1
  v_permlane32_swap_b32 v208, v210
  v_permlane32_swap_b32 v209, v211
  buffer_store_dwordx4 v[208:211], v236, s[4:7], s61 offen sc1
  v_exp_f32 v246, v246
  v_exp_f32 v247, v247
  v_exp_f32 v248, v248
  v_exp_f32 v249, v249
  v_rcp_f32 v245, v245
  v_pk_fma_f32 v[246:247], v[246:247], v[234:235], v[234:235] op_sel:[0,1,1] op_sel_hi:[1,1,1]
  v_pk_fma_f32 v[248:249], v[248:249], v[234:235], v[234:235] op_sel:[0,1,1] op_sel_hi:[1,1,1]
  v_pk_mul_f32 v[200:201], v[200:201], v[242:243]
  v_pk_mul_f32 v[202:203], v[202:203], v[244:245]
  v_rcp_f32 v246, v246
  v_rcp_f32 v247, v247
  v_rcp_f32 v248, v248
  v_cvt_pk_bf16_f32 v216, v200, v201
  v_cvt_pk_bf16_f32 v217, v202, v203
  v_rcp_f32 v249, v249
  s_nop 0
  v_pk_mul_f32 v[204:205], v[204:205], v[246:247]
  v_pk_mul_f32 v[206:207], v[206:207], v[248:249]
  v_cvt_pk_bf16_f32 v218, v204, v205
  v_cvt_pk_bf16_f32 v219, v206, v207
  s_nop 1
  v_permlane32_swap_b32 v216, v218
  v_permlane32_swap_b32 v217, v219
  buffer_store_dwordx4 v[216:219], v236, s[4:7], s62 offen sc1
  v_pk_mul_f32 v[32:33], v[250:251], 0 op_sel:[1,0] op_sel_hi:[1,0]
  v_pk_mul_f32 v[34:35], v[250:251], 0 op_sel:[1,0] op_sel_hi:[1,0]
  v_pk_mul_f32 v[36:37], v[250:251], 0 op_sel:[1,0] op_sel_hi:[1,0]
  v_pk_mul_f32 v[38:39], v[250:251], 0 op_sel:[1,0] op_sel_hi:[1,0]
  v_pk_mul_f32 v[40:41], v[250:251], 0 op_sel:[1,0] op_sel_hi:[1,0]
  v_pk_mul_f32 v[42:43], v[250:251], 0 op_sel:[1,0] op_sel_hi:[1,0]
  v_pk_mul_f32 v[44:45], v[250:251], 0 op_sel:[1,0] op_sel_hi:[1,0]
  v_pk_mul_f32 v[46:47], v[250:251], 0 op_sel:[1,0] op_sel_hi:[1,0]
  v_pk_mul_f32 v[48:49], v[250:251], 0 op_sel:[1,0] op_sel_hi:[1,0]
  v_pk_mul_f32 v[50:51], v[250:251], 0 op_sel:[1,0] op_sel_hi:[1,0]
  v_pk_mul_f32 v[52:53], v[250:251], 0 op_sel:[1,0] op_sel_hi:[1,0]
  v_pk_mul_f32 v[54:55], v[250:251], 0 op_sel:[1,0] op_sel_hi:[1,0]
  v_pk_mul_f32 v[56:57], v[250:251], 0 op_sel:[1,0] op_sel_hi:[1,0]
  v_pk_mul_f32 v[58:59], v[250:251], 0 op_sel:[1,0] op_sel_hi:[1,0]
  v_pk_mul_f32 v[60:61], v[250:251], 0 op_sel:[1,0] op_sel_hi:[1,0]
  v_pk_mul_f32 v[62:63], v[250:251], 0 op_sel:[1,0] op_sel_hi:[1,0]
  v_lshlrev_b32 v64, 16, v16
  v_and_b32 v65, 0xffff0000, v16
  v_lshlrev_b32 v66, 16, v17
  v_and_b32 v67, 0xffff0000, v17
  v_lshlrev_b32 v72, 16, v18
  v_and_b32 v73, 0xffff0000, v18
  v_lshlrev_b32 v74, 16, v19
  v_and_b32 v75, 0xffff0000, v19
  v_lshlrev_b32 v80, 16, v20
  v_and_b32 v81, 0xffff0000, v20
  v_lshlrev_b32 v82, 16, v21
  v_and_b32 v83, 0xffff0000, v21
  v_lshlrev_b32 v88, 16, v22
  v_and_b32 v89, 0xffff0000, v22
  v_lshlrev_b32 v90, 16, v23
  v_and_b32 v91, 0xffff0000, v23
  v_lshlrev_b32 v68, 16, v24
  v_and_b32 v69, 0xffff0000, v24
  v_lshlrev_b32 v70, 16, v25
  v_and_b32 v71, 0xffff0000, v25
  v_lshlrev_b32 v76, 16, v26
  v_and_b32 v77, 0xffff0000, v26
  v_lshlrev_b32 v78, 16, v27
  v_and_b32 v79, 0xffff0000, v27
  v_lshlrev_b32 v84, 16, v28
  v_and_b32 v85, 0xffff0000, v28
  v_lshlrev_b32 v86, 16, v29
  v_and_b32 v87, 0xffff0000, v29
  v_lshlrev_b32 v92, 16, v30
  v_and_b32 v93, 0xffff0000, v30
  v_lshlrev_b32 v94, 16, v31
  v_and_b32 v95, 0xffff0000, v31
  s_mov_b32 s56, 2
.p2align 3
Lp4_loop:
  s_waitcnt vmcnt(24) lgkmcnt(8)
  v_mfma_f32_16x16x32_bf16 v[32:35], a[0:3], a[128:131], v[32:35]
  s_waitcnt vmcnt(26)
  s_barrier
  ds_read_b64_tr_b16 a[32:33], v0 offset:1024
  s_add_u32 m0, s79, 98304
  s_add_u32 s92, s92, 196608
  s_cmp_lg_u32 s88, 0
  v_mfma_f32_16x16x32_bf16 v[32:35], a[16:19], a[136:139], v[32:35]
  s_cselect_b32 s93, -2686976, 0
  ds_read_b64_tr_b16 a[34:35], v0 offset:5120
  s_add_u32 s93, s93, s92
  v_mfma_f32_16x16x32_bf16 v[36:39], a[16:19], a[140:143], v[36:39]
  ds_read_b64_tr_b16 a[48:49], v0 offset:9216
  buffer_load_dwordx4 v252, s[80:83], s93 offen lds
  v_mfma_f32_16x16x32_bf16 v[36:39], a[0:3], a[132:135], v[36:39]
  ds_read_b64_tr_b16 a[50:51], v0 offset:13312
  v_mfma_f32_16x16x32_bf16 v[44:47], a[4:7], a[132:135], v[44:47]
  ds_read_b64_tr_b16 a[36:37], v1 offset:1024
  v_mfma_f32_16x16x32_bf16 v[44:47], a[20:23], a[140:143], v[44:47]
  ds_read_b64_tr_b16 a[38:39], v1 offset:5120
  v_mfma_f32_16x16x32_bf16 v[40:43], a[20:23], a[136:139], v[40:43]
  ds_read_b64_tr_b16 a[52:53], v1 offset:9216
  buffer_load_dwordx4 v252, s[84:87], s93 offen offset:1024 lds
  v_mfma_f32_16x16x32_bf16 v[40:43], a[4:7], a[128:131], v[40:43]
  ds_read_b64_tr_b16 a[54:55], v1 offset:13312
  s_waitcnt lgkmcnt(8)
  v_mfma_f32_16x16x32_bf16 v[48:51], a[8:11], a[128:131], v[48:51]
  ds_read_b64_tr_b16 a[40:41], v2 offset:1024
  v_mfma_f32_16x16x32_bf16 v[48:51], a[24:27], a[136:139], v[48:51]
  s_add_u32 s48, s48, 4096
  ds_read_b64_tr_b16 a[42:43], v2 offset:5120
  s_min_u32 s63, s88, 4096
  v_mfma_f32_16x16x32_bf16 v[52:55], a[24:27], a[140:143], v[52:55]
  s_add_u32 s63, s63, s48
  ds_read_b64_tr_b16 a[56:57], v2 offset:9216
  buffer_load_dwordx4 a[192:195], v8, s[4:7], s63 offen offset:0 sc1
  v_mfma_f32_16x16x32_bf16 v[52:55], a[8:11], a[132:135], v[52:55]
  ds_read_b64_tr_b16 a[58:59], v2 offset:13312
  v_mfma_f32_16x16x32_bf16 v[60:63], a[12:15], a[132:135], v[60:63]
  ds_read_b64_tr_b16 a[44:45], v3 offset:1024
  v_mfma_f32_16x16x32_bf16 v[60:63], a[28:31], a[140:143], v[60:63]
  ds_read_b64_tr_b16 a[46:47], v3 offset:5120
  v_mfma_f32_16x16x32_bf16 v[56:59], a[28:31], a[136:139], v[56:59]
  ds_read_b64_tr_b16 a[60:61], v3 offset:9216
  buffer_load_dwordx4 a[196:199], v9, s[4:7], s63 offen offset:0 sc1
  v_mfma_f32_16x16x32_bf16 v[56:59], a[12:15], a[128:131], v[56:59]
  ds_read_b64_tr_b16 a[62:63], v3 offset:13312
  s_waitcnt lgkmcnt(8)
  v_mfma_f32_16x16x32_bf16 v[64:67], a[32:35], a[128:131], v[64:67]
  s_add_u32 m0, s79, 106496
  ds_read_b64_tr_b16 a[0:1], v0 offset:16384
  buffer_load_dword v10, v251, s[4:7], s64 offen sc1
  s_add_u32 s92, s92, 262144
  s_cmp_lg_u32 s89, 0
  v_mfma_f32_16x16x32_bf16 v[64:67], a[48:51], a[136:139], v[64:67]
  s_cselect_b32 s93, -2686976, 0
  ds_read_b64_tr_b16 a[2:3], v0 offset:20480
  s_add_u32 s93, s93, s92
  v_mfma_f32_16x16x32_bf16 v[68:71], a[48:51], a[140:143], v[68:71]
  ds_read_b64_tr_b16 a[16:17], v0 offset:24576
  buffer_load_dwordx4 v252, s[80:83], s93 offen lds
  v_mfma_f32_16x16x32_bf16 v[68:71], a[32:35], a[132:135], v[68:71]
  ds_read_b64_tr_b16 a[18:19], v0 offset:28672
  v_mfma_f32_16x16x32_bf16 v[76:79], a[36:39], a[132:135], v[76:79]
  ds_read_b64_tr_b16 a[4:5], v1 offset:16384
  v_mfma_f32_16x16x32_bf16 v[76:79], a[52:55], a[140:143], v[76:79]
  ds_read_b64_tr_b16 a[6:7], v1 offset:20480
  v_mfma_f32_16x16x32_bf16 v[72:75], a[52:55], a[136:139], v[72:75]
  ds_read_b64_tr_b16 a[20:21], v1 offset:24576
  buffer_load_dwordx4 v252, s[84:87], s93 offen offset:1024 lds
  v_mfma_f32_16x16x32_bf16 v[72:75], a[36:39], a[128:131], v[72:75]
  ds_read_b64_tr_b16 a[22:23], v1 offset:28672
  s_waitcnt lgkmcnt(8)
  v_mfma_f32_16x16x32_bf16 v[80:83], a[40:43], a[128:131], v[80:83]
  ds_read_b64_tr_b16 a[8:9], v2 offset:16384
  v_mfma_f32_16x16x32_bf16 v[80:83], a[56:59], a[136:139], v[80:83]
  s_min_u32 s63, s89, 4096
  ds_read_b64_tr_b16 a[10:11], v2 offset:20480
  s_add_u32 s63, s63, s48
  v_mfma_f32_16x16x32_bf16 v[84:87], a[56:59], a[140:143], v[84:87]
  ds_read_b64_tr_b16 a[24:25], v2 offset:24576
  buffer_load_dwordx4 a[200:203], v8, s[4:7], s63 offen offset:1024 sc1
  v_mfma_f32_16x16x32_bf16 v[84:87], a[40:43], a[132:135], v[84:87]
  ds_read_b64_tr_b16 a[26:27], v2 offset:28672
  v_mfma_f32_16x16x32_bf16 v[92:95], a[44:47], a[132:135], v[92:95]
  ds_read_b64_tr_b16 a[12:13], v3 offset:16384
  v_mfma_f32_16x16x32_bf16 v[92:95], a[60:63], a[140:143], v[92:95]
  ds_read_b64_tr_b16 a[14:15], v3 offset:20480
  v_mfma_f32_16x16x32_bf16 v[88:91], a[60:63], a[136:139], v[88:91]
  ds_read_b64_tr_b16 a[28:29], v3 offset:24576
  buffer_load_dwordx4 a[204:207], v9, s[4:7], s63 offen offset:1024 sc1
  v_mfma_f32_16x16x32_bf16 v[88:91], a[44:47], a[128:131], v[88:91]
  ds_read_b64_tr_b16 a[30:31], v3 offset:28672
  s_waitcnt vmcnt(25) lgkmcnt(8)
  v_mfma_f32_16x16x32_bf16 v[32:35], a[0:3], a[144:147], v[32:35]
  s_add_u32 m0, s79, 114688
  ds_read_b64_tr_b16 a[32:33], v0 offset:17408
  s_add_u32 s92, s92, 196608
  s_cmp_lg_u32 s90, 0
  v_mfma_f32_16x16x32_bf16 v[32:35], a[16:19], a[152:155], v[32:35]
  s_cselect_b32 s93, -2686976, 0
  ds_read_b64_tr_b16 a[34:35], v0 offset:21504
  s_add_u32 s93, s93, s92
  v_mfma_f32_16x16x32_bf16 v[36:39], a[16:19], a[156:159], v[36:39]
  ds_read_b64_tr_b16 a[48:49], v0 offset:25600
  buffer_load_dwordx4 v252, s[80:83], s93 offen lds
  v_mfma_f32_16x16x32_bf16 v[36:39], a[0:3], a[148:151], v[36:39]
  ds_read_b64_tr_b16 a[50:51], v0 offset:29696
  v_mfma_f32_16x16x32_bf16 v[44:47], a[4:7], a[148:151], v[44:47]
  ds_read_b64_tr_b16 a[36:37], v1 offset:17408
  v_mfma_f32_16x16x32_bf16 v[44:47], a[20:23], a[156:159], v[44:47]
  ds_read_b64_tr_b16 a[38:39], v1 offset:21504
  v_mfma_f32_16x16x32_bf16 v[40:43], a[20:23], a[152:155], v[40:43]
  ds_read_b64_tr_b16 a[52:53], v1 offset:25600
  buffer_load_dwordx4 v252, s[84:87], s93 offen offset:1024 lds
  v_mfma_f32_16x16x32_bf16 v[40:43], a[4:7], a[144:147], v[40:43]
  ds_read_b64_tr_b16 a[54:55], v1 offset:29696
  s_waitcnt lgkmcnt(8)
  v_mfma_f32_16x16x32_bf16 v[48:51], a[8:11], a[144:147], v[48:51]
  ds_read_b64_tr_b16 a[40:41], v2 offset:17408
  v_mfma_f32_16x16x32_bf16 v[48:51], a[24:27], a[152:155], v[48:51]
  s_min_u32 s63, s90, 4096
  ds_read_b64_tr_b16 a[42:43], v2 offset:21504
  s_add_u32 s63, s63, s48
  v_mfma_f32_16x16x32_bf16 v[52:55], a[24:27], a[156:159], v[52:55]
  ds_read_b64_tr_b16 a[56:57], v2 offset:25600
  buffer_load_dwordx4 a[208:211], v8, s[4:7], s63 offen offset:2048 sc1
  v_mfma_f32_16x16x32_bf16 v[52:55], a[8:11], a[148:151], v[52:55]
  ds_read_b64_tr_b16 a[58:59], v2 offset:29696
  v_mfma_f32_16x16x32_bf16 v[60:63], a[12:15], a[148:151], v[60:63]
  ds_read_b64_tr_b16 a[44:45], v3 offset:17408
  v_mfma_f32_16x16x32_bf16 v[60:63], a[28:31], a[156:159], v[60:63]
  ds_read_b64_tr_b16 a[46:47], v3 offset:21504
  v_mfma_f32_16x16x32_bf16 v[56:59], a[28:31], a[152:155], v[56:59]
  ds_read_b64_tr_b16 a[60:61], v3 offset:25600
  buffer_load_dwordx4 a[212:215], v9, s[4:7], s63 offen offset:2048 sc1
  v_mfma_f32_16x16x32_bf16 v[56:59], a[12:15], a[144:147], v[56:59]
  ds_read_b64_tr_b16 a[62:63], v3 offset:29696
  s_waitcnt lgkmcnt(8)
  v_mfma_f32_16x16x32_bf16 v[64:67], a[32:35], a[144:147], v[64:67]
  s_add_u32 m0, s79, 122880
  ds_read_b64_tr_b16 a[0:1], v0 offset:32768
  s_add_u32 s92, s92, 262144
  s_cmp_lg_u32 s91, 0
  v_mfma_f32_16x16x32_bf16 v[64:67], a[48:51], a[152:155], v[64:67]
  s_cselect_b32 s93, -2686976, 0
  ds_read_b64_tr_b16 a[2:3], v0 offset:36864
  s_add_u32 s93, s93, s92
  v_mfma_f32_16x16x32_bf16 v[68:71], a[48:51], a[156:159], v[68:71]
  ds_read_b64_tr_b16 a[16:17], v0 offset:40960
  buffer_load_dwordx4 v252, s[80:83], s93 offen lds
  v_mfma_f32_16x16x32_bf16 v[68:71], a[32:35], a[148:151], v[68:71]
  ds_read_b64_tr_b16 a[18:19], v0 offset:45056
  v_mfma_f32_16x16x32_bf16 v[76:79], a[36:39], a[148:151], v[76:79]
  ds_read_b64_tr_b16 a[4:5], v1 offset:32768
  v_mfma_f32_16x16x32_bf16 v[76:79], a[52:55], a[156:159], v[76:79]
  ds_read_b64_tr_b16 a[6:7], v1 offset:36864
  v_mfma_f32_16x16x32_bf16 v[72:75], a[52:55], a[152:155], v[72:75]
  ds_read_b64_tr_b16 a[20:21], v1 offset:40960
  buffer_load_dwordx4 v252, s[84:87], s93 offen offset:1024 lds
  v_mfma_f32_16x16x32_bf16 v[72:75], a[36:39], a[144:147], v[72:75]
  ds_read_b64_tr_b16 a[22:23], v1 offset:45056
  s_waitcnt lgkmcnt(8)
  v_mfma_f32_16x16x32_bf16 v[80:83], a[40:43], a[144:147], v[80:83]
  ds_read_b64_tr_b16 a[8:9], v2 offset:32768
  v_mfma_f32_16x16x32_bf16 v[80:83], a[56:59], a[152:155], v[80:83]
  s_min_u32 s63, s91, 4096
  ds_read_b64_tr_b16 a[10:11], v2 offset:36864
  s_add_u32 s63, s63, s48
  v_mfma_f32_16x16x32_bf16 v[84:87], a[56:59], a[156:159], v[84:87]
  ds_read_b64_tr_b16 a[24:25], v2 offset:40960
  buffer_load_dwordx4 a[216:219], v8, s[4:7], s63 offen offset:3072 sc1
  v_mfma_f32_16x16x32_bf16 v[84:87], a[40:43], a[148:151], v[84:87]
  ds_read_b64_tr_b16 a[26:27], v2 offset:45056
  v_mfma_f32_16x16x32_bf16 v[92:95], a[44:47], a[148:151], v[92:95]
  ds_read_b64_tr_b16 a[12:13], v3 offset:32768
  v_mfma_f32_16x16x32_bf16 v[92:95], a[60:63], a[156:159], v[92:95]
  ds_read_b64_tr_b16 a[14:15], v3 offset:36864
  v_mfma_f32_16x16x32_bf16 v[88:91], a[60:63], a[152:155], v[88:91]
  ds_read_b64_tr_b16 a[28:29], v3 offset:40960
  buffer_load_dwordx4 a[220:223], v9, s[4:7], s63 offen offset:3072 sc1
  v_mfma_f32_16x16x32_bf16 v[88:91], a[44:47], a[144:147], v[88:91]
  ds_read_b64_tr_b16 a[30:31], v3 offset:45056
  s_waitcnt vmcnt(25) lgkmcnt(8)
  v_mfma_f32_16x16x32_bf16 v[32:35], a[0:3], a[160:163], v[32:35]
  s_waitcnt vmcnt(24)
  s_barrier
  ds_read_b64_tr_b16 a[32:33], v0 offset:33792
  s_waitcnt vmcnt(12)
  v_cmp_gt_u32 vcc, 16, v10
  s_cbranch_vccz Lp4b_ok
  s_mov_b32 s43, 0x40000
Lp4b_sp:
  buffer_load_dword v10, v251, s[4:7], s64 offen sc1
  s_waitcnt vmcnt(0)
  v_cmp_gt_u32 vcc, 16, v10
  s_cbranch_vccz Lp4b_ok
  s_sub_u32 s43, s43, 1
  s_cmp_lg_u32 s43, 0
  s_cbranch_scc1 Lp4b_sp
Lp4b_ok:
  s_add_u32 s64, s64, 4096
  v_mfma_f32_16x16x32_bf16 v[32:35], a[16:19], a[168:171], v[32:35]
  s_add_u32 m0, s79, 0
  ds_read_b64_tr_b16 a[34:35], v0 offset:37888
  s_add_u32 s92, s92, -3407872
  v_mfma_f32_16x16x32_bf16 v[36:39], a[16:19], a[172:175], v[36:39]
  s_add_u32 s93, s92, s88
  ds_read_b64_tr_b16 a[48:49], v0 offset:41984
  buffer_load_dwordx4 v252, s[80:83], s93 offen lds
  v_mfma_f32_16x16x32_bf16 v[36:39], a[0:3], a[164:167], v[36:39]
  ds_read_b64_tr_b16 a[50:51], v0 offset:46080
  v_mfma_f32_16x16x32_bf16 v[44:47], a[4:7], a[164:167], v[44:47]
  ds_read_b64_tr_b16 a[36:37], v1 offset:33792
  v_mfma_f32_16x16x32_bf16 v[44:47], a[20:23], a[172:175], v[44:47]
  ds_read_b64_tr_b16 a[38:39], v1 offset:37888
  v_mfma_f32_16x16x32_bf16 v[40:43], a[20:23], a[168:171], v[40:43]
  ds_read_b64_tr_b16 a[52:53], v1 offset:41984
  buffer_load_dwordx4 v252, s[84:87], s93 offen offset:1024 lds
  v_mfma_f32_16x16x32_bf16 v[40:43], a[4:7], a[160:163], v[40:43]
  ds_read_b64_tr_b16 a[54:55], v1 offset:46080
  s_waitcnt lgkmcnt(8)
  v_mfma_f32_16x16x32_bf16 v[48:51], a[8:11], a[160:163], v[48:51]
  ds_read_b64_tr_b16 a[40:41], v2 offset:33792
  v_mfma_f32_16x16x32_bf16 v[48:51], a[24:27], a[168:171], v[48:51]
  s_add_u32 s48, s48, 4096
  ds_read_b64_tr_b16 a[42:43], v2 offset:37888
  s_min_u32 s63, s88, 4096
  v_mfma_f32_16x16x32_bf16 v[52:55], a[24:27], a[172:175], v[52:55]
  s_add_u32 s63, s63, s48
  ds_read_b64_tr_b16 a[56:57], v2 offset:41984
  buffer_load_dwordx4 a[224:227], v8, s[4:7], s63 offen offset:0 sc1
  v_mfma_f32_16x16x32_bf16 v[52:55], a[8:11], a[164:167], v[52:55]
  ds_read_b64_tr_b16 a[58:59], v2 offset:46080
  v_mfma_f32_16x16x32_bf16 v[60:63], a[12:15], a[164:167], v[60:63]
  ds_read_b64_tr_b16 a[44:45], v3 offset:33792
  v_mfma_f32_16x16x32_bf16 v[60:63], a[28:31], a[172:175], v[60:63]
  ds_read_b64_tr_b16 a[46:47], v3 offset:37888
  v_mfma_f32_16x16x32_bf16 v[56:59], a[28:31], a[168:171], v[56:59]
  ds_read_b64_tr_b16 a[60:61], v3 offset:41984
  buffer_load_dwordx4 a[228:231], v9, s[4:7], s63 offen offset:0 sc1
  v_mfma_f32_16x16x32_bf16 v[56:59], a[12:15], a[160:163], v[56:59]
  ds_read_b64_tr_b16 a[62:63], v3 offset:46080
  s_waitcnt lgkmcnt(8)
  v_mfma_f32_16x16x32_bf16 v[64:67], a[32:35], a[160:163], v[64:67]
  ds_read_b64_tr_b16 a[0:1], v0 offset:49152
  s_add_u32 m0, s79, 8192
  v_mfma_f32_16x16x32_bf16 v[64:67], a[48:51], a[168:171], v[64:67]
  s_add_u32 s92, s92, 262144
  ds_read_b64_tr_b16 a[2:3], v0 offset:53248
  s_add_u32 s93, s92, s89
  v_mfma_f32_16x16x32_bf16 v[68:71], a[48:51], a[172:175], v[68:71]
  ds_read_b64_tr_b16 a[16:17], v0 offset:57344
  buffer_load_dwordx4 v252, s[80:83], s93 offen lds
  v_mfma_f32_16x16x32_bf16 v[68:71], a[32:35], a[164:167], v[68:71]
  ds_read_b64_tr_b16 a[18:19], v0 offset:61440
  v_mfma_f32_16x16x32_bf16 v[76:79], a[36:39], a[164:167], v[76:79]
  ds_read_b64_tr_b16 a[4:5], v1 offset:49152
  v_mfma_f32_16x16x32_bf16 v[76:79], a[52:55], a[172:175], v[76:79]
  ds_read_b64_tr_b16 a[6:7], v1 offset:53248
  v_mfma_f32_16x16x32_bf16 v[72:75], a[52:55], a[168:171], v[72:75]
  ds_read_b64_tr_b16 a[20:21], v1 offset:57344
  buffer_load_dwordx4 v252, s[84:87], s93 offen offset:1024 lds
  v_mfma_f32_16x16x32_bf16 v[72:75], a[36:39], a[160:163], v[72:75]
  ds_read_b64_tr_b16 a[22:23], v1 offset:61440
  s_waitcnt lgkmcnt(8)
  v_mfma_f32_16x16x32_bf16 v[80:83], a[40:43], a[160:163], v[80:83]
  ds_read_b64_tr_b16 a[8:9], v2 offset:49152
  v_mfma_f32_16x16x32_bf16 v[80:83], a[56:59], a[168:171], v[80:83]
  s_min_u32 s63, s89, 4096
  ds_read_b64_tr_b16 a[10:11], v2 offset:53248
  s_add_u32 s63, s63, s48
  v_mfma_f32_16x16x32_bf16 v[84:87], a[56:59], a[172:175], v[84:87]
  ds_read_b64_tr_b16 a[24:25], v2 offset:57344
  buffer_load_dwordx4 a[232:235], v8, s[4:7], s63 offen offset:1024 sc1
  v_mfma_f32_16x16x32_bf16 v[84:87], a[40:43], a[164:167], v[84:87]
  ds_read_b64_tr_b16 a[26:27], v2 offset:61440
  v_mfma_f32_16x16x32_bf16 v[92:95], a[44:47], a[164:167], v[92:95]
  ds_read_b64_tr_b16 a[12:13], v3 offset:49152
  v_mfma_f32_16x16x32_bf16 v[92:95], a[60:63], a[172:175], v[92:95]
  ds_read_b64_tr_b16 a[14:15], v3 offset:53248
  v_mfma_f32_16x16x32_bf16 v[88:91], a[60:63], a[168:171], v[88:91]
  ds_read_b64_tr_b16 a[28:29], v3 offset:57344
  buffer_load_dwordx4 a[236:239], v9, s[4:7], s63 offen offset:1024 sc1
  v_mfma_f32_16x16x32_bf16 v[88:91], a[44:47], a[160:163], v[88:91]
  ds_read_b64_tr_b16 a[30:31], v3 offset:61440
  s_waitcnt vmcnt(25) lgkmcnt(8)
  v_mfma_f32_16x16x32_bf16 v[32:35], a[0:3], a[176:179], v[32:35]
  ds_read_b64_tr_b16 a[32:33], v0 offset:50176
  s_add_u32 m0, s79, 16384
  v_mfma_f32_16x16x32_bf16 v[32:35], a[16:19], a[184:187], v[32:35]
  s_add_u32 s92, s92, 196608
  ds_read_b64_tr_b16 a[34:35], v0 offset:54272
  s_add_u32 s93, s92, s90
  v_mfma_f32_16x16x32_bf16 v[36:39], a[16:19], a[188:191], v[36:39]
  ds_read_b64_tr_b16 a[48:49], v0 offset:58368
  buffer_load_dwordx4 v252, s[80:83], s93 offen lds
  v_mfma_f32_16x16x32_bf16 v[36:39], a[0:3], a[180:183], v[36:39]
  ds_read_b64_tr_b16 a[50:51], v0 offset:62464
  v_mfma_f32_16x16x32_bf16 v[44:47], a[4:7], a[180:183], v[44:47]
  ds_read_b64_tr_b16 a[36:37], v1 offset:50176
  v_mfma_f32_16x16x32_bf16 v[44:47], a[20:23], a[188:191], v[44:47]
  ds_read_b64_tr_b16 a[38:39], v1 offset:54272
  v_mfma_f32_16x16x32_bf16 v[40:43], a[20:23], a[184:187], v[40:43]
  ds_read_b64_tr_b16 a[52:53], v1 offset:58368
  buffer_load_dwordx4 v252, s[84:87], s93 offen offset:1024 lds
  v_mfma_f32_16x16x32_bf16 v[40:43], a[4:7], a[176:179], v[40:43]
  ds_read_b64_tr_b16 a[54:55], v1 offset:62464
  s_waitcnt lgkmcnt(8)
  v_mfma_f32_16x16x32_bf16 v[48:51], a[8:11], a[176:179], v[48:51]
  ds_read_b64_tr_b16 a[40:41], v2 offset:50176
  v_mfma_f32_16x16x32_bf16 v[48:51], a[24:27], a[184:187], v[48:51]
  s_min_u32 s63, s90, 4096
  ds_read_b64_tr_b16 a[42:43], v2 offset:54272
  s_add_u32 s63, s63, s48
  v_mfma_f32_16x16x32_bf16 v[52:55], a[24:27], a[188:191], v[52:55]
  ds_read_b64_tr_b16 a[56:57], v2 offset:58368
  buffer_load_dwordx4 a[240:243], v8, s[4:7], s63 offen offset:2048 sc1
  v_mfma_f32_16x16x32_bf16 v[52:55], a[8:11], a[180:183], v[52:55]
  ds_read_b64_tr_b16 a[58:59], v2 offset:62464
  v_mfma_f32_16x16x32_bf16 v[60:63], a[12:15], a[180:183], v[60:63]
  ds_read_b64_tr_b16 a[44:45], v3 offset:50176
  v_mfma_f32_16x16x32_bf16 v[60:63], a[28:31], a[188:191], v[60:63]
  ds_read_b64_tr_b16 a[46:47], v3 offset:54272
  v_mfma_f32_16x16x32_bf16 v[56:59], a[28:31], a[184:187], v[56:59]
  ds_read_b64_tr_b16 a[60:61], v3 offset:58368
  buffer_load_dwordx4 a[244:247], v9, s[4:7], s63 offen offset:2048 sc1
  v_mfma_f32_16x16x32_bf16 v[56:59], a[12:15], a[176:179], v[56:59]
  ds_read_b64_tr_b16 a[62:63], v3 offset:62464
  s_waitcnt lgkmcnt(8)
  v_mfma_f32_16x16x32_bf16 v[64:67], a[32:35], a[176:179], v[64:67]
  ds_read_b64_tr_b16 a[0:1], v4 offset:0
  s_add_u32 m0, s79, 24576
  v_mfma_f32_16x16x32_bf16 v[64:67], a[48:51], a[184:187], v[64:67]
  s_add_u32 s92, s92, 262144
  ds_read_b64_tr_b16 a[2:3], v4 offset:4096
  s_add_u32 s93, s92, s91
  v_mfma_f32_16x16x32_bf16 v[68:71], a[48:51], a[188:191], v[68:71]
  ds_read_b64_tr_b16 a[16:17], v4 offset:8192
  buffer_load_dwordx4 v252, s[80:83], s93 offen lds
  v_mfma_f32_16x16x32_bf16 v[68:71], a[32:35], a[180:183], v[68:71]
  ds_read_b64_tr_b16 a[18:19], v4 offset:12288
  v_mfma_f32_16x16x32_bf16 v[76:79], a[36:39], a[180:183], v[76:79]
  ds_read_b64_tr_b16 a[4:5], v5 offset:0
  v_mfma_f32_16x16x32_bf16 v[76:79], a[52:55], a[188:191], v[76:79]
  ds_read_b64_tr_b16 a[6:7], v5 offset:4096
  v_mfma_f32_16x16x32_bf16 v[72:75], a[52:55], a[184:187], v[72:75]
  ds_read_b64_tr_b16 a[20:21], v5 offset:8192
  buffer_load_dwordx4 v252, s[84:87], s93 offen offset:1024 lds
  v_mfma_f32_16x16x32_bf16 v[72:75], a[36:39], a[176:179], v[72:75]
  ds_read_b64_tr_b16 a[22:23], v5 offset:12288
  s_waitcnt lgkmcnt(8)
  v_mfma_f32_16x16x32_bf16 v[80:83], a[40:43], a[176:179], v[80:83]
  ds_read_b64_tr_b16 a[8:9], v6 offset:0
  v_mfma_f32_16x16x32_bf16 v[80:83], a[56:59], a[184:187], v[80:83]
  s_min_u32 s63, s91, 4096
  ds_read_b64_tr_b16 a[10:11], v6 offset:4096
  s_add_u32 s63, s63, s48
  v_mfma_f32_16x16x32_bf16 v[84:87], a[56:59], a[188:191], v[84:87]
  ds_read_b64_tr_b16 a[24:25], v6 offset:8192
  buffer_load_dwordx4 a[248:251], v8, s[4:7], s63 offen offset:3072 sc1
  v_mfma_f32_16x16x32_bf16 v[84:87], a[40:43], a[180:183], v[84:87]
  ds_read_b64_tr_b16 a[26:27], v6 offset:12288
  v_mfma_f32_16x16x32_bf16 v[92:95], a[44:47], a[180:183], v[92:95]
  ds_read_b64_tr_b16 a[12:13], v7 offset:0
  v_mfma_f32_16x16x32_bf16 v[92:95], a[60:63], a[188:191], v[92:95]
  ds_read_b64_tr_b16 a[14:15], v7 offset:4096
  v_mfma_f32_16x16x32_bf16 v[88:91], a[60:63], a[184:187], v[88:91]
  ds_read_b64_tr_b16 a[28:29], v7 offset:8192
  buffer_load_dwordx4 a[252:255], v9, s[4:7], s63 offen offset:3072 sc1
  v_mfma_f32_16x16x32_bf16 v[88:91], a[44:47], a[176:179], v[88:91]
  ds_read_b64_tr_b16 a[30:31], v7 offset:12288
  s_waitcnt vmcnt(24) lgkmcnt(8)
  v_mfma_f32_16x16x32_bf16 v[32:35], a[0:3], a[192:195], v[32:35]
  s_waitcnt vmcnt(26)
  s_barrier
  s_xor_b32 s43, s56, 2
  s_or_b32 s43, s43, s40
  s_cbranch_scc1 Lp3_sgl
  v_mov_b32 v250, 1
  s_mov_b64 exec, 1
  buffer_atomic_add v250, v251, s[4:7], s77 offen sc1
  s_mov_b64 exec, -1
Lp3_sgl:
  ds_read_b64_tr_b16 a[32:33], v4 offset:1024
  v_mfma_f32_16x16x32_bf16 v[32:35], a[16:19], a[200:203], v[32:35]
  s_add_u32 m0, s79, 32768
  ds_read_b64_tr_b16 a[34:35], v4 offset:5120
  s_add_u32 s92, s92, 196608
  v_mfma_f32_16x16x32_bf16 v[36:39], a[16:19], a[204:207], v[36:39]
  s_add_u32 s93, s92, s88
  ds_read_b64_tr_b16 a[48:49], v4 offset:9216
  buffer_load_dwordx4 v252, s[80:83], s93 offen lds
  v_mfma_f32_16x16x32_bf16 v[36:39], a[0:3], a[196:199], v[36:39]
  ds_read_b64_tr_b16 a[50:51], v4 offset:13312
  v_mfma_f32_16x16x32_bf16 v[44:47], a[4:7], a[196:199], v[44:47]
  ds_read_b64_tr_b16 a[36:37], v5 offset:1024
  v_mfma_f32_16x16x32_bf16 v[44:47], a[20:23], a[204:207], v[44:47]
  ds_read_b64_tr_b16 a[38:39], v5 offset:5120
  v_mfma_f32_16x16x32_bf16 v[40:43], a[20:23], a[200:203], v[40:43]
  ds_read_b64_tr_b16 a[52:53], v5 offset:9216
  buffer_load_dwordx4 v252, s[84:87], s93 offen offset:1024 lds
  v_mfma_f32_16x16x32_bf16 v[40:43], a[4:7], a[192:195], v[40:43]
  ds_read_b64_tr_b16 a[54:55], v5 offset:13312
  s_waitcnt lgkmcnt(8)
  v_mfma_f32_16x16x32_bf16 v[48:51], a[8:11], a[192:195], v[48:51]
  ds_read_b64_tr_b16 a[40:41], v6 offset:1024
  v_mfma_f32_16x16x32_bf16 v[48:51], a[24:27], a[200:203], v[48:51]
  s_add_u32 s48, s48, 4096
  ds_read_b64_tr_b16 a[42:43], v6 offset:5120
  s_min_u32 s63, s88, 4096
  v_mfma_f32_16x16x32_bf16 v[52:55], a[24:27], a[204:207], v[52:55]
  s_add_u32 s63, s63, s48
  ds_read_b64_tr_b16 a[56:57], v6 offset:9216
  buffer_load_dwordx4 a[128:131], v8, s[4:7], s63 offen offset:0 sc1
  v_mfma_f32_16x16x32_bf16 v[52:55], a[8:11], a[196:199], v[52:55]
  ds_read_b64_tr_b16 a[58:59], v6 offset:13312
  v_mfma_f32_16x16x32_bf16 v[60:63], a[12:15], a[196:199], v[60:63]
  ds_read_b64_tr_b16 a[44:45], v7 offset:1024
  v_mfma_f32_16x16x32_bf16 v[60:63], a[28:31], a[204:207], v[60:63]
  ds_read_b64_tr_b16 a[46:47], v7 offset:5120
  v_mfma_f32_16x16x32_bf16 v[56:59], a[28:31], a[200:203], v[56:59]
  ds_read_b64_tr_b16 a[60:61], v7 offset:9216
  buffer_load_dwordx4 a[132:135], v9, s[4:7], s63 offen offset:0 sc1
  v_mfma_f32_16x16x32_bf16 v[56:59], a[12:15], a[192:195], v[56:59]
  ds_read_b64_tr_b16 a[62:63], v7 offset:13312
  s_waitcnt lgkmcnt(8)
  v_mfma_f32_16x16x32_bf16 v[64:67], a[32:35], a[192:195], v[64:67]
  ds_read_b64_tr_b16 a[0:1], v4 offset:16384
  s_add_u32 m0, s79, 40960
  v_mfma_f32_16x16x32_bf16 v[64:67], a[48:51], a[200:203], v[64:67]
  s_add_u32 s92, s92, 262144
  ds_read_b64_tr_b16 a[2:3], v4 offset:20480
  s_add_u32 s93, s92, s89
  v_mfma_f32_16x16x32_bf16 v[68:71], a[48:51], a[204:207], v[68:71]
  ds_read_b64_tr_b16 a[16:17], v4 offset:24576
  buffer_load_dwordx4 v252, s[80:83], s93 offen lds
  v_mfma_f32_16x16x32_bf16 v[68:71], a[32:35], a[196:199], v[68:71]
  ds_read_b64_tr_b16 a[18:19], v4 offset:28672
  v_mfma_f32_16x16x32_bf16 v[76:79], a[36:39], a[196:199], v[76:79]
  ds_read_b64_tr_b16 a[4:5], v5 offset:16384
  v_mfma_f32_16x16x32_bf16 v[76:79], a[52:55], a[204:207], v[76:79]
  ds_read_b64_tr_b16 a[6:7], v5 offset:20480
  v_mfma_f32_16x16x32_bf16 v[72:75], a[52:55], a[200:203], v[72:75]
  ds_read_b64_tr_b16 a[20:21], v5 offset:24576
  buffer_load_dwordx4 v252, s[84:87], s93 offen offset:1024 lds
  v_mfma_f32_16x16x32_bf16 v[72:75], a[36:39], a[192:195], v[72:75]
  ds_read_b64_tr_b16 a[22:23], v5 offset:28672
  s_waitcnt lgkmcnt(8)
  v_mfma_f32_16x16x32_bf16 v[80:83], a[40:43], a[192:195], v[80:83]
  ds_read_b64_tr_b16 a[8:9], v6 offset:16384
  v_mfma_f32_16x16x32_bf16 v[80:83], a[56:59], a[200:203], v[80:83]
  s_min_u32 s63, s89, 4096
  ds_read_b64_tr_b16 a[10:11], v6 offset:20480
  s_add_u32 s63, s63, s48
  v_mfma_f32_16x16x32_bf16 v[84:87], a[56:59], a[204:207], v[84:87]
  ds_read_b64_tr_b16 a[24:25], v6 offset:24576
  buffer_load_dwordx4 a[136:139], v8, s[4:7], s63 offen offset:1024 sc1
  v_mfma_f32_16x16x32_bf16 v[84:87], a[40:43], a[196:199], v[84:87]
  ds_read_b64_tr_b16 a[26:27], v6 offset:28672
  v_mfma_f32_16x16x32_bf16 v[92:95], a[44:47], a[196:199], v[92:95]
  ds_read_b64_tr_b16 a[12:13], v7 offset:16384
  v_mfma_f32_16x16x32_bf16 v[92:95], a[60:63], a[204:207], v[92:95]
  ds_read_b64_tr_b16 a[14:15], v7 offset:20480
  v_mfma_f32_16x16x32_bf16 v[88:91], a[60:63], a[200:203], v[88:91]
  ds_read_b64_tr_b16 a[28:29], v7 offset:24576
  buffer_load_dwordx4 a[140:143], v9, s[4:7], s63 offen offset:1024 sc1
  v_mfma_f32_16x16x32_bf16 v[88:91], a[44:47], a[192:195], v[88:91]
  ds_read_b64_tr_b16 a[30:31], v7 offset:28672
  s_waitcnt vmcnt(24) lgkmcnt(8)
  v_mfma_f32_16x16x32_bf16 v[32:35], a[0:3], a[208:211], v[32:35]
  ds_read_b64_tr_b16 a[32:33], v4 offset:17408
  s_add_u32 m0, s79, 49152
  v_mfma_f32_16x16x32_bf16 v[32:35], a[16:19], a[216:219], v[32:35]
  s_add_u32 s92, s92, 196608
  ds_read_b64_tr_b16 a[34:35], v4 offset:21504
  s_add_u32 s93, s92, s90
  v_mfma_f32_16x16x32_bf16 v[36:39], a[16:19], a[220:223], v[36:39]
  ds_read_b64_tr_b16 a[48:49], v4 offset:25600
  buffer_load_dwordx4 v252, s[80:83], s93 offen lds
  v_mfma_f32_16x16x32_bf16 v[36:39], a[0:3], a[212:215], v[36:39]
  ds_read_b64_tr_b16 a[50:51], v4 offset:29696
  v_mfma_f32_16x16x32_bf16 v[44:47], a[4:7], a[212:215], v[44:47]
  ds_read_b64_tr_b16 a[36:37], v5 offset:17408
  v_mfma_f32_16x16x32_bf16 v[44:47], a[20:23], a[220:223], v[44:47]
  ds_read_b64_tr_b16 a[38:39], v5 offset:21504
  v_mfma_f32_16x16x32_bf16 v[40:43], a[20:23], a[216:219], v[40:43]
  ds_read_b64_tr_b16 a[52:53], v5 offset:25600
  buffer_load_dwordx4 v252, s[84:87], s93 offen offset:1024 lds
  v_mfma_f32_16x16x32_bf16 v[40:43], a[4:7], a[208:211], v[40:43]
  ds_read_b64_tr_b16 a[54:55], v5 offset:29696
  s_waitcnt lgkmcnt(8)
  v_mfma_f32_16x16x32_bf16 v[48:51], a[8:11], a[208:211], v[48:51]
  ds_read_b64_tr_b16 a[40:41], v6 offset:17408
  v_mfma_f32_16x16x32_bf16 v[48:51], a[24:27], a[216:219], v[48:51]
  s_min_u32 s63, s90, 4096
  ds_read_b64_tr_b16 a[42:43], v6 offset:21504
  s_add_u32 s63, s63, s48
  v_mfma_f32_16x16x32_bf16 v[52:55], a[24:27], a[220:223], v[52:55]
  ds_read_b64_tr_b16 a[56:57], v6 offset:25600
  buffer_load_dwordx4 a[144:147], v8, s[4:7], s63 offen offset:2048 sc1
  v_mfma_f32_16x16x32_bf16 v[52:55], a[8:11], a[212:215], v[52:55]
  ds_read_b64_tr_b16 a[58:59], v6 offset:29696
  v_mfma_f32_16x16x32_bf16 v[60:63], a[12:15], a[212:215], v[60:63]
  ds_read_b64_tr_b16 a[44:45], v7 offset:17408
  v_mfma_f32_16x16x32_bf16 v[60:63], a[28:31], a[220:223], v[60:63]
  ds_read_b64_tr_b16 a[46:47], v7 offset:21504
  v_mfma_f32_16x16x32_bf16 v[56:59], a[28:31], a[216:219], v[56:59]
  ds_read_b64_tr_b16 a[60:61], v7 offset:25600
  buffer_load_dwordx4 a[148:151], v9, s[4:7], s63 offen offset:2048 sc1
  v_mfma_f32_16x16x32_bf16 v[56:59], a[12:15], a[208:211], v[56:59]
  ds_read_b64_tr_b16 a[62:63], v7 offset:29696
  s_waitcnt lgkmcnt(8)
  v_mfma_f32_16x16x32_bf16 v[64:67], a[32:35], a[208:211], v[64:67]
  ds_read_b64_tr_b16 a[0:1], v4 offset:32768
  s_add_u32 m0, s79, 57344
  v_mfma_f32_16x16x32_bf16 v[64:67], a[48:51], a[216:219], v[64:67]
  s_add_u32 s92, s92, 262144
  ds_read_b64_tr_b16 a[2:3], v4 offset:36864
  s_add_u32 s93, s92, s91
  v_mfma_f32_16x16x32_bf16 v[68:71], a[48:51], a[220:223], v[68:71]
  ds_read_b64_tr_b16 a[16:17], v4 offset:40960
  buffer_load_dwordx4 v252, s[80:83], s93 offen lds
  v_mfma_f32_16x16x32_bf16 v[68:71], a[32:35], a[212:215], v[68:71]
  ds_read_b64_tr_b16 a[18:19], v4 offset:45056
  v_mfma_f32_16x16x32_bf16 v[76:79], a[36:39], a[212:215], v[76:79]
  ds_read_b64_tr_b16 a[4:5], v5 offset:32768
  v_mfma_f32_16x16x32_bf16 v[76:79], a[52:55], a[220:223], v[76:79]
  ds_read_b64_tr_b16 a[6:7], v5 offset:36864
  v_mfma_f32_16x16x32_bf16 v[72:75], a[52:55], a[216:219], v[72:75]
  ds_read_b64_tr_b16 a[20:21], v5 offset:40960
  buffer_load_dwordx4 v252, s[84:87], s93 offen offset:1024 lds
  v_mfma_f32_16x16x32_bf16 v[72:75], a[36:39], a[208:211], v[72:75]
  ds_read_b64_tr_b16 a[22:23], v5 offset:45056
  s_waitcnt lgkmcnt(8)
  v_mfma_f32_16x16x32_bf16 v[80:83], a[40:43], a[208:211], v[80:83]
  ds_read_b64_tr_b16 a[8:9], v6 offset:32768
  v_mfma_f32_16x16x32_bf16 v[80:83], a[56:59], a[216:219], v[80:83]
  s_min_u32 s63, s91, 4096
  ds_read_b64_tr_b16 a[10:11], v6 offset:36864
  s_add_u32 s63, s63, s48
  v_mfma_f32_16x16x32_bf16 v[84:87], a[56:59], a[220:223], v[84:87]
  ds_read_b64_tr_b16 a[24:25], v6 offset:40960
  buffer_load_dwordx4 a[152:155], v8, s[4:7], s63 offen offset:3072 sc1
  v_mfma_f32_16x16x32_bf16 v[84:87], a[40:43], a[212:215], v[84:87]
  ds_read_b64_tr_b16 a[26:27], v6 offset:45056
  v_mfma_f32_16x16x32_bf16 v[92:95], a[44:47], a[212:215], v[92:95]
  ds_read_b64_tr_b16 a[12:13], v7 offset:32768
  v_mfma_f32_16x16x32_bf16 v[92:95], a[60:63], a[220:223], v[92:95]
  ds_read_b64_tr_b16 a[14:15], v7 offset:36864
  v_mfma_f32_16x16x32_bf16 v[88:91], a[60:63], a[216:219], v[88:91]
  ds_read_b64_tr_b16 a[28:29], v7 offset:40960
  buffer_load_dwordx4 a[156:159], v9, s[4:7], s63 offen offset:3072 sc1
  v_mfma_f32_16x16x32_bf16 v[88:91], a[44:47], a[208:211], v[88:91]
  ds_read_b64_tr_b16 a[30:31], v7 offset:45056
  s_waitcnt vmcnt(24) lgkmcnt(8)
  v_mfma_f32_16x16x32_bf16 v[32:35], a[0:3], a[224:227], v[32:35]
  s_waitcnt vmcnt(26)
  s_barrier
  ds_read_b64_tr_b16 a[32:33], v4 offset:33792
  v_mfma_f32_16x16x32_bf16 v[32:35], a[16:19], a[232:235], v[32:35]
  s_add_u32 m0, s79, 65536
  ds_read_b64_tr_b16 a[34:35], v4 offset:37888
  s_add_u32 s92, s92, 196608
  v_mfma_f32_16x16x32_bf16 v[36:39], a[16:19], a[236:239], v[36:39]
  s_add_u32 s93, s92, s88
  ds_read_b64_tr_b16 a[48:49], v4 offset:41984
  buffer_load_dwordx4 v252, s[80:83], s93 offen lds
  v_mfma_f32_16x16x32_bf16 v[36:39], a[0:3], a[228:231], v[36:39]
  ds_read_b64_tr_b16 a[50:51], v4 offset:46080
  v_mfma_f32_16x16x32_bf16 v[44:47], a[4:7], a[228:231], v[44:47]
  ds_read_b64_tr_b16 a[36:37], v5 offset:33792
  v_mfma_f32_16x16x32_bf16 v[44:47], a[20:23], a[236:239], v[44:47]
  ds_read_b64_tr_b16 a[38:39], v5 offset:37888
  v_mfma_f32_16x16x32_bf16 v[40:43], a[20:23], a[232:235], v[40:43]
  ds_read_b64_tr_b16 a[52:53], v5 offset:41984
  buffer_load_dwordx4 v252, s[84:87], s93 offen offset:1024 lds
  v_mfma_f32_16x16x32_bf16 v[40:43], a[4:7], a[224:227], v[40:43]
  ds_read_b64_tr_b16 a[54:55], v5 offset:46080
  s_waitcnt lgkmcnt(8)
  v_mfma_f32_16x16x32_bf16 v[48:51], a[8:11], a[224:227], v[48:51]
  ds_read_b64_tr_b16 a[40:41], v6 offset:33792
  v_mfma_f32_16x16x32_bf16 v[48:51], a[24:27], a[232:235], v[48:51]
  s_add_u32 s48, s48, 4096
  ds_read_b64_tr_b16 a[42:43], v6 offset:37888
  s_min_u32 s63, s88, 4096
  v_mfma_f32_16x16x32_bf16 v[52:55], a[24:27], a[236:239], v[52:55]
  s_add_u32 s63, s63, s48
  ds_read_b64_tr_b16 a[56:57], v6 offset:41984
  buffer_load_dwordx4 a[160:163], v8, s[4:7], s63 offen offset:0 sc1
  v_mfma_f32_16x16x32_bf16 v[52:55], a[8:11], a[228:231], v[52:55]
  ds_read_b64_tr_b16 a[58:59], v6 offset:46080
  v_mfma_f32_16x16x32_bf16 v[60:63], a[12:15], a[228:231], v[60:63]
  ds_read_b64_tr_b16 a[44:45], v7 offset:33792
  v_mfma_f32_16x16x32_bf16 v[60:63], a[28:31], a[236:239], v[60:63]
  ds_read_b64_tr_b16 a[46:47], v7 offset:37888
  v_mfma_f32_16x16x32_bf16 v[56:59], a[28:31], a[232:235], v[56:59]
  ds_read_b64_tr_b16 a[60:61], v7 offset:41984
  buffer_load_dwordx4 a[164:167], v9, s[4:7], s63 offen offset:0 sc1
  v_mfma_f32_16x16x32_bf16 v[56:59], a[12:15], a[224:227], v[56:59]
  ds_read_b64_tr_b16 a[62:63], v7 offset:46080
  s_waitcnt lgkmcnt(8)
  v_mfma_f32_16x16x32_bf16 v[64:67], a[32:35], a[224:227], v[64:67]
  ds_read_b64_tr_b16 a[0:1], v4 offset:49152
  s_add_u32 m0, s79, 73728
  v_mfma_f32_16x16x32_bf16 v[64:67], a[48:51], a[232:235], v[64:67]
  s_add_u32 s92, s92, 262144
  ds_read_b64_tr_b16 a[2:3], v4 offset:53248
  s_add_u32 s93, s92, s89
  v_mfma_f32_16x16x32_bf16 v[68:71], a[48:51], a[236:239], v[68:71]
  ds_read_b64_tr_b16 a[16:17], v4 offset:57344
  buffer_load_dwordx4 v252, s[80:83], s93 offen lds
  v_mfma_f32_16x16x32_bf16 v[68:71], a[32:35], a[228:231], v[68:71]
  ds_read_b64_tr_b16 a[18:19], v4 offset:61440
  v_mfma_f32_16x16x32_bf16 v[76:79], a[36:39], a[228:231], v[76:79]
  ds_read_b64_tr_b16 a[4:5], v5 offset:49152
  v_mfma_f32_16x16x32_bf16 v[76:79], a[52:55], a[236:239], v[76:79]
  ds_read_b64_tr_b16 a[6:7], v5 offset:53248
  v_mfma_f32_16x16x32_bf16 v[72:75], a[52:55], a[232:235], v[72:75]
  ds_read_b64_tr_b16 a[20:21], v5 offset:57344
  buffer_load_dwordx4 v252, s[84:87], s93 offen offset:1024 lds
  v_mfma_f32_16x16x32_bf16 v[72:75], a[36:39], a[224:227], v[72:75]
  ds_read_b64_tr_b16 a[22:23], v5 offset:61440
  s_waitcnt lgkmcnt(8)
  v_mfma_f32_16x16x32_bf16 v[80:83], a[40:43], a[224:227], v[80:83]
  ds_read_b64_tr_b16 a[8:9], v6 offset:49152
  v_mfma_f32_16x16x32_bf16 v[80:83], a[56:59], a[232:235], v[80:83]
  s_min_u32 s63, s89, 4096
  ds_read_b64_tr_b16 a[10:11], v6 offset:53248
  s_add_u32 s63, s63, s48
  v_mfma_f32_16x16x32_bf16 v[84:87], a[56:59], a[236:239], v[84:87]
  ds_read_b64_tr_b16 a[24:25], v6 offset:57344
  buffer_load_dwordx4 a[168:171], v8, s[4:7], s63 offen offset:1024 sc1
  v_mfma_f32_16x16x32_bf16 v[84:87], a[40:43], a[228:231], v[84:87]
  ds_read_b64_tr_b16 a[26:27], v6 offset:61440
  v_mfma_f32_16x16x32_bf16 v[92:95], a[44:47], a[228:231], v[92:95]
  ds_read_b64_tr_b16 a[12:13], v7 offset:49152
  v_mfma_f32_16x16x32_bf16 v[92:95], a[60:63], a[236:239], v[92:95]
  ds_read_b64_tr_b16 a[14:15], v7 offset:53248
  v_mfma_f32_16x16x32_bf16 v[88:91], a[60:63], a[232:235], v[88:91]
  ds_read_b64_tr_b16 a[28:29], v7 offset:57344
  buffer_load_dwordx4 a[172:175], v9, s[4:7], s63 offen offset:1024 sc1
  v_mfma_f32_16x16x32_bf16 v[88:91], a[44:47], a[224:227], v[88:91]
  ds_read_b64_tr_b16 a[30:31], v7 offset:61440
  s_waitcnt vmcnt(24) lgkmcnt(8)
  v_mfma_f32_16x16x32_bf16 v[32:35], a[0:3], a[240:243], v[32:35]
  ds_read_b64_tr_b16 a[32:33], v4 offset:50176
  s_add_u32 m0, s79, 81920
  v_mfma_f32_16x16x32_bf16 v[32:35], a[16:19], a[248:251], v[32:35]
  s_add_u32 s92, s92, 196608
  ds_read_b64_tr_b16 a[34:35], v4 offset:54272
  s_add_u32 s93, s92, s90
  v_mfma_f32_16x16x32_bf16 v[36:39], a[16:19], a[252:255], v[36:39]
  ds_read_b64_tr_b16 a[48:49], v4 offset:58368
  buffer_load_dwordx4 v252, s[80:83], s93 offen lds
  v_mfma_f32_16x16x32_bf16 v[36:39], a[0:3], a[244:247], v[36:39]
  ds_read_b64_tr_b16 a[50:51], v4 offset:62464
  v_mfma_f32_16x16x32_bf16 v[44:47], a[4:7], a[244:247], v[44:47]
  ds_read_b64_tr_b16 a[36:37], v5 offset:50176
  v_mfma_f32_16x16x32_bf16 v[44:47], a[20:23], a[252:255], v[44:47]
  ds_read_b64_tr_b16 a[38:39], v5 offset:54272
  v_mfma_f32_16x16x32_bf16 v[40:43], a[20:23], a[248:251], v[40:43]
  ds_read_b64_tr_b16 a[52:53], v5 offset:58368
  buffer_load_dwordx4 v252, s[84:87], s93 offen offset:1024 lds
  v_mfma_f32_16x16x32_bf16 v[40:43], a[4:7], a[240:243], v[40:43]
  ds_read_b64_tr_b16 a[54:55], v5 offset:62464
  s_waitcnt lgkmcnt(8)
  v_mfma_f32_16x16x32_bf16 v[48:51], a[8:11], a[240:243], v[48:51]
  ds_read_b64_tr_b16 a[40:41], v6 offset:50176
  v_mfma_f32_16x16x32_bf16 v[48:51], a[24:27], a[248:251], v[48:51]
  s_min_u32 s63, s90, 4096
  ds_read_b64_tr_b16 a[42:43], v6 offset:54272
  s_add_u32 s63, s63, s48
  v_mfma_f32_16x16x32_bf16 v[52:55], a[24:27], a[252:255], v[52:55]
  ds_read_b64_tr_b16 a[56:57], v6 offset:58368
  buffer_load_dwordx4 a[176:179], v8, s[4:7], s63 offen offset:2048 sc1
  v_mfma_f32_16x16x32_bf16 v[52:55], a[8:11], a[244:247], v[52:55]
  ds_read_b64_tr_b16 a[58:59], v6 offset:62464
  v_mfma_f32_16x16x32_bf16 v[60:63], a[12:15], a[244:247], v[60:63]
  ds_read_b64_tr_b16 a[44:45], v7 offset:50176
  v_mfma_f32_16x16x32_bf16 v[60:63], a[28:31], a[252:255], v[60:63]
  ds_read_b64_tr_b16 a[46:47], v7 offset:54272
  v_mfma_f32_16x16x32_bf16 v[56:59], a[28:31], a[248:251], v[56:59]
  ds_read_b64_tr_b16 a[60:61], v7 offset:58368
  buffer_load_dwordx4 a[180:183], v9, s[4:7], s63 offen offset:2048 sc1
  v_mfma_f32_16x16x32_bf16 v[56:59], a[12:15], a[240:243], v[56:59]
  ds_read_b64_tr_b16 a[62:63], v7 offset:62464
  s_waitcnt lgkmcnt(8)
  v_mfma_f32_16x16x32_bf16 v[64:67], a[32:35], a[240:243], v[64:67]
  ds_read_b64_tr_b16 a[0:1], v0 offset:0
  s_add_u32 m0, s79, 90112
  v_mfma_f32_16x16x32_bf16 v[64:67], a[48:51], a[248:251], v[64:67]
  s_add_u32 s92, s92, 262144
  ds_read_b64_tr_b16 a[2:3], v0 offset:4096
  s_add_u32 s93, s92, s91
  v_mfma_f32_16x16x32_bf16 v[68:71], a[48:51], a[252:255], v[68:71]
  ds_read_b64_tr_b16 a[16:17], v0 offset:8192
  buffer_load_dwordx4 v252, s[80:83], s93 offen lds
  v_mfma_f32_16x16x32_bf16 v[68:71], a[32:35], a[244:247], v[68:71]
  ds_read_b64_tr_b16 a[18:19], v0 offset:12288
  v_mfma_f32_16x16x32_bf16 v[76:79], a[36:39], a[244:247], v[76:79]
  ds_read_b64_tr_b16 a[4:5], v1 offset:0
  v_mfma_f32_16x16x32_bf16 v[76:79], a[52:55], a[252:255], v[76:79]
  ds_read_b64_tr_b16 a[6:7], v1 offset:4096
  v_mfma_f32_16x16x32_bf16 v[72:75], a[52:55], a[248:251], v[72:75]
  ds_read_b64_tr_b16 a[20:21], v1 offset:8192
  buffer_load_dwordx4 v252, s[84:87], s93 offen offset:1024 lds
  v_mfma_f32_16x16x32_bf16 v[72:75], a[36:39], a[240:243], v[72:75]
  ds_read_b64_tr_b16 a[22:23], v1 offset:12288
  s_waitcnt lgkmcnt(8)
  v_mfma_f32_16x16x32_bf16 v[80:83], a[40:43], a[240:243], v[80:83]
  ds_read_b64_tr_b16 a[8:9], v2 offset:0
  v_mfma_f32_16x16x32_bf16 v[80:83], a[56:59], a[248:251], v[80:83]
  s_min_u32 s63, s91, 4096
  ds_read_b64_tr_b16 a[10:11], v2 offset:4096
  s_add_u32 s63, s63, s48
  v_mfma_f32_16x16x32_bf16 v[84:87], a[56:59], a[252:255], v[84:87]
  ds_read_b64_tr_b16 a[24:25], v2 offset:8192
  buffer_load_dwordx4 a[184:187], v8, s[4:7], s63 offen offset:3072 sc1
  v_mfma_f32_16x16x32_bf16 v[84:87], a[40:43], a[244:247], v[84:87]
  ds_read_b64_tr_b16 a[26:27], v2 offset:12288
  v_mfma_f32_16x16x32_bf16 v[92:95], a[44:47], a[244:247], v[92:95]
  ds_read_b64_tr_b16 a[12:13], v3 offset:0
  v_mfma_f32_16x16x32_bf16 v[92:95], a[60:63], a[252:255], v[92:95]
  ds_read_b64_tr_b16 a[14:15], v3 offset:4096
  v_mfma_f32_16x16x32_bf16 v[88:91], a[60:63], a[248:251], v[88:91]
  ds_read_b64_tr_b16 a[28:29], v3 offset:8192
  buffer_load_dwordx4 a[188:191], v9, s[4:7], s63 offen offset:3072 sc1
  v_mfma_f32_16x16x32_bf16 v[88:91], a[44:47], a[240:243], v[88:91]
  s_sub_u32 s56, s56, 1
  ds_read_b64_tr_b16 a[30:31], v3 offset:12288
  s_cmp_lg_u32 s56, 0
  s_cbranch_scc1 Lp4_loop
Lmk_Lp4_loop_tail:
  s_waitcnt vmcnt(24) lgkmcnt(8)
  v_mfma_f32_16x16x32_bf16 v[32:35], a[0:3], a[128:131], v[32:35]
  s_waitcnt vmcnt(26)
  s_barrier
  ds_read_b64_tr_b16 a[32:33], v0 offset:1024
  s_add_u32 m0, s79, 98304
  s_add_u32 s92, s92, 196608
  s_cmp_lg_u32 s88, 0
  s_cselect_b32 s93, -2686976, 0
  s_cselect_b32 s43, s78, 0
  v_mfma_f32_16x16x32_bf16 v[32:35], a[16:19], a[136:139], v[32:35]
  s_add_u32 s93, s93, s43
  ds_read_b64_tr_b16 a[34:35], v0 offset:5120
  s_add_u32 s93, s93, s92
  v_mfma_f32_16x16x32_bf16 v[36:39], a[16:19], a[140:143], v[36:39]
  ds_read_b64_tr_b16 a[48:49], v0 offset:9216
  buffer_load_dwordx4 v252, s[80:83], s93 offen lds
  v_mfma_f32_16x16x32_bf16 v[36:39], a[0:3], a[132:135], v[36:39]
  ds_read_b64_tr_b16 a[50:51], v0 offset:13312
  v_mfma_f32_16x16x32_bf16 v[44:47], a[4:7], a[132:135], v[44:47]
  ds_read_b64_tr_b16 a[36:37], v1 offset:1024
  v_mfma_f32_16x16x32_bf16 v[44:47], a[20:23], a[140:143], v[44:47]
  ds_read_b64_tr_b16 a[38:39], v1 offset:5120
  v_mfma_f32_16x16x32_bf16 v[40:43], a[20:23], a[136:139], v[40:43]
  ds_read_b64_tr_b16 a[52:53], v1 offset:9216
  buffer_load_dwordx4 v252, s[84:87], s93 offen offset:1024 lds
  v_mfma_f32_16x16x32_bf16 v[40:43], a[4:7], a[128:131], v[40:43]
  ds_read_b64_tr_b16 a[54:55], v1 offset:13312
  s_waitcnt lgkmcnt(8)
  v_mfma_f32_16x16x32_bf16 v[48:51], a[8:11], a[128:131], v[48:51]
  ds_read_b64_tr_b16 a[40:41], v2 offset:1024
  v_mfma_f32_16x16x32_bf16 v[48:51], a[24:27], a[136:139], v[48:51]
  s_add_u32 s48, s48, 4096
  ds_read_b64_tr_b16 a[42:43], v2 offset:5120
  s_min_u32 s63, s88, 4096
  v_mfma_f32_16x16x32_bf16 v[52:55], a[24:27], a[140:143], v[52:55]
  s_add_u32 s63, s63, s48
  ds_read_b64_tr_b16 a[56:57], v2 offset:9216
  buffer_load_dwordx4 a[192:195], v8, s[4:7], s63 offen offset:0 sc1
  v_mfma_f32_16x16x32_bf16 v[52:55], a[8:11], a[132:135], v[52:55]
  ds_read_b64_tr_b16 a[58:59], v2 offset:13312
  v_mfma_f32_16x16x32_bf16 v[60:63], a[12:15], a[132:135], v[60:63]
  ds_read_b64_tr_b16 a[44:45], v3 offset:1024
  v_mfma_f32_16x16x32_bf16 v[60:63], a[28:31], a[140:143], v[60:63]
  ds_read_b64_tr_b16 a[46:47], v3 offset:5120
  v_mfma_f32_16x16x32_bf16 v[56:59], a[28:31], a[136:139], v[56:59]
  ds_read_b64_tr_b16 a[60:61], v3 offset:9216
  buffer_load_dwordx4 a[196:199], v9, s[4:7], s63 offen offset:0 sc1
  v_mfma_f32_16x16x32_bf16 v[56:59], a[12:15], a[128:131], v[56:59]
  ds_read_b64_tr_b16 a[62:63], v3 offset:13312
  s_waitcnt lgkmcnt(8)
  v_mfma_f32_16x16x32_bf16 v[64:67], a[32:35], a[128:131], v[64:67]
  s_add_u32 m0, s79, 106496
  ds_read_b64_tr_b16 a[0:1], v0 offset:16384
  s_add_u32 s92, s92, 262144
  s_cmp_lg_u32 s89, 0
  s_cselect_b32 s93, -2490368, 0
  s_cselect_b32 s43, s78, 0
  v_mfma_f32_16x16x32_bf16 v[64:67], a[48:51], a[136:139], v[64:67]
  s_add_u32 s93, s93, s43
  ds_read_b64_tr_b16 a[2:3], v0 offset:20480
  s_add_u32 s93, s93, s92
  v_mfma_f32_16x16x32_bf16 v[68:71], a[48:51], a[140:143], v[68:71]
  ds_read_b64_tr_b16 a[16:17], v0 offset:24576
  buffer_load_dwordx4 v252, s[80:83], s93 offen lds
  v_mfma_f32_16x16x32_bf16 v[68:71], a[32:35], a[132:135], v[68:71]
  ds_read_b64_tr_b16 a[18:19], v0 offset:28672
  v_mfma_f32_16x16x32_bf16 v[76:79], a[36:39], a[132:135], v[76:79]
  ds_read_b64_tr_b16 a[4:5], v1 offset:16384
  v_mfma_f32_16x16x32_bf16 v[76:79], a[52:55], a[140:143], v[76:79]
  ds_read_b64_tr_b16 a[6:7], v1 offset:20480
  v_mfma_f32_16x16x32_bf16 v[72:75], a[52:55], a[136:139], v[72:75]
  ds_read_b64_tr_b16 a[20:21], v1 offset:24576
  buffer_load_dwordx4 v252, s[84:87], s93 offen offset:1024 lds
  v_mfma_f32_16x16x32_bf16 v[72:75], a[36:39], a[128:131], v[72:75]
  ds_read_b64_tr_b16 a[22:23], v1 offset:28672
  s_waitcnt lgkmcnt(8)
  v_mfma_f32_16x16x32_bf16 v[80:83], a[40:43], a[128:131], v[80:83]
  ds_read_b64_tr_b16 a[8:9], v2 offset:16384
  v_mfma_f32_16x16x32_bf16 v[80:83], a[56:59], a[136:139], v[80:83]
  s_min_u32 s63, s89, 4096
  ds_read_b64_tr_b16 a[10:11], v2 offset:20480
  s_add_u32 s63, s63, s48
  v_mfma_f32_16x16x32_bf16 v[84:87], a[56:59], a[140:143], v[84:87]
  ds_read_b64_tr_b16 a[24:25], v2 offset:24576
  buffer_load_dwordx4 a[200:203], v8, s[4:7], s63 offen offset:1024 sc1
  v_mfma_f32_16x16x32_bf16 v[84:87], a[40:43], a[132:135], v[84:87]
  ds_read_b64_tr_b16 a[26:27], v2 offset:28672
  v_mfma_f32_16x16x32_bf16 v[92:95], a[44:47], a[132:135], v[92:95]
  ds_read_b64_tr_b16 a[12:13], v3 offset:16384
  v_mfma_f32_16x16x32_bf16 v[92:95], a[60:63], a[140:143], v[92:95]
  ds_read_b64_tr_b16 a[14:15], v3 offset:20480
  v_mfma_f32_16x16x32_bf16 v[88:91], a[60:63], a[136:139], v[88:91]
  ds_read_b64_tr_b16 a[28:29], v3 offset:24576
  buffer_load_dwordx4 a[204:207], v9, s[4:7], s63 offen offset:1024 sc1
  v_mfma_f32_16x16x32_bf16 v[88:91], a[44:47], a[128:131], v[88:91]
  ds_read_b64_tr_b16 a[30:31], v3 offset:28672
  s_waitcnt vmcnt(24) lgkmcnt(8)
  v_mfma_f32_16x16x32_bf16 v[32:35], a[0:3], a[144:147], v[32:35]
  s_add_u32 m0, s79, 114688
  ds_read_b64_tr_b16 a[32:33], v0 offset:17408
  s_add_u32 s92, s92, 196608
  s_cmp_lg_u32 s90, 0
  s_cselect_b32 s93, -2228224, 0
  s_cselect_b32 s43, s78, 0
  v_mfma_f32_16x16x32_bf16 v[32:35], a[16:19], a[152:155], v[32:35]
  s_add_u32 s93, s93, s43
  ds_read_b64_tr_b16 a[34:35], v0 offset:21504
  s_add_u32 s93, s93, s92
  v_mfma_f32_16x16x32_bf16 v[36:39], a[16:19], a[156:159], v[36:39]
  ds_read_b64_tr_b16 a[48:49], v0 offset:25600
  buffer_load_dwordx4 v252, s[80:83], s93 offen lds
  v_mfma_f32_16x16x32_bf16 v[36:39], a[0:3], a[148:151], v[36:39]
  ds_read_b64_tr_b16 a[50:51], v0 offset:29696
  v_mfma_f32_16x16x32_bf16 v[44:47], a[4:7], a[148:151], v[44:47]
  ds_read_b64_tr_b16 a[36:37], v1 offset:17408
  v_mfma_f32_16x16x32_bf16 v[44:47], a[20:23], a[156:159], v[44:47]
  ds_read_b64_tr_b16 a[38:39], v1 offset:21504
  v_mfma_f32_16x16x32_bf16 v[40:43], a[20:23], a[152:155], v[40:43]
  ds_read_b64_tr_b16 a[52:53], v1 offset:25600
  buffer_load_dwordx4 v252, s[84:87], s93 offen offset:1024 lds
  v_mfma_f32_16x16x32_bf16 v[40:43], a[4:7], a[144:147], v[40:43]
  ds_read_b64_tr_b16 a[54:55], v1 offset:29696
  s_waitcnt lgkmcnt(8)
  v_mfma_f32_16x16x32_bf16 v[48:51], a[8:11], a[144:147], v[48:51]
  ds_read_b64_tr_b16 a[40:41], v2 offset:17408
  v_mfma_f32_16x16x32_bf16 v[48:51], a[24:27], a[152:155], v[48:51]
  s_min_u32 s63, s90, 4096
  ds_read_b64_tr_b16 a[42:43], v2 offset:21504
  s_add_u32 s63, s63, s48
  v_mfma_f32_16x16x32_bf16 v[52:55], a[24:27], a[156:159], v[52:55]
  ds_read_b64_tr_b16 a[56:57], v2 offset:25600
  buffer_load_dwordx4 a[208:211], v8, s[4:7], s63 offen offset:2048 sc1
  v_mfma_f32_16x16x32_bf16 v[52:55], a[8:11], a[148:151], v[52:55]
  ds_read_b64_tr_b16 a[58:59], v2 offset:29696
  v_mfma_f32_16x16x32_bf16 v[60:63], a[12:15], a[148:151], v[60:63]
  ds_read_b64_tr_b16 a[44:45], v3 offset:17408
  v_mfma_f32_16x16x32_bf16 v[60:63], a[28:31], a[156:159], v[60:63]
  ds_read_b64_tr_b16 a[46:47], v3 offset:21504
  v_mfma_f32_16x16x32_bf16 v[56:59], a[28:31], a[152:155], v[56:59]
  ds_read_b64_tr_b16 a[60:61], v3 offset:25600
  buffer_load_dwordx4 a[212:215], v9, s[4:7], s63 offen offset:2048 sc1
  v_mfma_f32_16x16x32_bf16 v[56:59], a[12:15], a[144:147], v[56:59]
  ds_read_b64_tr_b16 a[62:63], v3 offset:29696
  s_waitcnt lgkmcnt(8)
  v_mfma_f32_16x16x32_bf16 v[64:67], a[32:35], a[144:147], v[64:67]
  s_add_u32 m0, s79, 122880
  ds_read_b64_tr_b16 a[0:1], v0 offset:32768
  s_add_u32 s92, s92, 262144
  s_cmp_lg_u32 s91, 0
  s_cselect_b32 s93, -2031616, 0
  s_cselect_b32 s43, s78, 0
  v_mfma_f32_16x16x32_bf16 v[64:67], a[48:51], a[152:155], v[64:67]
  s_add_u32 s93, s93, s43
  ds_read_b64_tr_b16 a[2:3], v0 offset:36864
  s_add_u32 s93, s93, s92
  v_mfma_f32_16x16x32_bf16 v[68:71], a[48:51], a[156:159], v[68:71]
  ds_read_b64_tr_b16 a[16:17], v0 offset:40960
  buffer_load_dwordx4 v252, s[80:83], s93 offen lds
  v_mfma_f32_16x16x32_bf16 v[68:71], a[32:35], a[148:151], v[68:71]
  ds_read_b64_tr_b16 a[18:19], v0 offset:45056
  v_mfma_f32_16x16x32_bf16 v[76:79], a[36:39], a[148:151], v[76:79]
  ds_read_b64_tr_b16 a[4:5], v1 offset:32768
  v_mfma_f32_16x16x32_bf16 v[76:79], a[52:55], a[156:159], v[76:79]
  ds_read_b64_tr_b16 a[6:7], v1 offset:36864
  v_mfma_f32_16x16x32_bf16 v[72:75], a[52:55], a[152:155], v[72:75]
  ds_read_b64_tr_b16 a[20:21], v1 offset:40960
  buffer_load_dwordx4 v252, s[84:87], s93 offen offset:1024 lds
  v_mfma_f32_16x16x32_bf16 v[72:75], a[36:39], a[144:147], v[72:75]
  ds_read_b64_tr_b16 a[22:23], v1 offset:45056
  s_waitcnt lgkmcnt(8)
  v_mfma_f32_16x16x32_bf16 v[80:83], a[40:43], a[144:147], v[80:83]
  ds_read_b64_tr_b16 a[8:9], v2 offset:32768
  v_mfma_f32_16x16x32_bf16 v[80:83], a[56:59], a[152:155], v[80:83]
  s_min_u32 s63, s91, 4096
  ds_read_b64_tr_b16 a[10:11], v2 offset:36864
  s_add_u32 s63, s63, s48
  v_mfma_f32_16x16x32_bf16 v[84:87], a[56:59], a[156:159], v[84:87]
  ds_read_b64_tr_b16 a[24:25], v2 offset:40960
  buffer_load_dwordx4 a[216:219], v8, s[4:7], s63 offen offset:3072 sc1
  v_mfma_f32_16x16x32_bf16 v[84:87], a[40:43], a[148:151], v[84:87]
  ds_read_b64_tr_b16 a[26:27], v2 offset:45056
  v_mfma_f32_16x16x32_bf16 v[92:95], a[44:47], a[148:151], v[92:95]
  ds_read_b64_tr_b16 a[12:13], v3 offset:32768
  v_mfma_f32_16x16x32_bf16 v[92:95], a[60:63], a[156:159], v[92:95]
  ds_read_b64_tr_b16 a[14:15], v3 offset:36864
  v_mfma_f32_16x16x32_bf16 v[88:91], a[60:63], a[152:155], v[88:91]
  ds_read_b64_tr_b16 a[28:29], v3 offset:40960
  buffer_load_dwordx4 a[220:223], v9, s[4:7], s63 offen offset:3072 sc1
  v_mfma_f32_16x16x32_bf16 v[88:91], a[44:47], a[144:147], v[88:91]
  ds_read_b64_tr_b16 a[30:31], v3 offset:45056
  s_waitcnt vmcnt(24) lgkmcnt(8)
  v_mfma_f32_16x16x32_bf16 v[32:35], a[0:3], a[160:163], v[32:35]
  s_waitcnt vmcnt(26)
  s_barrier
  ds_read_b64_tr_b16 a[32:33], v0 offset:33792
  s_add_u32 m0, s79, 0
  s_add_u32 s92, s92, -3407872
  s_add_u32 s92, s92, s78
  s_cmp_lg_u32 s88, 0
  v_mfma_f32_16x16x32_bf16 v[32:35], a[16:19], a[168:171], v[32:35]
  s_cselect_b32 s93, 1835008, 0
  ds_read_b64_tr_b16 a[34:35], v0 offset:37888
  s_add_u32 s93, s93, s92
  v_mfma_f32_16x16x32_bf16 v[36:39], a[16:19], a[172:175], v[36:39]
  ds_read_b64_tr_b16 a[48:49], v0 offset:41984
  buffer_load_dwordx4 v252, s[80:83], s93 offen lds
  v_mfma_f32_16x16x32_bf16 v[36:39], a[0:3], a[164:167], v[36:39]
  ds_read_b64_tr_b16 a[50:51], v0 offset:46080
  v_mfma_f32_16x16x32_bf16 v[44:47], a[4:7], a[164:167], v[44:47]
  ds_read_b64_tr_b16 a[36:37], v1 offset:33792
  v_mfma_f32_16x16x32_bf16 v[44:47], a[20:23], a[172:175], v[44:47]
  ds_read_b64_tr_b16 a[38:39], v1 offset:37888
  v_mfma_f32_16x16x32_bf16 v[40:43], a[20:23], a[168:171], v[40:43]
  ds_read_b64_tr_b16 a[52:53], v1 offset:41984
  buffer_load_dwordx4 v252, s[84:87], s93 offen offset:1024 lds
  v_mfma_f32_16x16x32_bf16 v[40:43], a[4:7], a[160:163], v[40:43]
  ds_read_b64_tr_b16 a[54:55], v1 offset:46080
  s_waitcnt lgkmcnt(8)
  v_mfma_f32_16x16x32_bf16 v[48:51], a[8:11], a[160:163], v[48:51]
  ds_read_b64_tr_b16 a[40:41], v2 offset:33792
  v_mfma_f32_16x16x32_bf16 v[48:51], a[24:27], a[168:171], v[48:51]
  s_add_u32 s48, s48, 4096
  ds_read_b64_tr_b16 a[42:43], v2 offset:37888
  s_min_u32 s63, s88, 4096
  v_mfma_f32_16x16x32_bf16 v[52:55], a[24:27], a[172:175], v[52:55]
  s_add_u32 s63, s63, s48
  ds_read_b64_tr_b16 a[56:57], v2 offset:41984
  buffer_load_dwordx4 a[224:227], v8, s[4:7], s63 offen offset:0 sc1
  v_mfma_f32_16x16x32_bf16 v[52:55], a[8:11], a[164:167], v[52:55]
  ds_read_b64_tr_b16 a[58:59], v2 offset:46080
  v_mfma_f32_16x16x32_bf16 v[60:63], a[12:15], a[164:167], v[60:63]
  ds_read_b64_tr_b16 a[44:45], v3 offset:33792
  v_mfma_f32_16x16x32_bf16 v[60:63], a[28:31], a[172:175], v[60:63]
  ds_read_b64_tr_b16 a[46:47], v3 offset:37888
  v_mfma_f32_16x16x32_bf16 v[56:59], a[28:31], a[168:171], v[56:59]
  ds_read_b64_tr_b16 a[60:61], v3 offset:41984
  buffer_load_dwordx4 a[228:231], v9, s[4:7], s63 offen offset:0 sc1
  v_mfma_f32_16x16x32_bf16 v[56:59], a[12:15], a[160:163], v[56:59]
  ds_read_b64_tr_b16 a[62:63], v3 offset:46080
  s_waitcnt lgkmcnt(8)
  v_mfma_f32_16x16x32_bf16 v[64:67], a[32:35], a[160:163], v[64:67]
  s_add_u32 m0, s79, 8192
  ds_read_b64_tr_b16 a[0:1], v0 offset:49152
  s_add_u32 s92, s92, 458752
  s_cmp_lg_u32 s89, 0
  v_mfma_f32_16x16x32_bf16 v[64:67], a[48:51], a[168:171], v[64:67]
  s_cselect_b32 s93, 1835008, 0
  ds_read_b64_tr_b16 a[2:3], v0 offset:53248
  s_add_u32 s93, s93, s92
  v_mfma_f32_16x16x32_bf16 v[68:71], a[48:51], a[172:175], v[68:71]
  ds_read_b64_tr_b16 a[16:17], v0 offset:57344
  buffer_load_dwordx4 v252, s[80:83], s93 offen lds
  v_mfma_f32_16x16x32_bf16 v[68:71], a[32:35], a[164:167], v[68:71]
  ds_read_b64_tr_b16 a[18:19], v0 offset:61440
  v_mfma_f32_16x16x32_bf16 v[76:79], a[36:39], a[164:167], v[76:79]
  ds_read_b64_tr_b16 a[4:5], v1 offset:49152
  v_mfma_f32_16x16x32_bf16 v[76:79], a[52:55], a[172:175], v[76:79]
  ds_read_b64_tr_b16 a[6:7], v1 offset:53248
  v_mfma_f32_16x16x32_bf16 v[72:75], a[52:55], a[168:171], v[72:75]
  ds_read_b64_tr_b16 a[20:21], v1 offset:57344
  buffer_load_dwordx4 v252, s[84:87], s93 offen offset:1024 lds
  v_mfma_f32_16x16x32_bf16 v[72:75], a[36:39], a[160:163], v[72:75]
  ds_read_b64_tr_b16 a[22:23], v1 offset:61440
  s_waitcnt lgkmcnt(8)
  v_mfma_f32_16x16x32_bf16 v[80:83], a[40:43], a[160:163], v[80:83]
  ds_read_b64_tr_b16 a[8:9], v2 offset:49152
  v_mfma_f32_16x16x32_bf16 v[80:83], a[56:59], a[168:171], v[80:83]
  s_min_u32 s63, s89, 4096
  ds_read_b64_tr_b16 a[10:11], v2 offset:53248
  s_add_u32 s63, s63, s48
  v_mfma_f32_16x16x32_bf16 v[84:87], a[56:59], a[172:175], v[84:87]
  ds_read_b64_tr_b16 a[24:25], v2 offset:57344
  buffer_load_dwordx4 a[232:235], v8, s[4:7], s63 offen offset:1024 sc1
  v_mfma_f32_16x16x32_bf16 v[84:87], a[40:43], a[164:167], v[84:87]
  ds_read_b64_tr_b16 a[26:27], v2 offset:61440
  v_mfma_f32_16x16x32_bf16 v[92:95], a[44:47], a[164:167], v[92:95]
  ds_read_b64_tr_b16 a[12:13], v3 offset:49152
  v_mfma_f32_16x16x32_bf16 v[92:95], a[60:63], a[172:175], v[92:95]
  ds_read_b64_tr_b16 a[14:15], v3 offset:53248
  v_mfma_f32_16x16x32_bf16 v[88:91], a[60:63], a[168:171], v[88:91]
  ds_read_b64_tr_b16 a[28:29], v3 offset:57344
  buffer_load_dwordx4 a[236:239], v9, s[4:7], s63 offen offset:1024 sc1
  v_mfma_f32_16x16x32_bf16 v[88:91], a[44:47], a[160:163], v[88:91]
  ds_read_b64_tr_b16 a[30:31], v3 offset:61440
  s_waitcnt vmcnt(24) lgkmcnt(8)
  v_mfma_f32_16x16x32_bf16 v[32:35], a[0:3], a[176:179], v[32:35]
  s_add_u32 m0, s79, 16384
  ds_read_b64_tr_b16 a[32:33], v0 offset:50176
  s_add_u32 s92, s92, 458752
  s_cmp_lg_u32 s90, 0
  v_mfma_f32_16x16x32_bf16 v[32:35], a[16:19], a[184:187], v[32:35]
  s_cselect_b32 s93, 1835008, 0
  ds_read_b64_tr_b16 a[34:35], v0 offset:54272
  s_add_u32 s93, s93, s92
  v_mfma_f32_16x16x32_bf16 v[36:39], a[16:19], a[188:191], v[36:39]
  ds_read_b64_tr_b16 a[48:49], v0 offset:58368
  buffer_load_dwordx4 v252, s[80:83], s93 offen lds
  v_mfma_f32_16x16x32_bf16 v[36:39], a[0:3], a[180:183], v[36:39]
  ds_read_b64_tr_b16 a[50:51], v0 offset:62464
  v_mfma_f32_16x16x32_bf16 v[44:47], a[4:7], a[180:183], v[44:47]
  ds_read_b64_tr_b16 a[36:37], v1 offset:50176
  v_mfma_f32_16x16x32_bf16 v[44:47], a[20:23], a[188:191], v[44:47]
  ds_read_b64_tr_b16 a[38:39], v1 offset:54272
  v_mfma_f32_16x16x32_bf16 v[40:43], a[20:23], a[184:187], v[40:43]
  ds_read_b64_tr_b16 a[52:53], v1 offset:58368
  buffer_load_dwordx4 v252, s[84:87], s93 offen offset:1024 lds
  v_mfma_f32_16x16x32_bf16 v[40:43], a[4:7], a[176:179], v[40:43]
  ds_read_b64_tr_b16 a[54:55], v1 offset:62464
  s_waitcnt lgkmcnt(8)
  v_mfma_f32_16x16x32_bf16 v[48:51], a[8:11], a[176:179], v[48:51]
  ds_read_b64_tr_b16 a[40:41], v2 offset:50176
  v_mfma_f32_16x16x32_bf16 v[48:51], a[24:27], a[184:187], v[48:51]
  s_min_u32 s63, s90, 4096
  ds_read_b64_tr_b16 a[42:43], v2 offset:54272
  s_add_u32 s63, s63, s48
  v_mfma_f32_16x16x32_bf16 v[52:55], a[24:27], a[188:191], v[52:55]
  ds_read_b64_tr_b16 a[56:57], v2 offset:58368
  buffer_load_dwordx4 a[240:243], v8, s[4:7], s63 offen offset:2048 sc1
  v_mfma_f32_16x16x32_bf16 v[52:55], a[8:11], a[180:183], v[52:55]
  ds_read_b64_tr_b16 a[58:59], v2 offset:62464
  v_mfma_f32_16x16x32_bf16 v[60:63], a[12:15], a[180:183], v[60:63]
  ds_read_b64_tr_b16 a[44:45], v3 offset:50176
  v_mfma_f32_16x16x32_bf16 v[60:63], a[28:31], a[188:191], v[60:63]
  ds_read_b64_tr_b16 a[46:47], v3 offset:54272
  v_mfma_f32_16x16x32_bf16 v[56:59], a[28:31], a[184:187], v[56:59]
  ds_read_b64_tr_b16 a[60:61], v3 offset:58368
  buffer_load_dwordx4 a[244:247], v9, s[4:7], s63 offen offset:2048 sc1
  v_mfma_f32_16x16x32_bf16 v[56:59], a[12:15], a[176:179], v[56:59]
  ds_read_b64_tr_b16 a[62:63], v3 offset:62464
  s_waitcnt lgkmcnt(8)
  v_mfma_f32_16x16x32_bf16 v[64:67], a[32:35], a[176:179], v[64:67]
  s_add_u32 m0, s79, 24576
  ds_read_b64_tr_b16 a[0:1], v4 offset:0
  s_add_u32 s92, s92, 458752
  s_cmp_lg_u32 s91, 0
  v_mfma_f32_16x16x32_bf16 v[64:67], a[48:51], a[184:187], v[64:67]
  s_cselect_b32 s93, 1835008, 0
  ds_read_b64_tr_b16 a[2:3], v4 offset:4096
  s_add_u32 s93, s93, s92
  v_mfma_f32_16x16x32_bf16 v[68:71], a[48:51], a[188:191], v[68:71]
  ds_read_b64_tr_b16 a[16:17], v4 offset:8192
  buffer_load_dwordx4 v252, s[80:83], s93 offen lds
  v_mfma_f32_16x16x32_bf16 v[68:71], a[32:35], a[180:183], v[68:71]
  ds_read_b64_tr_b16 a[18:19], v4 offset:12288
  v_mfma_f32_16x16x32_bf16 v[76:79], a[36:39], a[180:183], v[76:79]
  ds_read_b64_tr_b16 a[4:5], v5 offset:0
  v_mfma_f32_16x16x32_bf16 v[76:79], a[52:55], a[188:191], v[76:79]
  ds_read_b64_tr_b16 a[6:7], v5 offset:4096
  v_mfma_f32_16x16x32_bf16 v[72:75], a[52:55], a[184:187], v[72:75]
  ds_read_b64_tr_b16 a[20:21], v5 offset:8192
  buffer_load_dwordx4 v252, s[84:87], s93 offen offset:1024 lds
  v_mfma_f32_16x16x32_bf16 v[72:75], a[36:39], a[176:179], v[72:75]
  ds_read_b64_tr_b16 a[22:23], v5 offset:12288
  s_waitcnt lgkmcnt(8)
  v_mfma_f32_16x16x32_bf16 v[80:83], a[40:43], a[176:179], v[80:83]
  ds_read_b64_tr_b16 a[8:9], v6 offset:0
  v_mfma_f32_16x16x32_bf16 v[80:83], a[56:59], a[184:187], v[80:83]
  s_min_u32 s63, s91, 4096
  ds_read_b64_tr_b16 a[10:11], v6 offset:4096
  s_add_u32 s63, s63, s48
  v_mfma_f32_16x16x32_bf16 v[84:87], a[56:59], a[188:191], v[84:87]
  ds_read_b64_tr_b16 a[24:25], v6 offset:8192
  buffer_load_dwordx4 a[248:251], v8, s[4:7], s63 offen offset:3072 sc1
  v_mfma_f32_16x16x32_bf16 v[84:87], a[40:43], a[180:183], v[84:87]
  ds_read_b64_tr_b16 a[26:27], v6 offset:12288
  v_mfma_f32_16x16x32_bf16 v[92:95], a[44:47], a[180:183], v[92:95]
  ds_read_b64_tr_b16 a[12:13], v7 offset:0
  v_mfma_f32_16x16x32_bf16 v[92:95], a[60:63], a[188:191], v[92:95]
  ds_read_b64_tr_b16 a[14:15], v7 offset:4096
  v_mfma_f32_16x16x32_bf16 v[88:91], a[60:63], a[184:187], v[88:91]
  ds_read_b64_tr_b16 a[28:29], v7 offset:8192
  buffer_load_dwordx4 a[252:255], v9, s[4:7], s63 offen offset:3072 sc1
  v_mfma_f32_16x16x32_bf16 v[88:91], a[44:47], a[176:179], v[88:91]
  ds_read_b64_tr_b16 a[30:31], v7 offset:12288
  s_waitcnt vmcnt(24) lgkmcnt(8)
  v_mfma_f32_16x16x32_bf16 v[32:35], a[0:3], a[192:195], v[32:35]
  s_waitcnt vmcnt(26)
  s_barrier
  ds_read_b64_tr_b16 a[32:33], v4 offset:16384
  s_add_u32 m0, s79, 32768
  s_add_u32 s92, s92, 458752
  s_cmp_lg_u32 s88, 0
  s_cselect_b32 s93, -2031616, 0
  s_cselect_b32 s43, s78, 0
  v_mfma_f32_16x16x32_bf16 v[32:35], a[16:19], a[200:203], v[32:35]
  s_sub_u32 s93, s93, s43
  ds_read_b64_tr_b16 a[34:35], v4 offset:20480
  s_add_u32 s93, s93, s92
  v_mfma_f32_16x16x32_bf16 v[36:39], a[16:19], a[204:207], v[36:39]
  ds_read_b64_tr_b16 a[48:49], v4 offset:24576
  buffer_load_dwordx4 v252, s[80:83], s93 offen lds
  v_mfma_f32_16x16x32_bf16 v[36:39], a[0:3], a[196:199], v[36:39]
  ds_read_b64_tr_b16 a[50:51], v4 offset:28672
  v_mfma_f32_16x16x32_bf16 v[44:47], a[4:7], a[196:199], v[44:47]
  ds_read_b64_tr_b16 a[36:37], v5 offset:16384
  buffer_load_dwordx4 v252, s[84:87], s93 offen offset:1024 lds
  v_mfma_f32_16x16x32_bf16 v[44:47], a[20:23], a[204:207], v[44:47]
  s_add_u32 s48, s48, 4096
  ds_read_b64_tr_b16 a[38:39], v5 offset:20480
  s_min_u32 s63, s88, 4096
  v_mfma_f32_16x16x32_bf16 v[40:43], a[20:23], a[200:203], v[40:43]
  s_add_u32 s63, s63, s48
  ds_read_b64_tr_b16 a[52:53], v5 offset:24576
  buffer_load_dwordx4 a[128:131], v8, s[4:7], s63 offen offset:0 sc1
  v_mfma_f32_16x16x32_bf16 v[40:43], a[4:7], a[192:195], v[40:43]
  ds_read_b64_tr_b16 a[54:55], v5 offset:28672
  s_waitcnt lgkmcnt(8)
  v_mfma_f32_16x16x32_bf16 v[48:51], a[8:11], a[192:195], v[48:51]
  s_add_u32 m0, s79, 40960
  ds_read_b64_tr_b16 a[40:41], v6 offset:16384
  buffer_load_dwordx4 a[132:135], v9, s[4:7], s63 offen offset:0 sc1
  s_add_u32 s92, s92, 458752
  s_cmp_lg_u32 s89, 0
  s_cselect_b32 s93, -2228224, 0
  s_cselect_b32 s43, s78, 0
  v_mfma_f32_16x16x32_bf16 v[48:51], a[24:27], a[200:203], v[48:51]
  s_sub_u32 s93, s93, s43
  ds_read_b64_tr_b16 a[42:43], v6 offset:20480
  s_add_u32 s93, s93, s92
  v_mfma_f32_16x16x32_bf16 v[52:55], a[24:27], a[204:207], v[52:55]
  ds_read_b64_tr_b16 a[56:57], v6 offset:24576
  buffer_load_dwordx4 v252, s[80:83], s93 offen lds
  v_mfma_f32_16x16x32_bf16 v[52:55], a[8:11], a[196:199], v[52:55]
  ds_read_b64_tr_b16 a[58:59], v6 offset:28672
  v_mfma_f32_16x16x32_bf16 v[60:63], a[12:15], a[196:199], v[60:63]
  ds_read_b64_tr_b16 a[44:45], v7 offset:16384
  buffer_load_dwordx4 v252, s[84:87], s93 offen offset:1024 lds
  v_mfma_f32_16x16x32_bf16 v[60:63], a[28:31], a[204:207], v[60:63]
  s_min_u32 s63, s89, 4096
  ds_read_b64_tr_b16 a[46:47], v7 offset:20480
  s_add_u32 s63, s63, s48
  v_mfma_f32_16x16x32_bf16 v[56:59], a[28:31], a[200:203], v[56:59]
  ds_read_b64_tr_b16 a[60:61], v7 offset:24576
  buffer_load_dwordx4 a[136:139], v8, s[4:7], s63 offen offset:1024 sc1
  v_mfma_f32_16x16x32_bf16 v[56:59], a[12:15], a[192:195], v[56:59]
  s_waitcnt vmcnt(23) lgkmcnt(7)
  ds_read_b64_tr_b16 a[62:63], v7 offset:28672
  buffer_load_dwordx4 a[140:143], v9, s[4:7], s63 offen offset:1024 sc1
  v_mfma_f32_16x16x32_bf16 v[32:35], a[32:35], a[208:211], v[32:35]
  s_add_u32 m0, s79, 49152
  ds_read_b64_tr_b16 a[0:1], v4 offset:32768
  s_add_u32 s92, s92, 458752
  s_cmp_lg_u32 s90, 0
  s_cselect_b32 s93, -2490368, 0
  s_cselect_b32 s43, s78, 0
  v_mfma_f32_16x16x32_bf16 v[32:35], a[48:51], a[216:219], v[32:35]
  s_sub_u32 s93, s93, s43
  ds_read_b64_tr_b16 a[2:3], v4 offset:36864
  s_add_u32 s93, s93, s92
  v_mfma_f32_16x16x32_bf16 v[36:39], a[48:51], a[220:223], v[36:39]
  ds_read_b64_tr_b16 a[16:17], v4 offset:40960
  buffer_load_dwordx4 v252, s[80:83], s93 offen lds
  v_mfma_f32_16x16x32_bf16 v[36:39], a[32:35], a[212:215], v[36:39]
  ds_read_b64_tr_b16 a[18:19], v4 offset:45056
  v_mfma_f32_16x16x32_bf16 v[44:47], a[36:39], a[212:215], v[44:47]
  ds_read_b64_tr_b16 a[4:5], v5 offset:32768
  buffer_load_dwordx4 v252, s[84:87], s93 offen offset:1024 lds
  v_mfma_f32_16x16x32_bf16 v[44:47], a[52:55], a[220:223], v[44:47]
  s_min_u32 s63, s90, 4096
  ds_read_b64_tr_b16 a[6:7], v5 offset:36864
  s_add_u32 s63, s63, s48
  v_mfma_f32_16x16x32_bf16 v[40:43], a[52:55], a[216:219], v[40:43]
  ds_read_b64_tr_b16 a[20:21], v5 offset:40960
  buffer_load_dwordx4 a[144:147], v8, s[4:7], s63 offen offset:2048 sc1
  v_mfma_f32_16x16x32_bf16 v[40:43], a[36:39], a[208:211], v[40:43]
  ds_read_b64_tr_b16 a[22:23], v5 offset:45056
  s_waitcnt lgkmcnt(8)
  v_mfma_f32_16x16x32_bf16 v[48:51], a[40:43], a[208:211], v[48:51]
  s_add_u32 m0, s79, 57344
  ds_read_b64_tr_b16 a[8:9], v6 offset:32768
  buffer_load_dwordx4 a[148:151], v9, s[4:7], s63 offen offset:2048 sc1
  s_add_u32 s92, s92, 458752
  s_cmp_lg_u32 s91, 0
  s_cselect_b32 s93, -2686976, 0
  s_cselect_b32 s43, s78, 0
  v_mfma_f32_16x16x32_bf16 v[48:51], a[56:59], a[216:219], v[48:51]
  s_sub_u32 s93, s93, s43
  ds_read_b64_tr_b16 a[10:11], v6 offset:36864
  s_add_u32 s93, s93, s92
  v_mfma_f32_16x16x32_bf16 v[52:55], a[56:59], a[220:223], v[52:55]
  ds_read_b64_tr_b16 a[24:25], v6 offset:40960
  buffer_load_dwordx4 v252, s[80:83], s93 offen lds
  v_mfma_f32_16x16x32_bf16 v[52:55], a[40:43], a[212:215], v[52:55]
  ds_read_b64_tr_b16 a[26:27], v6 offset:45056
  v_mfma_f32_16x16x32_bf16 v[60:63], a[44:47], a[212:215], v[60:63]
  ds_read_b64_tr_b16 a[12:13], v7 offset:32768
  buffer_load_dwordx4 v252, s[84:87], s93 offen offset:1024 lds
  v_mfma_f32_16x16x32_bf16 v[60:63], a[60:63], a[220:223], v[60:63]
  s_min_u32 s63, s91, 4096
  ds_read_b64_tr_b16 a[14:15], v7 offset:36864
  s_add_u32 s63, s63, s48
  v_mfma_f32_16x16x32_bf16 v[56:59], a[60:63], a[216:219], v[56:59]
  ds_read_b64_tr_b16 a[28:29], v7 offset:40960
  buffer_load_dwordx4 a[152:155], v8, s[4:7], s63 offen offset:3072 sc1
  v_mfma_f32_16x16x32_bf16 v[56:59], a[44:47], a[208:211], v[56:59]
  s_waitcnt vmcnt(23) lgkmcnt(7)
  ds_read_b64_tr_b16 a[30:31], v7 offset:45056
  buffer_load_dwordx4 a[156:159], v9, s[4:7], s63 offen offset:3072 sc1
  v_mfma_f32_16x16x32_bf16 v[32:35], a[0:3], a[224:227], v[32:35]
  s_waitcnt vmcnt(26)
  s_barrier
  ds_read_b64_tr_b16 a[32:33], v4 offset:49152
  v_mfma_f32_16x16x32_bf16 v[32:35], a[16:19], a[232:235], v[32:35]
  s_add_u32 s48, s48, 4096
  ds_read_b64_tr_b16 a[34:35], v4 offset:53248
  s_min_u32 s63, s88, 4096
  s_mul_i32 s63, s63, -13
  v_mfma_f32_16x16x32_bf16 v[36:39], a[16:19], a[236:239], v[36:39]
  s_add_u32 s63, s63, s48
  ds_read_b64_tr_b16 a[48:49], v4 offset:57344
  buffer_load_dwordx4 a[160:163], v8, s[4:7], s63 offen offset:0 sc1
  v_mfma_f32_16x16x32_bf16 v[36:39], a[0:3], a[228:231], v[36:39]
  ds_read_b64_tr_b16 a[50:51], v4 offset:61440
  v_mfma_f32_16x16x32_bf16 v[44:47], a[4:7], a[228:231], v[44:47]
  ds_read_b64_tr_b16 a[36:37], v5 offset:49152
  v_mfma_f32_16x16x32_bf16 v[44:47], a[20:23], a[236:239], v[44:47]
  ds_read_b64_tr_b16 a[38:39], v5 offset:53248
  v_mfma_f32_16x16x32_bf16 v[40:43], a[20:23], a[232:235], v[40:43]
  ds_read_b64_tr_b16 a[52:53], v5 offset:57344
  buffer_load_dwordx4 a[164:167], v9, s[4:7], s63 offen offset:0 sc1
  v_mfma_f32_16x16x32_bf16 v[40:43], a[4:7], a[224:227], v[40:43]
  ds_read_b64_tr_b16 a[54:55], v5 offset:61440
  s_waitcnt lgkmcnt(8)
  v_mfma_f32_16x16x32_bf16 v[48:51], a[8:11], a[224:227], v[48:51]
  ds_read_b64_tr_b16 a[40:41], v6 offset:49152
  v_mfma_f32_16x16x32_bf16 v[48:51], a[24:27], a[232:235], v[48:51]
  s_min_u32 s63, s89, 4096
  ds_read_b64_tr_b16 a[42:43], v6 offset:53248
  s_mul_i32 s63, s63, -13
  v_mfma_f32_16x16x32_bf16 v[52:55], a[24:27], a[236:239], v[52:55]
  s_add_u32 s63, s63, s48
  ds_read_b64_tr_b16 a[56:57], v6 offset:57344
  buffer_load_dwordx4 a[168:171], v8, s[4:7], s63 offen offset:1024 sc1
  v_mfma_f32_16x16x32_bf16 v[52:55], a[8:11], a[228:231], v[52:55]
  ds_read_b64_tr_b16 a[58:59], v6 offset:61440
  v_mfma_f32_16x16x32_bf16 v[60:63], a[12:15], a[228:231], v[60:63]
  ds_read_b64_tr_b16 a[44:45], v7 offset:49152
  v_mfma_f32_16x16x32_bf16 v[60:63], a[28:31], a[236:239], v[60:63]
  ds_read_b64_tr_b16 a[46:47], v7 offset:53248
  v_mfma_f32_16x16x32_bf16 v[56:59], a[28:31], a[232:235], v[56:59]
  ds_read_b64_tr_b16 a[60:61], v7 offset:57344
  buffer_load_dwordx4 a[172:175], v9, s[4:7], s63 offen offset:1024 sc1
  v_mfma_f32_16x16x32_bf16 v[56:59], a[12:15], a[224:227], v[56:59]
  ds_read_b64_tr_b16 a[62:63], v7 offset:61440
  s_waitcnt vmcnt(20) lgkmcnt(8)
  v_mfma_f32_16x16x32_bf16 v[32:35], a[32:35], a[240:243], v[32:35]
  ds_read_b64_tr_b16 a[0:1], v0 offset:0
  v_mfma_f32_16x16x32_bf16 v[32:35], a[48:51], a[248:251], v[32:35]
  s_min_u32 s63, s90, 4096
  ds_read_b64_tr_b16 a[2:3], v0 offset:4096
  s_mul_i32 s63, s63, -13
  v_mfma_f32_16x16x32_bf16 v[36:39], a[48:51], a[252:255], v[36:39]
  s_add_u32 s63, s63, s48
  ds_read_b64_tr_b16 a[16:17], v0 offset:8192
  buffer_load_dwordx4 a[176:179], v8, s[4:7], s63 offen offset:2048 sc1
  v_mfma_f32_16x16x32_bf16 v[36:39], a[32:35], a[244:247], v[36:39]
  ds_read_b64_tr_b16 a[18:19], v0 offset:12288
  v_mfma_f32_16x16x32_bf16 v[44:47], a[36:39], a[244:247], v[44:47]
  ds_read_b64_tr_b16 a[4:5], v1 offset:0
  v_mfma_f32_16x16x32_bf16 v[44:47], a[52:55], a[252:255], v[44:47]
  ds_read_b64_tr_b16 a[6:7], v1 offset:4096
  v_mfma_f32_16x16x32_bf16 v[40:43], a[52:55], a[248:251], v[40:43]
  ds_read_b64_tr_b16 a[20:21], v1 offset:8192
  buffer_load_dwordx4 a[180:183], v9, s[4:7], s63 offen offset:2048 sc1
  v_mfma_f32_16x16x32_bf16 v[40:43], a[36:39], a[240:243], v[40:43]
  ds_read_b64_tr_b16 a[22:23], v1 offset:12288
  s_waitcnt lgkmcnt(8)
  v_mfma_f32_16x16x32_bf16 v[48:51], a[40:43], a[240:243], v[48:51]
  ds_read_b64_tr_b16 a[8:9], v2 offset:0
  v_mfma_f32_16x16x32_bf16 v[48:51], a[56:59], a[248:251], v[48:51]
  s_min_u32 s63, s91, 4096
  ds_read_b64_tr_b16 a[10:11], v2 offset:4096
  s_mul_i32 s63, s63, -13
  v_mfma_f32_16x16x32_bf16 v[52:55], a[56:59], a[252:255], v[52:55]
  s_add_u32 s63, s63, s48
  ds_read_b64_tr_b16 a[24:25], v2 offset:8192
  buffer_load_dwordx4 a[184:187], v8, s[4:7], s63 offen offset:3072 sc1
  v_mfma_f32_16x16x32_bf16 v[52:55], a[40:43], a[244:247], v[52:55]
  ds_read_b64_tr_b16 a[26:27], v2 offset:12288
  v_mfma_f32_16x16x32_bf16 v[60:63], a[44:47], a[244:247], v[60:63]
  ds_read_b64_tr_b16 a[12:13], v3 offset:0
  v_mfma_f32_16x16x32_bf16 v[60:63], a[60:63], a[252:255], v[60:63]
  ds_read_b64_tr_b16 a[14:15], v3 offset:4096
  v_mfma_f32_16x16x32_bf16 v[56:59], a[60:63], a[248:251], v[56:59]
  ds_read_b64_tr_b16 a[28:29], v3 offset:8192
  buffer_load_dwordx4 a[188:191], v9, s[4:7], s63 offen offset:3072 sc1
  v_mfma_f32_16x16x32_bf16 v[56:59], a[44:47], a[240:243], v[56:59]
  ds_read_b64_tr_b16 a[30:31], v3 offset:12288
  s_waitcnt vmcnt(16) lgkmcnt(8)
  v_mfma_f32_16x16x32_bf16 v[32:35], a[0:3], a[128:131], v[32:35]
  s_waitcnt vmcnt(18)
  s_barrier
  ds_read_b64_tr_b16 a[32:33], v0 offset:16384
  v_mfma_f32_16x16x32_bf16 v[32:35], a[16:19], a[136:139], v[32:35]
  ds_read_b64_tr_b16 a[34:35], v0 offset:20480
  v_mfma_f32_16x16x32_bf16 v[36:39], a[16:19], a[140:143], v[36:39]
  ds_read_b64_tr_b16 a[48:49], v0 offset:24576
  v_mfma_f32_16x16x32_bf16 v[36:39], a[0:3], a[132:135], v[36:39]
  ds_read_b64_tr_b16 a[50:51], v0 offset:28672
  v_mfma_f32_16x16x32_bf16 v[44:47], a[4:7], a[132:135], v[44:47]
  ds_read_b64_tr_b16 a[36:37], v1 offset:16384
  v_mfma_f32_16x16x32_bf16 v[44:47], a[20:23], a[140:143], v[44:47]
  ds_read_b64_tr_b16 a[38:39], v1 offset:20480
  v_mfma_f32_16x16x32_bf16 v[40:43], a[20:23], a[136:139], v[40:43]
  ds_read_b64_tr_b16 a[52:53], v1 offset:24576
  v_mfma_f32_16x16x32_bf16 v[40:43], a[4:7], a[128:131], v[40:43]
  ds_read_b64_tr_b16 a[54:55], v1 offset:28672
  s_waitcnt lgkmcnt(8)
  v_mfma_f32_16x16x32_bf16 v[48:51], a[8:11], a[128:131], v[48:51]
  ds_read_b64_tr_b16 a[40:41], v2 offset:16384
  v_mfma_f32_16x16x32_bf16 v[48:51], a[24:27], a[136:139], v[48:51]
  ds_read_b64_tr_b16 a[42:43], v2 offset:20480
  v_mfma_f32_16x16x32_bf16 v[52:55], a[24:27], a[140:143], v[52:55]
  ds_read_b64_tr_b16 a[56:57], v2 offset:24576
  v_mfma_f32_16x16x32_bf16 v[52:55], a[8:11], a[132:135], v[52:55]
  ds_read_b64_tr_b16 a[58:59], v2 offset:28672
  v_mfma_f32_16x16x32_bf16 v[60:63], a[12:15], a[132:135], v[60:63]
  ds_read_b64_tr_b16 a[44:45], v3 offset:16384
  v_mfma_f32_16x16x32_bf16 v[60:63], a[28:31], a[140:143], v[60:63]
  ds_read_b64_tr_b16 a[46:47], v3 offset:20480
  v_mfma_f32_16x16x32_bf16 v[56:59], a[28:31], a[136:139], v[56:59]
  ds_read_b64_tr_b16 a[60:61], v3 offset:24576
  v_mfma_f32_16x16x32_bf16 v[56:59], a[12:15], a[128:131], v[56:59]
  ds_read_b64_tr_b16 a[62:63], v3 offset:28672
  s_waitcnt vmcnt(8) lgkmcnt(8)
  v_mfma_f32_16x16x32_bf16 v[32:35], a[32:35], a[144:147], v[32:35]
  ds_read_b64_tr_b16 a[0:1], v0 offset:32768
  v_mfma_f32_16x16x32_bf16 v[32:35], a[48:51], a[152:155], v[32:35]
  ds_read_b64_tr_b16 a[2:3], v0 offset:36864
  v_mfma_f32_16x16x32_bf16 v[36:39], a[48:51], a[156:159], v[36:39]
  ds_read_b64_tr_b16 a[16:17], v0 offset:40960
  v_mfma_f32_16x16x32_bf16 v[36:39], a[32:35], a[148:151], v[36:39]
  ds_read_b64_tr_b16 a[18:19], v0 offset:45056
  v_mfma_f32_16x16x32_bf16 v[44:47], a[36:39], a[148:151], v[44:47]
  ds_read_b64_tr_b16 a[4:5], v1 offset:32768
  v_mfma_f32_16x16x32_bf16 v[44:47], a[52:55], a[156:159], v[44:47]
  ds_read_b64_tr_b16 a[6:7], v1 offset:36864
  v_mfma_f32_16x16x32_bf16 v[40:43], a[52:55], a[152:155], v[40:43]
  ds_read_b64_tr_b16 a[20:21], v1 offset:40960
  v_mfma_f32_16x16x32_bf16 v[40:43], a[36:39], a[144:147], v[40:43]
  ds_read_b64_tr_b16 a[22:23], v1 offset:45056
  s_waitcnt lgkmcnt(8)
  v_mfma_f32_16x16x32_bf16 v[48:51], a[40:43], a[144:147], v[48:51]
  ds_read_b64_tr_b16 a[8:9], v2 offset:32768
  v_mfma_f32_16x16x32_bf16 v[48:51], a[56:59], a[152:155], v[48:51]
  ds_read_b64_tr_b16 a[10:11], v2 offset:36864
  v_mfma_f32_16x16x32_bf16 v[52:55], a[56:59], a[156:159], v[52:55]
  ds_read_b64_tr_b16 a[24:25], v2 offset:40960
  v_mfma_f32_16x16x32_bf16 v[52:55], a[40:43], a[148:151], v[52:55]
  ds_read_b64_tr_b16 a[26:27], v2 offset:45056
  v_mfma_f32_16x16x32_bf16 v[60:63], a[44:47], a[148:151], v[60:63]
  ds_read_b64_tr_b16 a[12:13], v3 offset:32768
  v_mfma_f32_16x16x32_bf16 v[60:63], a[60:63], a[156:159], v[60:63]
  ds_read_b64_tr_b16 a[14:15], v3 offset:36864
  v_mfma_f32_16x16x32_bf16 v[56:59], a[60:63], a[152:155], v[56:59]
  ds_read_b64_tr_b16 a[28:29], v3 offset:40960
  v_mfma_f32_16x16x32_bf16 v[56:59], a[44:47], a[144:147], v[56:59]
  ds_read_b64_tr_b16 a[30:31], v3 offset:45056
  s_waitcnt vmcnt(4) lgkmcnt(8)
  v_mfma_f32_16x16x32_bf16 v[32:35], a[0:3], a[160:163], v[32:35]
  s_waitcnt vmcnt(10)
  s_barrier
  ds_read_b64_tr_b16 a[32:33], v0 offset:49152
  v_mfma_f32_16x16x32_bf16 v[32:35], a[16:19], a[168:171], v[32:35]
  ds_read_b64_tr_b16 a[34:35], v0 offset:53248
  v_mfma_f32_16x16x32_bf16 v[36:39], a[16:19], a[172:175], v[36:39]
  ds_read_b64_tr_b16 a[48:49], v0 offset:57344
  v_mfma_f32_16x16x32_bf16 v[36:39], a[0:3], a[164:167], v[36:39]
  ds_read_b64_tr_b16 a[50:51], v0 offset:61440
  v_mfma_f32_16x16x32_bf16 v[44:47], a[4:7], a[164:167], v[44:47]
  ds_read_b64_tr_b16 a[36:37], v1 offset:49152
  v_mfma_f32_16x16x32_bf16 v[44:47], a[20:23], a[172:175], v[44:47]
  ds_read_b64_tr_b16 a[38:39], v1 offset:53248
  v_mfma_f32_16x16x32_bf16 v[40:43], a[20:23], a[168:171], v[40:43]
  ds_read_b64_tr_b16 a[52:53], v1 offset:57344
  v_mfma_f32_16x16x32_bf16 v[40:43], a[4:7], a[160:163], v[40:43]
  ds_read_b64_tr_b16 a[54:55], v1 offset:61440
  s_waitcnt lgkmcnt(8)
  v_mfma_f32_16x16x32_bf16 v[48:51], a[8:11], a[160:163], v[48:51]
  ds_read_b64_tr_b16 a[40:41], v2 offset:49152
  v_mfma_f32_16x16x32_bf16 v[48:51], a[24:27], a[168:171], v[48:51]
  ds_read_b64_tr_b16 a[42:43], v2 offset:53248
  v_mfma_f32_16x16x32_bf16 v[52:55], a[24:27], a[172:175], v[52:55]
  ds_read_b64_tr_b16 a[56:57], v2 offset:57344
  v_mfma_f32_16x16x32_bf16 v[52:55], a[8:11], a[164:167], v[52:55]
  ds_read_b64_tr_b16 a[58:59], v2 offset:61440
  v_mfma_f32_16x16x32_bf16 v[60:63], a[12:15], a[164:167], v[60:63]
  ds_read_b64_tr_b16 a[44:45], v3 offset:49152
  v_mfma_f32_16x16x32_bf16 v[60:63], a[28:31], a[172:175], v[60:63]
  ds_read_b64_tr_b16 a[46:47], v3 offset:53248
  v_mfma_f32_16x16x32_bf16 v[56:59], a[28:31], a[168:171], v[56:59]
  ds_read_b64_tr_b16 a[60:61], v3 offset:57344
  v_mfma_f32_16x16x32_bf16 v[56:59], a[12:15], a[160:163], v[56:59]
  ds_read_b64_tr_b16 a[62:63], v3 offset:61440
  s_waitcnt vmcnt(0) lgkmcnt(8)
  v_mfma_f32_16x16x32_bf16 v[32:35], a[32:35], a[176:179], v[32:35]
  ds_read_b64_tr_b16 a[0:1], v4 offset:1024
  v_mfma_f32_16x16x32_bf16 v[32:35], a[48:51], a[184:187], v[32:35]
  ds_read_b64_tr_b16 a[2:3], v4 offset:5120
  v_mfma_f32_16x16x32_bf16 v[36:39], a[48:51], a[188:191], v[36:39]
  ds_read_b64_tr_b16 a[16:17], v4 offset:9216
  v_mfma_f32_16x16x32_bf16 v[36:39], a[32:35], a[180:183], v[36:39]
  ds_read_b64_tr_b16 a[18:19], v4 offset:13312
  v_mfma_f32_16x16x32_bf16 v[44:47], a[36:39], a[180:183], v[44:47]
  ds_read_b64_tr_b16 a[4:5], v5 offset:1024
  v_mfma_f32_16x16x32_bf16 v[44:47], a[52:55], a[188:191], v[44:47]
  ds_read_b64_tr_b16 a[6:7], v5 offset:5120
  v_mfma_f32_16x16x32_bf16 v[40:43], a[52:55], a[184:187], v[40:43]
  ds_read_b64_tr_b16 a[20:21], v5 offset:9216
  v_mfma_f32_16x16x32_bf16 v[40:43], a[36:39], a[176:179], v[40:43]
  ds_read_b64_tr_b16 a[22:23], v5 offset:13312
  s_waitcnt lgkmcnt(8)
  v_mfma_f32_16x16x32_bf16 v[48:51], a[40:43], a[176:179], v[48:51]
  ds_read_b64_tr_b16 a[8:9], v6 offset:1024
  v_mfma_f32_16x16x32_bf16 v[48:51], a[56:59], a[184:187], v[48:51]
  ds_read_b64_tr_b16 a[10:11], v6 offset:5120
  v_mfma_f32_16x16x32_bf16 v[52:55], a[56:59], a[188:191], v[52:55]
  ds_read_b64_tr_b16 a[24:25], v6 offset:9216
  v_mfma_f32_16x16x32_bf16 v[52:55], a[40:43], a[180:183], v[52:55]
  ds_read_b64_tr_b16 a[26:27], v6 offset:13312
  v_mfma_f32_16x16x32_bf16 v[60:63], a[44:47], a[180:183], v[60:63]
  ds_read_b64_tr_b16 a[12:13], v7 offset:1024
  v_mfma_f32_16x16x32_bf16 v[60:63], a[60:63], a[188:191], v[60:63]
  ds_read_b64_tr_b16 a[14:15], v7 offset:5120
  v_mfma_f32_16x16x32_bf16 v[56:59], a[60:63], a[184:187], v[56:59]
  ds_read_b64_tr_b16 a[28:29], v7 offset:9216
  v_mfma_f32_16x16x32_bf16 v[56:59], a[44:47], a[176:179], v[56:59]
  ds_read_b64_tr_b16 a[30:31], v7 offset:13312
  s_waitcnt lgkmcnt(8)
  v_mfma_f32_16x16x32_bf16 v[64:67], a[0:3], a[192:195], v[64:67]
  s_lshl_b32 s45, s2, 2
  ds_read_b64_tr_b16 a[32:33], v4 offset:17408
  s_add_u32 s45, s45, s40
  v_mfma_f32_16x16x32_bf16 v[64:67], a[16:19], a[200:203], v[64:67]
  s_lshl_b32 s45, s45, 12
  ds_read_b64_tr_b16 a[34:35], v4 offset:21504
  s_xor_b32 s44, s45, 32768
  v_mfma_f32_16x16x32_bf16 v[68:71], a[16:19], a[204:207], v[68:71]
  s_add_u32 s43, s42, 28311552
  ds_read_b64_tr_b16 a[48:49], v4 offset:25600
  s_add_u32 s44, s44, s43
  v_mfma_f32_16x16x32_bf16 v[68:71], a[0:3], a[196:199], v[68:71]
  s_add_u32 s45, s45, s43
  ds_read_b64_tr_b16 a[50:51], v4 offset:29696
  v_cvt_pk_bf16_f32 v16, v32, v33
  v_mfma_f32_16x16x32_bf16 v[76:79], a[4:7], a[196:199], v[76:79]
  ds_read_b64_tr_b16 a[36:37], v5 offset:17408
  v_cvt_pk_bf16_f32 v17, v34, v35
  v_cvt_pk_bf16_f32 v18, v40, v41
  v_mfma_f32_16x16x32_bf16 v[76:79], a[20:23], a[204:207], v[76:79]
  ds_read_b64_tr_b16 a[38:39], v5 offset:21504
  v_cvt_pk_bf16_f32 v19, v42, v43
  buffer_store_dwordx4 v[16:19], v8, s[4:7], s44 offen offset:0 sc1
  v_mfma_f32_16x16x32_bf16 v[72:75], a[20:23], a[200:203], v[72:75]
  ds_read_b64_tr_b16 a[52:53], v5 offset:25600
  v_cvt_pk_bf16_f32 v24, v36, v37
  v_cvt_pk_bf16_f32 v25, v38, v39
  v_mfma_f32_16x16x32_bf16 v[72:75], a[4:7], a[192:195], v[72:75]
  s_waitcnt lgkmcnt(7)
  ds_read_b64_tr_b16 a[54:55], v5 offset:29696
  v_cvt_pk_bf16_f32 v26, v44, v45
  v_cvt_pk_bf16_f32 v27, v46, v47
  v_mfma_f32_16x16x32_bf16 v[80:83], a[8:11], a[192:195], v[80:83]
  ds_read_b64_tr_b16 a[40:41], v6 offset:17408
  buffer_store_dwordx4 v[24:27], v8, s[4:7], s44 offen offset:2048 sc1
  v_cvt_pk_bf16_f32 v20, v48, v49
  v_mfma_f32_16x16x32_bf16 v[80:83], a[24:27], a[200:203], v[80:83]
  ds_read_b64_tr_b16 a[42:43], v6 offset:21504
  v_cvt_pk_bf16_f32 v21, v50, v51
  v_cvt_pk_bf16_f32 v22, v56, v57
  v_mfma_f32_16x16x32_bf16 v[84:87], a[24:27], a[204:207], v[84:87]
  ds_read_b64_tr_b16 a[56:57], v6 offset:25600
  v_cvt_pk_bf16_f32 v23, v58, v59
  buffer_store_dwordx4 v[20:23], v8, s[4:7], s44 offen offset:1024 sc1
  v_mfma_f32_16x16x32_bf16 v[84:87], a[8:11], a[196:199], v[84:87]
  ds_read_b64_tr_b16 a[58:59], v6 offset:29696
  v_cvt_pk_bf16_f32 v28, v52, v53
  v_cvt_pk_bf16_f32 v29, v54, v55
  v_mfma_f32_16x16x32_bf16 v[92:95], a[12:15], a[196:199], v[92:95]
  ds_read_b64_tr_b16 a[44:45], v7 offset:17408
  v_cvt_pk_bf16_f32 v30, v60, v61
  v_cvt_pk_bf16_f32 v31, v62, v63
  v_mfma_f32_16x16x32_bf16 v[92:95], a[28:31], a[204:207], v[92:95]
  ds_read_b64_tr_b16 a[46:47], v7 offset:21504
  buffer_store_dwordx4 v[28:31], v8, s[4:7], s44 offen offset:3072 sc1
  v_mfma_f32_16x16x32_bf16 v[88:91], a[28:31], a[200:203], v[88:91]
  ds_read_b64_tr_b16 a[60:61], v7 offset:25600
  v_mfma_f32_16x16x32_bf16 v[88:91], a[12:15], a[192:195], v[88:91]
  ds_read_b64_tr_b16 a[62:63], v7 offset:29696
  s_waitcnt lgkmcnt(8)
  v_mfma_f32_16x16x32_bf16 v[64:67], a[32:35], a[208:211], v[64:67]
  ds_read_b64_tr_b16 a[0:1], v4 offset:33792
  v_and_b32 v148, 15, v253
  v_mfma_f32_16x16x32_bf16 v[64:67], a[48:51], a[216:219], v[64:67]
  ds_read_b64_tr_b16 a[2:3], v4 offset:37888
  v_lshrrev_b32 v149, 4, v253
  v_mfma_f32_16x16x32_bf16 v[68:71], a[48:51], a[220:223], v[68:71]
  ds_read_b64_tr_b16 a[16:17], v4 offset:41984
  v_lshrrev_b32 v128, 2, v148
  v_mfma_f32_16x16x32_bf16 v[68:71], a[32:35], a[212:215], v[68:71]
  ds_read_b64_tr_b16 a[18:19], v4 offset:46080
  v_cmp_eq_u32 vcc, v128, v149
  v_mfma_f32_16x16x32_bf16 v[76:79], a[36:39], a[212:215], v[76:79]
  ds_read_b64_tr_b16 a[4:5], v5 offset:33792
  v_and_b32 v128, 3, v148
  v_mfma_f32_16x16x32_bf16 v[76:79], a[52:55], a[220:223], v[76:79]
  ds_read_b64_tr_b16 a[6:7], v5 offset:37888
  v_lshlrev_b32 v148, 3, v148
  v_mfma_f32_16x16x32_bf16 v[72:75], a[52:55], a[216:219], v[72:75]
  ds_read_b64_tr_b16 a[20:21], v5 offset:41984
  v_mov_b32 v149, 0x7ffffff0
  v_mfma_f32_16x16x32_bf16 v[72:75], a[36:39], a[208:211], v[72:75]
  s_waitcnt lgkmcnt(7)
  ds_read_b64_tr_b16 a[22:23], v5 offset:46080
  v_cndmask_b32 v148, v149, v148, vcc
  v_mfma_f32_16x16x32_bf16 v[80:83], a[40:43], a[208:211], v[80:83]
  ds_read_b64_tr_b16 a[8:9], v6 offset:33792
  v_cmp_eq_u32 s[66:67], 1, v128
  v_mfma_f32_16x16x32_bf16 v[80:83], a[56:59], a[216:219], v[80:83]
  ds_read_b64_tr_b16 a[10:11], v6 offset:37888
  v_cmp_eq_u32 s[68:69], 2, v128
  v_mfma_f32_16x16x32_bf16 v[84:87], a[56:59], a[220:223], v[84:87]
  ds_read_b64_tr_b16 a[24:25], v6 offset:41984
  v_cmp_eq_u32 s[70:71], 3, v128
  v_mfma_f32_16x16x32_bf16 v[84:87], a[40:43], a[212:215], v[84:87]
  ds_read_b64_tr_b16 a[26:27], v6 offset:46080
  v_mov_b32 v128, 0x3f803f80
  v_mfma_f32_16x16x32_bf16 v[92:95], a[44:47], a[212:215], v[92:95]
  ds_read_b64_tr_b16 a[12:13], v7 offset:33792
  v_mov_b32 v129, 0x3f803f80
  v_mfma_f32_16x16x32_bf16 v[92:95], a[60:63], a[220:223], v[92:95]
  ds_read_b64_tr_b16 a[14:15], v7 offset:37888
  v_mov_b32 v130, 0x3f803f80
  v_mfma_f32_16x16x32_bf16 v[88:91], a[60:63], a[216:219], v[88:91]
  ds_read_b64_tr_b16 a[28:29], v7 offset:41984
  v_mov_b32 v131, 0x3f803f80
  v_mfma_f32_16x16x32_bf16 v[88:91], a[44:47], a[208:211], v[88:91]
  ds_read_b64_tr_b16 a[30:31], v7 offset:46080
  s_waitcnt lgkmcnt(8)
  v_mfma_f32_16x16x32_bf16 v[64:67], a[0:3], a[224:227], v[64:67]
  ds_read_b64_tr_b16 a[32:33], v4 offset:50176
  v_and_b32 v152, 15, v253
  v_lshrrev_b32 v153, 4, v253
  v_mfma_f32_16x16x32_bf16 v[64:67], a[16:19], a[232:235], v[64:67]
  ds_read_b64_tr_b16 a[34:35], v4 offset:54272
  v_lshrrev_b32 v155, 1, v153
  v_and_b32 v153, 1, v153
  v_mfma_f32_16x16x32_bf16 v[68:71], a[16:19], a[236:239], v[68:71]
  ds_read_b64_tr_b16 a[48:49], v4 offset:58368
  v_lshl_add_u32 v153, v153, 1, v155
  v_and_b32 v155, 7, v253
  v_mfma_f32_16x16x32_bf16 v[68:71], a[0:3], a[228:231], v[68:71]
  ds_read_b64_tr_b16 a[50:51], v4 offset:62464
  v_xor_b32 v153, v153, v155
  v_lshlrev_b32 v153, 4, v153
  v_mfma_f32_16x16x32_bf16 v[76:79], a[4:7], a[228:231], v[76:79]
  s_lshl_b32 s43, s40, 12
  ds_read_b64_tr_b16 a[36:37], v5 offset:50176
  v_lshl_add_u32 v152, v152, 7, v153
  v_mfma_f32_16x16x32_bf16 v[76:79], a[20:23], a[236:239], v[76:79]
  ds_read_b64_tr_b16 a[38:39], v5 offset:54272
  v_add_u32 v152, s43, v152
  v_xor_b32 v153, 64, v152
  v_mfma_f32_16x16x32_bf16 v[72:75], a[20:23], a[232:235], v[72:75]
  ds_read_b64_tr_b16 a[52:53], v5 offset:58368
  v_lshrrev_b32 v156, 3, v253
  v_xor_b32 v154, v156, v155
  v_mfma_f32_16x16x32_bf16 v[72:75], a[4:7], a[224:227], v[72:75]
  s_waitcnt lgkmcnt(7)
  ds_read_b64_tr_b16 a[54:55], v5 offset:62464
  v_lshlrev_b32 v154, 4, v154
  v_lshl_add_u32 v154, v156, 7, v154
  v_mfma_f32_16x16x32_bf16 v[80:83], a[8:11], a[224:227], v[80:83]
  ds_read_b64_tr_b16 a[40:41], v6 offset:50176
  v_add_u32 v154, s43, v154
  v_lshlrev_b32 v155, 4, v155
  v_mfma_f32_16x16x32_bf16 v[80:83], a[24:27], a[232:235], v[80:83]
  ds_read_b64_tr_b16 a[42:43], v6 offset:54272
  v_lshl_add_u32 v155, v156, 12, v155
  v_mfma_f32_16x16x32_bf16 v[84:87], a[24:27], a[236:239], v[84:87]
  ds_read_b64_tr_b16 a[56:57], v6 offset:58368
  v_mfma_f32_16x16x32_bf16 v[84:87], a[8:11], a[228:231], v[84:87]
  ds_read_b64_tr_b16 a[58:59], v6 offset:62464
  v_mfma_f32_16x16x32_bf16 v[92:95], a[12:15], a[228:231], v[92:95]
  ds_read_b64_tr_b16 a[44:45], v7 offset:50176
  v_mfma_f32_16x16x32_bf16 v[92:95], a[28:31], a[236:239], v[92:95]
  ds_read_b64_tr_b16 a[46:47], v7 offset:54272
  v_mfma_f32_16x16x32_bf16 v[88:91], a[28:31], a[232:235], v[88:91]
  ds_read_b64_tr_b16 a[60:61], v7 offset:58368
  v_mfma_f32_16x16x32_bf16 v[88:91], a[12:15], a[224:227], v[88:91]
  ds_read_b64_tr_b16 a[62:63], v7 offset:62464
  s_waitcnt lgkmcnt(8)
  v_mfma_f32_16x16x32_bf16 v[64:67], a[32:35], a[240:243], v[64:67]
  s_add_u32 s46, s76, 41943040
  ds_read_b64_tr_b16 a[0:1], v0 offset:1024
  s_add_u32 s47, s46, 32768
  v_mfma_f32_16x16x32_bf16 v[64:67], a[48:51], a[248:251], v[64:67]
  s_lshl_b32 s48, s49, 11
  ds_read_b64_tr_b16 a[2:3], v0 offset:5120
  s_lshl_b32 s43, s53, 7
  v_mfma_f32_16x16x32_bf16 v[68:71], a[48:51], a[252:255], v[68:71]
  s_add_u32 s48, s48, s43
  ds_read_b64_tr_b16 a[16:17], v0 offset:9216
  s_add_u32 s48, s48, 69206016
  v_mfma_f32_16x16x32_bf16 v[68:71], a[32:35], a[244:247], v[68:71]
  s_and_b32 s57, s49, 63
  ds_read_b64_tr_b16 a[18:19], v0 offset:13312
  s_lshl_b32 s57, s57, 16
  v_mfma_f32_16x16x32_bf16 v[76:79], a[36:39], a[244:247], v[76:79]
  s_add_u32 s57, s57, s43
  ds_read_b64_tr_b16 a[4:5], v1 offset:1024
  s_lshr_b32 s43, s49, 6
  v_mfma_f32_16x16x32_bf16 v[76:79], a[52:55], a[252:255], v[76:79]
  s_lshl_b32 s43, s43, 11
  ds_read_b64_tr_b16 a[6:7], v1 offset:5120
  s_add_u32 s57, s57, s43
  v_mfma_f32_16x16x32_bf16 v[72:75], a[52:55], a[248:251], v[72:75]
  s_and_b32 s43, s53, 1
  ds_read_b64_tr_b16 a[20:21], v1 offset:9216
  s_mul_i32 s77, s52, 2
  v_mfma_f32_16x16x32_bf16 v[72:75], a[36:39], a[240:243], v[72:75]
  s_add_u32 s77, s77, s43
  ds_read_b64_tr_b16 a[22:23], v1 offset:13312
  s_lshl_b32 s77, s77, 7
  s_waitcnt lgkmcnt(8)
  v_mfma_f32_16x16x32_bf16 v[80:83], a[40:43], a[240:243], v[80:83]
  ds_read_b64_tr_b16 a[8:9], v2 offset:1024
  s_add_u32 s77, s77, 27811840
  v_mfma_f32_16x16x32_bf16 v[80:83], a[56:59], a[248:251], v[80:83]
  ds_read_b64_tr_b16 a[10:11], v2 offset:5120
  v_mfma_f32_16x16x32_bf16 v[84:87], a[56:59], a[252:255], v[84:87]
  ds_read_b64_tr_b16 a[24:25], v2 offset:9216
  v_mfma_f32_16x16x32_bf16 v[84:87], a[40:43], a[244:247], v[84:87]
  ds_read_b64_tr_b16 a[26:27], v2 offset:13312
  v_mfma_f32_16x16x32_bf16 v[92:95], a[44:47], a[244:247], v[92:95]
  ds_read_b64_tr_b16 a[12:13], v3 offset:1024
  v_mfma_f32_16x16x32_bf16 v[92:95], a[60:63], a[252:255], v[92:95]
  ds_read_b64_tr_b16 a[14:15], v3 offset:5120
  v_mfma_f32_16x16x32_bf16 v[88:91], a[60:63], a[248:251], v[88:91]
  ds_read_b64_tr_b16 a[28:29], v3 offset:9216
  v_mfma_f32_16x16x32_bf16 v[88:91], a[44:47], a[240:243], v[88:91]
  ds_read_b64_tr_b16 a[30:31], v3 offset:13312
  s_waitcnt lgkmcnt(8)
  v_mfma_f32_16x16x32_bf16 v[64:67], a[0:3], a[128:131], v[64:67]
  ds_read_b64_tr_b16 a[32:33], v0 offset:17408
  v_mfma_f32_16x16x32_bf16 v[64:67], a[16:19], a[136:139], v[64:67]
  ds_read_b64_tr_b16 a[34:35], v0 offset:21504
  v_mfma_f32_16x16x32_bf16 v[68:71], a[16:19], a[140:143], v[68:71]
  ds_read_b64_tr_b16 a[48:49], v0 offset:25600
  v_mfma_f32_16x16x32_bf16 v[68:71], a[0:3], a[132:135], v[68:71]
  ds_read_b64_tr_b16 a[50:51], v0 offset:29696
  v_mfma_f32_16x16x32_bf16 v[76:79], a[4:7], a[132:135], v[76:79]
  ds_read_b64_tr_b16 a[36:37], v1 offset:17408
  v_mfma_f32_16x16x32_bf16 v[76:79], a[20:23], a[140:143], v[76:79]
  ds_read_b64_tr_b16 a[38:39], v1 offset:21504
  v_mfma_f32_16x16x32_bf16 v[72:75], a[20:23], a[136:139], v[72:75]
  ds_read_b64_tr_b16 a[52:53], v1 offset:25600
  v_mfma_f32_16x16x32_bf16 v[72:75], a[4:7], a[128:131], v[72:75]
  ds_read_b64_tr_b16 a[54:55], v1 offset:29696
  s_waitcnt lgkmcnt(8)
  v_mfma_f32_16x16x32_bf16 v[80:83], a[8:11], a[128:131], v[80:83]
  ds_read_b64_tr_b16 a[40:41], v2 offset:17408
  v_mfma_f32_16x16x32_bf16 v[80:83], a[24:27], a[136:139], v[80:83]
  ds_read_b64_tr_b16 a[42:43], v2 offset:21504
  v_mfma_f32_16x16x32_bf16 v[84:87], a[24:27], a[140:143], v[84:87]
  ds_read_b64_tr_b16 a[56:57], v2 offset:25600
  v_mfma_f32_16x16x32_bf16 v[84:87], a[8:11], a[132:135], v[84:87]
  ds_read_b64_tr_b16 a[58:59], v2 offset:29696
  v_mfma_f32_16x16x32_bf16 v[92:95], a[12:15], a[132:135], v[92:95]
  ds_read_b64_tr_b16 a[44:45], v3 offset:17408
  v_mfma_f32_16x16x32_bf16 v[92:95], a[28:31], a[140:143], v[92:95]
  ds_read_b64_tr_b16 a[46:47], v3 offset:21504
  v_mfma_f32_16x16x32_bf16 v[88:91], a[28:31], a[136:139], v[88:91]
  ds_read_b64_tr_b16 a[60:61], v3 offset:25600
  v_mfma_f32_16x16x32_bf16 v[88:91], a[12:15], a[128:131], v[88:91]
  ds_read_b64_tr_b16 a[62:63], v3 offset:29696
  s_waitcnt lgkmcnt(8)
  v_mfma_f32_16x16x32_bf16 v[64:67], a[32:35], a[144:147], v[64:67]
  ds_read_b64_tr_b16 a[0:1], v0 offset:33792
  v_mfma_f32_16x16x32_bf16 v[64:67], a[48:51], a[152:155], v[64:67]
  ds_read_b64_tr_b16 a[2:3], v0 offset:37888
  v_mfma_f32_16x16x32_bf16 v[68:71], a[48:51], a[156:159], v[68:71]
  ds_read_b64_tr_b16 a[16:17], v0 offset:41984
  v_mfma_f32_16x16x32_bf16 v[68:71], a[32:35], a[148:151], v[68:71]
  ds_read_b64_tr_b16 a[18:19], v0 offset:46080
  v_mfma_f32_16x16x32_bf16 v[76:79], a[36:39], a[148:151], v[76:79]
  ds_read_b64_tr_b16 a[4:5], v1 offset:33792
  buffer_load_dwordx4 v[96:99], v8, s[4:7], s45 offen offset:0 sc1
  buffer_load_dwordx4 v[100:103], v8, s[4:7], s45 offen offset:1024 sc1
  v_mfma_f32_16x16x32_bf16 v[76:79], a[52:55], a[156:159], v[76:79]
  ds_read_b64_tr_b16 a[6:7], v1 offset:37888
  v_mfma_f32_16x16x32_bf16 v[72:75], a[52:55], a[152:155], v[72:75]
  ds_read_b64_tr_b16 a[20:21], v1 offset:41984
  buffer_load_dwordx4 v[104:107], v8, s[4:7], s45 offen offset:2048 sc1
  buffer_load_dwordx4 v[108:111], v8, s[4:7], s45 offen offset:3072 sc1
  v_mfma_f32_16x16x32_bf16 v[72:75], a[36:39], a[144:147], v[72:75]
  ds_read_b64_tr_b16 a[22:23], v1 offset:46080
  s_waitcnt lgkmcnt(8)
  v_mfma_f32_16x16x32_bf16 v[80:83], a[40:43], a[144:147], v[80:83]
  ds_read_b64_tr_b16 a[8:9], v2 offset:33792
  v_mfma_f32_16x16x32_bf16 v[80:83], a[56:59], a[152:155], v[80:83]
  ds_read_b64_tr_b16 a[10:11], v2 offset:37888
  v_mfma_f32_16x16x32_bf16 v[84:87], a[56:59], a[156:159], v[84:87]
  ds_read_b64_tr_b16 a[24:25], v2 offset:41984
  v_mfma_f32_16x16x32_bf16 v[84:87], a[40:43], a[148:151], v[84:87]
  ds_read_b64_tr_b16 a[26:27], v2 offset:46080
  v_mfma_f32_16x16x32_bf16 v[92:95], a[44:47], a[148:151], v[92:95]
  ds_read_b64_tr_b16 a[12:13], v3 offset:33792
  v_mfma_f32_16x16x32_bf16 v[92:95], a[60:63], a[156:159], v[92:95]
  ds_read_b64_tr_b16 a[14:15], v3 offset:37888
  v_mfma_f32_16x16x32_bf16 v[88:91], a[60:63], a[152:155], v[88:91]
  ds_read_b64_tr_b16 a[28:29], v3 offset:41984
  v_mfma_f32_16x16x32_bf16 v[88:91], a[44:47], a[144:147], v[88:91]
  ds_read_b64_tr_b16 a[30:31], v3 offset:46080
  s_waitcnt lgkmcnt(8)
  v_mfma_f32_16x16x32_bf16 v[64:67], a[0:3], a[160:163], v[64:67]
  ds_read_b64_tr_b16 a[32:33], v0 offset:50176
  v_mfma_f32_16x16x32_bf16 v[64:67], a[16:19], a[168:171], v[64:67]
  ds_read_b64_tr_b16 a[34:35], v0 offset:54272
  v_mfma_f32_16x16x32_bf16 v[68:71], a[16:19], a[172:175], v[68:71]
  ds_read_b64_tr_b16 a[48:49], v0 offset:58368
  v_mfma_f32_16x16x32_bf16 v[68:71], a[0:3], a[164:167], v[68:71]
  ds_read_b64_tr_b16 a[50:51], v0 offset:62464
  v_mfma_f32_16x16x32_bf16 v[76:79], a[4:7], a[164:167], v[76:79]
  ds_read_b64_tr_b16 a[36:37], v1 offset:50176
  v_mfma_f32_16x16x32_bf16 v[76:79], a[20:23], a[172:175], v[76:79]
  ds_read_b64_tr_b16 a[38:39], v1 offset:54272
  v_mfma_f32_16x16x32_bf16 v[72:75], a[20:23], a[168:171], v[72:75]
  ds_read_b64_tr_b16 a[52:53], v1 offset:58368
  v_mfma_f32_16x16x32_bf16 v[72:75], a[4:7], a[160:163], v[72:75]
  ds_read_b64_tr_b16 a[54:55], v1 offset:62464
  s_waitcnt lgkmcnt(8)
  v_mfma_f32_16x16x32_bf16 v[80:83], a[8:11], a[160:163], v[80:83]
  ds_read_b64_tr_b16 a[40:41], v2 offset:50176
  v_mfma_f32_16x16x32_bf16 v[80:83], a[24:27], a[168:171], v[80:83]
  ds_read_b64_tr_b16 a[42:43], v2 offset:54272
  v_mfma_f32_16x16x32_bf16 v[84:87], a[24:27], a[172:175], v[84:87]
  ds_read_b64_tr_b16 a[56:57], v2 offset:58368
  v_mfma_f32_16x16x32_bf16 v[84:87], a[8:11], a[164:167], v[84:87]
  ds_read_b64_tr_b16 a[58:59], v2 offset:62464
  v_mfma_f32_16x16x32_bf16 v[92:95], a[12:15], a[164:167], v[92:95]
  ds_read_b64_tr_b16 a[44:45], v3 offset:50176
  v_mfma_f32_16x16x32_bf16 v[92:95], a[28:31], a[172:175], v[92:95]
  ds_read_b64_tr_b16 a[46:47], v3 offset:54272
  v_mfma_f32_16x16x32_bf16 v[88:91], a[28:31], a[168:171], v[88:91]
  ds_read_b64_tr_b16 a[60:61], v3 offset:58368
  v_mfma_f32_16x16x32_bf16 v[88:91], a[12:15], a[160:163], v[88:91]
  ds_read_b64_tr_b16 a[62:63], v3 offset:62464
  s_mov_b32 s43, 0x40000
Lp4_mb:
  s_waitcnt vmcnt(0)
  v_max3_u32 v112, v96, v97, v98
  v_max3_u32 v113, v99, v100, v101
  v_max3_u32 v112, v112, v102, v103
  v_max3_u32 v113, v113, v104, v105
  v_max3_u32 v112, v112, v106, v107
  v_max3_u32 v113, v113, v108, v109
  v_max3_u32 v112, v112, v110, v111
  v_max_u32 v112, v112, v113
  v_cmp_eq_u32 vcc, -1, v112
  s_cbranch_vccz Lp4_mbok
  buffer_load_dwordx4 v[96:99], v8, s[4:7], s45 offen offset:0 sc1
  buffer_load_dwordx4 v[100:103], v8, s[4:7], s45 offen offset:1024 sc1
  buffer_load_dwordx4 v[104:107], v8, s[4:7], s45 offen offset:2048 sc1
  buffer_load_dwordx4 v[108:111], v8, s[4:7], s45 offen offset:3072 sc1
  s_sub_u32 s43, s43, 1
  s_cmp_lg_u32 s43, 0
  s_cbranch_scc1 Lp4_mb
  s_waitcnt vmcnt(0)
Lp4_mbok:
  s_waitcnt lgkmcnt(8)
  v_mfma_f32_16x16x32_bf16 v[64:67], a[32:35], a[176:179], v[64:67]
  v_lshlrev_b32 v32, 16, v96
  v_and_b32 v33, 0xffff0000, v96
  v_mfma_f32_16x16x32_bf16 v[64:67], a[48:51], a[184:187], v[64:67]
  v_lshlrev_b32 v34, 16, v97
  v_and_b32 v35, 0xffff0000, v97
  v_mfma_f32_16x16x32_bf16 v[68:71], a[48:51], a[188:191], v[68:71]
  v_lshlrev_b32 v40, 16, v98
  v_and_b32 v41, 0xffff0000, v98
  v_mfma_f32_16x16x32_bf16 v[68:71], a[32:35], a[180:183], v[68:71]
  v_lshlrev_b32 v42, 16, v99
  v_and_b32 v43, 0xffff0000, v99
  v_mfma_f32_16x16x32_bf16 v[76:79], a[36:39], a[180:183], v[76:79]
  v_lshlrev_b32 v36, 16, v104
  v_and_b32 v37, 0xffff0000, v104
  v_mfma_f32_16x16x32_bf16 v[76:79], a[52:55], a[188:191], v[76:79]
  v_lshlrev_b32 v38, 16, v105
  v_and_b32 v39, 0xffff0000, v105
  v_mfma_f32_16x16x32_bf16 v[72:75], a[52:55], a[184:187], v[72:75]
  v_lshlrev_b32 v44, 16, v106
  v_and_b32 v45, 0xffff0000, v106
  v_mfma_f32_16x16x32_bf16 v[72:75], a[36:39], a[176:179], v[72:75]
  s_waitcnt lgkmcnt(0)
  v_lshlrev_b32 v46, 16, v107
  v_and_b32 v47, 0xffff0000, v107
  v_mfma_f32_16x16x32_bf16 v[80:83], a[40:43], a[176:179], v[80:83]
  v_lshlrev_b32 v48, 16, v100
  v_and_b32 v49, 0xffff0000, v100
  v_mfma_f32_16x16x32_bf16 v[80:83], a[56:59], a[184:187], v[80:83]
  s_barrier
  v_lshlrev_b32 v50, 16, v101
  v_mfma_f32_16x16x32_bf16 v[84:87], a[56:59], a[188:191], v[84:87]
  v_and_b32 v51, 0xffff0000, v101
  v_lshlrev_b32 v56, 16, v102
  v_mfma_f32_16x16x32_bf16 v[84:87], a[40:43], a[180:183], v[84:87]
  v_and_b32 v57, 0xffff0000, v102
  v_lshlrev_b32 v58, 16, v103
  v_mfma_f32_16x16x32_bf16 v[92:95], a[44:47], a[180:183], v[92:95]
  v_and_b32 v59, 0xffff0000, v103
  v_lshlrev_b32 v52, 16, v108
  v_mfma_f32_16x16x32_bf16 v[92:95], a[60:63], a[188:191], v[92:95]
  v_and_b32 v53, 0xffff0000, v108
  v_lshlrev_b32 v54, 16, v109
  v_mfma_f32_16x16x32_bf16 v[88:91], a[60:63], a[184:187], v[88:91]
  v_and_b32 v55, 0xffff0000, v109
  v_lshlrev_b32 v60, 16, v110
  v_mfma_f32_16x16x32_bf16 v[88:91], a[44:47], a[176:179], v[88:91]
  v_and_b32 v61, 0xffff0000, v110
  v_lshlrev_b32 v62, 16, v111
  v_and_b32 v63, 0xffff0000, v111
  v_pk_add_f32 v[68:69], v[68:69], v[36:37]
  v_pk_add_f32 v[70:71], v[70:71], v[38:39]
  v_pk_add_f32 v[76:77], v[76:77], v[44:45]
  v_pk_add_f32 v[78:79], v[78:79], v[46:47]
  v_cvt_pk_bf16_f32 v24, v68, v69
  v_cvt_pk_bf16_f32 v25, v70, v71
  v_cvt_pk_bf16_f32 v26, v76, v77
  v_cvt_pk_bf16_f32 v27, v78, v79
  v_pk_add_f32 v[64:65], v[64:65], v[32:33]
  v_pk_add_f32 v[66:67], v[66:67], v[34:35]
  v_pk_add_f32 v[72:73], v[72:73], v[40:41]
  v_pk_add_f32 v[74:75], v[74:75], v[42:43]
  v_cvt_pk_bf16_f32 v16, v64, v65
  v_cvt_pk_bf16_f32 v17, v66, v67
  v_cvt_pk_bf16_f32 v18, v72, v73
  v_cvt_pk_bf16_f32 v19, v74, v75
  v_pk_add_f32 v[84:85], v[84:85], v[52:53]
  v_pk_add_f32 v[86:87], v[86:87], v[54:55]
  v_pk_add_f32 v[92:93], v[92:93], v[60:61]
  v_pk_add_f32 v[94:95], v[94:95], v[62:63]
  v_cvt_pk_bf16_f32 v28, v84, v85
  v_cvt_pk_bf16_f32 v29, v86, v87
  v_cvt_pk_bf16_f32 v30, v92, v93
  v_cvt_pk_bf16_f32 v31, v94, v95
  v_pk_add_f32 v[80:81], v[80:81], v[48:49]
  v_pk_add_f32 v[82:83], v[82:83], v[50:51]
  v_pk_add_f32 v[88:89], v[88:89], v[56:57]
  v_pk_add_f32 v[90:91], v[90:91], v[58:59]
  v_cvt_pk_bf16_f32 v20, v80, v81
  v_cvt_pk_bf16_f32 v21, v82, v83
  v_cvt_pk_bf16_f32 v22, v88, v89
  v_cvt_pk_bf16_f32 v23, v90, v91
  s_cmp_eq_u32 s41, 0
  s_cbranch_scc1 Lp4_mid
  v_permlane16_swap_b32 v16, v18
  v_permlane16_swap_b32 v17, v19
  v_permlane16_swap_b32 v20, v22
  v_permlane16_swap_b32 v21, v23
  ds_write_b128 v152, v[16:19] offset:0
  ds_write_b128 v153, v[20:23] offset:0
  ds_read_b128 v[96:99], v154 offset:0
  ds_read_b128 v[100:103], v154 offset:1024
  v_permlane16_swap_b32 v24, v26
  v_permlane16_swap_b32 v25, v27
  v_permlane16_swap_b32 v28, v30
  v_permlane16_swap_b32 v29, v31
  ds_write_b128 v152, v[24:27] offset:2048
  ds_write_b128 v153, v[28:31] offset:2048
  ds_read_b128 v[104:107], v154 offset:2048
  ds_read_b128 v[108:111], v154 offset:3072
  s_waitcnt lgkmcnt(5)
  buffer_store_dwordx4 v[96:99], v155, s[32:35], s57 offen nt
  s_add_u32 s57, s57, 32768
  s_waitcnt lgkmcnt(4)
  buffer_store_dwordx4 v[100:103], v155, s[32:35], s57 offen nt
  s_add_u32 s57, s57, 32768
  s_waitcnt lgkmcnt(1)
  buffer_store_dwordx4 v[104:107], v155, s[32:35], s57 offen nt
  s_add_u32 s57, s57, 32768
  s_waitcnt lgkmcnt(0)
  buffer_store_dwordx4 v[108:111], v155, s[32:35], s57 offen nt
  s_add_u32 s57, s57, 32768
  s_endpgm
Lp4_mid:
  buffer_store_dwordx4 v[16:19], v8, s[4:7], s46 offen offset:0 sc1
  buffer_store_dwordx4 v[24:27], v8, s[4:7], s47 offen offset:0 sc1
  v_mfma_f32_16x16x32_bf16 v[144:147], v[24:27], v[24:27], 0
  v_mfma_f32_16x16x32_bf16 v[140:143], v[128:131], v[24:27], 0
  v_mfma_f32_16x16x32_bf16 v[136:139], v[16:19], v[16:19], 0
  v_mfma_f32_16x16x32_bf16 v[132:135], v[128:131], v[16:19], 0
  buffer_store_dwordx4 v[20:23], v8, s[4:7], s46 offen offset:1024 sc1
  buffer_store_dwordx4 v[28:31], v8, s[4:7], s47 offen offset:1024 sc1
  v_mfma_f32_16x16x32_bf16 v[144:147], v[28:31], v[28:31], v[144:147]
  v_mfma_f32_16x16x32_bf16 v[140:143], v[128:131], v[28:31], v[140:143]
  v_mfma_f32_16x16x32_bf16 v[136:139], v[20:23], v[20:23], v[136:139]
  v_mfma_f32_16x16x32_bf16 v[132:135], v[128:131], v[20:23], v[132:135]
  s_nop 5
  v_cndmask_b32 v141, v144, v145, s[66:67]
  v_cndmask_b32 v141, v141, v146, s[68:69]
  v_cndmask_b32 v141, v141, v147, s[70:71]
  buffer_store_dwordx2 v[140:141], v148, s[4:7], s48 offen offset:2048 sc1
  v_cndmask_b32 v133, v136, v137, s[66:67]
  v_cndmask_b32 v133, v133, v138, s[68:69]
  v_cndmask_b32 v133, v133, v139, s[70:71]
  buffer_store_dwordx2 v[132:133], v148, s[4:7], s48 offen offset:0 sc1
  s_mov_b32 s41, 1
  s_mov_b32 s42, 0x2800000
  s_mov_b32 s28, s4
  s_mov_b32 s29, s5
  s_mov_b32 s30, 0x10000000
  s_lshr_b32 s57, s40, 1
  s_and_b32 s58, s40, 1
  s_lshl_b32 s71, s50, 3
  s_add_u32 s67, s50, s51
  s_and_b32 s67, s67, 0
  s_lshl_b32 s67, s67, 3
  s_lshl_b32 s62, s40, 12
  s_mul_i32 s63, s40, 6144
  s_add_u32 s76, s63, 139264
  s_and_b32 s43, s50, 7
  s_cmp_lg_u32 s43, 0
  s_cselect_b32 s43, 1, 0
  s_sub_u32 s72, s71, s43
  v_lshrrev_b32 v2, 3, v253
  v_bfe_u32 v3, v253, 1, 2
  v_lshrrev_b32 v4, 4, v253
  v_xor_b32 v3, v3, v4
  v_and_b32 v5, 1, v253
  v_mov_b32 v6, v2
  s_lshl_b32 s43, s40, 4
  v_mul_u32_u24 v6, 6144, v6
  v_lshl_add_u32 v6, v3, 5, v6
  v_lshl_add_u32 v124, v5, 4, v6
  v_add_u32 v125, 48128, v124
  s_mul_i32 s43, s43, 6144
  s_lshl_b32 s60, s51, 7
  s_add_u32 s60, s60, s43
  v_and_b32 v3, 7, v253
  s_lshl_b32 s43, s40, 1
  s_add_u32 s43, s43, s71
  v_lshlrev_b32 v120, 4, v253
  v_mov_b32 v121, v120
  v_add_u32 v122, 30720, v120
  v_add_u32 v123, 30720, v120
  v_lshlrev_b32 v5, 8, v2
  v_lshl_add_u32 v5, v3, 4, v5
  v_add_u32 v126, 128, v5
  s_lshl_b32 s43, s43, 15
  s_mov_b32 s44, 41943040
  s_add_u32 s59, s43, s44
  s_lshl_b32 s43, s72, 15
  s_add_u32 s73, s43, s44
  s_movk_i32 s61, 2048
  v_and_b32 v2, 15, v253
  v_lshrrev_b32 v3, 4, v253
  v_and_b32 v4, 7, v253
  v_lshlrev_b32 v6, 4, v253
  v_add_u32 v7, 1024, v6
  v_lshlrev_b32 v5, 7, v3
  v_lshl_add_u32 v8, v4, 4, v5
  v_add_u32 v9, 512, v8
  s_lshl_b32 s43, s57, 13
  s_add_u32 s43, s43, 73728
  v_add_u32 v112, s43, v6
  v_add_u32 v113, s43, v7
  v_add_u32 v114, 122880, v8
  v_add_u32 v115, 122880, v9
  s_lshl_b32 s43, s52, 3
  s_lshl_b32 s44, s40, 1
  s_add_u32 s43, s43, s44
  v_mov_b32 v187, v6
  s_lshl_b32 s43, s43, 15
  s_lshl_b32 s44, s53, 11
  s_add_u32 s43, s43, s44
  s_add_u32 s64, s43, 41943040
  v_lshrrev_b32 v2, 2, v253
  v_bfe_u32 v3, v253, 3, 2
  v_and_b32 v4, 3, v253
  v_lshlrev_b32 v4, 3, v4
  v_lshl_add_u32 v4, v2, 7, v4
  s_lshl_b32 s43, s58, 1
  s_or_b32 s43, s43, s57
  v_xor_b32 v5, s43, v3
  v_lshl_add_u32 v116, v5, 5, v4
  v_xor_b32 v5, 1, v5
  v_lshl_add_u32 v117, v5, 5, v4
  v_add_u32 v118, 49152, v116
  v_add_u32 v119, 49152, v117
  s_mov_b32 s84, s16
  s_mov_b32 s85, s17
  s_mov_b32 s86, 7340032
  s_mov_b32 s87, 0x20000
  s_mov_b32 s3, 0
  s_mov_b32 s88, 63
  s_mov_b32 s100, 0
  v_mov_b32 v238, 0x40000000
  s_waitcnt vmcnt(0)
  s_barrier
  s_cmp_lg_u32 s40, 0
  s_cbranch_scc1 Lsig19
  v_mov_b32 v250, 1
  s_mov_b64 exec, 1
  buffer_atomic_add v250, v251, s[4:7], s77 offen sc1
  s_mov_b64 exec, -1
Lsig19:
  s_add_u32 s44, s67, 0
  s_and_b32 s44, s44, 15
  s_mul_i32 s45, s44, 393216
  s_add_u32 s69, s45, s60
  s_add_u32 s70, s69, 4096
  s_add_u32 m0, s63, 0
  s_nop 0
  buffer_load_dwordx4 v124, s[8:11], s69 offen offset:0  lds
  buffer_load_dwordx4 v125, s[8:11], s69 offen offset:1024  lds
  buffer_load_dwordx4 v124, s[8:11], s69 offen offset:2048  lds
  buffer_load_dwordx4 v125, s[8:11], s69 offen offset:3072  lds
  s_add_u32 m0, s63, 4096
  s_nop 0
  buffer_load_dwordx4 v124, s[8:11], s70 offen offset:0  lds
  buffer_load_dwordx4 v125, s[8:11], s70 offen offset:1024  lds
  s_add_u32 s44, s67, 1
  s_and_b32 s44, s44, 15
  s_mul_i32 s45, s44, 393216
  s_add_u32 s69, s45, s60
  s_add_u32 s70, s69, 4096
  s_add_u32 m0, s63, 24576
  s_nop 0
  buffer_load_dwordx4 v124, s[8:11], s69 offen offset:0  lds
  buffer_load_dwordx4 v125, s[8:11], s69 offen offset:1024  lds
  buffer_load_dwordx4 v124, s[8:11], s69 offen offset:2048  lds
  buffer_load_dwordx4 v125, s[8:11], s69 offen offset:3072  lds
  s_add_u32 m0, s63, 28672
  s_nop 0
  buffer_load_dwordx4 v124, s[8:11], s70 offen offset:0  lds
  buffer_load_dwordx4 v125, s[8:11], s70 offen offset:1024  lds
  s_add_u32 s44, s67, 2
  s_and_b32 s44, s44, 15
  s_mul_i32 s45, s44, 393216
  s_add_u32 s69, s45, s60
  s_add_u32 s70, s69, 4096
  s_add_u32 m0, s63, 49152
  s_nop 0
  buffer_load_dwordx4 v124, s[8:11], s69 offen offset:0  lds
  buffer_load_dwordx4 v125, s[8:11], s69 offen offset:1024  lds
  buffer_load_dwordx4 v124, s[8:11], s69 offen offset:2048  lds
  buffer_load_dwordx4 v125, s[8:11], s69 offen offset:3072  lds
  s_add_u32 m0, s63, 53248
  s_nop 0
  buffer_load_dwordx4 v124, s[8:11], s70 offen offset:0  lds
  buffer_load_dwordx4 v125, s[8:11], s70 offen offset:1024  lds
  v_mov_b32 v0, 0
  v_mov_b32 v1, 0
  v_mov_b32 v2, 0
  v_mov_b32 v3, 0
  v_mov_b32 v4, 0
  v_mov_b32 v5, 0
  v_mov_b32 v6, 0
  v_mov_b32 v7, 0
  v_mov_b32 v8, 0
  v_mov_b32 v9, 0
  v_mov_b32 v10, 0
  v_mov_b32 v11, 0
  v_mov_b32 v12, 0
  v_mov_b32 v13, 0
  v_mov_b32 v14, 0
  v_mov_b32 v15, 0
  v_mov_b32 v16, 0
  v_mov_b32 v17, 0
  v_mov_b32 v18, 0
  v_mov_b32 v19, 0
  v_mov_b32 v20, 0
  v_mov_b32 v21, 0
  v_mov_b32 v22, 0
  v_mov_b32 v23, 0
  v_mov_b32 v24, 0
  v_mov_b32 v25, 0
  v_mov_b32 v26, 0
  v_mov_b32 v27, 0
  v_mov_b32 v28, 0
  v_mov_b32 v29, 0
  v_mov_b32 v30, 0
  v_mov_b32 v31, 0
  v_mov_b32 v32, 0
  v_mov_b32 v33, 0
  v_mov_b32 v34, 0
  v_mov_b32 v35, 0
  v_mov_b32 v36, 0
  v_mov_b32 v37, 0
  v_mov_b32 v38, 0
  v_mov_b32 v39, 0
  v_mov_b32 v40, 0
  v_mov_b32 v41, 0
  v_mov_b32 v42, 0
  v_mov_b32 v43, 0
  v_mov_b32 v44, 0
  v_mov_b32 v45, 0
  v_mov_b32 v46, 0
  v_mov_b32 v47, 0
  v_mov_b32 v48, 0
  v_mov_b32 v49, 0
  v_mov_b32 v50, 0
  v_mov_b32 v51, 0
  v_mov_b32 v52, 0
  v_mov_b32 v53, 0
  v_mov_b32 v54, 0
  v_mov_b32 v55, 0
  v_mov_b32 v56, 0
  v_mov_b32 v57, 0
  v_mov_b32 v58, 0
  v_mov_b32 v59, 0
  v_mov_b32 v60, 0
  v_mov_b32 v61, 0
  v_mov_b32 v62, 0
  v_mov_b32 v63, 0
  v_mov_b32 v64, 0
  v_mov_b32 v65, 0
  v_mov_b32 v66, 0
  v_mov_b32 v67, 0
  v_mov_b32 v68, 0
  v_mov_b32 v69, 0
  v_mov_b32 v70, 0
  v_mov_b32 v71, 0
  v_mov_b32 v72, 0
  v_mov_b32 v73, 0
  v_mov_b32 v74, 0
  v_mov_b32 v75, 0
  v_mov_b32 v76, 0
  v_mov_b32 v77, 0
  v_mov_b32 v78, 0
  v_mov_b32 v79, 0
  v_mov_b32 v80, 0
  v_mov_b32 v81, 0
  v_mov_b32 v82, 0
  v_mov_b32 v83, 0
  v_mov_b32 v84, 0
  v_mov_b32 v85, 0
  v_mov_b32 v86, 0
  v_mov_b32 v87, 0
  v_mov_b32 v88, 0
  v_mov_b32 v89, 0
  v_mov_b32 v90, 0
  v_mov_b32 v91, 0
  v_mov_b32 v92, 0
  v_mov_b32 v93, 0
  v_mov_b32 v94, 0
  v_mov_b32 v95, 0
  v_mov_b32 v96, 0
  v_mov_b32 v97, 0
  v_mov_b32 v98, 0
  v_mov_b32 v99, 0
  v_mov_b32 v100, 0
  v_mov_b32 v101, 0
  v_mov_b32 v102, 0
  v_mov_b32 v103, 0
  s_mul_i32 s77, s50, 256
  s_add_u32 s77, s77, 27811584
  s_and_b32 s43, s50, 7
  s_cmp_eq_u32 s43, 0
  s_cselect_b32 s43, 256, 0
  v_lshlrev_b32 v249, 7, v253
  v_or_b32 v249, s43, v249
  s_branch Llayer
Lend:
  s_endpgm
Lside_sub:
  s_cmp_eq_u32 s90, 1
  s_cbranch_scc0 Lside_l
  s_cmp_lg_u32 s40, 0
  s_cbranch_scc1 Lside_a
  s_and_b32 s43, s2, 1
  s_lshl_b32 s43, s43, 7
  v_mov_b32 v250, 1
  s_mov_b64 exec, 1
  buffer_atomic_add v250, v251, s[36:39], s43 offen sc1
  s_mov_b64 exec, -1
Lside_a:
  s_add_u32 s88, s88, 3
  s_add_u32 s90, s90, 1
  s_setpc_b64 s[78:79]
Lside_l:
  buffer_load_dwordx4 a[240:243], v239, s[12:15], s89 offen
  s_add_u32 s89, s89, 1024
  s_cmp_eq_u32 s90, 0
  s_cbranch_scc0 Lside_b
  buffer_load_dwordx4 a[176:179], v238, s[84:87], s100 offen
  s_add_u32 s100, s100, 57344
  buffer_load_dwordx4 a[180:183], v238, s[84:87], s100 offen
  s_add_u32 s100, s100, 57344
  buffer_load_dwordx4 a[184:187], v238, s[84:87], s100 offen
  s_add_u32 s100, s100, 57344
  buffer_load_dwordx4 a[188:191], v238, s[84:87], s100 offen
  s_add_u32 s100, s100, 57344
  buffer_load_dwordx4 a[192:195], v238, s[84:87], s100 offen
  s_add_u32 s100, s100, 57344
  buffer_load_dwordx4 a[196:199], v238, s[84:87], s100 offen
  s_add_u32 s100, s100, 57344
  buffer_load_dwordx4 a[200:203], v238, s[84:87], s100 offen
  s_add_u32 s100, s100, 57344
  buffer_load_dwordx4 a[204:207], v238, s[84:87], s100 offen
  s_add_u32 s100, s100, 57344
  s_add_u32 s100, s100, 3211264
  s_add_u32 s88, s88, 3
  s_add_u32 s90, s90, 1
  s_setpc_b64 s[78:79]
Lside_b:
  buffer_load_dwordx4 a[208:211], v238, s[84:87], s100 offen
  s_add_u32 s100, s100, 57344
  buffer_load_dwordx4 a[212:215], v238, s[84:87], s100 offen
  s_add_u32 s100, s100, 57344
  buffer_load_dwordx4 a[216:219], v238, s[84:87], s100 offen
  s_add_u32 s100, s100, 57344
  buffer_load_dwordx4 a[220:223], v238, s[84:87], s100 offen
  s_add_u32 s100, s100, 57344
  buffer_load_dwordx4 a[224:227], v238, s[84:87], s100 offen
  s_add_u32 s100, s100, 57344
  buffer_load_dwordx4 a[228:231], v238, s[84:87], s100 offen
  s_add_u32 s100, s100, 57344
  buffer_load_dwordx4 a[232:235], v238, s[84:87], s100 offen
  s_add_u32 s100, s100, 57344
  buffer_load_dwordx4 a[236:239], v238, s[84:87], s100 offen
  s_add_u32 s100, s100, 57344
  s_mov_b32 s88, 63
  s_setpc_b64 s[78:79]
Lcode_end:
.fill (Lpc0 + 69632 - Lcode_end)/4, 4, 0xbf810000
.section .rodata,"a"
.p2align 6
.amdhsa_kernel interleave_layers__sliding_local_dilated__swiglu_ffn__prompt_kernel
  .amdhsa_next_free_vgpr 512
  .amdhsa_next_free_sgpr 102
  .amdhsa_accum_offset 256
  .amdhsa_group_segment_fixed_size 0
  .amdhsa_kernarg_size 80
  .amdhsa_user_sgpr_count 2
  .amdhsa_user_sgpr_kernarg_segment_ptr 1
  .amdhsa_system_sgpr_workgroup_id_x 1
  .amdhsa_float_denorm_mode_32 3
.end_amdhsa_kernel
```

```asm
; @launch grid=(256,1,1) block=(256,1,1) lds=163840
.amdgcn_target "amdgcn-amd-amdhsa--gfx950"
.text
.globl interleave_layers__sliding_local_dilated__swiglu_ffn__prompt_kernel
.p2align 8
.type interleave_layers__sliding_local_dilated__swiglu_ffn__prompt_kernel,@function
interleave_layers__sliding_local_dilated__swiglu_ffn__prompt_kernel:
  s_cmp_lt_u32 s2, 256
  s_cbranch_scc1 Lgo
  s_endpgm
Lgo:
  s_load_dwordx2 s[28:29], s[0:1], 0
  s_load_dwordx2 s[8:9], s[0:1], 8
  s_getpc_b64 s[44:45]
Lpc0:
  s_bfe_u32 s43, s2, 0x40003
  s_lshl_b32 s43, s43, 12
  v_lshl_add_u32 v2, v0, 4, s43
  s_and_b32 s44, s44, 0xffffff80
  global_load_dwordx4 a[240:243], v2, s[44:45]
  v_lshrrev_b32 v1, 6, v0
  v_and_b32 v253, 63, v0
  v_readfirstlane_b32 s40, v1
  v_mov_b32 v251, 0
  s_mov_b32 s30, 0x400000
  s_mov_b32 s31, 0x20000
  s_mov_b32 s10, 0x600000
  s_mov_b32 s11, 0x20000
  s_and_b32 s44, s2, 1
  s_bfe_u32 s45, s2, 0x20001
  s_lshr_b32 s46, s2, 3
  s_lshl_b32 s47, s44, 3
  s_and_b32 s43, s46, 7
  s_add_u32 s50, s47, s43
  s_lshl_b32 s43, s45, 2
  s_lshr_b32 s51, s46, 3
  s_add_u32 s51, s51, s43
  s_lshr_b32 s57, s40, 1
  s_and_b32 s58, s40, 1
  s_lshl_b32 s71, s50, 3
  s_add_u32 s67, s50, s51
  s_and_b32 s67, s67, 15
  s_lshl_b32 s62, s40, 12
  s_mul_i32 s63, s40, 6144
  s_add_u32 s76, s63, 139264
  s_and_b32 s43, s50, 7
  s_cmp_lg_u32 s43, 0
  s_cselect_b32 s43, 1, 0
  s_sub_u32 s72, s71, s43
  v_lshrrev_b32 v2, 3, v253
  v_bfe_u32 v3, v253, 1, 2
  v_lshrrev_b32 v4, 4, v253
  v_xor_b32 v3, v3, v4
  v_and_b32 v5, 1, v253
  v_lshrrev_b32 v6, 5, v253
  v_lshl_add_u32 v6, v6, 2, v2
  s_lshl_b32 s43, s57, 5
  s_lshl_b32 s44, s58, 2
  s_add_u32 s43, s43, s44
  v_mul_u32_u24 v6, 6144, v6
  v_lshl_add_u32 v6, v3, 5, v6
  v_lshl_add_u32 v124, v5, 4, v6
  v_add_u32 v125, 97280, v124
  s_mul_i32 s43, s43, 6144
  s_lshl_b32 s60, s51, 7
  s_add_u32 s60, s60, s43
  v_and_b32 v3, 7, v253
  s_lshl_b32 s43, s40, 1
  s_add_u32 s43, s43, s71
  v_add_u32 v5, 0, v4
  v_xor_b32 v5, v5, v3
  v_lshlrev_b32 v5, 4, v5
  v_lshl_add_u32 v5, v2, 12, v5
  v_add_u32 v120, 0, v5
  v_add_u32 v5, 4, v4
  v_xor_b32 v5, v5, v3
  v_lshlrev_b32 v5, 4, v5
  v_lshl_add_u32 v5, v2, 12, v5
  v_add_u32 v121, 31744, v5
  v_add_u32 v5, 0, v4
  v_xor_b32 v5, v5, v3
  v_lshlrev_b32 v5, 4, v5
  v_lshl_add_u32 v5, v2, 12, v5
  v_add_u32 v122, 63488, v5
  v_add_u32 v5, 4, v4
  v_xor_b32 v5, v5, v3
  v_lshlrev_b32 v5, 4, v5
  v_lshl_add_u32 v5, v2, 12, v5
  v_add_u32 v123, 95232, v5
  v_and_b32 v5, 6, v2
  v_xor_b32 v5, v5, v3
  v_lshlrev_b32 v5, 4, v5
  v_lshl_add_u32 v5, v2, 12, v5
  v_add_u32 v126, 32768, v5
  s_lshr_b32 s44, s50, 3
  s_lshl_b32 s44, s44, 11
  s_and_b32 s43, s43, 63
  s_lshl_b32 s43, s43, 16
  s_add_u32 s59, s43, s44
  s_and_b32 s43, s72, 63
  s_lshl_b32 s43, s43, 16
  s_add_u32 s73, s43, s44
  s_movk_i32 s61, 128
  s_waitcnt lgkmcnt(0)
  s_add_u32 s44, s67, 0
  s_and_b32 s44, s44, 15
  s_mul_i32 s45, s44, s61
  s_add_u32 s68, s45, s59
  s_add_u32 m0, s62, 73728
  s_nop 0
  buffer_load_dwordx4 v120, s[28:31], s68 offen offset:0 sc1  lds
  buffer_load_dwordx4 v121, s[28:31], s68 offen offset:1024 sc1  lds
  buffer_load_dwordx4 v122, s[28:31], s68 offen offset:2048 sc1  lds
  buffer_load_dwordx4 v123, s[28:31], s68 offen offset:3072 sc1  lds
  s_add_u32 s44, s67, 0
  s_and_b32 s44, s44, 15
  s_mul_i32 s45, s44, 393216
  s_add_u32 s69, s45, s60
  s_add_u32 s70, s69, 4096
  s_add_u32 m0, s63, 0
  s_nop 0
  buffer_load_dwordx4 v124, s[8:11], s69 offen offset:0  lds
  buffer_load_dwordx4 v125, s[8:11], s69 offen offset:1024  lds
  buffer_load_dwordx4 v124, s[8:11], s69 offen offset:2048  lds
  buffer_load_dwordx4 v125, s[8:11], s69 offen offset:3072  lds
  s_add_u32 m0, s63, 4096
  s_nop 0
  buffer_load_dwordx4 v124, s[8:11], s70 offen offset:0  lds
  buffer_load_dwordx4 v125, s[8:11], s70 offen offset:1024  lds
  s_add_u32 s44, s67, s40
  s_add_u32 s44, s44, 0
  s_and_b32 s44, s44, 15
  s_mul_i32 s44, s44, s61
  s_lshl_b32 s45, s40, 10
  s_add_u32 m0, s45, 122880
  s_add_u32 s44, s44, s73
  buffer_load_dwordx4 v126, s[28:31], s44 offen sc1 lds
  s_load_dwordx2 s[4:5], s[0:1], 72
  s_load_dwordx2 s[12:13], s[0:1], 16
  s_load_dwordx2 s[16:17], s[0:1], 32
  s_load_dwordx2 s[20:21], s[0:1], 40
  s_load_dwordx2 s[24:25], s[0:1], 48
  s_load_dwordx2 s[32:33], s[0:1], 56
  s_load_dwordx2 s[36:37], s[0:1], 64
  s_mov_b32 s6, 0x10000000
  s_mov_b32 s7, 0x20000
  s_mov_b32 s14, 0x200000
  s_mov_b32 s15, 0x20000
  s_mov_b32 s18, 0x700000
  s_mov_b32 s19, 0x20000
  s_mov_b32 s22, 0x700000
  s_mov_b32 s23, 0x20000
  s_mov_b32 s26, 0x700000
  s_mov_b32 s27, 0x20000
  s_mov_b32 s34, 0x400000
  s_mov_b32 s35, 0x20000
  s_mov_b32 s38, 0x100
  s_mov_b32 s39, 0x20000
  s_mov_b32 s41, 0
  s_mov_b32 s42, 0
  s_and_b32 s44, s2, 1
  s_bfe_u32 s45, s2, 0x20001
  s_lshr_b32 s46, s2, 3
  s_lshl_b32 s47, s44, 3
  s_lshr_b32 s43, s45, 1
  s_lshl_b32 s43, s43, 2
  s_add_u32 s52, s47, s43
  s_and_b32 s48, s46, 3
  s_add_u32 s52, s52, s48
  s_and_b32 s43, s45, 1
  s_lshr_b32 s49, s46, 2
  s_lshl_b32 s53, s49, 1
  s_add_u32 s53, s53, s43
  s_lshl_b32 s43, s44, 2
  s_add_u32 s54, s43, s48
  s_lshl_b32 s43, s45, 3
  s_add_u32 s55, s43, s49
  v_lshrrev_b32 v2, 3, v253
  v_bfe_u32 v3, v253, 1, 2
  v_lshrrev_b32 v4, 4, v253
  v_xor_b32 v3, v3, v4
  v_and_b32 v4, 1, v253
  v_lshlrev_b32 v2, 11, v2
  v_lshl_add_u32 v2, v3, 5, v2
  v_lshl_add_u32 v252, v4, 4, v2
  s_waitcnt lgkmcnt(0)
  s_and_b32 s43, s40, 1
  s_mul_i32 s43, s43, 41943040
  s_lshl_b32 s44, s2, 7
  s_add_u32 s43, s43, s44
  s_add_u32 s43, s43, 27787264
  buffer_store_dword v251, v251, s[4:7], s43 offen sc1
  v_and_b32 v2, 15, v253
  v_lshrrev_b32 v3, 4, v253
  v_and_b32 v4, 7, v253
  v_lshrrev_b32 v5, 1, v2
  v_xor_b32 v5, v5, v3
  v_lshlrev_b32 v5, 4, v5
  v_lshl_add_u32 v6, v2, 7, v5
  v_xor_b32 v7, 64, v6
  v_and_b32 v5, 6, v4
  v_xor_b32 v5, v5, v3
  v_lshlrev_b32 v5, 4, v5
  v_lshl_add_u32 v8, v4, 7, v5
  v_xor_b32 v9, 64, v8
  s_lshl_b32 s43, s57, 13
  s_add_u32 s43, s43, 73728
  v_add_u32 v112, s43, v6
  v_add_u32 v113, s43, v7
  v_add_u32 v114, 122880, v8
  v_add_u32 v115, 122880, v9
  s_lshl_b32 s43, s52, 3
  s_lshl_b32 s44, s40, 1
  s_add_u32 s43, s43, s44
  v_lshrrev_b32 v5, 1, v3
  v_lshrrev_b32 v187, 1, v2
  v_xor_b32 v5, v5, v187
  v_lshlrev_b32 v5, 4, v5
  v_lshl_add_u32 v187, v2, 7, v5
  v_and_b32 v5, 1, v3
  v_lshl_add_u32 v187, v5, 3, v187
  s_lshr_b32 s44, s43, 6
  s_lshl_b32 s44, s44, 11
  s_and_b32 s43, s43, 63
  s_lshl_b32 s43, s43, 16
  s_add_u32 s43, s43, s44
  s_lshl_b32 s44, s53, 7
  s_add_u32 s64, s43, s44
  v_lshrrev_b32 v2, 2, v253
  v_bfe_u32 v3, v253, 3, 2
  v_and_b32 v4, 3, v253
  v_lshlrev_b32 v4, 3, v4
  v_lshl_add_u32 v4, v2, 7, v4
  s_lshl_b32 s43, s58, 1
  s_or_b32 s43, s43, s57
  v_xor_b32 v5, s43, v3
  v_lshl_add_u32 v116, v5, 5, v4
  v_xor_b32 v5, 1, v5
  v_lshl_add_u32 v117, v5, 5, v4
  v_add_u32 v118, 49152, v116
  v_add_u32 v119, 49152, v117
  v_and_b32 v235, 15, v253
  v_lshrrev_b32 v236, 4, v253
  v_lshlrev_b32 v236, 2, v236
  v_sub_u32 v235, v235, v236
  v_mov_b32 v237, 0xf149f2ca
  v_subrev_u32 v238, 0, v235
  v_cmp_gt_u32 vcc, 8, v238
  v_add_u32 v238, 16, v238
  v_cmp_gt_u32 s[78:79], 8, v238
  v_cndmask_b32 v132, v237, 0, vcc
  s_nop 0
  v_cndmask_b32 v136, v237, 0, s[78:79]
  v_subrev_u32 v238, 1, v235
  v_cmp_gt_u32 vcc, 8, v238
  v_add_u32 v238, 16, v238
  v_cmp_gt_u32 s[78:79], 8, v238
  v_cndmask_b32 v133, v237, 0, vcc
  s_nop 0
  v_cndmask_b32 v137, v237, 0, s[78:79]
  v_subrev_u32 v238, 2, v235
  v_cmp_gt_u32 vcc, 8, v238
  v_add_u32 v238, 16, v238
  v_cmp_gt_u32 s[78:79], 8, v238
  v_cndmask_b32 v134, v237, 0, vcc
  s_nop 0
  v_cndmask_b32 v138, v237, 0, s[78:79]
  v_subrev_u32 v238, 3, v235
  v_cmp_gt_u32 vcc, 8, v238
  v_add_u32 v238, 16, v238
  v_cmp_gt_u32 s[78:79], 8, v238
  v_cndmask_b32 v135, v237, 0, vcc
  s_nop 0
  v_cndmask_b32 v139, v237, 0, s[78:79]
  v_lshlrev_b32 v232, 4, v253
  v_add_u32 v232, 149504, v232
  ds_write_b128 v232, v[132:135]
  ds_write_b128 v232, v[136:139] offset:1024
  s_lshr_b32 s46, s2, 3
  s_cmp_ge_u32 s46, 14
  s_cselect_b32 s44, 14, 0
  s_cselect_b32 s45, 1, 0
  s_cselect_b32 s84, s20, s16
  s_cselect_b32 s85, s21, s17
  s_mov_b32 s86, 7340032
  s_mov_b32 s87, 0x20000
  s_sub_u32 s44, s46, s44
  s_bfe_u32 s47, s2, 0x20001
  s_mul_i32 s47, s47, 14
  s_add_u32 s44, s44, s47
  s_and_b32 s47, s2, 1
  s_lshl_b32 s48, s47, 1
  s_add_u32 s48, s48, s45
  s_mul_i32 s48, s48, 14336
  s_lshl_b32 s49, s44, 8
  s_add_u32 s48, s48, s49
  s_add_u32 s101, s48, 27918336
  s_lshl_b32 s47, s47, 2
  s_add_u32 s47, s47, s40
  s_mul_i32 s47, s47, 458752
  s_lshl_b32 s44, s44, 7
  s_add_u32 s100, s47, s44
  s_cmp_lt_u32 s46, 28
  s_cselect_b32 s3, 1, 0
  s_cmp_eq_u32 s41, 0
  s_cselect_b32 s3, s3, 0
  v_lshrrev_b32 v238, 3, v253
  v_mul_u32_u24 v238, 7168, v238
  v_and_b32 v239, 7, v253
  v_lshl_add_u32 v238, v239, 4, v238
  s_cmp_eq_u32 s3, 0
  s_cselect_b32 s43, 0x40000000, 0
  v_or_b32 v238, s43, v238
  v_lshlrev_b32 v239, 4, v253
  s_lshl_b32 s43, s2, 2
  s_add_u32 s43, s43, s40
  s_lshl_b32 s89, s43, 11
  s_mul_i32 s43, s46, 43
  s_lshr_b32 s43, s43, 8
  s_mul_i32 s43, s43, 6
  s_sub_u32 s43, s46, s43
  s_add_u32 s43, s43, 5
  s_cmp_eq_u32 s41, 0
  s_cselect_b32 s88, s43, 63
  s_mov_b32 s90, 0
  s_lshl_b32 s43, s58, 12
  v_add_u32 v132, s43, v112
  v_add_u32 v133, s43, v113
  v_and_b32 v128, 15, v253
  v_lshrrev_b32 v129, 4, v253
  v_cmp_eq_u32 vcc, 0, v128
  v_lshlrev_b32 v129, 4, v129
  v_mov_b32 v130, 0x40000000
  v_cndmask_b32 v136, v130, v129, vcc
  v_mov_b32 v156, 0x3f803f80
  v_mov_b32 v157, 0x3f803f80
  v_mov_b32 v158, 0x3f803f80
  v_mov_b32 v159, 0x3f803f80
  s_lshl_b32 s43, s40, 1
  s_add_u32 s43, s43, s71
  s_lshl_b32 s48, s43, 11
  s_lshl_b32 s43, s67, 7
  s_add_u32 s48, s48, s43
  s_add_u32 s48, s48, 27262976
  s_lshl_b32 s43, s51, 2
  s_lshl_b32 s44, s58, 1
  s_add_u32 s43, s43, s44
  s_add_u32 s43, s43, s57
  s_lshl_b32 s43, s43, 6
  s_mul_i32 s49, s67, 12288
  s_add_u32 s49, s49, s43
  s_add_u32 s49, s49, 27983872
  v_and_b32 v212, 15, v253
  v_lshrrev_b32 v213, 4, v253
  v_lshrrev_b32 v192, 2, v212
  v_cmp_eq_u32 vcc, v192, v213
  v_and_b32 v192, 3, v212
  v_lshlrev_b32 v212, 3, v212
  v_mov_b32 v213, 0x7ffffff0
  v_cndmask_b32 v212, v213, v212, vcc
  v_cmp_eq_u32 s[78:79], 1, v192
  v_cmp_eq_u32 s[80:81], 2, v192
  v_cmp_eq_u32 s[82:83], 3, v192
  v_mov_b32 v192, 0x3f803f80
  v_mov_b32 v193, 0x3f803f80
  v_mov_b32 v194, 0x3f803f80
  v_mov_b32 v195, 0x3f803f80
  s_add_u32 s44, s67, 1
  s_and_b32 s44, s44, 15
  s_mul_i32 s45, s44, s61
  s_add_u32 s68, s45, s59
  s_add_u32 m0, s62, 90112
  s_nop 0
  buffer_load_dwordx4 v120, s[28:31], s68 offen offset:0 sc1  lds
  buffer_load_dwordx4 v121, s[28:31], s68 offen offset:1024 sc1  lds
  buffer_load_dwordx4 v122, s[28:31], s68 offen offset:2048 sc1  lds
  buffer_load_dwordx4 v123, s[28:31], s68 offen offset:3072 sc1  lds
  s_waitcnt vmcnt(5)
  s_barrier
  ds_read_b64_tr_b16 a[40:41], v116 offset:0
  ds_read_b64_tr_b16 a[42:43], v116 offset:6144
  ds_read_b64_tr_b16 a[64:65], v116 offset:12288
  ds_read_b64_tr_b16 a[66:67], v116 offset:18432
  ds_read_b128 a[4:7], v112 offset:0
  ds_read_b128 a[24:27], v113 offset:0
  ds_read_b128 a[8:11], v112 offset:2048
  ds_read_b128 a[28:31], v113 offset:2048
  ds_read_b128 a[12:15], v112 offset:4096
  ds_read_b128 a[32:35], v113 offset:4096
  ds_read_b128 a[16:19], v112 offset:6144
  ds_read_b128 a[36:39], v113 offset:6144
  ds_read_b64_tr_b16 a[44:45], v117 offset:0
  ds_read_b64_tr_b16 a[46:47], v117 offset:6144
  ds_read_b64_tr_b16 a[68:69], v117 offset:12288
  ds_read_b64_tr_b16 a[70:71], v117 offset:18432
  ds_read_b128 a[0:3], v114 offset:0
  ds_read_b128 a[20:23], v115 offset:0
  ds_read_b64_tr_b16 a[48:49], v116 offset:2048
  ds_read_b64_tr_b16 a[50:51], v116 offset:8192
  ds_read_b64_tr_b16 a[72:73], v116 offset:14336
  ds_read_b64_tr_b16 a[74:75], v116 offset:20480
  ds_read_b64_tr_b16 a[52:53], v117 offset:2048
  ds_read_b64_tr_b16 a[54:55], v117 offset:8192
  ds_read_b64_tr_b16 a[76:77], v117 offset:14336
  ds_read_b64_tr_b16 a[78:79], v117 offset:20480
  ds_read_b64_tr_b16 a[56:57], v116 offset:4096
  ds_read_b64_tr_b16 a[58:59], v116 offset:10240
  ds_read_b64_tr_b16 a[80:81], v116 offset:16384
  ds_read_b64_tr_b16 a[82:83], v116 offset:22528
  ds_read_b64_tr_b16 a[60:61], v117 offset:4096
  ds_read_b64_tr_b16 a[62:63], v117 offset:10240
  ds_read_b64_tr_b16 a[84:85], v117 offset:16384
  ds_read_b64_tr_b16 a[86:87], v117 offset:22528
  ds_read_b128 v[140:143], v132 offset:0
  ds_read_b128 v[144:147], v133 offset:0
  ds_read_b128 v[148:151], v132 offset:2048
  ds_read_b128 v[152:155], v133 offset:2048
  s_add_u32 s44, s67, 1
  s_and_b32 s44, s44, 15
  s_mul_i32 s45, s44, 393216
  s_add_u32 s69, s45, s60
  s_add_u32 s70, s69, 4096
  s_add_u32 m0, s63, 24576
  s_nop 0
  buffer_load_dwordx4 v124, s[8:11], s69 offen offset:0  lds
  buffer_load_dwordx4 v125, s[8:11], s69 offen offset:1024  lds
  buffer_load_dwordx4 v124, s[8:11], s69 offen offset:2048  lds
  buffer_load_dwordx4 v125, s[8:11], s69 offen offset:3072  lds
  s_add_u32 m0, s63, 28672
  s_nop 0
  buffer_load_dwordx4 v124, s[8:11], s70 offen offset:0  lds
  buffer_load_dwordx4 v125, s[8:11], s70 offen offset:1024  lds
  s_waitcnt lgkmcnt(15)
  v_mfma_f32_16x16x32_bf16 v[0:3], a[40:43], a[4:7], 0
  s_add_u32 s44, s67, 2
  s_and_b32 s44, s44, 15
  s_mul_i32 s45, s44, 393216
  s_add_u32 s69, s45, s60
  s_add_u32 s70, s69, 4096
  s_add_u32 m0, s63, 49152
  s_nop 0
  v_mfma_f32_16x16x32_bf16 v[0:3], a[64:67], a[24:27], v[0:3]
  buffer_load_dwordx4 v124, s[8:11], s69 offen offset:0  lds
  v_mfma_f32_16x16x32_bf16 v[4:7], a[64:67], a[28:31], 0
  v_mfma_f32_16x16x32_bf16 v[4:7], a[40:43], a[8:11], v[4:7]
  buffer_load_dwordx4 v125, s[8:11], s69 offen offset:1024  lds
  v_mfma_f32_16x16x32_bf16 v[8:11], a[40:43], a[12:15], 0
  v_mfma_f32_16x16x32_bf16 v[8:11], a[64:67], a[32:35], v[8:11]
  v_mfma_f32_16x16x32_bf16 v[12:15], a[64:67], a[36:39], 0
  buffer_load_dwordx4 v124, s[8:11], s69 offen offset:2048  lds
  v_mfma_f32_16x16x32_bf16 v[12:15], a[40:43], a[16:19], v[12:15]
  v_mfma_f32_16x16x32_bf16 v[28:31], a[44:47], a[16:19], 0
  buffer_load_dwordx4 v125, s[8:11], s69 offen offset:3072  lds
  v_mfma_f32_16x16x32_bf16 v[28:31], a[68:71], a[36:39], v[28:31]
  s_add_u32 m0, s63, 53248
  s_nop 0
  v_mfma_f32_16x16x32_bf16 v[24:27], a[68:71], a[32:35], 0
  v_mfma_f32_16x16x32_bf16 v[24:27], a[44:47], a[12:15], v[24:27]
  buffer_load_dwordx4 v124, s[8:11], s70 offen offset:0  lds
  v_mfma_f32_16x16x32_bf16 v[20:23], a[44:47], a[8:11], 0
  v_mfma_f32_16x16x32_bf16 v[20:23], a[68:71], a[28:31], v[20:23]
  buffer_load_dwordx4 v125, s[8:11], s70 offen offset:1024  lds
  v_mfma_f32_16x16x32_bf16 v[16:19], a[68:71], a[24:27], 0
  s_add_u32 s44, s67, 2
  s_and_b32 s44, s44, 15
  s_mul_i32 s45, s44, s61
  s_add_u32 s68, s45, s59
  s_add_u32 m0, s62, 106496
  s_nop 0
  v_mfma_f32_16x16x32_bf16 v[16:19], a[44:47], a[4:7], v[16:19]
  v_mfma_f32_16x16x32_bf16 v[96:99], a[48:51], a[0:3], 0
  s_waitcnt vmcnt(6) lgkmcnt(0)
  s_barrier
  ds_read_b64_tr_b16 a[128:129], v116 offset:24576
  v_mfma_f32_16x16x32_bf16 v[96:99], a[72:75], a[20:23], v[96:99]
  ds_read_b64_tr_b16 a[130:131], v116 offset:30720
  buffer_load_dwordx4 v120, s[28:31], s68 offen offset:0 sc1  lds
  v_mfma_f32_16x16x32_bf16 v[32:35], a[72:75], a[24:27], 0
  ds_read_b64_tr_b16 a[152:153], v116 offset:36864
  v_mfma_f32_16x16x32_bf16 v[32:35], a[48:51], a[4:7], v[32:35]
  ds_read_b64_tr_b16 a[154:155], v116 offset:43008
  v_mfma_f32_16x16x32_bf16 v[36:39], a[48:51], a[8:11], 0
  ds_read_b128 a[92:95], v112 offset:16384
  buffer_load_dwordx4 v121, s[28:31], s68 offen offset:1024 sc1  lds
  v_mfma_f32_16x16x32_bf16 v[36:39], a[72:75], a[28:31], v[36:39]
  ds_read_b128 a[112:115], v113 offset:16384
  v_mfma_f32_16x16x32_bf16 v[40:43], a[72:75], a[32:35], 0
  ds_read_b128 a[96:99], v112 offset:18432
  buffer_load_dwordx4 v122, s[28:31], s68 offen offset:2048 sc1  lds
  v_mfma_f32_16x16x32_bf16 v[40:43], a[48:51], a[12:15], v[40:43]
  ds_read_b128 a[116:119], v113 offset:18432
  v_mfma_f32_16x16x32_bf16 v[44:47], a[48:51], a[16:19], 0
  ds_read_b128 a[100:103], v112 offset:20480
  v_mfma_f32_16x16x32_bf16 v[44:47], a[72:75], a[36:39], v[44:47]
  s_add_u32 s44, s67, s40
  ds_read_b128 a[120:123], v113 offset:20480
  buffer_load_dwordx4 v123, s[28:31], s68 offen offset:3072 sc1  lds
  s_add_u32 s44, s44, 4
  s_and_b32 s44, s44, 15
  s_mul_i32 s44, s44, s61
  s_lshl_b32 s45, s40, 10
  v_mfma_f32_16x16x32_bf16 v[60:63], a[76:79], a[36:39], 0
  s_add_u32 m0, s45, 126976
  s_add_u32 s44, s44, s73
  ds_read_b128 a[104:107], v112 offset:22528
  v_mfma_f32_16x16x32_bf16 v[60:63], a[52:55], a[16:19], v[60:63]
  ds_read_b128 a[124:127], v113 offset:22528
  v_mfma_f32_16x16x32_bf16 v[56:59], a[52:55], a[12:15], 0
  ds_read_b64_tr_b16 a[132:133], v117 offset:24576
  buffer_load_dwordx4 v126, s[28:31], s44 offen sc1 lds
  s_add_u32 s44, s67, s40
  s_add_u32 s44, s44, 8
  s_and_b32 s44, s44, 15
  s_mul_i32 s44, s44, s61
  s_lshl_b32 s45, s40, 10
  v_mfma_f32_16x16x32_bf16 v[56:59], a[76:79], a[32:35], v[56:59]
  s_add_u32 m0, s45, 131072
  s_add_u32 s44, s44, s73
  ds_read_b64_tr_b16 a[134:135], v117 offset:30720
  v_mfma_f32_16x16x32_bf16 v[160:163], a[40:43], v[156:159], 0
  ds_read_b64_tr_b16 a[156:157], v117 offset:36864
  v_mfma_f32_16x16x32_bf16 v[164:167], a[48:51], v[156:159], 0
  ds_read_b64_tr_b16 a[158:159], v117 offset:43008
  buffer_load_dwordx4 v126, s[28:31], s44 offen sc1 lds
  s_add_u32 s44, s67, s40
  s_add_u32 s44, s44, 12
  s_and_b32 s44, s44, 15
  s_mul_i32 s44, s44, s61
  s_lshl_b32 s45, s40, 10
  v_mfma_f32_16x16x32_bf16 v[168:171], a[56:59], v[156:159], 0
  s_add_u32 m0, s45, 135168
  s_add_u32 s44, s44, s73
  ds_read_b128 a[88:91], v114 offset:1024
  v_mfma_f32_16x16x32_bf16 v[160:163], a[64:67], v[156:159], v[160:163]
  ds_read_b128 a[108:111], v115 offset:1024
  buffer_load_dwordx4 v126, s[28:31], s44 offen sc1 lds
  s_add_u32 s44, s67, 3
  s_and_b32 s44, s44, 15
  s_mul_i32 s45, s44, s61
  s_add_u32 s68, s45, s59
  s_add_u32 m0, s62, 73728
  s_nop 0
  v_mfma_f32_16x16x32_bf16 v[164:167], a[72:75], v[156:159], v[164:167]
  ds_read_b64_tr_b16 a[136:137], v116 offset:26624
  v_mfma_f32_16x16x32_bf16 v[168:171], a[80:83], v[156:159], v[168:171]
  ds_read_b64_tr_b16 a[138:139], v116 offset:32768
  v_mfma_f32_16x16x32_bf16 v[208:211], v[148:151], v[148:151], 0
  ds_read_b64_tr_b16 a[160:161], v116 offset:38912
  buffer_load_dwordx4 v120, s[28:31], s68 offen offset:0 sc1  lds
  v_mfma_f32_16x16x32_bf16 v[204:207], v[192:195], v[148:151], 0
  ds_read_b64_tr_b16 a[162:163], v116 offset:45056
  v_mfma_f32_16x16x32_bf16 v[200:203], v[140:143], v[140:143], 0
  ds_read_b64_tr_b16 a[140:141], v117 offset:26624
  v_mfma_f32_16x16x32_bf16 v[196:199], v[192:195], v[140:143], 0
  ds_read_b64_tr_b16 a[142:143], v117 offset:32768
  buffer_load_dwordx4 v121, s[28:31], s68 offen offset:1024 sc1  lds
  v_mfma_f32_16x16x32_bf16 v[208:211], v[152:155], v[152:155], v[208:211]
  ds_read_b64_tr_b16 a[164:165], v117 offset:38912
  v_mfma_f32_16x16x32_bf16 v[204:207], v[192:195], v[152:155], v[204:207]
  ds_read_b64_tr_b16 a[166:167], v117 offset:45056
  v_mfma_f32_16x16x32_bf16 v[200:203], v[144:147], v[144:147], v[200:203]
  ds_read_b64_tr_b16 a[144:145], v116 offset:28672
  buffer_load_dwordx4 v122, s[28:31], s68 offen offset:2048 sc1  lds
  v_mfma_f32_16x16x32_bf16 v[196:199], v[192:195], v[144:147], v[196:199]
  ds_read_b64_tr_b16 a[146:147], v116 offset:34816
  v_mfma_f32_16x16x32_bf16 v[52:55], a[76:79], a[28:31], 0
  s_add_u32 s44, s67, 3
  ds_read_b64_tr_b16 a[168:169], v116 offset:40960
  buffer_load_dwordx4 v123, s[28:31], s68 offen offset:3072 sc1  lds
  s_and_b32 s44, s44, 15
  s_mul_i32 s45, s44, 393216
  s_add_u32 s69, s45, s60
  s_add_u32 s70, s69, 4096
  s_add_u32 m0, s63, 0
  s_nop 0
  v_mfma_f32_16x16x32_bf16 v[52:55], a[52:55], a[8:11], v[52:55]
  ds_read_b64_tr_b16 a[170:171], v116 offset:47104
  v_mfma_f32_16x16x32_bf16 v[48:51], a[52:55], a[4:7], 0
  ds_read_b64_tr_b16 a[148:149], v117 offset:28672
  v_mfma_f32_16x16x32_bf16 v[48:51], a[76:79], a[24:27], v[48:51]
  ds_read_b64_tr_b16 a[150:151], v117 offset:34816
  buffer_load_dwordx4 v124, s[8:11], s69 offen offset:0  lds
  v_mfma_f32_16x16x32_bf16 v[100:103], a[20:23], a[80:83], 0
  ds_read_b64_tr_b16 a[172:173], v117 offset:40960
  v_mfma_f32_16x16x32_bf16 v[100:103], a[0:3], a[56:59], v[100:103]
  ds_read_b64_tr_b16 a[174:175], v117 offset:47104
  v_mfma_f32_16x16x32_bf16 v[64:67], a[4:7], a[56:59], 0
  buffer_load_dwordx4 v125, s[8:11], s69 offen offset:1024  lds
  v_mfma_f32_16x16x32_bf16 v[64:67], a[24:27], a[80:83], v[64:67]
  v_cndmask_b32 v205, v208, v209, s[78:79]
  v_cndmask_b32 v205, v205, v210, s[80:81]
  v_cndmask_b32 v205, v205, v211, s[82:83]
  v_mfma_f32_16x16x32_bf16 v[68:71], a[28:31], a[80:83], 0
  buffer_store_dwordx2 v[204:205], v212, s[4:7], s48 offen offset:2048 sc1
  v_cndmask_b32 v197, v200, v201, s[78:79]
  v_mfma_f32_16x16x32_bf16 v[68:71], a[8:11], a[56:59], v[68:71]
  buffer_load_dwordx4 v124, s[8:11], s69 offen offset:2048  lds
  v_mfma_f32_16x16x32_bf16 v[72:75], a[12:15], a[56:59], 0
  v_cndmask_b32 v197, v197, v202, s[80:81]
  v_cndmask_b32 v197, v197, v203, s[82:83]
  v_mfma_f32_16x16x32_bf16 v[72:75], a[32:35], a[80:83], v[72:75]
  buffer_store_dwordx2 v[196:197], v212, s[4:7], s48 offen offset:0 sc1
  buffer_load_dwordx4 v125, s[8:11], s69 offen offset:3072  lds
  s_add_u32 m0, s63, 4096
  s_nop 0
  v_mfma_f32_16x16x32_bf16 v[76:79], a[36:39], a[80:83], 0
  buffer_store_dwordx4 v[160:163], v136, s[4:7], s49 offen sc1
  v_mfma_f32_16x16x32_bf16 v[76:79], a[16:19], a[56:59], v[76:79]
  s_add_u32 s49, s49, 4096
  buffer_store_dwordx4 v[164:167], v136, s[4:7], s49 offen sc1
  v_mfma_f32_16x16x32_bf16 v[92:95], a[16:19], a[60:63], 0
  s_add_u32 s49, s49, 4096
  buffer_load_dwordx4 v124, s[8:11], s70 offen offset:0  lds
  v_mfma_f32_16x16x32_bf16 v[92:95], a[36:39], a[84:87], v[92:95]
  buffer_store_dwordx4 v[168:171], v136, s[4:7], s49 offen sc1
  v_mfma_f32_16x16x32_bf16 v[88:91], a[32:35], a[84:87], 0
  s_add_u32 s49, s49, 4096
  v_mfma_f32_16x16x32_bf16 v[88:91], a[12:15], a[60:63], v[88:91]
  buffer_load_dwordx4 v125, s[8:11], s70 offen offset:1024  lds
  v_mfma_f32_16x16x32_bf16 v[84:87], a[8:11], a[60:63], 0
  v_mfma_f32_16x16x32_bf16 v[84:87], a[28:31], a[84:87], v[84:87]
  v_mfma_f32_16x16x32_bf16 v[80:83], a[24:27], a[84:87], 0
  v_mfma_f32_16x16x32_bf16 v[80:83], a[4:7], a[60:63], v[80:83]
  s_add_u32 s44, s67, 4
  s_and_b32 s44, s44, 15
  s_mul_i32 s45, s44, s61
  s_add_u32 s68, s45, s59
  s_mov_b32 s66, 5
  s_mov_b32 s56, 2
  s_cmp_eq_u32 s66, s88
  s_cbranch_scc1 Lside_k9_c
Lside_k9_r:
  s_branch Lp1_u1
  s_branch Lp1_common
Llayer:
  s_cmp_lg_u32 s40, 0
  s_cbranch_scc1 Lpdn2
  s_mov_b32 s43, 0x40000
  s_mov_b64 exec, 3
Lpol1:
  buffer_load_dword v250, v249, s[4:7], s77 offen sc1
  s_waitcnt vmcnt(0)
  v_cmp_gt_u32 vcc, 16, v250
  s_cbranch_vccz Lpdn2x
  s_sub_u32 s43, s43, 1
  s_cmp_lg_u32 s43, 0
  s_cbranch_scc1 Lpol1
Lpdn2x:
  s_mov_b64 exec, -1
Lpdn2:
  s_waitcnt vmcnt(0) lgkmcnt(0)
  s_barrier
  s_add_u32 s44, s67, 0
  s_and_b32 s44, s44, 15
  s_mul_i32 s45, s44, s61
  s_add_u32 s68, s45, s59
  s_add_u32 m0, s62, 73728
  s_nop 0
  buffer_load_dwordx4 v120, s[28:31], s68 offen offset:0 sc1  lds
  buffer_load_dwordx4 v121, s[28:31], s68 offen offset:1024 sc1  lds
  buffer_load_dwordx4 v122, s[28:31], s68 offen offset:2048 sc1  lds
  buffer_load_dwordx4 v123, s[28:31], s68 offen offset:3072 sc1  lds
  s_add_u32 s44, s67, s40
  s_add_u32 s44, s44, 0
  s_and_b32 s44, s44, 15
  s_mul_i32 s44, s44, s61
  s_lshl_b32 s45, s40, 10
  s_add_u32 m0, s45, 122880
  s_add_u32 s44, s44, s73
  buffer_load_dwordx4 v126, s[28:31], s44 offen sc1 lds
  s_add_u32 s44, s67, 1
  s_and_b32 s44, s44, 15
  s_mul_i32 s45, s44, s61
  s_add_u32 s68, s45, s59
  s_add_u32 m0, s62, 90112
  s_nop 0
  buffer_load_dwordx4 v120, s[28:31], s68 offen offset:0 sc1  lds
  buffer_load_dwordx4 v121, s[28:31], s68 offen offset:1024 sc1  lds
  buffer_load_dwordx4 v122, s[28:31], s68 offen offset:2048 sc1  lds
  buffer_load_dwordx4 v123, s[28:31], s68 offen offset:3072 sc1  lds
  ds_read_b64_tr_b16 a[40:41], v116 offset:0
  ds_read_b64_tr_b16 a[42:43], v116 offset:6144
  ds_read_b64_tr_b16 a[64:65], v116 offset:12288
  ds_read_b64_tr_b16 a[66:67], v116 offset:18432
  ds_read_b64_tr_b16 a[44:45], v117 offset:0
  ds_read_b64_tr_b16 a[46:47], v117 offset:6144
  ds_read_b64_tr_b16 a[68:69], v117 offset:12288
  ds_read_b64_tr_b16 a[70:71], v117 offset:18432
  ds_read_b64_tr_b16 a[48:49], v116 offset:2048
  ds_read_b64_tr_b16 a[50:51], v116 offset:8192
  ds_read_b64_tr_b16 a[72:73], v116 offset:14336
  ds_read_b64_tr_b16 a[74:75], v116 offset:20480
  ds_read_b64_tr_b16 a[52:53], v117 offset:2048
  ds_read_b64_tr_b16 a[54:55], v117 offset:8192
  ds_read_b64_tr_b16 a[76:77], v117 offset:14336
  ds_read_b64_tr_b16 a[78:79], v117 offset:20480
  ds_read_b64_tr_b16 a[56:57], v116 offset:4096
  ds_read_b64_tr_b16 a[58:59], v116 offset:10240
  ds_read_b64_tr_b16 a[80:81], v116 offset:16384
  ds_read_b64_tr_b16 a[82:83], v116 offset:22528
  ds_read_b64_tr_b16 a[60:61], v117 offset:4096
  ds_read_b64_tr_b16 a[62:63], v117 offset:10240
  ds_read_b64_tr_b16 a[84:85], v117 offset:16384
  ds_read_b64_tr_b16 a[86:87], v117 offset:22528
  s_waitcnt vmcnt(4)
  s_barrier
  ds_read_b128 a[4:7], v112 offset:0
  ds_read_b128 a[24:27], v113 offset:0
  ds_read_b128 a[8:11], v112 offset:2048
  ds_read_b128 a[28:31], v113 offset:2048
  ds_read_b128 a[12:15], v112 offset:4096
  ds_read_b128 a[32:35], v113 offset:4096
  ds_read_b128 a[16:19], v112 offset:6144
  ds_read_b128 a[36:39], v113 offset:6144
  ds_read_b128 a[0:3], v114 offset:0
  ds_read_b128 a[20:23], v115 offset:0
  s_add_u32 s44, s67, s40
  s_add_u32 s44, s44, 4
  s_and_b32 s44, s44, 15
  s_mul_i32 s44, s44, s61
  s_lshl_b32 s45, s40, 10
  s_add_u32 m0, s45, 126976
  s_add_u32 s44, s44, s73
  buffer_load_dwordx4 v126, s[28:31], s44 offen sc1 lds
  s_add_u32 s44, s67, s40
  s_add_u32 s44, s44, 8
  s_and_b32 s44, s44, 15
  s_mul_i32 s44, s44, s61
  s_lshl_b32 s45, s40, 10
  s_add_u32 m0, s45, 131072
  s_add_u32 s44, s44, s73
  buffer_load_dwordx4 v126, s[28:31], s44 offen sc1 lds
  s_add_u32 s44, s67, s40
  s_add_u32 s44, s44, 12
  s_and_b32 s44, s44, 15
  s_mul_i32 s44, s44, s61
  s_lshl_b32 s45, s40, 10
  s_add_u32 m0, s45, 135168
  s_add_u32 s44, s44, s73
  buffer_load_dwordx4 v126, s[28:31], s44 offen sc1 lds
  s_add_u32 s44, s67, 2
  s_and_b32 s44, s44, 15
  s_mul_i32 s45, s44, s61
  s_add_u32 s68, s45, s59
  s_add_u32 m0, s62, 106496
  s_nop 0
  buffer_load_dwordx4 v120, s[28:31], s68 offen offset:0 sc1  lds
  buffer_load_dwordx4 v121, s[28:31], s68 offen offset:1024 sc1  lds
  buffer_load_dwordx4 v122, s[28:31], s68 offen offset:2048 sc1  lds
  buffer_load_dwordx4 v123, s[28:31], s68 offen offset:3072 sc1  lds
  s_waitcnt lgkmcnt(0)
Lp1_common:
  s_mov_b32 s66, 4
  s_add_u32 s44, s67, 3
  s_and_b32 s44, s44, 15
  s_mul_i32 s45, s44, s61
  s_add_u32 s68, s45, s59
  s_mov_b32 s56, 2
.p2align 3
Lp1_loop:
  s_waitcnt lgkmcnt(15)
  v_mfma_f32_16x16x32_bf16 v[0:3], a[40:43], a[4:7], v[0:3]
  s_mul_i32 s45, s44, 393216
  v_mfma_f32_16x16x32_bf16 v[0:3], a[64:67], a[24:27], v[0:3]
  s_add_u32 s69, s45, s60
  v_mfma_f32_16x16x32_bf16 v[4:7], a[64:67], a[28:31], v[4:7]
  s_add_u32 s70, s69, 4096
  v_mfma_f32_16x16x32_bf16 v[4:7], a[40:43], a[8:11], v[4:7]
  v_mfma_f32_16x16x32_bf16 v[8:11], a[40:43], a[12:15], v[8:11]
  s_waitcnt vmcnt(7) lgkmcnt(0)
  s_barrier
  ds_read_b64_tr_b16 a[128:129], v116 offset:24576
  v_mfma_f32_16x16x32_bf16 v[8:11], a[64:67], a[32:35], v[8:11]
  ds_read_b64_tr_b16 a[130:131], v116 offset:30720
  v_mfma_f32_16x16x32_bf16 v[12:15], a[64:67], a[36:39], v[12:15]
  s_add_u32 m0, s62, 73728
  ds_read_b64_tr_b16 a[152:153], v116 offset:36864
  v_mfma_f32_16x16x32_bf16 v[12:15], a[40:43], a[16:19], v[12:15]
  buffer_load_dwordx4 v120, s[28:31], s68 offen offset:0 sc1  lds
  v_mfma_f32_16x16x32_bf16 v[28:31], a[44:47], a[16:19], v[28:31]
  ds_read_b64_tr_b16 a[154:155], v116 offset:43008
  v_mfma_f32_16x16x32_bf16 v[28:31], a[68:71], a[36:39], v[28:31]
  ds_read_b128 a[92:95], v112 offset:16384
  v_mfma_f32_16x16x32_bf16 v[24:27], a[68:71], a[32:35], v[24:27]
  ds_read_b128 a[112:115], v113 offset:16384
  v_mfma_f32_16x16x32_bf16 v[24:27], a[44:47], a[12:15], v[24:27]
  buffer_load_dwordx4 v121, s[28:31], s68 offen offset:1024 sc1  lds
  v_mfma_f32_16x16x32_bf16 v[20:23], a[44:47], a[8:11], v[20:23]
  ds_read_b128 a[96:99], v112 offset:18432
  v_mfma_f32_16x16x32_bf16 v[20:23], a[68:71], a[28:31], v[20:23]
  ds_read_b128 a[116:119], v113 offset:18432
  v_mfma_f32_16x16x32_bf16 v[16:19], a[68:71], a[24:27], v[16:19]
  ds_read_b128 a[100:103], v112 offset:20480
  v_mfma_f32_16x16x32_bf16 v[16:19], a[44:47], a[4:7], v[16:19]
  buffer_load_dwordx4 v122, s[28:31], s68 offen offset:2048 sc1  lds
  v_mfma_f32_16x16x32_bf16 v[96:99], a[48:51], a[0:3], v[96:99]
  ds_read_b128 a[120:123], v113 offset:20480
  v_mfma_f32_16x16x32_bf16 v[96:99], a[72:75], a[20:23], v[96:99]
  ds_read_b128 a[104:107], v112 offset:22528
  v_mfma_f32_16x16x32_bf16 v[32:35], a[72:75], a[24:27], v[32:35]
  ds_read_b128 a[124:127], v113 offset:22528
  v_mfma_f32_16x16x32_bf16 v[32:35], a[48:51], a[4:7], v[32:35]
  buffer_load_dwordx4 v123, s[28:31], s68 offen offset:3072 sc1  lds
  v_mfma_f32_16x16x32_bf16 v[36:39], a[48:51], a[8:11], v[36:39]
  ds_read_b64_tr_b16 a[132:133], v117 offset:24576
  v_mfma_f32_16x16x32_bf16 v[36:39], a[72:75], a[28:31], v[36:39]
  ds_read_b64_tr_b16 a[134:135], v117 offset:30720
  v_mfma_f32_16x16x32_bf16 v[40:43], a[72:75], a[32:35], v[40:43]
  s_add_u32 m0, s63, 0
  ds_read_b64_tr_b16 a[156:157], v117 offset:36864
  v_mfma_f32_16x16x32_bf16 v[40:43], a[48:51], a[12:15], v[40:43]
  buffer_load_dwordx4 v124, s[8:11], s69 offen offset:0  lds
  v_mfma_f32_16x16x32_bf16 v[44:47], a[48:51], a[16:19], v[44:47]
  s_add_u32 s44, s44, 1
  ds_read_b64_tr_b16 a[158:159], v117 offset:43008
  v_mfma_f32_16x16x32_bf16 v[44:47], a[72:75], a[36:39], v[44:47]
  s_and_b32 s44, s44, 15
  ds_read_b128 a[88:91], v114 offset:1024
  v_mfma_f32_16x16x32_bf16 v[60:63], a[76:79], a[36:39], v[60:63]
  s_add_u32 s66, s66, 1
  ds_read_b128 a[108:111], v115 offset:1024
  v_mfma_f32_16x16x32_bf16 v[60:63], a[52:55], a[16:19], v[60:63]
  s_mul_i32 s45, s44, s61
  buffer_load_dwordx4 v125, s[8:11], s69 offen offset:1024  lds
  v_mfma_f32_16x16x32_bf16 v[56:59], a[52:55], a[12:15], v[56:59]
  s_add_u32 s68, s45, s59
  ds_read_b64_tr_b16 a[136:137], v116 offset:26624
  v_mfma_f32_16x16x32_bf16 v[56:59], a[76:79], a[32:35], v[56:59]
  ds_read_b64_tr_b16 a[138:139], v116 offset:32768
  v_mfma_f32_16x16x32_bf16 v[52:55], a[76:79], a[28:31], v[52:55]
  ds_read_b64_tr_b16 a[160:161], v116 offset:38912
  v_mfma_f32_16x16x32_bf16 v[52:55], a[52:55], a[8:11], v[52:55]
  buffer_load_dwordx4 v124, s[8:11], s69 offen offset:2048  lds
  v_mfma_f32_16x16x32_bf16 v[48:51], a[52:55], a[4:7], v[48:51]
  ds_read_b64_tr_b16 a[162:163], v116 offset:45056
  v_mfma_f32_16x16x32_bf16 v[48:51], a[76:79], a[24:27], v[48:51]
  ds_read_b64_tr_b16 a[140:141], v117 offset:26624
  v_mfma_f32_16x16x32_bf16 v[100:103], a[20:23], a[80:83], v[100:103]
  ds_read_b64_tr_b16 a[142:143], v117 offset:32768
  v_mfma_f32_16x16x32_bf16 v[100:103], a[0:3], a[56:59], v[100:103]
  buffer_load_dwordx4 v125, s[8:11], s69 offen offset:3072  lds
  v_mfma_f32_16x16x32_bf16 v[64:67], a[4:7], a[56:59], v[64:67]
  ds_read_b64_tr_b16 a[164:165], v117 offset:38912
  v_mfma_f32_16x16x32_bf16 v[64:67], a[24:27], a[80:83], v[64:67]
  ds_read_b64_tr_b16 a[166:167], v117 offset:45056
  v_mfma_f32_16x16x32_bf16 v[68:71], a[28:31], a[80:83], v[68:71]
  s_add_u32 m0, s63, 4096
  ds_read_b64_tr_b16 a[144:145], v116 offset:28672
  v_mfma_f32_16x16x32_bf16 v[68:71], a[8:11], a[56:59], v[68:71]
  buffer_load_dwordx4 v124, s[8:11], s70 offen offset:0  lds
  v_mfma_f32_16x16x32_bf16 v[72:75], a[12:15], a[56:59], v[72:75]
  ds_read_b64_tr_b16 a[146:147], v116 offset:34816
  v_mfma_f32_16x16x32_bf16 v[72:75], a[32:35], a[80:83], v[72:75]
  ds_read_b64_tr_b16 a[168:169], v116 offset:40960
  v_mfma_f32_16x16x32_bf16 v[76:79], a[36:39], a[80:83], v[76:79]
  ds_read_b64_tr_b16 a[170:171], v116 offset:47104
  v_mfma_f32_16x16x32_bf16 v[76:79], a[16:19], a[56:59], v[76:79]
  buffer_load_dwordx4 v125, s[8:11], s70 offen offset:1024  lds
  v_mfma_f32_16x16x32_bf16 v[92:95], a[16:19], a[60:63], v[92:95]
  ds_read_b64_tr_b16 a[148:149], v117 offset:28672
  v_mfma_f32_16x16x32_bf16 v[92:95], a[36:39], a[84:87], v[92:95]
  ds_read_b64_tr_b16 a[150:151], v117 offset:34816
  v_mfma_f32_16x16x32_bf16 v[88:91], a[32:35], a[84:87], v[88:91]
  ds_read_b64_tr_b16 a[172:173], v117 offset:40960
  v_mfma_f32_16x16x32_bf16 v[88:91], a[12:15], a[60:63], v[88:91]
  ds_read_b64_tr_b16 a[174:175], v117 offset:47104
  v_mfma_f32_16x16x32_bf16 v[84:87], a[8:11], a[60:63], v[84:87]
  s_cmp_eq_u32 s66, s88
  s_cbranch_scc1 Lside_k0_c
Lside_k0_r:
  v_mfma_f32_16x16x32_bf16 v[84:87], a[28:31], a[84:87], v[84:87]
  v_mfma_f32_16x16x32_bf16 v[80:83], a[24:27], a[84:87], v[80:83]
  v_mfma_f32_16x16x32_bf16 v[80:83], a[4:7], a[60:63], v[80:83]
Lp1_u1:
  s_waitcnt lgkmcnt(15)
  v_mfma_f32_16x16x32_bf16 v[0:3], a[128:131], a[92:95], v[0:3]
  s_mul_i32 s45, s44, 393216
  v_mfma_f32_16x16x32_bf16 v[0:3], a[152:155], a[112:115], v[0:3]
  s_add_u32 s69, s45, s60
  v_mfma_f32_16x16x32_bf16 v[4:7], a[152:155], a[116:119], v[4:7]
  s_add_u32 s70, s69, 4096
  v_mfma_f32_16x16x32_bf16 v[4:7], a[128:131], a[96:99], v[4:7]
  v_mfma_f32_16x16x32_bf16 v[8:11], a[128:131], a[100:103], v[8:11]
  s_waitcnt vmcnt(10) lgkmcnt(0)
  s_barrier
  ds_read_b64_tr_b16 a[40:41], v118 offset:0
  v_mfma_f32_16x16x32_bf16 v[8:11], a[152:155], a[120:123], v[8:11]
  ds_read_b64_tr_b16 a[42:43], v118 offset:6144
  v_mfma_f32_16x16x32_bf16 v[12:15], a[152:155], a[124:127], v[12:15]
  s_add_u32 m0, s62, 90112
  ds_read_b64_tr_b16 a[64:65], v118 offset:12288
  v_mfma_f32_16x16x32_bf16 v[12:15], a[128:131], a[104:107], v[12:15]
  buffer_load_dwordx4 v120, s[28:31], s68 offen offset:0 sc1  lds
  v_mfma_f32_16x16x32_bf16 v[28:31], a[132:135], a[104:107], v[28:31]
  ds_read_b64_tr_b16 a[66:67], v118 offset:18432
  v_mfma_f32_16x16x32_bf16 v[28:31], a[156:159], a[124:127], v[28:31]
  ds_read_b128 a[4:7], v112 offset:32768
  v_mfma_f32_16x16x32_bf16 v[24:27], a[156:159], a[120:123], v[24:27]
  ds_read_b128 a[24:27], v113 offset:32768
  v_mfma_f32_16x16x32_bf16 v[24:27], a[132:135], a[100:103], v[24:27]
  buffer_load_dwordx4 v121, s[28:31], s68 offen offset:1024 sc1  lds
  v_mfma_f32_16x16x32_bf16 v[20:23], a[132:135], a[96:99], v[20:23]
  ds_read_b128 a[8:11], v112 offset:34816
  v_mfma_f32_16x16x32_bf16 v[20:23], a[156:159], a[116:119], v[20:23]
  ds_read_b128 a[28:31], v113 offset:34816
  v_mfma_f32_16x16x32_bf16 v[16:19], a[156:159], a[112:115], v[16:19]
  ds_read_b128 a[12:15], v112 offset:36864
  v_mfma_f32_16x16x32_bf16 v[16:19], a[132:135], a[92:95], v[16:19]
  buffer_load_dwordx4 v122, s[28:31], s68 offen offset:2048 sc1  lds
  v_mfma_f32_16x16x32_bf16 v[96:99], a[136:139], a[88:91], v[96:99]
  ds_read_b128 a[32:35], v113 offset:36864
  v_mfma_f32_16x16x32_bf16 v[96:99], a[160:163], a[108:111], v[96:99]
  ds_read_b128 a[16:19], v112 offset:38912
  v_mfma_f32_16x16x32_bf16 v[32:35], a[160:163], a[112:115], v[32:35]
  ds_read_b128 a[36:39], v113 offset:38912
  v_mfma_f32_16x16x32_bf16 v[32:35], a[136:139], a[92:95], v[32:35]
  buffer_load_dwordx4 v123, s[28:31], s68 offen offset:3072 sc1  lds
  v_mfma_f32_16x16x32_bf16 v[36:39], a[136:139], a[96:99], v[36:39]
  ds_read_b64_tr_b16 a[44:45], v119 offset:0
  v_mfma_f32_16x16x32_bf16 v[36:39], a[160:163], a[116:119], v[36:39]
  ds_read_b64_tr_b16 a[46:47], v119 offset:6144
  v_mfma_f32_16x16x32_bf16 v[40:43], a[160:163], a[120:123], v[40:43]
  s_add_u32 m0, s63, 24576
  ds_read_b64_tr_b16 a[68:69], v119 offset:12288
  v_mfma_f32_16x16x32_bf16 v[40:43], a[136:139], a[100:103], v[40:43]
  buffer_load_dwordx4 v124, s[8:11], s69 offen offset:0  lds
  v_mfma_f32_16x16x32_bf16 v[44:47], a[136:139], a[104:107], v[44:47]
  s_add_u32 s44, s44, 1
  ds_read_b64_tr_b16 a[70:71], v119 offset:18432
  v_mfma_f32_16x16x32_bf16 v[44:47], a[160:163], a[124:127], v[44:47]
  s_and_b32 s44, s44, 15
  ds_read_b128 a[0:3], v114 offset:2048
  v_mfma_f32_16x16x32_bf16 v[60:63], a[164:167], a[124:127], v[60:63]
  s_add_u32 s66, s66, 1
  ds_read_b128 a[20:23], v115 offset:2048
  v_mfma_f32_16x16x32_bf16 v[60:63], a[140:143], a[104:107], v[60:63]
  s_mul_i32 s45, s44, s61
  buffer_load_dwordx4 v125, s[8:11], s69 offen offset:1024  lds
  v_mfma_f32_16x16x32_bf16 v[56:59], a[140:143], a[100:103], v[56:59]
  s_add_u32 s68, s45, s59
  ds_read_b64_tr_b16 a[48:49], v118 offset:2048
  v_mfma_f32_16x16x32_bf16 v[56:59], a[164:167], a[120:123], v[56:59]
  ds_read_b64_tr_b16 a[50:51], v118 offset:8192
  v_mfma_f32_16x16x32_bf16 v[52:55], a[164:167], a[116:119], v[52:55]
  ds_read_b64_tr_b16 a[72:73], v118 offset:14336
  v_mfma_f32_16x16x32_bf16 v[52:55], a[140:143], a[96:99], v[52:55]
  buffer_load_dwordx4 v124, s[8:11], s69 offen offset:2048  lds
  v_mfma_f32_16x16x32_bf16 v[48:51], a[140:143], a[92:95], v[48:51]
  ds_read_b64_tr_b16 a[74:75], v118 offset:20480
  v_mfma_f32_16x16x32_bf16 v[48:51], a[164:167], a[112:115], v[48:51]
  ds_read_b64_tr_b16 a[52:53], v119 offset:2048
  v_mfma_f32_16x16x32_bf16 v[100:103], a[108:111], a[168:171], v[100:103]
  ds_read_b64_tr_b16 a[54:55], v119 offset:8192
  v_mfma_f32_16x16x32_bf16 v[100:103], a[88:91], a[144:147], v[100:103]
  buffer_load_dwordx4 v125, s[8:11], s69 offen offset:3072  lds
  v_mfma_f32_16x16x32_bf16 v[64:67], a[92:95], a[144:147], v[64:67]
  ds_read_b64_tr_b16 a[76:77], v119 offset:14336
  v_mfma_f32_16x16x32_bf16 v[64:67], a[112:115], a[168:171], v[64:67]
  ds_read_b64_tr_b16 a[78:79], v119 offset:20480
  v_mfma_f32_16x16x32_bf16 v[68:71], a[116:119], a[168:171], v[68:71]
  s_add_u32 m0, s63, 28672
  ds_read_b64_tr_b16 a[56:57], v118 offset:4096
  v_mfma_f32_16x16x32_bf16 v[68:71], a[96:99], a[144:147], v[68:71]
  buffer_load_dwordx4 v124, s[8:11], s70 offen offset:0  lds
  v_mfma_f32_16x16x32_bf16 v[72:75], a[100:103], a[144:147], v[72:75]
  ds_read_b64_tr_b16 a[58:59], v118 offset:10240
  v_mfma_f32_16x16x32_bf16 v[72:75], a[120:123], a[168:171], v[72:75]
  ds_read_b64_tr_b16 a[80:81], v118 offset:16384
  v_mfma_f32_16x16x32_bf16 v[76:79], a[124:127], a[168:171], v[76:79]
  ds_read_b64_tr_b16 a[82:83], v118 offset:22528
  v_mfma_f32_16x16x32_bf16 v[76:79], a[104:107], a[144:147], v[76:79]
  buffer_load_dwordx4 v125, s[8:11], s70 offen offset:1024  lds
  v_mfma_f32_16x16x32_bf16 v[92:95], a[104:107], a[148:151], v[92:95]
  ds_read_b64_tr_b16 a[60:61], v119 offset:4096
  v_mfma_f32_16x16x32_bf16 v[92:95], a[124:127], a[172:175], v[92:95]
  ds_read_b64_tr_b16 a[62:63], v119 offset:10240
  v_mfma_f32_16x16x32_bf16 v[88:91], a[120:123], a[172:175], v[88:91]
  ds_read_b64_tr_b16 a[84:85], v119 offset:16384
  v_mfma_f32_16x16x32_bf16 v[88:91], a[100:103], a[148:151], v[88:91]
  ds_read_b64_tr_b16 a[86:87], v119 offset:22528
  v_mfma_f32_16x16x32_bf16 v[84:87], a[96:99], a[148:151], v[84:87]
  s_cmp_eq_u32 s66, s88
  s_cbranch_scc1 Lside_k1_c
Lside_k1_r:
  v_mfma_f32_16x16x32_bf16 v[84:87], a[116:119], a[172:175], v[84:87]
  v_mfma_f32_16x16x32_bf16 v[80:83], a[112:115], a[172:175], v[80:83]
  v_mfma_f32_16x16x32_bf16 v[80:83], a[92:95], a[148:151], v[80:83]
  s_waitcnt lgkmcnt(15)
  v_mfma_f32_16x16x32_bf16 v[0:3], a[40:43], a[4:7], v[0:3]
  s_mul_i32 s45, s44, 393216
  v_mfma_f32_16x16x32_bf16 v[0:3], a[64:67], a[24:27], v[0:3]
  s_add_u32 s69, s45, s60
  v_mfma_f32_16x16x32_bf16 v[4:7], a[64:67], a[28:31], v[4:7]
  s_add_u32 s70, s69, 4096
  v_mfma_f32_16x16x32_bf16 v[4:7], a[40:43], a[8:11], v[4:7]
  v_mfma_f32_16x16x32_bf16 v[8:11], a[40:43], a[12:15], v[8:11]
  s_waitcnt vmcnt(10) lgkmcnt(0)
  s_barrier
  ds_read_b64_tr_b16 a[128:129], v116 offset:0
  v_mfma_f32_16x16x32_bf16 v[8:11], a[64:67], a[32:35], v[8:11]
  ds_read_b64_tr_b16 a[130:131], v116 offset:6144
  v_mfma_f32_16x16x32_bf16 v[12:15], a[64:67], a[36:39], v[12:15]
  s_add_u32 m0, s62, 106496
  ds_read_b64_tr_b16 a[152:153], v116 offset:12288
  v_mfma_f32_16x16x32_bf16 v[12:15], a[40:43], a[16:19], v[12:15]
  buffer_load_dwordx4 v120, s[28:31], s68 offen offset:0 sc1  lds
  v_mfma_f32_16x16x32_bf16 v[28:31], a[44:47], a[16:19], v[28:31]
  ds_read_b64_tr_b16 a[154:155], v116 offset:18432
  v_mfma_f32_16x16x32_bf16 v[28:31], a[68:71], a[36:39], v[28:31]
  ds_read_b128 a[92:95], v112 offset:0
  v_mfma_f32_16x16x32_bf16 v[24:27], a[68:71], a[32:35], v[24:27]
  ds_read_b128 a[112:115], v113 offset:0
  v_mfma_f32_16x16x32_bf16 v[24:27], a[44:47], a[12:15], v[24:27]
  buffer_load_dwordx4 v121, s[28:31], s68 offen offset:1024 sc1  lds
  v_mfma_f32_16x16x32_bf16 v[20:23], a[44:47], a[8:11], v[20:23]
  ds_read_b128 a[96:99], v112 offset:2048
  v_mfma_f32_16x16x32_bf16 v[20:23], a[68:71], a[28:31], v[20:23]
  ds_read_b128 a[116:119], v113 offset:2048
  v_mfma_f32_16x16x32_bf16 v[16:19], a[68:71], a[24:27], v[16:19]
  ds_read_b128 a[100:103], v112 offset:4096
  v_mfma_f32_16x16x32_bf16 v[16:19], a[44:47], a[4:7], v[16:19]
  buffer_load_dwordx4 v122, s[28:31], s68 offen offset:2048 sc1  lds
  v_mfma_f32_16x16x32_bf16 v[96:99], a[48:51], a[0:3], v[96:99]
  ds_read_b128 a[120:123], v113 offset:4096
  v_mfma_f32_16x16x32_bf16 v[96:99], a[72:75], a[20:23], v[96:99]
  ds_read_b128 a[104:107], v112 offset:6144
  v_mfma_f32_16x16x32_bf16 v[32:35], a[72:75], a[24:27], v[32:35]
  ds_read_b128 a[124:127], v113 offset:6144
  v_mfma_f32_16x16x32_bf16 v[32:35], a[48:51], a[4:7], v[32:35]
  buffer_load_dwordx4 v123, s[28:31], s68 offen offset:3072 sc1  lds
  v_mfma_f32_16x16x32_bf16 v[36:39], a[48:51], a[8:11], v[36:39]
  ds_read_b64_tr_b16 a[132:133], v117 offset:0
  v_mfma_f32_16x16x32_bf16 v[36:39], a[72:75], a[28:31], v[36:39]
  ds_read_b64_tr_b16 a[134:135], v117 offset:6144
  v_mfma_f32_16x16x32_bf16 v[40:43], a[72:75], a[32:35], v[40:43]
  s_add_u32 m0, s63, 49152
  ds_read_b64_tr_b16 a[156:157], v117 offset:12288
  v_mfma_f32_16x16x32_bf16 v[40:43], a[48:51], a[12:15], v[40:43]
  buffer_load_dwordx4 v124, s[8:11], s69 offen offset:0  lds
  v_mfma_f32_16x16x32_bf16 v[44:47], a[48:51], a[16:19], v[44:47]
  s_add_u32 s44, s44, 1
  ds_read_b64_tr_b16 a[158:159], v117 offset:18432
  v_mfma_f32_16x16x32_bf16 v[44:47], a[72:75], a[36:39], v[44:47]
  s_and_b32 s44, s44, 15
  ds_read_b128 a[88:91], v114 offset:3072
  v_mfma_f32_16x16x32_bf16 v[60:63], a[76:79], a[36:39], v[60:63]
  s_add_u32 s66, s66, 1
  ds_read_b128 a[108:111], v115 offset:3072
  v_mfma_f32_16x16x32_bf16 v[60:63], a[52:55], a[16:19], v[60:63]
  s_mul_i32 s45, s44, s61
  buffer_load_dwordx4 v125, s[8:11], s69 offen offset:1024  lds
  v_mfma_f32_16x16x32_bf16 v[56:59], a[52:55], a[12:15], v[56:59]
  s_add_u32 s68, s45, s59
  ds_read_b64_tr_b16 a[136:137], v116 offset:2048
  v_mfma_f32_16x16x32_bf16 v[56:59], a[76:79], a[32:35], v[56:59]
  ds_read_b64_tr_b16 a[138:139], v116 offset:8192
  v_mfma_f32_16x16x32_bf16 v[52:55], a[76:79], a[28:31], v[52:55]
  ds_read_b64_tr_b16 a[160:161], v116 offset:14336
  v_mfma_f32_16x16x32_bf16 v[52:55], a[52:55], a[8:11], v[52:55]
  buffer_load_dwordx4 v124, s[8:11], s69 offen offset:2048  lds
  v_mfma_f32_16x16x32_bf16 v[48:51], a[52:55], a[4:7], v[48:51]
  ds_read_b64_tr_b16 a[162:163], v116 offset:20480
  v_mfma_f32_16x16x32_bf16 v[48:51], a[76:79], a[24:27], v[48:51]
  ds_read_b64_tr_b16 a[140:141], v117 offset:2048
  v_mfma_f32_16x16x32_bf16 v[100:103], a[20:23], a[80:83], v[100:103]
  ds_read_b64_tr_b16 a[142:143], v117 offset:8192
  v_mfma_f32_16x16x32_bf16 v[100:103], a[0:3], a[56:59], v[100:103]
  buffer_load_dwordx4 v125, s[8:11], s69 offen offset:3072  lds
  v_mfma_f32_16x16x32_bf16 v[64:67], a[4:7], a[56:59], v[64:67]
  ds_read_b64_tr_b16 a[164:165], v117 offset:14336
  v_mfma_f32_16x16x32_bf16 v[64:67], a[24:27], a[80:83], v[64:67]
  ds_read_b64_tr_b16 a[166:167], v117 offset:20480
  v_mfma_f32_16x16x32_bf16 v[68:71], a[28:31], a[80:83], v[68:71]
  s_add_u32 m0, s63, 53248
  ds_read_b64_tr_b16 a[144:145], v116 offset:4096
  v_mfma_f32_16x16x32_bf16 v[68:71], a[8:11], a[56:59], v[68:71]
  buffer_load_dwordx4 v124, s[8:11], s70 offen offset:0  lds
  v_mfma_f32_16x16x32_bf16 v[72:75], a[12:15], a[56:59], v[72:75]
  ds_read_b64_tr_b16 a[146:147], v116 offset:10240
  v_mfma_f32_16x16x32_bf16 v[72:75], a[32:35], a[80:83], v[72:75]
  ds_read_b64_tr_b16 a[168:169], v116 offset:16384
  v_mfma_f32_16x16x32_bf16 v[76:79], a[36:39], a[80:83], v[76:79]
  ds_read_b64_tr_b16 a[170:171], v116 offset:22528
  v_mfma_f32_16x16x32_bf16 v[76:79], a[16:19], a[56:59], v[76:79]
  buffer_load_dwordx4 v125, s[8:11], s70 offen offset:1024  lds
  v_mfma_f32_16x16x32_bf16 v[92:95], a[16:19], a[60:63], v[92:95]
  ds_read_b64_tr_b16 a[148:149], v117 offset:4096
  v_mfma_f32_16x16x32_bf16 v[92:95], a[36:39], a[84:87], v[92:95]
  ds_read_b64_tr_b16 a[150:151], v117 offset:10240
  v_mfma_f32_16x16x32_bf16 v[88:91], a[32:35], a[84:87], v[88:91]
  ds_read_b64_tr_b16 a[172:173], v117 offset:16384
  v_mfma_f32_16x16x32_bf16 v[88:91], a[12:15], a[60:63], v[88:91]
  ds_read_b64_tr_b16 a[174:175], v117 offset:22528
  v_mfma_f32_16x16x32_bf16 v[84:87], a[8:11], a[60:63], v[84:87]
  s_cmp_eq_u32 s66, s88
  s_cbranch_scc1 Lside_k2_c
Lside_k2_r:
  v_mfma_f32_16x16x32_bf16 v[84:87], a[28:31], a[84:87], v[84:87]
  v_mfma_f32_16x16x32_bf16 v[80:83], a[24:27], a[84:87], v[80:83]
  v_mfma_f32_16x16x32_bf16 v[80:83], a[4:7], a[60:63], v[80:83]
  s_waitcnt lgkmcnt(15)
  v_mfma_f32_16x16x32_bf16 v[0:3], a[128:131], a[92:95], v[0:3]
  s_mul_i32 s45, s44, 393216
  v_mfma_f32_16x16x32_bf16 v[0:3], a[152:155], a[112:115], v[0:3]
  s_add_u32 s69, s45, s60
  v_mfma_f32_16x16x32_bf16 v[4:7], a[152:155], a[116:119], v[4:7]
  s_add_u32 s70, s69, 4096
  v_mfma_f32_16x16x32_bf16 v[4:7], a[128:131], a[96:99], v[4:7]
  v_mfma_f32_16x16x32_bf16 v[8:11], a[128:131], a[100:103], v[8:11]
  s_waitcnt vmcnt(10) lgkmcnt(0)
  s_barrier
  ds_read_b64_tr_b16 a[40:41], v116 offset:24576
  v_mfma_f32_16x16x32_bf16 v[8:11], a[152:155], a[120:123], v[8:11]
  ds_read_b64_tr_b16 a[42:43], v116 offset:30720
  v_mfma_f32_16x16x32_bf16 v[12:15], a[152:155], a[124:127], v[12:15]
  s_add_u32 m0, s62, 73728
  ds_read_b64_tr_b16 a[64:65], v116 offset:36864
  v_mfma_f32_16x16x32_bf16 v[12:15], a[128:131], a[104:107], v[12:15]
  buffer_load_dwordx4 v120, s[28:31], s68 offen offset:0 sc1  lds
  v_mfma_f32_16x16x32_bf16 v[28:31], a[132:135], a[104:107], v[28:31]
  ds_read_b64_tr_b16 a[66:67], v116 offset:43008
  v_mfma_f32_16x16x32_bf16 v[28:31], a[156:159], a[124:127], v[28:31]
  ds_read_b128 a[4:7], v112 offset:16384
  v_mfma_f32_16x16x32_bf16 v[24:27], a[156:159], a[120:123], v[24:27]
  ds_read_b128 a[24:27], v113 offset:16384
  v_mfma_f32_16x16x32_bf16 v[24:27], a[132:135], a[100:103], v[24:27]
  buffer_load_dwordx4 v121, s[28:31], s68 offen offset:1024 sc1  lds
  v_mfma_f32_16x16x32_bf16 v[20:23], a[132:135], a[96:99], v[20:23]
  ds_read_b128 a[8:11], v112 offset:18432
  v_mfma_f32_16x16x32_bf16 v[20:23], a[156:159], a[116:119], v[20:23]
  ds_read_b128 a[28:31], v113 offset:18432
  v_mfma_f32_16x16x32_bf16 v[16:19], a[156:159], a[112:115], v[16:19]
  ds_read_b128 a[12:15], v112 offset:20480
  v_mfma_f32_16x16x32_bf16 v[16:19], a[132:135], a[92:95], v[16:19]
  buffer_load_dwordx4 v122, s[28:31], s68 offen offset:2048 sc1  lds
  v_mfma_f32_16x16x32_bf16 v[96:99], a[136:139], a[88:91], v[96:99]
  ds_read_b128 a[32:35], v113 offset:20480
  v_mfma_f32_16x16x32_bf16 v[96:99], a[160:163], a[108:111], v[96:99]
  ds_read_b128 a[16:19], v112 offset:22528
  v_mfma_f32_16x16x32_bf16 v[32:35], a[160:163], a[112:115], v[32:35]
  ds_read_b128 a[36:39], v113 offset:22528
  v_mfma_f32_16x16x32_bf16 v[32:35], a[136:139], a[92:95], v[32:35]
  buffer_load_dwordx4 v123, s[28:31], s68 offen offset:3072 sc1  lds
  v_mfma_f32_16x16x32_bf16 v[36:39], a[136:139], a[96:99], v[36:39]
  ds_read_b64_tr_b16 a[44:45], v117 offset:24576
  v_mfma_f32_16x16x32_bf16 v[36:39], a[160:163], a[116:119], v[36:39]
  ds_read_b64_tr_b16 a[46:47], v117 offset:30720
  v_mfma_f32_16x16x32_bf16 v[40:43], a[160:163], a[120:123], v[40:43]
  s_add_u32 m0, s63, 0
  ds_read_b64_tr_b16 a[68:69], v117 offset:36864
  v_mfma_f32_16x16x32_bf16 v[40:43], a[136:139], a[100:103], v[40:43]
  buffer_load_dwordx4 v124, s[8:11], s69 offen offset:0  lds
  v_mfma_f32_16x16x32_bf16 v[44:47], a[136:139], a[104:107], v[44:47]
  s_add_u32 s44, s44, 1
  ds_read_b64_tr_b16 a[70:71], v117 offset:43008
  v_mfma_f32_16x16x32_bf16 v[44:47], a[160:163], a[124:127], v[44:47]
  s_and_b32 s44, s44, 15
  ds_read_b128 a[0:3], v114 offset:4096
  v_mfma_f32_16x16x32_bf16 v[60:63], a[164:167], a[124:127], v[60:63]
  s_add_u32 s66, s66, 1
  ds_read_b128 a[20:23], v115 offset:4096
  v_mfma_f32_16x16x32_bf16 v[60:63], a[140:143], a[104:107], v[60:63]
  s_mul_i32 s45, s44, s61
  buffer_load_dwordx4 v125, s[8:11], s69 offen offset:1024  lds
  v_mfma_f32_16x16x32_bf16 v[56:59], a[140:143], a[100:103], v[56:59]
  s_add_u32 s68, s45, s59
  ds_read_b64_tr_b16 a[48:49], v116 offset:26624
  v_mfma_f32_16x16x32_bf16 v[56:59], a[164:167], a[120:123], v[56:59]
  ds_read_b64_tr_b16 a[50:51], v116 offset:32768
  v_mfma_f32_16x16x32_bf16 v[52:55], a[164:167], a[116:119], v[52:55]
  ds_read_b64_tr_b16 a[72:73], v116 offset:38912
  v_mfma_f32_16x16x32_bf16 v[52:55], a[140:143], a[96:99], v[52:55]
  buffer_load_dwordx4 v124, s[8:11], s69 offen offset:2048  lds
  v_mfma_f32_16x16x32_bf16 v[48:51], a[140:143], a[92:95], v[48:51]
  ds_read_b64_tr_b16 a[74:75], v116 offset:45056
  v_mfma_f32_16x16x32_bf16 v[48:51], a[164:167], a[112:115], v[48:51]
  ds_read_b64_tr_b16 a[52:53], v117 offset:26624
  v_mfma_f32_16x16x32_bf16 v[100:103], a[108:111], a[168:171], v[100:103]
  ds_read_b64_tr_b16 a[54:55], v117 offset:32768
  v_mfma_f32_16x16x32_bf16 v[100:103], a[88:91], a[144:147], v[100:103]
  buffer_load_dwordx4 v125, s[8:11], s69 offen offset:3072  lds
  v_mfma_f32_16x16x32_bf16 v[64:67], a[92:95], a[144:147], v[64:67]
  ds_read_b64_tr_b16 a[76:77], v117 offset:38912
  v_mfma_f32_16x16x32_bf16 v[64:67], a[112:115], a[168:171], v[64:67]
  ds_read_b64_tr_b16 a[78:79], v117 offset:45056
  v_mfma_f32_16x16x32_bf16 v[68:71], a[116:119], a[168:171], v[68:71]
  s_add_u32 m0, s63, 4096
  ds_read_b64_tr_b16 a[56:57], v116 offset:28672
  v_mfma_f32_16x16x32_bf16 v[68:71], a[96:99], a[144:147], v[68:71]
  buffer_load_dwordx4 v124, s[8:11], s70 offen offset:0  lds
  v_mfma_f32_16x16x32_bf16 v[72:75], a[100:103], a[144:147], v[72:75]
  ds_read_b64_tr_b16 a[58:59], v116 offset:34816
  v_mfma_f32_16x16x32_bf16 v[72:75], a[120:123], a[168:171], v[72:75]
  ds_read_b64_tr_b16 a[80:81], v116 offset:40960
  v_mfma_f32_16x16x32_bf16 v[76:79], a[124:127], a[168:171], v[76:79]
  ds_read_b64_tr_b16 a[82:83], v116 offset:47104
  v_mfma_f32_16x16x32_bf16 v[76:79], a[104:107], a[144:147], v[76:79]
  buffer_load_dwordx4 v125, s[8:11], s70 offen offset:1024  lds
  v_mfma_f32_16x16x32_bf16 v[92:95], a[104:107], a[148:151], v[92:95]
  ds_read_b64_tr_b16 a[60:61], v117 offset:28672
  v_mfma_f32_16x16x32_bf16 v[92:95], a[124:127], a[172:175], v[92:95]
  ds_read_b64_tr_b16 a[62:63], v117 offset:34816
  v_mfma_f32_16x16x32_bf16 v[88:91], a[120:123], a[172:175], v[88:91]
  ds_read_b64_tr_b16 a[84:85], v117 offset:40960
  v_mfma_f32_16x16x32_bf16 v[88:91], a[100:103], a[148:151], v[88:91]
  ds_read_b64_tr_b16 a[86:87], v117 offset:47104
  v_mfma_f32_16x16x32_bf16 v[84:87], a[96:99], a[148:151], v[84:87]
  s_cmp_eq_u32 s66, s88
  s_cbranch_scc1 Lside_k3_c
Lside_k3_r:
  v_mfma_f32_16x16x32_bf16 v[84:87], a[116:119], a[172:175], v[84:87]
  v_mfma_f32_16x16x32_bf16 v[80:83], a[112:115], a[172:175], v[80:83]
  v_mfma_f32_16x16x32_bf16 v[80:83], a[92:95], a[148:151], v[80:83]
  s_waitcnt lgkmcnt(15)
  v_mfma_f32_16x16x32_bf16 v[0:3], a[40:43], a[4:7], v[0:3]
  s_mul_i32 s45, s44, 393216
  v_mfma_f32_16x16x32_bf16 v[0:3], a[64:67], a[24:27], v[0:3]
  s_add_u32 s69, s45, s60
  v_mfma_f32_16x16x32_bf16 v[4:7], a[64:67], a[28:31], v[4:7]
  s_add_u32 s70, s69, 4096
  v_mfma_f32_16x16x32_bf16 v[4:7], a[40:43], a[8:11], v[4:7]
  v_mfma_f32_16x16x32_bf16 v[8:11], a[40:43], a[12:15], v[8:11]
  s_waitcnt vmcnt(10) lgkmcnt(0)
  s_barrier
  ds_read_b64_tr_b16 a[128:129], v118 offset:0
  v_mfma_f32_16x16x32_bf16 v[8:11], a[64:67], a[32:35], v[8:11]
  ds_read_b64_tr_b16 a[130:131], v118 offset:6144
  v_mfma_f32_16x16x32_bf16 v[12:15], a[64:67], a[36:39], v[12:15]
  s_add_u32 m0, s62, 90112
  ds_read_b64_tr_b16 a[152:153], v118 offset:12288
  v_mfma_f32_16x16x32_bf16 v[12:15], a[40:43], a[16:19], v[12:15]
  buffer_load_dwordx4 v120, s[28:31], s68 offen offset:0 sc1  lds
  v_mfma_f32_16x16x32_bf16 v[28:31], a[44:47], a[16:19], v[28:31]
  ds_read_b64_tr_b16 a[154:155], v118 offset:18432
  v_mfma_f32_16x16x32_bf16 v[28:31], a[68:71], a[36:39], v[28:31]
  ds_read_b128 a[92:95], v112 offset:32768
  v_mfma_f32_16x16x32_bf16 v[24:27], a[68:71], a[32:35], v[24:27]
  ds_read_b128 a[112:115], v113 offset:32768
  v_mfma_f32_16x16x32_bf16 v[24:27], a[44:47], a[12:15], v[24:27]
  buffer_load_dwordx4 v121, s[28:31], s68 offen offset:1024 sc1  lds
  v_mfma_f32_16x16x32_bf16 v[20:23], a[44:47], a[8:11], v[20:23]
  ds_read_b128 a[96:99], v112 offset:34816
  v_mfma_f32_16x16x32_bf16 v[20:23], a[68:71], a[28:31], v[20:23]
  ds_read_b128 a[116:119], v113 offset:34816
  v_mfma_f32_16x16x32_bf16 v[16:19], a[68:71], a[24:27], v[16:19]
  ds_read_b128 a[100:103], v112 offset:36864
  v_mfma_f32_16x16x32_bf16 v[16:19], a[44:47], a[4:7], v[16:19]
  buffer_load_dwordx4 v122, s[28:31], s68 offen offset:2048 sc1  lds
  v_mfma_f32_16x16x32_bf16 v[96:99], a[48:51], a[0:3], v[96:99]
  ds_read_b128 a[120:123], v113 offset:36864
  v_mfma_f32_16x16x32_bf16 v[96:99], a[72:75], a[20:23], v[96:99]
  ds_read_b128 a[104:107], v112 offset:38912
  v_mfma_f32_16x16x32_bf16 v[32:35], a[72:75], a[24:27], v[32:35]
  ds_read_b128 a[124:127], v113 offset:38912
  v_mfma_f32_16x16x32_bf16 v[32:35], a[48:51], a[4:7], v[32:35]
  buffer_load_dwordx4 v123, s[28:31], s68 offen offset:3072 sc1  lds
  v_mfma_f32_16x16x32_bf16 v[36:39], a[48:51], a[8:11], v[36:39]
  ds_read_b64_tr_b16 a[132:133], v119 offset:0
  v_mfma_f32_16x16x32_bf16 v[36:39], a[72:75], a[28:31], v[36:39]
  ds_read_b64_tr_b16 a[134:135], v119 offset:6144
  v_mfma_f32_16x16x32_bf16 v[40:43], a[72:75], a[32:35], v[40:43]
  s_add_u32 m0, s63, 24576
  ds_read_b64_tr_b16 a[156:157], v119 offset:12288
  v_mfma_f32_16x16x32_bf16 v[40:43], a[48:51], a[12:15], v[40:43]
  buffer_load_dwordx4 v124, s[8:11], s69 offen offset:0  lds
  v_mfma_f32_16x16x32_bf16 v[44:47], a[48:51], a[16:19], v[44:47]
  s_add_u32 s44, s44, 1
  ds_read_b64_tr_b16 a[158:159], v119 offset:18432
  v_mfma_f32_16x16x32_bf16 v[44:47], a[72:75], a[36:39], v[44:47]
  s_and_b32 s44, s44, 15
  ds_read_b128 a[88:91], v114 offset:5120
  v_mfma_f32_16x16x32_bf16 v[60:63], a[76:79], a[36:39], v[60:63]
  s_add_u32 s66, s66, 1
  ds_read_b128 a[108:111], v115 offset:5120
  v_mfma_f32_16x16x32_bf16 v[60:63], a[52:55], a[16:19], v[60:63]
  s_mul_i32 s45, s44, s61
  buffer_load_dwordx4 v125, s[8:11], s69 offen offset:1024  lds
  v_mfma_f32_16x16x32_bf16 v[56:59], a[52:55], a[12:15], v[56:59]
  s_add_u32 s68, s45, s59
  ds_read_b64_tr_b16 a[136:137], v118 offset:2048
  v_mfma_f32_16x16x32_bf16 v[56:59], a[76:79], a[32:35], v[56:59]
  ds_read_b64_tr_b16 a[138:139], v118 offset:8192
  v_mfma_f32_16x16x32_bf16 v[52:55], a[76:79], a[28:31], v[52:55]
  ds_read_b64_tr_b16 a[160:161], v118 offset:14336
  v_mfma_f32_16x16x32_bf16 v[52:55], a[52:55], a[8:11], v[52:55]
  buffer_load_dwordx4 v124, s[8:11], s69 offen offset:2048  lds
  v_mfma_f32_16x16x32_bf16 v[48:51], a[52:55], a[4:7], v[48:51]
  ds_read_b64_tr_b16 a[162:163], v118 offset:20480
  v_mfma_f32_16x16x32_bf16 v[48:51], a[76:79], a[24:27], v[48:51]
  ds_read_b64_tr_b16 a[140:141], v119 offset:2048
  v_mfma_f32_16x16x32_bf16 v[100:103], a[20:23], a[80:83], v[100:103]
  ds_read_b64_tr_b16 a[142:143], v119 offset:8192
  v_mfma_f32_16x16x32_bf16 v[100:103], a[0:3], a[56:59], v[100:103]
  buffer_load_dwordx4 v125, s[8:11], s69 offen offset:3072  lds
  v_mfma_f32_16x16x32_bf16 v[64:67], a[4:7], a[56:59], v[64:67]
  ds_read_b64_tr_b16 a[164:165], v119 offset:14336
  v_mfma_f32_16x16x32_bf16 v[64:67], a[24:27], a[80:83], v[64:67]
  ds_read_b64_tr_b16 a[166:167], v119 offset:20480
  v_mfma_f32_16x16x32_bf16 v[68:71], a[28:31], a[80:83], v[68:71]
  s_add_u32 m0, s63, 28672
  ds_read_b64_tr_b16 a[144:145], v118 offset:4096
  v_mfma_f32_16x16x32_bf16 v[68:71], a[8:11], a[56:59], v[68:71]
  buffer_load_dwordx4 v124, s[8:11], s70 offen offset:0  lds
  v_mfma_f32_16x16x32_bf16 v[72:75], a[12:15], a[56:59], v[72:75]
  ds_read_b64_tr_b16 a[146:147], v118 offset:10240
  v_mfma_f32_16x16x32_bf16 v[72:75], a[32:35], a[80:83], v[72:75]
  ds_read_b64_tr_b16 a[168:169], v118 offset:16384
  v_mfma_f32_16x16x32_bf16 v[76:79], a[36:39], a[80:83], v[76:79]
  ds_read_b64_tr_b16 a[170:171], v118 offset:22528
  v_mfma_f32_16x16x32_bf16 v[76:79], a[16:19], a[56:59], v[76:79]
  buffer_load_dwordx4 v125, s[8:11], s70 offen offset:1024  lds
  v_mfma_f32_16x16x32_bf16 v[92:95], a[16:19], a[60:63], v[92:95]
  ds_read_b64_tr_b16 a[148:149], v119 offset:4096
  v_mfma_f32_16x16x32_bf16 v[92:95], a[36:39], a[84:87], v[92:95]
  ds_read_b64_tr_b16 a[150:151], v119 offset:10240
  v_mfma_f32_16x16x32_bf16 v[88:91], a[32:35], a[84:87], v[88:91]
  ds_read_b64_tr_b16 a[172:173], v119 offset:16384
  v_mfma_f32_16x16x32_bf16 v[88:91], a[12:15], a[60:63], v[88:91]
  ds_read_b64_tr_b16 a[174:175], v119 offset:22528
  v_mfma_f32_16x16x32_bf16 v[84:87], a[8:11], a[60:63], v[84:87]
  s_cmp_eq_u32 s66, s88
  s_cbranch_scc1 Lside_k4_c
Lside_k4_r:
  v_mfma_f32_16x16x32_bf16 v[84:87], a[28:31], a[84:87], v[84:87]
  v_mfma_f32_16x16x32_bf16 v[80:83], a[24:27], a[84:87], v[80:83]
  v_mfma_f32_16x16x32_bf16 v[80:83], a[4:7], a[60:63], v[80:83]
  s_waitcnt lgkmcnt(15)
  v_mfma_f32_16x16x32_bf16 v[0:3], a[128:131], a[92:95], v[0:3]
  s_mul_i32 s45, s44, 393216
  v_mfma_f32_16x16x32_bf16 v[0:3], a[152:155], a[112:115], v[0:3]
  s_add_u32 s69, s45, s60
  v_mfma_f32_16x16x32_bf16 v[4:7], a[152:155], a[116:119], v[4:7]
  s_add_u32 s70, s69, 4096
  v_mfma_f32_16x16x32_bf16 v[4:7], a[128:131], a[96:99], v[4:7]
  v_mfma_f32_16x16x32_bf16 v[8:11], a[128:131], a[100:103], v[8:11]
  s_waitcnt vmcnt(10) lgkmcnt(0)
  s_barrier
  ds_read_b64_tr_b16 a[40:41], v116 offset:0
  v_mfma_f32_16x16x32_bf16 v[8:11], a[152:155], a[120:123], v[8:11]
  ds_read_b64_tr_b16 a[42:43], v116 offset:6144
  v_mfma_f32_16x16x32_bf16 v[12:15], a[152:155], a[124:127], v[12:15]
  s_add_u32 m0, s62, 106496
  ds_read_b64_tr_b16 a[64:65], v116 offset:12288
  v_mfma_f32_16x16x32_bf16 v[12:15], a[128:131], a[104:107], v[12:15]
  buffer_load_dwordx4 v120, s[28:31], s68 offen offset:0 sc1  lds
  v_mfma_f32_16x16x32_bf16 v[28:31], a[132:135], a[104:107], v[28:31]
  ds_read_b64_tr_b16 a[66:67], v116 offset:18432
  v_mfma_f32_16x16x32_bf16 v[28:31], a[156:159], a[124:127], v[28:31]
  ds_read_b128 a[4:7], v112 offset:0
  v_mfma_f32_16x16x32_bf16 v[24:27], a[156:159], a[120:123], v[24:27]
  ds_read_b128 a[24:27], v113 offset:0
  v_mfma_f32_16x16x32_bf16 v[24:27], a[132:135], a[100:103], v[24:27]
  buffer_load_dwordx4 v121, s[28:31], s68 offen offset:1024 sc1  lds
  v_mfma_f32_16x16x32_bf16 v[20:23], a[132:135], a[96:99], v[20:23]
  ds_read_b128 a[8:11], v112 offset:2048
  v_mfma_f32_16x16x32_bf16 v[20:23], a[156:159], a[116:119], v[20:23]
  ds_read_b128 a[28:31], v113 offset:2048
  v_mfma_f32_16x16x32_bf16 v[16:19], a[156:159], a[112:115], v[16:19]
  ds_read_b128 a[12:15], v112 offset:4096
  v_mfma_f32_16x16x32_bf16 v[16:19], a[132:135], a[92:95], v[16:19]
  buffer_load_dwordx4 v122, s[28:31], s68 offen offset:2048 sc1  lds
  v_mfma_f32_16x16x32_bf16 v[96:99], a[136:139], a[88:91], v[96:99]
  ds_read_b128 a[32:35], v113 offset:4096
  v_mfma_f32_16x16x32_bf16 v[96:99], a[160:163], a[108:111], v[96:99]
  ds_read_b128 a[16:19], v112 offset:6144
  v_mfma_f32_16x16x32_bf16 v[32:35], a[160:163], a[112:115], v[32:35]
  ds_read_b128 a[36:39], v113 offset:6144
  v_mfma_f32_16x16x32_bf16 v[32:35], a[136:139], a[92:95], v[32:35]
  buffer_load_dwordx4 v123, s[28:31], s68 offen offset:3072 sc1  lds
  v_mfma_f32_16x16x32_bf16 v[36:39], a[136:139], a[96:99], v[36:39]
  ds_read_b64_tr_b16 a[44:45], v117 offset:0
  v_mfma_f32_16x16x32_bf16 v[36:39], a[160:163], a[116:119], v[36:39]
  ds_read_b64_tr_b16 a[46:47], v117 offset:6144
  v_mfma_f32_16x16x32_bf16 v[40:43], a[160:163], a[120:123], v[40:43]
  s_add_u32 m0, s63, 49152
  ds_read_b64_tr_b16 a[68:69], v117 offset:12288
  v_mfma_f32_16x16x32_bf16 v[40:43], a[136:139], a[100:103], v[40:43]
  buffer_load_dwordx4 v124, s[8:11], s69 offen offset:0  lds
  v_mfma_f32_16x16x32_bf16 v[44:47], a[136:139], a[104:107], v[44:47]
  s_add_u32 s44, s44, 1
  ds_read_b64_tr_b16 a[70:71], v117 offset:18432
  v_mfma_f32_16x16x32_bf16 v[44:47], a[160:163], a[124:127], v[44:47]
  s_and_b32 s44, s44, 15
  ds_read_b128 a[0:3], v114 offset:6144
  v_add_u32 v114, 6144, v114
  v_mfma_f32_16x16x32_bf16 v[60:63], a[164:167], a[124:127], v[60:63]
  s_add_u32 s66, s66, 1
  ds_read_b128 a[20:23], v115 offset:6144
  v_add_u32 v115, 6144, v115
  v_mfma_f32_16x16x32_bf16 v[60:63], a[140:143], a[104:107], v[60:63]
  s_mul_i32 s45, s44, s61
  buffer_load_dwordx4 v125, s[8:11], s69 offen offset:1024  lds
  v_mfma_f32_16x16x32_bf16 v[56:59], a[140:143], a[100:103], v[56:59]
  s_add_u32 s68, s45, s59
  ds_read_b64_tr_b16 a[48:49], v116 offset:2048
  v_mfma_f32_16x16x32_bf16 v[56:59], a[164:167], a[120:123], v[56:59]
  ds_read_b64_tr_b16 a[50:51], v116 offset:8192
  v_mfma_f32_16x16x32_bf16 v[52:55], a[164:167], a[116:119], v[52:55]
  ds_read_b64_tr_b16 a[72:73], v116 offset:14336
  v_mfma_f32_16x16x32_bf16 v[52:55], a[140:143], a[96:99], v[52:55]
  buffer_load_dwordx4 v124, s[8:11], s69 offen offset:2048  lds
  v_mfma_f32_16x16x32_bf16 v[48:51], a[140:143], a[92:95], v[48:51]
  ds_read_b64_tr_b16 a[74:75], v116 offset:20480
  v_mfma_f32_16x16x32_bf16 v[48:51], a[164:167], a[112:115], v[48:51]
  ds_read_b64_tr_b16 a[52:53], v117 offset:2048
  v_mfma_f32_16x16x32_bf16 v[100:103], a[108:111], a[168:171], v[100:103]
  ds_read_b64_tr_b16 a[54:55], v117 offset:8192
  v_mfma_f32_16x16x32_bf16 v[100:103], a[88:91], a[144:147], v[100:103]
  buffer_load_dwordx4 v125, s[8:11], s69 offen offset:3072  lds
  v_mfma_f32_16x16x32_bf16 v[64:67], a[92:95], a[144:147], v[64:67]
  ds_read_b64_tr_b16 a[76:77], v117 offset:14336
  v_mfma_f32_16x16x32_bf16 v[64:67], a[112:115], a[168:171], v[64:67]
  ds_read_b64_tr_b16 a[78:79], v117 offset:20480
  v_mfma_f32_16x16x32_bf16 v[68:71], a[116:119], a[168:171], v[68:71]
  s_add_u32 m0, s63, 53248
  ds_read_b64_tr_b16 a[56:57], v116 offset:4096
  v_mfma_f32_16x16x32_bf16 v[68:71], a[96:99], a[144:147], v[68:71]
  buffer_load_dwordx4 v124, s[8:11], s70 offen offset:0  lds
  v_mfma_f32_16x16x32_bf16 v[72:75], a[100:103], a[144:147], v[72:75]
  ds_read_b64_tr_b16 a[58:59], v116 offset:10240
  v_mfma_f32_16x16x32_bf16 v[72:75], a[120:123], a[168:171], v[72:75]
  ds_read_b64_tr_b16 a[80:81], v116 offset:16384
  v_mfma_f32_16x16x32_bf16 v[76:79], a[124:127], a[168:171], v[76:79]
  ds_read_b64_tr_b16 a[82:83], v116 offset:22528
  v_mfma_f32_16x16x32_bf16 v[76:79], a[104:107], a[144:147], v[76:79]
  buffer_load_dwordx4 v125, s[8:11], s70 offen offset:1024  lds
  v_mfma_f32_16x16x32_bf16 v[92:95], a[104:107], a[148:151], v[92:95]
  ds_read_b64_tr_b16 a[60:61], v117 offset:4096
  v_mfma_f32_16x16x32_bf16 v[92:95], a[124:127], a[172:175], v[92:95]
  ds_read_b64_tr_b16 a[62:63], v117 offset:10240
  v_mfma_f32_16x16x32_bf16 v[88:91], a[120:123], a[172:175], v[88:91]
  ds_read_b64_tr_b16 a[84:85], v117 offset:16384
  v_mfma_f32_16x16x32_bf16 v[88:91], a[100:103], a[148:151], v[88:91]
  ds_read_b64_tr_b16 a[86:87], v117 offset:22528
  v_mfma_f32_16x16x32_bf16 v[84:87], a[96:99], a[148:151], v[84:87]
  s_cmp_eq_u32 s66, s88
  s_cbranch_scc1 Lside_k5_c
Lside_k5_r:
  v_mfma_f32_16x16x32_bf16 v[84:87], a[116:119], a[172:175], v[84:87]
  s_sub_u32 s56, s56, 1
  v_mfma_f32_16x16x32_bf16 v[80:83], a[112:115], a[172:175], v[80:83]
  s_cmp_lg_u32 s56, 0
  v_mfma_f32_16x16x32_bf16 v[80:83], a[92:95], a[148:151], v[80:83]
  s_cbranch_scc1 Lp1_loop
Lmk_Lp1_loop_tail:
  s_waitcnt lgkmcnt(15)
  v_mfma_f32_16x16x32_bf16 v[0:3], a[40:43], a[4:7], v[0:3]
  s_mul_i32 s45, s44, 393216
  v_and_b32 v240, 1, v253
  v_lshlrev_b32 v240, 7, v240
  v_mfma_f32_16x16x32_bf16 v[0:3], a[64:67], a[24:27], v[0:3]
  s_add_u32 s69, s45, s60
  v_mfma_f32_16x16x32_bf16 v[4:7], a[64:67], a[28:31], v[4:7]
  s_add_u32 s70, s69, 4096
  buffer_load_dword v127, v240, s[36:39], 0 offen sc1
  v_mfma_f32_16x16x32_bf16 v[4:7], a[40:43], a[8:11], v[4:7]
  s_lshl_b32 s43, s57, 2
  v_mfma_f32_16x16x32_bf16 v[8:11], a[40:43], a[12:15], v[8:11]
  s_waitcnt vmcnt(11) lgkmcnt(0)
  s_barrier
  ds_read_b64_tr_b16 a[128:129], v116 offset:24576
  v_mfma_f32_16x16x32_bf16 v[8:11], a[64:67], a[32:35], v[8:11]
  s_add_u32 s74, s71, s43
  ds_read_b64_tr_b16 a[130:131], v116 offset:30720
  v_mfma_f32_16x16x32_bf16 v[12:15], a[64:67], a[36:39], v[12:15]
  s_add_u32 m0, s62, 73728
  ds_read_b64_tr_b16 a[152:153], v116 offset:36864
  v_mfma_f32_16x16x32_bf16 v[12:15], a[40:43], a[16:19], v[12:15]
  s_add_u32 s45, s42, 27262976
  buffer_load_dwordx4 v120, s[28:31], s68 offen offset:0 sc1  lds
  v_mfma_f32_16x16x32_bf16 v[28:31], a[44:47], a[16:19], v[28:31]
  s_lshl_b32 s44, s72, 11
  ds_read_b64_tr_b16 a[154:155], v116 offset:43008
  v_mfma_f32_16x16x32_bf16 v[28:31], a[68:71], a[36:39], v[28:31]
  s_add_u32 s77, s44, s45
  ds_read_b128 a[92:95], v112 offset:16384
  v_mfma_f32_16x16x32_bf16 v[24:27], a[68:71], a[32:35], v[24:27]
  s_lshl_b32 s44, s40, 1
  ds_read_b128 a[112:115], v113 offset:16384
  v_mfma_f32_16x16x32_bf16 v[24:27], a[44:47], a[12:15], v[24:27]
  s_add_u32 s44, s44, s71
  buffer_load_dwordx4 v121, s[28:31], s68 offen offset:1024 sc1  lds
  v_mfma_f32_16x16x32_bf16 v[20:23], a[44:47], a[8:11], v[20:23]
  s_lshl_b32 s44, s44, 11
  ds_read_b128 a[96:99], v112 offset:18432
  v_mfma_f32_16x16x32_bf16 v[20:23], a[68:71], a[28:31], v[20:23]
  s_add_u32 s78, s44, s45
  ds_read_b128 a[116:119], v113 offset:18432
  v_mfma_f32_16x16x32_bf16 v[16:19], a[68:71], a[24:27], v[16:19]
  s_lshl_b32 s43, s51, 1
  ds_read_b128 a[100:103], v112 offset:20480
  v_mfma_f32_16x16x32_bf16 v[16:19], a[44:47], a[4:7], v[16:19]
  s_add_u32 s75, s43, s58
  buffer_load_dwordx4 v122, s[28:31], s68 offen offset:2048 sc1  lds
  v_mfma_f32_16x16x32_bf16 v[96:99], a[48:51], a[0:3], v[96:99]
  s_lshl_b32 s43, s75, 7
  ds_read_b128 a[120:123], v113 offset:20480
  v_mfma_f32_16x16x32_bf16 v[96:99], a[72:75], a[20:23], v[96:99]
  s_add_u32 s46, s43, 27983872
  ds_read_b128 a[104:107], v112 offset:22528
  v_mfma_f32_16x16x32_bf16 v[32:35], a[72:75], a[24:27], v[32:35]
  s_lshl_b32 s43, s57, 6
  ds_read_b128 a[124:127], v113 offset:22528
  v_mfma_f32_16x16x32_bf16 v[32:35], a[48:51], a[4:7], v[32:35]
  buffer_load_dwordx4 v123, s[28:31], s68 offen offset:3072 sc1  lds
  v_mfma_f32_16x16x32_bf16 v[36:39], a[48:51], a[8:11], v[36:39]
  ds_read_b64_tr_b16 a[132:133], v117 offset:24576
  v_mfma_f32_16x16x32_bf16 v[36:39], a[72:75], a[28:31], v[36:39]
  ds_read_b64_tr_b16 a[134:135], v117 offset:30720
  v_mfma_f32_16x16x32_bf16 v[40:43], a[72:75], a[32:35], v[40:43]
  s_add_u32 m0, s63, 0
  ds_read_b64_tr_b16 a[156:157], v117 offset:36864
  v_mfma_f32_16x16x32_bf16 v[40:43], a[48:51], a[12:15], v[40:43]
  buffer_load_dwordx4 v124, s[8:11], s69 offen offset:0  lds
  v_mfma_f32_16x16x32_bf16 v[44:47], a[48:51], a[16:19], v[44:47]
  ds_read_b64_tr_b16 a[158:159], v117 offset:43008
  v_mfma_f32_16x16x32_bf16 v[44:47], a[72:75], a[36:39], v[44:47]
  ds_read_b128 a[88:91], v114 offset:1024
  v_mfma_f32_16x16x32_bf16 v[60:63], a[76:79], a[36:39], v[60:63]
  ds_read_b128 a[108:111], v115 offset:1024
  v_mfma_f32_16x16x32_bf16 v[60:63], a[52:55], a[16:19], v[60:63]
  buffer_load_dwordx4 v125, s[8:11], s69 offen offset:1024  lds
  v_mfma_f32_16x16x32_bf16 v[56:59], a[52:55], a[12:15], v[56:59]
  ds_read_b64_tr_b16 a[136:137], v116 offset:26624
  v_mfma_f32_16x16x32_bf16 v[56:59], a[76:79], a[32:35], v[56:59]
  ds_read_b64_tr_b16 a[138:139], v116 offset:32768
  v_mfma_f32_16x16x32_bf16 v[52:55], a[76:79], a[28:31], v[52:55]
  ds_read_b64_tr_b16 a[160:161], v116 offset:38912
  v_lshlrev_b32 v105, 3, v253
  v_mfma_f32_16x16x32_bf16 v[52:55], a[52:55], a[8:11], v[52:55]
  buffer_load_dwordx4 v124, s[8:11], s69 offen offset:2048  lds
  v_mfma_f32_16x16x32_bf16 v[48:51], a[52:55], a[4:7], v[48:51]
  ds_read_b64_tr_b16 a[162:163], v116 offset:45056
  v_lshlrev_b32 v104, 4, v253
  v_mfma_f32_16x16x32_bf16 v[48:51], a[76:79], a[24:27], v[48:51]
  ds_read_b64_tr_b16 a[140:141], v117 offset:26624
  v_xor_b32 v126, s43, v104
  v_mfma_f32_16x16x32_bf16 v[100:103], a[20:23], a[80:83], v[100:103]
  ds_read_b64_tr_b16 a[142:143], v117 offset:32768
  v_add_u32 v126, s76, v126
  v_mfma_f32_16x16x32_bf16 v[100:103], a[0:3], a[56:59], v[100:103]
  buffer_load_dwordx4 v125, s[8:11], s69 offen offset:3072  lds
  v_mfma_f32_16x16x32_bf16 v[64:67], a[4:7], a[56:59], v[64:67]
  ds_read_b64_tr_b16 a[164:165], v117 offset:38912
  v_bfe_u32 v106, v253, 3, 2
  v_mfma_f32_16x16x32_bf16 v[64:67], a[24:27], a[80:83], v[64:67]
  ds_read_b64_tr_b16 a[166:167], v117 offset:45056
  v_lshrrev_b32 v107, 5, v253
  v_mfma_f32_16x16x32_bf16 v[68:71], a[28:31], a[80:83], v[68:71]
  s_add_u32 m0, s63, 4096
  ds_read_b64_tr_b16 a[144:145], v116 offset:28672
  v_mad_u32_u24 v106, v107, 3, v106
  v_mfma_f32_16x16x32_bf16 v[68:71], a[8:11], a[56:59], v[68:71]
  buffer_load_dwordx4 v124, s[8:11], s70 offen offset:0  lds
  v_mfma_f32_16x16x32_bf16 v[72:75], a[12:15], a[56:59], v[72:75]
  ds_read_b64_tr_b16 a[146:147], v116 offset:34816
  v_and_b32 v107, 7, v253
  v_mfma_f32_16x16x32_bf16 v[72:75], a[32:35], a[80:83], v[72:75]
  ds_read_b64_tr_b16 a[168:169], v116 offset:40960
  v_lshlrev_b32 v107, 4, v107
  v_mfma_f32_16x16x32_bf16 v[76:79], a[36:39], a[80:83], v[76:79]
  ds_read_b64_tr_b16 a[170:171], v116 offset:47104
  v_lshl_add_u32 v106, v106, 12, v107
  v_mfma_f32_16x16x32_bf16 v[76:79], a[16:19], a[56:59], v[76:79]
  buffer_load_dwordx4 v125, s[8:11], s70 offen offset:1024  lds
  v_mfma_f32_16x16x32_bf16 v[92:95], a[16:19], a[60:63], v[92:95]
  ds_read_b64_tr_b16 a[148:149], v117 offset:28672
  v_mfma_f32_16x16x32_bf16 v[92:95], a[36:39], a[84:87], v[92:95]
  ds_read_b64_tr_b16 a[150:151], v117 offset:34816
  v_mfma_f32_16x16x32_bf16 v[88:91], a[32:35], a[84:87], v[88:91]
  ds_read_b64_tr_b16 a[172:173], v117 offset:40960
  v_mfma_f32_16x16x32_bf16 v[88:91], a[12:15], a[60:63], v[88:91]
  s_waitcnt vmcnt(10)
  v_cmp_gt_u32 vcc, 128, v127
  s_cbranch_vccnz Lchk3_c
Lchk3_r:
  v_mfma_f32_16x16x32_bf16 v[84:87], a[8:11], a[60:63], v[84:87]
  ds_read_b64_tr_b16 a[174:175], v117 offset:47104
  v_mfma_f32_16x16x32_bf16 v[84:87], a[28:31], a[84:87], v[84:87]
  v_mfma_f32_16x16x32_bf16 v[80:83], a[24:27], a[84:87], v[80:83]
  v_mfma_f32_16x16x32_bf16 v[80:83], a[4:7], a[60:63], v[80:83]
  s_waitcnt lgkmcnt(15)
  v_mfma_f32_16x16x32_bf16 v[0:3], a[128:131], a[92:95], v[0:3]
  s_cmp_eq_u32 s41, 0
  s_cbranch_scc1 Lc4_c
Lc4_r:
  v_mfma_f32_16x16x32_bf16 v[0:3], a[152:155], a[112:115], v[0:3]
  s_lshl_b32 s92, s53, 7
  s_lshl_b32 s93, s40, 14
  s_add_u32 s92, s92, s93
  v_mfma_f32_16x16x32_bf16 v[4:7], a[152:155], a[116:119], v[4:7]
  s_lshl_b32 s89, s40, 10
  v_add_u32 v186, s92, v252
  s_bfe_u32 s88, s2, 0x5
  v_mfma_f32_16x16x32_bf16 v[4:7], a[128:131], a[96:99], v[4:7]
  s_lshl_b32 s88, s88, 21
  buffer_load_dwordx2 v[128:129], v105, s[4:7], s78 offen offset:0 sc1
  v_mfma_f32_16x16x32_bf16 v[8:11], a[128:131], a[100:103], v[8:11]
  s_waitcnt lgkmcnt(0)
  s_barrier
  ds_read_b64_tr_b16 a[40:41], v118 offset:0
  v_mfma_f32_16x16x32_bf16 v[8:11], a[152:155], a[120:123], v[8:11]
  ds_read_b64_tr_b16 a[42:43], v118 offset:6144
  v_mfma_f32_16x16x32_bf16 v[12:15], a[152:155], a[124:127], v[12:15]
  s_cmp_eq_u32 s41, 0
  s_cbranch_scc1 Lc5_c
Lc5_r:
  ds_read_b64_tr_b16 a[64:65], v118 offset:12288
  v_mfma_f32_16x16x32_bf16 v[12:15], a[128:131], a[104:107], v[12:15]
  buffer_load_dwordx2 v[130:131], v105, s[4:7], s78 offen offset:512 sc1
  v_mfma_f32_16x16x32_bf16 v[28:31], a[132:135], a[104:107], v[28:31]
  ds_read_b64_tr_b16 a[66:67], v118 offset:18432
  v_mfma_f32_16x16x32_bf16 v[28:31], a[156:159], a[124:127], v[28:31]
  ds_read_b128 a[4:7], v112 offset:32768
  v_mfma_f32_16x16x32_bf16 v[24:27], a[156:159], a[120:123], v[24:27]
  ds_read_b128 a[24:27], v113 offset:32768
  v_mfma_f32_16x16x32_bf16 v[24:27], a[132:135], a[100:103], v[24:27]
  buffer_load_dwordx2 v[132:133], v105, s[4:7], s78 offen offset:1024 sc1
  v_mfma_f32_16x16x32_bf16 v[20:23], a[132:135], a[96:99], v[20:23]
  s_cmp_eq_u32 s41, 0
  s_cbranch_scc1 Lc6_c
Lc6_r:
  ds_read_b128 a[8:11], v112 offset:34816
  v_mfma_f32_16x16x32_bf16 v[20:23], a[156:159], a[116:119], v[20:23]
  ds_read_b128 a[28:31], v113 offset:34816
  v_mfma_f32_16x16x32_bf16 v[16:19], a[156:159], a[112:115], v[16:19]
  ds_read_b128 a[12:15], v112 offset:36864
  v_mfma_f32_16x16x32_bf16 v[16:19], a[132:135], a[92:95], v[16:19]
  buffer_load_dwordx2 v[134:135], v105, s[4:7], s78 offen offset:1536 sc1
  v_mfma_f32_16x16x32_bf16 v[96:99], a[136:139], a[88:91], v[96:99]
  ds_read_b128 a[32:35], v113 offset:36864
  v_mfma_f32_16x16x32_bf16 v[96:99], a[160:163], a[108:111], v[96:99]
  ds_read_b128 a[16:19], v112 offset:38912
  v_mfma_f32_16x16x32_bf16 v[32:35], a[160:163], a[112:115], v[32:35]
  s_cmp_eq_u32 s41, 0
  s_cbranch_scc1 Lc7_c
Lc7_r:
  ds_read_b128 a[36:39], v113 offset:38912
  v_mfma_f32_16x16x32_bf16 v[32:35], a[136:139], a[92:95], v[32:35]
  buffer_load_dwordx2 v[136:137], v105, s[4:7], s78 offen offset:2048 sc1
  v_mfma_f32_16x16x32_bf16 v[36:39], a[136:139], a[96:99], v[36:39]
  ds_read_b64_tr_b16 a[44:45], v119 offset:0
  v_mfma_f32_16x16x32_bf16 v[36:39], a[160:163], a[116:119], v[36:39]
  ds_read_b64_tr_b16 a[46:47], v119 offset:6144
  v_mfma_f32_16x16x32_bf16 v[40:43], a[160:163], a[120:123], v[40:43]
  ds_read_b64_tr_b16 a[68:69], v119 offset:12288
  v_mfma_f32_16x16x32_bf16 v[40:43], a[136:139], a[100:103], v[40:43]
  buffer_load_dwordx2 v[138:139], v105, s[4:7], s78 offen offset:2560 sc1
  v_mfma_f32_16x16x32_bf16 v[44:47], a[136:139], a[104:107], v[44:47]
  ds_read_b64_tr_b16 a[70:71], v119 offset:18432
  v_lshrrev_b32 v240, 4, v253
  v_mfma_f32_16x16x32_bf16 v[44:47], a[160:163], a[124:127], v[44:47]
  ds_read_b128 a[0:3], v114 offset:2048
  v_lshlrev_b32 v124, 4, v240
  v_mfma_f32_16x16x32_bf16 v[60:63], a[164:167], a[124:127], v[60:63]
  ds_read_b128 a[20:23], v115 offset:2048
  v_and_b32 v125, 15, v253
  v_mfma_f32_16x16x32_bf16 v[60:63], a[140:143], a[104:107], v[60:63]
  buffer_load_dwordx2 v[140:141], v105, s[4:7], s78 offen offset:3072 sc1
  v_mfma_f32_16x16x32_bf16 v[56:59], a[140:143], a[100:103], v[56:59]
  ds_read_b64_tr_b16 a[48:49], v118 offset:2048
  v_lshlrev_b32 v125, 2, v125
  v_mfma_f32_16x16x32_bf16 v[56:59], a[164:167], a[120:123], v[56:59]
  s_lshl_b32 s43, s57, 9
  ds_read_b64_tr_b16 a[50:51], v118 offset:8192
  v_add_u32 v164, 155648, v124
  v_mfma_f32_16x16x32_bf16 v[52:55], a[164:167], a[116:119], v[52:55]
  ds_read_b64_tr_b16 a[72:73], v118 offset:14336
  v_add_u32 v166, 155648, v125
  v_mfma_f32_16x16x32_bf16 v[52:55], a[140:143], a[96:99], v[52:55]
  buffer_load_dwordx2 v[142:143], v105, s[4:7], s78 offen offset:3584 sc1
  v_mfma_f32_16x16x32_bf16 v[48:51], a[140:143], a[92:95], v[48:51]
  ds_read_b64_tr_b16 a[74:75], v118 offset:20480
  v_add_u32 v165, s43, v164
  v_mfma_f32_16x16x32_bf16 v[48:51], a[164:167], a[112:115], v[48:51]
  ds_read_b64_tr_b16 a[52:53], v119 offset:2048
  v_add_u32 v167, s43, v166
  v_mfma_f32_16x16x32_bf16 v[100:103], a[108:111], a[168:171], v[100:103]
  s_lshl_b32 s43, s40, 1
  ds_read_b64_tr_b16 a[54:55], v119 offset:8192
  v_mfma_f32_16x16x32_bf16 v[100:103], a[88:91], a[144:147], v[100:103]
  s_add_u32 s43, s43, 1
  buffer_load_dwordx2 v[144:145], v105, s[4:7], s77 offen offset:0 sc1
  v_mfma_f32_16x16x32_bf16 v[64:67], a[92:95], a[144:147], v[64:67]
  ds_read_b64_tr_b16 a[76:77], v119 offset:14336
  v_add_u32 v241, s43, v240
  v_mfma_f32_16x16x32_bf16 v[64:67], a[112:115], a[168:171], v[64:67]
  ds_read_b64_tr_b16 a[78:79], v119 offset:20480
  v_cmp_gt_u32 vcc, 2, v240
  v_mfma_f32_16x16x32_bf16 v[68:71], a[116:119], a[168:171], v[68:71]
  ds_read_b64_tr_b16 a[56:57], v118 offset:4096
  v_and_b32 v240, 1, v240
  v_mfma_f32_16x16x32_bf16 v[68:71], a[96:99], a[144:147], v[68:71]
  buffer_load_dwordx2 v[146:147], v105, s[4:7], s77 offen offset:512 sc1
  v_mfma_f32_16x16x32_bf16 v[72:75], a[100:103], a[144:147], v[72:75]
  ds_read_b64_tr_b16 a[58:59], v118 offset:10240
  v_mul_u32_u24 v240, 9, v240
  v_mfma_f32_16x16x32_bf16 v[72:75], a[120:123], a[168:171], v[72:75]
  ds_read_b64_tr_b16 a[80:81], v118 offset:16384
  v_cndmask_b32 v240, v240, v241, vcc
  v_mfma_f32_16x16x32_bf16 v[76:79], a[124:127], a[168:171], v[76:79]
  ds_read_b64_tr_b16 a[82:83], v118 offset:22528
  v_lshl_add_u32 v106, v240, 7, v166
  v_mfma_f32_16x16x32_bf16 v[76:79], a[104:107], a[144:147], v[76:79]
  buffer_load_dwordx2 v[148:149], v105, s[4:7], s77 offen offset:1024 sc1
  v_mfma_f32_16x16x32_bf16 v[92:95], a[104:107], a[148:151], v[92:95]
  ds_read_b64_tr_b16 a[60:61], v119 offset:4096
  v_add_u32 v124, s76, v124
  v_mfma_f32_16x16x32_bf16 v[92:95], a[124:127], a[172:175], v[92:95]
  ds_read_b64_tr_b16 a[62:63], v119 offset:10240
  v_add_u32 v125, s76, v125
  v_mfma_f32_16x16x32_bf16 v[88:91], a[120:123], a[172:175], v[88:91]
  ds_read_b64_tr_b16 a[84:85], v119 offset:16384
  v_add_u32 v107, 149504, v104
  v_mfma_f32_16x16x32_bf16 v[88:91], a[100:103], a[148:151], v[88:91]
  buffer_load_dwordx2 v[150:151], v105, s[4:7], s77 offen offset:1536 sc1
  v_mfma_f32_16x16x32_bf16 v[84:87], a[96:99], a[148:151], v[84:87]
  ds_read_b64_tr_b16 a[86:87], v119 offset:22528
  v_mfma_f32_16x16x32_bf16 v[84:87], a[116:119], a[172:175], v[84:87]
  v_mfma_f32_16x16x32_bf16 v[80:83], a[112:115], a[172:175], v[80:83]
  v_mfma_f32_16x16x32_bf16 v[80:83], a[92:95], a[148:151], v[80:83]
  s_waitcnt lgkmcnt(15)
  v_mfma_f32_16x16x32_bf16 v[0:3], a[40:43], a[4:7], v[0:3]
  s_lshl_b32 s44, s2, 2
  s_add_u32 s44, s44, s40
  s_lshl_b32 s44, s44, 12
  v_mfma_f32_16x16x32_bf16 v[0:3], a[64:67], a[24:27], v[0:3]
  s_add_u32 s44, s44, s42
  v_mfma_f32_16x16x32_bf16 v[4:7], a[64:67], a[28:31], v[4:7]
  s_add_u32 s44, s44, 28311552
  v_mov_b32 v246, -1
  v_mov_b32 v247, -1
  v_mfma_f32_16x16x32_bf16 v[4:7], a[40:43], a[8:11], v[4:7]
  v_mov_b32 v248, -1
  v_mov_b32 v249, -1
  v_mfma_f32_16x16x32_bf16 v[8:11], a[40:43], a[12:15], v[8:11]
  s_waitcnt vmcnt(12) lgkmcnt(0)
  s_barrier
  ds_read_b64_tr_b16 a[128:129], v116 offset:0
  v_mfma_f32_16x16x32_bf16 v[8:11], a[64:67], a[32:35], v[8:11]
  ds_read_b64_tr_b16 a[130:131], v116 offset:6144
  v_mfma_f32_16x16x32_bf16 v[12:15], a[64:67], a[36:39], v[12:15]
  s_waitcnt vmcnt(8)
  ds_read_b64_tr_b16 a[152:153], v116 offset:12288
  v_add_u32 v198, 1024, v125
  v_mfma_f32_16x16x32_bf16 v[12:15], a[40:43], a[16:19], v[12:15]
  ds_read_b64_tr_b16 a[154:155], v116 offset:18432
  v_add_f32 v128, v128, v130
  v_mfma_f32_16x16x32_bf16 v[28:31], a[44:47], a[16:19], v[28:31]
  buffer_store_dwordx4 v[246:249], v104, s[4:7], s44 offen offset:0 sc1
  v_mfma_f32_16x16x32_bf16 v[28:31], a[68:71], a[36:39], v[28:31]
  ds_read_b128 a[92:95], v112 offset:0
  v_add_f32 v129, v129, v131
  v_mfma_f32_16x16x32_bf16 v[24:27], a[68:71], a[32:35], v[24:27]
  ds_read_b128 a[112:115], v113 offset:0
  v_add_f32 v132, v132, v134
  v_mfma_f32_16x16x32_bf16 v[24:27], a[44:47], a[12:15], v[24:27]
  ds_read_b128 a[96:99], v112 offset:2048
  v_add_f32 v133, v133, v135
  v_mfma_f32_16x16x32_bf16 v[20:23], a[44:47], a[8:11], v[20:23]
  buffer_store_dwordx4 v[246:249], v104, s[4:7], s44 offen offset:1024 sc1
  v_mfma_f32_16x16x32_bf16 v[20:23], a[68:71], a[28:31], v[20:23]
  ds_read_b128 a[116:119], v113 offset:2048
  v_add_f32 v128, v128, v132
  v_mfma_f32_16x16x32_bf16 v[16:19], a[68:71], a[24:27], v[16:19]
  ds_read_b128 a[100:103], v112 offset:4096
  v_add_f32 v129, v129, v133
  v_mfma_f32_16x16x32_bf16 v[16:19], a[44:47], a[4:7], v[16:19]
  s_waitcnt vmcnt(6)
  ds_read_b128 a[120:123], v113 offset:4096
  s_cmp_eq_u32 s41, 0
  s_cbranch_scc1 Lc8_c
Lc8_r:
  v_mfma_f32_16x16x32_bf16 v[96:99], a[48:51], a[0:3], v[96:99]
  buffer_store_dwordx4 v[246:249], v104, s[4:7], s44 offen offset:2048 sc1
  v_mfma_f32_16x16x32_bf16 v[96:99], a[72:75], a[20:23], v[96:99]
  ds_read_b128 a[104:107], v112 offset:6144
  ds_read_b128 v[168:171], v124 offset:1024
  v_mfma_f32_16x16x32_bf16 v[32:35], a[72:75], a[24:27], v[32:35]
  ds_read_b128 a[124:127], v113 offset:6144
  ds_read_b128 v[172:175], v124 offset:1088
  v_mfma_f32_16x16x32_bf16 v[32:35], a[48:51], a[4:7], v[32:35]
  ds_read_b64_tr_b16 a[132:133], v117 offset:0
  ds_read_b128 v[176:179], v124 offset:1152
  v_mfma_f32_16x16x32_bf16 v[36:39], a[48:51], a[8:11], v[36:39]
  buffer_store_dwordx4 v[246:249], v104, s[4:7], s44 offen offset:3072 sc1
  v_mfma_f32_16x16x32_bf16 v[36:39], a[72:75], a[28:31], v[36:39]
  ds_read_b64_tr_b16 a[134:135], v117 offset:6144
  ds_read_b128 v[180:183], v124 offset:1216
  v_mfma_f32_16x16x32_bf16 v[40:43], a[72:75], a[32:35], v[40:43]
  ds_read_b64_tr_b16 a[156:157], v117 offset:12288
  ds_read2_b32 v[184:185], v198 offset0:64 offset1:80
  v_mfma_f32_16x16x32_bf16 v[40:43], a[48:51], a[12:15], v[40:43]
  s_add_u32 m0, s62, 90112
  ds_read_b64_tr_b16 a[158:159], v117 offset:18432
  s_xor_b32 s47, s40, 2
  v_mfma_f32_16x16x32_bf16 v[44:47], a[48:51], a[16:19], v[44:47]
  s_mul_i32 s47, s47, 6144
  buffer_load_dwordx4 v120, s[28:31], s64 offen offset:0 sc1 lds
  v_mfma_f32_16x16x32_bf16 v[44:47], a[72:75], a[36:39], v[44:47]
  s_add_u32 s47, s47, 139264
  ds_read_b128 a[88:91], v114 offset:3072
  s_add_u32 s49, s47, 3072
  v_mfma_f32_16x16x32_bf16 v[60:63], a[76:79], a[36:39], v[60:63]
  s_add_u32 s79, s47, 2048
  ds_read_b128 a[108:111], v115 offset:3072
  v_mfma_f32_16x16x32_bf16 v[60:63], a[52:55], a[16:19], v[60:63]
  s_cmp_eq_u32 s57, 0
  s_cselect_b32 s49, s76, s49
  s_cselect_b32 s79, s47, s79
  ds_read_b64_tr_b16 a[136:137], v116 offset:2048
  v_add_u32 v198, s49, v105
  v_mfma_f32_16x16x32_bf16 v[56:59], a[52:55], a[12:15], v[56:59]
  ds_read_b64_tr_b16 a[138:139], v116 offset:8192
  v_add_u32 v199, s79, v105
  v_mfma_f32_16x16x32_bf16 v[56:59], a[76:79], a[32:35], v[56:59]
  ds_read_b64_tr_b16 a[160:161], v116 offset:14336
  v_add_u32 v105, s76, v105
  v_mfma_f32_16x16x32_bf16 v[52:55], a[76:79], a[28:31], v[52:55]
  ds_read_b64_tr_b16 a[162:163], v116 offset:20480
  v_add_f32 v136, v136, v138
  v_mfma_f32_16x16x32_bf16 v[52:55], a[52:55], a[8:11], v[52:55]
  ds_read_b64_tr_b16 a[140:141], v117 offset:2048
  v_add_f32 v137, v137, v139
  v_mfma_f32_16x16x32_bf16 v[48:51], a[52:55], a[4:7], v[48:51]
  buffer_load_dwordx4 v121, s[28:31], s64 offen offset:1024 sc1 lds
  v_mfma_f32_16x16x32_bf16 v[48:51], a[76:79], a[24:27], v[48:51]
  ds_read_b64_tr_b16 a[142:143], v117 offset:8192
  v_add_f32 v140, v140, v142
  v_mfma_f32_16x16x32_bf16 v[100:103], a[20:23], a[80:83], v[100:103]
  ds_read_b64_tr_b16 a[164:165], v117 offset:14336
  v_add_f32 v141, v141, v143
  v_mfma_f32_16x16x32_bf16 v[100:103], a[0:3], a[56:59], v[100:103]
  ds_read_b64_tr_b16 a[166:167], v117 offset:20480
  v_add_f32 v136, v136, v140
  v_mfma_f32_16x16x32_bf16 v[64:67], a[4:7], a[56:59], v[64:67]
  ds_read_b64_tr_b16 a[144:145], v116 offset:4096
  v_add_f32 v137, v137, v141
  v_mfma_f32_16x16x32_bf16 v[64:67], a[24:27], a[80:83], v[64:67]
  s_waitcnt vmcnt(6)
  ds_read_b64_tr_b16 a[146:147], v116 offset:10240
  v_add_f32 v144, v144, v146
  v_mfma_f32_16x16x32_bf16 v[68:71], a[28:31], a[80:83], v[68:71]
  ds_read_b64_tr_b16 a[168:169], v116 offset:16384
  v_add_f32 v145, v145, v147
  v_mfma_f32_16x16x32_bf16 v[68:71], a[8:11], a[56:59], v[68:71]
  ds_read_b64_tr_b16 a[170:171], v116 offset:22528
  v_add_f32 v148, v148, v150
  v_mfma_f32_16x16x32_bf16 v[72:75], a[12:15], a[56:59], v[72:75]
  buffer_load_dwordx4 v122, s[28:31], s64 offen offset:2048 sc1 lds
  v_mfma_f32_16x16x32_bf16 v[72:75], a[32:35], a[80:83], v[72:75]
  ds_read_b64_tr_b16 a[148:149], v117 offset:4096
  v_add_f32 v149, v149, v151
  v_mfma_f32_16x16x32_bf16 v[76:79], a[36:39], a[80:83], v[76:79]
  ds_read_b64_tr_b16 a[150:151], v117 offset:10240
  v_add_f32 v144, v144, v148
  v_mfma_f32_16x16x32_bf16 v[76:79], a[16:19], a[56:59], v[76:79]
  ds_read_b64_tr_b16 a[172:173], v117 offset:16384
  v_add_f32 v145, v145, v149
  v_mfma_f32_16x16x32_bf16 v[92:95], a[16:19], a[60:63], v[92:95]
  s_mov_b32 s48, 0x3a800000
  ds_read_b64_tr_b16 a[174:175], v117 offset:22528
  v_mov_b32 v240, 0x3727c5ac
  v_mfma_f32_16x16x32_bf16 v[92:95], a[36:39], a[84:87], v[92:95]
  v_permlane32_swap_b32 v136, v130
  v_permlane32_swap_b32 v137, v131
  v_mfma_f32_16x16x32_bf16 v[88:91], a[32:35], a[84:87], v[88:91]
  v_permlane32_swap_b32 v128, v144
  v_permlane32_swap_b32 v129, v145
  v_mfma_f32_16x16x32_bf16 v[88:91], a[12:15], a[60:63], v[88:91]
  v_add_f32 v136, v136, v130
  v_add_f32 v128, v128, v144
  v_mfma_f32_16x16x32_bf16 v[84:87], a[8:11], a[60:63], v[84:87]
  buffer_load_dwordx4 v123, s[28:31], s64 offen offset:3072 sc1 lds
  v_mfma_f32_16x16x32_bf16 v[84:87], a[28:31], a[84:87], v[84:87]
  v_add_f32 v137, v137, v131
  v_add_f32 v129, v129, v145
  v_mfma_f32_16x16x32_bf16 v[80:83], a[24:27], a[84:87], v[80:83]
  v_permlane16_swap_b32 v128, v136
  v_mfma_f32_16x16x32_bf16 v[80:83], a[4:7], a[60:63], v[80:83]
  s_nop 0
  v_permlane16_swap_b32 v129, v137
  v_add_f32 v128, v128, v136
  s_waitcnt lgkmcnt(15)
  v_mfma_f32_16x16x32_bf16 v[0:3], a[128:131], a[92:95], v[0:3]
  v_add_f32 v129, v129, v137
  v_mul_f32 v128, 0xba800000, v128
  v_mfma_f32_16x16x32_bf16 v[0:3], a[152:155], a[112:115], v[0:3]
  s_add_u32 m0, s89, 40960
  v_fma_f32 v129, v129, s48, v240
  v_fma_f32 v129, -v128, v128, v129
  v_mfma_f32_16x16x32_bf16 v[4:7], a[152:155], a[116:119], v[4:7]
  s_xor_b32 s92, s88, 655360
  v_max_f32 v129, v129, v240
  v_rsq_f32 v129, v129
  v_mfma_f32_16x16x32_bf16 v[4:7], a[128:131], a[96:99], v[4:7]
  s_nop 0
  buffer_load_dwordx4 v186, s[12:15], s92 offen lds
  v_mfma_f32_16x16x32_bf16 v[8:11], a[128:131], a[100:103], v[8:11]
  ds_write2_b32 v106, v128, v129 offset0:0 offset1:16
  v_mfma_f32_16x16x32_bf16 v[8:11], a[152:155], a[120:123], v[8:11]
  v_mfma_f32_16x16x32_bf16 v[12:15], a[152:155], a[124:127], v[12:15]
  s_add_u32 m0, s89, 45056
  v_mfma_f32_16x16x32_bf16 v[12:15], a[128:131], a[104:107], v[12:15]
  s_xor_b32 s92, s88, 720896
  v_mfma_f32_16x16x32_bf16 v[28:31], a[132:135], a[104:107], v[28:31]
  buffer_load_dwordx4 v186, s[12:15], s92 offen lds
  v_mfma_f32_16x16x32_bf16 v[28:31], a[156:159], a[124:127], v[28:31]
  v_mfma_f32_16x16x32_bf16 v[24:27], a[156:159], a[120:123], v[24:27]
  s_waitcnt lgkmcnt(0)
  s_barrier
  ds_read2_b32 v[190:191], v167 offset0:32 offset1:48
  ds_read2_b32 v[192:193], v167 offset0:64 offset1:80
  v_mfma_f32_16x16x32_bf16 v[24:27], a[132:135], a[100:103], v[24:27]
  s_add_u32 m0, s89, 49152
  ds_read2_b32 v[194:195], v167 offset0:96 offset1:112
  ds_read2_b32 v[196:197], v167 offset0:128 offset1:144
  v_mfma_f32_16x16x32_bf16 v[20:23], a[132:135], a[96:99], v[20:23]
  s_xor_b32 s92, s88, 786432
  ds_read2_b32 v[188:189], v166 offset0:0 offset1:16
  ds_read_b128 v[128:131], v107
  v_mfma_f32_16x16x32_bf16 v[20:23], a[156:159], a[116:119], v[20:23]
  buffer_load_dwordx4 v186, s[12:15], s92 offen lds
  v_mfma_f32_16x16x32_bf16 v[16:19], a[156:159], a[112:115], v[16:19]
  ds_read_b128 v[132:135], v107 offset:1024
  ds_read_b128 v[200:203], v164 offset:0
  v_mfma_f32_16x16x32_bf16 v[16:19], a[132:135], a[92:95], v[16:19]
  ds_read_b128 v[220:223], v164 offset:64
  ds_read_b128 v[216:219], v165 offset:512
  v_mfma_f32_16x16x32_bf16 v[96:99], a[136:139], a[88:91], v[96:99]
  s_add_u32 m0, s89, 53248
  ds_read_b128 v[236:239], v165 offset:576
  ds_read_b128 v[204:207], v165 offset:128
  v_mfma_f32_16x16x32_bf16 v[96:99], a[160:163], a[108:111], v[96:99]
  s_xor_b32 s92, s88, 851968
  ds_read_b128 v[224:227], v165 offset:192
  ds_read_b128 v[208:211], v165 offset:256
  v_mfma_f32_16x16x32_bf16 v[32:35], a[160:163], a[112:115], v[32:35]
  buffer_load_dwordx4 v186, s[12:15], s92 offen lds
  v_mfma_f32_16x16x32_bf16 v[32:35], a[136:139], a[92:95], v[32:35]
  ds_read_b128 v[228:231], v165 offset:320
  ds_read_b128 v[212:215], v165 offset:384
  v_mfma_f32_16x16x32_bf16 v[36:39], a[136:139], a[96:99], v[36:39]
  ds_read_b128 v[232:235], v165 offset:448
  s_and_b32 s43, s50, 7
  v_mfma_f32_16x16x32_bf16 v[36:39], a[160:163], a[116:119], v[36:39]
  s_add_u32 m0, s89, 57344
  s_or_b32 s43, s43, s57
  s_cselect_b64 s[46:47], -1, 0
  v_mfma_f32_16x16x32_bf16 v[40:43], a[160:163], a[120:123], v[40:43]
  s_xor_b32 s92, s88, 917504
  v_mov_b32 v245, 0xf149f2ca
  v_mfma_f32_16x16x32_bf16 v[40:43], a[136:139], a[100:103], v[40:43]
  s_waitcnt lgkmcnt(10)
  buffer_load_dwordx4 v186, s[12:15], s92 offen lds
  v_mfma_f32_16x16x32_bf16 v[44:47], a[136:139], a[104:107], v[44:47]
  v_fmac_f32 v12, v168, v196
  v_fmac_f32 v13, v169, v196
  v_mfma_f32_16x16x32_bf16 v[44:47], a[160:163], a[124:127], v[44:47]
  v_fmac_f32 v14, v170, v196
  v_fmac_f32 v15, v171, v196
  v_mfma_f32_16x16x32_bf16 v[60:63], a[164:167], a[124:127], v[60:63]
  s_add_u32 m0, s89, 61440
  v_fmac_f32 v28, v172, v196
  v_fmac_f32 v29, v173, v196
  v_mfma_f32_16x16x32_bf16 v[60:63], a[140:143], a[104:107], v[60:63]
  s_xor_b32 s92, s88, 983040
  v_fmac_f32 v30, v174, v196
  v_fmac_f32 v31, v175, v196
  v_mfma_f32_16x16x32_bf16 v[56:59], a[140:143], a[100:103], v[56:59]
  buffer_load_dwordx4 v186, s[12:15], s92 offen lds
  v_mfma_f32_16x16x32_bf16 v[56:59], a[164:167], a[120:123], v[56:59]
  v_cvt_pk_bf16_f32 v12, v12, v13
  v_cvt_pk_bf16_f32 v13, v14, v15
  v_mfma_f32_16x16x32_bf16 v[52:55], a[164:167], a[116:119], v[52:55]
  v_cvt_pk_bf16_f32 v14, v28, v29
  v_cvt_pk_bf16_f32 v15, v30, v31
  v_mfma_f32_16x16x32_bf16 v[52:55], a[140:143], a[96:99], v[52:55]
  s_add_u32 m0, s89, 65536
  v_fmac_f32 v8, v168, v194
  v_fmac_f32 v9, v169, v194
  v_mfma_f32_16x16x32_bf16 v[48:51], a[140:143], a[92:95], v[48:51]
  s_xor_b32 s92, s88, 1048576
  v_fmac_f32 v10, v170, v194
  v_fmac_f32 v11, v171, v194
  v_mfma_f32_16x16x32_bf16 v[48:51], a[164:167], a[112:115], v[48:51]
  buffer_load_dwordx4 v186, s[12:15], s92 offen lds
  v_mfma_f32_16x16x32_bf16 v[100:103], a[108:111], a[168:171], v[100:103]
  v_fmac_f32 v24, v172, v194
  v_fmac_f32 v25, v173, v194
  v_mfma_f32_16x16x32_bf16 v[100:103], a[88:91], a[144:147], v[100:103]
  v_fmac_f32 v26, v174, v194
  v_fmac_f32 v27, v175, v194
  v_mfma_f32_16x16x32_bf16 v[64:67], a[92:95], a[144:147], v[64:67]
  s_add_u32 m0, s89, 69632
  v_cvt_pk_bf16_f32 v8, v8, v9
  v_cvt_pk_bf16_f32 v9, v10, v11
  v_mfma_f32_16x16x32_bf16 v[64:67], a[112:115], a[168:171], v[64:67]
  s_xor_b32 s92, s88, 1114112
  v_cvt_pk_bf16_f32 v10, v24, v25
  v_cvt_pk_bf16_f32 v11, v26, v27
  v_mfma_f32_16x16x32_bf16 v[68:71], a[116:119], a[168:171], v[68:71]
  buffer_load_dwordx4 v186, s[12:15], s92 offen lds
  v_mfma_f32_16x16x32_bf16 v[68:71], a[96:99], a[144:147], v[68:71]
  v_fmac_f32 v4, v168, v192
  v_fmac_f32 v5, v169, v192
  v_mfma_f32_16x16x32_bf16 v[72:75], a[100:103], a[144:147], v[72:75]
  v_fmac_f32 v6, v170, v192
  v_fmac_f32 v7, v171, v192
  v_mfma_f32_16x16x32_bf16 v[72:75], a[120:123], a[168:171], v[72:75]
  s_add_u32 m0, s89, 0
  v_fmac_f32 v20, v172, v192
  v_fmac_f32 v21, v173, v192
  v_mfma_f32_16x16x32_bf16 v[76:79], a[124:127], a[168:171], v[76:79]
  s_xor_b32 s92, s88, 0
  v_fmac_f32 v22, v174, v192
  v_fmac_f32 v23, v175, v192
  v_mfma_f32_16x16x32_bf16 v[76:79], a[104:107], a[144:147], v[76:79]
  buffer_load_dwordx4 v186, s[12:15], s92 offen lds
  v_mfma_f32_16x16x32_bf16 v[92:95], a[104:107], a[148:151], v[92:95]
  v_cvt_pk_bf16_f32 v4, v4, v5
  v_cvt_pk_bf16_f32 v5, v6, v7
  v_mfma_f32_16x16x32_bf16 v[92:95], a[124:127], a[172:175], v[92:95]
  v_cvt_pk_bf16_f32 v6, v20, v21
  v_cvt_pk_bf16_f32 v7, v22, v23
  v_mfma_f32_16x16x32_bf16 v[88:91], a[120:123], a[172:175], v[88:91]
  s_add_u32 m0, s89, 4096
  v_fmac_f32 v0, v168, v190
  v_fmac_f32 v1, v169, v190
  v_mfma_f32_16x16x32_bf16 v[88:91], a[100:103], a[148:151], v[88:91]
  s_xor_b32 s92, s88, 65536
  v_fmac_f32 v2, v170, v190
  v_fmac_f32 v3, v171, v190
  v_mfma_f32_16x16x32_bf16 v[84:87], a[96:99], a[148:151], v[84:87]
  buffer_load_dwordx4 v186, s[12:15], s92 offen lds
  v_mfma_f32_16x16x32_bf16 v[84:87], a[116:119], a[172:175], v[84:87]
  v_fmac_f32 v16, v172, v190
  v_fmac_f32 v17, v173, v190
  v_mfma_f32_16x16x32_bf16 v[80:83], a[112:115], a[172:175], v[80:83]
  v_fmac_f32 v18, v174, v190
  v_fmac_f32 v19, v175, v190
  v_mfma_f32_16x16x32_bf16 v[80:83], a[92:95], a[148:151], v[80:83]
  v_cvt_pk_bf16_f32 v0, v0, v1
  v_cvt_pk_bf16_f32 v1, v2, v3
Lmk_p1epi:
  v_cvt_pk_bf16_f32 v2, v16, v17
  v_cvt_pk_bf16_f32 v3, v18, v19
  v_cndmask_b32 v136, v245, v132, s[46:47]
  v_mov_b32 v160, 0x3f803f80
  v_mul_f32 v108, 0x3e8293ee, v191
  v_cndmask_b32 v137, v245, v133, s[46:47]
  v_mov_b32 v161, 0x3f803f80
  v_mul_f32 v109, 0x3e8293ee, v193
  v_cndmask_b32 v138, v245, v134, s[46:47]
  v_mov_b32 v162, 0x3f803f80
  v_mul_f32 v110, 0x3e8293ee, v195
  v_cndmask_b32 v139, v245, v135, s[46:47]
  v_mov_b32 v163, 0x3f803f80
  v_mul_f32 v111, 0x3e8293ee, v197
  s_waitcnt lgkmcnt(0)
  v_pk_fma_f32 v[96:97], v[176:177], v[188:189], v[96:97] op_sel:[0,0,0] op_sel_hi:[1,0,1]
  v_pk_fma_f32 v[98:99], v[178:179], v[188:189], v[98:99] op_sel:[0,0,0] op_sel_hi:[1,0,1]
  v_pk_mul_f32 v[96:97], v[96:97], v[188:189] op_sel:[0,1] op_sel_hi:[1,1]
  v_pk_mul_f32 v[98:99], v[98:99], v[188:189] op_sel:[0,1] op_sel_hi:[1,1]
  v_cvt_pk_bf16_f32 v96, v96, v97
  v_cvt_pk_bf16_f32 v97, v98, v99
  v_pk_fma_f32 v[44:45], v[176:177], v[196:197], v[44:45] op_sel:[0,0,0] op_sel_hi:[1,0,1]
  v_pk_fma_f32 v[46:47], v[178:179], v[196:197], v[46:47] op_sel:[0,0,0] op_sel_hi:[1,0,1]
  v_pk_fma_f32 v[60:61], v[180:181], v[196:197], v[60:61] op_sel:[0,0,0] op_sel_hi:[1,0,1]
  v_pk_fma_f32 v[62:63], v[182:183], v[196:197], v[62:63] op_sel:[0,0,0] op_sel_hi:[1,0,1]
  v_pk_mul_f32 v[44:45], v[44:45], v[196:197] op_sel:[0,1] op_sel_hi:[1,1]
  v_pk_mul_f32 v[46:47], v[46:47], v[196:197] op_sel:[0,1] op_sel_hi:[1,1]
  v_pk_mul_f32 v[60:61], v[60:61], v[196:197] op_sel:[0,1] op_sel_hi:[1,1]
  v_pk_mul_f32 v[62:63], v[62:63], v[196:197] op_sel:[0,1] op_sel_hi:[1,1]
  v_cvt_pk_bf16_f32 v44, v44, v45
  v_cvt_pk_bf16_f32 v45, v46, v47
  v_cvt_pk_bf16_f32 v46, v60, v61
  v_cvt_pk_bf16_f32 v47, v62, v63
  v_pk_fma_f32 v[100:101], v[200:201], v[184:185], v[100:101] op_sel:[0,0,0] op_sel_hi:[1,0,1]
  v_pk_fma_f32 v[102:103], v[202:203], v[184:185], v[102:103] op_sel:[0,0,0] op_sel_hi:[1,0,1]
  v_pk_mul_f32 v[100:101], v[100:101], v[220:221]
  v_pk_mul_f32 v[102:103], v[102:103], v[222:223]
  v_cvt_pk_bf16_f32 v100, v100, v101
  v_cvt_pk_bf16_f32 v101, v102, v103
  v_pk_fma_f32 v[76:77], v[216:217], v[184:185], v[76:77] op_sel:[0,0,0] op_sel_hi:[1,0,1]
  v_pk_fma_f32 v[78:79], v[218:219], v[184:185], v[78:79] op_sel:[0,0,0] op_sel_hi:[1,0,1]
  v_pk_fma_f32 v[92:93], v[216:217], v[184:185], v[92:93] op_sel:[0,1,0] op_sel_hi:[1,1,1]
  v_pk_fma_f32 v[94:95], v[218:219], v[184:185], v[94:95] op_sel:[0,1,0] op_sel_hi:[1,1,1]
  v_pk_mul_f32 v[76:77], v[76:77], v[236:237]
  v_pk_mul_f32 v[78:79], v[78:79], v[238:239]
  v_pk_mul_f32 v[92:93], v[92:93], v[236:237]
  v_pk_mul_f32 v[94:95], v[94:95], v[238:239]
  v_cvt_pk_bf16_f32 v148, v76, v77
  v_cvt_pk_bf16_f32 v149, v78, v79
  v_cvt_pk_bf16_f32 v158, v92, v93
  v_cvt_pk_bf16_f32 v159, v94, v95
  ds_write2st64_b64 v105, v[96:97], v[100:101] offset0:0 offset1:1
  ds_write2st64_b64 v105, v[44:45], v[148:149] offset0:4 offset1:5
  ds_write2st64_b64 v105, v[46:47], v[158:159] offset0:6 offset1:7
  s_add_u32 m0, s89, 8192
  s_xor_b32 s92, s88, 131072
  buffer_load_dwordx4 v186, s[12:15], s92 offen lds
  v_pk_fma_f32 v[40:41], v[176:177], v[194:195], v[40:41] op_sel:[0,0,0] op_sel_hi:[1,0,1]
  v_pk_fma_f32 v[42:43], v[178:179], v[194:195], v[42:43] op_sel:[0,0,0] op_sel_hi:[1,0,1]
  v_pk_fma_f32 v[56:57], v[180:181], v[194:195], v[56:57] op_sel:[0,0,0] op_sel_hi:[1,0,1]
  v_pk_fma_f32 v[58:59], v[182:183], v[194:195], v[58:59] op_sel:[0,0,0] op_sel_hi:[1,0,1]
  v_pk_mul_f32 v[40:41], v[40:41], v[194:195] op_sel:[0,1] op_sel_hi:[1,1]
  v_pk_mul_f32 v[42:43], v[42:43], v[194:195] op_sel:[0,1] op_sel_hi:[1,1]
  v_pk_mul_f32 v[56:57], v[56:57], v[194:195] op_sel:[0,1] op_sel_hi:[1,1]
  v_pk_mul_f32 v[58:59], v[58:59], v[194:195] op_sel:[0,1] op_sel_hi:[1,1]
  v_cvt_pk_bf16_f32 v40, v40, v41
  v_cvt_pk_bf16_f32 v41, v42, v43
  v_cvt_pk_bf16_f32 v42, v56, v57
  v_cvt_pk_bf16_f32 v43, v58, v59
  s_add_u32 m0, s89, 12288
  s_xor_b32 s92, s88, 196608
  buffer_load_dwordx4 v186, s[12:15], s92 offen lds
  v_pk_fma_f32 v[36:37], v[176:177], v[192:193], v[36:37] op_sel:[0,0,0] op_sel_hi:[1,0,1]
  v_pk_fma_f32 v[38:39], v[178:179], v[192:193], v[38:39] op_sel:[0,0,0] op_sel_hi:[1,0,1]
  v_pk_fma_f32 v[52:53], v[180:181], v[192:193], v[52:53] op_sel:[0,0,0] op_sel_hi:[1,0,1]
  v_pk_fma_f32 v[54:55], v[182:183], v[192:193], v[54:55] op_sel:[0,0,0] op_sel_hi:[1,0,1]
  v_pk_mul_f32 v[36:37], v[36:37], v[192:193] op_sel:[0,1] op_sel_hi:[1,1]
  v_pk_mul_f32 v[38:39], v[38:39], v[192:193] op_sel:[0,1] op_sel_hi:[1,1]
  v_pk_mul_f32 v[52:53], v[52:53], v[192:193] op_sel:[0,1] op_sel_hi:[1,1]
  v_pk_mul_f32 v[54:55], v[54:55], v[192:193] op_sel:[0,1] op_sel_hi:[1,1]
  v_cvt_pk_bf16_f32 v36, v36, v37
  v_cvt_pk_bf16_f32 v37, v38, v39
  v_cvt_pk_bf16_f32 v38, v52, v53
  v_cvt_pk_bf16_f32 v39, v54, v55
  s_add_u32 m0, s89, 16384
  s_xor_b32 s92, s88, 262144
  buffer_load_dwordx4 v186, s[12:15], s92 offen lds
  v_pk_fma_f32 v[32:33], v[176:177], v[190:191], v[32:33] op_sel:[0,0,0] op_sel_hi:[1,0,1]
  v_pk_fma_f32 v[34:35], v[178:179], v[190:191], v[34:35] op_sel:[0,0,0] op_sel_hi:[1,0,1]
  v_pk_fma_f32 v[48:49], v[180:181], v[190:191], v[48:49] op_sel:[0,0,0] op_sel_hi:[1,0,1]
  v_pk_fma_f32 v[50:51], v[182:183], v[190:191], v[50:51] op_sel:[0,0,0] op_sel_hi:[1,0,1]
  v_pk_mul_f32 v[32:33], v[32:33], v[190:191] op_sel:[0,1] op_sel_hi:[1,1]
  v_pk_mul_f32 v[34:35], v[34:35], v[190:191] op_sel:[0,1] op_sel_hi:[1,1]
  v_pk_mul_f32 v[48:49], v[48:49], v[190:191] op_sel:[0,1] op_sel_hi:[1,1]
  v_pk_mul_f32 v[50:51], v[50:51], v[190:191] op_sel:[0,1] op_sel_hi:[1,1]
  v_cvt_pk_bf16_f32 v32, v32, v33
  v_cvt_pk_bf16_f32 v33, v34, v35
  v_cvt_pk_bf16_f32 v34, v48, v49
  v_cvt_pk_bf16_f32 v35, v50, v51
  s_waitcnt lgkmcnt(0)
  s_barrier
  ds_read_b64 v[120:121], v198
  ds_read_b64 v[122:123], v199
  ds_read_b64 v[140:141], v198 offset:512
  ds_read_b64 v[150:151], v199 offset:512
  v_mfma_f32_16x16x32_bf16 v[60:63], v[44:47], v[12:15], v[128:131]
  v_mfma_f32_16x16x32_bf16 v[28:31], v[40:43], v[12:15], v[132:135]
  v_mfma_f32_16x16x32_bf16 v[56:59], v[40:43], v[8:11], v[128:131]
  v_mfma_f32_16x16x32_bf16 v[24:27], v[36:39], v[8:11], v[132:135]
  v_mfma_f32_16x16x32_bf16 v[52:55], v[36:39], v[4:7], v[128:131]
  v_mfma_f32_16x16x32_bf16 v[20:23], v[32:35], v[4:7], v[132:135]
  v_mfma_f32_16x16x32_bf16 v[48:51], v[32:35], v[0:3], v[128:131]
  s_waitcnt lgkmcnt(0)
  v_mfma_f32_16x16x32_bf16 v[16:19], v[120:123], v[0:3], v[136:139]
  s_add_u32 m0, s89, 20480
  s_xor_b32 s92, s88, 327680
  buffer_load_dwordx4 v186, s[12:15], s92 offen lds
  v_pk_fma_f32 v[64:65], v[204:205], v[184:185], v[64:65] op_sel:[0,0,0] op_sel_hi:[1,0,1]
  v_pk_fma_f32 v[66:67], v[206:207], v[184:185], v[66:67] op_sel:[0,0,0] op_sel_hi:[1,0,1]
  v_pk_fma_f32 v[80:81], v[204:205], v[184:185], v[80:81] op_sel:[0,1,0] op_sel_hi:[1,1,1]
  v_pk_fma_f32 v[82:83], v[206:207], v[184:185], v[82:83] op_sel:[0,1,0] op_sel_hi:[1,1,1]
  v_pk_mul_f32 v[64:65], v[64:65], v[224:225]
  v_pk_mul_f32 v[66:67], v[66:67], v[226:227]
  v_pk_mul_f32 v[80:81], v[80:81], v[224:225]
  v_pk_mul_f32 v[82:83], v[82:83], v[226:227]
  v_cvt_pk_bf16_f32 v142, v64, v65
  v_cvt_pk_bf16_f32 v143, v66, v67
  v_cvt_pk_bf16_f32 v152, v80, v81
  v_cvt_pk_bf16_f32 v153, v82, v83
  v_pk_fma_f32 v[68:69], v[208:209], v[184:185], v[68:69] op_sel:[0,0,0] op_sel_hi:[1,0,1]
  v_pk_fma_f32 v[70:71], v[210:211], v[184:185], v[70:71] op_sel:[0,0,0] op_sel_hi:[1,0,1]
  v_pk_fma_f32 v[84:85], v[208:209], v[184:185], v[84:85] op_sel:[0,1,0] op_sel_hi:[1,1,1]
  v_pk_fma_f32 v[86:87], v[210:211], v[184:185], v[86:87] op_sel:[0,1,0] op_sel_hi:[1,1,1]
  v_pk_mul_f32 v[68:69], v[68:69], v[228:229]
  v_pk_mul_f32 v[70:71], v[70:71], v[230:231]
  v_pk_mul_f32 v[84:85], v[84:85], v[228:229]
  v_pk_mul_f32 v[86:87], v[86:87], v[230:231]
  v_cvt_pk_bf16_f32 v144, v68, v69
  v_cvt_pk_bf16_f32 v145, v70, v71
  v_cvt_pk_bf16_f32 v154, v84, v85
  v_cvt_pk_bf16_f32 v155, v86, v87
  v_pk_fma_f32 v[72:73], v[212:213], v[184:185], v[72:73] op_sel:[0,0,0] op_sel_hi:[1,0,1]
  v_pk_fma_f32 v[74:75], v[214:215], v[184:185], v[74:75] op_sel:[0,0,0] op_sel_hi:[1,0,1]
  v_pk_fma_f32 v[88:89], v[212:213], v[184:185], v[88:89] op_sel:[0,1,0] op_sel_hi:[1,1,1]
  v_pk_fma_f32 v[90:91], v[214:215], v[184:185], v[90:91] op_sel:[0,1,0] op_sel_hi:[1,1,1]
  v_pk_mul_f32 v[72:73], v[72:73], v[232:233]
  v_pk_mul_f32 v[74:75], v[74:75], v[234:235]
  v_pk_mul_f32 v[88:89], v[88:89], v[232:233]
  v_pk_mul_f32 v[90:91], v[90:91], v[234:235]
  v_cvt_pk_bf16_f32 v146, v72, v73
  v_cvt_pk_bf16_f32 v147, v74, v75
  v_cvt_pk_bf16_f32 v156, v88, v89
  v_cvt_pk_bf16_f32 v157, v90, v91
  s_cmp_eq_u32 s57, 0
  s_cbranch_scc1 Lp1_nsw
  v_swap_b32 v140, v150
  v_swap_b32 v141, v151
  v_swap_b32 v142, v152
  v_swap_b32 v143, v153
  v_swap_b32 v144, v154
  v_swap_b32 v145, v155
  v_swap_b32 v146, v156
  v_swap_b32 v147, v157
  v_swap_b32 v148, v158
  v_swap_b32 v149, v159
Lp1_nsw:
  v_max3_f32 v240, v16, v17, v18
  v_max3_f32 v241, v20, v21, v22
  v_max3_f32 v242, v24, v25, v26
  v_max3_f32 v243, v28, v29, v30
  v_max3_f32 v240, v240, v19, v48
  v_max3_f32 v241, v241, v23, v52
  v_max3_f32 v242, v242, v27, v56
  v_max3_f32 v243, v243, v31, v60
  v_max3_f32 v240, v240, v49, v50
  v_max3_f32 v241, v241, v53, v54
  v_max3_f32 v242, v242, v57, v58
  v_max3_f32 v243, v243, v61, v62
  v_max_f32 v240, v240, v51
  v_max_f32 v241, v241, v55
  v_max_f32 v242, v242, v59
  v_max_f32 v243, v243, v63
  v_mov_b32 v244, v240
  v_mov_b32 v245, v241
  v_mov_b32 v246, v242
  v_mov_b32 v247, v243
  v_permlane32_swap_b32 v240, v244
  v_permlane32_swap_b32 v241, v245
  v_permlane32_swap_b32 v242, v246
  v_permlane32_swap_b32 v243, v247
  v_max_f32 v240, v240, v244
  v_max_f32 v241, v241, v245
  v_max_f32 v242, v242, v246
  v_max_f32 v243, v243, v247
  v_mov_b32 v244, v240
  v_mov_b32 v245, v241
  v_mov_b32 v246, v242
  v_mov_b32 v247, v243
  v_permlane16_swap_b32 v240, v244
  v_permlane16_swap_b32 v241, v245
  v_permlane16_swap_b32 v242, v246
  v_permlane16_swap_b32 v243, v247
  v_max_f32 v240, v240, v244
  v_max_f32 v241, v241, v245
  v_max_f32 v242, v242, v246
  v_max_f32 v243, v243, v247
  v_pk_mul_f32 v[240:241], v[240:241], v[108:109] neg_lo:[0,1] neg_hi:[0,1]
  v_pk_mul_f32 v[242:243], v[242:243], v[110:111] neg_lo:[0,1] neg_hi:[0,1]
  v_pk_fma_f32 v[16:17], v[16:17], v[108:109], v[240:241] op_sel:[0,0,0] op_sel_hi:[1,0,0]
  v_pk_fma_f32 v[18:19], v[18:19], v[108:109], v[240:241] op_sel:[0,0,0] op_sel_hi:[1,0,0]
  v_pk_fma_f32 v[48:49], v[48:49], v[108:109], v[240:241] op_sel:[0,0,0] op_sel_hi:[1,0,0]
  v_pk_fma_f32 v[50:51], v[50:51], v[108:109], v[240:241] op_sel:[0,0,0] op_sel_hi:[1,0,0]
  v_exp_f32 v16, v16
  v_exp_f32 v17, v17
  v_exp_f32 v18, v18
  v_exp_f32 v19, v19
  v_exp_f32 v48, v48
  v_exp_f32 v49, v49
  v_exp_f32 v50, v50
  v_exp_f32 v51, v51
  v_cvt_pk_bf16_f32 v0, v16, v17
  v_cvt_pk_bf16_f32 v1, v18, v19
  v_cvt_pk_bf16_f32 v2, v48, v49
  v_cvt_pk_bf16_f32 v3, v50, v51
  v_pk_fma_f32 v[20:21], v[20:21], v[108:109], v[240:241] op_sel:[0,1,1] op_sel_hi:[1,1,1]
  v_pk_fma_f32 v[22:23], v[22:23], v[108:109], v[240:241] op_sel:[0,1,1] op_sel_hi:[1,1,1]
  v_pk_fma_f32 v[52:53], v[52:53], v[108:109], v[240:241] op_sel:[0,1,1] op_sel_hi:[1,1,1]
  v_pk_fma_f32 v[54:55], v[54:55], v[108:109], v[240:241] op_sel:[0,1,1] op_sel_hi:[1,1,1]
  v_exp_f32 v20, v20
  v_exp_f32 v21, v21
  v_exp_f32 v22, v22
  v_exp_f32 v23, v23
  v_exp_f32 v52, v52
  v_exp_f32 v53, v53
  v_exp_f32 v54, v54
  v_exp_f32 v55, v55
  v_cvt_pk_bf16_f32 v4, v20, v21
  v_cvt_pk_bf16_f32 v5, v22, v23
  v_cvt_pk_bf16_f32 v6, v52, v53
  v_cvt_pk_bf16_f32 v7, v54, v55
  v_pk_fma_f32 v[24:25], v[24:25], v[110:111], v[242:243] op_sel:[0,0,0] op_sel_hi:[1,0,0]
  v_pk_fma_f32 v[26:27], v[26:27], v[110:111], v[242:243] op_sel:[0,0,0] op_sel_hi:[1,0,0]
  v_pk_fma_f32 v[56:57], v[56:57], v[110:111], v[242:243] op_sel:[0,0,0] op_sel_hi:[1,0,0]
  v_pk_fma_f32 v[58:59], v[58:59], v[110:111], v[242:243] op_sel:[0,0,0] op_sel_hi:[1,0,0]
  v_exp_f32 v24, v24
  v_exp_f32 v25, v25
  v_exp_f32 v26, v26
  v_exp_f32 v27, v27
  v_exp_f32 v56, v56
  v_exp_f32 v57, v57
  v_exp_f32 v58, v58
  v_exp_f32 v59, v59
  v_cvt_pk_bf16_f32 v8, v24, v25
  v_cvt_pk_bf16_f32 v9, v26, v27
  v_cvt_pk_bf16_f32 v10, v56, v57
  v_cvt_pk_bf16_f32 v11, v58, v59
  v_pk_fma_f32 v[28:29], v[28:29], v[110:111], v[242:243] op_sel:[0,1,1] op_sel_hi:[1,1,1]
  v_pk_fma_f32 v[30:31], v[30:31], v[110:111], v[242:243] op_sel:[0,1,1] op_sel_hi:[1,1,1]
  v_pk_fma_f32 v[60:61], v[60:61], v[110:111], v[242:243] op_sel:[0,1,1] op_sel_hi:[1,1,1]
  v_pk_fma_f32 v[62:63], v[62:63], v[110:111], v[242:243] op_sel:[0,1,1] op_sel_hi:[1,1,1]
  v_exp_f32 v28, v28
  v_exp_f32 v29, v29
  v_exp_f32 v30, v30
  v_exp_f32 v31, v31
  v_exp_f32 v60, v60
  v_exp_f32 v61, v61
  v_exp_f32 v62, v62
  v_exp_f32 v63, v63
  v_cvt_pk_bf16_f32 v12, v28, v29
  v_cvt_pk_bf16_f32 v13, v30, v31
  v_cvt_pk_bf16_f32 v14, v60, v61
  v_cvt_pk_bf16_f32 v15, v62, v63
  v_mfma_f32_16x16x32_bf16 v[32:35], v[160:163], v[0:3], 0
  s_lshl_b32 s43, s74, 15
  s_lshl_b32 s44, s75, 10
  v_mfma_f32_16x16x32_bf16 v[36:39], v[160:163], v[4:7], 0
  s_add_u32 s43, s43, s44
  s_add_u32 s43, s43, s42
  v_mfma_f32_16x16x32_bf16 v[40:43], v[160:163], v[8:11], 0
  s_add_u32 s46, s43, 8388608
  s_add_u32 s47, s46, 32768
  v_mfma_f32_16x16x32_bf16 v[44:47], v[160:163], v[12:15], 0
  s_add_u32 s48, s47, 32768
  s_add_u32 s49, s48, 32768
  v_mfma_f32_16x16x32_bf16 v[64:67], v[140:143], v[0:3], 0
  s_lshl_b32 s77, s50, 1
  v_mfma_f32_16x16x32_bf16 v[80:83], v[150:153], v[0:3], 0
  s_lshr_b32 s43, s51, 3
  v_mfma_f32_16x16x32_bf16 v[68:71], v[142:145], v[4:7], 0
  s_add_u32 s77, s77, s43
  v_mfma_f32_16x16x32_bf16 v[84:87], v[152:155], v[4:7], 0
  s_lshl_b32 s77, s77, 7
  v_mfma_f32_16x16x32_bf16 v[72:75], v[144:147], v[8:11], 0
  s_add_u32 s77, s77, s42
  v_rcp_f32 v32, v32
  v_mfma_f32_16x16x32_bf16 v[88:91], v[154:157], v[8:11], 0
  s_add_u32 s77, s77, 27787264
  v_rcp_f32 v36, v36
  v_mfma_f32_16x16x32_bf16 v[76:79], v[146:149], v[12:15], 0
  v_rcp_f32 v40, v40
  v_mfma_f32_16x16x32_bf16 v[92:95], v[156:159], v[12:15], 0
  v_rcp_f32 v44, v44
  v_pk_mul_f32 v[64:65], v[64:65], v[32:33] op_sel:[0,0] op_sel_hi:[1,0]
  v_pk_mul_f32 v[66:67], v[66:67], v[32:33] op_sel:[0,0] op_sel_hi:[1,0]
  v_pk_mul_f32 v[80:81], v[80:81], v[32:33] op_sel:[0,0] op_sel_hi:[1,0]
  v_pk_mul_f32 v[82:83], v[82:83], v[32:33] op_sel:[0,0] op_sel_hi:[1,0]
  v_cvt_pk_bf16_f32 v16, v64, v65
  v_cvt_pk_bf16_f32 v17, v66, v67
  v_cvt_pk_bf16_f32 v18, v80, v81
  v_cvt_pk_bf16_f32 v19, v82, v83
  buffer_store_dwordx4 v[16:19], v104, s[4:7], s46 offen sc1
  v_pk_mul_f32 v[68:69], v[68:69], v[36:37] op_sel:[0,0] op_sel_hi:[1,0]
  v_pk_mul_f32 v[70:71], v[70:71], v[36:37] op_sel:[0,0] op_sel_hi:[1,0]
  v_pk_mul_f32 v[84:85], v[84:85], v[36:37] op_sel:[0,0] op_sel_hi:[1,0]
  v_pk_mul_f32 v[86:87], v[86:87], v[36:37] op_sel:[0,0] op_sel_hi:[1,0]
  v_cvt_pk_bf16_f32 v20, v68, v69
  v_cvt_pk_bf16_f32 v21, v70, v71
  v_cvt_pk_bf16_f32 v22, v84, v85
  v_cvt_pk_bf16_f32 v23, v86, v87
  buffer_store_dwordx4 v[20:23], v104, s[4:7], s47 offen sc1
  v_pk_mul_f32 v[72:73], v[72:73], v[40:41] op_sel:[0,0] op_sel_hi:[1,0]
  v_pk_mul_f32 v[74:75], v[74:75], v[40:41] op_sel:[0,0] op_sel_hi:[1,0]
  v_pk_mul_f32 v[88:89], v[88:89], v[40:41] op_sel:[0,0] op_sel_hi:[1,0]
  v_pk_mul_f32 v[90:91], v[90:91], v[40:41] op_sel:[0,0] op_sel_hi:[1,0]
  v_cvt_pk_bf16_f32 v24, v72, v73
  v_cvt_pk_bf16_f32 v25, v74, v75
  v_cvt_pk_bf16_f32 v26, v88, v89
  v_cvt_pk_bf16_f32 v27, v90, v91
  buffer_store_dwordx4 v[24:27], v104, s[4:7], s48 offen sc1
  v_pk_mul_f32 v[76:77], v[76:77], v[44:45] op_sel:[0,0] op_sel_hi:[1,0]
  v_pk_mul_f32 v[78:79], v[78:79], v[44:45] op_sel:[0,0] op_sel_hi:[1,0]
  v_pk_mul_f32 v[92:93], v[92:93], v[44:45] op_sel:[0,0] op_sel_hi:[1,0]
  v_pk_mul_f32 v[94:95], v[94:95], v[44:45] op_sel:[0,0] op_sel_hi:[1,0]
  v_cvt_pk_bf16_f32 v28, v76, v77
  v_cvt_pk_bf16_f32 v29, v78, v79
  v_cvt_pk_bf16_f32 v30, v92, v93
  v_cvt_pk_bf16_f32 v31, v94, v95
  buffer_store_dwordx4 v[28:31], v104, s[4:7], s49 offen sc1
Lmk_p1end:
  s_lshl_b32 s44, s52, 3
  s_lshl_b32 s43, s40, 1
  s_add_u32 s44, s44, s43
  s_lshl_b32 s45, s44, 15
  s_add_u32 s57, s45, s42
  s_add_u32 s57, s57, 8388608
  s_lshl_b32 s43, s53, 11
  s_add_u32 s45, s45, s43
  s_add_u32 s45, s45, s42
  s_add_u32 s58, s45, 4194304
  s_add_u32 s59, s58, 32768
  s_lshl_b32 s44, s44, 11
  s_lshl_b32 s43, s53, 7
  s_add_u32 s44, s44, s43
  s_add_u32 s44, s44, s42
  s_add_u32 s60, s44, 27525120
  v_lshlrev_b32 v48, 4, v253
  v_add_u32 v49, 32768, v48
  s_cmp_eq_u32 s41, 0
  s_cselect_b32 s44, 32, 8
  s_cselect_b32 s45, 64, 0x400
  s_lshl_b32 s43, s40, 12
  s_add_u32 s43, s43, 90112
  v_xor_b32 v3, s44, v187
  v_xor_b32 v4, s45, v187
  v_xor_b32 v5, s45, v3
  v_add_u32 v2, s43, v187
  v_add_u32 v3, s43, v3
  v_add_u32 v4, s43, v4
  v_add_u32 v5, s43, v5
  s_waitcnt vmcnt(18)
  ds_read_b64 v[52:53], v2 offset:0
  ds_read_b64 v[54:55], v3 offset:0
  ds_read_b64 v[56:57], v4 offset:0
  ds_read_b64 v[58:59], v5 offset:0
  ds_read_b64 v[60:61], v2 offset:2048
  ds_read_b64 v[62:63], v3 offset:2048
  ds_read_b64 v[64:65], v4 offset:2048
  ds_read_b64 v[66:67], v5 offset:2048
  v_lshrrev_b32 v2, 2, v253
  v_bfe_u32 v3, v253, 3, 2
  v_and_b32 v4, 3, v253
  v_lshlrev_b32 v4, 3, v4
  v_lshl_add_u32 v4, v2, 7, v4
  v_xor_b32 v5, 0, v3
  v_lshl_add_u32 v40, v5, 5, v4
  v_xor_b32 v5, 1, v3
  v_lshl_add_u32 v41, v5, 5, v4
  v_xor_b32 v5, 2, v3
  v_lshl_add_u32 v42, v5, 5, v4
  v_xor_b32 v5, 3, v3
  v_lshl_add_u32 v43, v5, 5, v4
  s_cmp_lg_u32 s3, 0
  s_cbranch_scc1 Lc10_c
Lc10_r:
  s_waitcnt lgkmcnt(0)
  s_waitcnt vmcnt(0)
  s_barrier
  s_cmp_lg_u32 s40, 0
  s_cbranch_scc1 Lsig9
  v_mov_b32 v250, 1
  s_mov_b64 exec, 1
  buffer_atomic_add v250, v251, s[4:7], s77 offen sc1
  s_mov_b64 exec, -1
Lsig9:
  s_add_u32 m0, s89, 24576
  s_xor_b32 s92, s88, 393216
  buffer_load_dwordx4 v186, s[12:15], s92 offen lds
  s_add_u32 m0, s89, 28672
  s_xor_b32 s92, s88, 458752
  buffer_load_dwordx4 v186, s[12:15], s92 offen lds
  s_add_u32 m0, s89, 32768
  s_xor_b32 s92, s88, 524288
  buffer_load_dwordx4 v186, s[12:15], s92 offen lds
  s_add_u32 m0, s89, 36864
  s_xor_b32 s92, s88, 589824
  buffer_load_dwordx4 v186, s[12:15], s92 offen lds
  s_add_u32 m0, s89, 73728
  s_xor_b32 s92, s88, 1179648
  buffer_load_dwordx4 v186, s[12:15], s92 offen lds
  s_add_u32 m0, s89, 77824
  s_xor_b32 s92, s88, 1245184
  buffer_load_dwordx4 v186, s[12:15], s92 offen lds
  s_add_u32 m0, s89, 81920
  s_xor_b32 s92, s88, 1310720
  buffer_load_dwordx4 v186, s[12:15], s92 offen lds
  s_add_u32 m0, s89, 86016
  s_xor_b32 s92, s88, 1376256
  buffer_load_dwordx4 v186, s[12:15], s92 offen lds
  s_add_u32 m0, s89, 90112
  s_xor_b32 s92, s88, 1441792
  buffer_load_dwordx4 v186, s[12:15], s92 offen lds
  s_add_u32 m0, s89, 94208
  s_xor_b32 s92, s88, 1507328
  buffer_load_dwordx4 v186, s[12:15], s92 offen lds
  s_add_u32 m0, s89, 98304
  s_xor_b32 s92, s88, 1572864
  buffer_load_dwordx4 v186, s[12:15], s92 offen lds
  s_add_u32 m0, s89, 102400
  s_xor_b32 s92, s88, 1638400
  buffer_load_dwordx4 v186, s[12:15], s92 offen lds
  s_add_u32 m0, s89, 106496
  s_xor_b32 s92, s88, 1703936
  buffer_load_dwordx4 v186, s[12:15], s92 offen lds
  s_add_u32 m0, s89, 110592
  s_xor_b32 s92, s88, 1769472
  buffer_load_dwordx4 v186, s[12:15], s92 offen lds
  s_add_u32 m0, s89, 114688
  s_xor_b32 s92, s88, 1835008
  buffer_load_dwordx4 v186, s[12:15], s92 offen lds
  s_add_u32 m0, s89, 118784
  s_xor_b32 s92, s88, 1900544
  buffer_load_dwordx4 v186, s[12:15], s92 offen lds
  s_add_u32 m0, s89, 122880
  s_xor_b32 s92, s88, 1966080
  buffer_load_dwordx4 v186, s[12:15], s92 offen lds
  s_add_u32 m0, s89, 126976
  s_xor_b32 s92, s88, 2031616
  buffer_load_dwordx4 v186, s[12:15], s92 offen lds
  v_lshlrev_b32 v0, 16, v52
  v_and_b32 v1, 0xffff0000, v52
  v_lshlrev_b32 v2, 16, v53
  v_and_b32 v3, 0xffff0000, v53
  v_lshlrev_b32 v8, 16, v54
  v_and_b32 v9, 0xffff0000, v54
  v_lshlrev_b32 v10, 16, v55
  v_and_b32 v11, 0xffff0000, v55
  v_lshlrev_b32 v16, 16, v56
  v_and_b32 v17, 0xffff0000, v56
  v_lshlrev_b32 v18, 16, v57
  v_and_b32 v19, 0xffff0000, v57
  v_lshlrev_b32 v24, 16, v58
  v_and_b32 v25, 0xffff0000, v58
  v_lshlrev_b32 v26, 16, v59
  v_and_b32 v27, 0xffff0000, v59
  v_lshlrev_b32 v4, 16, v60
  v_and_b32 v5, 0xffff0000, v60
  v_lshlrev_b32 v6, 16, v61
  v_and_b32 v7, 0xffff0000, v61
  v_lshlrev_b32 v12, 16, v62
  v_and_b32 v13, 0xffff0000, v62
  v_lshlrev_b32 v14, 16, v63
  v_and_b32 v15, 0xffff0000, v63
  v_lshlrev_b32 v20, 16, v64
  v_and_b32 v21, 0xffff0000, v64
  v_lshlrev_b32 v22, 16, v65
  v_and_b32 v23, 0xffff0000, v65
  v_lshlrev_b32 v28, 16, v66
  v_and_b32 v29, 0xffff0000, v66
  v_lshlrev_b32 v30, 16, v67
  v_and_b32 v31, 0xffff0000, v67
  v_and_b32 v92, 15, v253
  v_lshrrev_b32 v93, 4, v253
  v_lshrrev_b32 v72, 2, v92
  v_cmp_eq_u32 vcc, v72, v93
  v_and_b32 v72, 3, v92
  v_lshlrev_b32 v92, 3, v92
  v_mov_b32 v93, 0x7ffffff0
  v_cndmask_b32 v92, v93, v92, vcc
  v_cmp_eq_u32 s[64:65], 1, v72
  v_cmp_eq_u32 s[66:67], 2, v72
  v_cmp_eq_u32 s[68:69], 3, v72
  v_mov_b32 v72, 0x3f803f80
  v_mov_b32 v73, 0x3f803f80
  v_mov_b32 v74, 0x3f803f80
  v_mov_b32 v75, 0x3f803f80
  s_cmp_lg_u32 s3, 0
  s_cbranch_scc1 Lc11_c
Lc11_r:
  s_lshl_b32 s77, s52, 8
  s_add_u32 s77, s77, 27787264
  v_lshlrev_b32 v249, 7, v253
  s_add_u32 s77, s77, s42
  s_cmp_lg_u32 s40, 0
  s_cbranch_scc1 Lpdn13
  s_mov_b32 s43, 0x40000
  s_mov_b64 exec, 3
Lpol12:
  buffer_load_dword v250, v249, s[4:7], s77 offen sc1
  s_waitcnt vmcnt(0)
  v_cmp_gt_u32 vcc, 8, v250
  s_cbranch_vccz Lpdn13x
  s_sub_u32 s43, s43, 1
  s_cmp_lg_u32 s43, 0
  s_cbranch_scc1 Lpol12
Lpdn13x:
  s_mov_b64 exec, -1
Lpdn13:
  s_waitcnt vmcnt(0) lgkmcnt(0)
  s_barrier
  s_lshr_b32 s88, s88, 6
  s_xor_b32 s93, s57, s88
  buffer_load_dwordx4 a[0:3], v48, s[4:7], s93 offen offset:0 sc1
  buffer_load_dwordx4 a[4:7], v49, s[4:7], s93 offen offset:0 sc1
  buffer_load_dwordx4 a[8:11], v48, s[4:7], s93 offen offset:1024 sc1
  buffer_load_dwordx4 a[12:15], v49, s[4:7], s93 offen offset:1024 sc1
  buffer_load_dwordx4 a[16:19], v48, s[4:7], s93 offen offset:2048 sc1
  buffer_load_dwordx4 a[20:23], v49, s[4:7], s93 offen offset:2048 sc1
  buffer_load_dwordx4 a[24:27], v48, s[4:7], s93 offen offset:3072 sc1
  buffer_load_dwordx4 a[28:31], v49, s[4:7], s93 offen offset:3072 sc1
  s_add_u32 s57, s57, 4096
  s_xor_b32 s93, s57, s88
  buffer_load_dwordx4 a[32:35], v48, s[4:7], s93 offen offset:0 sc1
  buffer_load_dwordx4 a[36:39], v49, s[4:7], s93 offen offset:0 sc1
  buffer_load_dwordx4 a[40:43], v48, s[4:7], s93 offen offset:1024 sc1
  buffer_load_dwordx4 a[44:47], v49, s[4:7], s93 offen offset:1024 sc1
  s_cmp_eq_u32 s40, 1
  s_cselect_b32 s3, s3, 0
  s_cmp_lg_u32 s3, 0
  s_cbranch_scc1 Lc14_c
Lc14_r:
  ds_read_b64_tr_b16 a[128:129], v40 offset:0
  ds_read_b64_tr_b16 a[130:131], v40 offset:2048
  ds_read_b64_tr_b16 a[144:145], v40 offset:4096
  ds_read_b64_tr_b16 a[146:147], v40 offset:6144
  ds_read_b64_tr_b16 a[132:133], v41 offset:0
  ds_read_b64_tr_b16 a[134:135], v41 offset:2048
  ds_read_b64_tr_b16 a[148:149], v41 offset:4096
  ds_read_b64_tr_b16 a[150:151], v41 offset:6144
  ds_read_b64_tr_b16 a[136:137], v42 offset:0
  ds_read_b64_tr_b16 a[138:139], v42 offset:2048
  ds_read_b64_tr_b16 a[152:153], v42 offset:4096
  ds_read_b64_tr_b16 a[154:155], v42 offset:6144
  ds_read_b64_tr_b16 a[140:141], v43 offset:0
  ds_read_b64_tr_b16 a[142:143], v43 offset:2048
  ds_read_b64_tr_b16 a[156:157], v43 offset:4096
  ds_read_b64_tr_b16 a[158:159], v43 offset:6144
  s_and_b32 s43, s53, 0
  s_mul_i32 s77, s52, 1
  s_add_u32 s77, s77, s43
  s_lshl_b32 s77, s77, 7
  s_add_u32 s77, s77, s42
  s_add_u32 s77, s77, 27791360
  s_mov_b32 s56, 3
.p2align 3
Lp2_loop:
  s_waitcnt vmcnt(8) lgkmcnt(8)
  v_mfma_f32_16x16x32_bf16 v[0:3], a[128:131], a[0:3], v[0:3]
  ds_read_b64_tr_b16 a[160:161], v40 offset:8192
  v_mfma_f32_16x16x32_bf16 v[0:3], a[144:147], a[8:11], v[0:3]
  buffer_load_dwordx4 a[48:51], v48, s[4:7], s93 offen offset:2048 sc1
  v_mfma_f32_16x16x32_bf16 v[4:7], a[144:147], a[12:15], v[4:7]
  ds_read_b64_tr_b16 a[162:163], v40 offset:10240
  ds_read_b64_tr_b16 a[176:177], v40 offset:12288
  v_mfma_f32_16x16x32_bf16 v[4:7], a[128:131], a[4:7], v[4:7]
  ds_read_b64_tr_b16 a[178:179], v40 offset:14336
  v_mfma_f32_16x16x32_bf16 v[12:15], a[132:135], a[4:7], v[12:15]
  ds_read_b64_tr_b16 a[164:165], v41 offset:8192
  v_mfma_f32_16x16x32_bf16 v[12:15], a[148:151], a[12:15], v[12:15]
  buffer_load_dwordx4 a[52:55], v49, s[4:7], s93 offen offset:2048 sc1
  v_mfma_f32_16x16x32_bf16 v[8:11], a[148:151], a[8:11], v[8:11]
  ds_read_b64_tr_b16 a[166:167], v41 offset:10240
  ds_read_b64_tr_b16 a[180:181], v41 offset:12288
  v_mfma_f32_16x16x32_bf16 v[8:11], a[132:135], a[0:3], v[8:11]
  ds_read_b64_tr_b16 a[182:183], v41 offset:14336
  s_waitcnt lgkmcnt(8)
  v_mfma_f32_16x16x32_bf16 v[16:19], a[136:139], a[0:3], v[16:19]
  ds_read_b64_tr_b16 a[168:169], v42 offset:8192
  v_mfma_f32_16x16x32_bf16 v[16:19], a[152:155], a[8:11], v[16:19]
  buffer_load_dwordx4 a[56:59], v48, s[4:7], s93 offen offset:3072 sc1
  v_mfma_f32_16x16x32_bf16 v[20:23], a[152:155], a[12:15], v[20:23]
  ds_read_b64_tr_b16 a[170:171], v42 offset:10240
  ds_read_b64_tr_b16 a[184:185], v42 offset:12288
  v_mfma_f32_16x16x32_bf16 v[20:23], a[136:139], a[4:7], v[20:23]
  ds_read_b64_tr_b16 a[186:187], v42 offset:14336
  v_mfma_f32_16x16x32_bf16 v[28:31], a[140:143], a[4:7], v[28:31]
  ds_read_b64_tr_b16 a[172:173], v43 offset:8192
  v_mfma_f32_16x16x32_bf16 v[28:31], a[156:159], a[12:15], v[28:31]
  buffer_load_dwordx4 a[60:63], v49, s[4:7], s93 offen offset:3072 sc1
  v_mfma_f32_16x16x32_bf16 v[24:27], a[156:159], a[8:11], v[24:27]
  ds_read_b64_tr_b16 a[174:175], v43 offset:10240
  ds_read_b64_tr_b16 a[188:189], v43 offset:12288
  v_mfma_f32_16x16x32_bf16 v[24:27], a[140:143], a[0:3], v[24:27]
  ds_read_b64_tr_b16 a[190:191], v43 offset:14336
  s_waitcnt vmcnt(8) lgkmcnt(8)
  v_mfma_f32_16x16x32_bf16 v[0:3], a[160:163], a[16:19], v[0:3]
  ds_read_b64_tr_b16 a[128:129], v40 offset:16384
  v_mfma_f32_16x16x32_bf16 v[0:3], a[176:179], a[24:27], v[0:3]
  s_add_u32 s57, s57, 4096
  s_xor_b32 s93, s57, s88
  buffer_load_dwordx4 a[0:3], v48, s[4:7], s93 offen offset:0 sc1
  v_mfma_f32_16x16x32_bf16 v[4:7], a[176:179], a[28:31], v[4:7]
  ds_read_b64_tr_b16 a[130:131], v40 offset:18432
  ds_read_b64_tr_b16 a[144:145], v40 offset:20480
  v_mfma_f32_16x16x32_bf16 v[4:7], a[160:163], a[20:23], v[4:7]
  ds_read_b64_tr_b16 a[146:147], v40 offset:22528
  v_mfma_f32_16x16x32_bf16 v[12:15], a[164:167], a[20:23], v[12:15]
  ds_read_b64_tr_b16 a[132:133], v41 offset:16384
  v_mfma_f32_16x16x32_bf16 v[12:15], a[180:183], a[28:31], v[12:15]
  buffer_load_dwordx4 a[4:7], v49, s[4:7], s93 offen offset:0 sc1
  v_mfma_f32_16x16x32_bf16 v[8:11], a[180:183], a[24:27], v[8:11]
  ds_read_b64_tr_b16 a[134:135], v41 offset:18432
  ds_read_b64_tr_b16 a[148:149], v41 offset:20480
  v_mfma_f32_16x16x32_bf16 v[8:11], a[164:167], a[16:19], v[8:11]
  ds_read_b64_tr_b16 a[150:151], v41 offset:22528
  s_waitcnt lgkmcnt(8)
  v_mfma_f32_16x16x32_bf16 v[16:19], a[168:171], a[16:19], v[16:19]
  ds_read_b64_tr_b16 a[136:137], v42 offset:16384
  v_mfma_f32_16x16x32_bf16 v[16:19], a[184:187], a[24:27], v[16:19]
  buffer_load_dwordx4 a[8:11], v48, s[4:7], s93 offen offset:1024 sc1
  v_mfma_f32_16x16x32_bf16 v[20:23], a[184:187], a[28:31], v[20:23]
  ds_read_b64_tr_b16 a[138:139], v42 offset:18432
  ds_read_b64_tr_b16 a[152:153], v42 offset:20480
  v_mfma_f32_16x16x32_bf16 v[20:23], a[168:171], a[20:23], v[20:23]
  ds_read_b64_tr_b16 a[154:155], v42 offset:22528
  v_mfma_f32_16x16x32_bf16 v[28:31], a[172:175], a[20:23], v[28:31]
  ds_read_b64_tr_b16 a[140:141], v43 offset:16384
  v_mfma_f32_16x16x32_bf16 v[28:31], a[188:191], a[28:31], v[28:31]
  buffer_load_dwordx4 a[12:15], v49, s[4:7], s93 offen offset:1024 sc1
  v_mfma_f32_16x16x32_bf16 v[24:27], a[188:191], a[24:27], v[24:27]
  ds_read_b64_tr_b16 a[142:143], v43 offset:18432
  ds_read_b64_tr_b16 a[156:157], v43 offset:20480
  v_mfma_f32_16x16x32_bf16 v[24:27], a[172:175], a[16:19], v[24:27]
  ds_read_b64_tr_b16 a[158:159], v43 offset:22528
  s_waitcnt vmcnt(8) lgkmcnt(8)
  v_mfma_f32_16x16x32_bf16 v[0:3], a[128:131], a[32:35], v[0:3]
  ds_read_b64_tr_b16 a[160:161], v40 offset:24576
  v_mfma_f32_16x16x32_bf16 v[0:3], a[144:147], a[40:43], v[0:3]
  buffer_load_dwordx4 a[16:19], v48, s[4:7], s93 offen offset:2048 sc1
  v_mfma_f32_16x16x32_bf16 v[4:7], a[144:147], a[44:47], v[4:7]
  ds_read_b64_tr_b16 a[162:163], v40 offset:26624
  ds_read_b64_tr_b16 a[176:177], v40 offset:28672
  v_mfma_f32_16x16x32_bf16 v[4:7], a[128:131], a[36:39], v[4:7]
  ds_read_b64_tr_b16 a[178:179], v40 offset:30720
  v_add_u32 v40, 32768, v40
  v_mfma_f32_16x16x32_bf16 v[12:15], a[132:135], a[36:39], v[12:15]
  ds_read_b64_tr_b16 a[164:165], v41 offset:24576
  v_mfma_f32_16x16x32_bf16 v[12:15], a[148:151], a[44:47], v[12:15]
  buffer_load_dwordx4 a[20:23], v49, s[4:7], s93 offen offset:2048 sc1
  v_mfma_f32_16x16x32_bf16 v[8:11], a[148:151], a[40:43], v[8:11]
  ds_read_b64_tr_b16 a[166:167], v41 offset:26624
  ds_read_b64_tr_b16 a[180:181], v41 offset:28672
  v_mfma_f32_16x16x32_bf16 v[8:11], a[132:135], a[32:35], v[8:11]
  s_waitcnt lgkmcnt(7)
  ds_read_b64_tr_b16 a[182:183], v41 offset:30720
  v_add_u32 v41, 32768, v41
  v_mfma_f32_16x16x32_bf16 v[16:19], a[136:139], a[32:35], v[16:19]
  ds_read_b64_tr_b16 a[168:169], v42 offset:24576
  v_mfma_f32_16x16x32_bf16 v[16:19], a[152:155], a[40:43], v[16:19]
  buffer_load_dwordx4 a[24:27], v48, s[4:7], s93 offen offset:3072 sc1
  v_mfma_f32_16x16x32_bf16 v[20:23], a[152:155], a[44:47], v[20:23]
  ds_read_b64_tr_b16 a[170:171], v42 offset:26624
  ds_read_b64_tr_b16 a[184:185], v42 offset:28672
  v_mfma_f32_16x16x32_bf16 v[20:23], a[136:139], a[36:39], v[20:23]
  ds_read_b64_tr_b16 a[186:187], v42 offset:30720
  v_add_u32 v42, 32768, v42
  v_mfma_f32_16x16x32_bf16 v[28:31], a[140:143], a[36:39], v[28:31]
  ds_read_b64_tr_b16 a[172:173], v43 offset:24576
  v_mfma_f32_16x16x32_bf16 v[28:31], a[156:159], a[44:47], v[28:31]
  buffer_load_dwordx4 a[28:31], v49, s[4:7], s93 offen offset:3072 sc1
  v_mfma_f32_16x16x32_bf16 v[24:27], a[156:159], a[40:43], v[24:27]
  ds_read_b64_tr_b16 a[174:175], v43 offset:26624
  ds_read_b64_tr_b16 a[188:189], v43 offset:28672
  v_mfma_f32_16x16x32_bf16 v[24:27], a[140:143], a[32:35], v[24:27]
  s_waitcnt vmcnt(8) lgkmcnt(7)
  ds_read_b64_tr_b16 a[190:191], v43 offset:30720
  v_add_u32 v43, 32768, v43
  v_mfma_f32_16x16x32_bf16 v[0:3], a[160:163], a[48:51], v[0:3]
  ds_read_b64_tr_b16 a[128:129], v40 offset:0
  v_mfma_f32_16x16x32_bf16 v[0:3], a[176:179], a[56:59], v[0:3]
  s_add_u32 s57, s57, 4096
  s_xor_b32 s93, s57, s88
  buffer_load_dwordx4 a[32:35], v48, s[4:7], s93 offen offset:0 sc1
  v_mfma_f32_16x16x32_bf16 v[4:7], a[176:179], a[60:63], v[4:7]
  ds_read_b64_tr_b16 a[130:131], v40 offset:2048
  ds_read_b64_tr_b16 a[144:145], v40 offset:4096
  v_mfma_f32_16x16x32_bf16 v[4:7], a[160:163], a[52:55], v[4:7]
  ds_read_b64_tr_b16 a[146:147], v40 offset:6144
  v_mfma_f32_16x16x32_bf16 v[12:15], a[164:167], a[52:55], v[12:15]
  ds_read_b64_tr_b16 a[132:133], v41 offset:0
  v_mfma_f32_16x16x32_bf16 v[12:15], a[180:183], a[60:63], v[12:15]
  buffer_load_dwordx4 a[36:39], v49, s[4:7], s93 offen offset:0 sc1
  v_mfma_f32_16x16x32_bf16 v[8:11], a[180:183], a[56:59], v[8:11]
  ds_read_b64_tr_b16 a[134:135], v41 offset:2048
  ds_read_b64_tr_b16 a[148:149], v41 offset:4096
  v_mfma_f32_16x16x32_bf16 v[8:11], a[164:167], a[48:51], v[8:11]
  ds_read_b64_tr_b16 a[150:151], v41 offset:6144
  s_waitcnt lgkmcnt(8)
  v_mfma_f32_16x16x32_bf16 v[16:19], a[168:171], a[48:51], v[16:19]
  ds_read_b64_tr_b16 a[136:137], v42 offset:0
  v_mfma_f32_16x16x32_bf16 v[16:19], a[184:187], a[56:59], v[16:19]
  buffer_load_dwordx4 a[40:43], v48, s[4:7], s93 offen offset:1024 sc1
  v_mfma_f32_16x16x32_bf16 v[20:23], a[184:187], a[60:63], v[20:23]
  ds_read_b64_tr_b16 a[138:139], v42 offset:2048
  ds_read_b64_tr_b16 a[152:153], v42 offset:4096
  v_mfma_f32_16x16x32_bf16 v[20:23], a[168:171], a[52:55], v[20:23]
  ds_read_b64_tr_b16 a[154:155], v42 offset:6144
  v_mfma_f32_16x16x32_bf16 v[28:31], a[172:175], a[52:55], v[28:31]
  ds_read_b64_tr_b16 a[140:141], v43 offset:0
  v_mfma_f32_16x16x32_bf16 v[28:31], a[188:191], a[60:63], v[28:31]
  s_sub_u32 s56, s56, 1
  buffer_load_dwordx4 a[44:47], v49, s[4:7], s93 offen offset:1024 sc1
  v_mfma_f32_16x16x32_bf16 v[24:27], a[188:191], a[56:59], v[24:27]
  s_cmp_lg_u32 s56, 0
  ds_read_b64_tr_b16 a[142:143], v43 offset:2048
  ds_read_b64_tr_b16 a[156:157], v43 offset:4096
  v_mfma_f32_16x16x32_bf16 v[24:27], a[172:175], a[48:51], v[24:27]
  ds_read_b64_tr_b16 a[158:159], v43 offset:6144
  s_cbranch_scc1 Lp2_loop
Lmk_Lp2_loop_tail:
  s_waitcnt vmcnt(8) lgkmcnt(8)
  v_mfma_f32_16x16x32_bf16 v[0:3], a[128:131], a[0:3], v[0:3]
  ds_read_b64_tr_b16 a[160:161], v40 offset:8192
  v_mfma_f32_16x16x32_bf16 v[0:3], a[144:147], a[8:11], v[0:3]
  buffer_load_dwordx4 a[48:51], v48, s[4:7], s93 offen offset:2048 sc1
  v_mfma_f32_16x16x32_bf16 v[4:7], a[144:147], a[12:15], v[4:7]
  ds_read_b64_tr_b16 a[162:163], v40 offset:10240
  ds_read_b64_tr_b16 a[176:177], v40 offset:12288
  v_mfma_f32_16x16x32_bf16 v[4:7], a[128:131], a[4:7], v[4:7]
  ds_read_b64_tr_b16 a[178:179], v40 offset:14336
  v_mfma_f32_16x16x32_bf16 v[12:15], a[132:135], a[4:7], v[12:15]
  ds_read_b64_tr_b16 a[164:165], v41 offset:8192
  v_mfma_f32_16x16x32_bf16 v[12:15], a[148:151], a[12:15], v[12:15]
  buffer_load_dwordx4 a[52:55], v49, s[4:7], s93 offen offset:2048 sc1
  v_mfma_f32_16x16x32_bf16 v[8:11], a[148:151], a[8:11], v[8:11]
  ds_read_b64_tr_b16 a[166:167], v41 offset:10240
  ds_read_b64_tr_b16 a[180:181], v41 offset:12288
  v_mfma_f32_16x16x32_bf16 v[8:11], a[132:135], a[0:3], v[8:11]
  ds_read_b64_tr_b16 a[182:183], v41 offset:14336
  s_waitcnt lgkmcnt(8)
  v_mfma_f32_16x16x32_bf16 v[16:19], a[136:139], a[0:3], v[16:19]
  ds_read_b64_tr_b16 a[168:169], v42 offset:8192
  v_mfma_f32_16x16x32_bf16 v[16:19], a[152:155], a[8:11], v[16:19]
  buffer_load_dwordx4 a[56:59], v48, s[4:7], s93 offen offset:3072 sc1
  v_mfma_f32_16x16x32_bf16 v[20:23], a[152:155], a[12:15], v[20:23]
  ds_read_b64_tr_b16 a[170:171], v42 offset:10240
  ds_read_b64_tr_b16 a[184:185], v42 offset:12288
  v_mfma_f32_16x16x32_bf16 v[20:23], a[136:139], a[4:7], v[20:23]
  ds_read_b64_tr_b16 a[186:187], v42 offset:14336
  v_mfma_f32_16x16x32_bf16 v[28:31], a[140:143], a[4:7], v[28:31]
  ds_read_b64_tr_b16 a[172:173], v43 offset:8192
  v_mfma_f32_16x16x32_bf16 v[28:31], a[156:159], a[12:15], v[28:31]
  buffer_load_dwordx4 a[60:63], v49, s[4:7], s93 offen offset:3072 sc1
  v_mfma_f32_16x16x32_bf16 v[24:27], a[156:159], a[8:11], v[24:27]
  ds_read_b64_tr_b16 a[174:175], v43 offset:10240
  ds_read_b64_tr_b16 a[188:189], v43 offset:12288
  v_mfma_f32_16x16x32_bf16 v[24:27], a[140:143], a[0:3], v[24:27]
  ds_read_b64_tr_b16 a[190:191], v43 offset:14336
  s_waitcnt vmcnt(8) lgkmcnt(8)
  v_mfma_f32_16x16x32_bf16 v[0:3], a[160:163], a[16:19], v[0:3]
  ds_read_b64_tr_b16 a[128:129], v40 offset:16384
  v_mfma_f32_16x16x32_bf16 v[0:3], a[176:179], a[24:27], v[0:3]
  ds_read_b64_tr_b16 a[130:131], v40 offset:18432
  v_mfma_f32_16x16x32_bf16 v[4:7], a[176:179], a[28:31], v[4:7]
  ds_read_b64_tr_b16 a[144:145], v40 offset:20480
  v_mfma_f32_16x16x32_bf16 v[4:7], a[160:163], a[20:23], v[4:7]
  ds_read_b64_tr_b16 a[146:147], v40 offset:22528
  v_mfma_f32_16x16x32_bf16 v[12:15], a[164:167], a[20:23], v[12:15]
  ds_read_b64_tr_b16 a[132:133], v41 offset:16384
  v_mfma_f32_16x16x32_bf16 v[12:15], a[180:183], a[28:31], v[12:15]
  ds_read_b64_tr_b16 a[134:135], v41 offset:18432
  v_mfma_f32_16x16x32_bf16 v[8:11], a[180:183], a[24:27], v[8:11]
  ds_read_b64_tr_b16 a[148:149], v41 offset:20480
  v_mfma_f32_16x16x32_bf16 v[8:11], a[164:167], a[16:19], v[8:11]
  ds_read_b64_tr_b16 a[150:151], v41 offset:22528
  s_waitcnt lgkmcnt(8)
  v_mfma_f32_16x16x32_bf16 v[16:19], a[168:171], a[16:19], v[16:19]
  ds_read_b64_tr_b16 a[136:137], v42 offset:16384
  v_mfma_f32_16x16x32_bf16 v[16:19], a[184:187], a[24:27], v[16:19]
  ds_read_b64_tr_b16 a[138:139], v42 offset:18432
  v_mfma_f32_16x16x32_bf16 v[20:23], a[184:187], a[28:31], v[20:23]
  ds_read_b64_tr_b16 a[152:153], v42 offset:20480
  v_mfma_f32_16x16x32_bf16 v[20:23], a[168:171], a[20:23], v[20:23]
  ds_read_b64_tr_b16 a[154:155], v42 offset:22528
  v_mfma_f32_16x16x32_bf16 v[28:31], a[172:175], a[20:23], v[28:31]
  ds_read_b64_tr_b16 a[140:141], v43 offset:16384
  v_mfma_f32_16x16x32_bf16 v[28:31], a[188:191], a[28:31], v[28:31]
  ds_read_b64_tr_b16 a[142:143], v43 offset:18432
  v_mfma_f32_16x16x32_bf16 v[24:27], a[188:191], a[24:27], v[24:27]
  ds_read_b64_tr_b16 a[156:157], v43 offset:20480
  v_mfma_f32_16x16x32_bf16 v[24:27], a[172:175], a[16:19], v[24:27]
  ds_read_b64_tr_b16 a[158:159], v43 offset:22528
  s_waitcnt vmcnt(4) lgkmcnt(8)
  v_mfma_f32_16x16x32_bf16 v[0:3], a[128:131], a[32:35], v[0:3]
  ds_read_b64_tr_b16 a[160:161], v40 offset:24576
  v_mfma_f32_16x16x32_bf16 v[0:3], a[144:147], a[40:43], v[0:3]
  ds_read_b64_tr_b16 a[162:163], v40 offset:26624
  v_mfma_f32_16x16x32_bf16 v[4:7], a[144:147], a[44:47], v[4:7]
  ds_read_b64_tr_b16 a[176:177], v40 offset:28672
  v_mfma_f32_16x16x32_bf16 v[4:7], a[128:131], a[36:39], v[4:7]
  ds_read_b64_tr_b16 a[178:179], v40 offset:30720
  v_add_u32 v40, 32768, v40
  v_mfma_f32_16x16x32_bf16 v[12:15], a[132:135], a[36:39], v[12:15]
  ds_read_b64_tr_b16 a[164:165], v41 offset:24576
  v_mfma_f32_16x16x32_bf16 v[12:15], a[148:151], a[44:47], v[12:15]
  ds_read_b64_tr_b16 a[166:167], v41 offset:26624
  v_mfma_f32_16x16x32_bf16 v[8:11], a[148:151], a[40:43], v[8:11]
  ds_read_b64_tr_b16 a[180:181], v41 offset:28672
  v_mfma_f32_16x16x32_bf16 v[8:11], a[132:135], a[32:35], v[8:11]
  s_waitcnt lgkmcnt(7)
  ds_read_b64_tr_b16 a[182:183], v41 offset:30720
  v_add_u32 v41, 32768, v41
  v_mfma_f32_16x16x32_bf16 v[16:19], a[136:139], a[32:35], v[16:19]
  ds_read_b64_tr_b16 a[168:169], v42 offset:24576
  v_mfma_f32_16x16x32_bf16 v[16:19], a[152:155], a[40:43], v[16:19]
  ds_read_b64_tr_b16 a[170:171], v42 offset:26624
  v_mfma_f32_16x16x32_bf16 v[20:23], a[152:155], a[44:47], v[20:23]
  ds_read_b64_tr_b16 a[184:185], v42 offset:28672
  v_mfma_f32_16x16x32_bf16 v[20:23], a[136:139], a[36:39], v[20:23]
  ds_read_b64_tr_b16 a[186:187], v42 offset:30720
  v_add_u32 v42, 32768, v42
  v_mfma_f32_16x16x32_bf16 v[28:31], a[140:143], a[36:39], v[28:31]
  ds_read_b64_tr_b16 a[172:173], v43 offset:24576
  v_mfma_f32_16x16x32_bf16 v[28:31], a[156:159], a[44:47], v[28:31]
  ds_read_b64_tr_b16 a[174:175], v43 offset:26624
  v_mfma_f32_16x16x32_bf16 v[24:27], a[156:159], a[40:43], v[24:27]
  ds_read_b64_tr_b16 a[188:189], v43 offset:28672
  v_mfma_f32_16x16x32_bf16 v[24:27], a[140:143], a[32:35], v[24:27]
  s_waitcnt vmcnt(0) lgkmcnt(7)
  ds_read_b64_tr_b16 a[190:191], v43 offset:30720
  v_add_u32 v43, 32768, v43
  v_mfma_f32_16x16x32_bf16 v[0:3], a[160:163], a[48:51], v[0:3]
  v_mfma_f32_16x16x32_bf16 v[0:3], a[176:179], a[56:59], v[0:3]
  v_mfma_f32_16x16x32_bf16 v[4:7], a[176:179], a[60:63], v[4:7]
  v_mfma_f32_16x16x32_bf16 v[4:7], a[160:163], a[52:55], v[4:7]
  v_mfma_f32_16x16x32_bf16 v[12:15], a[164:167], a[52:55], v[12:15]
  v_mfma_f32_16x16x32_bf16 v[12:15], a[180:183], a[60:63], v[12:15]
  v_mfma_f32_16x16x32_bf16 v[8:11], a[180:183], a[56:59], v[8:11]
  v_mfma_f32_16x16x32_bf16 v[8:11], a[164:167], a[48:51], v[8:11]
  s_waitcnt lgkmcnt(0)
  v_mfma_f32_16x16x32_bf16 v[16:19], a[168:171], a[48:51], v[16:19]
  s_nop 0
  v_mfma_f32_16x16x32_bf16 v[16:19], a[184:187], a[56:59], v[16:19]
  s_nop 0
  v_mfma_f32_16x16x32_bf16 v[20:23], a[184:187], a[60:63], v[20:23]
  s_nop 0
  v_mfma_f32_16x16x32_bf16 v[20:23], a[168:171], a[52:55], v[20:23]
  v_cvt_pk_bf16_f32 v60, v4, v5
  v_cvt_pk_bf16_f32 v61, v6, v7
  v_mfma_f32_16x16x32_bf16 v[28:31], a[172:175], a[52:55], v[28:31]
  v_cvt_pk_bf16_f32 v62, v12, v13
  v_cvt_pk_bf16_f32 v63, v14, v15
  v_mfma_f32_16x16x32_bf16 v[28:31], a[188:191], a[60:63], v[28:31]
  buffer_store_dwordx4 v[60:63], v48, s[4:7], s59 offen offset:0 sc1
  v_mfma_f32_16x16x32_bf16 v[24:27], a[188:191], a[56:59], v[24:27]
  v_cvt_pk_bf16_f32 v52, v0, v1
  v_cvt_pk_bf16_f32 v53, v2, v3
  v_mfma_f32_16x16x32_bf16 v[24:27], a[172:175], a[48:51], v[24:27]
  v_cvt_pk_bf16_f32 v54, v8, v9
  v_cvt_pk_bf16_f32 v55, v10, v11
  v_mfma_f32_16x16x32_bf16 v[88:91], v[60:63], v[60:63], 0
  buffer_store_dwordx4 v[52:55], v48, s[4:7], s58 offen offset:0 sc1
  v_mfma_f32_16x16x32_bf16 v[84:87], v[72:75], v[60:63], 0
  v_cvt_pk_bf16_f32 v64, v20, v21
  v_mfma_f32_16x16x32_bf16 v[80:83], v[52:55], v[52:55], 0
  v_cvt_pk_bf16_f32 v65, v22, v23
  v_cvt_pk_bf16_f32 v66, v28, v29
  v_cvt_pk_bf16_f32 v67, v30, v31
  v_mfma_f32_16x16x32_bf16 v[76:79], v[72:75], v[52:55], 0
  buffer_store_dwordx4 v[64:67], v48, s[4:7], s59 offen offset:1024 sc1
  v_cvt_pk_bf16_f32 v56, v16, v17
  v_cvt_pk_bf16_f32 v57, v18, v19
  v_cvt_pk_bf16_f32 v58, v24, v25
  v_cvt_pk_bf16_f32 v59, v26, v27
  buffer_store_dwordx4 v[56:59], v48, s[4:7], s58 offen offset:1024 sc1
  s_nop 0
  v_mfma_f32_16x16x32_bf16 v[88:91], v[64:67], v[64:67], v[88:91]
  v_mfma_f32_16x16x32_bf16 v[84:87], v[72:75], v[64:67], v[84:87]
  v_mfma_f32_16x16x32_bf16 v[80:83], v[56:59], v[56:59], v[80:83]
  v_mfma_f32_16x16x32_bf16 v[76:79], v[72:75], v[56:59], v[76:79]
  s_nop 5
  v_cndmask_b32 v85, v88, v89, s[64:65]
  v_cndmask_b32 v85, v85, v90, s[66:67]
  v_cndmask_b32 v85, v85, v91, s[68:69]
  buffer_store_dwordx2 v[84:85], v92, s[4:7], s60 offen offset:2048 sc1
  v_cndmask_b32 v77, v80, v81, s[64:65]
  v_cndmask_b32 v77, v77, v82, s[66:67]
  v_cndmask_b32 v77, v77, v83, s[68:69]
  buffer_store_dwordx2 v[76:77], v92, s[4:7], s60 offen offset:0 sc1
  s_and_b32 s66, s55, 1
  v_lshrrev_b32 v2, 4, v253
  v_bfe_u32 v3, v253, 1, 3
  v_and_b32 v4, 1, v253
  v_lshlrev_b32 v4, 4, v4
  v_mul_u32_u24 v5, 7168, v2
  v_add_u32 v5, v5, v4
  s_cmp_eq_u32 s66, 0
  s_cselect_b32 s44, 7, 0
  v_mov_b32 v7, 0x40000000
  v_add_u32 v6, 0, v2
  v_xor_b32 v6, v6, v3
  v_cmp_eq_u32 vcc, s44, v6
  v_lshl_add_u32 v6, v6, 5, v5
  v_add_u32 v6, 0, v6
  v_cndmask_b32 v232, v6, v7, vcc
  v_add_u32 v6, 4, v2
  v_xor_b32 v6, v6, v3
  v_cmp_eq_u32 vcc, s44, v6
  v_lshl_add_u32 v6, v6, 5, v5
  v_add_u32 v6, 27648, v6
  v_cndmask_b32 v233, v6, v7, vcc
  v_add_u32 v6, 0, v2
  v_xor_b32 v6, v6, v3
  v_cmp_eq_u32 vcc, s44, v6
  v_lshl_add_u32 v6, v6, 5, v5
  v_add_u32 v6, 55296, v6
  v_cndmask_b32 v234, v6, v7, vcc
  v_add_u32 v6, 4, v2
  v_xor_b32 v6, v6, v3
  v_cmp_eq_u32 vcc, s44, v6
  v_lshl_add_u32 v6, v6, 5, v5
  v_add_u32 v6, 82944, v6
  v_cndmask_b32 v235, v6, v7, vcc
  s_mul_i32 s67, s55, 224
  s_and_b32 s67, s67, 0xffffffc0
  s_mul_i32 s43, s40, 114688
  s_add_u32 s67, s67, s43
  s_lshl_b32 s68, s40, 12
  v_lshlrev_b32 v231, 4, v253
  s_lshl_b32 s43, s41, 30
  v_or_b32 v236, s43, v231
  s_lshl_b32 s43, s2, 2
  s_add_u32 s43, s43, s40
  s_mul_i32 s70, s43, 7168
  s_lshl_b32 s69, s54, 2
  s_add_u32 s69, s69, s40
  s_lshl_b32 s72, s69, 17
  s_add_u32 s72, s72, s42
  s_add_u32 s72, s72, 4194304
  s_add_u32 s73, s72, 32768
  s_add_u32 s74, s73, 32768
  s_add_u32 s75, s74, 32768
  s_lshl_b32 s71, s40, 11
  s_add_u32 s71, s71, 131072
  v_lshrrev_b32 v2, 2, v253
  v_and_b32 v3, 7, v2
  v_and_b32 v4, 3, v253
  v_lshlrev_b32 v5, 3, v4
  v_lshl_add_u32 v5, v2, 8, v5
  s_lshl_b32 s43, s66, 1
  s_cmp_eq_u32 s66, 0
  s_cselect_b32 s45, 6, 1
  s_add_u32 s46, s43, 0
  v_xor_b32 v6, s46, v3
  v_lshl_add_u32 v224, v6, 5, v5
  s_add_u32 s46, s43, 1
  v_xor_b32 v6, s46, v3
  v_lshl_add_u32 v225, v6, 5, v5
  s_add_u32 s46, s43, 2
  v_xor_b32 v6, s46, v3
  v_lshl_add_u32 v226, v6, 5, v5
  s_add_u32 s46, s43, 3
  v_xor_b32 v6, s46, v3
  v_lshl_add_u32 v227, v6, 5, v5
  s_add_u32 s46, s43, 4
  v_xor_b32 v6, s46, v3
  v_lshl_add_u32 v228, v6, 5, v5
  s_add_u32 s46, s43, 5
  v_xor_b32 v6, s46, v3
  v_lshl_add_u32 v229, v6, 5, v5
  v_xor_b32 v6, s45, v3
  v_lshl_add_u32 v230, v6, 5, v5
  s_mul_i32 s46, s55, 448
  s_add_u32 s46, s46, 27918336
  s_add_u32 s47, s46, 28672
  s_lshr_b32 s48, s55, 3
  s_lshl_b32 s48, s48, 7
  s_add_u32 s48, s48, 27794432
  s_lshl_b32 s44, s69, 13
  s_add_u32 s44, s44, s42
  s_add_u32 s44, s44, 27525120
  s_add_u32 s45, s44, 4096
  s_waitcnt vmcnt(0)
  s_barrier
  s_cmp_lg_u32 s40, 0
  s_cbranch_scc1 Lsig15
  v_mov_b32 v250, 1
  s_mov_b64 exec, 1
  buffer_atomic_add v250, v251, s[4:7], s77 offen sc1
  s_mov_b64 exec, -1
Lsig15:
  s_cmp_lg_u32 s3, 0
  s_cbranch_scc1 Lc16_c
Lc16_r:
  s_add_u32 m0, s68, 0
  s_nop 0
  buffer_load_dwordx4 v232, s[16:19], s67 offen offset:0  lds
  buffer_load_dwordx4 v233, s[16:19], s67 offen offset:1024  lds
  buffer_load_dwordx4 v234, s[16:19], s67 offen offset:2048  lds
  buffer_load_dwordx4 v235, s[16:19], s67 offen offset:3072  lds
  s_add_u32 m0, s68, 16384
  s_nop 0
  buffer_load_dwordx4 v232, s[20:23], s67 offen offset:0  lds
  buffer_load_dwordx4 v233, s[20:23], s67 offen offset:1024  lds
  buffer_load_dwordx4 v234, s[20:23], s67 offen offset:2048  lds
  buffer_load_dwordx4 v235, s[20:23], s67 offen offset:3072  lds
  s_add_u32 s67, s67, 458752
  s_add_u32 m0, s68, 32768
  s_nop 0
  buffer_load_dwordx4 v232, s[16:19], s67 offen offset:0  lds
  buffer_load_dwordx4 v233, s[16:19], s67 offen offset:1024  lds
  buffer_load_dwordx4 v234, s[16:19], s67 offen offset:2048  lds
  buffer_load_dwordx4 v235, s[16:19], s67 offen offset:3072  lds
  s_add_u32 m0, s68, 49152
  s_nop 0
  buffer_load_dwordx4 v232, s[20:23], s67 offen offset:0  lds
  buffer_load_dwordx4 v233, s[20:23], s67 offen offset:1024  lds
  buffer_load_dwordx4 v234, s[20:23], s67 offen offset:2048  lds
  buffer_load_dwordx4 v235, s[20:23], s67 offen offset:3072  lds
  s_add_u32 s67, s67, 458752
  s_xor_b32 s68, s68, 0x10000
  s_mul_i32 s77, s54, 256
  s_add_u32 s77, s77, s42
  s_add_u32 s77, s77, 27791360
  v_lshlrev_b32 v249, 7, v253
  s_cmp_lg_u32 s40, 0
  s_cbranch_scc1 Lpdn18
  s_mov_b32 s43, 0x40000
  s_mov_b64 exec, 3
Lpol17:
  buffer_load_dword v250, v249, s[4:7], s77 offen sc1
  s_waitcnt vmcnt(0)
  v_cmp_gt_u32 vcc, 16, v250
  s_cbranch_vccz Lpdn18x
  s_sub_u32 s43, s43, 1
  s_cmp_lg_u32 s43, 0
  s_cbranch_scc1 Lpol17
Lpdn18x:
  s_mov_b64 exec, -1
Lpdn18:
  s_waitcnt vmcnt(0) lgkmcnt(0)
  s_barrier
  buffer_load_dwordx4 a[0:3], v231, s[4:7], s72 offen offset:0 sc1
  buffer_load_dwordx4 a[16:19], v231, s[4:7], s72 offen offset:1024 sc1
  buffer_load_dwordx4 a[4:7], v231, s[4:7], s73 offen offset:0 sc1
  buffer_load_dwordx4 a[20:23], v231, s[4:7], s73 offen offset:1024 sc1
  buffer_load_dwordx4 a[8:11], v231, s[4:7], s74 offen offset:0 sc1
  buffer_load_dwordx4 a[24:27], v231, s[4:7], s74 offen offset:1024 sc1
  buffer_load_dwordx4 a[12:15], v231, s[4:7], s75 offen offset:0 sc1
  buffer_load_dwordx4 a[28:31], v231, s[4:7], s75 offen offset:1024 sc1
  ds_read_b64_tr_b16 a[64:65], v224 offset:0
  ds_read_b64_tr_b16 a[66:67], v224 offset:4096
  ds_read_b64_tr_b16 a[68:69], v224 offset:8192
  ds_read_b64_tr_b16 a[70:71], v224 offset:12288
  ds_read_b64_tr_b16 a[72:73], v224 offset:16384
  ds_read_b64_tr_b16 a[74:75], v224 offset:20480
  ds_read_b64_tr_b16 a[76:77], v224 offset:24576
  ds_read_b64_tr_b16 a[78:79], v224 offset:28672
Lmk_p3s0:
  s_waitcnt vmcnt(6) lgkmcnt(4)
  v_mfma_f32_16x16x32_bf16 v[0:3], a[64:67], a[0:3], 0
  ds_read_b64_tr_b16 a[80:81], v225 offset:0
  v_mfma_f32_16x16x32_bf16 v[0:3], a[68:71], a[16:19], v[0:3]
  ds_read_b64_tr_b16 a[82:83], v225 offset:4096
  s_waitcnt vmcnt(4)
  v_mfma_f32_16x16x32_bf16 v[4:7], a[68:71], a[20:23], 0
  v_mfma_f32_16x16x32_bf16 v[4:7], a[64:67], a[4:7], v[4:7]
  s_waitcnt vmcnt(2)
  v_mfma_f32_16x16x32_bf16 v[8:11], a[64:67], a[8:11], 0
  ds_read_b64_tr_b16 a[84:85], v225 offset:8192
  v_mfma_f32_16x16x32_bf16 v[8:11], a[68:71], a[24:27], v[8:11]
  ds_read_b64_tr_b16 a[86:87], v225 offset:12288
  s_waitcnt vmcnt(0)
  v_mfma_f32_16x16x32_bf16 v[12:15], a[68:71], a[28:31], 0
  v_mfma_f32_16x16x32_bf16 v[12:15], a[64:67], a[12:15], v[12:15]
  s_waitcnt lgkmcnt(4)
  v_mfma_f32_16x16x32_bf16 v[28:31], a[72:75], a[12:15], 0
  ds_read_b64_tr_b16 a[88:89], v225 offset:16384
  v_mfma_f32_16x16x32_bf16 v[28:31], a[76:79], a[28:31], v[28:31]
  ds_read_b64_tr_b16 a[90:91], v225 offset:20480
  v_mfma_f32_16x16x32_bf16 v[24:27], a[76:79], a[24:27], 0
  buffer_load_dwordx4 a[32:35], v231, s[4:7], s72 offen offset:2048 sc1
  v_mfma_f32_16x16x32_bf16 v[24:27], a[72:75], a[8:11], v[24:27]
  v_mfma_f32_16x16x32_bf16 v[20:23], a[72:75], a[4:7], 0
  ds_read_b64_tr_b16 a[92:93], v225 offset:24576
  v_mfma_f32_16x16x32_bf16 v[20:23], a[76:79], a[20:23], v[20:23]
  ds_read_b64_tr_b16 a[94:95], v225 offset:28672
  v_mfma_f32_16x16x32_bf16 v[16:19], a[76:79], a[16:19], 0
  buffer_load_dwordx4 a[48:51], v231, s[4:7], s72 offen offset:3072 sc1
  v_mfma_f32_16x16x32_bf16 v[16:19], a[72:75], a[0:3], v[16:19]
  s_add_u32 s72, s72, 4096
  s_waitcnt lgkmcnt(4)
  v_mfma_f32_16x16x32_bf16 v[32:35], a[80:83], a[0:3], 0
  ds_read_b64_tr_b16 a[64:65], v226 offset:0
  v_mfma_f32_16x16x32_bf16 v[32:35], a[84:87], a[16:19], v[32:35]
  ds_read_b64_tr_b16 a[66:67], v226 offset:4096
  v_mfma_f32_16x16x32_bf16 v[36:39], a[84:87], a[20:23], 0
  buffer_load_dwordx4 a[36:39], v231, s[4:7], s73 offen offset:2048 sc1
  v_mfma_f32_16x16x32_bf16 v[36:39], a[80:83], a[4:7], v[36:39]
  v_mfma_f32_16x16x32_bf16 v[40:43], a[80:83], a[8:11], 0
  ds_read_b64_tr_b16 a[68:69], v226 offset:8192
  v_mfma_f32_16x16x32_bf16 v[40:43], a[84:87], a[24:27], v[40:43]
  ds_read_b64_tr_b16 a[70:71], v226 offset:12288
  v_mfma_f32_16x16x32_bf16 v[44:47], a[84:87], a[28:31], 0
  buffer_load_dwordx4 a[52:55], v231, s[4:7], s73 offen offset:3072 sc1
  v_mfma_f32_16x16x32_bf16 v[44:47], a[80:83], a[12:15], v[44:47]
  s_add_u32 s73, s73, 4096
  s_waitcnt lgkmcnt(4)
  v_mfma_f32_16x16x32_bf16 v[60:63], a[88:91], a[12:15], 0
  ds_read_b64_tr_b16 a[72:73], v226 offset:16384
  v_mfma_f32_16x16x32_bf16 v[60:63], a[92:95], a[28:31], v[60:63]
  ds_read_b64_tr_b16 a[74:75], v226 offset:20480
  v_mfma_f32_16x16x32_bf16 v[56:59], a[92:95], a[24:27], 0
  buffer_load_dwordx4 a[40:43], v231, s[4:7], s74 offen offset:2048 sc1
  v_mfma_f32_16x16x32_bf16 v[56:59], a[88:91], a[8:11], v[56:59]
  v_mfma_f32_16x16x32_bf16 v[52:55], a[88:91], a[4:7], 0
  ds_read_b64_tr_b16 a[76:77], v226 offset:24576
  v_mfma_f32_16x16x32_bf16 v[52:55], a[92:95], a[20:23], v[52:55]
  ds_read_b64_tr_b16 a[78:79], v226 offset:28672
  v_mfma_f32_16x16x32_bf16 v[48:51], a[92:95], a[16:19], 0
  buffer_load_dwordx4 a[56:59], v231, s[4:7], s74 offen offset:3072 sc1
  v_mfma_f32_16x16x32_bf16 v[48:51], a[88:91], a[0:3], v[48:51]
  s_add_u32 s74, s74, 4096
  s_waitcnt lgkmcnt(4)
  v_mfma_f32_16x16x32_bf16 v[64:67], a[64:67], a[0:3], 0
  ds_read_b64_tr_b16 a[80:81], v227 offset:0
  v_mfma_f32_16x16x32_bf16 v[64:67], a[68:71], a[16:19], v[64:67]
  ds_read_b64_tr_b16 a[82:83], v227 offset:4096
  v_mfma_f32_16x16x32_bf16 v[68:71], a[68:71], a[20:23], 0
  buffer_load_dwordx4 a[44:47], v231, s[4:7], s75 offen offset:2048 sc1
  v_mfma_f32_16x16x32_bf16 v[68:71], a[64:67], a[4:7], v[68:71]
  v_mfma_f32_16x16x32_bf16 v[72:75], a[64:67], a[8:11], 0
  ds_read_b64_tr_b16 a[84:85], v227 offset:8192
  v_mfma_f32_16x16x32_bf16 v[72:75], a[68:71], a[24:27], v[72:75]
  ds_read_b64_tr_b16 a[86:87], v227 offset:12288
  v_mfma_f32_16x16x32_bf16 v[76:79], a[68:71], a[28:31], 0
  buffer_load_dwordx4 a[60:63], v231, s[4:7], s75 offen offset:3072 sc1
  v_mfma_f32_16x16x32_bf16 v[76:79], a[64:67], a[12:15], v[76:79]
  s_add_u32 s75, s75, 4096
  s_waitcnt lgkmcnt(4)
  v_mfma_f32_16x16x32_bf16 v[92:95], a[72:75], a[12:15], 0
  ds_read_b64_tr_b16 a[88:89], v227 offset:16384
  v_mfma_f32_16x16x32_bf16 v[92:95], a[76:79], a[28:31], v[92:95]
  ds_read_b64_tr_b16 a[90:91], v227 offset:20480
  s_add_u32 m0, s68, 32768
  v_mfma_f32_16x16x32_bf16 v[88:91], a[76:79], a[24:27], 0
  buffer_load_dwordx4 v231, s[4:7], s44 offen offset:0 sc1 lds
  v_mfma_f32_16x16x32_bf16 v[88:91], a[72:75], a[8:11], v[88:91]
  v_mfma_f32_16x16x32_bf16 v[84:87], a[72:75], a[4:7], 0
  ds_read_b64_tr_b16 a[92:93], v227 offset:24576
  v_mfma_f32_16x16x32_bf16 v[84:87], a[76:79], a[20:23], v[84:87]
  ds_read_b64_tr_b16 a[94:95], v227 offset:28672
  v_mfma_f32_16x16x32_bf16 v[80:83], a[76:79], a[16:19], 0
  buffer_load_dwordx4 v231, s[4:7], s44 offen offset:1024 sc1 lds
  v_mfma_f32_16x16x32_bf16 v[80:83], a[72:75], a[0:3], v[80:83]
  s_waitcnt lgkmcnt(4)
  v_mfma_f32_16x16x32_bf16 v[96:99], a[80:83], a[0:3], 0
  ds_read_b64_tr_b16 a[64:65], v228 offset:0
  v_mfma_f32_16x16x32_bf16 v[96:99], a[84:87], a[16:19], v[96:99]
  ds_read_b64_tr_b16 a[66:67], v228 offset:4096
  v_mfma_f32_16x16x32_bf16 v[100:103], a[84:87], a[20:23], 0
  buffer_load_dwordx4 v231, s[4:7], s44 offen offset:2048 sc1 lds
  v_mfma_f32_16x16x32_bf16 v[100:103], a[80:83], a[4:7], v[100:103]
  v_mfma_f32_16x16x32_bf16 v[104:107], a[80:83], a[8:11], 0
  ds_read_b64_tr_b16 a[68:69], v228 offset:8192
  v_mfma_f32_16x16x32_bf16 v[104:107], a[84:87], a[24:27], v[104:107]
  ds_read_b64_tr_b16 a[70:71], v228 offset:12288
  v_mfma_f32_16x16x32_bf16 v[108:111], a[84:87], a[28:31], 0
  buffer_load_dwordx4 v231, s[4:7], s44 offen offset:3072 sc1 lds
  v_mfma_f32_16x16x32_bf16 v[108:111], a[80:83], a[12:15], v[108:111]
  s_waitcnt lgkmcnt(4)
  v_mfma_f32_16x16x32_bf16 v[124:127], a[88:91], a[12:15], 0
  ds_read_b64_tr_b16 a[72:73], v228 offset:16384
  v_mfma_f32_16x16x32_bf16 v[124:127], a[92:95], a[28:31], v[124:127]
  ds_read_b64_tr_b16 a[74:75], v228 offset:20480
  s_add_u32 m0, s68, 49152
  v_mfma_f32_16x16x32_bf16 v[120:123], a[92:95], a[24:27], 0
  buffer_load_dwordx4 v231, s[4:7], s45 offen offset:0 sc1 lds
  v_mfma_f32_16x16x32_bf16 v[120:123], a[88:91], a[8:11], v[120:123]
  v_mfma_f32_16x16x32_bf16 v[116:119], a[88:91], a[4:7], 0
  ds_read_b64_tr_b16 a[76:77], v228 offset:24576
  v_mfma_f32_16x16x32_bf16 v[116:119], a[92:95], a[20:23], v[116:119]
  ds_read_b64_tr_b16 a[78:79], v228 offset:28672
  v_mfma_f32_16x16x32_bf16 v[112:115], a[92:95], a[16:19], 0
  buffer_load_dwordx4 v231, s[4:7], s45 offen offset:1024 sc1 lds
  v_mfma_f32_16x16x32_bf16 v[112:115], a[88:91], a[0:3], v[112:115]
  s_waitcnt lgkmcnt(4)
  v_mfma_f32_16x16x32_bf16 v[128:131], a[64:67], a[0:3], 0
  ds_read_b64_tr_b16 a[80:81], v229 offset:0
  v_mfma_f32_16x16x32_bf16 v[128:131], a[68:71], a[16:19], v[128:131]
  ds_read_b64_tr_b16 a[82:83], v229 offset:4096
  v_mfma_f32_16x16x32_bf16 v[132:135], a[68:71], a[20:23], 0
  buffer_load_dwordx4 v231, s[4:7], s45 offen offset:2048 sc1 lds
  v_mfma_f32_16x16x32_bf16 v[132:135], a[64:67], a[4:7], v[132:135]
  v_mfma_f32_16x16x32_bf16 v[136:139], a[64:67], a[8:11], 0
  ds_read_b64_tr_b16 a[84:85], v229 offset:8192
  v_mfma_f32_16x16x32_bf16 v[136:139], a[68:71], a[24:27], v[136:139]
  ds_read_b64_tr_b16 a[86:87], v229 offset:12288
  v_mfma_f32_16x16x32_bf16 v[140:143], a[68:71], a[28:31], 0
  buffer_load_dwordx4 v231, s[4:7], s45 offen offset:3072 sc1 lds
  v_mfma_f32_16x16x32_bf16 v[140:143], a[64:67], a[12:15], v[140:143]
  s_waitcnt lgkmcnt(4)
  v_mfma_f32_16x16x32_bf16 v[156:159], a[72:75], a[12:15], 0
  ds_read_b64_tr_b16 a[88:89], v229 offset:16384
  v_mfma_f32_16x16x32_bf16 v[156:159], a[76:79], a[28:31], v[156:159]
  ds_read_b64_tr_b16 a[90:91], v229 offset:20480
  s_add_u32 m0, s68, 0
  v_mfma_f32_16x16x32_bf16 v[152:155], a[76:79], a[24:27], 0
  buffer_load_dwordx4 v232, s[16:19], s67 offen offset:0  lds
  v_mfma_f32_16x16x32_bf16 v[152:155], a[72:75], a[8:11], v[152:155]
  v_mfma_f32_16x16x32_bf16 v[148:151], a[72:75], a[4:7], 0
  ds_read_b64_tr_b16 a[92:93], v229 offset:24576
  v_mfma_f32_16x16x32_bf16 v[148:151], a[76:79], a[20:23], v[148:151]
  ds_read_b64_tr_b16 a[94:95], v229 offset:28672
  v_mfma_f32_16x16x32_bf16 v[144:147], a[76:79], a[16:19], 0
  buffer_load_dwordx4 v233, s[16:19], s67 offen offset:1024  lds
  v_mfma_f32_16x16x32_bf16 v[144:147], a[72:75], a[0:3], v[144:147]
  s_waitcnt lgkmcnt(4)
  v_mfma_f32_16x16x32_bf16 v[160:163], a[80:83], a[0:3], 0
  ds_read_b64_tr_b16 a[64:65], v230 offset:0
  v_mfma_f32_16x16x32_bf16 v[160:163], a[84:87], a[16:19], v[160:163]
  ds_read_b64_tr_b16 a[66:67], v230 offset:4096
  v_mfma_f32_16x16x32_bf16 v[164:167], a[84:87], a[20:23], 0
  buffer_load_dwordx4 v234, s[16:19], s67 offen offset:2048  lds
  v_mfma_f32_16x16x32_bf16 v[164:167], a[80:83], a[4:7], v[164:167]
  v_mfma_f32_16x16x32_bf16 v[168:171], a[80:83], a[8:11], 0
  ds_read_b64_tr_b16 a[68:69], v230 offset:8192
  v_mfma_f32_16x16x32_bf16 v[168:171], a[84:87], a[24:27], v[168:171]
  ds_read_b64_tr_b16 a[70:71], v230 offset:12288
  v_mfma_f32_16x16x32_bf16 v[172:175], a[84:87], a[28:31], 0
  buffer_load_dwordx4 v235, s[16:19], s67 offen offset:3072  lds
  v_mfma_f32_16x16x32_bf16 v[172:175], a[80:83], a[12:15], v[172:175]
  s_waitcnt lgkmcnt(4)
  v_mfma_f32_16x16x32_bf16 v[188:191], a[88:91], a[12:15], 0
  ds_read_b64_tr_b16 a[72:73], v230 offset:16384
  v_mfma_f32_16x16x32_bf16 v[188:191], a[92:95], a[28:31], v[188:191]
  ds_read_b64_tr_b16 a[74:75], v230 offset:20480
  s_add_u32 m0, s68, 16384
  v_mfma_f32_16x16x32_bf16 v[184:187], a[92:95], a[24:27], 0
  buffer_load_dwordx4 v232, s[20:23], s67 offen offset:0  lds
  v_mfma_f32_16x16x32_bf16 v[184:187], a[88:91], a[8:11], v[184:187]
  v_mfma_f32_16x16x32_bf16 v[180:183], a[88:91], a[4:7], 0
  ds_read_b64_tr_b16 a[76:77], v230 offset:24576
  v_mfma_f32_16x16x32_bf16 v[180:183], a[92:95], a[20:23], v[180:183]
  ds_read_b64_tr_b16 a[78:79], v230 offset:28672
  v_mfma_f32_16x16x32_bf16 v[176:179], a[92:95], a[16:19], 0
  buffer_load_dwordx4 v233, s[20:23], s67 offen offset:1024  lds
  v_mfma_f32_16x16x32_bf16 v[176:179], a[88:91], a[0:3], v[176:179]
  s_waitcnt lgkmcnt(4)
  v_mfma_f32_16x16x32_bf16 v[192:195], a[64:67], a[0:3], 0
  s_barrier
  ds_read_b64_tr_b16 a[80:81], v224 offset:32768
  v_mfma_f32_16x16x32_bf16 v[192:195], a[68:71], a[16:19], v[192:195]
  ds_read_b64_tr_b16 a[82:83], v224 offset:36864
  v_mfma_f32_16x16x32_bf16 v[196:199], a[68:71], a[20:23], 0
  buffer_load_dwordx4 v234, s[20:23], s67 offen offset:2048  lds
  v_mfma_f32_16x16x32_bf16 v[196:199], a[64:67], a[4:7], v[196:199]
  v_mfma_f32_16x16x32_bf16 v[200:203], a[64:67], a[8:11], 0
  ds_read_b64_tr_b16 a[84:85], v224 offset:40960
  v_mfma_f32_16x16x32_bf16 v[200:203], a[68:71], a[24:27], v[200:203]
  ds_read_b64_tr_b16 a[86:87], v224 offset:45056
  v_mfma_f32_16x16x32_bf16 v[204:207], a[68:71], a[28:31], 0
  buffer_load_dwordx4 v235, s[20:23], s67 offen offset:3072  lds
  v_mfma_f32_16x16x32_bf16 v[204:207], a[64:67], a[12:15], v[204:207]
  s_add_u32 s67, s67, 458752
  s_waitcnt lgkmcnt(4)
  v_mfma_f32_16x16x32_bf16 v[220:223], a[72:75], a[12:15], 0
  ds_read_b64_tr_b16 a[88:89], v224 offset:49152
  v_mfma_f32_16x16x32_bf16 v[220:223], a[76:79], a[28:31], v[220:223]
  ds_read_b64_tr_b16 a[90:91], v224 offset:53248
  v_mfma_f32_16x16x32_bf16 v[216:219], a[76:79], a[24:27], 0
  buffer_load_dwordx4 a[96:99], v236, s[24:27], s70 offen
  v_mfma_f32_16x16x32_bf16 v[216:219], a[72:75], a[8:11], v[216:219]
  s_add_u32 s70, s70, 1024
  v_mfma_f32_16x16x32_bf16 v[212:215], a[72:75], a[4:7], 0
  ds_read_b64_tr_b16 a[92:93], v224 offset:57344
  v_mfma_f32_16x16x32_bf16 v[212:215], a[76:79], a[20:23], v[212:215]
  ds_read_b64_tr_b16 a[94:95], v224 offset:61440
  v_xor_b32 v224, 0x10000, v224
  v_mfma_f32_16x16x32_bf16 v[208:211], a[76:79], a[16:19], 0
  v_mfma_f32_16x16x32_bf16 v[208:211], a[72:75], a[0:3], v[208:211]
Lmk_p3s1:
  s_waitcnt vmcnt(17) lgkmcnt(4)
  v_mfma_f32_16x16x32_bf16 v[0:3], a[80:83], a[32:35], v[0:3]
  ds_read_b64_tr_b16 a[64:65], v225 offset:32768
  s_add_u32 s43, s68, 32768
  v_mfma_f32_16x16x32_bf16 v[0:3], a[84:87], a[48:51], v[0:3]
  ds_read_b64_tr_b16 a[66:67], v225 offset:36864
  v_lshlrev_b32 v250, 3, v253
  v_mfma_f32_16x16x32_bf16 v[4:7], a[84:87], a[52:55], v[4:7]
  buffer_load_dwordx4 a[0:3], v231, s[4:7], s72 offen offset:0 sc1
  v_mfma_f32_16x16x32_bf16 v[4:7], a[80:83], a[36:39], v[4:7]
  v_add_u32 v250, s43, v250
  v_mfma_f32_16x16x32_bf16 v[8:11], a[80:83], a[40:43], v[8:11]
  ds_read_b64_tr_b16 a[68:69], v225 offset:40960
  v_mfma_f32_16x16x32_bf16 v[8:11], a[84:87], a[56:59], v[8:11]
  ds_read_b64_tr_b16 a[70:71], v225 offset:45056
  v_mfma_f32_16x16x32_bf16 v[12:15], a[84:87], a[60:63], v[12:15]
  s_waitcnt vmcnt(10)
  ds_read_b64 v[238:239], v250 offset:0
  ds_read_b64 v[240:241], v250 offset:2048
  v_mfma_f32_16x16x32_bf16 v[12:15], a[80:83], a[44:47], v[12:15]
  s_waitcnt lgkmcnt(6)
  ds_read_b64 v[242:243], v250 offset:16384
  ds_read_b64 v[244:245], v250 offset:18432
  v_mfma_f32_16x16x32_bf16 v[28:31], a[88:91], a[44:47], v[28:31]
  ds_read_b64_tr_b16 a[72:73], v225 offset:49152
  v_mfma_f32_16x16x32_bf16 v[28:31], a[92:95], a[60:63], v[28:31]
  ds_read_b64_tr_b16 a[74:75], v225 offset:53248
  v_mfma_f32_16x16x32_bf16 v[24:27], a[92:95], a[56:59], v[24:27]
  buffer_load_dwordx4 a[16:19], v231, s[4:7], s72 offen offset:1024 sc1
  v_mfma_f32_16x16x32_bf16 v[24:27], a[88:91], a[40:43], v[24:27]
  ds_read_b64 v[246:247], v250 offset:512
  v_mfma_f32_16x16x32_bf16 v[20:23], a[88:91], a[36:39], v[20:23]
  ds_read_b64_tr_b16 a[76:77], v225 offset:57344
  v_mfma_f32_16x16x32_bf16 v[20:23], a[92:95], a[52:55], v[20:23]
  ds_read_b64_tr_b16 a[78:79], v225 offset:61440
  v_xor_b32 v225, 0x10000, v225
  v_mfma_f32_16x16x32_bf16 v[16:19], a[92:95], a[48:51], v[16:19]
  v_mfma_f32_16x16x32_bf16 v[16:19], a[88:91], a[32:35], v[16:19]
  ds_read_b64 v[248:249], v250 offset:2560
  s_waitcnt lgkmcnt(10)
  v_mfma_f32_16x16x32_bf16 v[32:35], a[64:67], a[32:35], v[32:35]
  s_waitcnt lgkmcnt(3)
  ds_read_b64_tr_b16 a[80:81], v226 offset:32768
  v_add_f32 v238, v238, v246
  v_mfma_f32_16x16x32_bf16 v[32:35], a[68:71], a[48:51], v[32:35]
  ds_read_b64_tr_b16 a[82:83], v226 offset:36864
  v_add_f32 v239, v239, v247
  v_mfma_f32_16x16x32_bf16 v[36:39], a[68:71], a[52:55], v[36:39]
  buffer_load_dwordx4 a[4:7], v231, s[4:7], s73 offen offset:0 sc1
  v_mfma_f32_16x16x32_bf16 v[36:39], a[64:67], a[36:39], v[36:39]
  ds_read_b64 v[246:247], v250 offset:16896
  v_mfma_f32_16x16x32_bf16 v[40:43], a[64:67], a[40:43], v[40:43]
  s_waitcnt lgkmcnt(3)
  ds_read_b64_tr_b16 a[84:85], v226 offset:40960
  v_add_f32 v240, v240, v248
  v_mfma_f32_16x16x32_bf16 v[40:43], a[68:71], a[56:59], v[40:43]
  ds_read_b64_tr_b16 a[86:87], v226 offset:45056
  v_add_f32 v241, v241, v249
  v_mfma_f32_16x16x32_bf16 v[44:47], a[68:71], a[60:63], v[44:47]
  buffer_load_dwordx4 a[20:23], v231, s[4:7], s73 offen offset:1024 sc1
  v_mfma_f32_16x16x32_bf16 v[44:47], a[64:67], a[44:47], v[44:47]
  ds_read_b64 v[248:249], v250 offset:18944
  v_mfma_f32_16x16x32_bf16 v[60:63], a[72:75], a[44:47], v[60:63]
  s_waitcnt lgkmcnt(3)
  ds_read_b64_tr_b16 a[88:89], v226 offset:49152
  v_add_f32 v242, v242, v246
  v_mfma_f32_16x16x32_bf16 v[60:63], a[76:79], a[60:63], v[60:63]
  ds_read_b64_tr_b16 a[90:91], v226 offset:53248
  v_add_f32 v243, v243, v247
  v_mfma_f32_16x16x32_bf16 v[56:59], a[76:79], a[56:59], v[56:59]
  v_mfma_f32_16x16x32_bf16 v[56:59], a[72:75], a[40:43], v[56:59]
  ds_read_b64 v[246:247], v250 offset:1024
  v_mfma_f32_16x16x32_bf16 v[52:55], a[72:75], a[36:39], v[52:55]
  s_waitcnt lgkmcnt(3)
  ds_read_b64_tr_b16 a[92:93], v226 offset:57344
  v_add_f32 v244, v244, v248
  v_mfma_f32_16x16x32_bf16 v[52:55], a[76:79], a[52:55], v[52:55]
  ds_read_b64_tr_b16 a[94:95], v226 offset:61440
  v_xor_b32 v226, 0x10000, v226
  v_add_f32 v245, v245, v249
  v_mfma_f32_16x16x32_bf16 v[48:51], a[76:79], a[48:51], v[48:51]
  buffer_load_dwordx4 a[8:11], v231, s[4:7], s74 offen offset:0 sc1
  v_mfma_f32_16x16x32_bf16 v[48:51], a[72:75], a[32:35], v[48:51]
  ds_read_b64 v[248:249], v250 offset:3072
  v_mfma_f32_16x16x32_bf16 v[64:67], a[80:83], a[32:35], v[64:67]
  s_waitcnt lgkmcnt(3)
  ds_read_b64_tr_b16 a[64:65], v227 offset:32768
  v_add_f32 v238, v238, v246
  v_mfma_f32_16x16x32_bf16 v[64:67], a[84:87], a[48:51], v[64:67]
  ds_read_b64_tr_b16 a[66:67], v227 offset:36864
  v_add_f32 v239, v239, v247
  v_mfma_f32_16x16x32_bf16 v[68:71], a[84:87], a[52:55], v[68:71]
  v_mfma_f32_16x16x32_bf16 v[68:71], a[80:83], a[36:39], v[68:71]
  ds_read_b64 v[246:247], v250 offset:17408
  v_mfma_f32_16x16x32_bf16 v[72:75], a[80:83], a[40:43], v[72:75]
  s_waitcnt lgkmcnt(3)
  ds_read_b64_tr_b16 a[68:69], v227 offset:40960
  v_add_f32 v240, v240, v248
  v_mfma_f32_16x16x32_bf16 v[72:75], a[84:87], a[56:59], v[72:75]
  ds_read_b64_tr_b16 a[70:71], v227 offset:45056
  v_add_f32 v241, v241, v249
  v_mfma_f32_16x16x32_bf16 v[76:79], a[84:87], a[60:63], v[76:79]
  buffer_load_dwordx4 a[24:27], v231, s[4:7], s74 offen offset:1024 sc1
  v_mfma_f32_16x16x32_bf16 v[76:79], a[80:83], a[44:47], v[76:79]
  ds_read_b64 v[248:249], v250 offset:19456
  v_mfma_f32_16x16x32_bf16 v[92:95], a[88:91], a[44:47], v[92:95]
  s_waitcnt lgkmcnt(3)
  ds_read_b64_tr_b16 a[72:73], v227 offset:49152
  v_add_f32 v242, v242, v246
  v_mfma_f32_16x16x32_bf16 v[92:95], a[92:95], a[60:63], v[92:95]
  ds_read_b64_tr_b16 a[74:75], v227 offset:53248
  v_add_f32 v243, v243, v247
  v_mfma_f32_16x16x32_bf16 v[88:91], a[92:95], a[56:59], v[88:91]
  buffer_load_dword v237, v251, s[4:7], s48 offen sc1
  v_mfma_f32_16x16x32_bf16 v[88:91], a[88:91], a[40:43], v[88:91]
  ds_read_b64 v[246:247], v250 offset:1536
  v_mfma_f32_16x16x32_bf16 v[84:87], a[88:91], a[36:39], v[84:87]
  s_waitcnt lgkmcnt(3)
  ds_read_b64_tr_b16 a[76:77], v227 offset:57344
  v_add_f32 v244, v244, v248
  v_mfma_f32_16x16x32_bf16 v[84:87], a[92:95], a[52:55], v[84:87]
  ds_read_b64_tr_b16 a[78:79], v227 offset:61440
  v_xor_b32 v227, 0x10000, v227
  v_add_f32 v245, v245, v249
  v_mfma_f32_16x16x32_bf16 v[80:83], a[92:95], a[48:51], v[80:83]
  buffer_load_dwordx4 a[12:15], v231, s[4:7], s75 offen offset:0 sc1
  v_mfma_f32_16x16x32_bf16 v[80:83], a[88:91], a[32:35], v[80:83]
  ds_read_b64 v[248:249], v250 offset:3584
  v_mfma_f32_16x16x32_bf16 v[96:99], a[64:67], a[32:35], v[96:99]
  s_waitcnt lgkmcnt(3)
  ds_read_b64_tr_b16 a[80:81], v228 offset:32768
  v_add_f32 v238, v238, v246
  v_mfma_f32_16x16x32_bf16 v[96:99], a[68:71], a[48:51], v[96:99]
  ds_read_b64_tr_b16 a[82:83], v228 offset:36864
  v_add_f32 v239, v239, v247
  v_mfma_f32_16x16x32_bf16 v[100:103], a[68:71], a[52:55], v[100:103]
  buffer_load_dwordx4 a[96:99], v236, s[24:27], s70 offen
  v_mfma_f32_16x16x32_bf16 v[100:103], a[64:67], a[36:39], v[100:103]
  s_add_u32 s70, s70, 1024
  ds_read_b64 v[246:247], v250 offset:17920
  v_mfma_f32_16x16x32_bf16 v[104:107], a[64:67], a[40:43], v[104:107]
  s_waitcnt lgkmcnt(3)
  ds_read_b64_tr_b16 a[84:85], v228 offset:40960
  v_add_f32 v240, v240, v248
  v_mfma_f32_16x16x32_bf16 v[104:107], a[68:71], a[56:59], v[104:107]
  ds_read_b64_tr_b16 a[86:87], v228 offset:45056
  v_add_f32 v241, v241, v249
  v_mfma_f32_16x16x32_bf16 v[108:111], a[68:71], a[60:63], v[108:111]
  buffer_load_dwordx4 a[28:31], v231, s[4:7], s75 offen offset:1024 sc1
  v_mfma_f32_16x16x32_bf16 v[108:111], a[64:67], a[44:47], v[108:111]
  ds_read_b64 v[248:249], v250 offset:19968
  v_mfma_f32_16x16x32_bf16 v[124:127], a[72:75], a[44:47], v[124:127]
  s_waitcnt lgkmcnt(3)
  ds_read_b64_tr_b16 a[88:89], v228 offset:49152
  v_add_f32 v242, v242, v246
  v_mfma_f32_16x16x32_bf16 v[124:127], a[76:79], a[60:63], v[124:127]
  ds_read_b64_tr_b16 a[90:91], v228 offset:53248
  v_add_f32 v243, v243, v247
  v_mfma_f32_16x16x32_bf16 v[120:123], a[76:79], a[56:59], v[120:123]
  v_mfma_f32_16x16x32_bf16 v[120:123], a[72:75], a[40:43], v[120:123]
  v_mfma_f32_16x16x32_bf16 v[116:119], a[72:75], a[36:39], v[116:119]
  s_waitcnt lgkmcnt(2)
  ds_read_b64_tr_b16 a[92:93], v228 offset:57344
  v_add_f32 v244, v244, v248
  v_mfma_f32_16x16x32_bf16 v[116:119], a[76:79], a[52:55], v[116:119]
  ds_read_b64_tr_b16 a[94:95], v228 offset:61440
  v_xor_b32 v228, 0x10000, v228
  v_mfma_f32_16x16x32_bf16 v[112:115], a[76:79], a[48:51], v[112:115]
  s_mov_b32 s43, 0x3a800000
  v_add_f32 v245, v245, v249
  v_mov_b32 v250, 0x3727c5ac
  v_mfma_f32_16x16x32_bf16 v[112:115], a[72:75], a[32:35], v[112:115]
  v_lshlrev_b32 v246, 2, v253
  v_add_u32 v246, s71, v246
  v_mfma_f32_16x16x32_bf16 v[128:131], a[80:83], a[32:35], v[128:131]
  ds_read_b64_tr_b16 a[64:65], v229 offset:32768
  v_permlane32_swap_b32 v238, v242
  v_mfma_f32_16x16x32_bf16 v[128:131], a[84:87], a[48:51], v[128:131]
  ds_read_b64_tr_b16 a[66:67], v229 offset:36864
  s_add_u32 m0, s68, 32768
  v_mfma_f32_16x16x32_bf16 v[132:135], a[84:87], a[52:55], v[132:135]
  buffer_load_dwordx4 v232, s[16:19], s67 offen offset:0  lds
  v_mfma_f32_16x16x32_bf16 v[132:135], a[80:83], a[36:39], v[132:135]
  v_permlane32_swap_b32 v239, v243
  v_permlane32_swap_b32 v240, v244
  v_mfma_f32_16x16x32_bf16 v[136:139], a[80:83], a[40:43], v[136:139]
  ds_read_b64_tr_b16 a[68:69], v229 offset:40960
  v_permlane32_swap_b32 v241, v245
  v_mfma_f32_16x16x32_bf16 v[136:139], a[84:87], a[56:59], v[136:139]
  ds_read_b64_tr_b16 a[70:71], v229 offset:45056
  v_add_f32 v238, v238, v242
  v_mfma_f32_16x16x32_bf16 v[140:143], a[84:87], a[60:63], v[140:143]
  buffer_load_dwordx4 v233, s[16:19], s67 offen offset:1024  lds
  v_mfma_f32_16x16x32_bf16 v[140:143], a[80:83], a[44:47], v[140:143]
  s_waitcnt lgkmcnt(4)
  v_add_f32 v240, v240, v244
  v_add_f32 v239, v239, v243
  v_mfma_f32_16x16x32_bf16 v[156:159], a[88:91], a[44:47], v[156:159]
  ds_read_b64_tr_b16 a[72:73], v229 offset:49152
  v_add_f32 v241, v241, v245
  v_mfma_f32_16x16x32_bf16 v[156:159], a[92:95], a[60:63], v[156:159]
  ds_read_b64_tr_b16 a[74:75], v229 offset:53248
  v_and_b32 v247, 0xffffff3f, v246
  v_mfma_f32_16x16x32_bf16 v[152:155], a[92:95], a[56:59], v[152:155]
  buffer_load_dwordx4 v234, s[16:19], s67 offen offset:2048  lds
  v_mfma_f32_16x16x32_bf16 v[152:155], a[88:91], a[40:43], v[152:155]
  v_permlane16_swap_b32 v238, v240
  v_permlane16_swap_b32 v239, v241
  v_mfma_f32_16x16x32_bf16 v[148:151], a[88:91], a[36:39], v[148:151]
  ds_read_b64_tr_b16 a[76:77], v229 offset:57344
  v_add_f32 v238, v238, v240
  v_mfma_f32_16x16x32_bf16 v[148:151], a[92:95], a[52:55], v[148:151]
  ds_read_b64_tr_b16 a[78:79], v229 offset:61440
  v_xor_b32 v229, 0x10000, v229
  v_add_f32 v239, v239, v241
  v_mfma_f32_16x16x32_bf16 v[144:147], a[92:95], a[48:51], v[144:147]
  v_add_u32 v247, 1024, v247
  v_mul_f32 v238, 0xba800000, v238
  v_mfma_f32_16x16x32_bf16 v[144:147], a[88:91], a[32:35], v[144:147]
  s_waitcnt lgkmcnt(4)
  v_fma_f32 v239, v239, s43, v250
  v_fma_f32 v239, -v238, v238, v239
  v_mfma_f32_16x16x32_bf16 v[160:163], a[64:67], a[32:35], v[160:163]
  ds_read_b64_tr_b16 a[80:81], v230 offset:32768
  v_max_f32 v239, v239, v250
  v_mfma_f32_16x16x32_bf16 v[160:163], a[68:71], a[48:51], v[160:163]
  ds_read_b64_tr_b16 a[82:83], v230 offset:36864
  v_rsq_f32 v240, v239
  v_mfma_f32_16x16x32_bf16 v[164:167], a[68:71], a[52:55], v[164:167]
  buffer_load_dwordx4 v235, s[16:19], s67 offen offset:3072  lds
  v_mfma_f32_16x16x32_bf16 v[164:167], a[64:67], a[36:39], v[164:167]
  ds_write_b32 v246, v238 offset:1024
  ds_write_b32 v246, v239 offset:1536
  v_mfma_f32_16x16x32_bf16 v[168:171], a[64:67], a[40:43], v[168:171]
  ds_read_b64_tr_b16 a[84:85], v230 offset:40960
  v_mul_f32 v240, 0xbfb8aa3b, v240
  v_mfma_f32_16x16x32_bf16 v[168:171], a[68:71], a[56:59], v[168:171]
  ds_read_b64_tr_b16 a[86:87], v230 offset:45056
  s_add_u32 m0, s68, 49152
  v_mfma_f32_16x16x32_bf16 v[172:175], a[68:71], a[60:63], v[172:175]
  buffer_load_dwordx4 v232, s[20:23], s67 offen offset:0  lds
  v_mfma_f32_16x16x32_bf16 v[172:175], a[64:67], a[44:47], v[172:175]
  s_waitcnt lgkmcnt(6)
  ds_write_b32 v246, v240 offset:1280
  ds_read2_b32 v[238:239], v247 offset0:0 offset1:16
  v_mfma_f32_16x16x32_bf16 v[188:191], a[72:75], a[44:47], v[188:191]
  ds_read_b64_tr_b16 a[88:89], v230 offset:49152
  ds_read2_b32 v[240:241], v247 offset0:32 offset1:48
  v_mfma_f32_16x16x32_bf16 v[188:191], a[76:79], a[60:63], v[188:191]
  ds_read_b64_tr_b16 a[90:91], v230 offset:53248
  v_lshrrev_b32 v250, 3, v253
  v_mfma_f32_16x16x32_bf16 v[184:187], a[76:79], a[56:59], v[184:187]
  v_add_u32 v250, s66, v250
  v_cmp_ne_u32 vcc, 7, v250
  v_mfma_f32_16x16x32_bf16 v[184:187], a[72:75], a[40:43], v[184:187]
  v_bfe_u32 v242, v253, 2, 1
  v_mul_u32_u24 v242, 14336, v242
  v_mfma_f32_16x16x32_bf16 v[180:183], a[72:75], a[36:39], v[180:183]
  ds_read_b64_tr_b16 a[92:93], v230 offset:57344
  v_cndmask_b32 v250, 0, v250, vcc
  v_mfma_f32_16x16x32_bf16 v[180:183], a[76:79], a[52:55], v[180:183]
  ds_read_b64_tr_b16 a[94:95], v230 offset:61440
  v_xor_b32 v230, 0x10000, v230
  v_lshl_add_u32 v250, v250, 6, v242
  v_mfma_f32_16x16x32_bf16 v[176:179], a[76:79], a[48:51], v[176:179]
  buffer_load_dwordx4 v233, s[20:23], s67 offen offset:1024  lds
  v_mfma_f32_16x16x32_bf16 v[176:179], a[72:75], a[32:35], v[176:179]
  s_waitcnt lgkmcnt(7)
  v_and_b32 v242, 3, v253
  v_lshl_add_u32 v250, v242, 4, v250
  v_mfma_f32_16x16x32_bf16 v[192:195], a[80:83], a[32:35], v[192:195]
  s_waitcnt vmcnt(17)
  s_barrier
  ds_read_b64_tr_b16 a[64:65], v224 offset:0
  s_waitcnt vmcnt(9)
  v_cmp_gt_u32 vcc, 56, v237
  s_cbranch_vccnz Lchk19_c
Lchk19_r:
  v_mfma_f32_16x16x32_bf16 v[192:195], a[84:87], a[48:51], v[192:195]
  ds_read_b64_tr_b16 a[66:67], v224 offset:4096
  buffer_load_dwordx4 v[242:245], v250, s[4:7], s46 offen sc1
  v_mfma_f32_16x16x32_bf16 v[196:199], a[84:87], a[52:55], v[196:199]
  buffer_load_dwordx4 v[246:249], v250, s[4:7], s47 offen sc1
  v_lshrrev_b32 v237, 4, v253
  v_mfma_f32_16x16x32_bf16 v[196:199], a[80:83], a[36:39], v[196:199]
  v_lshlrev_b32 v237, 4, v237
  v_add_u32 v237, s71, v237
  v_mfma_f32_16x16x32_bf16 v[200:203], a[80:83], a[40:43], v[200:203]
  ds_read_b64_tr_b16 a[68:69], v224 offset:8192
  v_add_u32 v250, s71, v231
  v_mfma_f32_16x16x32_bf16 v[200:203], a[84:87], a[56:59], v[200:203]
  ds_read_b64_tr_b16 a[70:71], v224 offset:12288
  v_mfma_f32_16x16x32_bf16 v[204:207], a[84:87], a[60:63], v[204:207]
  buffer_load_dwordx4 v234, s[20:23], s67 offen offset:2048  lds
  v_mfma_f32_16x16x32_bf16 v[204:207], a[80:83], a[44:47], v[204:207]
  s_waitcnt lgkmcnt(4)
  v_mfma_f32_16x16x32_bf16 v[220:223], a[88:91], a[44:47], v[220:223]
  ds_read_b64_tr_b16 a[72:73], v224 offset:16384
  v_mfma_f32_16x16x32_bf16 v[220:223], a[92:95], a[60:63], v[220:223]
  ds_read_b64_tr_b16 a[74:75], v224 offset:20480
  v_mfma_f32_16x16x32_bf16 v[216:219], a[92:95], a[56:59], v[216:219]
  buffer_load_dwordx4 v235, s[20:23], s67 offen offset:3072  lds
  v_mfma_f32_16x16x32_bf16 v[216:219], a[88:91], a[40:43], v[216:219]
  s_add_u32 s67, s67, 458752
  s_xor_b32 s68, s68, 0x10000
  v_mfma_f32_16x16x32_bf16 v[212:215], a[88:91], a[36:39], v[212:215]
  ds_read_b64_tr_b16 a[76:77], v224 offset:24576
  v_mfma_f32_16x16x32_bf16 v[212:215], a[92:95], a[52:55], v[212:215]
  ds_read_b64_tr_b16 a[78:79], v224 offset:28672
  v_mfma_f32_16x16x32_bf16 v[208:211], a[92:95], a[48:51], v[208:211]
  v_mfma_f32_16x16x32_bf16 v[208:211], a[88:91], a[32:35], v[208:211]
  s_mov_b32 s56, 5
.p2align 3
Lp3_loop:
  s_waitcnt vmcnt(8) lgkmcnt(4)
  v_mfma_f32_16x16x32_bf16 v[0:3], a[64:67], a[0:3], v[0:3]
  ds_read_b64_tr_b16 a[80:81], v225 offset:0
  v_mfma_f32_16x16x32_bf16 v[0:3], a[68:71], a[16:19], v[0:3]
  ds_read_b64_tr_b16 a[82:83], v225 offset:4096
  v_mfma_f32_16x16x32_bf16 v[4:7], a[68:71], a[20:23], v[4:7]
  buffer_load_dwordx4 a[32:35], v231, s[4:7], s72 offen offset:2048 sc1
  v_mfma_f32_16x16x32_bf16 v[4:7], a[64:67], a[4:7], v[4:7]
  v_mfma_f32_16x16x32_bf16 v[8:11], a[64:67], a[8:11], v[8:11]
  ds_read_b64_tr_b16 a[84:85], v225 offset:8192
  v_mfma_f32_16x16x32_bf16 v[8:11], a[68:71], a[24:27], v[8:11]
  ds_read_b64_tr_b16 a[86:87], v225 offset:12288
  v_mfma_f32_16x16x32_bf16 v[12:15], a[68:71], a[28:31], v[12:15]
  v_mfma_f32_16x16x32_bf16 v[12:15], a[64:67], a[12:15], v[12:15]
  s_waitcnt lgkmcnt(4)
  v_mfma_f32_16x16x32_bf16 v[28:31], a[72:75], a[12:15], v[28:31]
  ds_read_b64_tr_b16 a[88:89], v225 offset:16384
  v_mfma_f32_16x16x32_bf16 v[28:31], a[76:79], a[28:31], v[28:31]
  ds_read_b64_tr_b16 a[90:91], v225 offset:20480
  v_mfma_f32_16x16x32_bf16 v[24:27], a[76:79], a[24:27], v[24:27]
  buffer_load_dwordx4 a[48:51], v231, s[4:7], s72 offen offset:3072 sc1
  v_mfma_f32_16x16x32_bf16 v[24:27], a[72:75], a[8:11], v[24:27]
  s_add_u32 s72, s72, 4096
  v_mfma_f32_16x16x32_bf16 v[20:23], a[72:75], a[4:7], v[20:23]
  ds_read_b64_tr_b16 a[92:93], v225 offset:24576
  v_mfma_f32_16x16x32_bf16 v[20:23], a[76:79], a[20:23], v[20:23]
  ds_read_b64_tr_b16 a[94:95], v225 offset:28672
  v_mfma_f32_16x16x32_bf16 v[16:19], a[76:79], a[16:19], v[16:19]
  v_mfma_f32_16x16x32_bf16 v[16:19], a[72:75], a[0:3], v[16:19]
  s_waitcnt lgkmcnt(4)
  v_mfma_f32_16x16x32_bf16 v[32:35], a[80:83], a[0:3], v[32:35]
  ds_read_b64_tr_b16 a[64:65], v226 offset:0
  v_mfma_f32_16x16x32_bf16 v[32:35], a[84:87], a[16:19], v[32:35]
  ds_read_b64_tr_b16 a[66:67], v226 offset:4096
  v_mfma_f32_16x16x32_bf16 v[36:39], a[84:87], a[20:23], v[36:39]
  buffer_load_dwordx4 a[36:39], v231, s[4:7], s73 offen offset:2048 sc1
  v_mfma_f32_16x16x32_bf16 v[36:39], a[80:83], a[4:7], v[36:39]
  v_mfma_f32_16x16x32_bf16 v[40:43], a[80:83], a[8:11], v[40:43]
  ds_read_b64_tr_b16 a[68:69], v226 offset:8192
  v_mfma_f32_16x16x32_bf16 v[40:43], a[84:87], a[24:27], v[40:43]
  ds_read_b64_tr_b16 a[70:71], v226 offset:12288
  v_mfma_f32_16x16x32_bf16 v[44:47], a[84:87], a[28:31], v[44:47]
  buffer_load_dwordx4 a[52:55], v231, s[4:7], s73 offen offset:3072 sc1
  v_mfma_f32_16x16x32_bf16 v[44:47], a[80:83], a[12:15], v[44:47]
  s_add_u32 s73, s73, 4096
  s_waitcnt lgkmcnt(4)
  v_mfma_f32_16x16x32_bf16 v[60:63], a[88:91], a[12:15], v[60:63]
  ds_read_b64_tr_b16 a[72:73], v226 offset:16384
  v_mfma_f32_16x16x32_bf16 v[60:63], a[92:95], a[28:31], v[60:63]
  ds_read_b64_tr_b16 a[74:75], v226 offset:20480
  v_mfma_f32_16x16x32_bf16 v[56:59], a[92:95], a[24:27], v[56:59]
  v_mfma_f32_16x16x32_bf16 v[56:59], a[88:91], a[8:11], v[56:59]
  v_mfma_f32_16x16x32_bf16 v[52:55], a[88:91], a[4:7], v[52:55]
  ds_read_b64_tr_b16 a[76:77], v226 offset:24576
  v_mfma_f32_16x16x32_bf16 v[52:55], a[92:95], a[20:23], v[52:55]
  ds_read_b64_tr_b16 a[78:79], v226 offset:28672
  v_mfma_f32_16x16x32_bf16 v[48:51], a[92:95], a[16:19], v[48:51]
  buffer_load_dwordx4 a[40:43], v231, s[4:7], s74 offen offset:2048 sc1
  v_mfma_f32_16x16x32_bf16 v[48:51], a[88:91], a[0:3], v[48:51]
  s_waitcnt lgkmcnt(4)
  v_mfma_f32_16x16x32_bf16 v[64:67], a[64:67], a[0:3], v[64:67]
  ds_read_b64_tr_b16 a[80:81], v227 offset:0
  v_mfma_f32_16x16x32_bf16 v[64:67], a[68:71], a[16:19], v[64:67]
  ds_read_b64_tr_b16 a[82:83], v227 offset:4096
  v_mfma_f32_16x16x32_bf16 v[68:71], a[68:71], a[20:23], v[68:71]
  v_mfma_f32_16x16x32_bf16 v[68:71], a[64:67], a[4:7], v[68:71]
  v_mfma_f32_16x16x32_bf16 v[72:75], a[64:67], a[8:11], v[72:75]
  ds_read_b64_tr_b16 a[84:85], v227 offset:8192
  v_mfma_f32_16x16x32_bf16 v[72:75], a[68:71], a[24:27], v[72:75]
  ds_read_b64_tr_b16 a[86:87], v227 offset:12288
  v_mfma_f32_16x16x32_bf16 v[76:79], a[68:71], a[28:31], v[76:79]
  buffer_load_dwordx4 a[56:59], v231, s[4:7], s74 offen offset:3072 sc1
  v_mfma_f32_16x16x32_bf16 v[76:79], a[64:67], a[12:15], v[76:79]
  s_add_u32 s74, s74, 4096
  s_waitcnt lgkmcnt(4)
  v_mfma_f32_16x16x32_bf16 v[92:95], a[72:75], a[12:15], v[92:95]
  ds_read_b64_tr_b16 a[88:89], v227 offset:16384
  v_mfma_f32_16x16x32_bf16 v[92:95], a[76:79], a[28:31], v[92:95]
  ds_read_b64_tr_b16 a[90:91], v227 offset:20480
  v_mfma_f32_16x16x32_bf16 v[88:91], a[76:79], a[24:27], v[88:91]
  v_mfma_f32_16x16x32_bf16 v[88:91], a[72:75], a[8:11], v[88:91]
  v_mfma_f32_16x16x32_bf16 v[84:87], a[72:75], a[4:7], v[84:87]
  ds_read_b64_tr_b16 a[92:93], v227 offset:24576
  v_mfma_f32_16x16x32_bf16 v[84:87], a[76:79], a[20:23], v[84:87]
  ds_read_b64_tr_b16 a[94:95], v227 offset:28672
  v_mfma_f32_16x16x32_bf16 v[80:83], a[76:79], a[16:19], v[80:83]
  buffer_load_dwordx4 a[44:47], v231, s[4:7], s75 offen offset:2048 sc1
  v_mfma_f32_16x16x32_bf16 v[80:83], a[72:75], a[0:3], v[80:83]
  s_waitcnt lgkmcnt(4)
  v_mfma_f32_16x16x32_bf16 v[96:99], a[80:83], a[0:3], v[96:99]
  ds_read_b64_tr_b16 a[64:65], v228 offset:0
  v_mfma_f32_16x16x32_bf16 v[96:99], a[84:87], a[16:19], v[96:99]
  ds_read_b64_tr_b16 a[66:67], v228 offset:4096
  v_mfma_f32_16x16x32_bf16 v[100:103], a[84:87], a[20:23], v[100:103]
  buffer_load_dwordx4 a[96:99], v236, s[24:27], s70 offen
  v_mfma_f32_16x16x32_bf16 v[100:103], a[80:83], a[4:7], v[100:103]
  s_add_u32 s70, s70, 1024
  v_mfma_f32_16x16x32_bf16 v[104:107], a[80:83], a[8:11], v[104:107]
  ds_read_b64_tr_b16 a[68:69], v228 offset:8192
  v_mfma_f32_16x16x32_bf16 v[104:107], a[84:87], a[24:27], v[104:107]
  ds_read_b64_tr_b16 a[70:71], v228 offset:12288
  v_mfma_f32_16x16x32_bf16 v[108:111], a[84:87], a[28:31], v[108:111]
  buffer_load_dwordx4 a[60:63], v231, s[4:7], s75 offen offset:3072 sc1
  v_mfma_f32_16x16x32_bf16 v[108:111], a[80:83], a[12:15], v[108:111]
  s_add_u32 s75, s75, 4096
  s_waitcnt lgkmcnt(4)
  v_mfma_f32_16x16x32_bf16 v[124:127], a[88:91], a[12:15], v[124:127]
  ds_read_b64_tr_b16 a[72:73], v228 offset:16384
  v_mfma_f32_16x16x32_bf16 v[124:127], a[92:95], a[28:31], v[124:127]
  ds_read_b64_tr_b16 a[74:75], v228 offset:20480
  s_add_u32 m0, s68, 0
  v_mfma_f32_16x16x32_bf16 v[120:123], a[92:95], a[24:27], v[120:123]
  buffer_load_dwordx4 v232, s[16:19], s67 offen offset:0  lds
  v_mfma_f32_16x16x32_bf16 v[120:123], a[88:91], a[8:11], v[120:123]
  v_mfma_f32_16x16x32_bf16 v[116:119], a[88:91], a[4:7], v[116:119]
  ds_read_b64_tr_b16 a[76:77], v228 offset:24576
  v_mfma_f32_16x16x32_bf16 v[116:119], a[92:95], a[20:23], v[116:119]
  ds_read_b64_tr_b16 a[78:79], v228 offset:28672
  v_mfma_f32_16x16x32_bf16 v[112:115], a[92:95], a[16:19], v[112:115]
  v_mfma_f32_16x16x32_bf16 v[112:115], a[88:91], a[0:3], v[112:115]
  s_waitcnt lgkmcnt(4)
  v_mfma_f32_16x16x32_bf16 v[128:131], a[64:67], a[0:3], v[128:131]
  ds_read_b64_tr_b16 a[80:81], v229 offset:0
  v_mfma_f32_16x16x32_bf16 v[128:131], a[68:71], a[16:19], v[128:131]
  ds_read_b64_tr_b16 a[82:83], v229 offset:4096
  v_mfma_f32_16x16x32_bf16 v[132:135], a[68:71], a[20:23], v[132:135]
  buffer_load_dwordx4 v233, s[16:19], s67 offen offset:1024  lds
  v_mfma_f32_16x16x32_bf16 v[132:135], a[64:67], a[4:7], v[132:135]
  v_mfma_f32_16x16x32_bf16 v[136:139], a[64:67], a[8:11], v[136:139]
  ds_read_b64_tr_b16 a[84:85], v229 offset:8192
  v_mfma_f32_16x16x32_bf16 v[136:139], a[68:71], a[24:27], v[136:139]
  ds_read_b64_tr_b16 a[86:87], v229 offset:12288
  v_mfma_f32_16x16x32_bf16 v[140:143], a[68:71], a[28:31], v[140:143]
  v_mfma_f32_16x16x32_bf16 v[140:143], a[64:67], a[12:15], v[140:143]
  s_waitcnt lgkmcnt(4)
  v_mfma_f32_16x16x32_bf16 v[156:159], a[72:75], a[12:15], v[156:159]
  ds_read_b64_tr_b16 a[88:89], v229 offset:16384
  v_mfma_f32_16x16x32_bf16 v[156:159], a[76:79], a[28:31], v[156:159]
  ds_read_b64_tr_b16 a[90:91], v229 offset:20480
  v_mfma_f32_16x16x32_bf16 v[152:155], a[76:79], a[24:27], v[152:155]
  buffer_load_dwordx4 v234, s[16:19], s67 offen offset:2048  lds
  v_mfma_f32_16x16x32_bf16 v[152:155], a[72:75], a[8:11], v[152:155]
  v_mfma_f32_16x16x32_bf16 v[148:151], a[72:75], a[4:7], v[148:151]
  ds_read_b64_tr_b16 a[92:93], v229 offset:24576
  v_mfma_f32_16x16x32_bf16 v[148:151], a[76:79], a[20:23], v[148:151]
  ds_read_b64_tr_b16 a[94:95], v229 offset:28672
  v_mfma_f32_16x16x32_bf16 v[144:147], a[76:79], a[16:19], v[144:147]
  buffer_load_dwordx4 v235, s[16:19], s67 offen offset:3072  lds
  v_mfma_f32_16x16x32_bf16 v[144:147], a[72:75], a[0:3], v[144:147]
  s_waitcnt lgkmcnt(4)
  v_mfma_f32_16x16x32_bf16 v[160:163], a[80:83], a[0:3], v[160:163]
  ds_read_b64_tr_b16 a[64:65], v230 offset:0
  v_mfma_f32_16x16x32_bf16 v[160:163], a[84:87], a[16:19], v[160:163]
  ds_read_b64_tr_b16 a[66:67], v230 offset:4096
  v_mfma_f32_16x16x32_bf16 v[164:167], a[84:87], a[20:23], v[164:167]
  v_mfma_f32_16x16x32_bf16 v[164:167], a[80:83], a[4:7], v[164:167]
  v_mfma_f32_16x16x32_bf16 v[168:171], a[80:83], a[8:11], v[168:171]
  ds_read_b64_tr_b16 a[68:69], v230 offset:8192
  v_mfma_f32_16x16x32_bf16 v[168:171], a[84:87], a[24:27], v[168:171]
  ds_read_b64_tr_b16 a[70:71], v230 offset:12288
  s_add_u32 m0, s68, 16384
  v_mfma_f32_16x16x32_bf16 v[172:175], a[84:87], a[28:31], v[172:175]
  buffer_load_dwordx4 v232, s[20:23], s67 offen offset:0  lds
  v_mfma_f32_16x16x32_bf16 v[172:175], a[80:83], a[12:15], v[172:175]
  s_waitcnt lgkmcnt(4)
  v_mfma_f32_16x16x32_bf16 v[188:191], a[88:91], a[12:15], v[188:191]
  ds_read_b64_tr_b16 a[72:73], v230 offset:16384
  v_mfma_f32_16x16x32_bf16 v[188:191], a[92:95], a[28:31], v[188:191]
  ds_read_b64_tr_b16 a[74:75], v230 offset:20480
  v_mfma_f32_16x16x32_bf16 v[184:187], a[92:95], a[24:27], v[184:187]
  v_mfma_f32_16x16x32_bf16 v[184:187], a[88:91], a[8:11], v[184:187]
  v_mfma_f32_16x16x32_bf16 v[180:183], a[88:91], a[4:7], v[180:183]
  ds_read_b64_tr_b16 a[76:77], v230 offset:24576
  v_mfma_f32_16x16x32_bf16 v[180:183], a[92:95], a[20:23], v[180:183]
  ds_read_b64_tr_b16 a[78:79], v230 offset:28672
  v_mfma_f32_16x16x32_bf16 v[176:179], a[92:95], a[16:19], v[176:179]
  buffer_load_dwordx4 v233, s[20:23], s67 offen offset:1024  lds
  v_mfma_f32_16x16x32_bf16 v[176:179], a[88:91], a[0:3], v[176:179]
  s_waitcnt lgkmcnt(4)
  v_mfma_f32_16x16x32_bf16 v[192:195], a[64:67], a[0:3], v[192:195]
  s_waitcnt vmcnt(15)
  s_barrier
  ds_read_b64_tr_b16 a[80:81], v224 offset:32768
  v_mfma_f32_16x16x32_bf16 v[192:195], a[68:71], a[16:19], v[192:195]
  ds_read_b64_tr_b16 a[82:83], v224 offset:36864
  v_mfma_f32_16x16x32_bf16 v[196:199], a[68:71], a[20:23], v[196:199]
  v_mfma_f32_16x16x32_bf16 v[196:199], a[64:67], a[4:7], v[196:199]
  v_mfma_f32_16x16x32_bf16 v[200:203], a[64:67], a[8:11], v[200:203]
  ds_read_b64_tr_b16 a[84:85], v224 offset:40960
  v_mfma_f32_16x16x32_bf16 v[200:203], a[68:71], a[24:27], v[200:203]
  ds_read_b64_tr_b16 a[86:87], v224 offset:45056
  v_mfma_f32_16x16x32_bf16 v[204:207], a[68:71], a[28:31], v[204:207]
  buffer_load_dwordx4 v234, s[20:23], s67 offen offset:2048  lds
  v_mfma_f32_16x16x32_bf16 v[204:207], a[64:67], a[12:15], v[204:207]
  s_waitcnt lgkmcnt(4)
  v_mfma_f32_16x16x32_bf16 v[220:223], a[72:75], a[12:15], v[220:223]
  ds_read_b64_tr_b16 a[88:89], v224 offset:49152
  v_mfma_f32_16x16x32_bf16 v[220:223], a[76:79], a[28:31], v[220:223]
  ds_read_b64_tr_b16 a[90:91], v224 offset:53248
  v_mfma_f32_16x16x32_bf16 v[216:219], a[76:79], a[24:27], v[216:219]
  buffer_load_dwordx4 v235, s[20:23], s67 offen offset:3072  lds
  v_mfma_f32_16x16x32_bf16 v[216:219], a[72:75], a[8:11], v[216:219]
  s_add_u32 s67, s67, 458752
  v_mfma_f32_16x16x32_bf16 v[212:215], a[72:75], a[4:7], v[212:215]
  ds_read_b64_tr_b16 a[92:93], v224 offset:57344
  v_mfma_f32_16x16x32_bf16 v[212:215], a[76:79], a[20:23], v[212:215]
  ds_read_b64_tr_b16 a[94:95], v224 offset:61440
  v_xor_b32 v224, 0x10000, v224
  v_mfma_f32_16x16x32_bf16 v[208:211], a[76:79], a[16:19], v[208:211]
  v_mfma_f32_16x16x32_bf16 v[208:211], a[72:75], a[0:3], v[208:211]
  s_waitcnt vmcnt(8) lgkmcnt(4)
  v_mfma_f32_16x16x32_bf16 v[0:3], a[80:83], a[32:35], v[0:3]
  ds_read_b64_tr_b16 a[64:65], v225 offset:32768
  v_mfma_f32_16x16x32_bf16 v[0:3], a[84:87], a[48:51], v[0:3]
  ds_read_b64_tr_b16 a[66:67], v225 offset:36864
  v_mfma_f32_16x16x32_bf16 v[4:7], a[84:87], a[52:55], v[4:7]
  buffer_load_dwordx4 a[0:3], v231, s[4:7], s72 offen offset:0 sc1
  v_mfma_f32_16x16x32_bf16 v[4:7], a[80:83], a[36:39], v[4:7]
  v_mfma_f32_16x16x32_bf16 v[8:11], a[80:83], a[40:43], v[8:11]
  ds_read_b64_tr_b16 a[68:69], v225 offset:40960
  v_mfma_f32_16x16x32_bf16 v[8:11], a[84:87], a[56:59], v[8:11]
  ds_read_b64_tr_b16 a[70:71], v225 offset:45056
  v_mfma_f32_16x16x32_bf16 v[12:15], a[84:87], a[60:63], v[12:15]
  v_mfma_f32_16x16x32_bf16 v[12:15], a[80:83], a[44:47], v[12:15]
  s_waitcnt lgkmcnt(4)
  v_mfma_f32_16x16x32_bf16 v[28:31], a[88:91], a[44:47], v[28:31]
  ds_read_b64_tr_b16 a[72:73], v225 offset:49152
  v_mfma_f32_16x16x32_bf16 v[28:31], a[92:95], a[60:63], v[28:31]
  ds_read_b64_tr_b16 a[74:75], v225 offset:53248
  v_mfma_f32_16x16x32_bf16 v[24:27], a[92:95], a[56:59], v[24:27]
  buffer_load_dwordx4 a[16:19], v231, s[4:7], s72 offen offset:1024 sc1
  v_mfma_f32_16x16x32_bf16 v[24:27], a[88:91], a[40:43], v[24:27]
  v_mfma_f32_16x16x32_bf16 v[20:23], a[88:91], a[36:39], v[20:23]
  ds_read_b64_tr_b16 a[76:77], v225 offset:57344
  v_mfma_f32_16x16x32_bf16 v[20:23], a[92:95], a[52:55], v[20:23]
  ds_read_b64_tr_b16 a[78:79], v225 offset:61440
  v_xor_b32 v225, 0x10000, v225
  v_mfma_f32_16x16x32_bf16 v[16:19], a[92:95], a[48:51], v[16:19]
  v_mfma_f32_16x16x32_bf16 v[16:19], a[88:91], a[32:35], v[16:19]
  s_waitcnt lgkmcnt(4)
  v_mfma_f32_16x16x32_bf16 v[32:35], a[64:67], a[32:35], v[32:35]
  ds_read_b64_tr_b16 a[80:81], v226 offset:32768
  v_mfma_f32_16x16x32_bf16 v[32:35], a[68:71], a[48:51], v[32:35]
  ds_read_b64_tr_b16 a[82:83], v226 offset:36864
  v_mfma_f32_16x16x32_bf16 v[36:39], a[68:71], a[52:55], v[36:39]
  buffer_load_dwordx4 a[4:7], v231, s[4:7], s73 offen offset:0 sc1
  v_mfma_f32_16x16x32_bf16 v[36:39], a[64:67], a[36:39], v[36:39]
  v_mfma_f32_16x16x32_bf16 v[40:43], a[64:67], a[40:43], v[40:43]
  ds_read_b64_tr_b16 a[84:85], v226 offset:40960
  v_mfma_f32_16x16x32_bf16 v[40:43], a[68:71], a[56:59], v[40:43]
  ds_read_b64_tr_b16 a[86:87], v226 offset:45056
  v_mfma_f32_16x16x32_bf16 v[44:47], a[68:71], a[60:63], v[44:47]
  buffer_load_dwordx4 a[20:23], v231, s[4:7], s73 offen offset:1024 sc1
  v_mfma_f32_16x16x32_bf16 v[44:47], a[64:67], a[44:47], v[44:47]
  s_waitcnt lgkmcnt(4)
  v_mfma_f32_16x16x32_bf16 v[60:63], a[72:75], a[44:47], v[60:63]
  ds_read_b64_tr_b16 a[88:89], v226 offset:49152
  v_mfma_f32_16x16x32_bf16 v[60:63], a[76:79], a[60:63], v[60:63]
  ds_read_b64_tr_b16 a[90:91], v226 offset:53248
  v_mfma_f32_16x16x32_bf16 v[56:59], a[76:79], a[56:59], v[56:59]
  v_mfma_f32_16x16x32_bf16 v[56:59], a[72:75], a[40:43], v[56:59]
  v_mfma_f32_16x16x32_bf16 v[52:55], a[72:75], a[36:39], v[52:55]
  ds_read_b64_tr_b16 a[92:93], v226 offset:57344
  v_mfma_f32_16x16x32_bf16 v[52:55], a[76:79], a[52:55], v[52:55]
  ds_read_b64_tr_b16 a[94:95], v226 offset:61440
  v_xor_b32 v226, 0x10000, v226
  v_mfma_f32_16x16x32_bf16 v[48:51], a[76:79], a[48:51], v[48:51]
  buffer_load_dwordx4 a[8:11], v231, s[4:7], s74 offen offset:0 sc1
  v_mfma_f32_16x16x32_bf16 v[48:51], a[72:75], a[32:35], v[48:51]
  s_waitcnt lgkmcnt(4)
  v_mfma_f32_16x16x32_bf16 v[64:67], a[80:83], a[32:35], v[64:67]
  ds_read_b64_tr_b16 a[64:65], v227 offset:32768
  v_mfma_f32_16x16x32_bf16 v[64:67], a[84:87], a[48:51], v[64:67]
  ds_read_b64_tr_b16 a[66:67], v227 offset:36864
  v_mfma_f32_16x16x32_bf16 v[68:71], a[84:87], a[52:55], v[68:71]
  v_mfma_f32_16x16x32_bf16 v[68:71], a[80:83], a[36:39], v[68:71]
  v_mfma_f32_16x16x32_bf16 v[72:75], a[80:83], a[40:43], v[72:75]
  ds_read_b64_tr_b16 a[68:69], v227 offset:40960
  v_mfma_f32_16x16x32_bf16 v[72:75], a[84:87], a[56:59], v[72:75]
  ds_read_b64_tr_b16 a[70:71], v227 offset:45056
  v_mfma_f32_16x16x32_bf16 v[76:79], a[84:87], a[60:63], v[76:79]
  buffer_load_dwordx4 a[24:27], v231, s[4:7], s74 offen offset:1024 sc1
  v_mfma_f32_16x16x32_bf16 v[76:79], a[80:83], a[44:47], v[76:79]
  s_waitcnt lgkmcnt(4)
  v_mfma_f32_16x16x32_bf16 v[92:95], a[88:91], a[44:47], v[92:95]
  ds_read_b64_tr_b16 a[72:73], v227 offset:49152
  v_mfma_f32_16x16x32_bf16 v[92:95], a[92:95], a[60:63], v[92:95]
  ds_read_b64_tr_b16 a[74:75], v227 offset:53248
  v_mfma_f32_16x16x32_bf16 v[88:91], a[92:95], a[56:59], v[88:91]
  v_mfma_f32_16x16x32_bf16 v[88:91], a[88:91], a[40:43], v[88:91]
  v_mfma_f32_16x16x32_bf16 v[84:87], a[88:91], a[36:39], v[84:87]
  ds_read_b64_tr_b16 a[76:77], v227 offset:57344
  v_mfma_f32_16x16x32_bf16 v[84:87], a[92:95], a[52:55], v[84:87]
  ds_read_b64_tr_b16 a[78:79], v227 offset:61440
  v_xor_b32 v227, 0x10000, v227
  v_mfma_f32_16x16x32_bf16 v[80:83], a[92:95], a[48:51], v[80:83]
  buffer_load_dwordx4 a[12:15], v231, s[4:7], s75 offen offset:0 sc1
  v_mfma_f32_16x16x32_bf16 v[80:83], a[88:91], a[32:35], v[80:83]
  s_waitcnt lgkmcnt(4)
  v_mfma_f32_16x16x32_bf16 v[96:99], a[64:67], a[32:35], v[96:99]
  ds_read_b64_tr_b16 a[80:81], v228 offset:32768
  v_mfma_f32_16x16x32_bf16 v[96:99], a[68:71], a[48:51], v[96:99]
  ds_read_b64_tr_b16 a[82:83], v228 offset:36864
  v_mfma_f32_16x16x32_bf16 v[100:103], a[68:71], a[52:55], v[100:103]
  v_mfma_f32_16x16x32_bf16 v[100:103], a[64:67], a[36:39], v[100:103]
  v_mfma_f32_16x16x32_bf16 v[104:107], a[64:67], a[40:43], v[104:107]
  ds_read_b64_tr_b16 a[84:85], v228 offset:40960
  v_mfma_f32_16x16x32_bf16 v[104:107], a[68:71], a[56:59], v[104:107]
  ds_read_b64_tr_b16 a[86:87], v228 offset:45056
  v_mfma_f32_16x16x32_bf16 v[108:111], a[68:71], a[60:63], v[108:111]
  buffer_load_dwordx4 a[28:31], v231, s[4:7], s75 offen offset:1024 sc1
  v_mfma_f32_16x16x32_bf16 v[108:111], a[64:67], a[44:47], v[108:111]
  s_waitcnt lgkmcnt(4)
  v_mfma_f32_16x16x32_bf16 v[124:127], a[72:75], a[44:47], v[124:127]
  ds_read_b64_tr_b16 a[88:89], v228 offset:49152
  v_mfma_f32_16x16x32_bf16 v[124:127], a[76:79], a[60:63], v[124:127]
  ds_read_b64_tr_b16 a[90:91], v228 offset:53248
  s_add_u32 m0, s68, 32768
  v_mfma_f32_16x16x32_bf16 v[120:123], a[76:79], a[56:59], v[120:123]
  buffer_load_dwordx4 v232, s[16:19], s67 offen offset:0  lds
  v_mfma_f32_16x16x32_bf16 v[120:123], a[72:75], a[40:43], v[120:123]
  v_mfma_f32_16x16x32_bf16 v[116:119], a[72:75], a[36:39], v[116:119]
  ds_read_b64_tr_b16 a[92:93], v228 offset:57344
  v_mfma_f32_16x16x32_bf16 v[116:119], a[76:79], a[52:55], v[116:119]
  ds_read_b64_tr_b16 a[94:95], v228 offset:61440
  v_xor_b32 v228, 0x10000, v228
  v_mfma_f32_16x16x32_bf16 v[112:115], a[76:79], a[48:51], v[112:115]
  v_mfma_f32_16x16x32_bf16 v[112:115], a[72:75], a[32:35], v[112:115]
  s_waitcnt lgkmcnt(4)
  v_mfma_f32_16x16x32_bf16 v[128:131], a[80:83], a[32:35], v[128:131]
  ds_read_b64_tr_b16 a[64:65], v229 offset:32768
  v_mfma_f32_16x16x32_bf16 v[128:131], a[84:87], a[48:51], v[128:131]
  ds_read_b64_tr_b16 a[66:67], v229 offset:36864
  v_mfma_f32_16x16x32_bf16 v[132:135], a[84:87], a[52:55], v[132:135]
  buffer_load_dwordx4 v233, s[16:19], s67 offen offset:1024  lds
  v_mfma_f32_16x16x32_bf16 v[132:135], a[80:83], a[36:39], v[132:135]
  v_mfma_f32_16x16x32_bf16 v[136:139], a[80:83], a[40:43], v[136:139]
  ds_read_b64_tr_b16 a[68:69], v229 offset:40960
  v_mfma_f32_16x16x32_bf16 v[136:139], a[84:87], a[56:59], v[136:139]
  ds_read_b64_tr_b16 a[70:71], v229 offset:45056
  v_mfma_f32_16x16x32_bf16 v[140:143], a[84:87], a[60:63], v[140:143]
  v_mfma_f32_16x16x32_bf16 v[140:143], a[80:83], a[44:47], v[140:143]
  s_waitcnt lgkmcnt(4)
  v_mfma_f32_16x16x32_bf16 v[156:159], a[88:91], a[44:47], v[156:159]
  ds_read_b64_tr_b16 a[72:73], v229 offset:49152
  v_mfma_f32_16x16x32_bf16 v[156:159], a[92:95], a[60:63], v[156:159]
  ds_read_b64_tr_b16 a[74:75], v229 offset:53248
  v_mfma_f32_16x16x32_bf16 v[152:155], a[92:95], a[56:59], v[152:155]
  buffer_load_dwordx4 v234, s[16:19], s67 offen offset:2048  lds
  v_mfma_f32_16x16x32_bf16 v[152:155], a[88:91], a[40:43], v[152:155]
  v_mfma_f32_16x16x32_bf16 v[148:151], a[88:91], a[36:39], v[148:151]
  ds_read_b64_tr_b16 a[76:77], v229 offset:57344
  v_mfma_f32_16x16x32_bf16 v[148:151], a[92:95], a[52:55], v[148:151]
  ds_read_b64_tr_b16 a[78:79], v229 offset:61440
  v_xor_b32 v229, 0x10000, v229
  v_mfma_f32_16x16x32_bf16 v[144:147], a[92:95], a[48:51], v[144:147]
  buffer_load_dwordx4 v235, s[16:19], s67 offen offset:3072  lds
  v_mfma_f32_16x16x32_bf16 v[144:147], a[88:91], a[32:35], v[144:147]
  s_waitcnt lgkmcnt(4)
  v_mfma_f32_16x16x32_bf16 v[160:163], a[64:67], a[32:35], v[160:163]
  ds_read_b64_tr_b16 a[80:81], v230 offset:32768
  v_mfma_f32_16x16x32_bf16 v[160:163], a[68:71], a[48:51], v[160:163]
  ds_read_b64_tr_b16 a[82:83], v230 offset:36864
  v_mfma_f32_16x16x32_bf16 v[164:167], a[68:71], a[52:55], v[164:167]
  v_mfma_f32_16x16x32_bf16 v[164:167], a[64:67], a[36:39], v[164:167]
  v_mfma_f32_16x16x32_bf16 v[168:171], a[64:67], a[40:43], v[168:171]
  ds_read_b64_tr_b16 a[84:85], v230 offset:40960
  v_mfma_f32_16x16x32_bf16 v[168:171], a[68:71], a[56:59], v[168:171]
  ds_read_b64_tr_b16 a[86:87], v230 offset:45056
  s_add_u32 m0, s68, 49152
  v_mfma_f32_16x16x32_bf16 v[172:175], a[68:71], a[60:63], v[172:175]
  buffer_load_dwordx4 v232, s[20:23], s67 offen offset:0  lds
  v_mfma_f32_16x16x32_bf16 v[172:175], a[64:67], a[44:47], v[172:175]
  s_waitcnt lgkmcnt(4)
  v_mfma_f32_16x16x32_bf16 v[188:191], a[72:75], a[44:47], v[188:191]
  ds_read_b64_tr_b16 a[88:89], v230 offset:49152
  v_mfma_f32_16x16x32_bf16 v[188:191], a[76:79], a[60:63], v[188:191]
  ds_read_b64_tr_b16 a[90:91], v230 offset:53248
  v_mfma_f32_16x16x32_bf16 v[184:187], a[76:79], a[56:59], v[184:187]
  v_mfma_f32_16x16x32_bf16 v[184:187], a[72:75], a[40:43], v[184:187]
  v_mfma_f32_16x16x32_bf16 v[180:183], a[72:75], a[36:39], v[180:183]
  ds_read_b64_tr_b16 a[92:93], v230 offset:57344
  v_mfma_f32_16x16x32_bf16 v[180:183], a[76:79], a[52:55], v[180:183]
  ds_read_b64_tr_b16 a[94:95], v230 offset:61440
  v_xor_b32 v230, 0x10000, v230
  v_mfma_f32_16x16x32_bf16 v[176:179], a[76:79], a[48:51], v[176:179]
  buffer_load_dwordx4 v233, s[20:23], s67 offen offset:1024  lds
  v_mfma_f32_16x16x32_bf16 v[176:179], a[72:75], a[32:35], v[176:179]
  s_waitcnt lgkmcnt(4)
  v_mfma_f32_16x16x32_bf16 v[192:195], a[80:83], a[32:35], v[192:195]
  s_waitcnt vmcnt(14)
  s_barrier
  ds_read_b64_tr_b16 a[64:65], v224 offset:0
  v_mfma_f32_16x16x32_bf16 v[192:195], a[84:87], a[48:51], v[192:195]
  ds_read_b64_tr_b16 a[66:67], v224 offset:4096
  v_mfma_f32_16x16x32_bf16 v[196:199], a[84:87], a[52:55], v[196:199]
  v_mfma_f32_16x16x32_bf16 v[196:199], a[80:83], a[36:39], v[196:199]
  v_mfma_f32_16x16x32_bf16 v[200:203], a[80:83], a[40:43], v[200:203]
  ds_read_b64_tr_b16 a[68:69], v224 offset:8192
  v_mfma_f32_16x16x32_bf16 v[200:203], a[84:87], a[56:59], v[200:203]
  ds_read_b64_tr_b16 a[70:71], v224 offset:12288
  v_mfma_f32_16x16x32_bf16 v[204:207], a[84:87], a[60:63], v[204:207]
  buffer_load_dwordx4 v234, s[20:23], s67 offen offset:2048  lds
  v_mfma_f32_16x16x32_bf16 v[204:207], a[80:83], a[44:47], v[204:207]
  s_waitcnt lgkmcnt(4)
  v_mfma_f32_16x16x32_bf16 v[220:223], a[88:91], a[44:47], v[220:223]
  ds_read_b64_tr_b16 a[72:73], v224 offset:16384
  v_mfma_f32_16x16x32_bf16 v[220:223], a[92:95], a[60:63], v[220:223]
  ds_read_b64_tr_b16 a[74:75], v224 offset:20480
  v_mfma_f32_16x16x32_bf16 v[216:219], a[92:95], a[56:59], v[216:219]
  buffer_load_dwordx4 v235, s[20:23], s67 offen offset:3072  lds
  v_mfma_f32_16x16x32_bf16 v[216:219], a[88:91], a[40:43], v[216:219]
  s_add_u32 s67, s67, 458752
  s_xor_b32 s68, s68, 0x10000
  v_mfma_f32_16x16x32_bf16 v[212:215], a[88:91], a[36:39], v[212:215]
  ds_read_b64_tr_b16 a[76:77], v224 offset:24576
  v_mfma_f32_16x16x32_bf16 v[212:215], a[92:95], a[52:55], v[212:215]
  s_sub_u32 s56, s56, 1
  ds_read_b64_tr_b16 a[78:79], v224 offset:28672
  v_mfma_f32_16x16x32_bf16 v[208:211], a[92:95], a[48:51], v[208:211]
  s_cmp_lg_u32 s56, 0
  v_mfma_f32_16x16x32_bf16 v[208:211], a[88:91], a[32:35], v[208:211]
  s_cbranch_scc1 Lp3_loop
Lmk_Lp3_loop_tail:
  s_waitcnt vmcnt(8) lgkmcnt(4)
  v_mfma_f32_16x16x32_bf16 v[0:3], a[64:67], a[0:3], v[0:3]
  ds_read_b64_tr_b16 a[80:81], v225 offset:0
  v_add_f32 v242, v242, v246
  v_mfma_f32_16x16x32_bf16 v[0:3], a[68:71], a[16:19], v[0:3]
  ds_read_b64_tr_b16 a[82:83], v225 offset:4096
  v_add_f32 v243, v243, v247
  v_mfma_f32_16x16x32_bf16 v[4:7], a[68:71], a[20:23], v[4:7]
  buffer_load_dwordx4 a[32:35], v231, s[4:7], s72 offen offset:2048 sc1
  v_mfma_f32_16x16x32_bf16 v[4:7], a[64:67], a[4:7], v[4:7]
  v_add_f32 v244, v244, v248
  v_add_f32 v245, v245, v249
  v_mfma_f32_16x16x32_bf16 v[8:11], a[64:67], a[8:11], v[8:11]
  ds_read_b64_tr_b16 a[84:85], v225 offset:8192
  ds_write_b128 v250, v[242:245]
  v_mfma_f32_16x16x32_bf16 v[8:11], a[68:71], a[24:27], v[8:11]
  ds_read_b64_tr_b16 a[86:87], v225 offset:12288
  v_mfma_f32_16x16x32_bf16 v[12:15], a[68:71], a[28:31], v[12:15]
  buffer_load_dwordx4 a[48:51], v231, s[4:7], s72 offen offset:3072 sc1
  v_mfma_f32_16x16x32_bf16 v[12:15], a[64:67], a[12:15], v[12:15]
  s_add_u32 s72, s72, 4096
  s_waitcnt lgkmcnt(5)
  v_mfma_f32_16x16x32_bf16 v[28:31], a[72:75], a[12:15], v[28:31]
  ds_read_b64_tr_b16 a[88:89], v225 offset:16384
  v_mfma_f32_16x16x32_bf16 v[28:31], a[76:79], a[28:31], v[28:31]
  ds_read_b64_tr_b16 a[90:91], v225 offset:20480
  v_mfma_f32_16x16x32_bf16 v[24:27], a[76:79], a[24:27], v[24:27]
  buffer_load_dwordx4 a[36:39], v231, s[4:7], s73 offen offset:2048 sc1
  v_mfma_f32_16x16x32_bf16 v[24:27], a[72:75], a[8:11], v[24:27]
  ds_read_b128 v[246:249], v237 offset:384
  v_mfma_f32_16x16x32_bf16 v[20:23], a[72:75], a[4:7], v[20:23]
  ds_read_b64_tr_b16 a[92:93], v225 offset:24576
  v_mfma_f32_16x16x32_bf16 v[20:23], a[76:79], a[20:23], v[20:23]
  ds_read_b64_tr_b16 a[94:95], v225 offset:28672
  v_mfma_f32_16x16x32_bf16 v[16:19], a[76:79], a[16:19], v[16:19]
  buffer_load_dwordx4 a[52:55], v231, s[4:7], s73 offen offset:3072 sc1
  v_mfma_f32_16x16x32_bf16 v[16:19], a[72:75], a[0:3], v[16:19]
  s_add_u32 s73, s73, 4096
  s_waitcnt lgkmcnt(5)
  v_mfma_f32_16x16x32_bf16 v[32:35], a[80:83], a[0:3], v[32:35]
  s_waitcnt lgkmcnt(2)
  ds_read_b64_tr_b16 a[64:65], v226 offset:0
  v_fmac_f32 v96, v246, v238
  v_mfma_f32_16x16x32_bf16 v[32:35], a[84:87], a[16:19], v[32:35]
  ds_read_b64_tr_b16 a[66:67], v226 offset:4096
  v_fmac_f32 v97, v247, v238
  v_mfma_f32_16x16x32_bf16 v[36:39], a[84:87], a[20:23], v[36:39]
  v_fmac_f32 v98, v248, v238
  v_fmac_f32 v99, v249, v238
  v_mfma_f32_16x16x32_bf16 v[36:39], a[80:83], a[4:7], v[36:39]
  ds_read_b128 v[242:245], v237 offset:0
  v_fmac_f32 v100, v246, v239
  v_mfma_f32_16x16x32_bf16 v[40:43], a[80:83], a[8:11], v[40:43]
  s_xor_b32 s93, s53, 1
  ds_read_b64_tr_b16 a[68:69], v226 offset:8192
  v_fmac_f32 v101, v247, v239
  v_mfma_f32_16x16x32_bf16 v[40:43], a[84:87], a[24:27], v[40:43]
  s_lshl_b32 s93, s93, 7
  ds_read_b64_tr_b16 a[70:71], v226 offset:12288
  v_fmac_f32 v102, v248, v239
  v_mfma_f32_16x16x32_bf16 v[44:47], a[84:87], a[28:31], v[44:47]
  s_add_u32 s80, s24, s93
  s_addc_u32 s81, s25, 0
  buffer_load_dwordx4 a[40:43], v231, s[4:7], s74 offen offset:2048 sc1
  v_mfma_f32_16x16x32_bf16 v[44:47], a[80:83], a[12:15], v[44:47]
  s_sub_u32 s82, 7340032, s93
  v_fmac_f32 v103, v249, v239
  v_fmac_f32 v104, v246, v240
  s_waitcnt lgkmcnt(5)
  v_mfma_f32_16x16x32_bf16 v[60:63], a[88:91], a[12:15], v[60:63]
  s_mov_b32 s83, 0x20000
  ds_read_b64_tr_b16 a[72:73], v226 offset:16384
  v_fmac_f32 v105, v247, v240
  v_mfma_f32_16x16x32_bf16 v[60:63], a[92:95], a[28:31], v[60:63]
  s_lshl_b32 s93, s53, 7
  ds_read_b64_tr_b16 a[74:75], v226 offset:20480
  v_fmac_f32 v106, v248, v240
  v_mfma_f32_16x16x32_bf16 v[56:59], a[92:95], a[24:27], v[56:59]
  s_add_u32 s84, s24, s93
  s_addc_u32 s85, s25, 0
  buffer_load_dwordx4 a[56:59], v231, s[4:7], s74 offen offset:3072 sc1
  v_mfma_f32_16x16x32_bf16 v[56:59], a[88:91], a[8:11], v[56:59]
  s_add_u32 s74, s74, 4096
  v_fmac_f32 v107, v249, v240
  v_fmac_f32 v108, v246, v241
  v_mfma_f32_16x16x32_bf16 v[52:55], a[88:91], a[4:7], v[52:55]
  s_sub_u32 s84, s84, 1024
  s_subb_u32 s85, s85, 0
  ds_read_b64_tr_b16 a[76:77], v226 offset:24576
  v_fmac_f32 v109, v247, v241
  v_mfma_f32_16x16x32_bf16 v[52:55], a[92:95], a[20:23], v[52:55]
  s_sub_u32 s86, 7341056, s93
  ds_read_b64_tr_b16 a[78:79], v226 offset:28672
  v_fmac_f32 v110, v248, v241
  v_mfma_f32_16x16x32_bf16 v[48:51], a[92:95], a[16:19], v[48:51]
  s_mov_b32 s87, 0x20000
  buffer_load_dwordx4 a[44:47], v231, s[4:7], s75 offen offset:2048 sc1
  v_mfma_f32_16x16x32_bf16 v[48:51], a[88:91], a[0:3], v[48:51]
  s_and_b32 s93, s53, 1
  v_fmac_f32 v111, v249, v241
  s_waitcnt lgkmcnt(4)
  v_mfma_f32_16x16x32_bf16 v[64:67], a[64:67], a[0:3], v[64:67]
  ds_read_b64_tr_b16 a[80:81], v227 offset:0
  v_fmac_f32 v0, v242, v238
  v_mfma_f32_16x16x32_bf16 v[64:67], a[68:71], a[16:19], v[64:67]
  s_mul_i32 s92, s93, 3670016
  ds_read_b64_tr_b16 a[82:83], v227 offset:4096
  v_fmac_f32 v1, v243, v238
  v_mfma_f32_16x16x32_bf16 v[68:71], a[68:71], a[20:23], v[68:71]
  s_lshl_b32 s93, s40, 14
  buffer_load_dwordx4 a[60:63], v231, s[4:7], s75 offen offset:3072 sc1
  v_mfma_f32_16x16x32_bf16 v[68:71], a[64:67], a[4:7], v[68:71]
  s_add_u32 s75, s75, 4096
  ds_read_b128 v[246:249], v237 offset:64
  v_fmac_f32 v2, v244, v238
  v_mfma_f32_16x16x32_bf16 v[72:75], a[64:67], a[8:11], v[72:75]
  s_add_u32 s92, s92, s93
  ds_read_b64_tr_b16 a[84:85], v227 offset:8192
  v_fmac_f32 v3, v245, v238
  v_mfma_f32_16x16x32_bf16 v[72:75], a[68:71], a[24:27], v[72:75]
  s_lshl_b32 s79, s40, 11
  ds_read_b64_tr_b16 a[86:87], v227 offset:12288
  v_fmac_f32 v4, v242, v239
  v_mfma_f32_16x16x32_bf16 v[76:79], a[68:71], a[28:31], v[76:79]
  s_lshr_b32 s93, s53, 1
  v_fmac_f32 v5, v243, v239
  v_fmac_f32 v6, v244, v239
  v_mfma_f32_16x16x32_bf16 v[76:79], a[64:67], a[12:15], v[76:79]
  s_add_u32 s93, s93, s52
  v_fmac_f32 v7, v245, v239
  v_fmac_f32 v8, v242, v240
  s_waitcnt lgkmcnt(5)
  v_mfma_f32_16x16x32_bf16 v[92:95], a[72:75], a[12:15], v[92:95]
  s_and_b32 s93, s93, 3
  ds_read_b64_tr_b16 a[88:89], v227 offset:16384
  v_fmac_f32 v9, v243, v240
  v_mfma_f32_16x16x32_bf16 v[92:95], a[76:79], a[28:31], v[92:95]
  s_add_u32 m0, s68, 0
  ds_read_b64_tr_b16 a[90:91], v227 offset:20480
  v_fmac_f32 v10, v244, v240
  v_mfma_f32_16x16x32_bf16 v[88:91], a[76:79], a[24:27], v[88:91]
  s_cmp_eq_u32 s93, 0
  s_cselect_b32 s88, 917504, 0
  buffer_load_dwordx4 v232, s[16:19], s67 offen offset:0  lds
  v_mfma_f32_16x16x32_bf16 v[88:91], a[72:75], a[8:11], v[88:91]
  s_cmp_eq_u32 s93, 1
  s_cselect_b32 s89, 917504, 0
  v_fmac_f32 v11, v245, v240
  v_fmac_f32 v12, v242, v241
  v_mfma_f32_16x16x32_bf16 v[84:87], a[72:75], a[4:7], v[84:87]
  s_cmp_eq_u32 s93, 2
  s_cselect_b32 s90, 917504, 0
  ds_read_b64_tr_b16 a[92:93], v227 offset:24576
  v_fmac_f32 v13, v243, v241
  v_mfma_f32_16x16x32_bf16 v[84:87], a[76:79], a[20:23], v[84:87]
  s_cmp_eq_u32 s93, 3
  s_cselect_b32 s91, 917504, 0
  ds_read_b64_tr_b16 a[94:95], v227 offset:28672
  v_fmac_f32 v14, v244, v241
  v_mfma_f32_16x16x32_bf16 v[80:83], a[76:79], a[16:19], v[80:83]
  s_cmp_eq_u32 s40, 1
  s_cselect_b32 s78, 16384, 0
  buffer_load_dwordx4 v233, s[16:19], s67 offen offset:1024  lds
  v_mfma_f32_16x16x32_bf16 v[80:83], a[72:75], a[0:3], v[80:83]
  s_cmp_eq_u32 s40, 2
  s_cselect_b32 s78, -16384, s78
  v_fmac_f32 v15, v245, v241
  s_waitcnt lgkmcnt(4)
  v_mfma_f32_16x16x32_bf16 v[96:99], a[80:83], a[0:3], v[96:99]
  ds_read_b64_tr_b16 a[64:65], v228 offset:0
  v_fmac_f32 v16, v246, v238
  v_mfma_f32_16x16x32_bf16 v[96:99], a[84:87], a[16:19], v[96:99]
  s_mul_i32 s43, s69, 458752
  ds_read_b64_tr_b16 a[66:67], v228 offset:4096
  v_fmac_f32 v17, v247, v238
  v_mfma_f32_16x16x32_bf16 v[100:103], a[84:87], a[20:23], v[100:103]
  s_lshr_b32 s45, s55, 4
  buffer_load_dwordx4 v234, s[16:19], s67 offen offset:2048  lds
  v_mfma_f32_16x16x32_bf16 v[100:103], a[80:83], a[4:7], v[100:103]
  s_mul_i32 s45, s45, 57344
  ds_read_b128 v[242:245], v237 offset:128
  v_fmac_f32 v18, v248, v238
  v_mfma_f32_16x16x32_bf16 v[104:107], a[80:83], a[8:11], v[104:107]
  s_add_u32 s43, s43, s45
  ds_read_b64_tr_b16 a[68:69], v228 offset:8192
  v_fmac_f32 v19, v249, v238
  v_mfma_f32_16x16x32_bf16 v[104:107], a[84:87], a[24:27], v[104:107]
  s_add_u32 s43, s43, s42
  ds_read_b64_tr_b16 a[70:71], v228 offset:12288
  v_fmac_f32 v20, v246, v239
  v_mfma_f32_16x16x32_bf16 v[108:111], a[84:87], a[28:31], v[108:111]
  s_add_u32 s43, s43, 12582912
  buffer_load_dwordx4 v235, s[16:19], s67 offen offset:3072  lds
  v_mfma_f32_16x16x32_bf16 v[108:111], a[80:83], a[12:15], v[108:111]
  s_and_b32 s44, s55, 15
  v_fmac_f32 v21, v247, v239
  v_fmac_f32 v22, v248, v239
  s_waitcnt lgkmcnt(5)
  v_mfma_f32_16x16x32_bf16 v[124:127], a[88:91], a[12:15], v[124:127]
  s_lshl_b32 s45, s44, 10
  ds_read_b64_tr_b16 a[72:73], v228 offset:16384
  v_fmac_f32 v23, v249, v239
  v_mfma_f32_16x16x32_bf16 v[124:127], a[92:95], a[28:31], v[124:127]
  s_add_u32 s57, s43, s45
  ds_read_b64_tr_b16 a[74:75], v228 offset:20480
  v_fmac_f32 v24, v246, v240
  v_mfma_f32_16x16x32_bf16 v[120:123], a[92:95], a[24:27], v[120:123]
  s_lshl_b32 s45, s44, 9
  v_fmac_f32 v25, v247, v240
  v_fmac_f32 v26, v248, v240
  v_mfma_f32_16x16x32_bf16 v[120:123], a[88:91], a[8:11], v[120:123]
  s_add_u32 s61, s43, s45
  v_fmac_f32 v27, v249, v240
  v_fmac_f32 v28, v246, v241
  v_mfma_f32_16x16x32_bf16 v[116:119], a[88:91], a[4:7], v[116:119]
  s_add_u32 s61, s61, 49152
  ds_read_b64_tr_b16 a[76:77], v228 offset:24576
  v_fmac_f32 v29, v247, v241
  v_mfma_f32_16x16x32_bf16 v[116:119], a[92:95], a[20:23], v[116:119]
  s_add_u32 m0, s68, 16384
  ds_read_b64_tr_b16 a[78:79], v228 offset:28672
  v_fmac_f32 v30, v248, v241
  v_mfma_f32_16x16x32_bf16 v[112:115], a[92:95], a[16:19], v[112:115]
  s_add_u32 s62, s61, 229376
  buffer_load_dwordx4 v232, s[20:23], s67 offen offset:0  lds
  v_mfma_f32_16x16x32_bf16 v[112:115], a[88:91], a[0:3], v[112:115]
  s_add_u32 s58, s57, 114688
  v_fmac_f32 v31, v249, v241
  s_waitcnt lgkmcnt(4)
  v_mfma_f32_16x16x32_bf16 v[128:131], a[64:67], a[0:3], v[128:131]
  ds_read_b64_tr_b16 a[80:81], v229 offset:0
  v_fmac_f32 v32, v242, v238
  v_mfma_f32_16x16x32_bf16 v[128:131], a[68:71], a[16:19], v[128:131]
  s_add_u32 s59, s58, 114688
  ds_read_b64_tr_b16 a[82:83], v229 offset:4096
  v_fmac_f32 v33, v243, v238
  v_mfma_f32_16x16x32_bf16 v[132:135], a[68:71], a[20:23], v[132:135]
  s_add_u32 s60, s59, 114688
  buffer_load_dwordx4 v233, s[20:23], s67 offen offset:1024  lds
  v_mfma_f32_16x16x32_bf16 v[132:135], a[64:67], a[4:7], v[132:135]
  s_lshl_b32 s77, s54, 1
  ds_read_b128 v[246:249], v237 offset:192
  v_fmac_f32 v34, v244, v238
  v_mfma_f32_16x16x32_bf16 v[136:139], a[64:67], a[8:11], v[136:139]
  s_lshr_b32 s43, s55, 4
  ds_read_b64_tr_b16 a[84:85], v229 offset:8192
  v_fmac_f32 v35, v245, v238
  v_mfma_f32_16x16x32_bf16 v[136:139], a[68:71], a[24:27], v[136:139]
  s_add_u32 s77, s77, s43
  ds_read_b64_tr_b16 a[86:87], v229 offset:12288
  v_fmac_f32 v36, v242, v239
  v_mfma_f32_16x16x32_bf16 v[140:143], a[68:71], a[28:31], v[140:143]
  s_lshl_b32 s77, s77, 7
  buffer_load_dwordx4 v234, s[20:23], s67 offen offset:2048  lds
  v_mfma_f32_16x16x32_bf16 v[140:143], a[64:67], a[12:15], v[140:143]
  s_add_u32 s77, s77, s42
  v_fmac_f32 v37, v243, v239
  v_fmac_f32 v38, v244, v239
  s_waitcnt lgkmcnt(5)
  v_mfma_f32_16x16x32_bf16 v[156:159], a[72:75], a[12:15], v[156:159]
  s_add_u32 s77, s77, 27795456
  ds_read_b64_tr_b16 a[88:89], v229 offset:16384
  v_fmac_f32 v39, v245, v239
  v_mfma_f32_16x16x32_bf16 v[156:159], a[76:79], a[28:31], v[156:159]
  s_and_b32 s43, s53, 1
  ds_read_b64_tr_b16 a[90:91], v229 offset:20480
  v_fmac_f32 v40, v242, v240
  v_mfma_f32_16x16x32_bf16 v[152:155], a[76:79], a[24:27], v[152:155]
  s_and_b32 s64, s52, 14
  buffer_load_dwordx4 v235, s[20:23], s67 offen offset:3072  lds
  v_mfma_f32_16x16x32_bf16 v[152:155], a[72:75], a[8:11], v[152:155]
  s_add_u32 s67, s67, 458752
  v_fmac_f32 v41, v243, v240
  v_fmac_f32 v42, v244, v240
  v_mfma_f32_16x16x32_bf16 v[148:151], a[72:75], a[4:7], v[148:151]
  s_add_u32 s64, s64, s43
  ds_read_b64_tr_b16 a[92:93], v229 offset:24576
  v_fmac_f32 v43, v245, v240
  v_mfma_f32_16x16x32_bf16 v[148:151], a[76:79], a[20:23], v[148:151]
  s_lshl_b32 s64, s64, 7
  ds_read_b64_tr_b16 a[94:95], v229 offset:28672
  v_fmac_f32 v44, v242, v241
  v_mfma_f32_16x16x32_bf16 v[144:147], a[76:79], a[16:19], v[144:147]
  s_add_u32 s64, s64, s42
  v_fmac_f32 v45, v243, v241
  v_fmac_f32 v46, v244, v241
  v_mfma_f32_16x16x32_bf16 v[144:147], a[72:75], a[0:3], v[144:147]
  s_add_u32 s64, s64, 27795456
  v_fmac_f32 v47, v245, v241
  s_waitcnt lgkmcnt(4)
  v_mfma_f32_16x16x32_bf16 v[160:163], a[80:83], a[0:3], v[160:163]
  ds_read_b64_tr_b16 a[64:65], v230 offset:0
  v_fmac_f32 v48, v246, v238
  v_mfma_f32_16x16x32_bf16 v[160:163], a[84:87], a[16:19], v[160:163]
  s_lshl_b32 s49, s52, 3
  ds_read_b64_tr_b16 a[66:67], v230 offset:4096
  v_fmac_f32 v49, v247, v238
  v_mfma_f32_16x16x32_bf16 v[164:167], a[84:87], a[20:23], v[164:167]
  s_lshl_b32 s43, s40, 1
  buffer_load_dwordx4 a[96:99], v231, s[4:7], s72 offen offset:0 sc1
  v_mfma_f32_16x16x32_bf16 v[164:167], a[80:83], a[4:7], v[164:167]
  s_add_u32 s49, s49, s43
  ds_read_b128 v[242:245], v237 offset:256
  v_fmac_f32 v50, v248, v238
  v_mfma_f32_16x16x32_bf16 v[168:171], a[80:83], a[8:11], v[168:171]
  s_lshl_b32 s76, s49, 15
  ds_read_b64_tr_b16 a[68:69], v230 offset:8192
  v_fmac_f32 v51, v249, v238
  v_mfma_f32_16x16x32_bf16 v[168:171], a[84:87], a[24:27], v[168:171]
  s_lshl_b32 s43, s53, 11
  ds_read_b64_tr_b16 a[70:71], v230 offset:12288
  v_fmac_f32 v52, v246, v239
  v_mfma_f32_16x16x32_bf16 v[172:175], a[84:87], a[28:31], v[172:175]
  s_add_u32 s76, s76, s43
  buffer_load_dwordx4 a[112:115], v231, s[4:7], s72 offen offset:1024 sc1
  v_mfma_f32_16x16x32_bf16 v[172:175], a[80:83], a[12:15], v[172:175]
  s_add_u32 s76, s76, s42
  v_fmac_f32 v53, v247, v239
  v_fmac_f32 v54, v248, v239
  s_waitcnt lgkmcnt(5)
  v_mfma_f32_16x16x32_bf16 v[188:191], a[88:91], a[12:15], v[188:191]
  s_add_u32 s46, s76, 4194304
  ds_read_b64_tr_b16 a[72:73], v230 offset:16384
  v_fmac_f32 v55, v249, v239
  v_mfma_f32_16x16x32_bf16 v[188:191], a[92:95], a[28:31], v[188:191]
  s_add_u32 s47, s46, 32768
  ds_read_b64_tr_b16 a[74:75], v230 offset:20480
  v_fmac_f32 v56, v246, v240
  v_mfma_f32_16x16x32_bf16 v[184:187], a[92:95], a[24:27], v[184:187]
  s_mul_i32 s48, s49, 114688
  buffer_load_dwordx4 a[100:103], v231, s[4:7], s73 offen offset:0 sc1
  v_mfma_f32_16x16x32_bf16 v[184:187], a[88:91], a[8:11], v[184:187]
  s_and_b32 s43, s53, 1
  v_fmac_f32 v57, v247, v240
  v_fmac_f32 v58, v248, v240
  v_mfma_f32_16x16x32_bf16 v[180:183], a[88:91], a[4:7], v[180:183]
  s_mul_i32 s44, s43, 57344
  ds_read_b64_tr_b16 a[76:77], v230 offset:24576
  v_fmac_f32 v59, v249, v240
  v_mfma_f32_16x16x32_bf16 v[180:183], a[92:95], a[20:23], v[180:183]
  s_add_u32 s48, s48, s44
  ds_read_b64_tr_b16 a[78:79], v230 offset:28672
  v_fmac_f32 v60, v246, v241
  v_mfma_f32_16x16x32_bf16 v[176:179], a[92:95], a[16:19], v[176:179]
  s_add_u32 s48, s48, s42
  buffer_load_dwordx4 a[116:119], v231, s[4:7], s73 offen offset:1024 sc1
  v_mfma_f32_16x16x32_bf16 v[176:179], a[88:91], a[0:3], v[176:179]
  s_add_u32 s48, s48, 12582912
  v_fmac_f32 v61, v247, v241
  v_fmac_f32 v62, v248, v241
  v_fmac_f32 v63, v249, v241
  s_waitcnt lgkmcnt(4)
  v_mfma_f32_16x16x32_bf16 v[192:195], a[64:67], a[0:3], v[192:195]
  s_waitcnt vmcnt(20)
  s_barrier
  ds_read_b64_tr_b16 a[80:81], v224 offset:32768
  v_mfma_f32_16x16x32_bf16 v[192:195], a[68:71], a[16:19], v[192:195]
  ds_read_b64_tr_b16 a[82:83], v224 offset:36864
  v_fmac_f32 v64, v242, v238
  v_mfma_f32_16x16x32_bf16 v[196:199], a[68:71], a[20:23], v[196:199]
  v_fmac_f32 v65, v243, v238
  v_fmac_f32 v66, v244, v238
  v_mfma_f32_16x16x32_bf16 v[196:199], a[64:67], a[4:7], v[196:199]
  ds_read_b128 v[246:249], v237 offset:320
  v_fmac_f32 v67, v245, v238
  v_mfma_f32_16x16x32_bf16 v[200:203], a[64:67], a[8:11], v[200:203]
  ds_read_b64_tr_b16 a[84:85], v224 offset:40960
  v_fmac_f32 v68, v242, v239
  v_mfma_f32_16x16x32_bf16 v[200:203], a[68:71], a[24:27], v[200:203]
  ds_read_b64_tr_b16 a[86:87], v224 offset:45056
  v_fmac_f32 v69, v243, v239
  v_mfma_f32_16x16x32_bf16 v[204:207], a[68:71], a[28:31], v[204:207]
  buffer_load_dwordx4 a[104:107], v231, s[4:7], s74 offen offset:0 sc1
  v_mfma_f32_16x16x32_bf16 v[204:207], a[64:67], a[12:15], v[204:207]
  s_waitcnt lgkmcnt(5)
  v_fmac_f32 v70, v244, v239
  v_fmac_f32 v71, v245, v239
  v_mfma_f32_16x16x32_bf16 v[220:223], a[72:75], a[12:15], v[220:223]
  ds_read_b64_tr_b16 a[88:89], v224 offset:49152
  v_fmac_f32 v72, v242, v240
  v_mfma_f32_16x16x32_bf16 v[220:223], a[76:79], a[28:31], v[220:223]
  ds_read_b64_tr_b16 a[90:91], v224 offset:53248
  v_fmac_f32 v73, v243, v240
  v_mfma_f32_16x16x32_bf16 v[216:219], a[76:79], a[24:27], v[216:219]
  buffer_load_dwordx4 a[120:123], v231, s[4:7], s74 offen offset:1024 sc1
  v_mfma_f32_16x16x32_bf16 v[216:219], a[72:75], a[8:11], v[216:219]
  v_fmac_f32 v74, v244, v240
  v_fmac_f32 v75, v245, v240
  v_mfma_f32_16x16x32_bf16 v[212:215], a[72:75], a[4:7], v[212:215]
  ds_read_b64_tr_b16 a[92:93], v224 offset:57344
  v_fmac_f32 v76, v242, v241
  v_mfma_f32_16x16x32_bf16 v[212:215], a[76:79], a[20:23], v[212:215]
  ds_read_b64_tr_b16 a[94:95], v224 offset:61440
  v_xor_b32 v224, 0x10000, v224
  v_fmac_f32 v77, v243, v241
  v_mfma_f32_16x16x32_bf16 v[208:211], a[76:79], a[16:19], v[208:211]
  buffer_load_dwordx4 a[108:111], v231, s[4:7], s75 offen offset:0 sc1
  v_mfma_f32_16x16x32_bf16 v[208:211], a[72:75], a[0:3], v[208:211]
  s_waitcnt vmcnt(21) lgkmcnt(4)
  v_fmac_f32 v78, v244, v241
  v_fmac_f32 v79, v245, v241
  v_mfma_f32_16x16x32_bf16 v[0:3], a[80:83], a[32:35], v[0:3]
  ds_read_b64_tr_b16 a[64:65], v225 offset:32768
  v_fmac_f32 v80, v246, v238
  v_mfma_f32_16x16x32_bf16 v[0:3], a[84:87], a[48:51], v[0:3]
  s_waitcnt vmcnt(19)
  ds_read_b64_tr_b16 a[66:67], v225 offset:36864
  v_fmac_f32 v81, v247, v238
  v_mfma_f32_16x16x32_bf16 v[4:7], a[84:87], a[52:55], v[4:7]
  buffer_load_dwordx4 a[124:127], v231, s[4:7], s75 offen offset:1024 sc1
  v_mfma_f32_16x16x32_bf16 v[4:7], a[80:83], a[36:39], v[4:7]
  s_waitcnt vmcnt(18)
  ds_read_b128 v[242:245], v237 offset:448
  v_fmac_f32 v82, v248, v238
  v_mfma_f32_16x16x32_bf16 v[8:11], a[80:83], a[40:43], v[8:11]
  ds_read_b64_tr_b16 a[68:69], v225 offset:40960
  v_fmac_f32 v83, v249, v238
  v_mfma_f32_16x16x32_bf16 v[8:11], a[84:87], a[56:59], v[8:11]
  s_waitcnt vmcnt(16)
  ds_read_b64_tr_b16 a[70:71], v225 offset:45056
  v_fmac_f32 v84, v246, v239
  v_mfma_f32_16x16x32_bf16 v[12:15], a[84:87], a[60:63], v[12:15]
  v_fmac_f32 v85, v247, v239
  v_fmac_f32 v86, v248, v239
  v_mfma_f32_16x16x32_bf16 v[12:15], a[80:83], a[44:47], v[12:15]
  s_waitcnt lgkmcnt(5)
  v_fmac_f32 v87, v249, v239
  v_fmac_f32 v88, v246, v240
  v_mfma_f32_16x16x32_bf16 v[28:31], a[88:91], a[44:47], v[28:31]
  ds_read_b64_tr_b16 a[72:73], v225 offset:49152
  v_fmac_f32 v89, v247, v240
  v_mfma_f32_16x16x32_bf16 v[28:31], a[92:95], a[60:63], v[28:31]
  s_add_u32 m0, s68, 32768
  ds_read_b64_tr_b16 a[74:75], v225 offset:53248
  v_fmac_f32 v90, v248, v240
  v_mfma_f32_16x16x32_bf16 v[24:27], a[92:95], a[56:59], v[24:27]
  buffer_load_dwordx4 v232, s[16:19], s67 offen offset:0  lds
  v_mfma_f32_16x16x32_bf16 v[24:27], a[88:91], a[40:43], v[24:27]
  v_fmac_f32 v91, v249, v240
  v_fmac_f32 v92, v246, v241
  v_mfma_f32_16x16x32_bf16 v[20:23], a[88:91], a[36:39], v[20:23]
  ds_read_b64_tr_b16 a[76:77], v225 offset:57344
  v_fmac_f32 v93, v247, v241
  v_mfma_f32_16x16x32_bf16 v[20:23], a[92:95], a[52:55], v[20:23]
  ds_read_b64_tr_b16 a[78:79], v225 offset:61440
  v_xor_b32 v225, 0x10000, v225
  v_fmac_f32 v94, v248, v241
  v_mfma_f32_16x16x32_bf16 v[16:19], a[92:95], a[48:51], v[16:19]
  buffer_load_dwordx4 v233, s[16:19], s67 offen offset:1024  lds
  v_mfma_f32_16x16x32_bf16 v[16:19], a[88:91], a[32:35], v[16:19]
  v_fmac_f32 v95, v249, v241
  s_waitcnt lgkmcnt(4)
  v_mfma_f32_16x16x32_bf16 v[32:35], a[64:67], a[32:35], v[32:35]
  ds_read_b64_tr_b16 a[80:81], v226 offset:32768
  v_fmac_f32 v112, v242, v238
  v_mfma_f32_16x16x32_bf16 v[32:35], a[68:71], a[48:51], v[32:35]
  ds_read_b64_tr_b16 a[82:83], v226 offset:36864
  v_fmac_f32 v113, v243, v238
  v_mfma_f32_16x16x32_bf16 v[36:39], a[68:71], a[52:55], v[36:39]
  buffer_load_dwordx4 v234, s[16:19], s67 offen offset:2048  lds
  v_mfma_f32_16x16x32_bf16 v[36:39], a[64:67], a[36:39], v[36:39]
  ds_read_b128 v[246:249], v237 offset:512
  v_fmac_f32 v114, v244, v238
  v_mfma_f32_16x16x32_bf16 v[40:43], a[64:67], a[40:43], v[40:43]
  ds_read_b64_tr_b16 a[84:85], v226 offset:40960
  v_fmac_f32 v115, v245, v238
  v_mfma_f32_16x16x32_bf16 v[40:43], a[68:71], a[56:59], v[40:43]
  ds_read_b64_tr_b16 a[86:87], v226 offset:45056
  v_fmac_f32 v116, v242, v239
  v_mfma_f32_16x16x32_bf16 v[44:47], a[68:71], a[60:63], v[44:47]
  buffer_load_dwordx4 v235, s[16:19], s67 offen offset:3072  lds
  v_mfma_f32_16x16x32_bf16 v[44:47], a[64:67], a[44:47], v[44:47]
  s_waitcnt lgkmcnt(5)
  v_fmac_f32 v117, v243, v239
  v_fmac_f32 v118, v244, v239
  v_mfma_f32_16x16x32_bf16 v[60:63], a[72:75], a[44:47], v[60:63]
  ds_read_b64_tr_b16 a[88:89], v226 offset:49152
  v_fmac_f32 v119, v245, v239
  v_mfma_f32_16x16x32_bf16 v[60:63], a[76:79], a[60:63], v[60:63]
  ds_read_b64_tr_b16 a[90:91], v226 offset:53248
  v_fmac_f32 v120, v242, v240
  v_mfma_f32_16x16x32_bf16 v[56:59], a[76:79], a[56:59], v[56:59]
  v_fmac_f32 v121, v243, v240
  v_fmac_f32 v122, v244, v240
  v_mfma_f32_16x16x32_bf16 v[56:59], a[72:75], a[40:43], v[56:59]
  v_fmac_f32 v123, v245, v240
  v_fmac_f32 v124, v242, v241
  v_mfma_f32_16x16x32_bf16 v[52:55], a[72:75], a[36:39], v[52:55]
  ds_read_b64_tr_b16 a[92:93], v226 offset:57344
  v_fmac_f32 v125, v243, v241
  v_mfma_f32_16x16x32_bf16 v[52:55], a[76:79], a[52:55], v[52:55]
  s_add_u32 m0, s68, 49152
  ds_read_b64_tr_b16 a[94:95], v226 offset:61440
  v_xor_b32 v226, 0x10000, v226
  v_fmac_f32 v126, v244, v241
  v_mfma_f32_16x16x32_bf16 v[48:51], a[76:79], a[48:51], v[48:51]
  buffer_load_dwordx4 v232, s[20:23], s67 offen offset:0  lds
  v_mfma_f32_16x16x32_bf16 v[48:51], a[72:75], a[32:35], v[48:51]
  v_fmac_f32 v127, v245, v241
  s_waitcnt lgkmcnt(4)
  v_mfma_f32_16x16x32_bf16 v[64:67], a[80:83], a[32:35], v[64:67]
  ds_read_b64_tr_b16 a[64:65], v227 offset:32768
  v_fmac_f32 v128, v246, v238
  v_mfma_f32_16x16x32_bf16 v[64:67], a[84:87], a[48:51], v[64:67]
  ds_read_b64_tr_b16 a[66:67], v227 offset:36864
  v_fmac_f32 v129, v247, v238
  v_mfma_f32_16x16x32_bf16 v[68:71], a[84:87], a[52:55], v[68:71]
  buffer_load_dwordx4 v233, s[20:23], s67 offen offset:1024  lds
  v_mfma_f32_16x16x32_bf16 v[68:71], a[80:83], a[36:39], v[68:71]
  ds_read_b128 v[242:245], v237 offset:576
  v_fmac_f32 v130, v248, v238
  v_mfma_f32_16x16x32_bf16 v[72:75], a[80:83], a[40:43], v[72:75]
  ds_read_b64_tr_b16 a[68:69], v227 offset:40960
  v_fmac_f32 v131, v249, v238
  v_mfma_f32_16x16x32_bf16 v[72:75], a[84:87], a[56:59], v[72:75]
  ds_read_b64_tr_b16 a[70:71], v227 offset:45056
  v_fmac_f32 v132, v246, v239
  v_mfma_f32_16x16x32_bf16 v[76:79], a[84:87], a[60:63], v[76:79]
  buffer_load_dwordx4 v234, s[20:23], s67 offen offset:2048  lds
  v_mfma_f32_16x16x32_bf16 v[76:79], a[80:83], a[44:47], v[76:79]
  s_waitcnt lgkmcnt(5)
  v_fmac_f32 v133, v247, v239
  v_fmac_f32 v134, v248, v239
  v_mfma_f32_16x16x32_bf16 v[92:95], a[88:91], a[44:47], v[92:95]
  ds_read_b64_tr_b16 a[72:73], v227 offset:49152
  v_fmac_f32 v135, v249, v239
  v_mfma_f32_16x16x32_bf16 v[92:95], a[92:95], a[60:63], v[92:95]
  ds_read_b64_tr_b16 a[74:75], v227 offset:53248
  v_fmac_f32 v136, v246, v240
  v_mfma_f32_16x16x32_bf16 v[88:91], a[92:95], a[56:59], v[88:91]
  buffer_load_dwordx4 v235, s[20:23], s67 offen offset:3072  lds
  v_mfma_f32_16x16x32_bf16 v[88:91], a[88:91], a[40:43], v[88:91]
  s_add_u32 s67, s67, 458752
  s_xor_b32 s68, s68, 0x10000
  v_fmac_f32 v137, v247, v240
  v_mfma_f32_16x16x32_bf16 v[84:87], a[88:91], a[36:39], v[84:87]
  ds_read_b64_tr_b16 a[76:77], v227 offset:57344
  v_fmac_f32 v138, v248, v240
  v_mfma_f32_16x16x32_bf16 v[84:87], a[92:95], a[52:55], v[84:87]
  ds_read_b64_tr_b16 a[78:79], v227 offset:61440
  v_xor_b32 v227, 0x10000, v227
  v_fmac_f32 v139, v249, v240
  v_mfma_f32_16x16x32_bf16 v[80:83], a[92:95], a[48:51], v[80:83]
  v_fmac_f32 v140, v246, v241
  v_fmac_f32 v141, v247, v241
  v_mfma_f32_16x16x32_bf16 v[80:83], a[88:91], a[32:35], v[80:83]
  s_waitcnt lgkmcnt(4)
  v_fmac_f32 v142, v248, v241
  v_fmac_f32 v143, v249, v241
  v_mfma_f32_16x16x32_bf16 v[96:99], a[64:67], a[32:35], v[96:99]
  s_waitcnt vmcnt(16)
  s_barrier
  ds_read_b64_tr_b16 a[80:81], v224 offset:0
  v_mfma_f32_16x16x32_bf16 v[96:99], a[68:71], a[48:51], v[96:99]
  ds_read_b64_tr_b16 a[82:83], v224 offset:4096
  v_fmac_f32 v144, v242, v238
  v_mfma_f32_16x16x32_bf16 v[100:103], a[68:71], a[52:55], v[100:103]
  buffer_load_dwordx4 a[0:3], v231, s[4:7], s72 offen offset:2048 sc1
  v_mfma_f32_16x16x32_bf16 v[100:103], a[64:67], a[36:39], v[100:103]
  ds_read_b128 v[246:249], v237 offset:640
  v_fmac_f32 v145, v243, v238
  v_mfma_f32_16x16x32_bf16 v[104:107], a[64:67], a[40:43], v[104:107]
  ds_read_b64_tr_b16 a[84:85], v224 offset:8192
  v_fmac_f32 v146, v244, v238
  v_mfma_f32_16x16x32_bf16 v[104:107], a[68:71], a[56:59], v[104:107]
  ds_read_b64_tr_b16 a[86:87], v224 offset:12288
  v_fmac_f32 v147, v245, v238
  v_mfma_f32_16x16x32_bf16 v[108:111], a[68:71], a[60:63], v[108:111]
  buffer_load_dwordx4 a[16:19], v231, s[4:7], s72 offen offset:3072 sc1
  v_mfma_f32_16x16x32_bf16 v[108:111], a[64:67], a[44:47], v[108:111]
  s_add_u32 s72, s72, 4096
  v_fmac_f32 v148, v242, v239
  v_fmac_f32 v149, v243, v239
  s_waitcnt lgkmcnt(5)
  v_mfma_f32_16x16x32_bf16 v[124:127], a[72:75], a[44:47], v[124:127]
  ds_read_b64_tr_b16 a[88:89], v224 offset:16384
  v_fmac_f32 v150, v244, v239
  v_mfma_f32_16x16x32_bf16 v[124:127], a[76:79], a[60:63], v[124:127]
  ds_read_b64_tr_b16 a[90:91], v224 offset:20480
  v_fmac_f32 v151, v245, v239
  v_mfma_f32_16x16x32_bf16 v[120:123], a[76:79], a[56:59], v[120:123]
  buffer_load_dwordx4 a[4:7], v231, s[4:7], s73 offen offset:2048 sc1
  v_mfma_f32_16x16x32_bf16 v[120:123], a[72:75], a[40:43], v[120:123]
  v_fmac_f32 v152, v242, v240
  v_fmac_f32 v153, v243, v240
  v_mfma_f32_16x16x32_bf16 v[116:119], a[72:75], a[36:39], v[116:119]
  ds_read_b64_tr_b16 a[92:93], v224 offset:24576
  v_fmac_f32 v154, v244, v240
  v_mfma_f32_16x16x32_bf16 v[116:119], a[76:79], a[52:55], v[116:119]
  ds_read_b64_tr_b16 a[94:95], v224 offset:28672
  v_fmac_f32 v155, v245, v240
  v_mfma_f32_16x16x32_bf16 v[112:115], a[76:79], a[48:51], v[112:115]
  buffer_load_dwordx4 a[20:23], v231, s[4:7], s73 offen offset:3072 sc1
  v_mfma_f32_16x16x32_bf16 v[112:115], a[72:75], a[32:35], v[112:115]
  s_add_u32 s73, s73, 4096
  v_fmac_f32 v156, v242, v241
  v_fmac_f32 v157, v243, v241
  v_fmac_f32 v158, v244, v241
  v_fmac_f32 v159, v245, v241
  s_waitcnt vmcnt(18) lgkmcnt(4)
  v_mfma_f32_16x16x32_bf16 v[0:3], a[80:83], a[96:99], v[0:3]
  ds_read_b64_tr_b16 a[64:65], v225 offset:0
  v_fmac_f32 v160, v246, v238
  v_mfma_f32_16x16x32_bf16 v[0:3], a[84:87], a[112:115], v[0:3]
  s_waitcnt vmcnt(16)
  ds_read_b64_tr_b16 a[66:67], v225 offset:4096
  v_fmac_f32 v161, v247, v238
  v_mfma_f32_16x16x32_bf16 v[4:7], a[84:87], a[116:119], v[4:7]
  v_fmac_f32 v162, v248, v238
  v_fmac_f32 v163, v249, v238
  v_mfma_f32_16x16x32_bf16 v[4:7], a[80:83], a[100:103], v[4:7]
  s_waitcnt vmcnt(14)
  ds_read_b128 v[242:245], v237 offset:704
  v_fmac_f32 v164, v246, v239
  v_mfma_f32_16x16x32_bf16 v[8:11], a[80:83], a[104:107], v[8:11]
  ds_read_b64_tr_b16 a[68:69], v225 offset:8192
  v_fmac_f32 v165, v247, v239
  v_mfma_f32_16x16x32_bf16 v[8:11], a[84:87], a[120:123], v[8:11]
  s_waitcnt vmcnt(12)
  ds_read_b64_tr_b16 a[70:71], v225 offset:12288
  v_fmac_f32 v166, v248, v239
  v_mfma_f32_16x16x32_bf16 v[12:15], a[84:87], a[124:127], v[12:15]
  buffer_load_dwordx4 a[8:11], v231, s[4:7], s74 offen offset:2048 sc1
  v_mfma_f32_16x16x32_bf16 v[12:15], a[80:83], a[108:111], v[12:15]
  s_waitcnt lgkmcnt(5)
  v_fmac_f32 v167, v249, v239
  v_fmac_f32 v168, v246, v240
  v_mfma_f32_16x16x32_bf16 v[28:31], a[88:91], a[108:111], v[28:31]
  ds_read_b64_tr_b16 a[72:73], v225 offset:16384
  v_fmac_f32 v169, v247, v240
  v_mfma_f32_16x16x32_bf16 v[28:31], a[92:95], a[124:127], v[28:31]
  ds_read_b64_tr_b16 a[74:75], v225 offset:20480
  v_fmac_f32 v170, v248, v240
  v_mfma_f32_16x16x32_bf16 v[24:27], a[92:95], a[120:123], v[24:27]
  buffer_load_dwordx4 a[24:27], v231, s[4:7], s74 offen offset:3072 sc1
  v_mfma_f32_16x16x32_bf16 v[24:27], a[88:91], a[104:107], v[24:27]
  s_add_u32 s74, s74, 4096
  v_fmac_f32 v171, v249, v240
  v_fmac_f32 v172, v246, v241
  v_mfma_f32_16x16x32_bf16 v[20:23], a[88:91], a[100:103], v[20:23]
  ds_read_b64_tr_b16 a[76:77], v225 offset:24576
  v_fmac_f32 v173, v247, v241
  v_mfma_f32_16x16x32_bf16 v[20:23], a[92:95], a[116:119], v[20:23]
  ds_read_b64_tr_b16 a[78:79], v225 offset:28672
  v_fmac_f32 v174, v248, v241
  v_mfma_f32_16x16x32_bf16 v[16:19], a[92:95], a[112:115], v[16:19]
  buffer_load_dwordx4 a[12:15], v231, s[4:7], s75 offen offset:2048 sc1
  v_mfma_f32_16x16x32_bf16 v[16:19], a[88:91], a[96:99], v[16:19]
  v_fmac_f32 v175, v249, v241
  s_waitcnt lgkmcnt(4)
  v_mfma_f32_16x16x32_bf16 v[32:35], a[64:67], a[96:99], v[32:35]
  ds_read_b64_tr_b16 a[80:81], v226 offset:0
  v_fmac_f32 v176, v242, v238
  v_mfma_f32_16x16x32_bf16 v[32:35], a[68:71], a[112:115], v[32:35]
  ds_read_b64_tr_b16 a[82:83], v226 offset:4096
  v_fmac_f32 v177, v243, v238
  v_mfma_f32_16x16x32_bf16 v[36:39], a[68:71], a[116:119], v[36:39]
  buffer_load_dwordx4 a[28:31], v231, s[4:7], s75 offen offset:3072 sc1
  v_mfma_f32_16x16x32_bf16 v[36:39], a[64:67], a[100:103], v[36:39]
  s_add_u32 s75, s75, 4096
  ds_read_b128 v[246:249], v237 offset:768
  v_fmac_f32 v178, v244, v238
  v_mfma_f32_16x16x32_bf16 v[40:43], a[64:67], a[104:107], v[40:43]
  ds_read_b64_tr_b16 a[84:85], v226 offset:8192
  v_fmac_f32 v179, v245, v238
  v_mfma_f32_16x16x32_bf16 v[40:43], a[68:71], a[120:123], v[40:43]
  ds_read_b64_tr_b16 a[86:87], v226 offset:12288
  v_fmac_f32 v180, v242, v239
  v_mfma_f32_16x16x32_bf16 v[44:47], a[68:71], a[124:127], v[44:47]
  v_fmac_f32 v181, v243, v239
  v_fmac_f32 v182, v244, v239
  v_mfma_f32_16x16x32_bf16 v[44:47], a[64:67], a[108:111], v[44:47]
  s_waitcnt lgkmcnt(5)
  v_fmac_f32 v183, v245, v239
  v_fmac_f32 v184, v242, v240
  v_mfma_f32_16x16x32_bf16 v[60:63], a[72:75], a[108:111], v[60:63]
  ds_read_b64_tr_b16 a[88:89], v226 offset:16384
  v_fmac_f32 v185, v243, v240
  v_mfma_f32_16x16x32_bf16 v[60:63], a[76:79], a[124:127], v[60:63]
  ds_read_b64_tr_b16 a[90:91], v226 offset:20480
  v_fmac_f32 v186, v244, v240
  v_mfma_f32_16x16x32_bf16 v[56:59], a[76:79], a[120:123], v[56:59]
  v_fmac_f32 v187, v245, v240
  v_fmac_f32 v188, v242, v241
  v_mfma_f32_16x16x32_bf16 v[56:59], a[72:75], a[104:107], v[56:59]
  v_fmac_f32 v189, v243, v241
  v_fmac_f32 v190, v244, v241
  v_mfma_f32_16x16x32_bf16 v[52:55], a[72:75], a[100:103], v[52:55]
  s_add_u32 m0, s79, 0
  ds_read_b64_tr_b16 a[92:93], v226 offset:24576
  v_fmac_f32 v191, v245, v241
  v_mfma_f32_16x16x32_bf16 v[52:55], a[76:79], a[116:119], v[52:55]
  s_add_u32 s92, s92, 0
  s_add_u32 s93, s92, s88
  ds_read_b64_tr_b16 a[94:95], v226 offset:28672
  v_mfma_f32_16x16x32_bf16 v[48:51], a[76:79], a[112:115], v[48:51]
  buffer_load_dwordx4 v252, s[80:83], s93 offen lds
  v_mfma_f32_16x16x32_bf16 v[48:51], a[72:75], a[96:99], v[48:51]
  s_waitcnt lgkmcnt(4)
  v_mfma_f32_16x16x32_bf16 v[64:67], a[80:83], a[96:99], v[64:67]
  ds_read_b64_tr_b16 a[64:65], v228 offset:32768
  v_fmac_f32 v192, v246, v238
  v_mfma_f32_16x16x32_bf16 v[64:67], a[84:87], a[112:115], v[64:67]
  ds_read_b64_tr_b16 a[66:67], v228 offset:36864
  v_fmac_f32 v193, v247, v238
  v_mfma_f32_16x16x32_bf16 v[68:71], a[84:87], a[116:119], v[68:71]
  buffer_load_dwordx4 v252, s[84:87], s93 offen offset:1024 lds
  v_mfma_f32_16x16x32_bf16 v[68:71], a[80:83], a[100:103], v[68:71]
  ds_read_b128 v[242:245], v237 offset:832
  v_fmac_f32 v194, v248, v238
  v_mfma_f32_16x16x32_bf16 v[72:75], a[80:83], a[104:107], v[72:75]
  ds_read_b64_tr_b16 a[68:69], v228 offset:40960
  v_fmac_f32 v195, v249, v238
  v_mfma_f32_16x16x32_bf16 v[72:75], a[84:87], a[120:123], v[72:75]
  ds_read_b64_tr_b16 a[70:71], v228 offset:45056
  v_fmac_f32 v196, v246, v239
  v_mfma_f32_16x16x32_bf16 v[76:79], a[84:87], a[124:127], v[76:79]
  v_fmac_f32 v197, v247, v239
  v_fmac_f32 v198, v248, v239
  v_mfma_f32_16x16x32_bf16 v[76:79], a[80:83], a[108:111], v[76:79]
  s_waitcnt lgkmcnt(5)
  v_fmac_f32 v199, v249, v239
  v_fmac_f32 v200, v246, v240
  v_mfma_f32_16x16x32_bf16 v[92:95], a[88:91], a[108:111], v[92:95]
  s_add_u32 m0, s79, 8192
  ds_read_b64_tr_b16 a[72:73], v228 offset:49152
  v_fmac_f32 v201, v247, v240
  v_mfma_f32_16x16x32_bf16 v[92:95], a[92:95], a[124:127], v[92:95]
  s_add_u32 s92, s92, 262144
  s_add_u32 s93, s92, s89
  ds_read_b64_tr_b16 a[74:75], v228 offset:53248
  v_fmac_f32 v202, v248, v240
  v_mfma_f32_16x16x32_bf16 v[88:91], a[92:95], a[120:123], v[88:91]
  buffer_load_dwordx4 v252, s[80:83], s93 offen lds
  v_mfma_f32_16x16x32_bf16 v[88:91], a[88:91], a[104:107], v[88:91]
  v_fmac_f32 v203, v249, v240
  v_fmac_f32 v204, v246, v241
  v_mfma_f32_16x16x32_bf16 v[84:87], a[88:91], a[100:103], v[84:87]
  ds_read_b64_tr_b16 a[76:77], v228 offset:57344
  v_fmac_f32 v205, v247, v241
  v_mfma_f32_16x16x32_bf16 v[84:87], a[92:95], a[116:119], v[84:87]
  ds_read_b64_tr_b16 a[78:79], v228 offset:61440
  v_xor_b32 v228, 0x10000, v228
  v_fmac_f32 v206, v248, v241
  v_mfma_f32_16x16x32_bf16 v[80:83], a[92:95], a[112:115], v[80:83]
  buffer_load_dwordx4 v252, s[84:87], s93 offen offset:1024 lds
  v_mfma_f32_16x16x32_bf16 v[80:83], a[88:91], a[96:99], v[80:83]
  v_fmac_f32 v207, v249, v241
  s_waitcnt lgkmcnt(4)
  v_mfma_f32_16x16x32_bf16 v[128:131], a[64:67], a[32:35], v[128:131]
  s_waitcnt vmcnt(12)
  s_barrier
  ds_read_b64_tr_b16 a[80:81], v224 offset:32768
  v_mfma_f32_16x16x32_bf16 v[128:131], a[68:71], a[48:51], v[128:131]
  ds_read_b64_tr_b16 a[82:83], v224 offset:36864
  v_fmac_f32 v208, v242, v238
  v_mfma_f32_16x16x32_bf16 v[132:135], a[68:71], a[52:55], v[132:135]
  v_fmac_f32 v209, v243, v238
  v_fmac_f32 v210, v244, v238
  v_mfma_f32_16x16x32_bf16 v[132:135], a[64:67], a[36:39], v[132:135]
  v_fmac_f32 v211, v245, v238
  v_fmac_f32 v212, v242, v239
  v_mfma_f32_16x16x32_bf16 v[136:139], a[64:67], a[40:43], v[136:139]
  s_add_u32 m0, s79, 16384
  ds_read_b64_tr_b16 a[84:85], v224 offset:40960
  v_fmac_f32 v213, v243, v239
  v_mfma_f32_16x16x32_bf16 v[136:139], a[68:71], a[56:59], v[136:139]
  s_add_u32 s92, s92, 196608
  s_add_u32 s93, s92, s90
  ds_read_b64_tr_b16 a[86:87], v224 offset:45056
  v_fmac_f32 v214, v244, v239
  v_mfma_f32_16x16x32_bf16 v[140:143], a[68:71], a[60:63], v[140:143]
  buffer_load_dwordx4 v252, s[80:83], s93 offen lds
  v_mfma_f32_16x16x32_bf16 v[140:143], a[64:67], a[44:47], v[140:143]
  s_waitcnt lgkmcnt(4)
  v_fmac_f32 v215, v245, v239
  v_fmac_f32 v216, v242, v240
  v_mfma_f32_16x16x32_bf16 v[156:159], a[72:75], a[44:47], v[156:159]
  ds_read_b64_tr_b16 a[88:89], v224 offset:49152
  v_fmac_f32 v217, v243, v240
  v_mfma_f32_16x16x32_bf16 v[156:159], a[76:79], a[60:63], v[156:159]
  ds_read_b64_tr_b16 a[90:91], v224 offset:53248
  v_fmac_f32 v218, v244, v240
  v_mfma_f32_16x16x32_bf16 v[152:155], a[76:79], a[56:59], v[152:155]
  buffer_load_dwordx4 v252, s[84:87], s93 offen offset:1024 lds
  v_mfma_f32_16x16x32_bf16 v[152:155], a[72:75], a[40:43], v[152:155]
  v_fmac_f32 v219, v245, v240
  v_fmac_f32 v220, v242, v241
  v_mfma_f32_16x16x32_bf16 v[148:151], a[72:75], a[36:39], v[148:151]
  ds_read_b64_tr_b16 a[92:93], v224 offset:57344
  v_fmac_f32 v221, v243, v241
  v_mfma_f32_16x16x32_bf16 v[148:151], a[76:79], a[52:55], v[148:151]
  ds_read_b64_tr_b16 a[94:95], v224 offset:61440
  v_fmac_f32 v222, v244, v241
  v_mfma_f32_16x16x32_bf16 v[144:147], a[76:79], a[48:51], v[144:147]
  v_fmac_f32 v223, v245, v241
  v_mfma_f32_16x16x32_bf16 v[144:147], a[72:75], a[32:35], v[144:147]
  s_waitcnt vmcnt(12) lgkmcnt(4)
  v_mfma_f32_16x16x32_bf16 v[0:3], a[80:83], a[0:3], v[0:3]
  s_add_u32 m0, s79, 24576
  ds_read_b64_tr_b16 a[64:65], v229 offset:32768
  v_and_b32 v236, 31, v253
  v_mfma_f32_16x16x32_bf16 v[0:3], a[84:87], a[16:19], v[0:3]
  s_add_u32 s92, s92, 262144
  s_add_u32 s93, s92, s91
  ds_read_b64_tr_b16 a[66:67], v229 offset:36864
  v_lshlrev_b32 v236, 4, v236
  s_waitcnt vmcnt(10)
  v_mfma_f32_16x16x32_bf16 v[4:7], a[84:87], a[20:23], v[4:7]
  buffer_load_dwordx4 v252, s[80:83], s93 offen lds
  v_mfma_f32_16x16x32_bf16 v[4:7], a[80:83], a[4:7], v[4:7]
  v_lshrrev_b32 v250, 5, v253
  s_waitcnt vmcnt(9)
  v_mfma_f32_16x16x32_bf16 v[8:11], a[80:83], a[8:11], v[8:11]
  s_mov_b32 s43, 114688
  ds_read_b64_tr_b16 a[68:69], v229 offset:40960
  v_mad_u32_u24 v236, v250, s43, v236
  v_mfma_f32_16x16x32_bf16 v[8:11], a[84:87], a[24:27], v[8:11]
  s_waitcnt vmcnt(7)
  ds_read_b64_tr_b16 a[70:71], v229 offset:45056
  v_and_b32 v250, 15, v253
  v_mfma_f32_16x16x32_bf16 v[12:15], a[84:87], a[28:31], v[12:15]
  s_add_u32 s43, s71, 1024
  buffer_load_dwordx4 v252, s[84:87], s93 offen offset:1024 lds
  v_mfma_f32_16x16x32_bf16 v[12:15], a[80:83], a[12:15], v[12:15]
  s_waitcnt lgkmcnt(4)
  v_lshl_add_u32 v250, v250, 2, s43
  v_mfma_f32_16x16x32_bf16 v[28:31], a[88:91], a[12:15], v[28:31]
  ds_read2_b32 v[238:239], v250 offset0:64 offset1:80
  ds_read_b64_tr_b16 a[72:73], v229 offset:49152
  v_mfma_f32_16x16x32_bf16 v[28:31], a[92:95], a[28:31], v[28:31]
  ds_read2_b32 v[240:241], v250 offset0:96 offset1:112
  ds_read_b64_tr_b16 a[74:75], v229 offset:53248
  v_mfma_f32_16x16x32_bf16 v[24:27], a[92:95], a[24:27], v[24:27]
  ds_read2_b32 v[232:233], v250 offset0:128 offset1:144
  v_mfma_f32_16x16x32_bf16 v[24:27], a[88:91], a[8:11], v[24:27]
  ds_read2_b32 v[234:235], v250 offset0:160 offset1:176
  v_mfma_f32_16x16x32_bf16 v[20:23], a[88:91], a[4:7], v[20:23]
  ds_read_b64_tr_b16 a[76:77], v229 offset:57344
  v_mfma_f32_16x16x32_bf16 v[20:23], a[92:95], a[20:23], v[20:23]
  ds_read_b64_tr_b16 a[78:79], v229 offset:61440
  v_xor_b32 v229, 0x10000, v229
  v_mfma_f32_16x16x32_bf16 v[16:19], a[92:95], a[16:19], v[16:19]
  v_mfma_f32_16x16x32_bf16 v[16:19], a[88:91], a[0:3], v[16:19]
  s_waitcnt lgkmcnt(8)
  v_mfma_f32_16x16x32_bf16 v[160:163], a[64:67], a[32:35], v[160:163]
  ds_read_b64_tr_b16 a[80:81], v225 offset:32768
  v_mfma_f32_16x16x32_bf16 v[160:163], a[68:71], a[48:51], v[160:163]
  ds_read_b64_tr_b16 a[82:83], v225 offset:36864
  v_mfma_f32_16x16x32_bf16 v[164:167], a[68:71], a[52:55], v[164:167]
  s_waitcnt lgkmcnt(4)
  v_mfma_f32_16x16x32_bf16 v[164:167], a[64:67], a[36:39], v[164:167]
  v_pk_mul_f32 v[242:243], v[0:1], v[238:239] op_sel:[0,0] op_sel_hi:[1,0]
  v_pk_mul_f32 v[244:245], v[2:3], v[238:239] op_sel:[0,0] op_sel_hi:[1,0]
  v_pk_mul_f32 v[0:1], v[0:1], v[16:17]
  v_pk_mul_f32 v[2:3], v[2:3], v[18:19]
  v_mfma_f32_16x16x32_bf16 v[168:171], a[64:67], a[40:43], v[168:171]
  ds_read_b64_tr_b16 a[84:85], v225 offset:40960
  v_mfma_f32_16x16x32_bf16 v[168:171], a[68:71], a[56:59], v[168:171]
  ds_read_b64_tr_b16 a[86:87], v225 offset:45056
  v_mfma_f32_16x16x32_bf16 v[172:175], a[68:71], a[60:63], v[172:175]
  v_mfma_f32_16x16x32_bf16 v[172:175], a[64:67], a[44:47], v[172:175]
  s_waitcnt lgkmcnt(4)
  v_mfma_f32_16x16x32_bf16 v[188:191], a[72:75], a[44:47], v[188:191]
  v_exp_f32 v242, v242
  v_mfma_f32_16x16x32_bf16 v[188:191], a[76:79], a[60:63], v[188:191]
  v_exp_f32 v243, v243
  v_mfma_f32_16x16x32_bf16 v[184:187], a[76:79], a[56:59], v[184:187]
  ds_read_b64_tr_b16 a[88:89], v225 offset:49152
  ds_read_b64_tr_b16 a[90:91], v225 offset:53248
  v_mfma_f32_16x16x32_bf16 v[184:187], a[72:75], a[40:43], v[184:187]
  v_exp_f32 v244, v244
  v_exp_f32 v245, v245
  s_nop 0
  v_pk_fma_f32 v[242:243], v[242:243], v[232:233], v[232:233] op_sel:[0,0,0] op_sel_hi:[1,0,0]
  v_pk_fma_f32 v[244:245], v[244:245], v[232:233], v[232:233] op_sel:[0,0,0] op_sel_hi:[1,0,0]
  v_pk_mul_f32 v[246:247], v[4:5], v[238:239] op_sel:[0,1] op_sel_hi:[1,1]
  v_pk_mul_f32 v[248:249], v[6:7], v[238:239] op_sel:[0,1] op_sel_hi:[1,1]
  v_pk_mul_f32 v[4:5], v[4:5], v[20:21]
  v_pk_mul_f32 v[6:7], v[6:7], v[22:23]
  v_rcp_f32 v242, v242
  v_mfma_f32_16x16x32_bf16 v[180:183], a[72:75], a[36:39], v[180:183]
  v_rcp_f32 v243, v243
  v_mfma_f32_16x16x32_bf16 v[180:183], a[76:79], a[52:55], v[180:183]
  v_rcp_f32 v244, v244
  v_mfma_f32_16x16x32_bf16 v[176:179], a[76:79], a[48:51], v[176:179]
  ds_read_b64_tr_b16 a[92:93], v225 offset:57344
  v_mfma_f32_16x16x32_bf16 v[176:179], a[72:75], a[32:35], v[176:179]
  ds_read_b64_tr_b16 a[94:95], v225 offset:61440
  s_waitcnt lgkmcnt(4)
  v_mfma_f32_16x16x32_bf16 v[32:35], a[80:83], a[0:3], v[32:35]
  v_exp_f32 v246, v246
  v_mfma_f32_16x16x32_bf16 v[32:35], a[84:87], a[16:19], v[32:35]
  v_exp_f32 v247, v247
  v_mfma_f32_16x16x32_bf16 v[36:39], a[84:87], a[20:23], v[36:39]
  ds_read_b64_tr_b16 a[64:65], v230 offset:32768
  ds_read_b64_tr_b16 a[66:67], v230 offset:36864
  v_mfma_f32_16x16x32_bf16 v[36:39], a[80:83], a[4:7], v[36:39]
  v_exp_f32 v248, v248
  v_exp_f32 v249, v249
  v_rcp_f32 v245, v245
  v_pk_fma_f32 v[246:247], v[246:247], v[232:233], v[232:233] op_sel:[0,1,1] op_sel_hi:[1,1,1]
  v_pk_fma_f32 v[248:249], v[248:249], v[232:233], v[232:233] op_sel:[0,1,1] op_sel_hi:[1,1,1]
  v_pk_mul_f32 v[0:1], v[0:1], v[242:243]
  v_pk_mul_f32 v[2:3], v[2:3], v[244:245]
  v_pk_mul_f32 v[242:243], v[8:9], v[240:241] op_sel:[0,0] op_sel_hi:[1,0]
  v_pk_mul_f32 v[244:245], v[10:11], v[240:241] op_sel:[0,0] op_sel_hi:[1,0]
  v_pk_mul_f32 v[8:9], v[8:9], v[24:25]
  v_pk_mul_f32 v[10:11], v[10:11], v[26:27]
  v_rcp_f32 v246, v246
  v_mfma_f32_16x16x32_bf16 v[40:43], a[80:83], a[8:11], v[40:43]
  v_rcp_f32 v247, v247
  v_mfma_f32_16x16x32_bf16 v[40:43], a[84:87], a[24:27], v[40:43]
  v_rcp_f32 v248, v248
  v_mfma_f32_16x16x32_bf16 v[44:47], a[84:87], a[28:31], v[44:47]
  ds_read_b64_tr_b16 a[68:69], v230 offset:40960
  v_cvt_pk_bf16_f32 v16, v0, v1
  v_mfma_f32_16x16x32_bf16 v[44:47], a[80:83], a[12:15], v[44:47]
  s_waitcnt lgkmcnt(3)
  ds_read_b64_tr_b16 a[70:71], v230 offset:45056
  v_cvt_pk_bf16_f32 v17, v2, v3
  v_mfma_f32_16x16x32_bf16 v[60:63], a[88:91], a[12:15], v[60:63]
  v_exp_f32 v242, v242
  v_mfma_f32_16x16x32_bf16 v[60:63], a[92:95], a[28:31], v[60:63]
  v_exp_f32 v243, v243
  v_mfma_f32_16x16x32_bf16 v[56:59], a[92:95], a[24:27], v[56:59]
  ds_read_b64_tr_b16 a[72:73], v230 offset:49152
  ds_read_b64_tr_b16 a[74:75], v230 offset:53248
  v_mfma_f32_16x16x32_bf16 v[56:59], a[88:91], a[8:11], v[56:59]
  v_exp_f32 v244, v244
  v_exp_f32 v245, v245
  v_rcp_f32 v249, v249
  v_pk_fma_f32 v[242:243], v[242:243], v[234:235], v[234:235] op_sel:[0,0,0] op_sel_hi:[1,0,0]
  v_pk_fma_f32 v[244:245], v[244:245], v[234:235], v[234:235] op_sel:[0,0,0] op_sel_hi:[1,0,0]
  v_pk_mul_f32 v[4:5], v[4:5], v[246:247]
  v_pk_mul_f32 v[6:7], v[6:7], v[248:249]
  v_pk_mul_f32 v[246:247], v[12:13], v[240:241] op_sel:[0,1] op_sel_hi:[1,1]
  v_pk_mul_f32 v[248:249], v[14:15], v[240:241] op_sel:[0,1] op_sel_hi:[1,1]
  v_pk_mul_f32 v[12:13], v[12:13], v[28:29]
  v_pk_mul_f32 v[14:15], v[14:15], v[30:31]
  v_rcp_f32 v242, v242
  v_mfma_f32_16x16x32_bf16 v[52:55], a[88:91], a[4:7], v[52:55]
  v_rcp_f32 v243, v243
  v_mfma_f32_16x16x32_bf16 v[52:55], a[92:95], a[20:23], v[52:55]
  v_rcp_f32 v244, v244
  v_mfma_f32_16x16x32_bf16 v[48:51], a[92:95], a[16:19], v[48:51]
  ds_read_b64_tr_b16 a[76:77], v230 offset:57344
  v_cvt_pk_bf16_f32 v20, v4, v5
  v_mfma_f32_16x16x32_bf16 v[48:51], a[88:91], a[0:3], v[48:51]
  s_waitcnt lgkmcnt(3)
  ds_read_b64_tr_b16 a[78:79], v230 offset:61440
  v_xor_b32 v230, 0x10000, v230
  v_cvt_pk_bf16_f32 v21, v6, v7
  v_mfma_f32_16x16x32_bf16 v[192:195], a[64:67], a[32:35], v[192:195]
  v_exp_f32 v246, v246
  v_mfma_f32_16x16x32_bf16 v[192:195], a[68:71], a[48:51], v[192:195]
  v_exp_f32 v247, v247
  v_mfma_f32_16x16x32_bf16 v[196:199], a[68:71], a[52:55], v[196:199]
  ds_read_b64_tr_b16 a[80:81], v226 offset:32768
  ds_read_b64_tr_b16 a[82:83], v226 offset:36864
  v_mfma_f32_16x16x32_bf16 v[196:199], a[64:67], a[36:39], v[196:199]
  v_exp_f32 v248, v248
  v_exp_f32 v249, v249
  v_rcp_f32 v245, v245
  v_pk_fma_f32 v[246:247], v[246:247], v[234:235], v[234:235] op_sel:[0,1,1] op_sel_hi:[1,1,1]
  v_pk_fma_f32 v[248:249], v[248:249], v[234:235], v[234:235] op_sel:[0,1,1] op_sel_hi:[1,1,1]
  v_pk_mul_f32 v[8:9], v[8:9], v[242:243]
  v_pk_mul_f32 v[10:11], v[10:11], v[244:245]
  v_pk_mul_f32 v[242:243], v[32:33], v[238:239] op_sel:[0,0] op_sel_hi:[1,0]
  v_pk_mul_f32 v[244:245], v[34:35], v[238:239] op_sel:[0,0] op_sel_hi:[1,0]
  v_pk_mul_f32 v[32:33], v[32:33], v[48:49]
  v_pk_mul_f32 v[34:35], v[34:35], v[50:51]
  v_rcp_f32 v246, v246
  v_mfma_f32_16x16x32_bf16 v[200:203], a[64:67], a[40:43], v[200:203]
  v_rcp_f32 v247, v247
  v_mfma_f32_16x16x32_bf16 v[200:203], a[68:71], a[56:59], v[200:203]
  v_rcp_f32 v248, v248
  v_mfma_f32_16x16x32_bf16 v[204:207], a[68:71], a[60:63], v[204:207]
  ds_read_b64_tr_b16 a[84:85], v226 offset:40960
  v_cvt_pk_bf16_f32 v24, v8, v9
  v_mfma_f32_16x16x32_bf16 v[204:207], a[64:67], a[44:47], v[204:207]
  s_waitcnt lgkmcnt(3)
  ds_read_b64_tr_b16 a[86:87], v226 offset:45056
  v_cvt_pk_bf16_f32 v25, v10, v11
  v_mfma_f32_16x16x32_bf16 v[220:223], a[72:75], a[44:47], v[220:223]
  v_exp_f32 v242, v242
  v_mfma_f32_16x16x32_bf16 v[220:223], a[76:79], a[60:63], v[220:223]
  v_exp_f32 v243, v243
  v_mfma_f32_16x16x32_bf16 v[216:219], a[76:79], a[56:59], v[216:219]
  ds_read_b64_tr_b16 a[88:89], v226 offset:49152
  ds_read_b64_tr_b16 a[90:91], v226 offset:53248
  v_mfma_f32_16x16x32_bf16 v[216:219], a[72:75], a[40:43], v[216:219]
  v_exp_f32 v244, v244
  v_exp_f32 v245, v245
  v_rcp_f32 v249, v249
  v_pk_fma_f32 v[242:243], v[242:243], v[232:233], v[232:233] op_sel:[0,0,0] op_sel_hi:[1,0,0]
  v_pk_fma_f32 v[244:245], v[244:245], v[232:233], v[232:233] op_sel:[0,0,0] op_sel_hi:[1,0,0]
  v_pk_mul_f32 v[12:13], v[12:13], v[246:247]
  v_pk_mul_f32 v[14:15], v[14:15], v[248:249]
  v_pk_mul_f32 v[246:247], v[36:37], v[238:239] op_sel:[0,1] op_sel_hi:[1,1]
  v_pk_mul_f32 v[248:249], v[38:39], v[238:239] op_sel:[0,1] op_sel_hi:[1,1]
  v_pk_mul_f32 v[36:37], v[36:37], v[52:53]
  v_pk_mul_f32 v[38:39], v[38:39], v[54:55]
  v_rcp_f32 v242, v242
  v_mfma_f32_16x16x32_bf16 v[212:215], a[72:75], a[36:39], v[212:215]
  v_rcp_f32 v243, v243
  v_mfma_f32_16x16x32_bf16 v[212:215], a[76:79], a[52:55], v[212:215]
  v_rcp_f32 v244, v244
  v_mfma_f32_16x16x32_bf16 v[208:211], a[76:79], a[48:51], v[208:211]
  ds_read_b64_tr_b16 a[92:93], v226 offset:57344
  v_cvt_pk_bf16_f32 v28, v12, v13
  v_mfma_f32_16x16x32_bf16 v[208:211], a[72:75], a[32:35], v[208:211]
  s_waitcnt lgkmcnt(3)
  ds_read_b64_tr_b16 a[94:95], v226 offset:61440
  v_cvt_pk_bf16_f32 v29, v14, v15
  v_mfma_f32_16x16x32_bf16 v[64:67], a[80:83], a[0:3], v[64:67]
  v_exp_f32 v246, v246
  v_mfma_f32_16x16x32_bf16 v[64:67], a[84:87], a[16:19], v[64:67]
  v_exp_f32 v247, v247
  v_mfma_f32_16x16x32_bf16 v[68:71], a[84:87], a[20:23], v[68:71]
  ds_read_b64_tr_b16 a[64:65], v227 offset:0
  ds_read_b64_tr_b16 a[66:67], v227 offset:4096
  v_mfma_f32_16x16x32_bf16 v[68:71], a[80:83], a[4:7], v[68:71]
  v_exp_f32 v248, v248
  v_exp_f32 v249, v249
  v_rcp_f32 v245, v245
  v_pk_fma_f32 v[246:247], v[246:247], v[232:233], v[232:233] op_sel:[0,1,1] op_sel_hi:[1,1,1]
  v_pk_fma_f32 v[248:249], v[248:249], v[232:233], v[232:233] op_sel:[0,1,1] op_sel_hi:[1,1,1]
  v_pk_mul_f32 v[32:33], v[32:33], v[242:243]
  v_pk_mul_f32 v[34:35], v[34:35], v[244:245]
  v_pk_mul_f32 v[242:243], v[40:41], v[240:241] op_sel:[0,0] op_sel_hi:[1,0]
  v_pk_mul_f32 v[244:245], v[42:43], v[240:241] op_sel:[0,0] op_sel_hi:[1,0]
  v_pk_mul_f32 v[40:41], v[40:41], v[56:57]
  v_pk_mul_f32 v[42:43], v[42:43], v[58:59]
  v_rcp_f32 v246, v246
  v_mfma_f32_16x16x32_bf16 v[72:75], a[80:83], a[8:11], v[72:75]
  v_rcp_f32 v247, v247
  v_mfma_f32_16x16x32_bf16 v[72:75], a[84:87], a[24:27], v[72:75]
  v_rcp_f32 v248, v248
  v_mfma_f32_16x16x32_bf16 v[76:79], a[84:87], a[28:31], v[76:79]
  ds_read_b64_tr_b16 a[68:69], v227 offset:8192
  v_cvt_pk_bf16_f32 v18, v32, v33
  v_mfma_f32_16x16x32_bf16 v[76:79], a[80:83], a[12:15], v[76:79]
  s_waitcnt lgkmcnt(3)
  ds_read_b64_tr_b16 a[70:71], v227 offset:12288
  v_cvt_pk_bf16_f32 v19, v34, v35
  v_mfma_f32_16x16x32_bf16 v[92:95], a[88:91], a[12:15], v[92:95]
  buffer_store_dwordx4 v[16:19], v231, s[4:7], s57 offen sc1
  s_add_u32 s57, s57, 16384
  v_exp_f32 v242, v242
  v_mfma_f32_16x16x32_bf16 v[92:95], a[92:95], a[28:31], v[92:95]
  v_exp_f32 v243, v243
  v_mfma_f32_16x16x32_bf16 v[88:91], a[92:95], a[24:27], v[88:91]
  ds_read_b64_tr_b16 a[72:73], v227 offset:16384
  ds_read_b64_tr_b16 a[74:75], v227 offset:20480
  v_mfma_f32_16x16x32_bf16 v[88:91], a[88:91], a[8:11], v[88:91]
  v_exp_f32 v244, v244
  v_exp_f32 v245, v245
  v_rcp_f32 v249, v249
  v_pk_fma_f32 v[242:243], v[242:243], v[234:235], v[234:235] op_sel:[0,0,0] op_sel_hi:[1,0,0]
  v_pk_fma_f32 v[244:245], v[244:245], v[234:235], v[234:235] op_sel:[0,0,0] op_sel_hi:[1,0,0]
  v_pk_mul_f32 v[36:37], v[36:37], v[246:247]
  v_pk_mul_f32 v[38:39], v[38:39], v[248:249]
  v_pk_mul_f32 v[246:247], v[44:45], v[240:241] op_sel:[0,1] op_sel_hi:[1,1]
  v_pk_mul_f32 v[248:249], v[46:47], v[240:241] op_sel:[0,1] op_sel_hi:[1,1]
  v_pk_mul_f32 v[44:45], v[44:45], v[60:61]
  v_pk_mul_f32 v[46:47], v[46:47], v[62:63]
  v_rcp_f32 v242, v242
  v_mfma_f32_16x16x32_bf16 v[84:87], a[88:91], a[4:7], v[84:87]
  v_rcp_f32 v243, v243
  v_mfma_f32_16x16x32_bf16 v[84:87], a[92:95], a[20:23], v[84:87]
  v_rcp_f32 v244, v244
  v_mfma_f32_16x16x32_bf16 v[80:83], a[92:95], a[16:19], v[80:83]
  ds_read_b64_tr_b16 a[76:77], v227 offset:24576
  v_cvt_pk_bf16_f32 v22, v36, v37
  v_mfma_f32_16x16x32_bf16 v[80:83], a[88:91], a[0:3], v[80:83]
  s_waitcnt lgkmcnt(3)
  ds_read_b64_tr_b16 a[78:79], v227 offset:28672
  v_cvt_pk_bf16_f32 v23, v38, v39
  v_mfma_f32_16x16x32_bf16 v[96:99], a[64:67], a[96:99], v[96:99]
  buffer_store_dwordx4 v[20:23], v231, s[4:7], s58 offen sc1
  s_add_u32 s58, s58, 16384
  v_exp_f32 v246, v246
  v_mfma_f32_16x16x32_bf16 v[96:99], a[68:71], a[112:115], v[96:99]
  v_exp_f32 v247, v247
  v_mfma_f32_16x16x32_bf16 v[100:103], a[68:71], a[116:119], v[100:103]
  ds_read_b64_tr_b16 a[80:81], v227 offset:32768
  ds_read_b64_tr_b16 a[82:83], v227 offset:36864
  v_mfma_f32_16x16x32_bf16 v[100:103], a[64:67], a[100:103], v[100:103]
  v_exp_f32 v248, v248
  v_exp_f32 v249, v249
  v_rcp_f32 v245, v245
  v_pk_fma_f32 v[246:247], v[246:247], v[234:235], v[234:235] op_sel:[0,1,1] op_sel_hi:[1,1,1]
  v_pk_fma_f32 v[248:249], v[248:249], v[234:235], v[234:235] op_sel:[0,1,1] op_sel_hi:[1,1,1]
  v_pk_mul_f32 v[40:41], v[40:41], v[242:243]
  v_pk_mul_f32 v[42:43], v[42:43], v[244:245]
  v_pk_mul_f32 v[242:243], v[64:65], v[238:239] op_sel:[0,0] op_sel_hi:[1,0]
  v_pk_mul_f32 v[244:245], v[66:67], v[238:239] op_sel:[0,0] op_sel_hi:[1,0]
  v_pk_mul_f32 v[64:65], v[64:65], v[80:81]
  v_pk_mul_f32 v[66:67], v[66:67], v[82:83]
  v_rcp_f32 v246, v246
  v_mfma_f32_16x16x32_bf16 v[104:107], a[64:67], a[104:107], v[104:107]
  v_rcp_f32 v247, v247
  v_mfma_f32_16x16x32_bf16 v[104:107], a[68:71], a[120:123], v[104:107]
  v_rcp_f32 v248, v248
  v_mfma_f32_16x16x32_bf16 v[108:111], a[68:71], a[124:127], v[108:111]
  ds_read_b64_tr_b16 a[84:85], v227 offset:40960
  v_cvt_pk_bf16_f32 v26, v40, v41
  v_mfma_f32_16x16x32_bf16 v[108:111], a[64:67], a[108:111], v[108:111]
  s_waitcnt lgkmcnt(3)
  ds_read_b64_tr_b16 a[86:87], v227 offset:45056
  v_cvt_pk_bf16_f32 v27, v42, v43
  v_mfma_f32_16x16x32_bf16 v[124:127], a[72:75], a[108:111], v[124:127]
  buffer_store_dwordx4 v[24:27], v231, s[4:7], s59 offen sc1
  s_add_u32 s59, s59, 16384
  v_exp_f32 v242, v242
  v_mfma_f32_16x16x32_bf16 v[124:127], a[76:79], a[124:127], v[124:127]
  v_exp_f32 v243, v243
  v_mfma_f32_16x16x32_bf16 v[120:123], a[76:79], a[120:123], v[120:123]
  ds_read_b64_tr_b16 a[88:89], v227 offset:49152
  ds_read_b64_tr_b16 a[90:91], v227 offset:53248
  v_mfma_f32_16x16x32_bf16 v[120:123], a[72:75], a[104:107], v[120:123]
  v_exp_f32 v244, v244
  v_exp_f32 v245, v245
  v_rcp_f32 v249, v249
  v_pk_fma_f32 v[242:243], v[242:243], v[232:233], v[232:233] op_sel:[0,0,0] op_sel_hi:[1,0,0]
  v_pk_fma_f32 v[244:245], v[244:245], v[232:233], v[232:233] op_sel:[0,0,0] op_sel_hi:[1,0,0]
  v_pk_mul_f32 v[44:45], v[44:45], v[246:247]
  v_pk_mul_f32 v[46:47], v[46:47], v[248:249]
  v_pk_mul_f32 v[246:247], v[68:69], v[238:239] op_sel:[0,1] op_sel_hi:[1,1]
  v_pk_mul_f32 v[248:249], v[70:71], v[238:239] op_sel:[0,1] op_sel_hi:[1,1]
  v_pk_mul_f32 v[68:69], v[68:69], v[84:85]
  v_pk_mul_f32 v[70:71], v[70:71], v[86:87]
  v_rcp_f32 v242, v242
  v_mfma_f32_16x16x32_bf16 v[116:119], a[72:75], a[100:103], v[116:119]
  v_rcp_f32 v243, v243
  v_mfma_f32_16x16x32_bf16 v[116:119], a[76:79], a[116:119], v[116:119]
  v_rcp_f32 v244, v244
  v_mfma_f32_16x16x32_bf16 v[112:115], a[76:79], a[112:115], v[112:115]
  ds_read_b64_tr_b16 a[92:93], v227 offset:57344
  v_cvt_pk_bf16_f32 v30, v44, v45
  v_mfma_f32_16x16x32_bf16 v[112:115], a[72:75], a[96:99], v[112:115]
  s_waitcnt lgkmcnt(3)
  ds_read_b64_tr_b16 a[94:95], v227 offset:61440
  v_cvt_pk_bf16_f32 v31, v46, v47
  v_mfma_f32_16x16x32_bf16 v[96:99], a[80:83], a[0:3], v[96:99]
  buffer_store_dwordx4 v[28:31], v231, s[4:7], s60 offen sc1
  s_add_u32 s60, s60, 16384
  v_exp_f32 v246, v246
  v_mfma_f32_16x16x32_bf16 v[96:99], a[84:87], a[16:19], v[96:99]
  v_exp_f32 v247, v247
  v_mfma_f32_16x16x32_bf16 v[100:103], a[84:87], a[20:23], v[100:103]
  ds_read_b64_tr_b16 a[64:65], v228 offset:0
  ds_read_b64_tr_b16 a[66:67], v228 offset:4096
  v_mfma_f32_16x16x32_bf16 v[100:103], a[80:83], a[4:7], v[100:103]
  v_exp_f32 v248, v248
  v_exp_f32 v249, v249
  v_rcp_f32 v245, v245
  v_pk_fma_f32 v[246:247], v[246:247], v[232:233], v[232:233] op_sel:[0,1,1] op_sel_hi:[1,1,1]
  v_pk_fma_f32 v[248:249], v[248:249], v[232:233], v[232:233] op_sel:[0,1,1] op_sel_hi:[1,1,1]
  v_pk_mul_f32 v[64:65], v[64:65], v[242:243]
  v_pk_mul_f32 v[66:67], v[66:67], v[244:245]
  v_pk_mul_f32 v[242:243], v[72:73], v[240:241] op_sel:[0,0] op_sel_hi:[1,0]
  v_pk_mul_f32 v[244:245], v[74:75], v[240:241] op_sel:[0,0] op_sel_hi:[1,0]
  v_pk_mul_f32 v[72:73], v[72:73], v[88:89]
  v_pk_mul_f32 v[74:75], v[74:75], v[90:91]
  v_rcp_f32 v246, v246
  v_mfma_f32_16x16x32_bf16 v[104:107], a[80:83], a[8:11], v[104:107]
  v_rcp_f32 v247, v247
  v_lshlrev_b32 v8, 4, v253
  v_mfma_f32_16x16x32_bf16 v[104:107], a[84:87], a[24:27], v[104:107]
  v_rcp_f32 v248, v248
  v_add_u32 v9, 114688, v8
  v_mfma_f32_16x16x32_bf16 v[108:111], a[84:87], a[28:31], v[108:111]
  ds_read_b64_tr_b16 a[68:69], v228 offset:8192
  v_cvt_pk_bf16_f32 v80, v64, v65
  v_mfma_f32_16x16x32_bf16 v[108:111], a[80:83], a[12:15], v[108:111]
  s_waitcnt lgkmcnt(3)
  ds_read_b64_tr_b16 a[70:71], v228 offset:12288
  v_cvt_pk_bf16_f32 v81, v66, v67
  v_mfma_f32_16x16x32_bf16 v[124:127], a[88:91], a[12:15], v[124:127]
  buffer_load_dwordx4 v[16:19], v8, s[4:7], s46 offen offset:0 sc1
  v_exp_f32 v242, v242
  v_mfma_f32_16x16x32_bf16 v[124:127], a[92:95], a[28:31], v[124:127]
  buffer_load_dwordx4 v[20:23], v8, s[4:7], s46 offen offset:1024 sc1
  v_exp_f32 v243, v243
  v_mfma_f32_16x16x32_bf16 v[120:123], a[92:95], a[24:27], v[120:123]
  ds_read_b64_tr_b16 a[72:73], v228 offset:16384
  ds_read_b64_tr_b16 a[74:75], v228 offset:20480
  v_mfma_f32_16x16x32_bf16 v[120:123], a[88:91], a[8:11], v[120:123]
  v_exp_f32 v244, v244
  v_exp_f32 v245, v245
  v_rcp_f32 v249, v249
  v_pk_fma_f32 v[242:243], v[242:243], v[234:235], v[234:235] op_sel:[0,0,0] op_sel_hi:[1,0,0]
  v_pk_fma_f32 v[244:245], v[244:245], v[234:235], v[234:235] op_sel:[0,0,0] op_sel_hi:[1,0,0]
  v_pk_mul_f32 v[68:69], v[68:69], v[246:247]
  v_pk_mul_f32 v[70:71], v[70:71], v[248:249]
  v_pk_mul_f32 v[246:247], v[76:77], v[240:241] op_sel:[0,1] op_sel_hi:[1,1]
  v_pk_mul_f32 v[248:249], v[78:79], v[240:241] op_sel:[0,1] op_sel_hi:[1,1]
  v_pk_mul_f32 v[76:77], v[76:77], v[92:93]
  v_pk_mul_f32 v[78:79], v[78:79], v[94:95]
  v_rcp_f32 v242, v242
  v_mfma_f32_16x16x32_bf16 v[116:119], a[88:91], a[4:7], v[116:119]
  buffer_load_dwordx4 v[24:27], v8, s[4:7], s47 offen offset:0 sc1
  v_rcp_f32 v243, v243
  v_mfma_f32_16x16x32_bf16 v[116:119], a[92:95], a[20:23], v[116:119]
  buffer_load_dwordx4 v[28:31], v8, s[4:7], s47 offen offset:1024 sc1
  v_rcp_f32 v244, v244
  v_mfma_f32_16x16x32_bf16 v[112:115], a[92:95], a[16:19], v[112:115]
  ds_read_b64_tr_b16 a[76:77], v228 offset:24576
  v_cvt_pk_bf16_f32 v84, v68, v69
  v_mfma_f32_16x16x32_bf16 v[112:115], a[88:91], a[0:3], v[112:115]
  s_waitcnt lgkmcnt(3)
  ds_read_b64_tr_b16 a[78:79], v228 offset:28672
  v_cvt_pk_bf16_f32 v85, v70, v71
  v_mfma_f32_16x16x32_bf16 v[128:131], a[64:67], a[96:99], v[128:131]
  v_exp_f32 v246, v246
  v_bfe_u32 v11, v253, 2, 3
  v_mfma_f32_16x16x32_bf16 v[128:131], a[68:71], a[112:115], v[128:131]
  v_exp_f32 v247, v247
  v_bfe_u32 v12, v253, 3, 2
  v_mfma_f32_16x16x32_bf16 v[132:135], a[68:71], a[116:119], v[132:135]
  ds_read_b64_tr_b16 a[80:81], v228 offset:32768
  ds_read_b64_tr_b16 a[82:83], v228 offset:36864
  v_mfma_f32_16x16x32_bf16 v[132:135], a[64:67], a[100:103], v[132:135]
  v_exp_f32 v248, v248
  v_exp_f32 v249, v249
  v_rcp_f32 v245, v245
  v_pk_fma_f32 v[246:247], v[246:247], v[234:235], v[234:235] op_sel:[0,1,1] op_sel_hi:[1,1,1]
  v_pk_fma_f32 v[248:249], v[248:249], v[234:235], v[234:235] op_sel:[0,1,1] op_sel_hi:[1,1,1]
  v_pk_mul_f32 v[72:73], v[72:73], v[242:243]
  v_pk_mul_f32 v[74:75], v[74:75], v[244:245]
  v_pk_mul_f32 v[242:243], v[96:97], v[238:239] op_sel:[0,0] op_sel_hi:[1,0]
  v_pk_mul_f32 v[244:245], v[98:99], v[238:239] op_sel:[0,0] op_sel_hi:[1,0]
  v_pk_mul_f32 v[96:97], v[96:97], v[112:113]
  v_pk_mul_f32 v[98:99], v[98:99], v[114:115]
  v_rcp_f32 v246, v246
  v_mfma_f32_16x16x32_bf16 v[136:139], a[64:67], a[104:107], v[136:139]
  v_rcp_f32 v247, v247
  v_and_b32 v13, 3, v253
  v_mfma_f32_16x16x32_bf16 v[136:139], a[68:71], a[120:123], v[136:139]
  v_rcp_f32 v248, v248
  v_lshlrev_b32 v13, 3, v13
  v_mfma_f32_16x16x32_bf16 v[140:143], a[68:71], a[124:127], v[140:143]
  ds_read_b64_tr_b16 a[84:85], v228 offset:40960
  v_cvt_pk_bf16_f32 v88, v72, v73
  v_mfma_f32_16x16x32_bf16 v[140:143], a[64:67], a[108:111], v[140:143]
  s_waitcnt lgkmcnt(3)
  ds_read_b64_tr_b16 a[86:87], v228 offset:45056
  v_cvt_pk_bf16_f32 v89, v74, v75
  v_mfma_f32_16x16x32_bf16 v[156:159], a[72:75], a[108:111], v[156:159]
  v_exp_f32 v242, v242
  v_lshl_add_u32 v13, v11, 7, v13
  v_mfma_f32_16x16x32_bf16 v[156:159], a[76:79], a[124:127], v[156:159]
  v_exp_f32 v243, v243
  v_lshrrev_b32 v11, 5, v253
  v_mfma_f32_16x16x32_bf16 v[152:155], a[76:79], a[120:123], v[152:155]
  ds_read_b64_tr_b16 a[88:89], v228 offset:49152
  ds_read_b64_tr_b16 a[90:91], v228 offset:53248
  v_mfma_f32_16x16x32_bf16 v[152:155], a[72:75], a[104:107], v[152:155]
  v_exp_f32 v244, v244
  v_exp_f32 v245, v245
  v_rcp_f32 v249, v249
  v_pk_fma_f32 v[242:243], v[242:243], v[232:233], v[232:233] op_sel:[0,0,0] op_sel_hi:[1,0,0]
  v_pk_fma_f32 v[244:245], v[244:245], v[232:233], v[232:233] op_sel:[0,0,0] op_sel_hi:[1,0,0]
  v_pk_mul_f32 v[76:77], v[76:77], v[246:247]
  v_pk_mul_f32 v[78:79], v[78:79], v[248:249]
  v_pk_mul_f32 v[246:247], v[100:101], v[238:239] op_sel:[0,1] op_sel_hi:[1,1]
  v_pk_mul_f32 v[248:249], v[102:103], v[238:239] op_sel:[0,1] op_sel_hi:[1,1]
  v_pk_mul_f32 v[100:101], v[100:101], v[116:117]
  v_pk_mul_f32 v[102:103], v[102:103], v[118:119]
  v_rcp_f32 v242, v242
  v_mfma_f32_16x16x32_bf16 v[148:151], a[72:75], a[100:103], v[148:151]
  s_waitcnt vmcnt(4)
  s_barrier
  s_cmp_lg_u32 s40, 0
  s_cbranch_scc1 Lsgf20
  v_mov_b32 v250, 1
  s_mov_b64 exec, 1
  buffer_atomic_add v250, v251, s[4:7], s77 offen sc1
  s_mov_b64 exec, -1
Lsgf20:
  s_add_u32 s77, s77, 4096
  v_rcp_f32 v243, v243
  v_lshl_add_u32 v13, v11, 11, v13
  v_mfma_f32_16x16x32_bf16 v[148:151], a[76:79], a[116:119], v[148:151]
  s_add_u32 m0, s79, 32768
  v_rcp_f32 v244, v244
  v_xor_b32 v11, 0, v12
  v_mfma_f32_16x16x32_bf16 v[144:147], a[76:79], a[112:115], v[144:147]
  s_add_u32 s92, s92, 196608
  s_add_u32 s93, s92, s88
  ds_read_b64_tr_b16 a[92:93], v228 offset:57344
  v_cvt_pk_bf16_f32 v92, v76, v77
  v_mfma_f32_16x16x32_bf16 v[144:147], a[72:75], a[96:99], v[144:147]
  s_waitcnt lgkmcnt(3)
  ds_read_b64_tr_b16 a[94:95], v228 offset:61440
  v_cvt_pk_bf16_f32 v93, v78, v79
  v_mfma_f32_16x16x32_bf16 v[128:131], a[80:83], a[0:3], v[128:131]
  buffer_load_dwordx4 v252, s[80:83], s93 offen lds
  v_exp_f32 v246, v246
  v_mfma_f32_16x16x32_bf16 v[128:131], a[84:87], a[16:19], v[128:131]
  buffer_load_dwordx4 v252, s[84:87], s93 offen offset:1024 lds
  v_exp_f32 v247, v247
  v_mfma_f32_16x16x32_bf16 v[132:135], a[84:87], a[20:23], v[132:135]
  ds_read_b64_tr_b16 a[64:65], v229 offset:0
  ds_read_b64_tr_b16 a[66:67], v229 offset:4096
  v_mfma_f32_16x16x32_bf16 v[132:135], a[80:83], a[4:7], v[132:135]
  v_exp_f32 v248, v248
  v_exp_f32 v249, v249
  v_rcp_f32 v245, v245
  v_pk_fma_f32 v[246:247], v[246:247], v[232:233], v[232:233] op_sel:[0,1,1] op_sel_hi:[1,1,1]
  v_pk_fma_f32 v[248:249], v[248:249], v[232:233], v[232:233] op_sel:[0,1,1] op_sel_hi:[1,1,1]
  v_pk_mul_f32 v[96:97], v[96:97], v[242:243]
  v_pk_mul_f32 v[98:99], v[98:99], v[244:245]
  v_pk_mul_f32 v[242:243], v[104:105], v[240:241] op_sel:[0,0] op_sel_hi:[1,0]
  v_pk_mul_f32 v[244:245], v[106:107], v[240:241] op_sel:[0,0] op_sel_hi:[1,0]
  v_pk_mul_f32 v[104:105], v[104:105], v[120:121]
  v_pk_mul_f32 v[106:107], v[106:107], v[122:123]
  v_rcp_f32 v246, v246
  v_mfma_f32_16x16x32_bf16 v[136:139], a[80:83], a[8:11], v[136:139]
  s_add_u32 m0, s79, 40960
  v_rcp_f32 v247, v247
  v_lshl_add_u32 v0, v11, 5, v13
  v_mfma_f32_16x16x32_bf16 v[136:139], a[84:87], a[24:27], v[136:139]
  s_add_u32 s92, s92, 262144
  s_add_u32 s93, s92, s89
  buffer_load_dwordx4 v252, s[80:83], s93 offen lds
  v_rcp_f32 v248, v248
  v_mfma_f32_16x16x32_bf16 v[140:143], a[84:87], a[28:31], v[140:143]
  ds_read_b64_tr_b16 a[68:69], v229 offset:8192
  v_cvt_pk_bf16_f32 v82, v96, v97
  v_mfma_f32_16x16x32_bf16 v[140:143], a[80:83], a[12:15], v[140:143]
  s_waitcnt lgkmcnt(3)
  ds_read_b64_tr_b16 a[70:71], v229 offset:12288
  v_cvt_pk_bf16_f32 v83, v98, v99
  v_mfma_f32_16x16x32_bf16 v[156:159], a[88:91], a[12:15], v[156:159]
  buffer_load_dwordx4 v252, s[84:87], s93 offen offset:1024 lds
  buffer_store_dwordx4 v[80:83], v231, s[4:7], s57 offen sc1
  s_add_u32 s57, s57, 16384
  v_exp_f32 v242, v242
  v_mfma_f32_16x16x32_bf16 v[156:159], a[92:95], a[28:31], v[156:159]
  v_exp_f32 v243, v243
  v_add_u32 v4, 0x10000, v0
  v_mfma_f32_16x16x32_bf16 v[152:155], a[92:95], a[24:27], v[152:155]
  ds_read_b64_tr_b16 a[72:73], v229 offset:16384
  ds_read_b64_tr_b16 a[74:75], v229 offset:20480
  v_mfma_f32_16x16x32_bf16 v[152:155], a[88:91], a[8:11], v[152:155]
  v_exp_f32 v244, v244
  v_exp_f32 v245, v245
  v_rcp_f32 v249, v249
  v_pk_fma_f32 v[242:243], v[242:243], v[234:235], v[234:235] op_sel:[0,0,0] op_sel_hi:[1,0,0]
  v_pk_fma_f32 v[244:245], v[244:245], v[234:235], v[234:235] op_sel:[0,0,0] op_sel_hi:[1,0,0]
  v_pk_mul_f32 v[100:101], v[100:101], v[246:247]
  v_pk_mul_f32 v[102:103], v[102:103], v[248:249]
  v_pk_mul_f32 v[246:247], v[108:109], v[240:241] op_sel:[0,1] op_sel_hi:[1,1]
  v_pk_mul_f32 v[248:249], v[110:111], v[240:241] op_sel:[0,1] op_sel_hi:[1,1]
  v_pk_mul_f32 v[108:109], v[108:109], v[124:125]
  v_pk_mul_f32 v[110:111], v[110:111], v[126:127]
  v_rcp_f32 v242, v242
  v_mfma_f32_16x16x32_bf16 v[148:151], a[88:91], a[4:7], v[148:151]
  s_add_u32 m0, s79, 49152
  v_rcp_f32 v243, v243
  v_xor_b32 v11, 1, v12
  v_mfma_f32_16x16x32_bf16 v[148:151], a[92:95], a[20:23], v[148:151]
  s_add_u32 s92, s92, 196608
  s_add_u32 s93, s92, s90
  buffer_load_dwordx4 v252, s[80:83], s93 offen lds
  v_rcp_f32 v244, v244
  v_mfma_f32_16x16x32_bf16 v[144:147], a[92:95], a[16:19], v[144:147]
  ds_read_b64_tr_b16 a[76:77], v229 offset:24576
  v_cvt_pk_bf16_f32 v86, v100, v101
  v_mfma_f32_16x16x32_bf16 v[144:147], a[88:91], a[0:3], v[144:147]
  s_waitcnt lgkmcnt(3)
  ds_read_b64_tr_b16 a[78:79], v229 offset:28672
  v_cvt_pk_bf16_f32 v87, v102, v103
  v_mfma_f32_16x16x32_bf16 v[160:163], a[64:67], a[96:99], v[160:163]
  buffer_load_dwordx4 v252, s[84:87], s93 offen offset:1024 lds
  buffer_store_dwordx4 v[84:87], v231, s[4:7], s58 offen sc1
  s_add_u32 s58, s58, 16384
  v_exp_f32 v246, v246
  v_mfma_f32_16x16x32_bf16 v[160:163], a[68:71], a[112:115], v[160:163]
  v_exp_f32 v247, v247
  v_lshl_add_u32 v1, v11, 5, v13
  v_mfma_f32_16x16x32_bf16 v[164:167], a[68:71], a[116:119], v[164:167]
  ds_read_b64_tr_b16 a[80:81], v229 offset:32768
  ds_read_b64_tr_b16 a[82:83], v229 offset:36864
  v_mfma_f32_16x16x32_bf16 v[164:167], a[64:67], a[100:103], v[164:167]
  v_exp_f32 v248, v248
  v_exp_f32 v249, v249
  v_rcp_f32 v245, v245
  v_pk_fma_f32 v[246:247], v[246:247], v[234:235], v[234:235] op_sel:[0,1,1] op_sel_hi:[1,1,1]
  v_pk_fma_f32 v[248:249], v[248:249], v[234:235], v[234:235] op_sel:[0,1,1] op_sel_hi:[1,1,1]
  v_pk_mul_f32 v[104:105], v[104:105], v[242:243]
  v_pk_mul_f32 v[106:107], v[106:107], v[244:245]
  v_pk_mul_f32 v[242:243], v[128:129], v[238:239] op_sel:[0,0] op_sel_hi:[1,0]
  v_pk_mul_f32 v[244:245], v[130:131], v[238:239] op_sel:[0,0] op_sel_hi:[1,0]
  v_pk_mul_f32 v[128:129], v[128:129], v[144:145]
  v_pk_mul_f32 v[130:131], v[130:131], v[146:147]
  v_rcp_f32 v246, v246
  v_mfma_f32_16x16x32_bf16 v[168:171], a[64:67], a[104:107], v[168:171]
  s_add_u32 m0, s79, 57344
  v_rcp_f32 v247, v247
  v_add_u32 v5, 0x10000, v1
  v_mfma_f32_16x16x32_bf16 v[168:171], a[68:71], a[120:123], v[168:171]
  s_add_u32 s92, s92, 262144
  s_add_u32 s93, s92, s91
  buffer_load_dwordx4 v252, s[80:83], s93 offen lds
  v_rcp_f32 v248, v248
  v_mfma_f32_16x16x32_bf16 v[172:175], a[68:71], a[124:127], v[172:175]
  ds_read_b64_tr_b16 a[84:85], v229 offset:40960
  v_cvt_pk_bf16_f32 v90, v104, v105
  v_mfma_f32_16x16x32_bf16 v[172:175], a[64:67], a[108:111], v[172:175]
  s_waitcnt lgkmcnt(3)
  ds_read_b64_tr_b16 a[86:87], v229 offset:45056
  v_cvt_pk_bf16_f32 v91, v106, v107
  v_mfma_f32_16x16x32_bf16 v[188:191], a[72:75], a[108:111], v[188:191]
  buffer_load_dwordx4 v252, s[84:87], s93 offen offset:1024 lds
  buffer_store_dwordx4 v[88:91], v231, s[4:7], s59 offen sc1
  s_add_u32 s59, s59, 16384
  v_exp_f32 v242, v242
  v_mfma_f32_16x16x32_bf16 v[188:191], a[76:79], a[124:127], v[188:191]
  v_exp_f32 v243, v243
  v_xor_b32 v11, 2, v12
  v_mfma_f32_16x16x32_bf16 v[184:187], a[76:79], a[120:123], v[184:187]
  ds_read_b64_tr_b16 a[88:89], v229 offset:49152
  ds_read_b64_tr_b16 a[90:91], v229 offset:53248
  v_mfma_f32_16x16x32_bf16 v[184:187], a[72:75], a[104:107], v[184:187]
  v_exp_f32 v244, v244
  v_exp_f32 v245, v245
  v_rcp_f32 v249, v249
  v_pk_fma_f32 v[242:243], v[242:243], v[232:233], v[232:233] op_sel:[0,0,0] op_sel_hi:[1,0,0]
  v_pk_fma_f32 v[244:245], v[244:245], v[232:233], v[232:233] op_sel:[0,0,0] op_sel_hi:[1,0,0]
  v_pk_mul_f32 v[108:109], v[108:109], v[246:247]
  v_pk_mul_f32 v[110:111], v[110:111], v[248:249]
  v_pk_mul_f32 v[246:247], v[132:133], v[238:239] op_sel:[0,1] op_sel_hi:[1,1]
  v_pk_mul_f32 v[248:249], v[134:135], v[238:239] op_sel:[0,1] op_sel_hi:[1,1]
  v_pk_mul_f32 v[132:133], v[132:133], v[148:149]
  v_pk_mul_f32 v[134:135], v[134:135], v[150:151]
  v_rcp_f32 v242, v242
  v_mfma_f32_16x16x32_bf16 v[180:183], a[72:75], a[100:103], v[180:183]
  v_rcp_f32 v243, v243
  v_lshl_add_u32 v2, v11, 5, v13
  v_mfma_f32_16x16x32_bf16 v[180:183], a[76:79], a[116:119], v[180:183]
  v_rcp_f32 v244, v244
  v_add_u32 v6, 0x10000, v2
  v_mfma_f32_16x16x32_bf16 v[176:179], a[76:79], a[112:115], v[176:179]
  ds_read_b64_tr_b16 a[92:93], v229 offset:57344
  v_cvt_pk_bf16_f32 v94, v108, v109
  v_mfma_f32_16x16x32_bf16 v[176:179], a[72:75], a[96:99], v[176:179]
  s_waitcnt lgkmcnt(3)
  ds_read_b64_tr_b16 a[94:95], v229 offset:61440
  v_cvt_pk_bf16_f32 v95, v110, v111
  v_mfma_f32_16x16x32_bf16 v[160:163], a[80:83], a[0:3], v[160:163]
  buffer_store_dwordx4 v[92:95], v231, s[4:7], s60 offen sc1
  s_add_u32 s60, s60, 16384
  v_exp_f32 v246, v246
  v_mfma_f32_16x16x32_bf16 v[160:163], a[84:87], a[16:19], v[160:163]
  v_exp_f32 v247, v247
  v_xor_b32 v11, 3, v12
  v_mfma_f32_16x16x32_bf16 v[164:167], a[84:87], a[20:23], v[164:167]
  ds_read_b64_tr_b16 a[64:65], v230 offset:0
  ds_read_b64_tr_b16 a[66:67], v230 offset:4096
  v_mfma_f32_16x16x32_bf16 v[164:167], a[80:83], a[4:7], v[164:167]
  v_exp_f32 v248, v248
  v_exp_f32 v249, v249
  v_rcp_f32 v245, v245
  v_pk_fma_f32 v[246:247], v[246:247], v[232:233], v[232:233] op_sel:[0,1,1] op_sel_hi:[1,1,1]
  v_pk_fma_f32 v[248:249], v[248:249], v[232:233], v[232:233] op_sel:[0,1,1] op_sel_hi:[1,1,1]
  v_pk_mul_f32 v[128:129], v[128:129], v[242:243]
  v_pk_mul_f32 v[130:131], v[130:131], v[244:245]
  v_pk_mul_f32 v[242:243], v[136:137], v[240:241] op_sel:[0,0] op_sel_hi:[1,0]
  v_pk_mul_f32 v[244:245], v[138:139], v[240:241] op_sel:[0,0] op_sel_hi:[1,0]
  v_pk_mul_f32 v[136:137], v[136:137], v[152:153]
  v_pk_mul_f32 v[138:139], v[138:139], v[154:155]
  v_rcp_f32 v246, v246
  v_mfma_f32_16x16x32_bf16 v[168:171], a[80:83], a[8:11], v[168:171]
  buffer_load_dword v10, v251, s[4:7], s64 offen sc1
  v_rcp_f32 v247, v247
  v_mfma_f32_16x16x32_bf16 v[168:171], a[84:87], a[24:27], v[168:171]
  v_rcp_f32 v248, v248
  v_lshl_add_u32 v3, v11, 5, v13
  v_mfma_f32_16x16x32_bf16 v[172:175], a[84:87], a[28:31], v[172:175]
  ds_read_b64_tr_b16 a[68:69], v230 offset:8192
  v_cvt_pk_bf16_f32 v144, v128, v129
  v_mfma_f32_16x16x32_bf16 v[172:175], a[80:83], a[12:15], v[172:175]
  s_waitcnt lgkmcnt(3)
  ds_read_b64_tr_b16 a[70:71], v230 offset:12288
  v_cvt_pk_bf16_f32 v145, v130, v131
  v_mfma_f32_16x16x32_bf16 v[188:191], a[88:91], a[12:15], v[188:191]
  v_exp_f32 v242, v242
  v_add_u32 v7, 0x10000, v3
  v_mfma_f32_16x16x32_bf16 v[188:191], a[92:95], a[28:31], v[188:191]
  v_exp_f32 v243, v243
  v_mfma_f32_16x16x32_bf16 v[184:187], a[92:95], a[24:27], v[184:187]
  ds_read_b64_tr_b16 a[72:73], v230 offset:16384
  ds_read_b64_tr_b16 a[74:75], v230 offset:20480
  v_mfma_f32_16x16x32_bf16 v[184:187], a[88:91], a[8:11], v[184:187]
  v_exp_f32 v244, v244
  v_exp_f32 v245, v245
  v_rcp_f32 v249, v249
  v_pk_fma_f32 v[242:243], v[242:243], v[234:235], v[234:235] op_sel:[0,0,0] op_sel_hi:[1,0,0]
  v_pk_fma_f32 v[244:245], v[244:245], v[234:235], v[234:235] op_sel:[0,0,0] op_sel_hi:[1,0,0]
  v_pk_mul_f32 v[132:133], v[132:133], v[246:247]
  v_pk_mul_f32 v[134:135], v[134:135], v[248:249]
  v_pk_mul_f32 v[246:247], v[140:141], v[240:241] op_sel:[0,1] op_sel_hi:[1,1]
  v_pk_mul_f32 v[248:249], v[142:143], v[240:241] op_sel:[0,1] op_sel_hi:[1,1]
  v_pk_mul_f32 v[140:141], v[140:141], v[156:157]
  v_pk_mul_f32 v[142:143], v[142:143], v[158:159]
  v_rcp_f32 v242, v242
  v_mfma_f32_16x16x32_bf16 v[180:183], a[88:91], a[4:7], v[180:183]
  v_rcp_f32 v243, v243
  v_mfma_f32_16x16x32_bf16 v[180:183], a[92:95], a[20:23], v[180:183]
  v_rcp_f32 v244, v244
  v_mfma_f32_16x16x32_bf16 v[176:179], a[92:95], a[16:19], v[176:179]
  ds_read_b64_tr_b16 a[76:77], v230 offset:24576
  v_cvt_pk_bf16_f32 v148, v132, v133
  v_mfma_f32_16x16x32_bf16 v[176:179], a[88:91], a[0:3], v[176:179]
  s_waitcnt lgkmcnt(3)
  ds_read_b64_tr_b16 a[78:79], v230 offset:28672
  v_cvt_pk_bf16_f32 v149, v134, v135
  v_mfma_f32_16x16x32_bf16 v[192:195], a[64:67], a[96:99], v[192:195]
  v_exp_f32 v246, v246
  v_mfma_f32_16x16x32_bf16 v[192:195], a[68:71], a[112:115], v[192:195]
  v_exp_f32 v247, v247
  v_mfma_f32_16x16x32_bf16 v[196:199], a[68:71], a[116:119], v[196:199]
  ds_read_b64_tr_b16 a[80:81], v230 offset:32768
  ds_read_b64_tr_b16 a[82:83], v230 offset:36864
  v_mfma_f32_16x16x32_bf16 v[196:199], a[64:67], a[100:103], v[196:199]
  v_exp_f32 v248, v248
  v_exp_f32 v249, v249
  v_rcp_f32 v245, v245
  v_pk_fma_f32 v[246:247], v[246:247], v[234:235], v[234:235] op_sel:[0,1,1] op_sel_hi:[1,1,1]
  v_pk_fma_f32 v[248:249], v[248:249], v[234:235], v[234:235] op_sel:[0,1,1] op_sel_hi:[1,1,1]
  v_pk_mul_f32 v[136:137], v[136:137], v[242:243]
  v_pk_mul_f32 v[138:139], v[138:139], v[244:245]
  v_pk_mul_f32 v[242:243], v[160:161], v[238:239] op_sel:[0,0] op_sel_hi:[1,0]
  v_pk_mul_f32 v[244:245], v[162:163], v[238:239] op_sel:[0,0] op_sel_hi:[1,0]
  v_pk_mul_f32 v[160:161], v[160:161], v[176:177]
  v_pk_mul_f32 v[162:163], v[162:163], v[178:179]
  v_rcp_f32 v246, v246
  v_mfma_f32_16x16x32_bf16 v[200:203], a[64:67], a[104:107], v[200:203]
  v_rcp_f32 v247, v247
  v_mfma_f32_16x16x32_bf16 v[200:203], a[68:71], a[120:123], v[200:203]
  v_rcp_f32 v248, v248
  v_mfma_f32_16x16x32_bf16 v[204:207], a[68:71], a[124:127], v[204:207]
  ds_read_b64_tr_b16 a[84:85], v230 offset:40960
  v_cvt_pk_bf16_f32 v152, v136, v137
  v_mfma_f32_16x16x32_bf16 v[204:207], a[64:67], a[108:111], v[204:207]
  s_waitcnt lgkmcnt(3)
  ds_read_b64_tr_b16 a[86:87], v230 offset:45056
  v_cvt_pk_bf16_f32 v153, v138, v139
  v_mfma_f32_16x16x32_bf16 v[220:223], a[72:75], a[108:111], v[220:223]
  v_exp_f32 v242, v242
  v_mfma_f32_16x16x32_bf16 v[220:223], a[76:79], a[124:127], v[220:223]
  v_exp_f32 v243, v243
  v_mfma_f32_16x16x32_bf16 v[216:219], a[76:79], a[120:123], v[216:219]
  ds_read_b64_tr_b16 a[88:89], v230 offset:49152
  ds_read_b64_tr_b16 a[90:91], v230 offset:53248
  v_mfma_f32_16x16x32_bf16 v[216:219], a[72:75], a[104:107], v[216:219]
  v_exp_f32 v244, v244
  v_exp_f32 v245, v245
  v_rcp_f32 v249, v249
  v_pk_fma_f32 v[242:243], v[242:243], v[232:233], v[232:233] op_sel:[0,0,0] op_sel_hi:[1,0,0]
  v_pk_fma_f32 v[244:245], v[244:245], v[232:233], v[232:233] op_sel:[0,0,0] op_sel_hi:[1,0,0]
  v_pk_mul_f32 v[140:141], v[140:141], v[246:247]
  v_pk_mul_f32 v[142:143], v[142:143], v[248:249]
  v_pk_mul_f32 v[246:247], v[164:165], v[238:239] op_sel:[0,1] op_sel_hi:[1,1]
  v_pk_mul_f32 v[248:249], v[166:167], v[238:239] op_sel:[0,1] op_sel_hi:[1,1]
  v_pk_mul_f32 v[164:165], v[164:165], v[180:181]
  v_pk_mul_f32 v[166:167], v[166:167], v[182:183]
  v_rcp_f32 v242, v242
  v_mfma_f32_16x16x32_bf16 v[212:215], a[72:75], a[100:103], v[212:215]
  s_waitcnt vmcnt(0)
  v_cmp_gt_u32 vcc, 16, v10
  s_cbranch_vccnz Lp4a_c
Lp4a_r:
  s_add_u32 s64, s64, 4096
  v_rcp_f32 v243, v243
  v_mfma_f32_16x16x32_bf16 v[212:215], a[76:79], a[116:119], v[212:215]
  s_min_u32 s63, s88, 4096
  s_add_u32 s63, s63, s48
  buffer_load_dwordx4 a[128:131], v8, s[4:7], s63 offen offset:0 sc1
  v_rcp_f32 v244, v244
  v_mfma_f32_16x16x32_bf16 v[208:211], a[76:79], a[112:115], v[208:211]
  ds_read_b64_tr_b16 a[92:93], v230 offset:57344
  v_cvt_pk_bf16_f32 v156, v140, v141
  v_mfma_f32_16x16x32_bf16 v[208:211], a[72:75], a[96:99], v[208:211]
  s_waitcnt lgkmcnt(3)
  ds_read_b64_tr_b16 a[94:95], v230 offset:61440
  v_cvt_pk_bf16_f32 v157, v142, v143
  v_mfma_f32_16x16x32_bf16 v[192:195], a[80:83], a[0:3], v[192:195]
  buffer_load_dwordx4 a[132:135], v9, s[4:7], s63 offen offset:0 sc1
  v_mfma_f32_16x16x32_bf16 v[192:195], a[84:87], a[16:19], v[192:195]
  s_min_u32 s63, s89, 4096
  s_add_u32 s63, s63, s48
  buffer_load_dwordx4 a[136:139], v8, s[4:7], s63 offen offset:1024 sc1
  v_exp_f32 v246, v246
  v_mfma_f32_16x16x32_bf16 v[196:199], a[84:87], a[20:23], v[196:199]
  v_exp_f32 v247, v247
  v_mfma_f32_16x16x32_bf16 v[196:199], a[80:83], a[4:7], v[196:199]
  buffer_load_dwordx4 a[140:143], v9, s[4:7], s63 offen offset:1024 sc1
  v_exp_f32 v248, v248
  v_exp_f32 v249, v249
  v_rcp_f32 v245, v245
  v_pk_fma_f32 v[246:247], v[246:247], v[232:233], v[232:233] op_sel:[0,1,1] op_sel_hi:[1,1,1]
  v_pk_fma_f32 v[248:249], v[248:249], v[232:233], v[232:233] op_sel:[0,1,1] op_sel_hi:[1,1,1]
  v_pk_mul_f32 v[160:161], v[160:161], v[242:243]
  v_pk_mul_f32 v[162:163], v[162:163], v[244:245]
  v_pk_mul_f32 v[242:243], v[168:169], v[240:241] op_sel:[0,0] op_sel_hi:[1,0]
  v_pk_mul_f32 v[244:245], v[170:171], v[240:241] op_sel:[0,0] op_sel_hi:[1,0]
  v_pk_mul_f32 v[168:169], v[168:169], v[184:185]
  v_pk_mul_f32 v[170:171], v[170:171], v[186:187]
  v_rcp_f32 v246, v246
  v_mfma_f32_16x16x32_bf16 v[200:203], a[80:83], a[8:11], v[200:203]
  s_barrier
  s_cmp_lg_u32 s40, 0
  s_cbranch_scc1 Lsgf21
  v_mov_b32 v250, 1
  s_mov_b64 exec, 1
  buffer_atomic_add v250, v251, s[4:7], s77 offen sc1
  s_mov_b64 exec, -1
Lsgf21:
  s_add_u32 s77, s77, 4096
  v_mfma_f32_16x16x32_bf16 v[200:203], a[84:87], a[24:27], v[200:203]
  s_min_u32 s63, s90, 4096
  s_add_u32 s63, s63, s48
  buffer_load_dwordx4 a[144:147], v8, s[4:7], s63 offen offset:2048 sc1
  v_rcp_f32 v247, v247
  v_mfma_f32_16x16x32_bf16 v[204:207], a[84:87], a[28:31], v[204:207]
  v_rcp_f32 v248, v248
  v_cvt_pk_bf16_f32 v146, v160, v161
  v_cvt_pk_bf16_f32 v147, v162, v163
  v_mfma_f32_16x16x32_bf16 v[204:207], a[80:83], a[12:15], v[204:207]
  s_waitcnt lgkmcnt(0)
  buffer_load_dwordx4 a[148:151], v9, s[4:7], s63 offen offset:2048 sc1
  v_mfma_f32_16x16x32_bf16 v[220:223], a[88:91], a[12:15], v[220:223]
  buffer_store_dwordx4 v[144:147], v231, s[4:7], s57 offen sc1
  s_add_u32 s57, s57, 16384
  v_mfma_f32_16x16x32_bf16 v[220:223], a[92:95], a[28:31], v[220:223]
  s_min_u32 s63, s91, 4096
  s_add_u32 s63, s63, s48
  buffer_load_dwordx4 a[152:155], v8, s[4:7], s63 offen offset:3072 sc1
  v_exp_f32 v242, v242
  v_mfma_f32_16x16x32_bf16 v[216:219], a[92:95], a[24:27], v[216:219]
  v_exp_f32 v243, v243
  v_mfma_f32_16x16x32_bf16 v[216:219], a[88:91], a[8:11], v[216:219]
  buffer_load_dwordx4 a[156:159], v9, s[4:7], s63 offen offset:3072 sc1
  v_exp_f32 v244, v244
  v_exp_f32 v245, v245
  v_rcp_f32 v249, v249
  v_pk_fma_f32 v[242:243], v[242:243], v[234:235], v[234:235] op_sel:[0,0,0] op_sel_hi:[1,0,0]
  v_pk_fma_f32 v[244:245], v[244:245], v[234:235], v[234:235] op_sel:[0,0,0] op_sel_hi:[1,0,0]
  v_pk_mul_f32 v[164:165], v[164:165], v[246:247]
  v_pk_mul_f32 v[166:167], v[166:167], v[248:249]
  v_pk_mul_f32 v[246:247], v[172:173], v[240:241] op_sel:[0,1] op_sel_hi:[1,1]
  v_pk_mul_f32 v[248:249], v[174:175], v[240:241] op_sel:[0,1] op_sel_hi:[1,1]
  v_pk_mul_f32 v[172:173], v[172:173], v[188:189]
  v_pk_mul_f32 v[174:175], v[174:175], v[190:191]
  v_mfma_f32_16x16x32_bf16 v[212:215], a[88:91], a[4:7], v[212:215]
  v_rcp_f32 v242, v242
  v_mfma_f32_16x16x32_bf16 v[212:215], a[92:95], a[20:23], v[212:215]
  v_mfma_f32_16x16x32_bf16 v[208:211], a[92:95], a[16:19], v[208:211]
  v_mfma_f32_16x16x32_bf16 v[208:211], a[88:91], a[0:3], v[208:211]
  ds_read_b64_tr_b16 a[0:1], v0 offset:0
  ds_read_b64_tr_b16 a[2:3], v0 offset:4096
  ds_read_b64_tr_b16 a[16:17], v0 offset:8192
  ds_read_b64_tr_b16 a[18:19], v0 offset:12288
  ds_read_b64_tr_b16 a[4:5], v1 offset:0
  ds_read_b64_tr_b16 a[6:7], v1 offset:4096
  ds_read_b64_tr_b16 a[20:21], v1 offset:8192
  ds_read_b64_tr_b16 a[22:23], v1 offset:12288
  ds_read_b64_tr_b16 a[8:9], v2 offset:0
  ds_read_b64_tr_b16 a[10:11], v2 offset:4096
  ds_read_b64_tr_b16 a[24:25], v2 offset:8192
  ds_read_b64_tr_b16 a[26:27], v2 offset:12288
  ds_read_b64_tr_b16 a[12:13], v3 offset:0
  ds_read_b64_tr_b16 a[14:15], v3 offset:4096
  ds_read_b64_tr_b16 a[28:29], v3 offset:8192
  ds_read_b64_tr_b16 a[30:31], v3 offset:12288
  s_add_u32 s48, s48, 4096
  s_min_u32 s63, s88, 4096
  s_add_u32 s63, s63, s48
  buffer_load_dwordx4 a[160:163], v8, s[4:7], s63 offen offset:0 sc1
  buffer_load_dwordx4 a[164:167], v9, s[4:7], s63 offen offset:0 sc1
  v_rcp_f32 v243, v243
  v_rcp_f32 v244, v244
  v_cvt_pk_bf16_f32 v150, v164, v165
  v_cvt_pk_bf16_f32 v151, v166, v167
  s_min_u32 s63, s89, 4096
  s_add_u32 s63, s63, s48
  buffer_load_dwordx4 a[168:171], v8, s[4:7], s63 offen offset:1024 sc1
  buffer_load_dwordx4 a[172:175], v9, s[4:7], s63 offen offset:1024 sc1
  buffer_store_dwordx4 v[148:151], v231, s[4:7], s58 offen sc1
  s_add_u32 s58, s58, 16384
  v_exp_f32 v246, v246
  v_exp_f32 v247, v247
  v_exp_f32 v248, v248
  v_exp_f32 v249, v249
  v_rcp_f32 v245, v245
  v_pk_fma_f32 v[246:247], v[246:247], v[234:235], v[234:235] op_sel:[0,1,1] op_sel_hi:[1,1,1]
  v_pk_fma_f32 v[248:249], v[248:249], v[234:235], v[234:235] op_sel:[0,1,1] op_sel_hi:[1,1,1]
  v_pk_mul_f32 v[168:169], v[168:169], v[242:243]
  v_pk_mul_f32 v[170:171], v[170:171], v[244:245]
  v_pk_mul_f32 v[242:243], v[192:193], v[238:239] op_sel:[0,0] op_sel_hi:[1,0]
  v_pk_mul_f32 v[244:245], v[194:195], v[238:239] op_sel:[0,0] op_sel_hi:[1,0]
  v_pk_mul_f32 v[192:193], v[192:193], v[208:209]
  v_pk_mul_f32 v[194:195], v[194:195], v[210:211]
  v_rcp_f32 v246, v246
  s_min_u32 s63, s90, 4096
  s_add_u32 s63, s63, s48
  buffer_load_dwordx4 a[176:179], v8, s[4:7], s63 offen offset:2048 sc1
  buffer_load_dwordx4 a[180:183], v9, s[4:7], s63 offen offset:2048 sc1
  v_rcp_f32 v247, v247
  v_rcp_f32 v248, v248
  v_cvt_pk_bf16_f32 v154, v168, v169
  v_cvt_pk_bf16_f32 v155, v170, v171
  s_min_u32 s63, s91, 4096
  s_add_u32 s63, s63, s48
  buffer_load_dwordx4 a[184:187], v8, s[4:7], s63 offen offset:3072 sc1
  buffer_load_dwordx4 a[188:191], v9, s[4:7], s63 offen offset:3072 sc1
  buffer_store_dwordx4 v[152:155], v231, s[4:7], s59 offen sc1
  s_add_u32 s59, s59, 16384
  v_exp_f32 v242, v242
  v_exp_f32 v243, v243
  v_exp_f32 v244, v244
  v_exp_f32 v245, v245
  v_rcp_f32 v249, v249
  v_pk_fma_f32 v[242:243], v[242:243], v[232:233], v[232:233] op_sel:[0,0,0] op_sel_hi:[1,0,0]
  v_pk_fma_f32 v[244:245], v[244:245], v[232:233], v[232:233] op_sel:[0,0,0] op_sel_hi:[1,0,0]
  v_pk_mul_f32 v[172:173], v[172:173], v[246:247]
  v_pk_mul_f32 v[174:175], v[174:175], v[248:249]
  v_pk_mul_f32 v[246:247], v[196:197], v[238:239] op_sel:[0,1] op_sel_hi:[1,1]
  v_pk_mul_f32 v[248:249], v[198:199], v[238:239] op_sel:[0,1] op_sel_hi:[1,1]
  v_pk_mul_f32 v[196:197], v[196:197], v[212:213]
  v_pk_mul_f32 v[198:199], v[198:199], v[214:215]
  v_rcp_f32 v242, v242
  s_add_u32 m0, s79, 65536
  s_add_u32 s92, s92, 196608
  s_add_u32 s93, s92, s88
  v_rcp_f32 v243, v243
  v_rcp_f32 v244, v244
  v_cvt_pk_bf16_f32 v158, v172, v173
  v_cvt_pk_bf16_f32 v159, v174, v175
  buffer_load_dwordx4 v252, s[80:83], s93 offen lds
  buffer_load_dwordx4 v252, s[84:87], s93 offen offset:1024 lds
  buffer_store_dwordx4 v[156:159], v231, s[4:7], s60 offen sc1
  s_add_u32 s60, s60, 16384
  v_exp_f32 v246, v246
  v_exp_f32 v247, v247
  v_exp_f32 v248, v248
  v_exp_f32 v249, v249
  v_rcp_f32 v245, v245
  v_pk_fma_f32 v[246:247], v[246:247], v[232:233], v[232:233] op_sel:[0,1,1] op_sel_hi:[1,1,1]
  v_pk_fma_f32 v[248:249], v[248:249], v[232:233], v[232:233] op_sel:[0,1,1] op_sel_hi:[1,1,1]
  v_pk_mul_f32 v[192:193], v[192:193], v[242:243]
  v_pk_mul_f32 v[194:195], v[194:195], v[244:245]
  v_pk_mul_f32 v[242:243], v[200:201], v[240:241] op_sel:[0,0] op_sel_hi:[1,0]
  v_pk_mul_f32 v[244:245], v[202:203], v[240:241] op_sel:[0,0] op_sel_hi:[1,0]
  v_pk_mul_f32 v[200:201], v[200:201], v[216:217]
  v_pk_mul_f32 v[202:203], v[202:203], v[218:219]
  v_rcp_f32 v246, v246
  s_add_u32 m0, s79, 73728
  s_add_u32 s92, s92, 262144
  s_add_u32 s93, s92, s89
  v_rcp_f32 v247, v247
  v_rcp_f32 v248, v248
  v_cvt_pk_bf16_f32 v208, v192, v193
  v_cvt_pk_bf16_f32 v209, v194, v195
  buffer_load_dwordx4 v252, s[80:83], s93 offen lds
  buffer_load_dwordx4 v252, s[84:87], s93 offen offset:1024 lds
  v_exp_f32 v242, v242
  v_exp_f32 v243, v243
  v_exp_f32 v244, v244
  v_exp_f32 v245, v245
  v_rcp_f32 v249, v249
  v_pk_fma_f32 v[242:243], v[242:243], v[234:235], v[234:235] op_sel:[0,0,0] op_sel_hi:[1,0,0]
  v_pk_fma_f32 v[244:245], v[244:245], v[234:235], v[234:235] op_sel:[0,0,0] op_sel_hi:[1,0,0]
  v_pk_mul_f32 v[196:197], v[196:197], v[246:247]
  v_pk_mul_f32 v[198:199], v[198:199], v[248:249]
  v_pk_mul_f32 v[246:247], v[204:205], v[240:241] op_sel:[0,1] op_sel_hi:[1,1]
  v_pk_mul_f32 v[248:249], v[206:207], v[240:241] op_sel:[0,1] op_sel_hi:[1,1]
  v_pk_mul_f32 v[204:205], v[204:205], v[220:221]
  v_pk_mul_f32 v[206:207], v[206:207], v[222:223]
  v_rcp_f32 v242, v242
  s_add_u32 m0, s79, 81920
  s_add_u32 s92, s92, 196608
  s_add_u32 s93, s92, s90
  v_rcp_f32 v243, v243
  v_rcp_f32 v244, v244
  v_cvt_pk_bf16_f32 v210, v196, v197
  v_cvt_pk_bf16_f32 v211, v198, v199
  buffer_load_dwordx4 v252, s[80:83], s93 offen lds
  buffer_load_dwordx4 v252, s[84:87], s93 offen offset:1024 lds
  s_nop 1
  v_permlane32_swap_b32 v208, v210
  v_permlane32_swap_b32 v209, v211
  buffer_store_dwordx4 v[208:211], v236, s[4:7], s61 offen sc1
  v_exp_f32 v246, v246
  v_exp_f32 v247, v247
  v_exp_f32 v248, v248
  v_exp_f32 v249, v249
  v_rcp_f32 v245, v245
  v_pk_fma_f32 v[246:247], v[246:247], v[234:235], v[234:235] op_sel:[0,1,1] op_sel_hi:[1,1,1]
  v_pk_fma_f32 v[248:249], v[248:249], v[234:235], v[234:235] op_sel:[0,1,1] op_sel_hi:[1,1,1]
  v_pk_mul_f32 v[200:201], v[200:201], v[242:243]
  v_pk_mul_f32 v[202:203], v[202:203], v[244:245]
  v_rcp_f32 v246, v246
  s_add_u32 m0, s79, 90112
  s_add_u32 s92, s92, 262144
  s_add_u32 s93, s92, s91
  v_rcp_f32 v247, v247
  v_rcp_f32 v248, v248
  v_cvt_pk_bf16_f32 v216, v200, v201
  v_cvt_pk_bf16_f32 v217, v202, v203
  buffer_load_dwordx4 v252, s[80:83], s93 offen lds
  buffer_load_dwordx4 v252, s[84:87], s93 offen offset:1024 lds
  v_rcp_f32 v249, v249
  s_nop 0
  v_pk_mul_f32 v[204:205], v[204:205], v[246:247]
  v_pk_mul_f32 v[206:207], v[206:207], v[248:249]
  v_cvt_pk_bf16_f32 v218, v204, v205
  v_cvt_pk_bf16_f32 v219, v206, v207
  s_nop 1
  v_permlane32_swap_b32 v216, v218
  v_permlane32_swap_b32 v217, v219
  buffer_store_dwordx4 v[216:219], v236, s[4:7], s62 offen sc1
  v_pk_mul_f32 v[32:33], v[250:251], 0 op_sel:[1,0] op_sel_hi:[1,0]
  v_pk_mul_f32 v[34:35], v[250:251], 0 op_sel:[1,0] op_sel_hi:[1,0]
  v_pk_mul_f32 v[36:37], v[250:251], 0 op_sel:[1,0] op_sel_hi:[1,0]
  v_pk_mul_f32 v[38:39], v[250:251], 0 op_sel:[1,0] op_sel_hi:[1,0]
  v_pk_mul_f32 v[40:41], v[250:251], 0 op_sel:[1,0] op_sel_hi:[1,0]
  v_pk_mul_f32 v[42:43], v[250:251], 0 op_sel:[1,0] op_sel_hi:[1,0]
  v_pk_mul_f32 v[44:45], v[250:251], 0 op_sel:[1,0] op_sel_hi:[1,0]
  v_pk_mul_f32 v[46:47], v[250:251], 0 op_sel:[1,0] op_sel_hi:[1,0]
  v_pk_mul_f32 v[48:49], v[250:251], 0 op_sel:[1,0] op_sel_hi:[1,0]
  v_pk_mul_f32 v[50:51], v[250:251], 0 op_sel:[1,0] op_sel_hi:[1,0]
  v_pk_mul_f32 v[52:53], v[250:251], 0 op_sel:[1,0] op_sel_hi:[1,0]
  v_pk_mul_f32 v[54:55], v[250:251], 0 op_sel:[1,0] op_sel_hi:[1,0]
  v_pk_mul_f32 v[56:57], v[250:251], 0 op_sel:[1,0] op_sel_hi:[1,0]
  v_pk_mul_f32 v[58:59], v[250:251], 0 op_sel:[1,0] op_sel_hi:[1,0]
  v_pk_mul_f32 v[60:61], v[250:251], 0 op_sel:[1,0] op_sel_hi:[1,0]
  v_pk_mul_f32 v[62:63], v[250:251], 0 op_sel:[1,0] op_sel_hi:[1,0]
  v_lshlrev_b32 v64, 16, v16
  v_and_b32 v65, 0xffff0000, v16
  v_lshlrev_b32 v66, 16, v17
  v_and_b32 v67, 0xffff0000, v17
  v_lshlrev_b32 v72, 16, v18
  v_and_b32 v73, 0xffff0000, v18
  v_lshlrev_b32 v74, 16, v19
  v_and_b32 v75, 0xffff0000, v19
  v_lshlrev_b32 v80, 16, v20
  v_and_b32 v81, 0xffff0000, v20
  v_lshlrev_b32 v82, 16, v21
  v_and_b32 v83, 0xffff0000, v21
  v_lshlrev_b32 v88, 16, v22
  v_and_b32 v89, 0xffff0000, v22
  v_lshlrev_b32 v90, 16, v23
  v_and_b32 v91, 0xffff0000, v23
  v_lshlrev_b32 v68, 16, v24
  v_and_b32 v69, 0xffff0000, v24
  v_lshlrev_b32 v70, 16, v25
  v_and_b32 v71, 0xffff0000, v25
  v_lshlrev_b32 v76, 16, v26
  v_and_b32 v77, 0xffff0000, v26
  v_lshlrev_b32 v78, 16, v27
  v_and_b32 v79, 0xffff0000, v27
  v_lshlrev_b32 v84, 16, v28
  v_and_b32 v85, 0xffff0000, v28
  v_lshlrev_b32 v86, 16, v29
  v_and_b32 v87, 0xffff0000, v29
  v_lshlrev_b32 v92, 16, v30
  v_and_b32 v93, 0xffff0000, v30
  v_lshlrev_b32 v94, 16, v31
  v_and_b32 v95, 0xffff0000, v31
  s_mov_b32 s56, 2
.p2align 3
Lp4_loop:
  s_waitcnt vmcnt(24) lgkmcnt(8)
  v_mfma_f32_16x16x32_bf16 v[32:35], a[0:3], a[128:131], v[32:35]
  s_waitcnt vmcnt(26)
  s_barrier
  ds_read_b64_tr_b16 a[32:33], v0 offset:1024
  s_add_u32 m0, s79, 98304
  s_add_u32 s92, s92, 196608
  s_cmp_lg_u32 s88, 0
  v_mfma_f32_16x16x32_bf16 v[32:35], a[16:19], a[136:139], v[32:35]
  s_cselect_b32 s93, -2686976, 0
  ds_read_b64_tr_b16 a[34:35], v0 offset:5120
  s_add_u32 s93, s93, s92
  v_mfma_f32_16x16x32_bf16 v[36:39], a[16:19], a[140:143], v[36:39]
  buffer_load_dwordx4 v252, s[80:83], s93 offen lds
  v_mfma_f32_16x16x32_bf16 v[36:39], a[0:3], a[132:135], v[36:39]
  ds_read_b64_tr_b16 a[48:49], v0 offset:9216
  ds_read_b64_tr_b16 a[50:51], v0 offset:13312
  v_mfma_f32_16x16x32_bf16 v[44:47], a[4:7], a[132:135], v[44:47]
  ds_read_b64_tr_b16 a[36:37], v1 offset:1024
  v_mfma_f32_16x16x32_bf16 v[44:47], a[20:23], a[140:143], v[44:47]
  ds_read_b64_tr_b16 a[38:39], v1 offset:5120
  v_mfma_f32_16x16x32_bf16 v[40:43], a[20:23], a[136:139], v[40:43]
  buffer_load_dwordx4 v252, s[84:87], s93 offen offset:1024 lds
  v_mfma_f32_16x16x32_bf16 v[40:43], a[4:7], a[128:131], v[40:43]
  s_waitcnt lgkmcnt(6)
  ds_read_b64_tr_b16 a[52:53], v1 offset:9216
  ds_read_b64_tr_b16 a[54:55], v1 offset:13312
  v_mfma_f32_16x16x32_bf16 v[48:51], a[8:11], a[128:131], v[48:51]
  ds_read_b64_tr_b16 a[40:41], v2 offset:1024
  v_mfma_f32_16x16x32_bf16 v[48:51], a[24:27], a[136:139], v[48:51]
  s_add_u32 s48, s48, 4096
  ds_read_b64_tr_b16 a[42:43], v2 offset:5120
  s_min_u32 s63, s88, 4096
  v_mfma_f32_16x16x32_bf16 v[52:55], a[24:27], a[140:143], v[52:55]
  s_add_u32 s63, s63, s48
  buffer_load_dwordx4 a[192:195], v8, s[4:7], s63 offen offset:0 sc1
  v_mfma_f32_16x16x32_bf16 v[52:55], a[8:11], a[132:135], v[52:55]
  ds_read_b64_tr_b16 a[56:57], v2 offset:9216
  ds_read_b64_tr_b16 a[58:59], v2 offset:13312
  v_mfma_f32_16x16x32_bf16 v[60:63], a[12:15], a[132:135], v[60:63]
  ds_read_b64_tr_b16 a[44:45], v3 offset:1024
  v_mfma_f32_16x16x32_bf16 v[60:63], a[28:31], a[140:143], v[60:63]
  ds_read_b64_tr_b16 a[46:47], v3 offset:5120
  v_mfma_f32_16x16x32_bf16 v[56:59], a[28:31], a[136:139], v[56:59]
  buffer_load_dwordx4 a[196:199], v9, s[4:7], s63 offen offset:0 sc1
  v_mfma_f32_16x16x32_bf16 v[56:59], a[12:15], a[128:131], v[56:59]
  s_waitcnt lgkmcnt(6)
  ds_read_b64_tr_b16 a[60:61], v3 offset:9216
  ds_read_b64_tr_b16 a[62:63], v3 offset:13312
  v_mfma_f32_16x16x32_bf16 v[64:67], a[32:35], a[128:131], v[64:67]
  s_add_u32 m0, s79, 106496
  ds_read_b64_tr_b16 a[0:1], v0 offset:16384
  buffer_load_dword v10, v251, s[4:7], s64 offen sc1
  s_add_u32 s92, s92, 262144
  s_cmp_lg_u32 s89, 0
  v_mfma_f32_16x16x32_bf16 v[64:67], a[48:51], a[136:139], v[64:67]
  s_cselect_b32 s93, -2686976, 0
  ds_read_b64_tr_b16 a[2:3], v0 offset:20480
  s_add_u32 s93, s93, s92
  v_mfma_f32_16x16x32_bf16 v[68:71], a[48:51], a[140:143], v[68:71]
  buffer_load_dwordx4 v252, s[80:83], s93 offen lds
  v_mfma_f32_16x16x32_bf16 v[68:71], a[32:35], a[132:135], v[68:71]
  ds_read_b64_tr_b16 a[16:17], v0 offset:24576
  ds_read_b64_tr_b16 a[18:19], v0 offset:28672
  v_mfma_f32_16x16x32_bf16 v[76:79], a[36:39], a[132:135], v[76:79]
  ds_read_b64_tr_b16 a[4:5], v1 offset:16384
  v_mfma_f32_16x16x32_bf16 v[76:79], a[52:55], a[140:143], v[76:79]
  ds_read_b64_tr_b16 a[6:7], v1 offset:20480
  v_mfma_f32_16x16x32_bf16 v[72:75], a[52:55], a[136:139], v[72:75]
  buffer_load_dwordx4 v252, s[84:87], s93 offen offset:1024 lds
  v_mfma_f32_16x16x32_bf16 v[72:75], a[36:39], a[128:131], v[72:75]
  s_waitcnt lgkmcnt(6)
  ds_read_b64_tr_b16 a[20:21], v1 offset:24576
  ds_read_b64_tr_b16 a[22:23], v1 offset:28672
  v_mfma_f32_16x16x32_bf16 v[80:83], a[40:43], a[128:131], v[80:83]
  ds_read_b64_tr_b16 a[8:9], v2 offset:16384
  v_mfma_f32_16x16x32_bf16 v[80:83], a[56:59], a[136:139], v[80:83]
  s_min_u32 s63, s89, 4096
  ds_read_b64_tr_b16 a[10:11], v2 offset:20480
  s_add_u32 s63, s63, s48
  v_mfma_f32_16x16x32_bf16 v[84:87], a[56:59], a[140:143], v[84:87]
  buffer_load_dwordx4 a[200:203], v8, s[4:7], s63 offen offset:1024 sc1
  v_mfma_f32_16x16x32_bf16 v[84:87], a[40:43], a[132:135], v[84:87]
  ds_read_b64_tr_b16 a[24:25], v2 offset:24576
  ds_read_b64_tr_b16 a[26:27], v2 offset:28672
  v_mfma_f32_16x16x32_bf16 v[92:95], a[44:47], a[132:135], v[92:95]
  ds_read_b64_tr_b16 a[12:13], v3 offset:16384
  v_mfma_f32_16x16x32_bf16 v[92:95], a[60:63], a[140:143], v[92:95]
  ds_read_b64_tr_b16 a[14:15], v3 offset:20480
  v_mfma_f32_16x16x32_bf16 v[88:91], a[60:63], a[136:139], v[88:91]
  buffer_load_dwordx4 a[204:207], v9, s[4:7], s63 offen offset:1024 sc1
  v_mfma_f32_16x16x32_bf16 v[88:91], a[44:47], a[128:131], v[88:91]
  s_waitcnt vmcnt(25) lgkmcnt(6)
  ds_read_b64_tr_b16 a[28:29], v3 offset:24576
  ds_read_b64_tr_b16 a[30:31], v3 offset:28672
  v_mfma_f32_16x16x32_bf16 v[32:35], a[0:3], a[144:147], v[32:35]
  s_add_u32 m0, s79, 114688
  ds_read_b64_tr_b16 a[32:33], v0 offset:17408
  s_add_u32 s92, s92, 196608
  s_cmp_lg_u32 s90, 0
  v_mfma_f32_16x16x32_bf16 v[32:35], a[16:19], a[152:155], v[32:35]
  s_cselect_b32 s93, -2686976, 0
  ds_read_b64_tr_b16 a[34:35], v0 offset:21504
  s_add_u32 s93, s93, s92
  v_mfma_f32_16x16x32_bf16 v[36:39], a[16:19], a[156:159], v[36:39]
  buffer_load_dwordx4 v252, s[80:83], s93 offen lds
  v_mfma_f32_16x16x32_bf16 v[36:39], a[0:3], a[148:151], v[36:39]
  ds_read_b64_tr_b16 a[48:49], v0 offset:25600
  ds_read_b64_tr_b16 a[50:51], v0 offset:29696
  v_mfma_f32_16x16x32_bf16 v[44:47], a[4:7], a[148:151], v[44:47]
  ds_read_b64_tr_b16 a[36:37], v1 offset:17408
  v_mfma_f32_16x16x32_bf16 v[44:47], a[20:23], a[156:159], v[44:47]
  ds_read_b64_tr_b16 a[38:39], v1 offset:21504
  v_mfma_f32_16x16x32_bf16 v[40:43], a[20:23], a[152:155], v[40:43]
  buffer_load_dwordx4 v252, s[84:87], s93 offen offset:1024 lds
  v_mfma_f32_16x16x32_bf16 v[40:43], a[4:7], a[144:147], v[40:43]
  s_waitcnt lgkmcnt(6)
  ds_read_b64_tr_b16 a[52:53], v1 offset:25600
  ds_read_b64_tr_b16 a[54:55], v1 offset:29696
  v_mfma_f32_16x16x32_bf16 v[48:51], a[8:11], a[144:147], v[48:51]
  ds_read_b64_tr_b16 a[40:41], v2 offset:17408
  v_mfma_f32_16x16x32_bf16 v[48:51], a[24:27], a[152:155], v[48:51]
  s_min_u32 s63, s90, 4096
  ds_read_b64_tr_b16 a[42:43], v2 offset:21504
  s_add_u32 s63, s63, s48
  v_mfma_f32_16x16x32_bf16 v[52:55], a[24:27], a[156:159], v[52:55]
  buffer_load_dwordx4 a[208:211], v8, s[4:7], s63 offen offset:2048 sc1
  v_mfma_f32_16x16x32_bf16 v[52:55], a[8:11], a[148:151], v[52:55]
  ds_read_b64_tr_b16 a[56:57], v2 offset:25600
  ds_read_b64_tr_b16 a[58:59], v2 offset:29696
  v_mfma_f32_16x16x32_bf16 v[60:63], a[12:15], a[148:151], v[60:63]
  ds_read_b64_tr_b16 a[44:45], v3 offset:17408
  v_mfma_f32_16x16x32_bf16 v[60:63], a[28:31], a[156:159], v[60:63]
  ds_read_b64_tr_b16 a[46:47], v3 offset:21504
  v_mfma_f32_16x16x32_bf16 v[56:59], a[28:31], a[152:155], v[56:59]
  buffer_load_dwordx4 a[212:215], v9, s[4:7], s63 offen offset:2048 sc1
  v_mfma_f32_16x16x32_bf16 v[56:59], a[12:15], a[144:147], v[56:59]
  s_waitcnt lgkmcnt(6)
  ds_read_b64_tr_b16 a[60:61], v3 offset:25600
  ds_read_b64_tr_b16 a[62:63], v3 offset:29696
  v_mfma_f32_16x16x32_bf16 v[64:67], a[32:35], a[144:147], v[64:67]
  s_add_u32 m0, s79, 122880
  ds_read_b64_tr_b16 a[0:1], v0 offset:32768
  s_add_u32 s92, s92, 262144
  s_cmp_lg_u32 s91, 0
  v_mfma_f32_16x16x32_bf16 v[64:67], a[48:51], a[152:155], v[64:67]
  s_cselect_b32 s93, -2686976, 0
  ds_read_b64_tr_b16 a[2:3], v0 offset:36864
  s_add_u32 s93, s93, s92
  v_mfma_f32_16x16x32_bf16 v[68:71], a[48:51], a[156:159], v[68:71]
  buffer_load_dwordx4 v252, s[80:83], s93 offen lds
  v_mfma_f32_16x16x32_bf16 v[68:71], a[32:35], a[148:151], v[68:71]
  ds_read_b64_tr_b16 a[16:17], v0 offset:40960
  ds_read_b64_tr_b16 a[18:19], v0 offset:45056
  v_mfma_f32_16x16x32_bf16 v[76:79], a[36:39], a[148:151], v[76:79]
  ds_read_b64_tr_b16 a[4:5], v1 offset:32768
  v_mfma_f32_16x16x32_bf16 v[76:79], a[52:55], a[156:159], v[76:79]
  ds_read_b64_tr_b16 a[6:7], v1 offset:36864
  v_mfma_f32_16x16x32_bf16 v[72:75], a[52:55], a[152:155], v[72:75]
  buffer_load_dwordx4 v252, s[84:87], s93 offen offset:1024 lds
  v_mfma_f32_16x16x32_bf16 v[72:75], a[36:39], a[144:147], v[72:75]
  s_waitcnt lgkmcnt(6)
  ds_read_b64_tr_b16 a[20:21], v1 offset:40960
  ds_read_b64_tr_b16 a[22:23], v1 offset:45056
  v_mfma_f32_16x16x32_bf16 v[80:83], a[40:43], a[144:147], v[80:83]
  ds_read_b64_tr_b16 a[8:9], v2 offset:32768
  v_mfma_f32_16x16x32_bf16 v[80:83], a[56:59], a[152:155], v[80:83]
  s_min_u32 s63, s91, 4096
  ds_read_b64_tr_b16 a[10:11], v2 offset:36864
  s_add_u32 s63, s63, s48
  v_mfma_f32_16x16x32_bf16 v[84:87], a[56:59], a[156:159], v[84:87]
  buffer_load_dwordx4 a[216:219], v8, s[4:7], s63 offen offset:3072 sc1
  v_mfma_f32_16x16x32_bf16 v[84:87], a[40:43], a[148:151], v[84:87]
  ds_read_b64_tr_b16 a[24:25], v2 offset:40960
  ds_read_b64_tr_b16 a[26:27], v2 offset:45056
  v_mfma_f32_16x16x32_bf16 v[92:95], a[44:47], a[148:151], v[92:95]
  ds_read_b64_tr_b16 a[12:13], v3 offset:32768
  v_mfma_f32_16x16x32_bf16 v[92:95], a[60:63], a[156:159], v[92:95]
  ds_read_b64_tr_b16 a[14:15], v3 offset:36864
  v_mfma_f32_16x16x32_bf16 v[88:91], a[60:63], a[152:155], v[88:91]
  buffer_load_dwordx4 a[220:223], v9, s[4:7], s63 offen offset:3072 sc1
  v_mfma_f32_16x16x32_bf16 v[88:91], a[44:47], a[144:147], v[88:91]
  s_waitcnt vmcnt(25) lgkmcnt(6)
  ds_read_b64_tr_b16 a[28:29], v3 offset:40960
  ds_read_b64_tr_b16 a[30:31], v3 offset:45056
  v_mfma_f32_16x16x32_bf16 v[32:35], a[0:3], a[160:163], v[32:35]
  s_waitcnt vmcnt(23)
  s_barrier
  ds_read_b64_tr_b16 a[32:33], v0 offset:33792
  s_waitcnt vmcnt(12)
  v_cmp_gt_u32 vcc, 16, v10
  s_cbranch_vccnz Lp4b_c
Lp4b_r:
  s_add_u32 s64, s64, 4096
  v_mfma_f32_16x16x32_bf16 v[32:35], a[16:19], a[168:171], v[32:35]
  s_add_u32 m0, s79, 0
  ds_read_b64_tr_b16 a[34:35], v0 offset:37888
  s_add_u32 s92, s92, -3407872
  v_mfma_f32_16x16x32_bf16 v[36:39], a[16:19], a[172:175], v[36:39]
  s_add_u32 s93, s92, s88
  buffer_load_dwordx4 v252, s[80:83], s93 offen lds
  v_mfma_f32_16x16x32_bf16 v[36:39], a[0:3], a[164:167], v[36:39]
  ds_read_b64_tr_b16 a[48:49], v0 offset:41984
  ds_read_b64_tr_b16 a[50:51], v0 offset:46080
  v_mfma_f32_16x16x32_bf16 v[44:47], a[4:7], a[164:167], v[44:47]
  ds_read_b64_tr_b16 a[36:37], v1 offset:33792
  v_mfma_f32_16x16x32_bf16 v[44:47], a[20:23], a[172:175], v[44:47]
  ds_read_b64_tr_b16 a[38:39], v1 offset:37888
  v_mfma_f32_16x16x32_bf16 v[40:43], a[20:23], a[168:171], v[40:43]
  buffer_load_dwordx4 v252, s[84:87], s93 offen offset:1024 lds
  v_mfma_f32_16x16x32_bf16 v[40:43], a[4:7], a[160:163], v[40:43]
  s_waitcnt lgkmcnt(6)
  ds_read_b64_tr_b16 a[52:53], v1 offset:41984
  ds_read_b64_tr_b16 a[54:55], v1 offset:46080
  v_mfma_f32_16x16x32_bf16 v[48:51], a[8:11], a[160:163], v[48:51]
  ds_read_b64_tr_b16 a[40:41], v2 offset:33792
  v_mfma_f32_16x16x32_bf16 v[48:51], a[24:27], a[168:171], v[48:51]
  s_add_u32 s48, s48, 4096
  ds_read_b64_tr_b16 a[42:43], v2 offset:37888
  s_min_u32 s63, s88, 4096
  v_mfma_f32_16x16x32_bf16 v[52:55], a[24:27], a[172:175], v[52:55]
  s_add_u32 s63, s63, s48
  buffer_load_dwordx4 a[224:227], v8, s[4:7], s63 offen offset:0 sc1
  v_mfma_f32_16x16x32_bf16 v[52:55], a[8:11], a[164:167], v[52:55]
  ds_read_b64_tr_b16 a[56:57], v2 offset:41984
  ds_read_b64_tr_b16 a[58:59], v2 offset:46080
  v_mfma_f32_16x16x32_bf16 v[60:63], a[12:15], a[164:167], v[60:63]
  ds_read_b64_tr_b16 a[44:45], v3 offset:33792
  v_mfma_f32_16x16x32_bf16 v[60:63], a[28:31], a[172:175], v[60:63]
  ds_read_b64_tr_b16 a[46:47], v3 offset:37888
  v_mfma_f32_16x16x32_bf16 v[56:59], a[28:31], a[168:171], v[56:59]
  buffer_load_dwordx4 a[228:231], v9, s[4:7], s63 offen offset:0 sc1
  v_mfma_f32_16x16x32_bf16 v[56:59], a[12:15], a[160:163], v[56:59]
  s_waitcnt lgkmcnt(6)
  ds_read_b64_tr_b16 a[60:61], v3 offset:41984
  ds_read_b64_tr_b16 a[62:63], v3 offset:46080
  v_mfma_f32_16x16x32_bf16 v[64:67], a[32:35], a[160:163], v[64:67]
  ds_read_b64_tr_b16 a[0:1], v0 offset:49152
  s_add_u32 m0, s79, 8192
  v_mfma_f32_16x16x32_bf16 v[64:67], a[48:51], a[168:171], v[64:67]
  s_add_u32 s92, s92, 262144
  ds_read_b64_tr_b16 a[2:3], v0 offset:53248
  s_add_u32 s93, s92, s89
  v_mfma_f32_16x16x32_bf16 v[68:71], a[48:51], a[172:175], v[68:71]
  buffer_load_dwordx4 v252, s[80:83], s93 offen lds
  v_mfma_f32_16x16x32_bf16 v[68:71], a[32:35], a[164:167], v[68:71]
  ds_read_b64_tr_b16 a[16:17], v0 offset:57344
  ds_read_b64_tr_b16 a[18:19], v0 offset:61440
  v_mfma_f32_16x16x32_bf16 v[76:79], a[36:39], a[164:167], v[76:79]
  ds_read_b64_tr_b16 a[4:5], v1 offset:49152
  v_mfma_f32_16x16x32_bf16 v[76:79], a[52:55], a[172:175], v[76:79]
  ds_read_b64_tr_b16 a[6:7], v1 offset:53248
  v_mfma_f32_16x16x32_bf16 v[72:75], a[52:55], a[168:171], v[72:75]
  buffer_load_dwordx4 v252, s[84:87], s93 offen offset:1024 lds
  v_mfma_f32_16x16x32_bf16 v[72:75], a[36:39], a[160:163], v[72:75]
  s_waitcnt lgkmcnt(6)
  ds_read_b64_tr_b16 a[20:21], v1 offset:57344
  ds_read_b64_tr_b16 a[22:23], v1 offset:61440
  v_mfma_f32_16x16x32_bf16 v[80:83], a[40:43], a[160:163], v[80:83]
  ds_read_b64_tr_b16 a[8:9], v2 offset:49152
  v_mfma_f32_16x16x32_bf16 v[80:83], a[56:59], a[168:171], v[80:83]
  s_min_u32 s63, s89, 4096
  ds_read_b64_tr_b16 a[10:11], v2 offset:53248
  s_add_u32 s63, s63, s48
  v_mfma_f32_16x16x32_bf16 v[84:87], a[56:59], a[172:175], v[84:87]
  buffer_load_dwordx4 a[232:235], v8, s[4:7], s63 offen offset:1024 sc1
  v_mfma_f32_16x16x32_bf16 v[84:87], a[40:43], a[164:167], v[84:87]
  ds_read_b64_tr_b16 a[24:25], v2 offset:57344
  ds_read_b64_tr_b16 a[26:27], v2 offset:61440
  v_mfma_f32_16x16x32_bf16 v[92:95], a[44:47], a[164:167], v[92:95]
  ds_read_b64_tr_b16 a[12:13], v3 offset:49152
  v_mfma_f32_16x16x32_bf16 v[92:95], a[60:63], a[172:175], v[92:95]
  ds_read_b64_tr_b16 a[14:15], v3 offset:53248
  v_mfma_f32_16x16x32_bf16 v[88:91], a[60:63], a[168:171], v[88:91]
  buffer_load_dwordx4 a[236:239], v9, s[4:7], s63 offen offset:1024 sc1
  v_mfma_f32_16x16x32_bf16 v[88:91], a[44:47], a[160:163], v[88:91]
  s_waitcnt vmcnt(25) lgkmcnt(6)
  ds_read_b64_tr_b16 a[28:29], v3 offset:57344
  ds_read_b64_tr_b16 a[30:31], v3 offset:61440
  v_mfma_f32_16x16x32_bf16 v[32:35], a[0:3], a[176:179], v[32:35]
  ds_read_b64_tr_b16 a[32:33], v0 offset:50176
  s_add_u32 m0, s79, 16384
  v_mfma_f32_16x16x32_bf16 v[32:35], a[16:19], a[184:187], v[32:35]
  s_add_u32 s92, s92, 196608
  ds_read_b64_tr_b16 a[34:35], v0 offset:54272
  s_add_u32 s93, s92, s90
  v_mfma_f32_16x16x32_bf16 v[36:39], a[16:19], a[188:191], v[36:39]
  buffer_load_dwordx4 v252, s[80:83], s93 offen lds
  v_mfma_f32_16x16x32_bf16 v[36:39], a[0:3], a[180:183], v[36:39]
  ds_read_b64_tr_b16 a[48:49], v0 offset:58368
  ds_read_b64_tr_b16 a[50:51], v0 offset:62464
  v_mfma_f32_16x16x32_bf16 v[44:47], a[4:7], a[180:183], v[44:47]
  ds_read_b64_tr_b16 a[36:37], v1 offset:50176
  v_mfma_f32_16x16x32_bf16 v[44:47], a[20:23], a[188:191], v[44:47]
  ds_read_b64_tr_b16 a[38:39], v1 offset:54272
  v_mfma_f32_16x16x32_bf16 v[40:43], a[20:23], a[184:187], v[40:43]
  buffer_load_dwordx4 v252, s[84:87], s93 offen offset:1024 lds
  v_mfma_f32_16x16x32_bf16 v[40:43], a[4:7], a[176:179], v[40:43]
  s_waitcnt lgkmcnt(6)
  ds_read_b64_tr_b16 a[52:53], v1 offset:58368
  ds_read_b64_tr_b16 a[54:55], v1 offset:62464
  v_mfma_f32_16x16x32_bf16 v[48:51], a[8:11], a[176:179], v[48:51]
  ds_read_b64_tr_b16 a[40:41], v2 offset:50176
  v_mfma_f32_16x16x32_bf16 v[48:51], a[24:27], a[184:187], v[48:51]
  s_min_u32 s63, s90, 4096
  ds_read_b64_tr_b16 a[42:43], v2 offset:54272
  s_add_u32 s63, s63, s48
  v_mfma_f32_16x16x32_bf16 v[52:55], a[24:27], a[188:191], v[52:55]
  buffer_load_dwordx4 a[240:243], v8, s[4:7], s63 offen offset:2048 sc1
  v_mfma_f32_16x16x32_bf16 v[52:55], a[8:11], a[180:183], v[52:55]
  ds_read_b64_tr_b16 a[56:57], v2 offset:58368
  ds_read_b64_tr_b16 a[58:59], v2 offset:62464
  v_mfma_f32_16x16x32_bf16 v[60:63], a[12:15], a[180:183], v[60:63]
  ds_read_b64_tr_b16 a[44:45], v3 offset:50176
  v_mfma_f32_16x16x32_bf16 v[60:63], a[28:31], a[188:191], v[60:63]
  ds_read_b64_tr_b16 a[46:47], v3 offset:54272
  v_mfma_f32_16x16x32_bf16 v[56:59], a[28:31], a[184:187], v[56:59]
  buffer_load_dwordx4 a[244:247], v9, s[4:7], s63 offen offset:2048 sc1
  v_mfma_f32_16x16x32_bf16 v[56:59], a[12:15], a[176:179], v[56:59]
  s_waitcnt lgkmcnt(6)
  ds_read_b64_tr_b16 a[60:61], v3 offset:58368
  ds_read_b64_tr_b16 a[62:63], v3 offset:62464
  v_mfma_f32_16x16x32_bf16 v[64:67], a[32:35], a[176:179], v[64:67]
  ds_read_b64_tr_b16 a[0:1], v4 offset:0
  s_add_u32 m0, s79, 24576
  v_mfma_f32_16x16x32_bf16 v[64:67], a[48:51], a[184:187], v[64:67]
  s_add_u32 s92, s92, 262144
  ds_read_b64_tr_b16 a[2:3], v4 offset:4096
  s_add_u32 s93, s92, s91
  v_mfma_f32_16x16x32_bf16 v[68:71], a[48:51], a[188:191], v[68:71]
  buffer_load_dwordx4 v252, s[80:83], s93 offen lds
  v_mfma_f32_16x16x32_bf16 v[68:71], a[32:35], a[180:183], v[68:71]
  ds_read_b64_tr_b16 a[16:17], v4 offset:8192
  ds_read_b64_tr_b16 a[18:19], v4 offset:12288
  v_mfma_f32_16x16x32_bf16 v[76:79], a[36:39], a[180:183], v[76:79]
  ds_read_b64_tr_b16 a[4:5], v5 offset:0
  v_mfma_f32_16x16x32_bf16 v[76:79], a[52:55], a[188:191], v[76:79]
  ds_read_b64_tr_b16 a[6:7], v5 offset:4096
  v_mfma_f32_16x16x32_bf16 v[72:75], a[52:55], a[184:187], v[72:75]
  buffer_load_dwordx4 v252, s[84:87], s93 offen offset:1024 lds
  v_mfma_f32_16x16x32_bf16 v[72:75], a[36:39], a[176:179], v[72:75]
  s_waitcnt lgkmcnt(6)
  ds_read_b64_tr_b16 a[20:21], v5 offset:8192
  ds_read_b64_tr_b16 a[22:23], v5 offset:12288
  v_mfma_f32_16x16x32_bf16 v[80:83], a[40:43], a[176:179], v[80:83]
  ds_read_b64_tr_b16 a[8:9], v6 offset:0
  v_mfma_f32_16x16x32_bf16 v[80:83], a[56:59], a[184:187], v[80:83]
  s_min_u32 s63, s91, 4096
  ds_read_b64_tr_b16 a[10:11], v6 offset:4096
  s_add_u32 s63, s63, s48
  v_mfma_f32_16x16x32_bf16 v[84:87], a[56:59], a[188:191], v[84:87]
  buffer_load_dwordx4 a[248:251], v8, s[4:7], s63 offen offset:3072 sc1
  v_mfma_f32_16x16x32_bf16 v[84:87], a[40:43], a[180:183], v[84:87]
  ds_read_b64_tr_b16 a[24:25], v6 offset:8192
  ds_read_b64_tr_b16 a[26:27], v6 offset:12288
  v_mfma_f32_16x16x32_bf16 v[92:95], a[44:47], a[180:183], v[92:95]
  ds_read_b64_tr_b16 a[12:13], v7 offset:0
  v_mfma_f32_16x16x32_bf16 v[92:95], a[60:63], a[188:191], v[92:95]
  ds_read_b64_tr_b16 a[14:15], v7 offset:4096
  v_mfma_f32_16x16x32_bf16 v[88:91], a[60:63], a[184:187], v[88:91]
  buffer_load_dwordx4 a[252:255], v9, s[4:7], s63 offen offset:3072 sc1
  v_mfma_f32_16x16x32_bf16 v[88:91], a[44:47], a[176:179], v[88:91]
  s_waitcnt vmcnt(24) lgkmcnt(6)
  ds_read_b64_tr_b16 a[28:29], v7 offset:8192
  ds_read_b64_tr_b16 a[30:31], v7 offset:12288
  v_mfma_f32_16x16x32_bf16 v[32:35], a[0:3], a[192:195], v[32:35]
  s_waitcnt vmcnt(26)
  s_barrier
  s_xor_b32 s43, s56, 2
  s_or_b32 s43, s43, s40
  s_cbranch_scc0 Lp3_sgl_c
Lp3_sgl_r:
  ds_read_b64_tr_b16 a[32:33], v4 offset:1024
  v_mfma_f32_16x16x32_bf16 v[32:35], a[16:19], a[200:203], v[32:35]
  s_add_u32 m0, s79, 32768
  ds_read_b64_tr_b16 a[34:35], v4 offset:5120
  s_add_u32 s92, s92, 196608
  v_mfma_f32_16x16x32_bf16 v[36:39], a[16:19], a[204:207], v[36:39]
  s_add_u32 s93, s92, s88
  buffer_load_dwordx4 v252, s[80:83], s93 offen lds
  v_mfma_f32_16x16x32_bf16 v[36:39], a[0:3], a[196:199], v[36:39]
  ds_read_b64_tr_b16 a[48:49], v4 offset:9216
  ds_read_b64_tr_b16 a[50:51], v4 offset:13312
  v_mfma_f32_16x16x32_bf16 v[44:47], a[4:7], a[196:199], v[44:47]
  ds_read_b64_tr_b16 a[36:37], v5 offset:1024
  v_mfma_f32_16x16x32_bf16 v[44:47], a[20:23], a[204:207], v[44:47]
  ds_read_b64_tr_b16 a[38:39], v5 offset:5120
  v_mfma_f32_16x16x32_bf16 v[40:43], a[20:23], a[200:203], v[40:43]
  buffer_load_dwordx4 v252, s[84:87], s93 offen offset:1024 lds
  v_mfma_f32_16x16x32_bf16 v[40:43], a[4:7], a[192:195], v[40:43]
  s_waitcnt lgkmcnt(6)
  ds_read_b64_tr_b16 a[52:53], v5 offset:9216
  ds_read_b64_tr_b16 a[54:55], v5 offset:13312
  v_mfma_f32_16x16x32_bf16 v[48:51], a[8:11], a[192:195], v[48:51]
  ds_read_b64_tr_b16 a[40:41], v6 offset:1024
  v_mfma_f32_16x16x32_bf16 v[48:51], a[24:27], a[200:203], v[48:51]
  s_add_u32 s48, s48, 4096
  ds_read_b64_tr_b16 a[42:43], v6 offset:5120
  s_min_u32 s63, s88, 4096
  v_mfma_f32_16x16x32_bf16 v[52:55], a[24:27], a[204:207], v[52:55]
  s_add_u32 s63, s63, s48
  buffer_load_dwordx4 a[128:131], v8, s[4:7], s63 offen offset:0 sc1
  v_mfma_f32_16x16x32_bf16 v[52:55], a[8:11], a[196:199], v[52:55]
  ds_read_b64_tr_b16 a[56:57], v6 offset:9216
  ds_read_b64_tr_b16 a[58:59], v6 offset:13312
  v_mfma_f32_16x16x32_bf16 v[60:63], a[12:15], a[196:199], v[60:63]
  ds_read_b64_tr_b16 a[44:45], v7 offset:1024
  v_mfma_f32_16x16x32_bf16 v[60:63], a[28:31], a[204:207], v[60:63]
  ds_read_b64_tr_b16 a[46:47], v7 offset:5120
  v_mfma_f32_16x16x32_bf16 v[56:59], a[28:31], a[200:203], v[56:59]
  buffer_load_dwordx4 a[132:135], v9, s[4:7], s63 offen offset:0 sc1
  v_mfma_f32_16x16x32_bf16 v[56:59], a[12:15], a[192:195], v[56:59]
  s_waitcnt lgkmcnt(6)
  ds_read_b64_tr_b16 a[60:61], v7 offset:9216
  ds_read_b64_tr_b16 a[62:63], v7 offset:13312
  v_mfma_f32_16x16x32_bf16 v[64:67], a[32:35], a[192:195], v[64:67]
  ds_read_b64_tr_b16 a[0:1], v4 offset:16384
  s_add_u32 m0, s79, 40960
  v_mfma_f32_16x16x32_bf16 v[64:67], a[48:51], a[200:203], v[64:67]
  s_add_u32 s92, s92, 262144
  ds_read_b64_tr_b16 a[2:3], v4 offset:20480
  s_add_u32 s93, s92, s89
  v_mfma_f32_16x16x32_bf16 v[68:71], a[48:51], a[204:207], v[68:71]
  buffer_load_dwordx4 v252, s[80:83], s93 offen lds
  v_mfma_f32_16x16x32_bf16 v[68:71], a[32:35], a[196:199], v[68:71]
  ds_read_b64_tr_b16 a[16:17], v4 offset:24576
  ds_read_b64_tr_b16 a[18:19], v4 offset:28672
  v_mfma_f32_16x16x32_bf16 v[76:79], a[36:39], a[196:199], v[76:79]
  ds_read_b64_tr_b16 a[4:5], v5 offset:16384
  v_mfma_f32_16x16x32_bf16 v[76:79], a[52:55], a[204:207], v[76:79]
  ds_read_b64_tr_b16 a[6:7], v5 offset:20480
  v_mfma_f32_16x16x32_bf16 v[72:75], a[52:55], a[200:203], v[72:75]
  buffer_load_dwordx4 v252, s[84:87], s93 offen offset:1024 lds
  v_mfma_f32_16x16x32_bf16 v[72:75], a[36:39], a[192:195], v[72:75]
  s_waitcnt lgkmcnt(6)
  ds_read_b64_tr_b16 a[20:21], v5 offset:24576
  ds_read_b64_tr_b16 a[22:23], v5 offset:28672
  v_mfma_f32_16x16x32_bf16 v[80:83], a[40:43], a[192:195], v[80:83]
  ds_read_b64_tr_b16 a[8:9], v6 offset:16384
  v_mfma_f32_16x16x32_bf16 v[80:83], a[56:59], a[200:203], v[80:83]
  s_min_u32 s63, s89, 4096
  ds_read_b64_tr_b16 a[10:11], v6 offset:20480
  s_add_u32 s63, s63, s48
  v_mfma_f32_16x16x32_bf16 v[84:87], a[56:59], a[204:207], v[84:87]
  buffer_load_dwordx4 a[136:139], v8, s[4:7], s63 offen offset:1024 sc1
  v_mfma_f32_16x16x32_bf16 v[84:87], a[40:43], a[196:199], v[84:87]
  ds_read_b64_tr_b16 a[24:25], v6 offset:24576
  ds_read_b64_tr_b16 a[26:27], v6 offset:28672
  v_mfma_f32_16x16x32_bf16 v[92:95], a[44:47], a[196:199], v[92:95]
  ds_read_b64_tr_b16 a[12:13], v7 offset:16384
  v_mfma_f32_16x16x32_bf16 v[92:95], a[60:63], a[204:207], v[92:95]
  ds_read_b64_tr_b16 a[14:15], v7 offset:20480
  v_mfma_f32_16x16x32_bf16 v[88:91], a[60:63], a[200:203], v[88:91]
  buffer_load_dwordx4 a[140:143], v9, s[4:7], s63 offen offset:1024 sc1
  v_mfma_f32_16x16x32_bf16 v[88:91], a[44:47], a[192:195], v[88:91]
  s_waitcnt vmcnt(24) lgkmcnt(6)
  ds_read_b64_tr_b16 a[28:29], v7 offset:24576
  ds_read_b64_tr_b16 a[30:31], v7 offset:28672
  v_mfma_f32_16x16x32_bf16 v[32:35], a[0:3], a[208:211], v[32:35]
  ds_read_b64_tr_b16 a[32:33], v4 offset:17408
  s_add_u32 m0, s79, 49152
  v_mfma_f32_16x16x32_bf16 v[32:35], a[16:19], a[216:219], v[32:35]
  s_add_u32 s92, s92, 196608
  ds_read_b64_tr_b16 a[34:35], v4 offset:21504
  s_add_u32 s93, s92, s90
  v_mfma_f32_16x16x32_bf16 v[36:39], a[16:19], a[220:223], v[36:39]
  buffer_load_dwordx4 v252, s[80:83], s93 offen lds
  v_mfma_f32_16x16x32_bf16 v[36:39], a[0:3], a[212:215], v[36:39]
  ds_read_b64_tr_b16 a[48:49], v4 offset:25600
  ds_read_b64_tr_b16 a[50:51], v4 offset:29696
  v_mfma_f32_16x16x32_bf16 v[44:47], a[4:7], a[212:215], v[44:47]
  ds_read_b64_tr_b16 a[36:37], v5 offset:17408
  v_mfma_f32_16x16x32_bf16 v[44:47], a[20:23], a[220:223], v[44:47]
  ds_read_b64_tr_b16 a[38:39], v5 offset:21504
  v_mfma_f32_16x16x32_bf16 v[40:43], a[20:23], a[216:219], v[40:43]
  buffer_load_dwordx4 v252, s[84:87], s93 offen offset:1024 lds
  v_mfma_f32_16x16x32_bf16 v[40:43], a[4:7], a[208:211], v[40:43]
  s_waitcnt lgkmcnt(6)
  ds_read_b64_tr_b16 a[52:53], v5 offset:25600
  ds_read_b64_tr_b16 a[54:55], v5 offset:29696
  v_mfma_f32_16x16x32_bf16 v[48:51], a[8:11], a[208:211], v[48:51]
  ds_read_b64_tr_b16 a[40:41], v6 offset:17408
  v_mfma_f32_16x16x32_bf16 v[48:51], a[24:27], a[216:219], v[48:51]
  s_min_u32 s63, s90, 4096
  ds_read_b64_tr_b16 a[42:43], v6 offset:21504
  s_add_u32 s63, s63, s48
  v_mfma_f32_16x16x32_bf16 v[52:55], a[24:27], a[220:223], v[52:55]
  buffer_load_dwordx4 a[144:147], v8, s[4:7], s63 offen offset:2048 sc1
  v_mfma_f32_16x16x32_bf16 v[52:55], a[8:11], a[212:215], v[52:55]
  ds_read_b64_tr_b16 a[56:57], v6 offset:25600
  ds_read_b64_tr_b16 a[58:59], v6 offset:29696
  v_mfma_f32_16x16x32_bf16 v[60:63], a[12:15], a[212:215], v[60:63]
  ds_read_b64_tr_b16 a[44:45], v7 offset:17408
  v_mfma_f32_16x16x32_bf16 v[60:63], a[28:31], a[220:223], v[60:63]
  ds_read_b64_tr_b16 a[46:47], v7 offset:21504
  v_mfma_f32_16x16x32_bf16 v[56:59], a[28:31], a[216:219], v[56:59]
  buffer_load_dwordx4 a[148:151], v9, s[4:7], s63 offen offset:2048 sc1
  v_mfma_f32_16x16x32_bf16 v[56:59], a[12:15], a[208:211], v[56:59]
  s_waitcnt lgkmcnt(6)
  ds_read_b64_tr_b16 a[60:61], v7 offset:25600
  ds_read_b64_tr_b16 a[62:63], v7 offset:29696
  v_mfma_f32_16x16x32_bf16 v[64:67], a[32:35], a[208:211], v[64:67]
  ds_read_b64_tr_b16 a[0:1], v4 offset:32768
  s_add_u32 m0, s79, 57344
  v_mfma_f32_16x16x32_bf16 v[64:67], a[48:51], a[216:219], v[64:67]
  s_add_u32 s92, s92, 262144
  ds_read_b64_tr_b16 a[2:3], v4 offset:36864
  s_add_u32 s93, s92, s91
  v_mfma_f32_16x16x32_bf16 v[68:71], a[48:51], a[220:223], v[68:71]
  buffer_load_dwordx4 v252, s[80:83], s93 offen lds
  v_mfma_f32_16x16x32_bf16 v[68:71], a[32:35], a[212:215], v[68:71]
  ds_read_b64_tr_b16 a[16:17], v4 offset:40960
  ds_read_b64_tr_b16 a[18:19], v4 offset:45056
  v_mfma_f32_16x16x32_bf16 v[76:79], a[36:39], a[212:215], v[76:79]
  ds_read_b64_tr_b16 a[4:5], v5 offset:32768
  v_mfma_f32_16x16x32_bf16 v[76:79], a[52:55], a[220:223], v[76:79]
  ds_read_b64_tr_b16 a[6:7], v5 offset:36864
  v_mfma_f32_16x16x32_bf16 v[72:75], a[52:55], a[216:219], v[72:75]
  buffer_load_dwordx4 v252, s[84:87], s93 offen offset:1024 lds
  v_mfma_f32_16x16x32_bf16 v[72:75], a[36:39], a[208:211], v[72:75]
  s_waitcnt lgkmcnt(6)
  ds_read_b64_tr_b16 a[20:21], v5 offset:40960
  ds_read_b64_tr_b16 a[22:23], v5 offset:45056
  v_mfma_f32_16x16x32_bf16 v[80:83], a[40:43], a[208:211], v[80:83]
  ds_read_b64_tr_b16 a[8:9], v6 offset:32768
  v_mfma_f32_16x16x32_bf16 v[80:83], a[56:59], a[216:219], v[80:83]
  s_min_u32 s63, s91, 4096
  ds_read_b64_tr_b16 a[10:11], v6 offset:36864
  s_add_u32 s63, s63, s48
  v_mfma_f32_16x16x32_bf16 v[84:87], a[56:59], a[220:223], v[84:87]
  buffer_load_dwordx4 a[152:155], v8, s[4:7], s63 offen offset:3072 sc1
  v_mfma_f32_16x16x32_bf16 v[84:87], a[40:43], a[212:215], v[84:87]
  ds_read_b64_tr_b16 a[24:25], v6 offset:40960
  ds_read_b64_tr_b16 a[26:27], v6 offset:45056
  v_mfma_f32_16x16x32_bf16 v[92:95], a[44:47], a[212:215], v[92:95]
  ds_read_b64_tr_b16 a[12:13], v7 offset:32768
  v_mfma_f32_16x16x32_bf16 v[92:95], a[60:63], a[220:223], v[92:95]
  ds_read_b64_tr_b16 a[14:15], v7 offset:36864
  v_mfma_f32_16x16x32_bf16 v[88:91], a[60:63], a[216:219], v[88:91]
  buffer_load_dwordx4 a[156:159], v9, s[4:7], s63 offen offset:3072 sc1
  v_mfma_f32_16x16x32_bf16 v[88:91], a[44:47], a[208:211], v[88:91]
  s_waitcnt vmcnt(24) lgkmcnt(6)
  ds_read_b64_tr_b16 a[28:29], v7 offset:40960
  ds_read_b64_tr_b16 a[30:31], v7 offset:45056
  v_mfma_f32_16x16x32_bf16 v[32:35], a[0:3], a[224:227], v[32:35]
  s_waitcnt vmcnt(26)
  s_barrier
  ds_read_b64_tr_b16 a[32:33], v4 offset:33792
  v_mfma_f32_16x16x32_bf16 v[32:35], a[16:19], a[232:235], v[32:35]
  s_add_u32 m0, s79, 65536
  ds_read_b64_tr_b16 a[34:35], v4 offset:37888
  s_add_u32 s92, s92, 196608
  v_mfma_f32_16x16x32_bf16 v[36:39], a[16:19], a[236:239], v[36:39]
  s_add_u32 s93, s92, s88
  buffer_load_dwordx4 v252, s[80:83], s93 offen lds
  v_mfma_f32_16x16x32_bf16 v[36:39], a[0:3], a[228:231], v[36:39]
  ds_read_b64_tr_b16 a[48:49], v4 offset:41984
  ds_read_b64_tr_b16 a[50:51], v4 offset:46080
  v_mfma_f32_16x16x32_bf16 v[44:47], a[4:7], a[228:231], v[44:47]
  ds_read_b64_tr_b16 a[36:37], v5 offset:33792
  v_mfma_f32_16x16x32_bf16 v[44:47], a[20:23], a[236:239], v[44:47]
  ds_read_b64_tr_b16 a[38:39], v5 offset:37888
  v_mfma_f32_16x16x32_bf16 v[40:43], a[20:23], a[232:235], v[40:43]
  buffer_load_dwordx4 v252, s[84:87], s93 offen offset:1024 lds
  v_mfma_f32_16x16x32_bf16 v[40:43], a[4:7], a[224:227], v[40:43]
  s_waitcnt lgkmcnt(6)
  ds_read_b64_tr_b16 a[52:53], v5 offset:41984
  ds_read_b64_tr_b16 a[54:55], v5 offset:46080
  v_mfma_f32_16x16x32_bf16 v[48:51], a[8:11], a[224:227], v[48:51]
  ds_read_b64_tr_b16 a[40:41], v6 offset:33792
  v_mfma_f32_16x16x32_bf16 v[48:51], a[24:27], a[232:235], v[48:51]
  s_add_u32 s48, s48, 4096
  ds_read_b64_tr_b16 a[42:43], v6 offset:37888
  s_min_u32 s63, s88, 4096
  v_mfma_f32_16x16x32_bf16 v[52:55], a[24:27], a[236:239], v[52:55]
  s_add_u32 s63, s63, s48
  buffer_load_dwordx4 a[160:163], v8, s[4:7], s63 offen offset:0 sc1
  v_mfma_f32_16x16x32_bf16 v[52:55], a[8:11], a[228:231], v[52:55]
  ds_read_b64_tr_b16 a[56:57], v6 offset:41984
  ds_read_b64_tr_b16 a[58:59], v6 offset:46080
  v_mfma_f32_16x16x32_bf16 v[60:63], a[12:15], a[228:231], v[60:63]
  ds_read_b64_tr_b16 a[44:45], v7 offset:33792
  v_mfma_f32_16x16x32_bf16 v[60:63], a[28:31], a[236:239], v[60:63]
  ds_read_b64_tr_b16 a[46:47], v7 offset:37888
  v_mfma_f32_16x16x32_bf16 v[56:59], a[28:31], a[232:235], v[56:59]
  buffer_load_dwordx4 a[164:167], v9, s[4:7], s63 offen offset:0 sc1
  v_mfma_f32_16x16x32_bf16 v[56:59], a[12:15], a[224:227], v[56:59]
  s_waitcnt lgkmcnt(6)
  ds_read_b64_tr_b16 a[60:61], v7 offset:41984
  ds_read_b64_tr_b16 a[62:63], v7 offset:46080
  v_mfma_f32_16x16x32_bf16 v[64:67], a[32:35], a[224:227], v[64:67]
  ds_read_b64_tr_b16 a[0:1], v4 offset:49152
  s_add_u32 m0, s79, 73728
  v_mfma_f32_16x16x32_bf16 v[64:67], a[48:51], a[232:235], v[64:67]
  s_add_u32 s92, s92, 262144
  ds_read_b64_tr_b16 a[2:3], v4 offset:53248
  s_add_u32 s93, s92, s89
  v_mfma_f32_16x16x32_bf16 v[68:71], a[48:51], a[236:239], v[68:71]
  buffer_load_dwordx4 v252, s[80:83], s93 offen lds
  v_mfma_f32_16x16x32_bf16 v[68:71], a[32:35], a[228:231], v[68:71]
  ds_read_b64_tr_b16 a[16:17], v4 offset:57344
  ds_read_b64_tr_b16 a[18:19], v4 offset:61440
  v_mfma_f32_16x16x32_bf16 v[76:79], a[36:39], a[228:231], v[76:79]
  ds_read_b64_tr_b16 a[4:5], v5 offset:49152
  v_mfma_f32_16x16x32_bf16 v[76:79], a[52:55], a[236:239], v[76:79]
  ds_read_b64_tr_b16 a[6:7], v5 offset:53248
  v_mfma_f32_16x16x32_bf16 v[72:75], a[52:55], a[232:235], v[72:75]
  buffer_load_dwordx4 v252, s[84:87], s93 offen offset:1024 lds
  v_mfma_f32_16x16x32_bf16 v[72:75], a[36:39], a[224:227], v[72:75]
  s_waitcnt lgkmcnt(6)
  ds_read_b64_tr_b16 a[20:21], v5 offset:57344
  ds_read_b64_tr_b16 a[22:23], v5 offset:61440
  v_mfma_f32_16x16x32_bf16 v[80:83], a[40:43], a[224:227], v[80:83]
  ds_read_b64_tr_b16 a[8:9], v6 offset:49152
  v_mfma_f32_16x16x32_bf16 v[80:83], a[56:59], a[232:235], v[80:83]
  s_min_u32 s63, s89, 4096
  ds_read_b64_tr_b16 a[10:11], v6 offset:53248
  s_add_u32 s63, s63, s48
  v_mfma_f32_16x16x32_bf16 v[84:87], a[56:59], a[236:239], v[84:87]
  buffer_load_dwordx4 a[168:171], v8, s[4:7], s63 offen offset:1024 sc1
  v_mfma_f32_16x16x32_bf16 v[84:87], a[40:43], a[228:231], v[84:87]
  ds_read_b64_tr_b16 a[24:25], v6 offset:57344
  ds_read_b64_tr_b16 a[26:27], v6 offset:61440
  v_mfma_f32_16x16x32_bf16 v[92:95], a[44:47], a[228:231], v[92:95]
  ds_read_b64_tr_b16 a[12:13], v7 offset:49152
  v_mfma_f32_16x16x32_bf16 v[92:95], a[60:63], a[236:239], v[92:95]
  ds_read_b64_tr_b16 a[14:15], v7 offset:53248
  v_mfma_f32_16x16x32_bf16 v[88:91], a[60:63], a[232:235], v[88:91]
  buffer_load_dwordx4 a[172:175], v9, s[4:7], s63 offen offset:1024 sc1
  v_mfma_f32_16x16x32_bf16 v[88:91], a[44:47], a[224:227], v[88:91]
  s_waitcnt vmcnt(24) lgkmcnt(6)
  ds_read_b64_tr_b16 a[28:29], v7 offset:57344
  ds_read_b64_tr_b16 a[30:31], v7 offset:61440
  v_mfma_f32_16x16x32_bf16 v[32:35], a[0:3], a[240:243], v[32:35]
  ds_read_b64_tr_b16 a[32:33], v4 offset:50176
  s_add_u32 m0, s79, 81920
  v_mfma_f32_16x16x32_bf16 v[32:35], a[16:19], a[248:251], v[32:35]
  s_add_u32 s92, s92, 196608
  ds_read_b64_tr_b16 a[34:35], v4 offset:54272
  s_add_u32 s93, s92, s90
  v_mfma_f32_16x16x32_bf16 v[36:39], a[16:19], a[252:255], v[36:39]
  buffer_load_dwordx4 v252, s[80:83], s93 offen lds
  v_mfma_f32_16x16x32_bf16 v[36:39], a[0:3], a[244:247], v[36:39]
  ds_read_b64_tr_b16 a[48:49], v4 offset:58368
  ds_read_b64_tr_b16 a[50:51], v4 offset:62464
  v_mfma_f32_16x16x32_bf16 v[44:47], a[4:7], a[244:247], v[44:47]
  ds_read_b64_tr_b16 a[36:37], v5 offset:50176
  v_mfma_f32_16x16x32_bf16 v[44:47], a[20:23], a[252:255], v[44:47]
  ds_read_b64_tr_b16 a[38:39], v5 offset:54272
  v_mfma_f32_16x16x32_bf16 v[40:43], a[20:23], a[248:251], v[40:43]
  buffer_load_dwordx4 v252, s[84:87], s93 offen offset:1024 lds
  v_mfma_f32_16x16x32_bf16 v[40:43], a[4:7], a[240:243], v[40:43]
  s_waitcnt lgkmcnt(6)
  ds_read_b64_tr_b16 a[52:53], v5 offset:58368
  ds_read_b64_tr_b16 a[54:55], v5 offset:62464
  v_mfma_f32_16x16x32_bf16 v[48:51], a[8:11], a[240:243], v[48:51]
  ds_read_b64_tr_b16 a[40:41], v6 offset:50176
  v_mfma_f32_16x16x32_bf16 v[48:51], a[24:27], a[248:251], v[48:51]
  s_min_u32 s63, s90, 4096
  ds_read_b64_tr_b16 a[42:43], v6 offset:54272
  s_add_u32 s63, s63, s48
  v_mfma_f32_16x16x32_bf16 v[52:55], a[24:27], a[252:255], v[52:55]
  buffer_load_dwordx4 a[176:179], v8, s[4:7], s63 offen offset:2048 sc1
  v_mfma_f32_16x16x32_bf16 v[52:55], a[8:11], a[244:247], v[52:55]
  ds_read_b64_tr_b16 a[56:57], v6 offset:58368
  ds_read_b64_tr_b16 a[58:59], v6 offset:62464
  v_mfma_f32_16x16x32_bf16 v[60:63], a[12:15], a[244:247], v[60:63]
  ds_read_b64_tr_b16 a[44:45], v7 offset:50176
  v_mfma_f32_16x16x32_bf16 v[60:63], a[28:31], a[252:255], v[60:63]
  ds_read_b64_tr_b16 a[46:47], v7 offset:54272
  v_mfma_f32_16x16x32_bf16 v[56:59], a[28:31], a[248:251], v[56:59]
  buffer_load_dwordx4 a[180:183], v9, s[4:7], s63 offen offset:2048 sc1
  v_mfma_f32_16x16x32_bf16 v[56:59], a[12:15], a[240:243], v[56:59]
  s_waitcnt lgkmcnt(6)
  ds_read_b64_tr_b16 a[60:61], v7 offset:58368
  ds_read_b64_tr_b16 a[62:63], v7 offset:62464
  v_mfma_f32_16x16x32_bf16 v[64:67], a[32:35], a[240:243], v[64:67]
  ds_read_b64_tr_b16 a[0:1], v0 offset:0
  s_add_u32 m0, s79, 90112
  v_mfma_f32_16x16x32_bf16 v[64:67], a[48:51], a[248:251], v[64:67]
  s_add_u32 s92, s92, 262144
  ds_read_b64_tr_b16 a[2:3], v0 offset:4096
  s_add_u32 s93, s92, s91
  v_mfma_f32_16x16x32_bf16 v[68:71], a[48:51], a[252:255], v[68:71]
  buffer_load_dwordx4 v252, s[80:83], s93 offen lds
  v_mfma_f32_16x16x32_bf16 v[68:71], a[32:35], a[244:247], v[68:71]
  ds_read_b64_tr_b16 a[16:17], v0 offset:8192
  ds_read_b64_tr_b16 a[18:19], v0 offset:12288
  v_mfma_f32_16x16x32_bf16 v[76:79], a[36:39], a[244:247], v[76:79]
  ds_read_b64_tr_b16 a[4:5], v1 offset:0
  v_mfma_f32_16x16x32_bf16 v[76:79], a[52:55], a[252:255], v[76:79]
  ds_read_b64_tr_b16 a[6:7], v1 offset:4096
  v_mfma_f32_16x16x32_bf16 v[72:75], a[52:55], a[248:251], v[72:75]
  buffer_load_dwordx4 v252, s[84:87], s93 offen offset:1024 lds
  v_mfma_f32_16x16x32_bf16 v[72:75], a[36:39], a[240:243], v[72:75]
  s_waitcnt lgkmcnt(6)
  ds_read_b64_tr_b16 a[20:21], v1 offset:8192
  ds_read_b64_tr_b16 a[22:23], v1 offset:12288
  v_mfma_f32_16x16x32_bf16 v[80:83], a[40:43], a[240:243], v[80:83]
  ds_read_b64_tr_b16 a[8:9], v2 offset:0
  v_mfma_f32_16x16x32_bf16 v[80:83], a[56:59], a[248:251], v[80:83]
  s_min_u32 s63, s91, 4096
  ds_read_b64_tr_b16 a[10:11], v2 offset:4096
  s_add_u32 s63, s63, s48
  v_mfma_f32_16x16x32_bf16 v[84:87], a[56:59], a[252:255], v[84:87]
  buffer_load_dwordx4 a[184:187], v8, s[4:7], s63 offen offset:3072 sc1
  v_mfma_f32_16x16x32_bf16 v[84:87], a[40:43], a[244:247], v[84:87]
  ds_read_b64_tr_b16 a[24:25], v2 offset:8192
  ds_read_b64_tr_b16 a[26:27], v2 offset:12288
  v_mfma_f32_16x16x32_bf16 v[92:95], a[44:47], a[244:247], v[92:95]
  ds_read_b64_tr_b16 a[12:13], v3 offset:0
  v_mfma_f32_16x16x32_bf16 v[92:95], a[60:63], a[252:255], v[92:95]
  s_sub_u32 s56, s56, 1
  ds_read_b64_tr_b16 a[14:15], v3 offset:4096
  v_mfma_f32_16x16x32_bf16 v[88:91], a[60:63], a[248:251], v[88:91]
  s_cmp_lg_u32 s56, 0
  buffer_load_dwordx4 a[188:191], v9, s[4:7], s63 offen offset:3072 sc1
  ds_read_b64_tr_b16 a[28:29], v3 offset:8192
  v_mfma_f32_16x16x32_bf16 v[88:91], a[44:47], a[240:243], v[88:91]
  ds_read_b64_tr_b16 a[30:31], v3 offset:12288
  s_cbranch_scc1 Lp4_loop
Lmk_Lp4_loop_tail:
  s_waitcnt vmcnt(24) lgkmcnt(8)
  v_mfma_f32_16x16x32_bf16 v[32:35], a[0:3], a[128:131], v[32:35]
  s_waitcnt vmcnt(26)
  s_barrier
  ds_read_b64_tr_b16 a[32:33], v0 offset:1024
  s_add_u32 m0, s79, 98304
  s_add_u32 s92, s92, 196608
  s_cmp_lg_u32 s88, 0
  s_cselect_b32 s93, -2686976, 0
  s_cselect_b32 s43, s78, 0
  v_mfma_f32_16x16x32_bf16 v[32:35], a[16:19], a[136:139], v[32:35]
  s_add_u32 s93, s93, s43
  ds_read_b64_tr_b16 a[34:35], v0 offset:5120
  s_add_u32 s93, s93, s92
  v_mfma_f32_16x16x32_bf16 v[36:39], a[16:19], a[140:143], v[36:39]
  buffer_load_dwordx4 v252, s[80:83], s93 offen lds
  v_mfma_f32_16x16x32_bf16 v[36:39], a[0:3], a[132:135], v[36:39]
  ds_read_b64_tr_b16 a[48:49], v0 offset:9216
  ds_read_b64_tr_b16 a[50:51], v0 offset:13312
  v_mfma_f32_16x16x32_bf16 v[44:47], a[4:7], a[132:135], v[44:47]
  ds_read_b64_tr_b16 a[36:37], v1 offset:1024
  v_mfma_f32_16x16x32_bf16 v[44:47], a[20:23], a[140:143], v[44:47]
  ds_read_b64_tr_b16 a[38:39], v1 offset:5120
  v_mfma_f32_16x16x32_bf16 v[40:43], a[20:23], a[136:139], v[40:43]
  buffer_load_dwordx4 v252, s[84:87], s93 offen offset:1024 lds
  v_mfma_f32_16x16x32_bf16 v[40:43], a[4:7], a[128:131], v[40:43]
  s_waitcnt lgkmcnt(6)
  ds_read_b64_tr_b16 a[52:53], v1 offset:9216
  ds_read_b64_tr_b16 a[54:55], v1 offset:13312
  v_mfma_f32_16x16x32_bf16 v[48:51], a[8:11], a[128:131], v[48:51]
  ds_read_b64_tr_b16 a[40:41], v2 offset:1024
  v_mfma_f32_16x16x32_bf16 v[48:51], a[24:27], a[136:139], v[48:51]
  s_add_u32 s48, s48, 4096
  ds_read_b64_tr_b16 a[42:43], v2 offset:5120
  s_min_u32 s63, s88, 4096
  v_mfma_f32_16x16x32_bf16 v[52:55], a[24:27], a[140:143], v[52:55]
  s_add_u32 s63, s63, s48
  buffer_load_dwordx4 a[192:195], v8, s[4:7], s63 offen offset:0 sc1
  v_mfma_f32_16x16x32_bf16 v[52:55], a[8:11], a[132:135], v[52:55]
  ds_read_b64_tr_b16 a[56:57], v2 offset:9216
  ds_read_b64_tr_b16 a[58:59], v2 offset:13312
  v_mfma_f32_16x16x32_bf16 v[60:63], a[12:15], a[132:135], v[60:63]
  ds_read_b64_tr_b16 a[44:45], v3 offset:1024
  v_mfma_f32_16x16x32_bf16 v[60:63], a[28:31], a[140:143], v[60:63]
  ds_read_b64_tr_b16 a[46:47], v3 offset:5120
  v_mfma_f32_16x16x32_bf16 v[56:59], a[28:31], a[136:139], v[56:59]
  buffer_load_dwordx4 a[196:199], v9, s[4:7], s63 offen offset:0 sc1
  v_mfma_f32_16x16x32_bf16 v[56:59], a[12:15], a[128:131], v[56:59]
  s_waitcnt lgkmcnt(6)
  ds_read_b64_tr_b16 a[60:61], v3 offset:9216
  ds_read_b64_tr_b16 a[62:63], v3 offset:13312
  v_mfma_f32_16x16x32_bf16 v[64:67], a[32:35], a[128:131], v[64:67]
  s_add_u32 m0, s79, 106496
  ds_read_b64_tr_b16 a[0:1], v0 offset:16384
  s_add_u32 s92, s92, 262144
  s_cmp_lg_u32 s89, 0
  s_cselect_b32 s93, -2490368, 0
  s_cselect_b32 s43, s78, 0
  v_mfma_f32_16x16x32_bf16 v[64:67], a[48:51], a[136:139], v[64:67]
  s_add_u32 s93, s93, s43
  ds_read_b64_tr_b16 a[2:3], v0 offset:20480
  s_add_u32 s93, s93, s92
  v_mfma_f32_16x16x32_bf16 v[68:71], a[48:51], a[140:143], v[68:71]
  buffer_load_dwordx4 v252, s[80:83], s93 offen lds
  v_mfma_f32_16x16x32_bf16 v[68:71], a[32:35], a[132:135], v[68:71]
  ds_read_b64_tr_b16 a[16:17], v0 offset:24576
  ds_read_b64_tr_b16 a[18:19], v0 offset:28672
  v_mfma_f32_16x16x32_bf16 v[76:79], a[36:39], a[132:135], v[76:79]
  ds_read_b64_tr_b16 a[4:5], v1 offset:16384
  v_mfma_f32_16x16x32_bf16 v[76:79], a[52:55], a[140:143], v[76:79]
  ds_read_b64_tr_b16 a[6:7], v1 offset:20480
  v_mfma_f32_16x16x32_bf16 v[72:75], a[52:55], a[136:139], v[72:75]
  buffer_load_dwordx4 v252, s[84:87], s93 offen offset:1024 lds
  v_mfma_f32_16x16x32_bf16 v[72:75], a[36:39], a[128:131], v[72:75]
  s_waitcnt lgkmcnt(6)
  ds_read_b64_tr_b16 a[20:21], v1 offset:24576
  ds_read_b64_tr_b16 a[22:23], v1 offset:28672
  v_mfma_f32_16x16x32_bf16 v[80:83], a[40:43], a[128:131], v[80:83]
  ds_read_b64_tr_b16 a[8:9], v2 offset:16384
  v_mfma_f32_16x16x32_bf16 v[80:83], a[56:59], a[136:139], v[80:83]
  s_min_u32 s63, s89, 4096
  ds_read_b64_tr_b16 a[10:11], v2 offset:20480
  s_add_u32 s63, s63, s48
  v_mfma_f32_16x16x32_bf16 v[84:87], a[56:59], a[140:143], v[84:87]
  buffer_load_dwordx4 a[200:203], v8, s[4:7], s63 offen offset:1024 sc1
  v_mfma_f32_16x16x32_bf16 v[84:87], a[40:43], a[132:135], v[84:87]
  ds_read_b64_tr_b16 a[24:25], v2 offset:24576
  ds_read_b64_tr_b16 a[26:27], v2 offset:28672
  v_mfma_f32_16x16x32_bf16 v[92:95], a[44:47], a[132:135], v[92:95]
  ds_read_b64_tr_b16 a[12:13], v3 offset:16384
  v_mfma_f32_16x16x32_bf16 v[92:95], a[60:63], a[140:143], v[92:95]
  ds_read_b64_tr_b16 a[14:15], v3 offset:20480
  v_mfma_f32_16x16x32_bf16 v[88:91], a[60:63], a[136:139], v[88:91]
  buffer_load_dwordx4 a[204:207], v9, s[4:7], s63 offen offset:1024 sc1
  v_mfma_f32_16x16x32_bf16 v[88:91], a[44:47], a[128:131], v[88:91]
  s_waitcnt vmcnt(24) lgkmcnt(6)
  ds_read_b64_tr_b16 a[28:29], v3 offset:24576
  ds_read_b64_tr_b16 a[30:31], v3 offset:28672
  v_mfma_f32_16x16x32_bf16 v[32:35], a[0:3], a[144:147], v[32:35]
  s_add_u32 m0, s79, 114688
  ds_read_b64_tr_b16 a[32:33], v0 offset:17408
  s_add_u32 s92, s92, 196608
  s_cmp_lg_u32 s90, 0
  s_cselect_b32 s93, -2228224, 0
  s_cselect_b32 s43, s78, 0
  v_mfma_f32_16x16x32_bf16 v[32:35], a[16:19], a[152:155], v[32:35]
  s_add_u32 s93, s93, s43
  ds_read_b64_tr_b16 a[34:35], v0 offset:21504
  s_add_u32 s93, s93, s92
  v_mfma_f32_16x16x32_bf16 v[36:39], a[16:19], a[156:159], v[36:39]
  buffer_load_dwordx4 v252, s[80:83], s93 offen lds
  v_mfma_f32_16x16x32_bf16 v[36:39], a[0:3], a[148:151], v[36:39]
  ds_read_b64_tr_b16 a[48:49], v0 offset:25600
  ds_read_b64_tr_b16 a[50:51], v0 offset:29696
  v_mfma_f32_16x16x32_bf16 v[44:47], a[4:7], a[148:151], v[44:47]
  ds_read_b64_tr_b16 a[36:37], v1 offset:17408
  v_mfma_f32_16x16x32_bf16 v[44:47], a[20:23], a[156:159], v[44:47]
  ds_read_b64_tr_b16 a[38:39], v1 offset:21504
  v_mfma_f32_16x16x32_bf16 v[40:43], a[20:23], a[152:155], v[40:43]
  buffer_load_dwordx4 v252, s[84:87], s93 offen offset:1024 lds
  v_mfma_f32_16x16x32_bf16 v[40:43], a[4:7], a[144:147], v[40:43]
  s_waitcnt lgkmcnt(6)
  ds_read_b64_tr_b16 a[52:53], v1 offset:25600
  ds_read_b64_tr_b16 a[54:55], v1 offset:29696
  v_mfma_f32_16x16x32_bf16 v[48:51], a[8:11], a[144:147], v[48:51]
  ds_read_b64_tr_b16 a[40:41], v2 offset:17408
  v_mfma_f32_16x16x32_bf16 v[48:51], a[24:27], a[152:155], v[48:51]
  s_min_u32 s63, s90, 4096
  ds_read_b64_tr_b16 a[42:43], v2 offset:21504
  s_add_u32 s63, s63, s48
  v_mfma_f32_16x16x32_bf16 v[52:55], a[24:27], a[156:159], v[52:55]
  buffer_load_dwordx4 a[208:211], v8, s[4:7], s63 offen offset:2048 sc1
  v_mfma_f32_16x16x32_bf16 v[52:55], a[8:11], a[148:151], v[52:55]
  ds_read_b64_tr_b16 a[56:57], v2 offset:25600
  ds_read_b64_tr_b16 a[58:59], v2 offset:29696
  v_mfma_f32_16x16x32_bf16 v[60:63], a[12:15], a[148:151], v[60:63]
  ds_read_b64_tr_b16 a[44:45], v3 offset:17408
  v_mfma_f32_16x16x32_bf16 v[60:63], a[28:31], a[156:159], v[60:63]
  ds_read_b64_tr_b16 a[46:47], v3 offset:21504
  v_mfma_f32_16x16x32_bf16 v[56:59], a[28:31], a[152:155], v[56:59]
  buffer_load_dwordx4 a[212:215], v9, s[4:7], s63 offen offset:2048 sc1
  v_mfma_f32_16x16x32_bf16 v[56:59], a[12:15], a[144:147], v[56:59]
  s_waitcnt lgkmcnt(6)
  ds_read_b64_tr_b16 a[60:61], v3 offset:25600
  ds_read_b64_tr_b16 a[62:63], v3 offset:29696
  v_mfma_f32_16x16x32_bf16 v[64:67], a[32:35], a[144:147], v[64:67]
  s_add_u32 m0, s79, 122880
  ds_read_b64_tr_b16 a[0:1], v0 offset:32768
  s_add_u32 s92, s92, 262144
  s_cmp_lg_u32 s91, 0
  s_cselect_b32 s93, -2031616, 0
  s_cselect_b32 s43, s78, 0
  v_mfma_f32_16x16x32_bf16 v[64:67], a[48:51], a[152:155], v[64:67]
  s_add_u32 s93, s93, s43
  ds_read_b64_tr_b16 a[2:3], v0 offset:36864
  s_add_u32 s93, s93, s92
  v_mfma_f32_16x16x32_bf16 v[68:71], a[48:51], a[156:159], v[68:71]
  buffer_load_dwordx4 v252, s[80:83], s93 offen lds
  v_mfma_f32_16x16x32_bf16 v[68:71], a[32:35], a[148:151], v[68:71]
  ds_read_b64_tr_b16 a[16:17], v0 offset:40960
  ds_read_b64_tr_b16 a[18:19], v0 offset:45056
  v_mfma_f32_16x16x32_bf16 v[76:79], a[36:39], a[148:151], v[76:79]
  ds_read_b64_tr_b16 a[4:5], v1 offset:32768
  v_mfma_f32_16x16x32_bf16 v[76:79], a[52:55], a[156:159], v[76:79]
  ds_read_b64_tr_b16 a[6:7], v1 offset:36864
  v_mfma_f32_16x16x32_bf16 v[72:75], a[52:55], a[152:155], v[72:75]
  buffer_load_dwordx4 v252, s[84:87], s93 offen offset:1024 lds
  v_mfma_f32_16x16x32_bf16 v[72:75], a[36:39], a[144:147], v[72:75]
  s_waitcnt lgkmcnt(6)
  ds_read_b64_tr_b16 a[20:21], v1 offset:40960
  ds_read_b64_tr_b16 a[22:23], v1 offset:45056
  v_mfma_f32_16x16x32_bf16 v[80:83], a[40:43], a[144:147], v[80:83]
  ds_read_b64_tr_b16 a[8:9], v2 offset:32768
  v_mfma_f32_16x16x32_bf16 v[80:83], a[56:59], a[152:155], v[80:83]
  s_min_u32 s63, s91, 4096
  ds_read_b64_tr_b16 a[10:11], v2 offset:36864
  s_add_u32 s63, s63, s48
  v_mfma_f32_16x16x32_bf16 v[84:87], a[56:59], a[156:159], v[84:87]
  buffer_load_dwordx4 a[216:219], v8, s[4:7], s63 offen offset:3072 sc1
  v_mfma_f32_16x16x32_bf16 v[84:87], a[40:43], a[148:151], v[84:87]
  ds_read_b64_tr_b16 a[24:25], v2 offset:40960
  ds_read_b64_tr_b16 a[26:27], v2 offset:45056
  v_mfma_f32_16x16x32_bf16 v[92:95], a[44:47], a[148:151], v[92:95]
  ds_read_b64_tr_b16 a[12:13], v3 offset:32768
  v_mfma_f32_16x16x32_bf16 v[92:95], a[60:63], a[156:159], v[92:95]
  ds_read_b64_tr_b16 a[14:15], v3 offset:36864
  v_mfma_f32_16x16x32_bf16 v[88:91], a[60:63], a[152:155], v[88:91]
  buffer_load_dwordx4 a[220:223], v9, s[4:7], s63 offen offset:3072 sc1
  v_mfma_f32_16x16x32_bf16 v[88:91], a[44:47], a[144:147], v[88:91]
  s_waitcnt vmcnt(24) lgkmcnt(6)
  ds_read_b64_tr_b16 a[28:29], v3 offset:40960
  ds_read_b64_tr_b16 a[30:31], v3 offset:45056
  v_mfma_f32_16x16x32_bf16 v[32:35], a[0:3], a[160:163], v[32:35]
  s_waitcnt vmcnt(26)
  s_barrier
  ds_read_b64_tr_b16 a[32:33], v0 offset:33792
  s_add_u32 m0, s79, 0
  s_add_u32 s92, s92, -3407872
  s_add_u32 s92, s92, s78
  s_cmp_lg_u32 s88, 0
  v_mfma_f32_16x16x32_bf16 v[32:35], a[16:19], a[168:171], v[32:35]
  s_cselect_b32 s93, 1835008, 0
  ds_read_b64_tr_b16 a[34:35], v0 offset:37888
  s_add_u32 s93, s93, s92
  v_mfma_f32_16x16x32_bf16 v[36:39], a[16:19], a[172:175], v[36:39]
  buffer_load_dwordx4 v252, s[80:83], s93 offen lds
  v_mfma_f32_16x16x32_bf16 v[36:39], a[0:3], a[164:167], v[36:39]
  ds_read_b64_tr_b16 a[48:49], v0 offset:41984
  ds_read_b64_tr_b16 a[50:51], v0 offset:46080
  v_mfma_f32_16x16x32_bf16 v[44:47], a[4:7], a[164:167], v[44:47]
  ds_read_b64_tr_b16 a[36:37], v1 offset:33792
  v_mfma_f32_16x16x32_bf16 v[44:47], a[20:23], a[172:175], v[44:47]
  ds_read_b64_tr_b16 a[38:39], v1 offset:37888
  v_mfma_f32_16x16x32_bf16 v[40:43], a[20:23], a[168:171], v[40:43]
  buffer_load_dwordx4 v252, s[84:87], s93 offen offset:1024 lds
  v_mfma_f32_16x16x32_bf16 v[40:43], a[4:7], a[160:163], v[40:43]
  s_waitcnt lgkmcnt(6)
  ds_read_b64_tr_b16 a[52:53], v1 offset:41984
  ds_read_b64_tr_b16 a[54:55], v1 offset:46080
  v_mfma_f32_16x16x32_bf16 v[48:51], a[8:11], a[160:163], v[48:51]
  ds_read_b64_tr_b16 a[40:41], v2 offset:33792
  v_mfma_f32_16x16x32_bf16 v[48:51], a[24:27], a[168:171], v[48:51]
  s_add_u32 s48, s48, 4096
  ds_read_b64_tr_b16 a[42:43], v2 offset:37888
  s_min_u32 s63, s88, 4096
  v_mfma_f32_16x16x32_bf16 v[52:55], a[24:27], a[172:175], v[52:55]
  s_add_u32 s63, s63, s48
  buffer_load_dwordx4 a[224:227], v8, s[4:7], s63 offen offset:0 sc1
  v_mfma_f32_16x16x32_bf16 v[52:55], a[8:11], a[164:167], v[52:55]
  ds_read_b64_tr_b16 a[56:57], v2 offset:41984
  ds_read_b64_tr_b16 a[58:59], v2 offset:46080
  v_mfma_f32_16x16x32_bf16 v[60:63], a[12:15], a[164:167], v[60:63]
  ds_read_b64_tr_b16 a[44:45], v3 offset:33792
  v_mfma_f32_16x16x32_bf16 v[60:63], a[28:31], a[172:175], v[60:63]
  ds_read_b64_tr_b16 a[46:47], v3 offset:37888
  v_mfma_f32_16x16x32_bf16 v[56:59], a[28:31], a[168:171], v[56:59]
  buffer_load_dwordx4 a[228:231], v9, s[4:7], s63 offen offset:0 sc1
  v_mfma_f32_16x16x32_bf16 v[56:59], a[12:15], a[160:163], v[56:59]
  s_waitcnt lgkmcnt(6)
  ds_read_b64_tr_b16 a[60:61], v3 offset:41984
  ds_read_b64_tr_b16 a[62:63], v3 offset:46080
  v_mfma_f32_16x16x32_bf16 v[64:67], a[32:35], a[160:163], v[64:67]
  s_add_u32 m0, s79, 8192
  ds_read_b64_tr_b16 a[0:1], v0 offset:49152
  s_add_u32 s92, s92, 458752
  s_cmp_lg_u32 s89, 0
  v_mfma_f32_16x16x32_bf16 v[64:67], a[48:51], a[168:171], v[64:67]
  s_cselect_b32 s93, 1835008, 0
  ds_read_b64_tr_b16 a[2:3], v0 offset:53248
  s_add_u32 s93, s93, s92
  v_mfma_f32_16x16x32_bf16 v[68:71], a[48:51], a[172:175], v[68:71]
  buffer_load_dwordx4 v252, s[80:83], s93 offen lds
  v_mfma_f32_16x16x32_bf16 v[68:71], a[32:35], a[164:167], v[68:71]
  ds_read_b64_tr_b16 a[16:17], v0 offset:57344
  ds_read_b64_tr_b16 a[18:19], v0 offset:61440
  v_mfma_f32_16x16x32_bf16 v[76:79], a[36:39], a[164:167], v[76:79]
  ds_read_b64_tr_b16 a[4:5], v1 offset:49152
  v_mfma_f32_16x16x32_bf16 v[76:79], a[52:55], a[172:175], v[76:79]
  ds_read_b64_tr_b16 a[6:7], v1 offset:53248
  v_mfma_f32_16x16x32_bf16 v[72:75], a[52:55], a[168:171], v[72:75]
  buffer_load_dwordx4 v252, s[84:87], s93 offen offset:1024 lds
  v_mfma_f32_16x16x32_bf16 v[72:75], a[36:39], a[160:163], v[72:75]
  s_waitcnt lgkmcnt(6)
  ds_read_b64_tr_b16 a[20:21], v1 offset:57344
  ds_read_b64_tr_b16 a[22:23], v1 offset:61440
  v_mfma_f32_16x16x32_bf16 v[80:83], a[40:43], a[160:163], v[80:83]
  ds_read_b64_tr_b16 a[8:9], v2 offset:49152
  v_mfma_f32_16x16x32_bf16 v[80:83], a[56:59], a[168:171], v[80:83]
  s_min_u32 s63, s89, 4096
  ds_read_b64_tr_b16 a[10:11], v2 offset:53248
  s_add_u32 s63, s63, s48
  v_mfma_f32_16x16x32_bf16 v[84:87], a[56:59], a[172:175], v[84:87]
  buffer_load_dwordx4 a[232:235], v8, s[4:7], s63 offen offset:1024 sc1
  v_mfma_f32_16x16x32_bf16 v[84:87], a[40:43], a[164:167], v[84:87]
  ds_read_b64_tr_b16 a[24:25], v2 offset:57344
  ds_read_b64_tr_b16 a[26:27], v2 offset:61440
  v_mfma_f32_16x16x32_bf16 v[92:95], a[44:47], a[164:167], v[92:95]
  ds_read_b64_tr_b16 a[12:13], v3 offset:49152
  v_mfma_f32_16x16x32_bf16 v[92:95], a[60:63], a[172:175], v[92:95]
  ds_read_b64_tr_b16 a[14:15], v3 offset:53248
  v_mfma_f32_16x16x32_bf16 v[88:91], a[60:63], a[168:171], v[88:91]
  buffer_load_dwordx4 a[236:239], v9, s[4:7], s63 offen offset:1024 sc1
  v_mfma_f32_16x16x32_bf16 v[88:91], a[44:47], a[160:163], v[88:91]
  s_waitcnt vmcnt(24) lgkmcnt(6)
  ds_read_b64_tr_b16 a[28:29], v3 offset:57344
  ds_read_b64_tr_b16 a[30:31], v3 offset:61440
  v_mfma_f32_16x16x32_bf16 v[32:35], a[0:3], a[176:179], v[32:35]
  s_add_u32 m0, s79, 16384
  ds_read_b64_tr_b16 a[32:33], v0 offset:50176
  s_add_u32 s92, s92, 458752
  s_cmp_lg_u32 s90, 0
  v_mfma_f32_16x16x32_bf16 v[32:35], a[16:19], a[184:187], v[32:35]
  s_cselect_b32 s93, 1835008, 0
  ds_read_b64_tr_b16 a[34:35], v0 offset:54272
  s_add_u32 s93, s93, s92
  v_mfma_f32_16x16x32_bf16 v[36:39], a[16:19], a[188:191], v[36:39]
  buffer_load_dwordx4 v252, s[80:83], s93 offen lds
  v_mfma_f32_16x16x32_bf16 v[36:39], a[0:3], a[180:183], v[36:39]
  ds_read_b64_tr_b16 a[48:49], v0 offset:58368
  ds_read_b64_tr_b16 a[50:51], v0 offset:62464
  v_mfma_f32_16x16x32_bf16 v[44:47], a[4:7], a[180:183], v[44:47]
  ds_read_b64_tr_b16 a[36:37], v1 offset:50176
  v_mfma_f32_16x16x32_bf16 v[44:47], a[20:23], a[188:191], v[44:47]
  ds_read_b64_tr_b16 a[38:39], v1 offset:54272
  v_mfma_f32_16x16x32_bf16 v[40:43], a[20:23], a[184:187], v[40:43]
  buffer_load_dwordx4 v252, s[84:87], s93 offen offset:1024 lds
  v_mfma_f32_16x16x32_bf16 v[40:43], a[4:7], a[176:179], v[40:43]
  s_waitcnt lgkmcnt(6)
  ds_read_b64_tr_b16 a[52:53], v1 offset:58368
  ds_read_b64_tr_b16 a[54:55], v1 offset:62464
  v_mfma_f32_16x16x32_bf16 v[48:51], a[8:11], a[176:179], v[48:51]
  ds_read_b64_tr_b16 a[40:41], v2 offset:50176
  v_mfma_f32_16x16x32_bf16 v[48:51], a[24:27], a[184:187], v[48:51]
  s_min_u32 s63, s90, 4096
  ds_read_b64_tr_b16 a[42:43], v2 offset:54272
  s_add_u32 s63, s63, s48
  v_mfma_f32_16x16x32_bf16 v[52:55], a[24:27], a[188:191], v[52:55]
  buffer_load_dwordx4 a[240:243], v8, s[4:7], s63 offen offset:2048 sc1
  v_mfma_f32_16x16x32_bf16 v[52:55], a[8:11], a[180:183], v[52:55]
  ds_read_b64_tr_b16 a[56:57], v2 offset:58368
  ds_read_b64_tr_b16 a[58:59], v2 offset:62464
  v_mfma_f32_16x16x32_bf16 v[60:63], a[12:15], a[180:183], v[60:63]
  ds_read_b64_tr_b16 a[44:45], v3 offset:50176
  v_mfma_f32_16x16x32_bf16 v[60:63], a[28:31], a[188:191], v[60:63]
  ds_read_b64_tr_b16 a[46:47], v3 offset:54272
  v_mfma_f32_16x16x32_bf16 v[56:59], a[28:31], a[184:187], v[56:59]
  buffer_load_dwordx4 a[244:247], v9, s[4:7], s63 offen offset:2048 sc1
  v_mfma_f32_16x16x32_bf16 v[56:59], a[12:15], a[176:179], v[56:59]
  s_waitcnt lgkmcnt(6)
  ds_read_b64_tr_b16 a[60:61], v3 offset:58368
  ds_read_b64_tr_b16 a[62:63], v3 offset:62464
  v_mfma_f32_16x16x32_bf16 v[64:67], a[32:35], a[176:179], v[64:67]
  s_add_u32 m0, s79, 24576
  ds_read_b64_tr_b16 a[0:1], v4 offset:0
  s_add_u32 s92, s92, 458752
  s_cmp_lg_u32 s91, 0
  v_mfma_f32_16x16x32_bf16 v[64:67], a[48:51], a[184:187], v[64:67]
  s_cselect_b32 s93, 1835008, 0
  ds_read_b64_tr_b16 a[2:3], v4 offset:4096
  s_add_u32 s93, s93, s92
  v_mfma_f32_16x16x32_bf16 v[68:71], a[48:51], a[188:191], v[68:71]
  buffer_load_dwordx4 v252, s[80:83], s93 offen lds
  v_mfma_f32_16x16x32_bf16 v[68:71], a[32:35], a[180:183], v[68:71]
  ds_read_b64_tr_b16 a[16:17], v4 offset:8192
  ds_read_b64_tr_b16 a[18:19], v4 offset:12288
  v_mfma_f32_16x16x32_bf16 v[76:79], a[36:39], a[180:183], v[76:79]
  ds_read_b64_tr_b16 a[4:5], v5 offset:0
  v_mfma_f32_16x16x32_bf16 v[76:79], a[52:55], a[188:191], v[76:79]
  ds_read_b64_tr_b16 a[6:7], v5 offset:4096
  v_mfma_f32_16x16x32_bf16 v[72:75], a[52:55], a[184:187], v[72:75]
  buffer_load_dwordx4 v252, s[84:87], s93 offen offset:1024 lds
  v_mfma_f32_16x16x32_bf16 v[72:75], a[36:39], a[176:179], v[72:75]
  s_waitcnt lgkmcnt(6)
  ds_read_b64_tr_b16 a[20:21], v5 offset:8192
  ds_read_b64_tr_b16 a[22:23], v5 offset:12288
  v_mfma_f32_16x16x32_bf16 v[80:83], a[40:43], a[176:179], v[80:83]
  ds_read_b64_tr_b16 a[8:9], v6 offset:0
  v_mfma_f32_16x16x32_bf16 v[80:83], a[56:59], a[184:187], v[80:83]
  s_min_u32 s63, s91, 4096
  ds_read_b64_tr_b16 a[10:11], v6 offset:4096
  s_add_u32 s63, s63, s48
  v_mfma_f32_16x16x32_bf16 v[84:87], a[56:59], a[188:191], v[84:87]
  buffer_load_dwordx4 a[248:251], v8, s[4:7], s63 offen offset:3072 sc1
  v_mfma_f32_16x16x32_bf16 v[84:87], a[40:43], a[180:183], v[84:87]
  ds_read_b64_tr_b16 a[24:25], v6 offset:8192
  ds_read_b64_tr_b16 a[26:27], v6 offset:12288
  v_mfma_f32_16x16x32_bf16 v[92:95], a[44:47], a[180:183], v[92:95]
  ds_read_b64_tr_b16 a[12:13], v7 offset:0
  v_mfma_f32_16x16x32_bf16 v[92:95], a[60:63], a[188:191], v[92:95]
  ds_read_b64_tr_b16 a[14:15], v7 offset:4096
  v_mfma_f32_16x16x32_bf16 v[88:91], a[60:63], a[184:187], v[88:91]
  buffer_load_dwordx4 a[252:255], v9, s[4:7], s63 offen offset:3072 sc1
  v_mfma_f32_16x16x32_bf16 v[88:91], a[44:47], a[176:179], v[88:91]
  s_waitcnt vmcnt(24) lgkmcnt(6)
  ds_read_b64_tr_b16 a[28:29], v7 offset:8192
  ds_read_b64_tr_b16 a[30:31], v7 offset:12288
  v_mfma_f32_16x16x32_bf16 v[32:35], a[0:3], a[192:195], v[32:35]
  s_waitcnt vmcnt(26)
  s_barrier
  ds_read_b64_tr_b16 a[32:33], v4 offset:1024
  s_add_u32 m0, s79, 32768
  s_add_u32 s92, s92, 458752
  s_cmp_lg_u32 s88, 0
  s_cselect_b32 s93, -2031616, 0
  s_cselect_b32 s43, s78, 0
  v_mfma_f32_16x16x32_bf16 v[32:35], a[16:19], a[200:203], v[32:35]
  s_sub_u32 s93, s93, s43
  ds_read_b64_tr_b16 a[34:35], v4 offset:5120
  s_add_u32 s93, s93, s92
  v_mfma_f32_16x16x32_bf16 v[36:39], a[16:19], a[204:207], v[36:39]
  buffer_load_dwordx4 v252, s[80:83], s93 offen lds
  v_mfma_f32_16x16x32_bf16 v[36:39], a[0:3], a[196:199], v[36:39]
  ds_read_b64_tr_b16 a[48:49], v4 offset:9216
  ds_read_b64_tr_b16 a[50:51], v4 offset:13312
  v_mfma_f32_16x16x32_bf16 v[44:47], a[4:7], a[196:199], v[44:47]
  ds_read_b64_tr_b16 a[36:37], v5 offset:1024
  v_mfma_f32_16x16x32_bf16 v[44:47], a[20:23], a[204:207], v[44:47]
  ds_read_b64_tr_b16 a[38:39], v5 offset:5120
  v_mfma_f32_16x16x32_bf16 v[40:43], a[20:23], a[200:203], v[40:43]
  buffer_load_dwordx4 v252, s[84:87], s93 offen offset:1024 lds
  v_mfma_f32_16x16x32_bf16 v[40:43], a[4:7], a[192:195], v[40:43]
  s_waitcnt lgkmcnt(6)
  ds_read_b64_tr_b16 a[52:53], v5 offset:9216
  ds_read_b64_tr_b16 a[54:55], v5 offset:13312
  v_mfma_f32_16x16x32_bf16 v[48:51], a[8:11], a[192:195], v[48:51]
  ds_read_b64_tr_b16 a[40:41], v6 offset:1024
  v_mfma_f32_16x16x32_bf16 v[48:51], a[24:27], a[200:203], v[48:51]
  s_add_u32 s48, s48, 4096
  ds_read_b64_tr_b16 a[42:43], v6 offset:5120
  s_min_u32 s63, s88, 4096
  v_mfma_f32_16x16x32_bf16 v[52:55], a[24:27], a[204:207], v[52:55]
  s_add_u32 s63, s63, s48
  buffer_load_dwordx4 a[128:131], v8, s[4:7], s63 offen offset:0 sc1
  v_mfma_f32_16x16x32_bf16 v[52:55], a[8:11], a[196:199], v[52:55]
  ds_read_b64_tr_b16 a[56:57], v6 offset:9216
  ds_read_b64_tr_b16 a[58:59], v6 offset:13312
  v_mfma_f32_16x16x32_bf16 v[60:63], a[12:15], a[196:199], v[60:63]
  ds_read_b64_tr_b16 a[44:45], v7 offset:1024
  v_mfma_f32_16x16x32_bf16 v[60:63], a[28:31], a[204:207], v[60:63]
  ds_read_b64_tr_b16 a[46:47], v7 offset:5120
  v_mfma_f32_16x16x32_bf16 v[56:59], a[28:31], a[200:203], v[56:59]
  buffer_load_dwordx4 a[132:135], v9, s[4:7], s63 offen offset:0 sc1
  v_mfma_f32_16x16x32_bf16 v[56:59], a[12:15], a[192:195], v[56:59]
  s_waitcnt lgkmcnt(6)
  ds_read_b64_tr_b16 a[60:61], v7 offset:9216
  ds_read_b64_tr_b16 a[62:63], v7 offset:13312
  v_mfma_f32_16x16x32_bf16 v[64:67], a[32:35], a[192:195], v[64:67]
  s_add_u32 m0, s79, 40960
  ds_read_b64_tr_b16 a[0:1], v4 offset:16384
  s_add_u32 s92, s92, 458752
  s_cmp_lg_u32 s89, 0
  s_cselect_b32 s93, -2228224, 0
  s_cselect_b32 s43, s78, 0
  v_mfma_f32_16x16x32_bf16 v[64:67], a[48:51], a[200:203], v[64:67]
  s_sub_u32 s93, s93, s43
  ds_read_b64_tr_b16 a[2:3], v4 offset:20480
  s_add_u32 s93, s93, s92
  v_mfma_f32_16x16x32_bf16 v[68:71], a[48:51], a[204:207], v[68:71]
  buffer_load_dwordx4 v252, s[80:83], s93 offen lds
  v_mfma_f32_16x16x32_bf16 v[68:71], a[32:35], a[196:199], v[68:71]
  ds_read_b64_tr_b16 a[16:17], v4 offset:24576
  ds_read_b64_tr_b16 a[18:19], v4 offset:28672
  v_mfma_f32_16x16x32_bf16 v[76:79], a[36:39], a[196:199], v[76:79]
  ds_read_b64_tr_b16 a[4:5], v5 offset:16384
  v_mfma_f32_16x16x32_bf16 v[76:79], a[52:55], a[204:207], v[76:79]
  ds_read_b64_tr_b16 a[6:7], v5 offset:20480
  v_mfma_f32_16x16x32_bf16 v[72:75], a[52:55], a[200:203], v[72:75]
  buffer_load_dwordx4 v252, s[84:87], s93 offen offset:1024 lds
  v_mfma_f32_16x16x32_bf16 v[72:75], a[36:39], a[192:195], v[72:75]
  s_waitcnt lgkmcnt(6)
  ds_read_b64_tr_b16 a[20:21], v5 offset:24576
  ds_read_b64_tr_b16 a[22:23], v5 offset:28672
  v_mfma_f32_16x16x32_bf16 v[80:83], a[40:43], a[192:195], v[80:83]
  ds_read_b64_tr_b16 a[8:9], v6 offset:16384
  v_mfma_f32_16x16x32_bf16 v[80:83], a[56:59], a[200:203], v[80:83]
  s_min_u32 s63, s89, 4096
  ds_read_b64_tr_b16 a[10:11], v6 offset:20480
  s_add_u32 s63, s63, s48
  v_mfma_f32_16x16x32_bf16 v[84:87], a[56:59], a[204:207], v[84:87]
  buffer_load_dwordx4 a[136:139], v8, s[4:7], s63 offen offset:1024 sc1
  v_mfma_f32_16x16x32_bf16 v[84:87], a[40:43], a[196:199], v[84:87]
  ds_read_b64_tr_b16 a[24:25], v6 offset:24576
  ds_read_b64_tr_b16 a[26:27], v6 offset:28672
  v_mfma_f32_16x16x32_bf16 v[92:95], a[44:47], a[196:199], v[92:95]
  ds_read_b64_tr_b16 a[12:13], v7 offset:16384
  v_mfma_f32_16x16x32_bf16 v[92:95], a[60:63], a[204:207], v[92:95]
  ds_read_b64_tr_b16 a[14:15], v7 offset:20480
  v_mfma_f32_16x16x32_bf16 v[88:91], a[60:63], a[200:203], v[88:91]
  buffer_load_dwordx4 a[140:143], v9, s[4:7], s63 offen offset:1024 sc1
  v_mfma_f32_16x16x32_bf16 v[88:91], a[44:47], a[192:195], v[88:91]
  s_waitcnt vmcnt(24) lgkmcnt(6)
  ds_read_b64_tr_b16 a[28:29], v7 offset:24576
  ds_read_b64_tr_b16 a[30:31], v7 offset:28672
  v_mfma_f32_16x16x32_bf16 v[32:35], a[0:3], a[208:211], v[32:35]
  s_add_u32 m0, s79, 49152
  ds_read_b64_tr_b16 a[32:33], v4 offset:32768
  s_add_u32 s92, s92, 458752
  s_cmp_lg_u32 s90, 0
  s_cselect_b32 s93, -2490368, 0
  s_cselect_b32 s43, s78, 0
  v_mfma_f32_16x16x32_bf16 v[32:35], a[16:19], a[216:219], v[32:35]
  s_sub_u32 s93, s93, s43
  ds_read_b64_tr_b16 a[34:35], v4 offset:36864
  s_add_u32 s93, s93, s92
  v_mfma_f32_16x16x32_bf16 v[36:39], a[16:19], a[220:223], v[36:39]
  ds_read_b64_tr_b16 a[48:49], v4 offset:40960
  buffer_load_dwordx4 v252, s[80:83], s93 offen lds
  v_mfma_f32_16x16x32_bf16 v[36:39], a[0:3], a[212:215], v[36:39]
  ds_read_b64_tr_b16 a[50:51], v4 offset:45056
  v_mfma_f32_16x16x32_bf16 v[44:47], a[4:7], a[212:215], v[44:47]
  ds_read_b64_tr_b16 a[36:37], v5 offset:32768
  buffer_load_dwordx4 v252, s[84:87], s93 offen offset:1024 lds
  v_mfma_f32_16x16x32_bf16 v[44:47], a[20:23], a[220:223], v[44:47]
  s_min_u32 s63, s90, 4096
  ds_read_b64_tr_b16 a[38:39], v5 offset:36864
  s_add_u32 s63, s63, s48
  v_mfma_f32_16x16x32_bf16 v[40:43], a[20:23], a[216:219], v[40:43]
  ds_read_b64_tr_b16 a[52:53], v5 offset:40960
  buffer_load_dwordx4 a[144:147], v8, s[4:7], s63 offen offset:2048 sc1
  v_mfma_f32_16x16x32_bf16 v[40:43], a[4:7], a[208:211], v[40:43]
  ds_read_b64_tr_b16 a[54:55], v5 offset:45056
  s_waitcnt lgkmcnt(8)
  v_mfma_f32_16x16x32_bf16 v[48:51], a[8:11], a[208:211], v[48:51]
  s_add_u32 m0, s79, 57344
  ds_read_b64_tr_b16 a[40:41], v6 offset:32768
  buffer_load_dwordx4 a[148:151], v9, s[4:7], s63 offen offset:2048 sc1
  s_add_u32 s92, s92, 458752
  s_cmp_lg_u32 s91, 0
  s_cselect_b32 s93, -2686976, 0
  s_cselect_b32 s43, s78, 0
  v_mfma_f32_16x16x32_bf16 v[48:51], a[24:27], a[216:219], v[48:51]
  s_sub_u32 s93, s93, s43
  ds_read_b64_tr_b16 a[42:43], v6 offset:36864
  s_add_u32 s93, s93, s92
  v_mfma_f32_16x16x32_bf16 v[52:55], a[24:27], a[220:223], v[52:55]
  ds_read_b64_tr_b16 a[56:57], v6 offset:40960
  buffer_load_dwordx4 v252, s[80:83], s93 offen lds
  v_mfma_f32_16x16x32_bf16 v[52:55], a[8:11], a[212:215], v[52:55]
  ds_read_b64_tr_b16 a[58:59], v6 offset:45056
  v_mfma_f32_16x16x32_bf16 v[60:63], a[12:15], a[212:215], v[60:63]
  ds_read_b64_tr_b16 a[44:45], v7 offset:32768
  buffer_load_dwordx4 v252, s[84:87], s93 offen offset:1024 lds
  v_mfma_f32_16x16x32_bf16 v[60:63], a[28:31], a[220:223], v[60:63]
  s_min_u32 s63, s91, 4096
  ds_read_b64_tr_b16 a[46:47], v7 offset:36864
  s_add_u32 s63, s63, s48
  v_mfma_f32_16x16x32_bf16 v[56:59], a[28:31], a[216:219], v[56:59]
  ds_read_b64_tr_b16 a[60:61], v7 offset:40960
  buffer_load_dwordx4 a[152:155], v8, s[4:7], s63 offen offset:3072 sc1
  v_mfma_f32_16x16x32_bf16 v[56:59], a[12:15], a[208:211], v[56:59]
  s_waitcnt vmcnt(23) lgkmcnt(7)
  ds_read_b64_tr_b16 a[62:63], v7 offset:45056
  buffer_load_dwordx4 a[156:159], v9, s[4:7], s63 offen offset:3072 sc1
  v_mfma_f32_16x16x32_bf16 v[32:35], a[32:35], a[224:227], v[32:35]
  s_waitcnt vmcnt(26)
  s_barrier
  ds_read_b64_tr_b16 a[0:1], v4 offset:49152
  v_mfma_f32_16x16x32_bf16 v[32:35], a[48:51], a[232:235], v[32:35]
  s_add_u32 s48, s48, 4096
  ds_read_b64_tr_b16 a[2:3], v4 offset:53248
  s_min_u32 s63, s88, 4096
  s_mul_i32 s63, s63, -13
  v_mfma_f32_16x16x32_bf16 v[36:39], a[48:51], a[236:239], v[36:39]
  s_add_u32 s63, s63, s48
  ds_read_b64_tr_b16 a[16:17], v4 offset:57344
  buffer_load_dwordx4 a[160:163], v8, s[4:7], s63 offen offset:0 sc1
  v_mfma_f32_16x16x32_bf16 v[36:39], a[32:35], a[228:231], v[36:39]
  ds_read_b64_tr_b16 a[18:19], v4 offset:61440
  v_mfma_f32_16x16x32_bf16 v[44:47], a[36:39], a[228:231], v[44:47]
  ds_read_b64_tr_b16 a[4:5], v5 offset:49152
  v_mfma_f32_16x16x32_bf16 v[44:47], a[52:55], a[236:239], v[44:47]
  ds_read_b64_tr_b16 a[6:7], v5 offset:53248
  v_mfma_f32_16x16x32_bf16 v[40:43], a[52:55], a[232:235], v[40:43]
  ds_read_b64_tr_b16 a[20:21], v5 offset:57344
  buffer_load_dwordx4 a[164:167], v9, s[4:7], s63 offen offset:0 sc1
  v_mfma_f32_16x16x32_bf16 v[40:43], a[36:39], a[224:227], v[40:43]
  ds_read_b64_tr_b16 a[22:23], v5 offset:61440
  s_waitcnt lgkmcnt(8)
  v_mfma_f32_16x16x32_bf16 v[48:51], a[40:43], a[224:227], v[48:51]
  ds_read_b64_tr_b16 a[8:9], v6 offset:49152
  v_mfma_f32_16x16x32_bf16 v[48:51], a[56:59], a[232:235], v[48:51]
  s_min_u32 s63, s89, 4096
  ds_read_b64_tr_b16 a[10:11], v6 offset:53248
  s_mul_i32 s63, s63, -13
  v_mfma_f32_16x16x32_bf16 v[52:55], a[56:59], a[236:239], v[52:55]
  s_add_u32 s63, s63, s48
  ds_read_b64_tr_b16 a[24:25], v6 offset:57344
  buffer_load_dwordx4 a[168:171], v8, s[4:7], s63 offen offset:1024 sc1
  v_mfma_f32_16x16x32_bf16 v[52:55], a[40:43], a[228:231], v[52:55]
  ds_read_b64_tr_b16 a[26:27], v6 offset:61440
  v_mfma_f32_16x16x32_bf16 v[60:63], a[44:47], a[228:231], v[60:63]
  ds_read_b64_tr_b16 a[12:13], v7 offset:49152
  v_mfma_f32_16x16x32_bf16 v[60:63], a[60:63], a[236:239], v[60:63]
  ds_read_b64_tr_b16 a[14:15], v7 offset:53248
  v_mfma_f32_16x16x32_bf16 v[56:59], a[60:63], a[232:235], v[56:59]
  ds_read_b64_tr_b16 a[28:29], v7 offset:57344
  buffer_load_dwordx4 a[172:175], v9, s[4:7], s63 offen offset:1024 sc1
  v_mfma_f32_16x16x32_bf16 v[56:59], a[44:47], a[224:227], v[56:59]
  ds_read_b64_tr_b16 a[30:31], v7 offset:61440
  s_waitcnt vmcnt(20) lgkmcnt(8)
  v_mfma_f32_16x16x32_bf16 v[32:35], a[0:3], a[240:243], v[32:35]
  ds_read_b64_tr_b16 a[32:33], v0 offset:0
  v_mfma_f32_16x16x32_bf16 v[32:35], a[16:19], a[248:251], v[32:35]
  s_min_u32 s63, s90, 4096
  ds_read_b64_tr_b16 a[34:35], v0 offset:4096
  s_mul_i32 s63, s63, -13
  v_mfma_f32_16x16x32_bf16 v[36:39], a[16:19], a[252:255], v[36:39]
  s_add_u32 s63, s63, s48
  ds_read_b64_tr_b16 a[48:49], v0 offset:8192
  buffer_load_dwordx4 a[176:179], v8, s[4:7], s63 offen offset:2048 sc1
  v_mfma_f32_16x16x32_bf16 v[36:39], a[0:3], a[244:247], v[36:39]
  ds_read_b64_tr_b16 a[50:51], v0 offset:12288
  v_mfma_f32_16x16x32_bf16 v[44:47], a[4:7], a[244:247], v[44:47]
  ds_read_b64_tr_b16 a[36:37], v1 offset:0
  v_mfma_f32_16x16x32_bf16 v[44:47], a[20:23], a[252:255], v[44:47]
  ds_read_b64_tr_b16 a[38:39], v1 offset:4096
  v_mfma_f32_16x16x32_bf16 v[40:43], a[20:23], a[248:251], v[40:43]
  ds_read_b64_tr_b16 a[52:53], v1 offset:8192
  buffer_load_dwordx4 a[180:183], v9, s[4:7], s63 offen offset:2048 sc1
  v_mfma_f32_16x16x32_bf16 v[40:43], a[4:7], a[240:243], v[40:43]
  ds_read_b64_tr_b16 a[54:55], v1 offset:12288
  s_waitcnt lgkmcnt(8)
  v_mfma_f32_16x16x32_bf16 v[48:51], a[8:11], a[240:243], v[48:51]
  ds_read_b64_tr_b16 a[40:41], v2 offset:0
  v_mfma_f32_16x16x32_bf16 v[48:51], a[24:27], a[248:251], v[48:51]
  s_min_u32 s63, s91, 4096
  ds_read_b64_tr_b16 a[42:43], v2 offset:4096
  s_mul_i32 s63, s63, -13
  v_mfma_f32_16x16x32_bf16 v[52:55], a[24:27], a[252:255], v[52:55]
  s_add_u32 s63, s63, s48
  ds_read_b64_tr_b16 a[56:57], v2 offset:8192
  buffer_load_dwordx4 a[184:187], v8, s[4:7], s63 offen offset:3072 sc1
  v_mfma_f32_16x16x32_bf16 v[52:55], a[8:11], a[244:247], v[52:55]
  ds_read_b64_tr_b16 a[58:59], v2 offset:12288
  v_mfma_f32_16x16x32_bf16 v[60:63], a[12:15], a[244:247], v[60:63]
  ds_read_b64_tr_b16 a[44:45], v3 offset:0
  v_mfma_f32_16x16x32_bf16 v[60:63], a[28:31], a[252:255], v[60:63]
  ds_read_b64_tr_b16 a[46:47], v3 offset:4096
  v_mfma_f32_16x16x32_bf16 v[56:59], a[28:31], a[248:251], v[56:59]
  ds_read_b64_tr_b16 a[60:61], v3 offset:8192
  buffer_load_dwordx4 a[188:191], v9, s[4:7], s63 offen offset:3072 sc1
  v_mfma_f32_16x16x32_bf16 v[56:59], a[12:15], a[240:243], v[56:59]
  ds_read_b64_tr_b16 a[62:63], v3 offset:12288
  s_waitcnt vmcnt(16) lgkmcnt(8)
  v_mfma_f32_16x16x32_bf16 v[32:35], a[32:35], a[128:131], v[32:35]
  s_waitcnt vmcnt(18)
  s_barrier
  ds_read_b64_tr_b16 a[0:1], v0 offset:16384
  v_mfma_f32_16x16x32_bf16 v[32:35], a[48:51], a[136:139], v[32:35]
  ds_read_b64_tr_b16 a[2:3], v0 offset:20480
  v_mfma_f32_16x16x32_bf16 v[36:39], a[48:51], a[140:143], v[36:39]
  ds_read_b64_tr_b16 a[16:17], v0 offset:24576
  v_mfma_f32_16x16x32_bf16 v[36:39], a[32:35], a[132:135], v[36:39]
  ds_read_b64_tr_b16 a[18:19], v0 offset:28672
  v_mfma_f32_16x16x32_bf16 v[44:47], a[36:39], a[132:135], v[44:47]
  ds_read_b64_tr_b16 a[4:5], v1 offset:16384
  v_mfma_f32_16x16x32_bf16 v[44:47], a[52:55], a[140:143], v[44:47]
  ds_read_b64_tr_b16 a[6:7], v1 offset:20480
  v_mfma_f32_16x16x32_bf16 v[40:43], a[52:55], a[136:139], v[40:43]
  ds_read_b64_tr_b16 a[20:21], v1 offset:24576
  v_mfma_f32_16x16x32_bf16 v[40:43], a[36:39], a[128:131], v[40:43]
  ds_read_b64_tr_b16 a[22:23], v1 offset:28672
  s_waitcnt lgkmcnt(8)
  v_mfma_f32_16x16x32_bf16 v[48:51], a[40:43], a[128:131], v[48:51]
  ds_read_b64_tr_b16 a[8:9], v2 offset:16384
  v_mfma_f32_16x16x32_bf16 v[48:51], a[56:59], a[136:139], v[48:51]
  ds_read_b64_tr_b16 a[10:11], v2 offset:20480
  v_mfma_f32_16x16x32_bf16 v[52:55], a[56:59], a[140:143], v[52:55]
  ds_read_b64_tr_b16 a[24:25], v2 offset:24576
  v_mfma_f32_16x16x32_bf16 v[52:55], a[40:43], a[132:135], v[52:55]
  ds_read_b64_tr_b16 a[26:27], v2 offset:28672
  v_mfma_f32_16x16x32_bf16 v[60:63], a[44:47], a[132:135], v[60:63]
  ds_read_b64_tr_b16 a[12:13], v3 offset:16384
  v_mfma_f32_16x16x32_bf16 v[60:63], a[60:63], a[140:143], v[60:63]
  ds_read_b64_tr_b16 a[14:15], v3 offset:20480
  v_mfma_f32_16x16x32_bf16 v[56:59], a[60:63], a[136:139], v[56:59]
  ds_read_b64_tr_b16 a[28:29], v3 offset:24576
  v_mfma_f32_16x16x32_bf16 v[56:59], a[44:47], a[128:131], v[56:59]
  ds_read_b64_tr_b16 a[30:31], v3 offset:28672
  s_waitcnt vmcnt(8) lgkmcnt(8)
  v_mfma_f32_16x16x32_bf16 v[32:35], a[0:3], a[144:147], v[32:35]
  ds_read_b64_tr_b16 a[32:33], v0 offset:32768
  v_mfma_f32_16x16x32_bf16 v[32:35], a[16:19], a[152:155], v[32:35]
  ds_read_b64_tr_b16 a[34:35], v0 offset:36864
  v_mfma_f32_16x16x32_bf16 v[36:39], a[16:19], a[156:159], v[36:39]
  ds_read_b64_tr_b16 a[48:49], v0 offset:40960
  v_mfma_f32_16x16x32_bf16 v[36:39], a[0:3], a[148:151], v[36:39]
  ds_read_b64_tr_b16 a[50:51], v0 offset:45056
  v_mfma_f32_16x16x32_bf16 v[44:47], a[4:7], a[148:151], v[44:47]
  ds_read_b64_tr_b16 a[36:37], v1 offset:32768
  v_mfma_f32_16x16x32_bf16 v[44:47], a[20:23], a[156:159], v[44:47]
  ds_read_b64_tr_b16 a[38:39], v1 offset:36864
  v_mfma_f32_16x16x32_bf16 v[40:43], a[20:23], a[152:155], v[40:43]
  ds_read_b64_tr_b16 a[52:53], v1 offset:40960
  v_mfma_f32_16x16x32_bf16 v[40:43], a[4:7], a[144:147], v[40:43]
  ds_read_b64_tr_b16 a[54:55], v1 offset:45056
  s_waitcnt lgkmcnt(8)
  v_mfma_f32_16x16x32_bf16 v[48:51], a[8:11], a[144:147], v[48:51]
  ds_read_b64_tr_b16 a[40:41], v2 offset:32768
  v_mfma_f32_16x16x32_bf16 v[48:51], a[24:27], a[152:155], v[48:51]
  ds_read_b64_tr_b16 a[42:43], v2 offset:36864
  v_mfma_f32_16x16x32_bf16 v[52:55], a[24:27], a[156:159], v[52:55]
  ds_read_b64_tr_b16 a[56:57], v2 offset:40960
  v_mfma_f32_16x16x32_bf16 v[52:55], a[8:11], a[148:151], v[52:55]
  ds_read_b64_tr_b16 a[58:59], v2 offset:45056
  v_mfma_f32_16x16x32_bf16 v[60:63], a[12:15], a[148:151], v[60:63]
  ds_read_b64_tr_b16 a[44:45], v3 offset:32768
  v_mfma_f32_16x16x32_bf16 v[60:63], a[28:31], a[156:159], v[60:63]
  ds_read_b64_tr_b16 a[46:47], v3 offset:36864
  v_mfma_f32_16x16x32_bf16 v[56:59], a[28:31], a[152:155], v[56:59]
  ds_read_b64_tr_b16 a[60:61], v3 offset:40960
  v_mfma_f32_16x16x32_bf16 v[56:59], a[12:15], a[144:147], v[56:59]
  ds_read_b64_tr_b16 a[62:63], v3 offset:45056
  s_waitcnt vmcnt(4) lgkmcnt(8)
  v_mfma_f32_16x16x32_bf16 v[32:35], a[32:35], a[160:163], v[32:35]
  s_waitcnt vmcnt(10)
  s_barrier
  ds_read_b64_tr_b16 a[0:1], v0 offset:49152
  v_mfma_f32_16x16x32_bf16 v[32:35], a[48:51], a[168:171], v[32:35]
  ds_read_b64_tr_b16 a[2:3], v0 offset:53248
  v_mfma_f32_16x16x32_bf16 v[36:39], a[48:51], a[172:175], v[36:39]
  ds_read_b64_tr_b16 a[16:17], v0 offset:57344
  v_mfma_f32_16x16x32_bf16 v[36:39], a[32:35], a[164:167], v[36:39]
  ds_read_b64_tr_b16 a[18:19], v0 offset:61440
  v_mfma_f32_16x16x32_bf16 v[44:47], a[36:39], a[164:167], v[44:47]
  ds_read_b64_tr_b16 a[4:5], v1 offset:49152
  v_mfma_f32_16x16x32_bf16 v[44:47], a[52:55], a[172:175], v[44:47]
  ds_read_b64_tr_b16 a[6:7], v1 offset:53248
  v_mfma_f32_16x16x32_bf16 v[40:43], a[52:55], a[168:171], v[40:43]
  ds_read_b64_tr_b16 a[20:21], v1 offset:57344
  v_mfma_f32_16x16x32_bf16 v[40:43], a[36:39], a[160:163], v[40:43]
  ds_read_b64_tr_b16 a[22:23], v1 offset:61440
  s_waitcnt lgkmcnt(8)
  v_mfma_f32_16x16x32_bf16 v[48:51], a[40:43], a[160:163], v[48:51]
  ds_read_b64_tr_b16 a[8:9], v2 offset:49152
  v_mfma_f32_16x16x32_bf16 v[48:51], a[56:59], a[168:171], v[48:51]
  ds_read_b64_tr_b16 a[10:11], v2 offset:53248
  v_mfma_f32_16x16x32_bf16 v[52:55], a[56:59], a[172:175], v[52:55]
  ds_read_b64_tr_b16 a[24:25], v2 offset:57344
  v_mfma_f32_16x16x32_bf16 v[52:55], a[40:43], a[164:167], v[52:55]
  ds_read_b64_tr_b16 a[26:27], v2 offset:61440
  v_mfma_f32_16x16x32_bf16 v[60:63], a[44:47], a[164:167], v[60:63]
  ds_read_b64_tr_b16 a[12:13], v3 offset:49152
  v_mfma_f32_16x16x32_bf16 v[60:63], a[60:63], a[172:175], v[60:63]
  ds_read_b64_tr_b16 a[14:15], v3 offset:53248
  v_mfma_f32_16x16x32_bf16 v[56:59], a[60:63], a[168:171], v[56:59]
  ds_read_b64_tr_b16 a[28:29], v3 offset:57344
  v_mfma_f32_16x16x32_bf16 v[56:59], a[44:47], a[160:163], v[56:59]
  ds_read_b64_tr_b16 a[30:31], v3 offset:61440
  s_waitcnt vmcnt(0) lgkmcnt(8)
  v_mfma_f32_16x16x32_bf16 v[32:35], a[0:3], a[176:179], v[32:35]
  ds_read_b64_tr_b16 a[32:33], v4 offset:17408
  v_mfma_f32_16x16x32_bf16 v[32:35], a[16:19], a[184:187], v[32:35]
  ds_read_b64_tr_b16 a[34:35], v4 offset:21504
  v_mfma_f32_16x16x32_bf16 v[36:39], a[16:19], a[188:191], v[36:39]
  ds_read_b64_tr_b16 a[48:49], v4 offset:25600
  v_mfma_f32_16x16x32_bf16 v[36:39], a[0:3], a[180:183], v[36:39]
  ds_read_b64_tr_b16 a[50:51], v4 offset:29696
  v_mfma_f32_16x16x32_bf16 v[44:47], a[4:7], a[180:183], v[44:47]
  ds_read_b64_tr_b16 a[36:37], v5 offset:17408
  v_mfma_f32_16x16x32_bf16 v[44:47], a[20:23], a[188:191], v[44:47]
  ds_read_b64_tr_b16 a[38:39], v5 offset:21504
  v_mfma_f32_16x16x32_bf16 v[40:43], a[20:23], a[184:187], v[40:43]
  ds_read_b64_tr_b16 a[52:53], v5 offset:25600
  v_mfma_f32_16x16x32_bf16 v[40:43], a[4:7], a[176:179], v[40:43]
  ds_read_b64_tr_b16 a[54:55], v5 offset:29696
  s_waitcnt lgkmcnt(8)
  v_mfma_f32_16x16x32_bf16 v[48:51], a[8:11], a[176:179], v[48:51]
  ds_read_b64_tr_b16 a[40:41], v6 offset:17408
  v_mfma_f32_16x16x32_bf16 v[48:51], a[24:27], a[184:187], v[48:51]
  ds_read_b64_tr_b16 a[42:43], v6 offset:21504
  v_mfma_f32_16x16x32_bf16 v[52:55], a[24:27], a[188:191], v[52:55]
  ds_read_b64_tr_b16 a[56:57], v6 offset:25600
  v_mfma_f32_16x16x32_bf16 v[52:55], a[8:11], a[180:183], v[52:55]
  ds_read_b64_tr_b16 a[58:59], v6 offset:29696
  v_mfma_f32_16x16x32_bf16 v[60:63], a[12:15], a[180:183], v[60:63]
  ds_read_b64_tr_b16 a[44:45], v7 offset:17408
  v_mfma_f32_16x16x32_bf16 v[60:63], a[28:31], a[188:191], v[60:63]
  ds_read_b64_tr_b16 a[46:47], v7 offset:21504
  v_mfma_f32_16x16x32_bf16 v[56:59], a[28:31], a[184:187], v[56:59]
  ds_read_b64_tr_b16 a[60:61], v7 offset:25600
  v_mfma_f32_16x16x32_bf16 v[56:59], a[12:15], a[176:179], v[56:59]
  ds_read_b64_tr_b16 a[62:63], v7 offset:29696
  s_waitcnt lgkmcnt(8)
  v_mfma_f32_16x16x32_bf16 v[64:67], a[32:35], a[208:211], v[64:67]
  s_lshl_b32 s45, s2, 2
  ds_read_b64_tr_b16 a[0:1], v4 offset:33792
  s_add_u32 s45, s45, s40
  v_mfma_f32_16x16x32_bf16 v[64:67], a[48:51], a[216:219], v[64:67]
  s_lshl_b32 s45, s45, 12
  ds_read_b64_tr_b16 a[2:3], v4 offset:37888
  s_xor_b32 s44, s45, 32768
  v_mfma_f32_16x16x32_bf16 v[68:71], a[48:51], a[220:223], v[68:71]
  s_add_u32 s43, s42, 28311552
  ds_read_b64_tr_b16 a[16:17], v4 offset:41984
  s_add_u32 s44, s44, s43
  v_mfma_f32_16x16x32_bf16 v[68:71], a[32:35], a[212:215], v[68:71]
  s_add_u32 s45, s45, s43
  ds_read_b64_tr_b16 a[18:19], v4 offset:46080
  v_cvt_pk_bf16_f32 v16, v32, v33
  v_mfma_f32_16x16x32_bf16 v[76:79], a[36:39], a[212:215], v[76:79]
  ds_read_b64_tr_b16 a[4:5], v5 offset:33792
  v_cvt_pk_bf16_f32 v17, v34, v35
  v_mfma_f32_16x16x32_bf16 v[76:79], a[52:55], a[220:223], v[76:79]
  ds_read_b64_tr_b16 a[6:7], v5 offset:37888
  v_cvt_pk_bf16_f32 v18, v40, v41
  v_cvt_pk_bf16_f32 v19, v42, v43
  v_mfma_f32_16x16x32_bf16 v[72:75], a[52:55], a[216:219], v[72:75]
  buffer_store_dwordx4 v[16:19], v8, s[4:7], s44 offen offset:0 sc1
  ds_read_b64_tr_b16 a[20:21], v5 offset:41984
  v_cvt_pk_bf16_f32 v24, v36, v37
  v_cvt_pk_bf16_f32 v25, v38, v39
  v_mfma_f32_16x16x32_bf16 v[72:75], a[36:39], a[208:211], v[72:75]
  s_waitcnt lgkmcnt(7)
  ds_read_b64_tr_b16 a[22:23], v5 offset:46080
  v_cvt_pk_bf16_f32 v26, v44, v45
  v_cvt_pk_bf16_f32 v27, v46, v47
  v_mfma_f32_16x16x32_bf16 v[80:83], a[40:43], a[208:211], v[80:83]
  ds_read_b64_tr_b16 a[8:9], v6 offset:33792
  buffer_store_dwordx4 v[24:27], v8, s[4:7], s44 offen offset:2048 sc1
  v_cvt_pk_bf16_f32 v20, v48, v49
  v_mfma_f32_16x16x32_bf16 v[80:83], a[56:59], a[216:219], v[80:83]
  ds_read_b64_tr_b16 a[10:11], v6 offset:37888
  v_cvt_pk_bf16_f32 v21, v50, v51
  v_mfma_f32_16x16x32_bf16 v[84:87], a[56:59], a[220:223], v[84:87]
  ds_read_b64_tr_b16 a[24:25], v6 offset:41984
  v_cvt_pk_bf16_f32 v22, v56, v57
  v_cvt_pk_bf16_f32 v23, v58, v59
  v_mfma_f32_16x16x32_bf16 v[84:87], a[40:43], a[212:215], v[84:87]
  buffer_store_dwordx4 v[20:23], v8, s[4:7], s44 offen offset:1024 sc1
  ds_read_b64_tr_b16 a[26:27], v6 offset:46080
  v_cvt_pk_bf16_f32 v28, v52, v53
  v_cvt_pk_bf16_f32 v29, v54, v55
  v_mfma_f32_16x16x32_bf16 v[92:95], a[44:47], a[212:215], v[92:95]
  ds_read_b64_tr_b16 a[12:13], v7 offset:33792
  v_cvt_pk_bf16_f32 v30, v60, v61
  v_cvt_pk_bf16_f32 v31, v62, v63
  v_mfma_f32_16x16x32_bf16 v[92:95], a[60:63], a[220:223], v[92:95]
  ds_read_b64_tr_b16 a[14:15], v7 offset:37888
  buffer_store_dwordx4 v[28:31], v8, s[4:7], s44 offen offset:3072 sc1
  v_mfma_f32_16x16x32_bf16 v[88:91], a[60:63], a[216:219], v[88:91]
  ds_read_b64_tr_b16 a[28:29], v7 offset:41984
  v_mfma_f32_16x16x32_bf16 v[88:91], a[44:47], a[208:211], v[88:91]
  ds_read_b64_tr_b16 a[30:31], v7 offset:46080
  s_waitcnt lgkmcnt(8)
  v_mfma_f32_16x16x32_bf16 v[64:67], a[0:3], a[224:227], v[64:67]
  ds_read_b64_tr_b16 a[32:33], v4 offset:50176
  v_and_b32 v148, 15, v253
  v_mfma_f32_16x16x32_bf16 v[64:67], a[16:19], a[232:235], v[64:67]
  ds_read_b64_tr_b16 a[34:35], v4 offset:54272
  v_lshrrev_b32 v149, 4, v253
  v_mfma_f32_16x16x32_bf16 v[68:71], a[16:19], a[236:239], v[68:71]
  ds_read_b64_tr_b16 a[48:49], v4 offset:58368
  v_lshrrev_b32 v128, 2, v148
  v_mfma_f32_16x16x32_bf16 v[68:71], a[0:3], a[228:231], v[68:71]
  ds_read_b64_tr_b16 a[50:51], v4 offset:62464
  v_cmp_eq_u32 vcc, v128, v149
  v_mfma_f32_16x16x32_bf16 v[76:79], a[4:7], a[228:231], v[76:79]
  ds_read_b64_tr_b16 a[36:37], v5 offset:50176
  v_and_b32 v128, 3, v148
  v_mfma_f32_16x16x32_bf16 v[76:79], a[20:23], a[236:239], v[76:79]
  ds_read_b64_tr_b16 a[38:39], v5 offset:54272
  v_lshlrev_b32 v148, 3, v148
  v_mfma_f32_16x16x32_bf16 v[72:75], a[20:23], a[232:235], v[72:75]
  ds_read_b64_tr_b16 a[52:53], v5 offset:58368
  v_mov_b32 v149, 0x7ffffff0
  v_mfma_f32_16x16x32_bf16 v[72:75], a[4:7], a[224:227], v[72:75]
  s_waitcnt lgkmcnt(7)
  ds_read_b64_tr_b16 a[54:55], v5 offset:62464
  v_cndmask_b32 v148, v149, v148, vcc
  v_mfma_f32_16x16x32_bf16 v[80:83], a[8:11], a[224:227], v[80:83]
  ds_read_b64_tr_b16 a[40:41], v6 offset:50176
  v_cmp_eq_u32 s[66:67], 1, v128
  v_mfma_f32_16x16x32_bf16 v[80:83], a[24:27], a[232:235], v[80:83]
  ds_read_b64_tr_b16 a[42:43], v6 offset:54272
  v_cmp_eq_u32 s[68:69], 2, v128
  v_mfma_f32_16x16x32_bf16 v[84:87], a[24:27], a[236:239], v[84:87]
  ds_read_b64_tr_b16 a[56:57], v6 offset:58368
  v_cmp_eq_u32 s[70:71], 3, v128
  v_mfma_f32_16x16x32_bf16 v[84:87], a[8:11], a[228:231], v[84:87]
  ds_read_b64_tr_b16 a[58:59], v6 offset:62464
  v_mov_b32 v128, 0x3f803f80
  v_mfma_f32_16x16x32_bf16 v[92:95], a[12:15], a[228:231], v[92:95]
  ds_read_b64_tr_b16 a[44:45], v7 offset:50176
  v_mov_b32 v129, 0x3f803f80
  v_mfma_f32_16x16x32_bf16 v[92:95], a[28:31], a[236:239], v[92:95]
  ds_read_b64_tr_b16 a[46:47], v7 offset:54272
  v_mov_b32 v130, 0x3f803f80
  v_mfma_f32_16x16x32_bf16 v[88:91], a[28:31], a[232:235], v[88:91]
  ds_read_b64_tr_b16 a[60:61], v7 offset:58368
  v_mov_b32 v131, 0x3f803f80
  v_mfma_f32_16x16x32_bf16 v[88:91], a[12:15], a[224:227], v[88:91]
  ds_read_b64_tr_b16 a[62:63], v7 offset:62464
  s_waitcnt lgkmcnt(8)
  v_mfma_f32_16x16x32_bf16 v[64:67], a[32:35], a[240:243], v[64:67]
  ds_read_b64_tr_b16 a[0:1], v0 offset:1024
  v_and_b32 v152, 15, v253
  v_lshrrev_b32 v153, 4, v253
  v_mfma_f32_16x16x32_bf16 v[64:67], a[48:51], a[248:251], v[64:67]
  ds_read_b64_tr_b16 a[2:3], v0 offset:5120
  v_lshrrev_b32 v155, 1, v153
  v_and_b32 v153, 1, v153
  v_mfma_f32_16x16x32_bf16 v[68:71], a[48:51], a[252:255], v[68:71]
  ds_read_b64_tr_b16 a[16:17], v0 offset:9216
  v_lshl_add_u32 v153, v153, 1, v155
  v_and_b32 v155, 7, v253
  v_mfma_f32_16x16x32_bf16 v[68:71], a[32:35], a[244:247], v[68:71]
  ds_read_b64_tr_b16 a[18:19], v0 offset:13312
  v_xor_b32 v153, v153, v155
  v_lshlrev_b32 v153, 4, v153
  v_mfma_f32_16x16x32_bf16 v[76:79], a[36:39], a[244:247], v[76:79]
  s_lshl_b32 s43, s40, 12
  ds_read_b64_tr_b16 a[4:5], v1 offset:1024
  v_lshl_add_u32 v152, v152, 7, v153
  v_mfma_f32_16x16x32_bf16 v[76:79], a[52:55], a[252:255], v[76:79]
  ds_read_b64_tr_b16 a[6:7], v1 offset:5120
  v_add_u32 v152, s43, v152
  v_xor_b32 v153, 64, v152
  v_mfma_f32_16x16x32_bf16 v[72:75], a[52:55], a[248:251], v[72:75]
  ds_read_b64_tr_b16 a[20:21], v1 offset:9216
  v_lshrrev_b32 v156, 3, v253
  v_xor_b32 v154, v156, v155
  v_mfma_f32_16x16x32_bf16 v[72:75], a[36:39], a[240:243], v[72:75]
  s_waitcnt lgkmcnt(7)
  ds_read_b64_tr_b16 a[22:23], v1 offset:13312
  v_lshlrev_b32 v154, 4, v154
  v_lshl_add_u32 v154, v156, 7, v154
  v_mfma_f32_16x16x32_bf16 v[80:83], a[40:43], a[240:243], v[80:83]
  ds_read_b64_tr_b16 a[8:9], v2 offset:1024
  v_add_u32 v154, s43, v154
  v_mfma_f32_16x16x32_bf16 v[80:83], a[56:59], a[248:251], v[80:83]
  ds_read_b64_tr_b16 a[10:11], v2 offset:5120
  v_lshlrev_b32 v155, 4, v155
  v_mfma_f32_16x16x32_bf16 v[84:87], a[56:59], a[252:255], v[84:87]
  ds_read_b64_tr_b16 a[24:25], v2 offset:9216
  v_lshl_add_u32 v155, v156, 12, v155
  v_mfma_f32_16x16x32_bf16 v[84:87], a[40:43], a[244:247], v[84:87]
  ds_read_b64_tr_b16 a[26:27], v2 offset:13312
  v_mfma_f32_16x16x32_bf16 v[92:95], a[44:47], a[244:247], v[92:95]
  ds_read_b64_tr_b16 a[12:13], v3 offset:1024
  v_mfma_f32_16x16x32_bf16 v[92:95], a[60:63], a[252:255], v[92:95]
  ds_read_b64_tr_b16 a[14:15], v3 offset:5120
  v_mfma_f32_16x16x32_bf16 v[88:91], a[60:63], a[248:251], v[88:91]
  ds_read_b64_tr_b16 a[28:29], v3 offset:9216
  v_mfma_f32_16x16x32_bf16 v[88:91], a[44:47], a[240:243], v[88:91]
  ds_read_b64_tr_b16 a[30:31], v3 offset:13312
  s_waitcnt lgkmcnt(8)
  v_mfma_f32_16x16x32_bf16 v[64:67], a[0:3], a[128:131], v[64:67]
  s_add_u32 s46, s76, 41943040
  ds_read_b64_tr_b16 a[32:33], v0 offset:17408
  s_add_u32 s47, s46, 32768
  v_mfma_f32_16x16x32_bf16 v[64:67], a[16:19], a[136:139], v[64:67]
  s_lshl_b32 s48, s49, 11
  ds_read_b64_tr_b16 a[34:35], v0 offset:21504
  s_lshl_b32 s43, s53, 7
  v_mfma_f32_16x16x32_bf16 v[68:71], a[16:19], a[140:143], v[68:71]
  s_add_u32 s48, s48, s43
  ds_read_b64_tr_b16 a[48:49], v0 offset:25600
  s_add_u32 s48, s48, 69206016
  v_mfma_f32_16x16x32_bf16 v[68:71], a[0:3], a[132:135], v[68:71]
  s_and_b32 s57, s49, 63
  ds_read_b64_tr_b16 a[50:51], v0 offset:29696
  s_lshl_b32 s57, s57, 16
  v_mfma_f32_16x16x32_bf16 v[76:79], a[4:7], a[132:135], v[76:79]
  s_add_u32 s57, s57, s43
  ds_read_b64_tr_b16 a[36:37], v1 offset:17408
  s_lshr_b32 s43, s49, 6
  v_mfma_f32_16x16x32_bf16 v[76:79], a[20:23], a[140:143], v[76:79]
  s_lshl_b32 s43, s43, 11
  ds_read_b64_tr_b16 a[38:39], v1 offset:21504
  s_add_u32 s57, s57, s43
  v_mfma_f32_16x16x32_bf16 v[72:75], a[20:23], a[136:139], v[72:75]
  s_and_b32 s43, s53, 0
  ds_read_b64_tr_b16 a[52:53], v1 offset:25600
  s_mul_i32 s77, s52, 1
  v_mfma_f32_16x16x32_bf16 v[72:75], a[4:7], a[128:131], v[72:75]
  s_add_u32 s77, s77, s43
  ds_read_b64_tr_b16 a[54:55], v1 offset:29696
  s_lshl_b32 s77, s77, 7
  s_waitcnt lgkmcnt(8)
  v_mfma_f32_16x16x32_bf16 v[80:83], a[8:11], a[128:131], v[80:83]
  ds_read_b64_tr_b16 a[40:41], v2 offset:17408
  s_add_u32 s77, s77, 27815936
  v_mfma_f32_16x16x32_bf16 v[80:83], a[24:27], a[136:139], v[80:83]
  ds_read_b64_tr_b16 a[42:43], v2 offset:21504
  v_mfma_f32_16x16x32_bf16 v[84:87], a[24:27], a[140:143], v[84:87]
  ds_read_b64_tr_b16 a[56:57], v2 offset:25600
  v_mfma_f32_16x16x32_bf16 v[84:87], a[8:11], a[132:135], v[84:87]
  ds_read_b64_tr_b16 a[58:59], v2 offset:29696
  v_mfma_f32_16x16x32_bf16 v[92:95], a[12:15], a[132:135], v[92:95]
  ds_read_b64_tr_b16 a[44:45], v3 offset:17408
  v_mfma_f32_16x16x32_bf16 v[92:95], a[28:31], a[140:143], v[92:95]
  ds_read_b64_tr_b16 a[46:47], v3 offset:21504
  v_mfma_f32_16x16x32_bf16 v[88:91], a[28:31], a[136:139], v[88:91]
  ds_read_b64_tr_b16 a[60:61], v3 offset:25600
  v_mfma_f32_16x16x32_bf16 v[88:91], a[12:15], a[128:131], v[88:91]
  ds_read_b64_tr_b16 a[62:63], v3 offset:29696
  s_waitcnt lgkmcnt(8)
  v_mfma_f32_16x16x32_bf16 v[64:67], a[32:35], a[144:147], v[64:67]
  ds_read_b64_tr_b16 a[0:1], v0 offset:33792
  v_mfma_f32_16x16x32_bf16 v[64:67], a[48:51], a[152:155], v[64:67]
  ds_read_b64_tr_b16 a[2:3], v0 offset:37888
  v_mfma_f32_16x16x32_bf16 v[68:71], a[48:51], a[156:159], v[68:71]
  ds_read_b64_tr_b16 a[16:17], v0 offset:41984
  v_mfma_f32_16x16x32_bf16 v[68:71], a[32:35], a[148:151], v[68:71]
  ds_read_b64_tr_b16 a[18:19], v0 offset:46080
  v_mfma_f32_16x16x32_bf16 v[76:79], a[36:39], a[148:151], v[76:79]
  ds_read_b64_tr_b16 a[4:5], v1 offset:33792
  buffer_load_dwordx4 v[96:99], v8, s[4:7], s45 offen offset:0 sc1
  v_mfma_f32_16x16x32_bf16 v[76:79], a[52:55], a[156:159], v[76:79]
  buffer_load_dwordx4 v[100:103], v8, s[4:7], s45 offen offset:1024 sc1
  ds_read_b64_tr_b16 a[6:7], v1 offset:37888
  v_mfma_f32_16x16x32_bf16 v[72:75], a[52:55], a[152:155], v[72:75]
  ds_read_b64_tr_b16 a[20:21], v1 offset:41984
  buffer_load_dwordx4 v[104:107], v8, s[4:7], s45 offen offset:2048 sc1
  buffer_load_dwordx4 v[108:111], v8, s[4:7], s45 offen offset:3072 sc1
  v_mfma_f32_16x16x32_bf16 v[72:75], a[36:39], a[144:147], v[72:75]
  ds_read_b64_tr_b16 a[22:23], v1 offset:46080
  s_waitcnt lgkmcnt(8)
  v_mfma_f32_16x16x32_bf16 v[80:83], a[40:43], a[144:147], v[80:83]
  ds_read_b64_tr_b16 a[8:9], v2 offset:33792
  v_mfma_f32_16x16x32_bf16 v[80:83], a[56:59], a[152:155], v[80:83]
  ds_read_b64_tr_b16 a[10:11], v2 offset:37888
  v_mfma_f32_16x16x32_bf16 v[84:87], a[56:59], a[156:159], v[84:87]
  ds_read_b64_tr_b16 a[24:25], v2 offset:41984
  v_mfma_f32_16x16x32_bf16 v[84:87], a[40:43], a[148:151], v[84:87]
  ds_read_b64_tr_b16 a[26:27], v2 offset:46080
  v_mfma_f32_16x16x32_bf16 v[92:95], a[44:47], a[148:151], v[92:95]
  ds_read_b64_tr_b16 a[12:13], v3 offset:33792
  v_mfma_f32_16x16x32_bf16 v[92:95], a[60:63], a[156:159], v[92:95]
  ds_read_b64_tr_b16 a[14:15], v3 offset:37888
  v_mfma_f32_16x16x32_bf16 v[88:91], a[60:63], a[152:155], v[88:91]
  ds_read_b64_tr_b16 a[28:29], v3 offset:41984
  v_mfma_f32_16x16x32_bf16 v[88:91], a[44:47], a[144:147], v[88:91]
  ds_read_b64_tr_b16 a[30:31], v3 offset:46080
  s_waitcnt lgkmcnt(8)
  v_mfma_f32_16x16x32_bf16 v[64:67], a[0:3], a[160:163], v[64:67]
  ds_read_b64_tr_b16 a[32:33], v0 offset:50176
  v_mfma_f32_16x16x32_bf16 v[64:67], a[16:19], a[168:171], v[64:67]
  ds_read_b64_tr_b16 a[34:35], v0 offset:54272
  v_mfma_f32_16x16x32_bf16 v[68:71], a[16:19], a[172:175], v[68:71]
  ds_read_b64_tr_b16 a[48:49], v0 offset:58368
  v_mfma_f32_16x16x32_bf16 v[68:71], a[0:3], a[164:167], v[68:71]
  ds_read_b64_tr_b16 a[50:51], v0 offset:62464
  v_mfma_f32_16x16x32_bf16 v[76:79], a[4:7], a[164:167], v[76:79]
  ds_read_b64_tr_b16 a[36:37], v1 offset:50176
  v_mfma_f32_16x16x32_bf16 v[76:79], a[20:23], a[172:175], v[76:79]
  ds_read_b64_tr_b16 a[38:39], v1 offset:54272
  v_mfma_f32_16x16x32_bf16 v[72:75], a[20:23], a[168:171], v[72:75]
  ds_read_b64_tr_b16 a[52:53], v1 offset:58368
  v_mfma_f32_16x16x32_bf16 v[72:75], a[4:7], a[160:163], v[72:75]
  ds_read_b64_tr_b16 a[54:55], v1 offset:62464
  s_waitcnt lgkmcnt(8)
  v_mfma_f32_16x16x32_bf16 v[80:83], a[8:11], a[160:163], v[80:83]
  ds_read_b64_tr_b16 a[40:41], v2 offset:50176
  v_mfma_f32_16x16x32_bf16 v[80:83], a[24:27], a[168:171], v[80:83]
  ds_read_b64_tr_b16 a[42:43], v2 offset:54272
  v_mfma_f32_16x16x32_bf16 v[84:87], a[24:27], a[172:175], v[84:87]
  ds_read_b64_tr_b16 a[56:57], v2 offset:58368
  v_mfma_f32_16x16x32_bf16 v[84:87], a[8:11], a[164:167], v[84:87]
  ds_read_b64_tr_b16 a[58:59], v2 offset:62464
  v_mfma_f32_16x16x32_bf16 v[92:95], a[12:15], a[164:167], v[92:95]
  ds_read_b64_tr_b16 a[44:45], v3 offset:50176
  v_mfma_f32_16x16x32_bf16 v[92:95], a[28:31], a[172:175], v[92:95]
  ds_read_b64_tr_b16 a[46:47], v3 offset:54272
  v_mfma_f32_16x16x32_bf16 v[88:91], a[28:31], a[168:171], v[88:91]
  ds_read_b64_tr_b16 a[60:61], v3 offset:58368
  v_mfma_f32_16x16x32_bf16 v[88:91], a[12:15], a[160:163], v[88:91]
  s_waitcnt vmcnt(0)
  ds_read_b64_tr_b16 a[62:63], v3 offset:62464
  v_max3_u32 v112, v96, v97, v98
  v_max3_u32 v113, v99, v100, v101
  v_max3_u32 v112, v112, v102, v103
  v_max3_u32 v113, v113, v104, v105
  v_max3_u32 v112, v112, v106, v107
  v_max3_u32 v113, v113, v108, v109
  v_max3_u32 v112, v112, v110, v111
  v_max_u32 v112, v112, v113
  v_cmp_eq_u32 vcc, -1, v112
  s_cbranch_vccnz Lp4_mb_c
Lp4_mb_r:
  s_waitcnt lgkmcnt(8)
  v_mfma_f32_16x16x32_bf16 v[64:67], a[32:35], a[176:179], v[64:67]
  v_lshlrev_b32 v32, 16, v96
  v_and_b32 v33, 0xffff0000, v96
  v_mfma_f32_16x16x32_bf16 v[64:67], a[48:51], a[184:187], v[64:67]
  v_lshlrev_b32 v34, 16, v97
  v_and_b32 v35, 0xffff0000, v97
  v_mfma_f32_16x16x32_bf16 v[68:71], a[48:51], a[188:191], v[68:71]
  v_lshlrev_b32 v40, 16, v98
  v_and_b32 v41, 0xffff0000, v98
  v_mfma_f32_16x16x32_bf16 v[68:71], a[32:35], a[180:183], v[68:71]
  v_lshlrev_b32 v42, 16, v99
  v_and_b32 v43, 0xffff0000, v99
  v_mfma_f32_16x16x32_bf16 v[76:79], a[36:39], a[180:183], v[76:79]
  v_lshlrev_b32 v36, 16, v104
  v_and_b32 v37, 0xffff0000, v104
  v_mfma_f32_16x16x32_bf16 v[76:79], a[52:55], a[188:191], v[76:79]
  v_lshlrev_b32 v38, 16, v105
  v_and_b32 v39, 0xffff0000, v105
  v_mfma_f32_16x16x32_bf16 v[72:75], a[52:55], a[184:187], v[72:75]
  v_lshlrev_b32 v44, 16, v106
  v_and_b32 v45, 0xffff0000, v106
  v_mfma_f32_16x16x32_bf16 v[72:75], a[36:39], a[176:179], v[72:75]
  s_waitcnt lgkmcnt(0)
  v_lshlrev_b32 v46, 16, v107
  v_and_b32 v47, 0xffff0000, v107
  v_mfma_f32_16x16x32_bf16 v[80:83], a[40:43], a[176:179], v[80:83]
  v_lshlrev_b32 v48, 16, v100
  v_and_b32 v49, 0xffff0000, v100
  v_mfma_f32_16x16x32_bf16 v[80:83], a[56:59], a[184:187], v[80:83]
  s_barrier
  v_lshlrev_b32 v50, 16, v101
  v_mfma_f32_16x16x32_bf16 v[84:87], a[56:59], a[188:191], v[84:87]
  v_and_b32 v51, 0xffff0000, v101
  v_lshlrev_b32 v56, 16, v102
  v_mfma_f32_16x16x32_bf16 v[84:87], a[40:43], a[180:183], v[84:87]
  v_and_b32 v57, 0xffff0000, v102
  v_lshlrev_b32 v58, 16, v103
  v_mfma_f32_16x16x32_bf16 v[92:95], a[44:47], a[180:183], v[92:95]
  v_and_b32 v59, 0xffff0000, v103
  v_lshlrev_b32 v52, 16, v108
  v_mfma_f32_16x16x32_bf16 v[92:95], a[60:63], a[188:191], v[92:95]
  v_and_b32 v53, 0xffff0000, v108
  v_lshlrev_b32 v54, 16, v109
  v_mfma_f32_16x16x32_bf16 v[88:91], a[60:63], a[184:187], v[88:91]
  v_and_b32 v55, 0xffff0000, v109
  v_lshlrev_b32 v60, 16, v110
  v_mfma_f32_16x16x32_bf16 v[88:91], a[44:47], a[176:179], v[88:91]
  v_and_b32 v61, 0xffff0000, v110
  v_lshlrev_b32 v62, 16, v111
  v_and_b32 v63, 0xffff0000, v111
  v_pk_add_f32 v[68:69], v[68:69], v[36:37]
  v_pk_add_f32 v[70:71], v[70:71], v[38:39]
  v_pk_add_f32 v[76:77], v[76:77], v[44:45]
  v_pk_add_f32 v[78:79], v[78:79], v[46:47]
  v_cvt_pk_bf16_f32 v24, v68, v69
  v_cvt_pk_bf16_f32 v25, v70, v71
  v_cvt_pk_bf16_f32 v26, v76, v77
  v_cvt_pk_bf16_f32 v27, v78, v79
  v_pk_add_f32 v[64:65], v[64:65], v[32:33]
  v_pk_add_f32 v[66:67], v[66:67], v[34:35]
  v_pk_add_f32 v[72:73], v[72:73], v[40:41]
  v_pk_add_f32 v[74:75], v[74:75], v[42:43]
  v_cvt_pk_bf16_f32 v16, v64, v65
  v_cvt_pk_bf16_f32 v17, v66, v67
  v_cvt_pk_bf16_f32 v18, v72, v73
  v_cvt_pk_bf16_f32 v19, v74, v75
  v_pk_add_f32 v[84:85], v[84:85], v[52:53]
  v_pk_add_f32 v[86:87], v[86:87], v[54:55]
  v_pk_add_f32 v[92:93], v[92:93], v[60:61]
  v_pk_add_f32 v[94:95], v[94:95], v[62:63]
  v_cvt_pk_bf16_f32 v28, v84, v85
  v_cvt_pk_bf16_f32 v29, v86, v87
  v_cvt_pk_bf16_f32 v30, v92, v93
  v_cvt_pk_bf16_f32 v31, v94, v95
  v_pk_add_f32 v[80:81], v[80:81], v[48:49]
  v_pk_add_f32 v[82:83], v[82:83], v[50:51]
  v_pk_add_f32 v[88:89], v[88:89], v[56:57]
  v_pk_add_f32 v[90:91], v[90:91], v[58:59]
  v_cvt_pk_bf16_f32 v20, v80, v81
  v_cvt_pk_bf16_f32 v21, v82, v83
  v_cvt_pk_bf16_f32 v22, v88, v89
  v_cvt_pk_bf16_f32 v23, v90, v91
  s_cmp_eq_u32 s41, 0
  s_cbranch_scc1 Lp4_mid
  v_permlane16_swap_b32 v16, v18
  v_permlane16_swap_b32 v17, v19
  v_permlane16_swap_b32 v20, v22
  v_permlane16_swap_b32 v21, v23
  ds_write_b128 v152, v[16:19] offset:0
  ds_write_b128 v153, v[20:23] offset:0
  ds_read_b128 v[96:99], v154 offset:0
  ds_read_b128 v[100:103], v154 offset:1024
  v_permlane16_swap_b32 v24, v26
  v_permlane16_swap_b32 v25, v27
  v_permlane16_swap_b32 v28, v30
  v_permlane16_swap_b32 v29, v31
  ds_write_b128 v152, v[24:27] offset:2048
  ds_write_b128 v153, v[28:31] offset:2048
  ds_read_b128 v[104:107], v154 offset:2048
  ds_read_b128 v[108:111], v154 offset:3072
  s_waitcnt lgkmcnt(5)
  buffer_store_dwordx4 v[96:99], v155, s[32:35], s57 offen nt
  s_add_u32 s57, s57, 32768
  s_waitcnt lgkmcnt(4)
  buffer_store_dwordx4 v[100:103], v155, s[32:35], s57 offen nt
  s_add_u32 s57, s57, 32768
  s_waitcnt lgkmcnt(1)
  buffer_store_dwordx4 v[104:107], v155, s[32:35], s57 offen nt
  s_add_u32 s57, s57, 32768
  s_waitcnt lgkmcnt(0)
  buffer_store_dwordx4 v[108:111], v155, s[32:35], s57 offen nt
  s_add_u32 s57, s57, 32768
  s_endpgm
Lp4_mid:
  buffer_store_dwordx4 v[16:19], v8, s[4:7], s46 offen offset:0 sc1
  buffer_store_dwordx4 v[24:27], v8, s[4:7], s47 offen offset:0 sc1
  v_mfma_f32_16x16x32_bf16 v[144:147], v[24:27], v[24:27], 0
  v_mfma_f32_16x16x32_bf16 v[140:143], v[128:131], v[24:27], 0
  v_mfma_f32_16x16x32_bf16 v[136:139], v[16:19], v[16:19], 0
  v_mfma_f32_16x16x32_bf16 v[132:135], v[128:131], v[16:19], 0
  buffer_store_dwordx4 v[20:23], v8, s[4:7], s46 offen offset:1024 sc1
  v_mfma_f32_16x16x32_bf16 v[144:147], v[28:31], v[28:31], v[144:147]
  buffer_store_dwordx4 v[28:31], v8, s[4:7], s47 offen offset:1024 sc1
  v_mfma_f32_16x16x32_bf16 v[140:143], v[128:131], v[28:31], v[140:143]
  v_mfma_f32_16x16x32_bf16 v[136:139], v[20:23], v[20:23], v[136:139]
  v_mfma_f32_16x16x32_bf16 v[132:135], v[128:131], v[20:23], v[132:135]
  s_nop 5
  v_cndmask_b32 v141, v144, v145, s[66:67]
  v_cndmask_b32 v141, v141, v146, s[68:69]
  v_cndmask_b32 v141, v141, v147, s[70:71]
  buffer_store_dwordx2 v[140:141], v148, s[4:7], s48 offen offset:2048 sc1
  v_cndmask_b32 v133, v136, v137, s[66:67]
  v_cndmask_b32 v133, v133, v138, s[68:69]
  v_cndmask_b32 v133, v133, v139, s[70:71]
  buffer_store_dwordx2 v[132:133], v148, s[4:7], s48 offen offset:0 sc1
  s_mov_b32 s41, 1
  s_mov_b32 s42, 0x2800000
  s_mov_b32 s28, s4
  s_mov_b32 s29, s5
  s_mov_b32 s30, 0x10000000
  s_lshr_b32 s57, s40, 1
  s_and_b32 s58, s40, 1
  s_lshl_b32 s71, s50, 3
  s_add_u32 s67, s50, s51
  s_and_b32 s67, s67, 0
  s_lshl_b32 s67, s67, 3
  s_lshl_b32 s62, s40, 12
  s_mul_i32 s63, s40, 6144
  s_add_u32 s76, s63, 139264
  s_and_b32 s43, s50, 7
  s_cmp_lg_u32 s43, 0
  s_cselect_b32 s43, 1, 0
  s_sub_u32 s72, s71, s43
  v_lshrrev_b32 v2, 3, v253
  v_bfe_u32 v3, v253, 1, 2
  v_lshrrev_b32 v4, 4, v253
  v_xor_b32 v3, v3, v4
  v_and_b32 v5, 1, v253
  v_mov_b32 v6, v2
  s_lshl_b32 s43, s40, 4
  v_mul_u32_u24 v6, 6144, v6
  v_lshl_add_u32 v6, v3, 5, v6
  v_lshl_add_u32 v124, v5, 4, v6
  v_add_u32 v125, 48128, v124
  s_mul_i32 s43, s43, 6144
  s_lshl_b32 s60, s51, 7
  s_add_u32 s60, s60, s43
  v_and_b32 v3, 7, v253
  s_lshl_b32 s43, s40, 1
  s_add_u32 s43, s43, s71
  v_lshlrev_b32 v120, 4, v253
  v_mov_b32 v121, v120
  v_add_u32 v122, 30720, v120
  v_add_u32 v123, 30720, v120
  v_lshlrev_b32 v5, 8, v2
  v_lshl_add_u32 v5, v3, 4, v5
  v_add_u32 v126, 128, v5
  s_lshl_b32 s43, s43, 15
  s_mov_b32 s44, 41943040
  s_add_u32 s59, s43, s44
  s_lshl_b32 s43, s72, 15
  s_add_u32 s73, s43, s44
  s_movk_i32 s61, 2048
  v_and_b32 v2, 15, v253
  v_lshrrev_b32 v3, 4, v253
  v_and_b32 v4, 7, v253
  v_lshlrev_b32 v6, 4, v253
  v_add_u32 v7, 1024, v6
  v_lshlrev_b32 v5, 7, v3
  v_lshl_add_u32 v8, v4, 4, v5
  v_add_u32 v9, 512, v8
  s_lshl_b32 s43, s57, 13
  s_add_u32 s43, s43, 73728
  v_add_u32 v112, s43, v6
  v_add_u32 v113, s43, v7
  v_add_u32 v114, 122880, v8
  v_add_u32 v115, 122880, v9
  s_lshl_b32 s43, s52, 3
  s_lshl_b32 s44, s40, 1
  s_add_u32 s43, s43, s44
  v_mov_b32 v187, v6
  s_lshl_b32 s43, s43, 15
  s_lshl_b32 s44, s53, 11
  s_add_u32 s43, s43, s44
  s_add_u32 s64, s43, 41943040
  v_lshrrev_b32 v2, 2, v253
  v_bfe_u32 v3, v253, 3, 2
  v_and_b32 v4, 3, v253
  v_lshlrev_b32 v4, 3, v4
  v_lshl_add_u32 v4, v2, 7, v4
  s_lshl_b32 s43, s58, 1
  s_or_b32 s43, s43, s57
  v_xor_b32 v5, s43, v3
  v_lshl_add_u32 v116, v5, 5, v4
  v_xor_b32 v5, 1, v5
  v_lshl_add_u32 v117, v5, 5, v4
  v_add_u32 v118, 49152, v116
  v_add_u32 v119, 49152, v117
  s_mov_b32 s84, s16
  s_mov_b32 s85, s17
  s_mov_b32 s86, 7340032
  s_mov_b32 s87, 0x20000
  s_mov_b32 s3, 0
  s_mov_b32 s88, 63
  s_mov_b32 s100, 0
  v_mov_b32 v238, 0x40000000
  s_waitcnt vmcnt(0)
  s_barrier
  s_cmp_lg_u32 s40, 0
  s_cbranch_scc1 Lsig22
  v_mov_b32 v250, 1
  s_mov_b64 exec, 1
  buffer_atomic_add v250, v251, s[4:7], s77 offen sc1
  s_mov_b64 exec, -1
Lsig22:
  s_add_u32 s44, s67, 0
  s_and_b32 s44, s44, 15
  s_mul_i32 s45, s44, 393216
  s_add_u32 s69, s45, s60
  s_add_u32 s70, s69, 4096
  s_add_u32 m0, s63, 0
  s_nop 0
  buffer_load_dwordx4 v124, s[8:11], s69 offen offset:0  lds
  buffer_load_dwordx4 v125, s[8:11], s69 offen offset:1024  lds
  buffer_load_dwordx4 v124, s[8:11], s69 offen offset:2048  lds
  buffer_load_dwordx4 v125, s[8:11], s69 offen offset:3072  lds
  s_add_u32 m0, s63, 4096
  s_nop 0
  buffer_load_dwordx4 v124, s[8:11], s70 offen offset:0  lds
  buffer_load_dwordx4 v125, s[8:11], s70 offen offset:1024  lds
  s_add_u32 s44, s67, 1
  s_and_b32 s44, s44, 15
  s_mul_i32 s45, s44, 393216
  s_add_u32 s69, s45, s60
  s_add_u32 s70, s69, 4096
  s_add_u32 m0, s63, 24576
  s_nop 0
  buffer_load_dwordx4 v124, s[8:11], s69 offen offset:0  lds
  buffer_load_dwordx4 v125, s[8:11], s69 offen offset:1024  lds
  buffer_load_dwordx4 v124, s[8:11], s69 offen offset:2048  lds
  buffer_load_dwordx4 v125, s[8:11], s69 offen offset:3072  lds
  s_add_u32 m0, s63, 28672
  s_nop 0
  buffer_load_dwordx4 v124, s[8:11], s70 offen offset:0  lds
  buffer_load_dwordx4 v125, s[8:11], s70 offen offset:1024  lds
  s_add_u32 s44, s67, 2
  s_and_b32 s44, s44, 15
  s_mul_i32 s45, s44, 393216
  s_add_u32 s69, s45, s60
  s_add_u32 s70, s69, 4096
  s_add_u32 m0, s63, 49152
  s_nop 0
  buffer_load_dwordx4 v124, s[8:11], s69 offen offset:0  lds
  buffer_load_dwordx4 v125, s[8:11], s69 offen offset:1024  lds
  buffer_load_dwordx4 v124, s[8:11], s69 offen offset:2048  lds
  buffer_load_dwordx4 v125, s[8:11], s69 offen offset:3072  lds
  s_add_u32 m0, s63, 53248
  s_nop 0
  buffer_load_dwordx4 v124, s[8:11], s70 offen offset:0  lds
  buffer_load_dwordx4 v125, s[8:11], s70 offen offset:1024  lds
  v_mov_b32 v0, 0
  v_mov_b32 v1, 0
  v_mov_b32 v2, 0
  v_mov_b32 v3, 0
  v_mov_b32 v4, 0
  v_mov_b32 v5, 0
  v_mov_b32 v6, 0
  v_mov_b32 v7, 0
  v_mov_b32 v8, 0
  v_mov_b32 v9, 0
  v_mov_b32 v10, 0
  v_mov_b32 v11, 0
  v_mov_b32 v12, 0
  v_mov_b32 v13, 0
  v_mov_b32 v14, 0
  v_mov_b32 v15, 0
  v_mov_b32 v16, 0
  v_mov_b32 v17, 0
  v_mov_b32 v18, 0
  v_mov_b32 v19, 0
  v_mov_b32 v20, 0
  v_mov_b32 v21, 0
  v_mov_b32 v22, 0
  v_mov_b32 v23, 0
  v_mov_b32 v24, 0
  v_mov_b32 v25, 0
  v_mov_b32 v26, 0
  v_mov_b32 v27, 0
  v_mov_b32 v28, 0
  v_mov_b32 v29, 0
  v_mov_b32 v30, 0
  v_mov_b32 v31, 0
  v_mov_b32 v32, 0
  v_mov_b32 v33, 0
  v_mov_b32 v34, 0
  v_mov_b32 v35, 0
  v_mov_b32 v36, 0
  v_mov_b32 v37, 0
  v_mov_b32 v38, 0
  v_mov_b32 v39, 0
  v_mov_b32 v40, 0
  v_mov_b32 v41, 0
  v_mov_b32 v42, 0
  v_mov_b32 v43, 0
  v_mov_b32 v44, 0
  v_mov_b32 v45, 0
  v_mov_b32 v46, 0
  v_mov_b32 v47, 0
  v_mov_b32 v48, 0
  v_mov_b32 v49, 0
  v_mov_b32 v50, 0
  v_mov_b32 v51, 0
  v_mov_b32 v52, 0
  v_mov_b32 v53, 0
  v_mov_b32 v54, 0
  v_mov_b32 v55, 0
  v_mov_b32 v56, 0
  v_mov_b32 v57, 0
  v_mov_b32 v58, 0
  v_mov_b32 v59, 0
  v_mov_b32 v60, 0
  v_mov_b32 v61, 0
  v_mov_b32 v62, 0
  v_mov_b32 v63, 0
  v_mov_b32 v64, 0
  v_mov_b32 v65, 0
  v_mov_b32 v66, 0
  v_mov_b32 v67, 0
  v_mov_b32 v68, 0
  v_mov_b32 v69, 0
  v_mov_b32 v70, 0
  v_mov_b32 v71, 0
  v_mov_b32 v72, 0
  v_mov_b32 v73, 0
  v_mov_b32 v74, 0
  v_mov_b32 v75, 0
  v_mov_b32 v76, 0
  v_mov_b32 v77, 0
  v_mov_b32 v78, 0
  v_mov_b32 v79, 0
  v_mov_b32 v80, 0
  v_mov_b32 v81, 0
  v_mov_b32 v82, 0
  v_mov_b32 v83, 0
  v_mov_b32 v84, 0
  v_mov_b32 v85, 0
  v_mov_b32 v86, 0
  v_mov_b32 v87, 0
  v_mov_b32 v88, 0
  v_mov_b32 v89, 0
  v_mov_b32 v90, 0
  v_mov_b32 v91, 0
  v_mov_b32 v92, 0
  v_mov_b32 v93, 0
  v_mov_b32 v94, 0
  v_mov_b32 v95, 0
  v_mov_b32 v96, 0
  v_mov_b32 v97, 0
  v_mov_b32 v98, 0
  v_mov_b32 v99, 0
  v_mov_b32 v100, 0
  v_mov_b32 v101, 0
  v_mov_b32 v102, 0
  v_mov_b32 v103, 0
  s_mul_i32 s77, s50, 128
  s_add_u32 s77, s77, 27815808
  s_and_b32 s43, s50, 7
  s_cmp_eq_u32 s43, 0
  s_cselect_b32 s43, 128, 0
  v_lshlrev_b32 v249, 7, v253
  v_or_b32 v249, s43, v249
  s_branch Llayer
Lend:
  s_endpgm
Lside_sub:
  s_cmp_eq_u32 s90, 1
  s_cbranch_scc0 Lside_l
  s_cmp_lg_u32 s40, 0
  s_cbranch_scc1 Lside_a
  s_and_b32 s43, s2, 1
  s_lshl_b32 s43, s43, 7
  v_mov_b32 v250, 1
  s_mov_b64 exec, 1
  buffer_atomic_add v250, v251, s[36:39], s43 offen sc1
  s_mov_b64 exec, -1
Lside_a:
  s_add_u32 s88, s88, 3
  s_add_u32 s90, s90, 1
  s_setpc_b64 s[78:79]
Lside_l:
  buffer_load_dwordx4 a[240:243], v239, s[12:15], s89 offen
  s_add_u32 s89, s89, 1024
  s_cmp_eq_u32 s90, 0
  s_cbranch_scc0 Lside_b
  buffer_load_dwordx4 a[176:179], v238, s[84:87], s100 offen
  s_add_u32 s100, s100, 57344
  buffer_load_dwordx4 a[180:183], v238, s[84:87], s100 offen
  s_add_u32 s100, s100, 57344
  buffer_load_dwordx4 a[184:187], v238, s[84:87], s100 offen
  s_add_u32 s100, s100, 57344
  buffer_load_dwordx4 a[188:191], v238, s[84:87], s100 offen
  s_add_u32 s100, s100, 57344
  buffer_load_dwordx4 a[192:195], v238, s[84:87], s100 offen
  s_add_u32 s100, s100, 57344
  buffer_load_dwordx4 a[196:199], v238, s[84:87], s100 offen
  s_add_u32 s100, s100, 57344
  buffer_load_dwordx4 a[200:203], v238, s[84:87], s100 offen
  s_add_u32 s100, s100, 57344
  buffer_load_dwordx4 a[204:207], v238, s[84:87], s100 offen
  s_add_u32 s100, s100, 57344
  s_add_u32 s100, s100, 3211264
  s_add_u32 s88, s88, 3
  s_add_u32 s90, s90, 1
  s_setpc_b64 s[78:79]
Lside_b:
  buffer_load_dwordx4 a[208:211], v238, s[84:87], s100 offen
  s_add_u32 s100, s100, 57344
  buffer_load_dwordx4 a[212:215], v238, s[84:87], s100 offen
  s_add_u32 s100, s100, 57344
  buffer_load_dwordx4 a[216:219], v238, s[84:87], s100 offen
  s_add_u32 s100, s100, 57344
  buffer_load_dwordx4 a[220:223], v238, s[84:87], s100 offen
  s_add_u32 s100, s100, 57344
  buffer_load_dwordx4 a[224:227], v238, s[84:87], s100 offen
  s_add_u32 s100, s100, 57344
  buffer_load_dwordx4 a[228:231], v238, s[84:87], s100 offen
  s_add_u32 s100, s100, 57344
  buffer_load_dwordx4 a[232:235], v238, s[84:87], s100 offen
  s_add_u32 s100, s100, 57344
  buffer_load_dwordx4 a[236:239], v238, s[84:87], s100 offen
  s_add_u32 s100, s100, 57344
  s_mov_b32 s88, 63
  s_setpc_b64 s[78:79]
Lside_k9_c:
  s_call_b64 s[78:79], Lside_sub
  s_branch Lside_k9_r
Lside_k0_c:
  s_call_b64 s[78:79], Lside_sub
  s_branch Lside_k0_r
Lside_k1_c:
  s_call_b64 s[78:79], Lside_sub
  s_branch Lside_k1_r
Lside_k2_c:
  s_call_b64 s[78:79], Lside_sub
  s_branch Lside_k2_r
Lside_k3_c:
  s_call_b64 s[78:79], Lside_sub
  s_branch Lside_k3_r
Lside_k4_c:
  s_call_b64 s[78:79], Lside_sub
  s_branch Lside_k4_r
Lside_k5_c:
  s_call_b64 s[78:79], Lside_sub
  s_branch Lside_k5_r
Lchk3_c:
  s_mov_b32 s43, 0x40000
Lchk3_s:
  buffer_load_dword v127, v240, s[36:39], 0 offen sc1
  s_waitcnt vmcnt(0)
  v_cmp_gt_u32 vcc, 128, v127
  s_cbranch_vccz Lchk3_r
  s_sub_u32 s43, s43, 1
  s_cmp_lg_u32 s43, 0
  s_cbranch_scc1 Lchk3_s
  s_branch Lchk3_r
Lc4_c:
  buffer_load_dwordx4 v[200:203], v106, s[4:7], s46 offen sc1
  s_add_u32 s46, s46, 24576
  buffer_load_dwordx4 v[204:207], v106, s[4:7], s46 offen sc1
  s_add_u32 s46, s46, 24576
  s_branch Lc4_r
Lc5_c:
  buffer_load_dwordx4 v[208:211], v106, s[4:7], s46 offen sc1
  s_add_u32 s46, s46, 24576
  buffer_load_dwordx4 v[212:215], v106, s[4:7], s46 offen sc1
  s_add_u32 s46, s46, 24576
  s_branch Lc5_r
Lc6_c:
  buffer_load_dwordx4 v[216:219], v106, s[4:7], s46 offen sc1
  s_add_u32 s46, s46, 24576
  buffer_load_dwordx4 v[220:223], v106, s[4:7], s46 offen sc1
  s_add_u32 s46, s46, 24576
  s_branch Lc6_r
Lc7_c:
  buffer_load_dwordx4 v[224:227], v106, s[4:7], s46 offen sc1
  s_add_u32 s46, s46, 24576
  buffer_load_dwordx4 v[228:231], v106, s[4:7], s46 offen sc1
  s_add_u32 s46, s46, 24576
  s_branch Lc7_r
Lc8_c:
  v_pk_add_f32 v[200:201], v[200:201], v[216:217]
  v_pk_add_f32 v[202:203], v[202:203], v[218:219]
  v_pk_add_f32 v[204:205], v[204:205], v[220:221]
  v_pk_add_f32 v[206:207], v[206:207], v[222:223]
  v_pk_add_f32 v[208:209], v[208:209], v[224:225]
  v_pk_add_f32 v[210:211], v[210:211], v[226:227]
  v_pk_add_f32 v[212:213], v[212:213], v[228:229]
  v_pk_add_f32 v[214:215], v[214:215], v[230:231]
  v_pk_add_f32 v[200:201], v[200:201], v[208:209]
  v_pk_add_f32 v[202:203], v[202:203], v[210:211]
  v_pk_add_f32 v[204:205], v[204:205], v[212:213]
  v_pk_add_f32 v[206:207], v[206:207], v[214:215]
  v_pk_add_f32 v[200:201], v[200:201], v[204:205]
  v_pk_add_f32 v[202:203], v[202:203], v[206:207]
  v_mov_b32 v204, v200
  v_mov_b32 v205, v201
  v_mov_b32 v206, v202
  v_mov_b32 v207, v203
  v_permlane32_swap_b32 v200, v204
  v_permlane32_swap_b32 v201, v205
  v_permlane32_swap_b32 v202, v206
  v_permlane32_swap_b32 v203, v207
  v_add_f32 v200, v200, v204
  v_add_f32 v201, v201, v205
  v_add_f32 v202, v202, v206
  v_add_f32 v203, v203, v207
  ds_write_b128 v126, v[200:203] offset:1024
  s_branch Lc8_r
Lc10_c:
  v_accvgpr_read_b32 v236, a176
  v_accvgpr_read_b32 v237, a177
  v_accvgpr_read_b32 v238, a178
  v_accvgpr_read_b32 v239, a179
  v_lshlrev_b32 v224, 16, v236
  v_and_b32 v225, 0xffff0000, v236
  v_lshlrev_b32 v226, 16, v237
  v_and_b32 v227, 0xffff0000, v237
  v_lshlrev_b32 v228, 16, v238
  v_and_b32 v229, 0xffff0000, v238
  v_lshlrev_b32 v230, 16, v239
  v_and_b32 v231, 0xffff0000, v239
  v_accvgpr_read_b32 v236, a180
  v_accvgpr_read_b32 v237, a181
  v_accvgpr_read_b32 v238, a182
  v_accvgpr_read_b32 v239, a183
  v_lshlrev_b32 v232, 16, v236
  v_and_b32 v233, 0xffff0000, v236
  v_pk_add_f32 v[224:225], v[224:225], v[232:233]
  v_lshlrev_b32 v232, 16, v237
  v_and_b32 v233, 0xffff0000, v237
  v_pk_add_f32 v[226:227], v[226:227], v[232:233]
  v_lshlrev_b32 v232, 16, v238
  v_and_b32 v233, 0xffff0000, v238
  v_pk_add_f32 v[228:229], v[228:229], v[232:233]
  v_lshlrev_b32 v232, 16, v239
  v_and_b32 v233, 0xffff0000, v239
  v_pk_add_f32 v[230:231], v[230:231], v[232:233]
  v_accvgpr_read_b32 v236, a184
  v_accvgpr_read_b32 v237, a185
  v_accvgpr_read_b32 v238, a186
  v_accvgpr_read_b32 v239, a187
  v_lshlrev_b32 v232, 16, v236
  v_and_b32 v233, 0xffff0000, v236
  v_pk_add_f32 v[224:225], v[224:225], v[232:233]
  v_lshlrev_b32 v232, 16, v237
  v_and_b32 v233, 0xffff0000, v237
  v_pk_add_f32 v[226:227], v[226:227], v[232:233]
  v_lshlrev_b32 v232, 16, v238
  v_and_b32 v233, 0xffff0000, v238
  v_pk_add_f32 v[228:229], v[228:229], v[232:233]
  v_lshlrev_b32 v232, 16, v239
  v_and_b32 v233, 0xffff0000, v239
  v_pk_add_f32 v[230:231], v[230:231], v[232:233]
  v_accvgpr_read_b32 v236, a188
  v_accvgpr_read_b32 v237, a189
  v_accvgpr_read_b32 v238, a190
  v_accvgpr_read_b32 v239, a191
  v_lshlrev_b32 v232, 16, v236
  v_and_b32 v233, 0xffff0000, v236
  v_pk_add_f32 v[224:225], v[224:225], v[232:233]
  v_lshlrev_b32 v232, 16, v237
  v_and_b32 v233, 0xffff0000, v237
  v_pk_add_f32 v[226:227], v[226:227], v[232:233]
  v_lshlrev_b32 v232, 16, v238
  v_and_b32 v233, 0xffff0000, v238
  v_pk_add_f32 v[228:229], v[228:229], v[232:233]
  v_lshlrev_b32 v232, 16, v239
  v_and_b32 v233, 0xffff0000, v239
  v_pk_add_f32 v[230:231], v[230:231], v[232:233]
  v_accvgpr_read_b32 v236, a192
  v_accvgpr_read_b32 v237, a193
  v_accvgpr_read_b32 v238, a194
  v_accvgpr_read_b32 v239, a195
  v_lshlrev_b32 v232, 16, v236
  v_and_b32 v233, 0xffff0000, v236
  v_pk_add_f32 v[224:225], v[224:225], v[232:233]
  v_lshlrev_b32 v232, 16, v237
  v_and_b32 v233, 0xffff0000, v237
  v_pk_add_f32 v[226:227], v[226:227], v[232:233]
  v_lshlrev_b32 v232, 16, v238
  v_and_b32 v233, 0xffff0000, v238
  v_pk_add_f32 v[228:229], v[228:229], v[232:233]
  v_lshlrev_b32 v232, 16, v239
  v_and_b32 v233, 0xffff0000, v239
  v_pk_add_f32 v[230:231], v[230:231], v[232:233]
  v_accvgpr_read_b32 v236, a196
  v_accvgpr_read_b32 v237, a197
  v_accvgpr_read_b32 v238, a198
  v_accvgpr_read_b32 v239, a199
  v_lshlrev_b32 v232, 16, v236
  v_and_b32 v233, 0xffff0000, v236
  v_pk_add_f32 v[224:225], v[224:225], v[232:233]
  v_lshlrev_b32 v232, 16, v237
  v_and_b32 v233, 0xffff0000, v237
  v_pk_add_f32 v[226:227], v[226:227], v[232:233]
  v_lshlrev_b32 v232, 16, v238
  v_and_b32 v233, 0xffff0000, v238
  v_pk_add_f32 v[228:229], v[228:229], v[232:233]
  v_lshlrev_b32 v232, 16, v239
  v_and_b32 v233, 0xffff0000, v239
  v_pk_add_f32 v[230:231], v[230:231], v[232:233]
  v_accvgpr_read_b32 v236, a200
  v_accvgpr_read_b32 v237, a201
  v_accvgpr_read_b32 v238, a202
  v_accvgpr_read_b32 v239, a203
  v_lshlrev_b32 v232, 16, v236
  v_and_b32 v233, 0xffff0000, v236
  v_pk_add_f32 v[224:225], v[224:225], v[232:233]
  v_lshlrev_b32 v232, 16, v237
  v_and_b32 v233, 0xffff0000, v237
  v_pk_add_f32 v[226:227], v[226:227], v[232:233]
  v_lshlrev_b32 v232, 16, v238
  v_and_b32 v233, 0xffff0000, v238
  v_pk_add_f32 v[228:229], v[228:229], v[232:233]
  v_lshlrev_b32 v232, 16, v239
  v_and_b32 v233, 0xffff0000, v239
  v_pk_add_f32 v[230:231], v[230:231], v[232:233]
  v_accvgpr_read_b32 v236, a204
  v_accvgpr_read_b32 v237, a205
  v_accvgpr_read_b32 v238, a206
  v_accvgpr_read_b32 v239, a207
  v_lshlrev_b32 v232, 16, v236
  v_and_b32 v233, 0xffff0000, v236
  v_pk_add_f32 v[224:225], v[224:225], v[232:233]
  v_lshlrev_b32 v232, 16, v237
  v_and_b32 v233, 0xffff0000, v237
  v_pk_add_f32 v[226:227], v[226:227], v[232:233]
  v_lshlrev_b32 v232, 16, v238
  v_and_b32 v233, 0xffff0000, v238
  v_pk_add_f32 v[228:229], v[228:229], v[232:233]
  v_lshlrev_b32 v232, 16, v239
  v_and_b32 v233, 0xffff0000, v239
  v_pk_add_f32 v[230:231], v[230:231], v[232:233]
  s_branch Lc10_r
Lc11_c:
  v_accvgpr_read_b32 v236, a208
  v_accvgpr_read_b32 v237, a209
  v_accvgpr_read_b32 v238, a210
  v_accvgpr_read_b32 v239, a211
  v_lshlrev_b32 v232, 16, v236
  v_and_b32 v233, 0xffff0000, v236
  v_pk_add_f32 v[224:225], v[224:225], v[232:233]
  v_lshlrev_b32 v232, 16, v237
  v_and_b32 v233, 0xffff0000, v237
  v_pk_add_f32 v[226:227], v[226:227], v[232:233]
  v_lshlrev_b32 v232, 16, v238
  v_and_b32 v233, 0xffff0000, v238
  v_pk_add_f32 v[228:229], v[228:229], v[232:233]
  v_lshlrev_b32 v232, 16, v239
  v_and_b32 v233, 0xffff0000, v239
  v_pk_add_f32 v[230:231], v[230:231], v[232:233]
  v_accvgpr_read_b32 v236, a212
  v_accvgpr_read_b32 v237, a213
  v_accvgpr_read_b32 v238, a214
  v_accvgpr_read_b32 v239, a215
  v_lshlrev_b32 v232, 16, v236
  v_and_b32 v233, 0xffff0000, v236
  v_pk_add_f32 v[224:225], v[224:225], v[232:233]
  v_lshlrev_b32 v232, 16, v237
  v_and_b32 v233, 0xffff0000, v237
  v_pk_add_f32 v[226:227], v[226:227], v[232:233]
  v_lshlrev_b32 v232, 16, v238
  v_and_b32 v233, 0xffff0000, v238
  v_pk_add_f32 v[228:229], v[228:229], v[232:233]
  v_lshlrev_b32 v232, 16, v239
  v_and_b32 v233, 0xffff0000, v239
  v_pk_add_f32 v[230:231], v[230:231], v[232:233]
  v_accvgpr_read_b32 v236, a216
  v_accvgpr_read_b32 v237, a217
  v_accvgpr_read_b32 v238, a218
  v_accvgpr_read_b32 v239, a219
  v_lshlrev_b32 v232, 16, v236
  v_and_b32 v233, 0xffff0000, v236
  v_pk_add_f32 v[224:225], v[224:225], v[232:233]
  v_lshlrev_b32 v232, 16, v237
  v_and_b32 v233, 0xffff0000, v237
  v_pk_add_f32 v[226:227], v[226:227], v[232:233]
  v_lshlrev_b32 v232, 16, v238
  v_and_b32 v233, 0xffff0000, v238
  v_pk_add_f32 v[228:229], v[228:229], v[232:233]
  v_lshlrev_b32 v232, 16, v239
  v_and_b32 v233, 0xffff0000, v239
  v_pk_add_f32 v[230:231], v[230:231], v[232:233]
  v_accvgpr_read_b32 v236, a220
  v_accvgpr_read_b32 v237, a221
  v_accvgpr_read_b32 v238, a222
  v_accvgpr_read_b32 v239, a223
  v_lshlrev_b32 v232, 16, v236
  v_and_b32 v233, 0xffff0000, v236
  v_pk_add_f32 v[224:225], v[224:225], v[232:233]
  v_lshlrev_b32 v232, 16, v237
  v_and_b32 v233, 0xffff0000, v237
  v_pk_add_f32 v[226:227], v[226:227], v[232:233]
  v_lshlrev_b32 v232, 16, v238
  v_and_b32 v233, 0xffff0000, v238
  v_pk_add_f32 v[228:229], v[228:229], v[232:233]
  v_lshlrev_b32 v232, 16, v239
  v_and_b32 v233, 0xffff0000, v239
  v_pk_add_f32 v[230:231], v[230:231], v[232:233]
  v_accvgpr_read_b32 v236, a224
  v_accvgpr_read_b32 v237, a225
  v_accvgpr_read_b32 v238, a226
  v_accvgpr_read_b32 v239, a227
  v_lshlrev_b32 v232, 16, v236
  v_and_b32 v233, 0xffff0000, v236
  v_pk_add_f32 v[224:225], v[224:225], v[232:233]
  v_lshlrev_b32 v232, 16, v237
  v_and_b32 v233, 0xffff0000, v237
  v_pk_add_f32 v[226:227], v[226:227], v[232:233]
  v_lshlrev_b32 v232, 16, v238
  v_and_b32 v233, 0xffff0000, v238
  v_pk_add_f32 v[228:229], v[228:229], v[232:233]
  v_lshlrev_b32 v232, 16, v239
  v_and_b32 v233, 0xffff0000, v239
  v_pk_add_f32 v[230:231], v[230:231], v[232:233]
  v_accvgpr_read_b32 v236, a228
  v_accvgpr_read_b32 v237, a229
  v_accvgpr_read_b32 v238, a230
  v_accvgpr_read_b32 v239, a231
  v_lshlrev_b32 v232, 16, v236
  v_and_b32 v233, 0xffff0000, v236
  v_pk_add_f32 v[224:225], v[224:225], v[232:233]
  v_lshlrev_b32 v232, 16, v237
  v_and_b32 v233, 0xffff0000, v237
  v_pk_add_f32 v[226:227], v[226:227], v[232:233]
  v_lshlrev_b32 v232, 16, v238
  v_and_b32 v233, 0xffff0000, v238
  v_pk_add_f32 v[228:229], v[228:229], v[232:233]
  v_lshlrev_b32 v232, 16, v239
  v_and_b32 v233, 0xffff0000, v239
  v_pk_add_f32 v[230:231], v[230:231], v[232:233]
  v_accvgpr_read_b32 v236, a232
  v_accvgpr_read_b32 v237, a233
  v_accvgpr_read_b32 v238, a234
  v_accvgpr_read_b32 v239, a235
  v_lshlrev_b32 v232, 16, v236
  v_and_b32 v233, 0xffff0000, v236
  v_pk_add_f32 v[224:225], v[224:225], v[232:233]
  v_lshlrev_b32 v232, 16, v237
  v_and_b32 v233, 0xffff0000, v237
  v_pk_add_f32 v[226:227], v[226:227], v[232:233]
  v_lshlrev_b32 v232, 16, v238
  v_and_b32 v233, 0xffff0000, v238
  v_pk_add_f32 v[228:229], v[228:229], v[232:233]
  v_lshlrev_b32 v232, 16, v239
  v_and_b32 v233, 0xffff0000, v239
  v_pk_add_f32 v[230:231], v[230:231], v[232:233]
  v_accvgpr_read_b32 v236, a236
  v_accvgpr_read_b32 v237, a237
  v_accvgpr_read_b32 v238, a238
  v_accvgpr_read_b32 v239, a239
  v_lshlrev_b32 v232, 16, v236
  v_and_b32 v233, 0xffff0000, v236
  v_pk_add_f32 v[224:225], v[224:225], v[232:233]
  v_lshlrev_b32 v232, 16, v237
  v_and_b32 v233, 0xffff0000, v237
  v_pk_add_f32 v[226:227], v[226:227], v[232:233]
  v_lshlrev_b32 v232, 16, v238
  v_and_b32 v233, 0xffff0000, v238
  v_pk_add_f32 v[228:229], v[228:229], v[232:233]
  v_lshlrev_b32 v232, 16, v239
  v_and_b32 v233, 0xffff0000, v239
  v_pk_add_f32 v[230:231], v[230:231], v[232:233]
  v_mov_b32 v232, v224
  v_mov_b32 v233, v225
  v_mov_b32 v234, v226
  v_mov_b32 v235, v227
  v_mov_b32 v236, v228
  v_mov_b32 v237, v229
  v_mov_b32 v238, v230
  v_mov_b32 v239, v231
  v_permlane32_swap_b32 v224, v232
  v_permlane32_swap_b32 v225, v233
  v_permlane32_swap_b32 v226, v234
  v_permlane32_swap_b32 v227, v235
  v_permlane32_swap_b32 v228, v236
  v_permlane32_swap_b32 v229, v237
  v_permlane32_swap_b32 v230, v238
  v_permlane32_swap_b32 v231, v239
  v_add_f32 v224, v224, v232
  v_add_f32 v225, v225, v233
  v_add_f32 v226, v226, v234
  v_add_f32 v227, v227, v235
  v_add_f32 v228, v228, v236
  v_add_f32 v229, v229, v237
  v_add_f32 v230, v230, v238
  v_add_f32 v231, v231, v239
  v_mov_b32 v232, v224
  v_mov_b32 v233, v225
  v_mov_b32 v234, v226
  v_mov_b32 v235, v227
  v_mov_b32 v236, v228
  v_mov_b32 v237, v229
  v_mov_b32 v238, v230
  v_mov_b32 v239, v231
  v_permlane16_swap_b32 v224, v232
  v_permlane16_swap_b32 v225, v233
  v_permlane16_swap_b32 v226, v234
  v_permlane16_swap_b32 v227, v235
  v_permlane16_swap_b32 v228, v236
  v_permlane16_swap_b32 v229, v237
  v_permlane16_swap_b32 v230, v238
  v_permlane16_swap_b32 v231, v239
  v_add_f32 v224, v224, v232
  v_add_f32 v225, v225, v233
  v_add_f32 v226, v226, v234
  v_add_f32 v227, v227, v235
  v_add_f32 v228, v228, v236
  v_add_f32 v229, v229, v237
  v_add_f32 v230, v230, v238
  v_add_f32 v231, v231, v239
  v_and_b32 v232, 7, v253
  s_lshl_b32 s43, s40, 8
  s_add_u32 s43, s43, 143360
  v_add_f32_dpp v224, v224, v224 row_ror:8 row_mask:0xf bank_mask:0xf
  v_add_f32_dpp v225, v225, v225 row_ror:8 row_mask:0xf bank_mask:0xf
  v_add_f32_dpp v226, v226, v226 row_ror:8 row_mask:0xf bank_mask:0xf
  v_add_f32_dpp v227, v227, v227 row_ror:8 row_mask:0xf bank_mask:0xf
  v_add_f32_dpp v228, v228, v228 row_ror:8 row_mask:0xf bank_mask:0xf
  v_add_f32_dpp v229, v229, v229 row_ror:8 row_mask:0xf bank_mask:0xf
  v_add_f32_dpp v230, v230, v230 row_ror:8 row_mask:0xf bank_mask:0xf
  v_add_f32_dpp v231, v231, v231 row_ror:8 row_mask:0xf bank_mask:0xf
  v_lshl_add_u32 v232, v232, 5, s43
  ds_write_b128 v232, v[224:227]
  ds_write_b128 v232, v[228:231] offset:16
  s_branch Lc11_r
Lc14_c:
  v_lshlrev_b32 v232, 2, v253
  v_add_u32 v233, 143360, v232
  ds_read_b32 v234, v233 offset:0
  ds_read_b32 v235, v233 offset:256
  ds_read_b32 v236, v233 offset:512
  ds_read_b32 v237, v233 offset:768
  s_waitcnt lgkmcnt(0)
  v_add_f32 v234, v234, v235
  v_add_f32 v236, v236, v237
  v_add_f32 v234, v234, v236
  buffer_store_dword v234, v232, s[4:7], s101 offen sc1
  s_branch Lc14_r
Lc16_c:
  s_bfe_u32 s43, s2, 0x20001
  s_lshl_b32 s43, s43, 7
  s_add_u32 s43, s43, 27794432
  v_mov_b32 v250, 1
  s_mov_b64 exec, 1
  buffer_atomic_add v250, v251, s[4:7], s43 offen sc1
  s_mov_b64 exec, -1
  s_branch Lc16_r
Lchk19_c:
  s_mov_b32 s43, 0x40000
Lchk19_s:
  buffer_load_dword v237, v251, s[4:7], s48 offen sc1
  s_waitcnt vmcnt(0)
  v_cmp_gt_u32 vcc, 56, v237
  s_cbranch_vccz Lchk19_r
  s_sub_u32 s43, s43, 1
  s_cmp_lg_u32 s43, 0
  s_cbranch_scc1 Lchk19_s
  s_branch Lchk19_r
Lp4a_c:
  s_mov_b32 s43, 0x40000
Lp4a_s:
  buffer_load_dword v10, v251, s[4:7], s64 offen sc1
  s_waitcnt vmcnt(0)
  v_cmp_gt_u32 vcc, 16, v10
  s_cbranch_vccz Lp4a_r
  s_sub_u32 s43, s43, 1
  s_cmp_lg_u32 s43, 0
  s_cbranch_scc1 Lp4a_s
  s_branch Lp4a_r
Lp4b_c:
  s_mov_b32 s43, 0x40000
Lp4b_s:
  buffer_load_dword v10, v251, s[4:7], s64 offen sc1
  s_waitcnt vmcnt(0)
  v_cmp_gt_u32 vcc, 16, v10
  s_cbranch_vccz Lp4b_r
  s_sub_u32 s43, s43, 1
  s_cmp_lg_u32 s43, 0
  s_cbranch_scc1 Lp4b_s
  s_branch Lp4b_r
Lp3_sgl_c:
  v_mov_b32 v250, 1
  s_mov_b64 exec, 1
  buffer_atomic_add v250, v251, s[4:7], s77 offen sc1
  s_mov_b64 exec, -1
  s_branch Lp3_sgl_r
Lp4_mb_c:
  s_mov_b32 s43, 0x40000
Lp4_mb_s:
  buffer_load_dwordx4 v[96:99], v8, s[4:7], s45 offen offset:0 sc1
  buffer_load_dwordx4 v[100:103], v8, s[4:7], s45 offen offset:1024 sc1
  buffer_load_dwordx4 v[104:107], v8, s[4:7], s45 offen offset:2048 sc1
  buffer_load_dwordx4 v[108:111], v8, s[4:7], s45 offen offset:3072 sc1
  s_waitcnt vmcnt(0)
  v_max3_u32 v112, v96, v97, v98
  v_max3_u32 v113, v99, v100, v101
  v_max3_u32 v112, v112, v102, v103
  v_max3_u32 v113, v113, v104, v105
  v_max3_u32 v112, v112, v106, v107
  v_max3_u32 v113, v113, v108, v109
  v_max3_u32 v112, v112, v110, v111
  v_max_u32 v112, v112, v113
  v_cmp_eq_u32 vcc, -1, v112
  s_cbranch_vccz Lp4_mb_r
  s_sub_u32 s43, s43, 1
  s_cmp_lg_u32 s43, 0
  s_cbranch_scc1 Lp4_mb_s
  s_branch Lp4_mb_r
Lcode_end:
.fill (Lpc0 + 69632 - Lcode_end)/4, 4, 0xbf810000
.section .rodata,"a"
.p2align 6
.amdhsa_kernel interleave_layers__sliding_local_dilated__swiglu_ffn__prompt_kernel
  .amdhsa_next_free_vgpr 512
  .amdhsa_next_free_sgpr 102
  .amdhsa_accum_offset 256
  .amdhsa_group_segment_fixed_size 0
  .amdhsa_kernarg_size 80
  .amdhsa_user_sgpr_count 2
  .amdhsa_user_sgpr_kernarg_segment_ptr 1
  .amdhsa_system_sgpr_workgroup_id_x 1
  .amdhsa_float_denorm_mode_32 3
.end_amdhsa_kernel
```

```asm
; @launch grid=(256,1,1) block=(256,1,1) lds=163840
.amdgcn_target "amdgcn-amd-amdhsa--gfx950"
.text
.globl interleave_layers__sliding_local_dilated__swiglu_ffn__prompt_kernel
.p2align 8
.type interleave_layers__sliding_local_dilated__swiglu_ffn__prompt_kernel,@function
interleave_layers__sliding_local_dilated__swiglu_ffn__prompt_kernel:
  s_cmp_lt_u32 s2, 256
  s_cbranch_scc1 Lgo
  s_endpgm
Lgo:
  s_load_dwordx2 s[28:29], s[0:1], 0
  s_load_dwordx2 s[8:9], s[0:1], 8
  s_getpc_b64 s[44:45]
Lpc0:
  s_bfe_u32 s43, s2, 0x40003
  s_lshl_b32 s43, s43, 12
  v_lshl_add_u32 v2, v0, 4, s43
  s_and_b32 s44, s44, 0xffffff80
  global_load_dwordx4 a[240:243], v2, s[44:45]
  v_lshrrev_b32 v1, 6, v0
  v_and_b32 v253, 63, v0
  v_readfirstlane_b32 s40, v1
  v_mov_b32 v251, 0
  s_mov_b32 s30, 0x400000
  s_mov_b32 s31, 0x20000
  s_mov_b32 s10, 0x600000
  s_mov_b32 s11, 0x20000
  s_and_b32 s44, s2, 1
  s_bfe_u32 s45, s2, 0x20001
  s_lshr_b32 s46, s2, 3
  s_lshl_b32 s47, s44, 3
  s_and_b32 s43, s46, 7
  s_add_u32 s50, s47, s43
  s_lshl_b32 s43, s45, 2
  s_lshr_b32 s51, s46, 3
  s_add_u32 s51, s51, s43
  s_lshr_b32 s57, s40, 1
  s_and_b32 s58, s40, 1
  s_lshl_b32 s71, s50, 3
  s_add_u32 s67, s50, s51
  s_and_b32 s67, s67, 15
  s_lshl_b32 s62, s40, 12
  s_mul_i32 s63, s40, 6144
  s_add_u32 s76, s63, 139264
  s_and_b32 s43, s50, 7
  s_cmp_lg_u32 s43, 0
  s_cselect_b32 s43, 1, 0
  s_sub_u32 s72, s71, s43
  v_lshrrev_b32 v2, 3, v253
  v_bfe_u32 v3, v253, 1, 2
  v_lshrrev_b32 v4, 4, v253
  v_xor_b32 v3, v3, v4
  v_and_b32 v5, 1, v253
  v_lshrrev_b32 v6, 5, v253
  v_lshl_add_u32 v6, v6, 2, v2
  s_lshl_b32 s43, s57, 5
  s_lshl_b32 s44, s58, 2
  s_add_u32 s43, s43, s44
  v_mul_u32_u24 v6, 6144, v6
  v_lshl_add_u32 v6, v3, 5, v6
  v_lshl_add_u32 v124, v5, 4, v6
  v_add_u32 v125, 97280, v124
  s_mul_i32 s43, s43, 6144
  s_lshl_b32 s60, s51, 7
  s_add_u32 s60, s60, s43
  v_and_b32 v3, 7, v253
  s_lshl_b32 s43, s40, 1
  s_add_u32 s43, s43, s71
  v_add_u32 v5, 0, v4
  v_xor_b32 v5, v5, v3
  v_lshlrev_b32 v5, 4, v5
  v_lshl_add_u32 v5, v2, 12, v5
  v_add_u32 v120, 0, v5
  v_add_u32 v5, 4, v4
  v_xor_b32 v5, v5, v3
  v_lshlrev_b32 v5, 4, v5
  v_lshl_add_u32 v5, v2, 12, v5
  v_add_u32 v121, 31744, v5
  v_add_u32 v5, 0, v4
  v_xor_b32 v5, v5, v3
  v_lshlrev_b32 v5, 4, v5
  v_lshl_add_u32 v5, v2, 12, v5
  v_add_u32 v122, 63488, v5
  v_add_u32 v5, 4, v4
  v_xor_b32 v5, v5, v3
  v_lshlrev_b32 v5, 4, v5
  v_lshl_add_u32 v5, v2, 12, v5
  v_add_u32 v123, 95232, v5
  v_and_b32 v5, 6, v2
  v_xor_b32 v5, v5, v3
  v_lshlrev_b32 v5, 4, v5
  v_lshl_add_u32 v5, v2, 12, v5
  v_add_u32 v126, 32768, v5
  s_lshr_b32 s44, s50, 3
  s_lshl_b32 s44, s44, 11
  s_and_b32 s43, s43, 63
  s_lshl_b32 s43, s43, 16
  s_add_u32 s59, s43, s44
  s_and_b32 s43, s72, 63
  s_lshl_b32 s43, s43, 16
  s_add_u32 s73, s43, s44
  s_movk_i32 s61, 128
  s_waitcnt lgkmcnt(0)
  s_add_u32 s44, s67, 0
  s_and_b32 s44, s44, 15
  s_mul_i32 s45, s44, s61
  s_add_u32 s68, s45, s59
  s_add_u32 m0, s62, 73728
  s_nop 0
  buffer_load_dwordx4 v120, s[28:31], s68 offen offset:0 sc1  lds
  buffer_load_dwordx4 v121, s[28:31], s68 offen offset:1024 sc1  lds
  buffer_load_dwordx4 v122, s[28:31], s68 offen offset:2048 sc1  lds
  buffer_load_dwordx4 v123, s[28:31], s68 offen offset:3072 sc1  lds
  s_add_u32 s44, s67, 0
  s_and_b32 s44, s44, 15
  s_mul_i32 s45, s44, 393216
  s_add_u32 s69, s45, s60
  s_add_u32 s70, s69, 4096
  s_add_u32 m0, s63, 0
  s_nop 0
  buffer_load_dwordx4 v124, s[8:11], s69 offen offset:0  lds
  buffer_load_dwordx4 v125, s[8:11], s69 offen offset:1024  lds
  buffer_load_dwordx4 v124, s[8:11], s69 offen offset:2048  lds
  buffer_load_dwordx4 v125, s[8:11], s69 offen offset:3072  lds
  s_add_u32 m0, s63, 4096
  s_nop 0
  buffer_load_dwordx4 v124, s[8:11], s70 offen offset:0  lds
  buffer_load_dwordx4 v125, s[8:11], s70 offen offset:1024  lds
  s_add_u32 s44, s67, s40
  s_add_u32 s44, s44, 0
  s_and_b32 s44, s44, 15
  s_mul_i32 s44, s44, s61
  s_lshl_b32 s45, s40, 10
  s_add_u32 m0, s45, 122880
  s_add_u32 s44, s44, s73
  buffer_load_dwordx4 v126, s[28:31], s44 offen sc1 lds
  s_load_dwordx2 s[4:5], s[0:1], 72
  s_load_dwordx2 s[12:13], s[0:1], 16
  s_load_dwordx2 s[16:17], s[0:1], 32
  s_load_dwordx2 s[20:21], s[0:1], 40
  s_load_dwordx2 s[24:25], s[0:1], 48
  s_load_dwordx2 s[32:33], s[0:1], 56
  s_load_dwordx2 s[36:37], s[0:1], 64
  s_mov_b32 s6, 0x10000000
  s_mov_b32 s7, 0x20000
  s_mov_b32 s14, 0x200000
  s_mov_b32 s15, 0x20000
  s_mov_b32 s18, 0x700000
  s_mov_b32 s19, 0x20000
  s_mov_b32 s22, 0x700000
  s_mov_b32 s23, 0x20000
  s_mov_b32 s26, 0x700000
  s_mov_b32 s27, 0x20000
  s_mov_b32 s34, 0x400000
  s_mov_b32 s35, 0x20000
  s_mov_b32 s38, 0x100
  s_mov_b32 s39, 0x20000
  s_mov_b32 s41, 0
  s_mov_b32 s42, 0
  s_and_b32 s44, s2, 1
  s_bfe_u32 s45, s2, 0x20001
  s_lshr_b32 s46, s2, 3
  s_lshl_b32 s47, s44, 3
  s_lshr_b32 s43, s45, 1
  s_lshl_b32 s43, s43, 2
  s_add_u32 s52, s47, s43
  s_and_b32 s48, s46, 3
  s_add_u32 s52, s52, s48
  s_and_b32 s43, s45, 1
  s_lshr_b32 s49, s46, 2
  s_lshl_b32 s53, s49, 1
  s_add_u32 s53, s53, s43
  s_lshl_b32 s43, s44, 2
  s_add_u32 s54, s43, s48
  s_lshl_b32 s43, s45, 3
  s_add_u32 s55, s43, s49
  v_lshrrev_b32 v2, 3, v253
  v_bfe_u32 v3, v253, 1, 2
  v_lshrrev_b32 v4, 4, v253
  v_xor_b32 v3, v3, v4
  v_and_b32 v4, 1, v253
  v_lshlrev_b32 v2, 11, v2
  v_lshl_add_u32 v2, v3, 5, v2
  v_lshl_add_u32 v252, v4, 4, v2
  s_waitcnt lgkmcnt(0)
  s_and_b32 s43, s40, 1
  s_mul_i32 s43, s43, 41943040
  s_lshl_b32 s44, s2, 7
  s_add_u32 s43, s43, s44
  s_add_u32 s43, s43, 27787264
  buffer_store_dword v251, v251, s[4:7], s43 offen sc1
  v_and_b32 v2, 15, v253
  v_lshrrev_b32 v3, 4, v253
  v_and_b32 v4, 7, v253
  v_lshrrev_b32 v5, 1, v2
  v_xor_b32 v5, v5, v3
  v_lshlrev_b32 v5, 4, v5
  v_lshl_add_u32 v6, v2, 7, v5
  v_xor_b32 v7, 64, v6
  v_and_b32 v5, 6, v4
  v_xor_b32 v5, v5, v3
  v_lshlrev_b32 v5, 4, v5
  v_lshl_add_u32 v8, v4, 7, v5
  v_xor_b32 v9, 64, v8
  s_lshl_b32 s43, s57, 13
  s_add_u32 s43, s43, 73728
  v_add_u32 v112, s43, v6
  v_add_u32 v113, s43, v7
  v_add_u32 v114, 122880, v8
  v_add_u32 v115, 122880, v9
  s_lshl_b32 s43, s52, 3
  s_lshl_b32 s44, s40, 1
  s_add_u32 s43, s43, s44
  v_lshrrev_b32 v5, 1, v3
  v_lshrrev_b32 v187, 1, v2
  v_xor_b32 v5, v5, v187
  v_lshlrev_b32 v5, 4, v5
  v_lshl_add_u32 v187, v2, 7, v5
  v_and_b32 v5, 1, v3
  v_lshl_add_u32 v187, v5, 3, v187
  s_lshr_b32 s44, s43, 6
  s_lshl_b32 s44, s44, 11
  s_and_b32 s43, s43, 63
  s_lshl_b32 s43, s43, 16
  s_add_u32 s43, s43, s44
  s_lshl_b32 s44, s53, 7
  s_add_u32 s64, s43, s44
  v_lshrrev_b32 v2, 2, v253
  v_bfe_u32 v3, v253, 3, 2
  v_and_b32 v4, 3, v253
  v_lshlrev_b32 v4, 3, v4
  v_lshl_add_u32 v4, v2, 7, v4
  s_lshl_b32 s43, s58, 1
  s_or_b32 s43, s43, s57
  v_xor_b32 v5, s43, v3
  v_lshl_add_u32 v116, v5, 5, v4
  v_xor_b32 v5, 1, v5
  v_lshl_add_u32 v117, v5, 5, v4
  v_add_u32 v118, 49152, v116
  v_add_u32 v119, 49152, v117
  v_and_b32 v235, 15, v253
  v_lshrrev_b32 v236, 4, v253
  v_lshlrev_b32 v236, 2, v236
  v_sub_u32 v235, v235, v236
  v_mov_b32 v237, 0xf149f2ca
  v_subrev_u32 v238, 0, v235
  v_cmp_gt_u32 vcc, 8, v238
  v_add_u32 v238, 16, v238
  v_cmp_gt_u32 s[78:79], 8, v238
  v_cndmask_b32 v132, v237, 0, vcc
  s_nop 0
  v_cndmask_b32 v136, v237, 0, s[78:79]
  v_subrev_u32 v238, 1, v235
  v_cmp_gt_u32 vcc, 8, v238
  v_add_u32 v238, 16, v238
  v_cmp_gt_u32 s[78:79], 8, v238
  v_cndmask_b32 v133, v237, 0, vcc
  s_nop 0
  v_cndmask_b32 v137, v237, 0, s[78:79]
  v_subrev_u32 v238, 2, v235
  v_cmp_gt_u32 vcc, 8, v238
  v_add_u32 v238, 16, v238
  v_cmp_gt_u32 s[78:79], 8, v238
  v_cndmask_b32 v134, v237, 0, vcc
  s_nop 0
  v_cndmask_b32 v138, v237, 0, s[78:79]
  v_subrev_u32 v238, 3, v235
  v_cmp_gt_u32 vcc, 8, v238
  v_add_u32 v238, 16, v238
  v_cmp_gt_u32 s[78:79], 8, v238
  v_cndmask_b32 v135, v237, 0, vcc
  s_nop 0
  v_cndmask_b32 v139, v237, 0, s[78:79]
  v_lshlrev_b32 v232, 4, v253
  v_add_u32 v232, 149504, v232
  ds_write_b128 v232, v[132:135]
  ds_write_b128 v232, v[136:139] offset:1024
  s_lshr_b32 s46, s2, 3
  s_cmp_ge_u32 s46, 14
  s_cselect_b32 s44, 14, 0
  s_cselect_b32 s45, 1, 0
  s_cselect_b32 s84, s20, s16
  s_cselect_b32 s85, s21, s17
  s_mov_b32 s86, 7340032
  s_mov_b32 s87, 0x20000
  s_sub_u32 s44, s46, s44
  s_bfe_u32 s47, s2, 0x20001
  s_mul_i32 s47, s47, 14
  s_add_u32 s44, s44, s47
  s_and_b32 s47, s2, 1
  s_lshl_b32 s48, s47, 1
  s_add_u32 s48, s48, s45
  s_mul_i32 s48, s48, 14336
  s_lshl_b32 s49, s44, 8
  s_add_u32 s48, s48, s49
  s_add_u32 s101, s48, 27918336
  s_lshl_b32 s47, s47, 2
  s_add_u32 s47, s47, s40
  s_mul_i32 s47, s47, 458752
  s_lshl_b32 s44, s44, 7
  s_add_u32 s100, s47, s44
  s_cmp_lt_u32 s46, 28
  s_cselect_b32 s3, 1, 0
  s_cmp_eq_u32 s41, 0
  s_cselect_b32 s3, s3, 0
  v_lshrrev_b32 v238, 3, v253
  v_mul_u32_u24 v238, 7168, v238
  v_and_b32 v239, 7, v253
  v_lshl_add_u32 v238, v239, 4, v238
  s_cmp_eq_u32 s3, 0
  s_cselect_b32 s43, 0x40000000, 0
  v_or_b32 v238, s43, v238
  v_lshlrev_b32 v239, 4, v253
  s_lshl_b32 s43, s2, 2
  s_add_u32 s43, s43, s40
  s_lshl_b32 s89, s43, 11
  s_mul_i32 s43, s46, 43
  s_lshr_b32 s43, s43, 8
  s_mul_i32 s43, s43, 6
  s_sub_u32 s43, s46, s43
  s_add_u32 s43, s43, 5
  s_cmp_eq_u32 s41, 0
  s_cselect_b32 s88, s43, 63
  s_mov_b32 s90, 0
  s_lshl_b32 s43, s58, 12
  v_add_u32 v132, s43, v112
  v_add_u32 v133, s43, v113
  v_and_b32 v128, 15, v253
  v_lshrrev_b32 v129, 4, v253
  v_cmp_eq_u32 vcc, 0, v128
  v_lshlrev_b32 v129, 4, v129
  v_mov_b32 v130, 0x40000000
  v_cndmask_b32 v136, v130, v129, vcc
  v_mov_b32 v156, 0x3f803f80
  v_mov_b32 v157, 0x3f803f80
  v_mov_b32 v158, 0x3f803f80
  v_mov_b32 v159, 0x3f803f80
  s_lshl_b32 s43, s40, 1
  s_add_u32 s43, s43, s71
  s_lshl_b32 s48, s43, 11
  s_lshl_b32 s43, s67, 7
  s_add_u32 s48, s48, s43
  s_add_u32 s48, s48, 27262976
  s_lshl_b32 s43, s51, 2
  s_lshl_b32 s44, s58, 1
  s_add_u32 s43, s43, s44
  s_add_u32 s43, s43, s57
  s_lshl_b32 s43, s43, 6
  s_mul_i32 s49, s67, 12288
  s_add_u32 s49, s49, s43
  s_add_u32 s49, s49, 27983872
  v_and_b32 v212, 15, v253
  v_lshrrev_b32 v213, 4, v253
  v_lshrrev_b32 v192, 2, v212
  v_cmp_eq_u32 vcc, v192, v213
  v_and_b32 v192, 3, v212
  v_lshlrev_b32 v212, 3, v212
  v_mov_b32 v213, 0x7ffffff0
  v_cndmask_b32 v212, v213, v212, vcc
  v_cmp_eq_u32 s[78:79], 1, v192
  v_cmp_eq_u32 s[80:81], 2, v192
  v_cmp_eq_u32 s[82:83], 3, v192
  v_mov_b32 v192, 0x3f803f80
  v_mov_b32 v193, 0x3f803f80
  v_mov_b32 v194, 0x3f803f80
  v_mov_b32 v195, 0x3f803f80
  s_add_u32 s44, s67, 1
  s_and_b32 s44, s44, 15
  s_mul_i32 s45, s44, s61
  s_add_u32 s68, s45, s59
  s_add_u32 m0, s62, 90112
  s_nop 0
  buffer_load_dwordx4 v120, s[28:31], s68 offen offset:0 sc1  lds
  buffer_load_dwordx4 v121, s[28:31], s68 offen offset:1024 sc1  lds
  buffer_load_dwordx4 v122, s[28:31], s68 offen offset:2048 sc1  lds
  buffer_load_dwordx4 v123, s[28:31], s68 offen offset:3072 sc1  lds
  s_waitcnt vmcnt(5)
  s_barrier
  ds_read_b64_tr_b16 a[40:41], v116 offset:0
  ds_read_b64_tr_b16 a[42:43], v116 offset:6144
  ds_read_b64_tr_b16 a[64:65], v116 offset:12288
  ds_read_b64_tr_b16 a[66:67], v116 offset:18432
  ds_read_b128 a[4:7], v112 offset:0
  ds_read_b128 a[24:27], v113 offset:0
  ds_read_b128 a[8:11], v112 offset:2048
  ds_read_b128 a[28:31], v113 offset:2048
  ds_read_b128 a[12:15], v112 offset:4096
  ds_read_b128 a[32:35], v113 offset:4096
  ds_read_b128 a[16:19], v112 offset:6144
  ds_read_b128 a[36:39], v113 offset:6144
  ds_read_b64_tr_b16 a[44:45], v117 offset:0
  ds_read_b64_tr_b16 a[46:47], v117 offset:6144
  ds_read_b64_tr_b16 a[68:69], v117 offset:12288
  ds_read_b64_tr_b16 a[70:71], v117 offset:18432
  ds_read_b128 a[0:3], v114 offset:0
  ds_read_b128 a[20:23], v115 offset:0
  ds_read_b64_tr_b16 a[48:49], v116 offset:2048
  ds_read_b64_tr_b16 a[50:51], v116 offset:8192
  ds_read_b64_tr_b16 a[72:73], v116 offset:14336
  ds_read_b64_tr_b16 a[74:75], v116 offset:20480
  ds_read_b64_tr_b16 a[52:53], v117 offset:2048
  ds_read_b64_tr_b16 a[54:55], v117 offset:8192
  ds_read_b64_tr_b16 a[76:77], v117 offset:14336
  ds_read_b64_tr_b16 a[78:79], v117 offset:20480
  ds_read_b64_tr_b16 a[56:57], v116 offset:4096
  ds_read_b64_tr_b16 a[58:59], v116 offset:10240
  ds_read_b64_tr_b16 a[80:81], v116 offset:16384
  ds_read_b64_tr_b16 a[82:83], v116 offset:22528
  ds_read_b64_tr_b16 a[60:61], v117 offset:4096
  ds_read_b64_tr_b16 a[62:63], v117 offset:10240
  ds_read_b64_tr_b16 a[84:85], v117 offset:16384
  ds_read_b64_tr_b16 a[86:87], v117 offset:22528
  ds_read_b128 v[140:143], v132 offset:0
  ds_read_b128 v[144:147], v133 offset:0
  ds_read_b128 v[148:151], v132 offset:2048
  ds_read_b128 v[152:155], v133 offset:2048
  s_add_u32 s44, s67, 1
  s_and_b32 s44, s44, 15
  s_mul_i32 s45, s44, 393216
  s_add_u32 s69, s45, s60
  s_add_u32 s70, s69, 4096
  s_add_u32 m0, s63, 24576
  s_nop 0
  buffer_load_dwordx4 v124, s[8:11], s69 offen offset:0  lds
  buffer_load_dwordx4 v125, s[8:11], s69 offen offset:1024  lds
  buffer_load_dwordx4 v124, s[8:11], s69 offen offset:2048  lds
  buffer_load_dwordx4 v125, s[8:11], s69 offen offset:3072  lds
  s_add_u32 m0, s63, 28672
  s_nop 0
  buffer_load_dwordx4 v124, s[8:11], s70 offen offset:0  lds
  buffer_load_dwordx4 v125, s[8:11], s70 offen offset:1024  lds
  s_waitcnt lgkmcnt(15)
  v_mfma_f32_16x16x32_bf16 v[0:3], a[40:43], a[4:7], 0
  s_add_u32 s44, s67, 2
  s_and_b32 s44, s44, 15
  s_mul_i32 s45, s44, 393216
  s_add_u32 s69, s45, s60
  s_add_u32 s70, s69, 4096
  s_add_u32 m0, s63, 49152
  s_nop 0
  v_mfma_f32_16x16x32_bf16 v[0:3], a[64:67], a[24:27], v[0:3]
  buffer_load_dwordx4 v124, s[8:11], s69 offen offset:0  lds
  v_mfma_f32_16x16x32_bf16 v[4:7], a[64:67], a[28:31], 0
  v_mfma_f32_16x16x32_bf16 v[4:7], a[40:43], a[8:11], v[4:7]
  buffer_load_dwordx4 v125, s[8:11], s69 offen offset:1024  lds
  v_mfma_f32_16x16x32_bf16 v[8:11], a[40:43], a[12:15], 0
  v_mfma_f32_16x16x32_bf16 v[8:11], a[64:67], a[32:35], v[8:11]
  v_mfma_f32_16x16x32_bf16 v[12:15], a[64:67], a[36:39], 0
  buffer_load_dwordx4 v124, s[8:11], s69 offen offset:2048  lds
  v_mfma_f32_16x16x32_bf16 v[12:15], a[40:43], a[16:19], v[12:15]
  v_mfma_f32_16x16x32_bf16 v[28:31], a[44:47], a[16:19], 0
  buffer_load_dwordx4 v125, s[8:11], s69 offen offset:3072  lds
  v_mfma_f32_16x16x32_bf16 v[28:31], a[68:71], a[36:39], v[28:31]
  s_add_u32 m0, s63, 53248
  s_nop 0
  v_mfma_f32_16x16x32_bf16 v[24:27], a[68:71], a[32:35], 0
  v_mfma_f32_16x16x32_bf16 v[24:27], a[44:47], a[12:15], v[24:27]
  buffer_load_dwordx4 v124, s[8:11], s70 offen offset:0  lds
  v_mfma_f32_16x16x32_bf16 v[20:23], a[44:47], a[8:11], 0
  v_mfma_f32_16x16x32_bf16 v[20:23], a[68:71], a[28:31], v[20:23]
  buffer_load_dwordx4 v125, s[8:11], s70 offen offset:1024  lds
  v_mfma_f32_16x16x32_bf16 v[16:19], a[68:71], a[24:27], 0
  s_add_u32 s44, s67, 2
  s_and_b32 s44, s44, 15
  s_mul_i32 s45, s44, s61
  s_add_u32 s68, s45, s59
  s_add_u32 m0, s62, 106496
  s_nop 0
  v_mfma_f32_16x16x32_bf16 v[16:19], a[44:47], a[4:7], v[16:19]
  v_mfma_f32_16x16x32_bf16 v[96:99], a[48:51], a[0:3], 0
  s_waitcnt vmcnt(6) lgkmcnt(0)
  s_barrier
  ds_read_b64_tr_b16 a[128:129], v116 offset:24576
  v_mfma_f32_16x16x32_bf16 v[96:99], a[72:75], a[20:23], v[96:99]
  ds_read_b64_tr_b16 a[130:131], v116 offset:30720
  buffer_load_dwordx4 v120, s[28:31], s68 offen offset:0 sc1  lds
  v_mfma_f32_16x16x32_bf16 v[32:35], a[72:75], a[24:27], 0
  ds_read_b64_tr_b16 a[152:153], v116 offset:36864
  v_mfma_f32_16x16x32_bf16 v[32:35], a[48:51], a[4:7], v[32:35]
  ds_read_b64_tr_b16 a[154:155], v116 offset:43008
  v_mfma_f32_16x16x32_bf16 v[36:39], a[48:51], a[8:11], 0
  ds_read_b128 a[92:95], v112 offset:16384
  buffer_load_dwordx4 v121, s[28:31], s68 offen offset:1024 sc1  lds
  v_mfma_f32_16x16x32_bf16 v[36:39], a[72:75], a[28:31], v[36:39]
  ds_read_b128 a[112:115], v113 offset:16384
  v_mfma_f32_16x16x32_bf16 v[40:43], a[72:75], a[32:35], 0
  ds_read_b128 a[96:99], v112 offset:18432
  buffer_load_dwordx4 v122, s[28:31], s68 offen offset:2048 sc1  lds
  v_mfma_f32_16x16x32_bf16 v[40:43], a[48:51], a[12:15], v[40:43]
  ds_read_b128 a[116:119], v113 offset:18432
  v_mfma_f32_16x16x32_bf16 v[44:47], a[48:51], a[16:19], 0
  ds_read_b128 a[100:103], v112 offset:20480
  v_mfma_f32_16x16x32_bf16 v[44:47], a[72:75], a[36:39], v[44:47]
  s_add_u32 s44, s67, s40
  ds_read_b128 a[120:123], v113 offset:20480
  buffer_load_dwordx4 v123, s[28:31], s68 offen offset:3072 sc1  lds
  s_add_u32 s44, s44, 4
  s_and_b32 s44, s44, 15
  s_mul_i32 s44, s44, s61
  s_lshl_b32 s45, s40, 10
  v_mfma_f32_16x16x32_bf16 v[60:63], a[76:79], a[36:39], 0
  s_add_u32 m0, s45, 126976
  s_add_u32 s44, s44, s73
  ds_read_b128 a[104:107], v112 offset:22528
  v_mfma_f32_16x16x32_bf16 v[60:63], a[52:55], a[16:19], v[60:63]
  ds_read_b128 a[124:127], v113 offset:22528
  v_mfma_f32_16x16x32_bf16 v[56:59], a[52:55], a[12:15], 0
  ds_read_b64_tr_b16 a[132:133], v117 offset:24576
  buffer_load_dwordx4 v126, s[28:31], s44 offen sc1 lds
  s_add_u32 s44, s67, s40
  s_add_u32 s44, s44, 8
  s_and_b32 s44, s44, 15
  s_mul_i32 s44, s44, s61
  s_lshl_b32 s45, s40, 10
  v_mfma_f32_16x16x32_bf16 v[56:59], a[76:79], a[32:35], v[56:59]
  s_add_u32 m0, s45, 131072
  s_add_u32 s44, s44, s73
  ds_read_b64_tr_b16 a[134:135], v117 offset:30720
  v_mfma_f32_16x16x32_bf16 v[160:163], a[40:43], v[156:159], 0
  ds_read_b64_tr_b16 a[156:157], v117 offset:36864
  v_mfma_f32_16x16x32_bf16 v[164:167], a[48:51], v[156:159], 0
  ds_read_b64_tr_b16 a[158:159], v117 offset:43008
  buffer_load_dwordx4 v126, s[28:31], s44 offen sc1 lds
  s_add_u32 s44, s67, s40
  s_add_u32 s44, s44, 12
  s_and_b32 s44, s44, 15
  s_mul_i32 s44, s44, s61
  s_lshl_b32 s45, s40, 10
  v_mfma_f32_16x16x32_bf16 v[168:171], a[56:59], v[156:159], 0
  s_add_u32 m0, s45, 135168
  s_add_u32 s44, s44, s73
  ds_read_b128 a[88:91], v114 offset:1024
  v_mfma_f32_16x16x32_bf16 v[160:163], a[64:67], v[156:159], v[160:163]
  ds_read_b128 a[108:111], v115 offset:1024
  buffer_load_dwordx4 v126, s[28:31], s44 offen sc1 lds
  s_add_u32 s44, s67, 3
  s_and_b32 s44, s44, 15
  s_mul_i32 s45, s44, s61
  s_add_u32 s68, s45, s59
  s_add_u32 m0, s62, 73728
  s_nop 0
  v_mfma_f32_16x16x32_bf16 v[164:167], a[72:75], v[156:159], v[164:167]
  ds_read_b64_tr_b16 a[136:137], v116 offset:26624
  v_mfma_f32_16x16x32_bf16 v[168:171], a[80:83], v[156:159], v[168:171]
  ds_read_b64_tr_b16 a[138:139], v116 offset:32768
  v_mfma_f32_16x16x32_bf16 v[208:211], v[148:151], v[148:151], 0
  ds_read_b64_tr_b16 a[160:161], v116 offset:38912
  buffer_load_dwordx4 v120, s[28:31], s68 offen offset:0 sc1  lds
  v_mfma_f32_16x16x32_bf16 v[204:207], v[192:195], v[148:151], 0
  ds_read_b64_tr_b16 a[162:163], v116 offset:45056
  v_mfma_f32_16x16x32_bf16 v[200:203], v[140:143], v[140:143], 0
  ds_read_b64_tr_b16 a[140:141], v117 offset:26624
  v_mfma_f32_16x16x32_bf16 v[196:199], v[192:195], v[140:143], 0
  ds_read_b64_tr_b16 a[142:143], v117 offset:32768
  buffer_load_dwordx4 v121, s[28:31], s68 offen offset:1024 sc1  lds
  v_mfma_f32_16x16x32_bf16 v[208:211], v[152:155], v[152:155], v[208:211]
  ds_read_b64_tr_b16 a[164:165], v117 offset:38912
  v_mfma_f32_16x16x32_bf16 v[204:207], v[192:195], v[152:155], v[204:207]
  ds_read_b64_tr_b16 a[166:167], v117 offset:45056
  v_mfma_f32_16x16x32_bf16 v[200:203], v[144:147], v[144:147], v[200:203]
  ds_read_b64_tr_b16 a[144:145], v116 offset:28672
  buffer_load_dwordx4 v122, s[28:31], s68 offen offset:2048 sc1  lds
  v_mfma_f32_16x16x32_bf16 v[196:199], v[192:195], v[144:147], v[196:199]
  ds_read_b64_tr_b16 a[146:147], v116 offset:34816
  v_mfma_f32_16x16x32_bf16 v[52:55], a[76:79], a[28:31], 0
  s_add_u32 s44, s67, 3
  ds_read_b64_tr_b16 a[168:169], v116 offset:40960
  buffer_load_dwordx4 v123, s[28:31], s68 offen offset:3072 sc1  lds
  s_and_b32 s44, s44, 15
  s_mul_i32 s45, s44, 393216
  s_add_u32 s69, s45, s60
  s_add_u32 s70, s69, 4096
  s_add_u32 m0, s63, 0
  s_nop 0
  v_mfma_f32_16x16x32_bf16 v[52:55], a[52:55], a[8:11], v[52:55]
  ds_read_b64_tr_b16 a[170:171], v116 offset:47104
  v_mfma_f32_16x16x32_bf16 v[48:51], a[52:55], a[4:7], 0
  ds_read_b64_tr_b16 a[148:149], v117 offset:28672
  v_mfma_f32_16x16x32_bf16 v[48:51], a[76:79], a[24:27], v[48:51]
  ds_read_b64_tr_b16 a[150:151], v117 offset:34816
  buffer_load_dwordx4 v124, s[8:11], s69 offen offset:0  lds
  v_mfma_f32_16x16x32_bf16 v[100:103], a[20:23], a[80:83], 0
  ds_read_b64_tr_b16 a[172:173], v117 offset:40960
  v_mfma_f32_16x16x32_bf16 v[100:103], a[0:3], a[56:59], v[100:103]
  ds_read_b64_tr_b16 a[174:175], v117 offset:47104
  v_mfma_f32_16x16x32_bf16 v[64:67], a[4:7], a[56:59], 0
  buffer_load_dwordx4 v125, s[8:11], s69 offen offset:1024  lds
  v_mfma_f32_16x16x32_bf16 v[64:67], a[24:27], a[80:83], v[64:67]
  v_cndmask_b32 v205, v208, v209, s[78:79]
  v_cndmask_b32 v205, v205, v210, s[80:81]
  v_cndmask_b32 v205, v205, v211, s[82:83]
  v_mfma_f32_16x16x32_bf16 v[68:71], a[28:31], a[80:83], 0
  buffer_store_dwordx2 v[204:205], v212, s[4:7], s48 offen offset:2048 sc1
  v_cndmask_b32 v197, v200, v201, s[78:79]
  v_mfma_f32_16x16x32_bf16 v[68:71], a[8:11], a[56:59], v[68:71]
  buffer_load_dwordx4 v124, s[8:11], s69 offen offset:2048  lds
  v_mfma_f32_16x16x32_bf16 v[72:75], a[12:15], a[56:59], 0
  v_cndmask_b32 v197, v197, v202, s[80:81]
  v_cndmask_b32 v197, v197, v203, s[82:83]
  v_mfma_f32_16x16x32_bf16 v[72:75], a[32:35], a[80:83], v[72:75]
  buffer_store_dwordx2 v[196:197], v212, s[4:7], s48 offen offset:0 sc1
  buffer_load_dwordx4 v125, s[8:11], s69 offen offset:3072  lds
  s_add_u32 m0, s63, 4096
  s_nop 0
  v_mfma_f32_16x16x32_bf16 v[76:79], a[36:39], a[80:83], 0
  buffer_store_dwordx4 v[160:163], v136, s[4:7], s49 offen sc1
  v_mfma_f32_16x16x32_bf16 v[76:79], a[16:19], a[56:59], v[76:79]
  s_add_u32 s49, s49, 4096
  buffer_store_dwordx4 v[164:167], v136, s[4:7], s49 offen sc1
  v_mfma_f32_16x16x32_bf16 v[92:95], a[16:19], a[60:63], 0
  s_add_u32 s49, s49, 4096
  buffer_load_dwordx4 v124, s[8:11], s70 offen offset:0  lds
  v_mfma_f32_16x16x32_bf16 v[92:95], a[36:39], a[84:87], v[92:95]
  buffer_store_dwordx4 v[168:171], v136, s[4:7], s49 offen sc1
  v_mfma_f32_16x16x32_bf16 v[88:91], a[32:35], a[84:87], 0
  s_add_u32 s49, s49, 4096
  v_mfma_f32_16x16x32_bf16 v[88:91], a[12:15], a[60:63], v[88:91]
  buffer_load_dwordx4 v125, s[8:11], s70 offen offset:1024  lds
  v_mfma_f32_16x16x32_bf16 v[84:87], a[8:11], a[60:63], 0
  v_mfma_f32_16x16x32_bf16 v[84:87], a[28:31], a[84:87], v[84:87]
  v_mfma_f32_16x16x32_bf16 v[80:83], a[24:27], a[84:87], 0
  v_mfma_f32_16x16x32_bf16 v[80:83], a[4:7], a[60:63], v[80:83]
  s_add_u32 s44, s67, 4
  s_and_b32 s44, s44, 15
  s_mul_i32 s45, s44, s61
  s_add_u32 s68, s45, s59
  s_mov_b32 s66, 5
  s_mov_b32 s56, 2
  s_cmp_eq_u32 s66, s88
  s_cbranch_scc1 Lside_k9_c
Lside_k9_r:
  s_branch Lp1_u1
  s_branch Lp1_common
Llayer:
  s_cmp_lg_u32 s40, 0
  s_cbranch_scc1 Lpdn2
  s_mov_b32 s43, 0x40000
  s_mov_b64 exec, 3
Lpol1:
  buffer_load_dword v250, v249, s[4:7], s77 offen  sc1
  s_waitcnt vmcnt(0)
  v_cmp_gt_u32 vcc, 16, v250
  s_cbranch_vccz Lpdn2x
  s_sub_u32 s43, s43, 1
  s_cmp_lg_u32 s43, 0
  s_cbranch_scc1 Lpol1
Lpdn2x:
  s_mov_b64 exec, -1
Lpdn2:
  s_waitcnt vmcnt(0) lgkmcnt(0)
  s_barrier
  s_add_u32 s44, s67, 0
  s_and_b32 s44, s44, 15
  s_mul_i32 s45, s44, s61
  s_add_u32 s68, s45, s59
  s_add_u32 m0, s62, 73728
  s_nop 0
  buffer_load_dwordx4 v120, s[28:31], s68 offen offset:0 sc1  lds
  buffer_load_dwordx4 v121, s[28:31], s68 offen offset:1024 sc1  lds
  buffer_load_dwordx4 v122, s[28:31], s68 offen offset:2048 sc1  lds
  buffer_load_dwordx4 v123, s[28:31], s68 offen offset:3072 sc1  lds
  s_add_u32 s44, s67, s40
  s_add_u32 s44, s44, 0
  s_and_b32 s44, s44, 15
  s_mul_i32 s44, s44, s61
  s_lshl_b32 s45, s40, 10
  s_add_u32 m0, s45, 122880
  s_add_u32 s44, s44, s73
  buffer_load_dwordx4 v126, s[28:31], s44 offen sc1 lds
  s_add_u32 s44, s67, 1
  s_and_b32 s44, s44, 15
  s_mul_i32 s45, s44, s61
  s_add_u32 s68, s45, s59
  s_add_u32 m0, s62, 90112
  s_nop 0
  buffer_load_dwordx4 v120, s[28:31], s68 offen offset:0 sc1  lds
  buffer_load_dwordx4 v121, s[28:31], s68 offen offset:1024 sc1  lds
  buffer_load_dwordx4 v122, s[28:31], s68 offen offset:2048 sc1  lds
  buffer_load_dwordx4 v123, s[28:31], s68 offen offset:3072 sc1  lds
  ds_read_b64_tr_b16 a[40:41], v116 offset:0
  ds_read_b64_tr_b16 a[42:43], v116 offset:6144
  ds_read_b64_tr_b16 a[64:65], v116 offset:12288
  ds_read_b64_tr_b16 a[66:67], v116 offset:18432
  ds_read_b64_tr_b16 a[44:45], v117 offset:0
  ds_read_b64_tr_b16 a[46:47], v117 offset:6144
  ds_read_b64_tr_b16 a[68:69], v117 offset:12288
  ds_read_b64_tr_b16 a[70:71], v117 offset:18432
  ds_read_b64_tr_b16 a[48:49], v116 offset:2048
  ds_read_b64_tr_b16 a[50:51], v116 offset:8192
  ds_read_b64_tr_b16 a[72:73], v116 offset:14336
  ds_read_b64_tr_b16 a[74:75], v116 offset:20480
  ds_read_b64_tr_b16 a[52:53], v117 offset:2048
  ds_read_b64_tr_b16 a[54:55], v117 offset:8192
  ds_read_b64_tr_b16 a[76:77], v117 offset:14336
  ds_read_b64_tr_b16 a[78:79], v117 offset:20480
  ds_read_b64_tr_b16 a[56:57], v116 offset:4096
  ds_read_b64_tr_b16 a[58:59], v116 offset:10240
  ds_read_b64_tr_b16 a[80:81], v116 offset:16384
  ds_read_b64_tr_b16 a[82:83], v116 offset:22528
  ds_read_b64_tr_b16 a[60:61], v117 offset:4096
  ds_read_b64_tr_b16 a[62:63], v117 offset:10240
  ds_read_b64_tr_b16 a[84:85], v117 offset:16384
  ds_read_b64_tr_b16 a[86:87], v117 offset:22528
  s_waitcnt vmcnt(4)
  s_barrier
  ds_read_b128 a[4:7], v112 offset:0
  ds_read_b128 a[24:27], v113 offset:0
  ds_read_b128 a[8:11], v112 offset:2048
  ds_read_b128 a[28:31], v113 offset:2048
  ds_read_b128 a[12:15], v112 offset:4096
  ds_read_b128 a[32:35], v113 offset:4096
  ds_read_b128 a[16:19], v112 offset:6144
  ds_read_b128 a[36:39], v113 offset:6144
  ds_read_b128 a[0:3], v114 offset:0
  ds_read_b128 a[20:23], v115 offset:0
  s_add_u32 s44, s67, s40
  s_add_u32 s44, s44, 4
  s_and_b32 s44, s44, 15
  s_mul_i32 s44, s44, s61
  s_lshl_b32 s45, s40, 10
  s_add_u32 m0, s45, 126976
  s_add_u32 s44, s44, s73
  buffer_load_dwordx4 v126, s[28:31], s44 offen sc1 lds
  s_add_u32 s44, s67, s40
  s_add_u32 s44, s44, 8
  s_and_b32 s44, s44, 15
  s_mul_i32 s44, s44, s61
  s_lshl_b32 s45, s40, 10
  s_add_u32 m0, s45, 131072
  s_add_u32 s44, s44, s73
  buffer_load_dwordx4 v126, s[28:31], s44 offen sc1 lds
  s_add_u32 s44, s67, s40
  s_add_u32 s44, s44, 12
  s_and_b32 s44, s44, 15
  s_mul_i32 s44, s44, s61
  s_lshl_b32 s45, s40, 10
  s_add_u32 m0, s45, 135168
  s_add_u32 s44, s44, s73
  buffer_load_dwordx4 v126, s[28:31], s44 offen sc1 lds
  s_add_u32 s44, s67, 2
  s_and_b32 s44, s44, 15
  s_mul_i32 s45, s44, s61
  s_add_u32 s68, s45, s59
  s_add_u32 m0, s62, 106496
  s_nop 0
  buffer_load_dwordx4 v120, s[28:31], s68 offen offset:0 sc1  lds
  buffer_load_dwordx4 v121, s[28:31], s68 offen offset:1024 sc1  lds
  buffer_load_dwordx4 v122, s[28:31], s68 offen offset:2048 sc1  lds
  buffer_load_dwordx4 v123, s[28:31], s68 offen offset:3072 sc1  lds
  s_waitcnt lgkmcnt(0)
Lp1_common:
  s_mov_b32 s66, 4
  s_add_u32 s44, s67, 3
  s_and_b32 s44, s44, 15
  s_mul_i32 s45, s44, s61
  s_add_u32 s68, s45, s59
  s_mov_b32 s56, 2
.p2align 3
Lp1_loop:
  s_waitcnt lgkmcnt(15)
  v_mfma_f32_16x16x32_bf16 v[0:3], a[40:43], a[4:7], v[0:3]
  s_mul_i32 s45, s44, 393216
  v_mfma_f32_16x16x32_bf16 v[0:3], a[64:67], a[24:27], v[0:3]
  s_add_u32 s69, s45, s60
  v_mfma_f32_16x16x32_bf16 v[4:7], a[64:67], a[28:31], v[4:7]
  s_add_u32 s70, s69, 4096
  v_mfma_f32_16x16x32_bf16 v[4:7], a[40:43], a[8:11], v[4:7]
  v_mfma_f32_16x16x32_bf16 v[8:11], a[40:43], a[12:15], v[8:11]
  s_waitcnt vmcnt(7) lgkmcnt(0)
  s_barrier
  ds_read_b64_tr_b16 a[128:129], v116 offset:24576
  v_mfma_f32_16x16x32_bf16 v[8:11], a[64:67], a[32:35], v[8:11]
  ds_read_b64_tr_b16 a[130:131], v116 offset:30720
  v_mfma_f32_16x16x32_bf16 v[12:15], a[64:67], a[36:39], v[12:15]
  s_add_u32 m0, s62, 73728
  ds_read_b64_tr_b16 a[152:153], v116 offset:36864
  v_mfma_f32_16x16x32_bf16 v[12:15], a[40:43], a[16:19], v[12:15]
  buffer_load_dwordx4 v120, s[28:31], s68 offen offset:0 sc1  lds
  v_mfma_f32_16x16x32_bf16 v[28:31], a[44:47], a[16:19], v[28:31]
  ds_read_b64_tr_b16 a[154:155], v116 offset:43008
  v_mfma_f32_16x16x32_bf16 v[28:31], a[68:71], a[36:39], v[28:31]
  ds_read_b128 a[92:95], v112 offset:16384
  v_mfma_f32_16x16x32_bf16 v[24:27], a[68:71], a[32:35], v[24:27]
  ds_read_b128 a[112:115], v113 offset:16384
  v_mfma_f32_16x16x32_bf16 v[24:27], a[44:47], a[12:15], v[24:27]
  buffer_load_dwordx4 v121, s[28:31], s68 offen offset:1024 sc1  lds
  v_mfma_f32_16x16x32_bf16 v[20:23], a[44:47], a[8:11], v[20:23]
  ds_read_b128 a[96:99], v112 offset:18432
  v_mfma_f32_16x16x32_bf16 v[20:23], a[68:71], a[28:31], v[20:23]
  ds_read_b128 a[116:119], v113 offset:18432
  v_mfma_f32_16x16x32_bf16 v[16:19], a[68:71], a[24:27], v[16:19]
  ds_read_b128 a[100:103], v112 offset:20480
  v_mfma_f32_16x16x32_bf16 v[16:19], a[44:47], a[4:7], v[16:19]
  buffer_load_dwordx4 v122, s[28:31], s68 offen offset:2048 sc1  lds
  v_mfma_f32_16x16x32_bf16 v[96:99], a[48:51], a[0:3], v[96:99]
  ds_read_b128 a[120:123], v113 offset:20480
  v_mfma_f32_16x16x32_bf16 v[96:99], a[72:75], a[20:23], v[96:99]
  ds_read_b128 a[104:107], v112 offset:22528
  v_mfma_f32_16x16x32_bf16 v[32:35], a[72:75], a[24:27], v[32:35]
  ds_read_b128 a[124:127], v113 offset:22528
  v_mfma_f32_16x16x32_bf16 v[32:35], a[48:51], a[4:7], v[32:35]
  buffer_load_dwordx4 v123, s[28:31], s68 offen offset:3072 sc1  lds
  v_mfma_f32_16x16x32_bf16 v[36:39], a[48:51], a[8:11], v[36:39]
  ds_read_b64_tr_b16 a[132:133], v117 offset:24576
  v_mfma_f32_16x16x32_bf16 v[36:39], a[72:75], a[28:31], v[36:39]
  ds_read_b64_tr_b16 a[134:135], v117 offset:30720
  v_mfma_f32_16x16x32_bf16 v[40:43], a[72:75], a[32:35], v[40:43]
  s_add_u32 m0, s63, 0
  ds_read_b64_tr_b16 a[156:157], v117 offset:36864
  v_mfma_f32_16x16x32_bf16 v[40:43], a[48:51], a[12:15], v[40:43]
  buffer_load_dwordx4 v124, s[8:11], s69 offen offset:0  lds
  v_mfma_f32_16x16x32_bf16 v[44:47], a[48:51], a[16:19], v[44:47]
  s_add_u32 s44, s44, 1
  ds_read_b64_tr_b16 a[158:159], v117 offset:43008
  v_mfma_f32_16x16x32_bf16 v[44:47], a[72:75], a[36:39], v[44:47]
  s_and_b32 s44, s44, 15
  ds_read_b128 a[88:91], v114 offset:1024
  v_mfma_f32_16x16x32_bf16 v[60:63], a[76:79], a[36:39], v[60:63]
  s_add_u32 s66, s66, 1
  ds_read_b128 a[108:111], v115 offset:1024
  v_mfma_f32_16x16x32_bf16 v[60:63], a[52:55], a[16:19], v[60:63]
  s_mul_i32 s45, s44, s61
  buffer_load_dwordx4 v125, s[8:11], s69 offen offset:1024  lds
  v_mfma_f32_16x16x32_bf16 v[56:59], a[52:55], a[12:15], v[56:59]
  s_add_u32 s68, s45, s59
  ds_read_b64_tr_b16 a[136:137], v116 offset:26624
  v_mfma_f32_16x16x32_bf16 v[56:59], a[76:79], a[32:35], v[56:59]
  ds_read_b64_tr_b16 a[138:139], v116 offset:32768
  v_mfma_f32_16x16x32_bf16 v[52:55], a[76:79], a[28:31], v[52:55]
  ds_read_b64_tr_b16 a[160:161], v116 offset:38912
  v_mfma_f32_16x16x32_bf16 v[52:55], a[52:55], a[8:11], v[52:55]
  buffer_load_dwordx4 v124, s[8:11], s69 offen offset:2048  lds
  v_mfma_f32_16x16x32_bf16 v[48:51], a[52:55], a[4:7], v[48:51]
  ds_read_b64_tr_b16 a[162:163], v116 offset:45056
  v_mfma_f32_16x16x32_bf16 v[48:51], a[76:79], a[24:27], v[48:51]
  ds_read_b64_tr_b16 a[140:141], v117 offset:26624
  v_mfma_f32_16x16x32_bf16 v[100:103], a[20:23], a[80:83], v[100:103]
  ds_read_b64_tr_b16 a[142:143], v117 offset:32768
  v_mfma_f32_16x16x32_bf16 v[100:103], a[0:3], a[56:59], v[100:103]
  buffer_load_dwordx4 v125, s[8:11], s69 offen offset:3072  lds
  v_mfma_f32_16x16x32_bf16 v[64:67], a[4:7], a[56:59], v[64:67]
  ds_read_b64_tr_b16 a[164:165], v117 offset:38912
  v_mfma_f32_16x16x32_bf16 v[64:67], a[24:27], a[80:83], v[64:67]
  ds_read_b64_tr_b16 a[166:167], v117 offset:45056
  v_mfma_f32_16x16x32_bf16 v[68:71], a[28:31], a[80:83], v[68:71]
  s_add_u32 m0, s63, 4096
  ds_read_b64_tr_b16 a[144:145], v116 offset:28672
  v_mfma_f32_16x16x32_bf16 v[68:71], a[8:11], a[56:59], v[68:71]
  buffer_load_dwordx4 v124, s[8:11], s70 offen offset:0  lds
  v_mfma_f32_16x16x32_bf16 v[72:75], a[12:15], a[56:59], v[72:75]
  ds_read_b64_tr_b16 a[146:147], v116 offset:34816
  v_mfma_f32_16x16x32_bf16 v[72:75], a[32:35], a[80:83], v[72:75]
  ds_read_b64_tr_b16 a[168:169], v116 offset:40960
  v_mfma_f32_16x16x32_bf16 v[76:79], a[36:39], a[80:83], v[76:79]
  ds_read_b64_tr_b16 a[170:171], v116 offset:47104
  v_mfma_f32_16x16x32_bf16 v[76:79], a[16:19], a[56:59], v[76:79]
  buffer_load_dwordx4 v125, s[8:11], s70 offen offset:1024  lds
  v_mfma_f32_16x16x32_bf16 v[92:95], a[16:19], a[60:63], v[92:95]
  ds_read_b64_tr_b16 a[148:149], v117 offset:28672
  v_mfma_f32_16x16x32_bf16 v[92:95], a[36:39], a[84:87], v[92:95]
  ds_read_b64_tr_b16 a[150:151], v117 offset:34816
  v_mfma_f32_16x16x32_bf16 v[88:91], a[32:35], a[84:87], v[88:91]
  ds_read_b64_tr_b16 a[172:173], v117 offset:40960
  v_mfma_f32_16x16x32_bf16 v[88:91], a[12:15], a[60:63], v[88:91]
  ds_read_b64_tr_b16 a[174:175], v117 offset:47104
  v_mfma_f32_16x16x32_bf16 v[84:87], a[8:11], a[60:63], v[84:87]
  s_cmp_eq_u32 s66, s88
  s_cbranch_scc1 Lside_k0_c
Lside_k0_r:
  v_mfma_f32_16x16x32_bf16 v[84:87], a[28:31], a[84:87], v[84:87]
  v_mfma_f32_16x16x32_bf16 v[80:83], a[24:27], a[84:87], v[80:83]
  v_mfma_f32_16x16x32_bf16 v[80:83], a[4:7], a[60:63], v[80:83]
Lp1_u1:
  s_waitcnt lgkmcnt(15)
  v_mfma_f32_16x16x32_bf16 v[0:3], a[128:131], a[92:95], v[0:3]
  s_mul_i32 s45, s44, 393216
  v_mfma_f32_16x16x32_bf16 v[0:3], a[152:155], a[112:115], v[0:3]
  s_add_u32 s69, s45, s60
  v_mfma_f32_16x16x32_bf16 v[4:7], a[152:155], a[116:119], v[4:7]
  s_add_u32 s70, s69, 4096
  v_mfma_f32_16x16x32_bf16 v[4:7], a[128:131], a[96:99], v[4:7]
  v_mfma_f32_16x16x32_bf16 v[8:11], a[128:131], a[100:103], v[8:11]
  s_waitcnt vmcnt(10) lgkmcnt(0)
  s_barrier
  ds_read_b64_tr_b16 a[40:41], v118 offset:0
  v_mfma_f32_16x16x32_bf16 v[8:11], a[152:155], a[120:123], v[8:11]
  ds_read_b64_tr_b16 a[42:43], v118 offset:6144
  v_mfma_f32_16x16x32_bf16 v[12:15], a[152:155], a[124:127], v[12:15]
  s_add_u32 m0, s62, 90112
  ds_read_b64_tr_b16 a[64:65], v118 offset:12288
  v_mfma_f32_16x16x32_bf16 v[12:15], a[128:131], a[104:107], v[12:15]
  buffer_load_dwordx4 v120, s[28:31], s68 offen offset:0 sc1  lds
  v_mfma_f32_16x16x32_bf16 v[28:31], a[132:135], a[104:107], v[28:31]
  ds_read_b64_tr_b16 a[66:67], v118 offset:18432
  v_mfma_f32_16x16x32_bf16 v[28:31], a[156:159], a[124:127], v[28:31]
  ds_read_b128 a[4:7], v112 offset:32768
  v_mfma_f32_16x16x32_bf16 v[24:27], a[156:159], a[120:123], v[24:27]
  ds_read_b128 a[24:27], v113 offset:32768
  v_mfma_f32_16x16x32_bf16 v[24:27], a[132:135], a[100:103], v[24:27]
  buffer_load_dwordx4 v121, s[28:31], s68 offen offset:1024 sc1  lds
  v_mfma_f32_16x16x32_bf16 v[20:23], a[132:135], a[96:99], v[20:23]
  ds_read_b128 a[8:11], v112 offset:34816
  v_mfma_f32_16x16x32_bf16 v[20:23], a[156:159], a[116:119], v[20:23]
  ds_read_b128 a[28:31], v113 offset:34816
  v_mfma_f32_16x16x32_bf16 v[16:19], a[156:159], a[112:115], v[16:19]
  ds_read_b128 a[12:15], v112 offset:36864
  v_mfma_f32_16x16x32_bf16 v[16:19], a[132:135], a[92:95], v[16:19]
  buffer_load_dwordx4 v122, s[28:31], s68 offen offset:2048 sc1  lds
  v_mfma_f32_16x16x32_bf16 v[96:99], a[136:139], a[88:91], v[96:99]
  ds_read_b128 a[32:35], v113 offset:36864
  v_mfma_f32_16x16x32_bf16 v[96:99], a[160:163], a[108:111], v[96:99]
  ds_read_b128 a[16:19], v112 offset:38912
  v_mfma_f32_16x16x32_bf16 v[32:35], a[160:163], a[112:115], v[32:35]
  ds_read_b128 a[36:39], v113 offset:38912
  v_mfma_f32_16x16x32_bf16 v[32:35], a[136:139], a[92:95], v[32:35]
  buffer_load_dwordx4 v123, s[28:31], s68 offen offset:3072 sc1  lds
  v_mfma_f32_16x16x32_bf16 v[36:39], a[136:139], a[96:99], v[36:39]
  ds_read_b64_tr_b16 a[44:45], v119 offset:0
  v_mfma_f32_16x16x32_bf16 v[36:39], a[160:163], a[116:119], v[36:39]
  ds_read_b64_tr_b16 a[46:47], v119 offset:6144
  v_mfma_f32_16x16x32_bf16 v[40:43], a[160:163], a[120:123], v[40:43]
  s_add_u32 m0, s63, 24576
  ds_read_b64_tr_b16 a[68:69], v119 offset:12288
  v_mfma_f32_16x16x32_bf16 v[40:43], a[136:139], a[100:103], v[40:43]
  buffer_load_dwordx4 v124, s[8:11], s69 offen offset:0  lds
  v_mfma_f32_16x16x32_bf16 v[44:47], a[136:139], a[104:107], v[44:47]
  s_add_u32 s44, s44, 1
  ds_read_b64_tr_b16 a[70:71], v119 offset:18432
  v_mfma_f32_16x16x32_bf16 v[44:47], a[160:163], a[124:127], v[44:47]
  s_and_b32 s44, s44, 15
  ds_read_b128 a[0:3], v114 offset:2048
  v_mfma_f32_16x16x32_bf16 v[60:63], a[164:167], a[124:127], v[60:63]
  s_add_u32 s66, s66, 1
  ds_read_b128 a[20:23], v115 offset:2048
  v_mfma_f32_16x16x32_bf16 v[60:63], a[140:143], a[104:107], v[60:63]
  s_mul_i32 s45, s44, s61
  buffer_load_dwordx4 v125, s[8:11], s69 offen offset:1024  lds
  v_mfma_f32_16x16x32_bf16 v[56:59], a[140:143], a[100:103], v[56:59]
  s_add_u32 s68, s45, s59
  ds_read_b64_tr_b16 a[48:49], v118 offset:2048
  v_mfma_f32_16x16x32_bf16 v[56:59], a[164:167], a[120:123], v[56:59]
  ds_read_b64_tr_b16 a[50:51], v118 offset:8192
  v_mfma_f32_16x16x32_bf16 v[52:55], a[164:167], a[116:119], v[52:55]
  ds_read_b64_tr_b16 a[72:73], v118 offset:14336
  v_mfma_f32_16x16x32_bf16 v[52:55], a[140:143], a[96:99], v[52:55]
  buffer_load_dwordx4 v124, s[8:11], s69 offen offset:2048  lds
  v_mfma_f32_16x16x32_bf16 v[48:51], a[140:143], a[92:95], v[48:51]
  ds_read_b64_tr_b16 a[74:75], v118 offset:20480
  v_mfma_f32_16x16x32_bf16 v[48:51], a[164:167], a[112:115], v[48:51]
  ds_read_b64_tr_b16 a[52:53], v119 offset:2048
  v_mfma_f32_16x16x32_bf16 v[100:103], a[108:111], a[168:171], v[100:103]
  ds_read_b64_tr_b16 a[54:55], v119 offset:8192
  v_mfma_f32_16x16x32_bf16 v[100:103], a[88:91], a[144:147], v[100:103]
  buffer_load_dwordx4 v125, s[8:11], s69 offen offset:3072  lds
  v_mfma_f32_16x16x32_bf16 v[64:67], a[92:95], a[144:147], v[64:67]
  ds_read_b64_tr_b16 a[76:77], v119 offset:14336
  v_mfma_f32_16x16x32_bf16 v[64:67], a[112:115], a[168:171], v[64:67]
  ds_read_b64_tr_b16 a[78:79], v119 offset:20480
  v_mfma_f32_16x16x32_bf16 v[68:71], a[116:119], a[168:171], v[68:71]
  s_add_u32 m0, s63, 28672
  ds_read_b64_tr_b16 a[56:57], v118 offset:4096
  v_mfma_f32_16x16x32_bf16 v[68:71], a[96:99], a[144:147], v[68:71]
  buffer_load_dwordx4 v124, s[8:11], s70 offen offset:0  lds
  v_mfma_f32_16x16x32_bf16 v[72:75], a[100:103], a[144:147], v[72:75]
  ds_read_b64_tr_b16 a[58:59], v118 offset:10240
  v_mfma_f32_16x16x32_bf16 v[72:75], a[120:123], a[168:171], v[72:75]
  ds_read_b64_tr_b16 a[80:81], v118 offset:16384
  v_mfma_f32_16x16x32_bf16 v[76:79], a[124:127], a[168:171], v[76:79]
  ds_read_b64_tr_b16 a[82:83], v118 offset:22528
  v_mfma_f32_16x16x32_bf16 v[76:79], a[104:107], a[144:147], v[76:79]
  buffer_load_dwordx4 v125, s[8:11], s70 offen offset:1024  lds
  v_mfma_f32_16x16x32_bf16 v[92:95], a[104:107], a[148:151], v[92:95]
  ds_read_b64_tr_b16 a[60:61], v119 offset:4096
  v_mfma_f32_16x16x32_bf16 v[92:95], a[124:127], a[172:175], v[92:95]
  ds_read_b64_tr_b16 a[62:63], v119 offset:10240
  v_mfma_f32_16x16x32_bf16 v[88:91], a[120:123], a[172:175], v[88:91]
  ds_read_b64_tr_b16 a[84:85], v119 offset:16384
  v_mfma_f32_16x16x32_bf16 v[88:91], a[100:103], a[148:151], v[88:91]
  ds_read_b64_tr_b16 a[86:87], v119 offset:22528
  v_mfma_f32_16x16x32_bf16 v[84:87], a[96:99], a[148:151], v[84:87]
  s_cmp_eq_u32 s66, s88
  s_cbranch_scc1 Lside_k1_c
Lside_k1_r:
  v_mfma_f32_16x16x32_bf16 v[84:87], a[116:119], a[172:175], v[84:87]
  v_mfma_f32_16x16x32_bf16 v[80:83], a[112:115], a[172:175], v[80:83]
  v_mfma_f32_16x16x32_bf16 v[80:83], a[92:95], a[148:151], v[80:83]
  s_waitcnt lgkmcnt(15)
  v_mfma_f32_16x16x32_bf16 v[0:3], a[40:43], a[4:7], v[0:3]
  s_mul_i32 s45, s44, 393216
  v_mfma_f32_16x16x32_bf16 v[0:3], a[64:67], a[24:27], v[0:3]
  s_add_u32 s69, s45, s60
  v_mfma_f32_16x16x32_bf16 v[4:7], a[64:67], a[28:31], v[4:7]
  s_add_u32 s70, s69, 4096
  v_mfma_f32_16x16x32_bf16 v[4:7], a[40:43], a[8:11], v[4:7]
  v_mfma_f32_16x16x32_bf16 v[8:11], a[40:43], a[12:15], v[8:11]
  s_waitcnt vmcnt(10) lgkmcnt(0)
  s_barrier
  ds_read_b64_tr_b16 a[128:129], v116 offset:0
  v_mfma_f32_16x16x32_bf16 v[8:11], a[64:67], a[32:35], v[8:11]
  ds_read_b64_tr_b16 a[130:131], v116 offset:6144
  v_mfma_f32_16x16x32_bf16 v[12:15], a[64:67], a[36:39], v[12:15]
  s_add_u32 m0, s62, 106496
  ds_read_b64_tr_b16 a[152:153], v116 offset:12288
  v_mfma_f32_16x16x32_bf16 v[12:15], a[40:43], a[16:19], v[12:15]
  buffer_load_dwordx4 v120, s[28:31], s68 offen offset:0 sc1  lds
  v_mfma_f32_16x16x32_bf16 v[28:31], a[44:47], a[16:19], v[28:31]
  ds_read_b64_tr_b16 a[154:155], v116 offset:18432
  v_mfma_f32_16x16x32_bf16 v[28:31], a[68:71], a[36:39], v[28:31]
  ds_read_b128 a[92:95], v112 offset:0
  v_mfma_f32_16x16x32_bf16 v[24:27], a[68:71], a[32:35], v[24:27]
  ds_read_b128 a[112:115], v113 offset:0
  v_mfma_f32_16x16x32_bf16 v[24:27], a[44:47], a[12:15], v[24:27]
  buffer_load_dwordx4 v121, s[28:31], s68 offen offset:1024 sc1  lds
  v_mfma_f32_16x16x32_bf16 v[20:23], a[44:47], a[8:11], v[20:23]
  ds_read_b128 a[96:99], v112 offset:2048
  v_mfma_f32_16x16x32_bf16 v[20:23], a[68:71], a[28:31], v[20:23]
  ds_read_b128 a[116:119], v113 offset:2048
  v_mfma_f32_16x16x32_bf16 v[16:19], a[68:71], a[24:27], v[16:19]
  ds_read_b128 a[100:103], v112 offset:4096
  v_mfma_f32_16x16x32_bf16 v[16:19], a[44:47], a[4:7], v[16:19]
  buffer_load_dwordx4 v122, s[28:31], s68 offen offset:2048 sc1  lds
  v_mfma_f32_16x16x32_bf16 v[96:99], a[48:51], a[0:3], v[96:99]
  ds_read_b128 a[120:123], v113 offset:4096
  v_mfma_f32_16x16x32_bf16 v[96:99], a[72:75], a[20:23], v[96:99]
  ds_read_b128 a[104:107], v112 offset:6144
  v_mfma_f32_16x16x32_bf16 v[32:35], a[72:75], a[24:27], v[32:35]
  ds_read_b128 a[124:127], v113 offset:6144
  v_mfma_f32_16x16x32_bf16 v[32:35], a[48:51], a[4:7], v[32:35]
  buffer_load_dwordx4 v123, s[28:31], s68 offen offset:3072 sc1  lds
  v_mfma_f32_16x16x32_bf16 v[36:39], a[48:51], a[8:11], v[36:39]
  ds_read_b64_tr_b16 a[132:133], v117 offset:0
  v_mfma_f32_16x16x32_bf16 v[36:39], a[72:75], a[28:31], v[36:39]
  ds_read_b64_tr_b16 a[134:135], v117 offset:6144
  v_mfma_f32_16x16x32_bf16 v[40:43], a[72:75], a[32:35], v[40:43]
  s_add_u32 m0, s63, 49152
  ds_read_b64_tr_b16 a[156:157], v117 offset:12288
  v_mfma_f32_16x16x32_bf16 v[40:43], a[48:51], a[12:15], v[40:43]
  buffer_load_dwordx4 v124, s[8:11], s69 offen offset:0  lds
  v_mfma_f32_16x16x32_bf16 v[44:47], a[48:51], a[16:19], v[44:47]
  s_add_u32 s44, s44, 1
  ds_read_b64_tr_b16 a[158:159], v117 offset:18432
  v_mfma_f32_16x16x32_bf16 v[44:47], a[72:75], a[36:39], v[44:47]
  s_and_b32 s44, s44, 15
  ds_read_b128 a[88:91], v114 offset:3072
  v_mfma_f32_16x16x32_bf16 v[60:63], a[76:79], a[36:39], v[60:63]
  s_add_u32 s66, s66, 1
  ds_read_b128 a[108:111], v115 offset:3072
  v_mfma_f32_16x16x32_bf16 v[60:63], a[52:55], a[16:19], v[60:63]
  s_mul_i32 s45, s44, s61
  buffer_load_dwordx4 v125, s[8:11], s69 offen offset:1024  lds
  v_mfma_f32_16x16x32_bf16 v[56:59], a[52:55], a[12:15], v[56:59]
  s_add_u32 s68, s45, s59
  ds_read_b64_tr_b16 a[136:137], v116 offset:2048
  v_mfma_f32_16x16x32_bf16 v[56:59], a[76:79], a[32:35], v[56:59]
  ds_read_b64_tr_b16 a[138:139], v116 offset:8192
  v_mfma_f32_16x16x32_bf16 v[52:55], a[76:79], a[28:31], v[52:55]
  ds_read_b64_tr_b16 a[160:161], v116 offset:14336
  v_mfma_f32_16x16x32_bf16 v[52:55], a[52:55], a[8:11], v[52:55]
  buffer_load_dwordx4 v124, s[8:11], s69 offen offset:2048  lds
  v_mfma_f32_16x16x32_bf16 v[48:51], a[52:55], a[4:7], v[48:51]
  ds_read_b64_tr_b16 a[162:163], v116 offset:20480
  v_mfma_f32_16x16x32_bf16 v[48:51], a[76:79], a[24:27], v[48:51]
  ds_read_b64_tr_b16 a[140:141], v117 offset:2048
  v_mfma_f32_16x16x32_bf16 v[100:103], a[20:23], a[80:83], v[100:103]
  ds_read_b64_tr_b16 a[142:143], v117 offset:8192
  v_mfma_f32_16x16x32_bf16 v[100:103], a[0:3], a[56:59], v[100:103]
  buffer_load_dwordx4 v125, s[8:11], s69 offen offset:3072  lds
  v_mfma_f32_16x16x32_bf16 v[64:67], a[4:7], a[56:59], v[64:67]
  ds_read_b64_tr_b16 a[164:165], v117 offset:14336
  v_mfma_f32_16x16x32_bf16 v[64:67], a[24:27], a[80:83], v[64:67]
  ds_read_b64_tr_b16 a[166:167], v117 offset:20480
  v_mfma_f32_16x16x32_bf16 v[68:71], a[28:31], a[80:83], v[68:71]
  s_add_u32 m0, s63, 53248
  ds_read_b64_tr_b16 a[144:145], v116 offset:4096
  v_mfma_f32_16x16x32_bf16 v[68:71], a[8:11], a[56:59], v[68:71]
  buffer_load_dwordx4 v124, s[8:11], s70 offen offset:0  lds
  v_mfma_f32_16x16x32_bf16 v[72:75], a[12:15], a[56:59], v[72:75]
  ds_read_b64_tr_b16 a[146:147], v116 offset:10240
  v_mfma_f32_16x16x32_bf16 v[72:75], a[32:35], a[80:83], v[72:75]
  ds_read_b64_tr_b16 a[168:169], v116 offset:16384
  v_mfma_f32_16x16x32_bf16 v[76:79], a[36:39], a[80:83], v[76:79]
  ds_read_b64_tr_b16 a[170:171], v116 offset:22528
  v_mfma_f32_16x16x32_bf16 v[76:79], a[16:19], a[56:59], v[76:79]
  buffer_load_dwordx4 v125, s[8:11], s70 offen offset:1024  lds
  v_mfma_f32_16x16x32_bf16 v[92:95], a[16:19], a[60:63], v[92:95]
  ds_read_b64_tr_b16 a[148:149], v117 offset:4096
  v_mfma_f32_16x16x32_bf16 v[92:95], a[36:39], a[84:87], v[92:95]
  ds_read_b64_tr_b16 a[150:151], v117 offset:10240
  v_mfma_f32_16x16x32_bf16 v[88:91], a[32:35], a[84:87], v[88:91]
  ds_read_b64_tr_b16 a[172:173], v117 offset:16384
  v_mfma_f32_16x16x32_bf16 v[88:91], a[12:15], a[60:63], v[88:91]
  ds_read_b64_tr_b16 a[174:175], v117 offset:22528
  v_mfma_f32_16x16x32_bf16 v[84:87], a[8:11], a[60:63], v[84:87]
  s_cmp_eq_u32 s66, s88
  s_cbranch_scc1 Lside_k2_c
Lside_k2_r:
  v_mfma_f32_16x16x32_bf16 v[84:87], a[28:31], a[84:87], v[84:87]
  v_mfma_f32_16x16x32_bf16 v[80:83], a[24:27], a[84:87], v[80:83]
  v_mfma_f32_16x16x32_bf16 v[80:83], a[4:7], a[60:63], v[80:83]
  s_waitcnt lgkmcnt(15)
  v_mfma_f32_16x16x32_bf16 v[0:3], a[128:131], a[92:95], v[0:3]
  s_mul_i32 s45, s44, 393216
  v_mfma_f32_16x16x32_bf16 v[0:3], a[152:155], a[112:115], v[0:3]
  s_add_u32 s69, s45, s60
  v_mfma_f32_16x16x32_bf16 v[4:7], a[152:155], a[116:119], v[4:7]
  s_add_u32 s70, s69, 4096
  v_mfma_f32_16x16x32_bf16 v[4:7], a[128:131], a[96:99], v[4:7]
  v_mfma_f32_16x16x32_bf16 v[8:11], a[128:131], a[100:103], v[8:11]
  s_waitcnt vmcnt(10) lgkmcnt(0)
  s_barrier
  ds_read_b64_tr_b16 a[40:41], v116 offset:24576
  v_mfma_f32_16x16x32_bf16 v[8:11], a[152:155], a[120:123], v[8:11]
  ds_read_b64_tr_b16 a[42:43], v116 offset:30720
  v_mfma_f32_16x16x32_bf16 v[12:15], a[152:155], a[124:127], v[12:15]
  s_add_u32 m0, s62, 73728
  ds_read_b64_tr_b16 a[64:65], v116 offset:36864
  v_mfma_f32_16x16x32_bf16 v[12:15], a[128:131], a[104:107], v[12:15]
  buffer_load_dwordx4 v120, s[28:31], s68 offen offset:0 sc1  lds
  v_mfma_f32_16x16x32_bf16 v[28:31], a[132:135], a[104:107], v[28:31]
  ds_read_b64_tr_b16 a[66:67], v116 offset:43008
  v_mfma_f32_16x16x32_bf16 v[28:31], a[156:159], a[124:127], v[28:31]
  ds_read_b128 a[4:7], v112 offset:16384
  v_mfma_f32_16x16x32_bf16 v[24:27], a[156:159], a[120:123], v[24:27]
  ds_read_b128 a[24:27], v113 offset:16384
  v_mfma_f32_16x16x32_bf16 v[24:27], a[132:135], a[100:103], v[24:27]
  buffer_load_dwordx4 v121, s[28:31], s68 offen offset:1024 sc1  lds
  v_mfma_f32_16x16x32_bf16 v[20:23], a[132:135], a[96:99], v[20:23]
  ds_read_b128 a[8:11], v112 offset:18432
  v_mfma_f32_16x16x32_bf16 v[20:23], a[156:159], a[116:119], v[20:23]
  ds_read_b128 a[28:31], v113 offset:18432
  v_mfma_f32_16x16x32_bf16 v[16:19], a[156:159], a[112:115], v[16:19]
  ds_read_b128 a[12:15], v112 offset:20480
  v_mfma_f32_16x16x32_bf16 v[16:19], a[132:135], a[92:95], v[16:19]
  buffer_load_dwordx4 v122, s[28:31], s68 offen offset:2048 sc1  lds
  v_mfma_f32_16x16x32_bf16 v[96:99], a[136:139], a[88:91], v[96:99]
  ds_read_b128 a[32:35], v113 offset:20480
  v_mfma_f32_16x16x32_bf16 v[96:99], a[160:163], a[108:111], v[96:99]
  ds_read_b128 a[16:19], v112 offset:22528
  v_mfma_f32_16x16x32_bf16 v[32:35], a[160:163], a[112:115], v[32:35]
  ds_read_b128 a[36:39], v113 offset:22528
  v_mfma_f32_16x16x32_bf16 v[32:35], a[136:139], a[92:95], v[32:35]
  buffer_load_dwordx4 v123, s[28:31], s68 offen offset:3072 sc1  lds
  v_mfma_f32_16x16x32_bf16 v[36:39], a[136:139], a[96:99], v[36:39]
  ds_read_b64_tr_b16 a[44:45], v117 offset:24576
  v_mfma_f32_16x16x32_bf16 v[36:39], a[160:163], a[116:119], v[36:39]
  ds_read_b64_tr_b16 a[46:47], v117 offset:30720
  v_mfma_f32_16x16x32_bf16 v[40:43], a[160:163], a[120:123], v[40:43]
  s_add_u32 m0, s63, 0
  ds_read_b64_tr_b16 a[68:69], v117 offset:36864
  v_mfma_f32_16x16x32_bf16 v[40:43], a[136:139], a[100:103], v[40:43]
  buffer_load_dwordx4 v124, s[8:11], s69 offen offset:0  lds
  v_mfma_f32_16x16x32_bf16 v[44:47], a[136:139], a[104:107], v[44:47]
  s_add_u32 s44, s44, 1
  ds_read_b64_tr_b16 a[70:71], v117 offset:43008
  v_mfma_f32_16x16x32_bf16 v[44:47], a[160:163], a[124:127], v[44:47]
  s_and_b32 s44, s44, 15
  ds_read_b128 a[0:3], v114 offset:4096
  v_mfma_f32_16x16x32_bf16 v[60:63], a[164:167], a[124:127], v[60:63]
  s_add_u32 s66, s66, 1
  ds_read_b128 a[20:23], v115 offset:4096
  v_mfma_f32_16x16x32_bf16 v[60:63], a[140:143], a[104:107], v[60:63]
  s_mul_i32 s45, s44, s61
  buffer_load_dwordx4 v125, s[8:11], s69 offen offset:1024  lds
  v_mfma_f32_16x16x32_bf16 v[56:59], a[140:143], a[100:103], v[56:59]
  s_add_u32 s68, s45, s59
  ds_read_b64_tr_b16 a[48:49], v116 offset:26624
  v_mfma_f32_16x16x32_bf16 v[56:59], a[164:167], a[120:123], v[56:59]
  ds_read_b64_tr_b16 a[50:51], v116 offset:32768
  v_mfma_f32_16x16x32_bf16 v[52:55], a[164:167], a[116:119], v[52:55]
  ds_read_b64_tr_b16 a[72:73], v116 offset:38912
  v_mfma_f32_16x16x32_bf16 v[52:55], a[140:143], a[96:99], v[52:55]
  buffer_load_dwordx4 v124, s[8:11], s69 offen offset:2048  lds
  v_mfma_f32_16x16x32_bf16 v[48:51], a[140:143], a[92:95], v[48:51]
  ds_read_b64_tr_b16 a[74:75], v116 offset:45056
  v_mfma_f32_16x16x32_bf16 v[48:51], a[164:167], a[112:115], v[48:51]
  ds_read_b64_tr_b16 a[52:53], v117 offset:26624
  v_mfma_f32_16x16x32_bf16 v[100:103], a[108:111], a[168:171], v[100:103]
  ds_read_b64_tr_b16 a[54:55], v117 offset:32768
  v_mfma_f32_16x16x32_bf16 v[100:103], a[88:91], a[144:147], v[100:103]
  buffer_load_dwordx4 v125, s[8:11], s69 offen offset:3072  lds
  v_mfma_f32_16x16x32_bf16 v[64:67], a[92:95], a[144:147], v[64:67]
  ds_read_b64_tr_b16 a[76:77], v117 offset:38912
  v_mfma_f32_16x16x32_bf16 v[64:67], a[112:115], a[168:171], v[64:67]
  ds_read_b64_tr_b16 a[78:79], v117 offset:45056
  v_mfma_f32_16x16x32_bf16 v[68:71], a[116:119], a[168:171], v[68:71]
  s_add_u32 m0, s63, 4096
  ds_read_b64_tr_b16 a[56:57], v116 offset:28672
  v_mfma_f32_16x16x32_bf16 v[68:71], a[96:99], a[144:147], v[68:71]
  buffer_load_dwordx4 v124, s[8:11], s70 offen offset:0  lds
  v_mfma_f32_16x16x32_bf16 v[72:75], a[100:103], a[144:147], v[72:75]
  ds_read_b64_tr_b16 a[58:59], v116 offset:34816
  v_mfma_f32_16x16x32_bf16 v[72:75], a[120:123], a[168:171], v[72:75]
  ds_read_b64_tr_b16 a[80:81], v116 offset:40960
  v_mfma_f32_16x16x32_bf16 v[76:79], a[124:127], a[168:171], v[76:79]
  ds_read_b64_tr_b16 a[82:83], v116 offset:47104
  v_mfma_f32_16x16x32_bf16 v[76:79], a[104:107], a[144:147], v[76:79]
  buffer_load_dwordx4 v125, s[8:11], s70 offen offset:1024  lds
  v_mfma_f32_16x16x32_bf16 v[92:95], a[104:107], a[148:151], v[92:95]
  ds_read_b64_tr_b16 a[60:61], v117 offset:28672
  v_mfma_f32_16x16x32_bf16 v[92:95], a[124:127], a[172:175], v[92:95]
  ds_read_b64_tr_b16 a[62:63], v117 offset:34816
  v_mfma_f32_16x16x32_bf16 v[88:91], a[120:123], a[172:175], v[88:91]
  ds_read_b64_tr_b16 a[84:85], v117 offset:40960
  v_mfma_f32_16x16x32_bf16 v[88:91], a[100:103], a[148:151], v[88:91]
  ds_read_b64_tr_b16 a[86:87], v117 offset:47104
  v_mfma_f32_16x16x32_bf16 v[84:87], a[96:99], a[148:151], v[84:87]
  s_cmp_eq_u32 s66, s88
  s_cbranch_scc1 Lside_k3_c
Lside_k3_r:
  v_mfma_f32_16x16x32_bf16 v[84:87], a[116:119], a[172:175], v[84:87]
  v_mfma_f32_16x16x32_bf16 v[80:83], a[112:115], a[172:175], v[80:83]
  v_mfma_f32_16x16x32_bf16 v[80:83], a[92:95], a[148:151], v[80:83]
  s_waitcnt lgkmcnt(15)
  v_mfma_f32_16x16x32_bf16 v[0:3], a[40:43], a[4:7], v[0:3]
  s_mul_i32 s45, s44, 393216
  v_mfma_f32_16x16x32_bf16 v[0:3], a[64:67], a[24:27], v[0:3]
  s_add_u32 s69, s45, s60
  v_mfma_f32_16x16x32_bf16 v[4:7], a[64:67], a[28:31], v[4:7]
  s_add_u32 s70, s69, 4096
  v_mfma_f32_16x16x32_bf16 v[4:7], a[40:43], a[8:11], v[4:7]
  v_mfma_f32_16x16x32_bf16 v[8:11], a[40:43], a[12:15], v[8:11]
  s_waitcnt vmcnt(10) lgkmcnt(0)
  s_barrier
  ds_read_b64_tr_b16 a[128:129], v118 offset:0
  v_mfma_f32_16x16x32_bf16 v[8:11], a[64:67], a[32:35], v[8:11]
  ds_read_b64_tr_b16 a[130:131], v118 offset:6144
  v_mfma_f32_16x16x32_bf16 v[12:15], a[64:67], a[36:39], v[12:15]
  s_add_u32 m0, s62, 90112
  ds_read_b64_tr_b16 a[152:153], v118 offset:12288
  v_mfma_f32_16x16x32_bf16 v[12:15], a[40:43], a[16:19], v[12:15]
  buffer_load_dwordx4 v120, s[28:31], s68 offen offset:0 sc1  lds
  v_mfma_f32_16x16x32_bf16 v[28:31], a[44:47], a[16:19], v[28:31]
  ds_read_b64_tr_b16 a[154:155], v118 offset:18432
  v_mfma_f32_16x16x32_bf16 v[28:31], a[68:71], a[36:39], v[28:31]
  ds_read_b128 a[92:95], v112 offset:32768
  v_mfma_f32_16x16x32_bf16 v[24:27], a[68:71], a[32:35], v[24:27]
  ds_read_b128 a[112:115], v113 offset:32768
  v_mfma_f32_16x16x32_bf16 v[24:27], a[44:47], a[12:15], v[24:27]
  buffer_load_dwordx4 v121, s[28:31], s68 offen offset:1024 sc1  lds
  v_mfma_f32_16x16x32_bf16 v[20:23], a[44:47], a[8:11], v[20:23]
  ds_read_b128 a[96:99], v112 offset:34816
  v_mfma_f32_16x16x32_bf16 v[20:23], a[68:71], a[28:31], v[20:23]
  ds_read_b128 a[116:119], v113 offset:34816
  v_mfma_f32_16x16x32_bf16 v[16:19], a[68:71], a[24:27], v[16:19]
  ds_read_b128 a[100:103], v112 offset:36864
  v_mfma_f32_16x16x32_bf16 v[16:19], a[44:47], a[4:7], v[16:19]
  buffer_load_dwordx4 v122, s[28:31], s68 offen offset:2048 sc1  lds
  v_mfma_f32_16x16x32_bf16 v[96:99], a[48:51], a[0:3], v[96:99]
  ds_read_b128 a[120:123], v113 offset:36864
  v_mfma_f32_16x16x32_bf16 v[96:99], a[72:75], a[20:23], v[96:99]
  ds_read_b128 a[104:107], v112 offset:38912
  v_mfma_f32_16x16x32_bf16 v[32:35], a[72:75], a[24:27], v[32:35]
  ds_read_b128 a[124:127], v113 offset:38912
  v_mfma_f32_16x16x32_bf16 v[32:35], a[48:51], a[4:7], v[32:35]
  buffer_load_dwordx4 v123, s[28:31], s68 offen offset:3072 sc1  lds
  v_mfma_f32_16x16x32_bf16 v[36:39], a[48:51], a[8:11], v[36:39]
  ds_read_b64_tr_b16 a[132:133], v119 offset:0
  v_mfma_f32_16x16x32_bf16 v[36:39], a[72:75], a[28:31], v[36:39]
  ds_read_b64_tr_b16 a[134:135], v119 offset:6144
  v_mfma_f32_16x16x32_bf16 v[40:43], a[72:75], a[32:35], v[40:43]
  s_add_u32 m0, s63, 24576
  ds_read_b64_tr_b16 a[156:157], v119 offset:12288
  v_mfma_f32_16x16x32_bf16 v[40:43], a[48:51], a[12:15], v[40:43]
  buffer_load_dwordx4 v124, s[8:11], s69 offen offset:0  lds
  v_mfma_f32_16x16x32_bf16 v[44:47], a[48:51], a[16:19], v[44:47]
  s_add_u32 s44, s44, 1
  ds_read_b64_tr_b16 a[158:159], v119 offset:18432
  v_mfma_f32_16x16x32_bf16 v[44:47], a[72:75], a[36:39], v[44:47]
  s_and_b32 s44, s44, 15
  ds_read_b128 a[88:91], v114 offset:5120
  v_mfma_f32_16x16x32_bf16 v[60:63], a[76:79], a[36:39], v[60:63]
  s_add_u32 s66, s66, 1
  ds_read_b128 a[108:111], v115 offset:5120
  v_mfma_f32_16x16x32_bf16 v[60:63], a[52:55], a[16:19], v[60:63]
  s_mul_i32 s45, s44, s61
  buffer_load_dwordx4 v125, s[8:11], s69 offen offset:1024  lds
  v_mfma_f32_16x16x32_bf16 v[56:59], a[52:55], a[12:15], v[56:59]
  s_add_u32 s68, s45, s59
  ds_read_b64_tr_b16 a[136:137], v118 offset:2048
  v_mfma_f32_16x16x32_bf16 v[56:59], a[76:79], a[32:35], v[56:59]
  ds_read_b64_tr_b16 a[138:139], v118 offset:8192
  v_mfma_f32_16x16x32_bf16 v[52:55], a[76:79], a[28:31], v[52:55]
  ds_read_b64_tr_b16 a[160:161], v118 offset:14336
  v_mfma_f32_16x16x32_bf16 v[52:55], a[52:55], a[8:11], v[52:55]
  buffer_load_dwordx4 v124, s[8:11], s69 offen offset:2048  lds
  v_mfma_f32_16x16x32_bf16 v[48:51], a[52:55], a[4:7], v[48:51]
  ds_read_b64_tr_b16 a[162:163], v118 offset:20480
  v_mfma_f32_16x16x32_bf16 v[48:51], a[76:79], a[24:27], v[48:51]
  ds_read_b64_tr_b16 a[140:141], v119 offset:2048
  v_mfma_f32_16x16x32_bf16 v[100:103], a[20:23], a[80:83], v[100:103]
  ds_read_b64_tr_b16 a[142:143], v119 offset:8192
  v_mfma_f32_16x16x32_bf16 v[100:103], a[0:3], a[56:59], v[100:103]
  buffer_load_dwordx4 v125, s[8:11], s69 offen offset:3072  lds
  v_mfma_f32_16x16x32_bf16 v[64:67], a[4:7], a[56:59], v[64:67]
  ds_read_b64_tr_b16 a[164:165], v119 offset:14336
  v_mfma_f32_16x16x32_bf16 v[64:67], a[24:27], a[80:83], v[64:67]
  ds_read_b64_tr_b16 a[166:167], v119 offset:20480
  v_mfma_f32_16x16x32_bf16 v[68:71], a[28:31], a[80:83], v[68:71]
  s_add_u32 m0, s63, 28672
  ds_read_b64_tr_b16 a[144:145], v118 offset:4096
  v_mfma_f32_16x16x32_bf16 v[68:71], a[8:11], a[56:59], v[68:71]
  buffer_load_dwordx4 v124, s[8:11], s70 offen offset:0  lds
  v_mfma_f32_16x16x32_bf16 v[72:75], a[12:15], a[56:59], v[72:75]
  ds_read_b64_tr_b16 a[146:147], v118 offset:10240
  v_mfma_f32_16x16x32_bf16 v[72:75], a[32:35], a[80:83], v[72:75]
  ds_read_b64_tr_b16 a[168:169], v118 offset:16384
  v_mfma_f32_16x16x32_bf16 v[76:79], a[36:39], a[80:83], v[76:79]
  ds_read_b64_tr_b16 a[170:171], v118 offset:22528
  v_mfma_f32_16x16x32_bf16 v[76:79], a[16:19], a[56:59], v[76:79]
  buffer_load_dwordx4 v125, s[8:11], s70 offen offset:1024  lds
  v_mfma_f32_16x16x32_bf16 v[92:95], a[16:19], a[60:63], v[92:95]
  ds_read_b64_tr_b16 a[148:149], v119 offset:4096
  v_mfma_f32_16x16x32_bf16 v[92:95], a[36:39], a[84:87], v[92:95]
  ds_read_b64_tr_b16 a[150:151], v119 offset:10240
  v_mfma_f32_16x16x32_bf16 v[88:91], a[32:35], a[84:87], v[88:91]
  ds_read_b64_tr_b16 a[172:173], v119 offset:16384
  v_mfma_f32_16x16x32_bf16 v[88:91], a[12:15], a[60:63], v[88:91]
  ds_read_b64_tr_b16 a[174:175], v119 offset:22528
  v_mfma_f32_16x16x32_bf16 v[84:87], a[8:11], a[60:63], v[84:87]
  s_cmp_eq_u32 s66, s88
  s_cbranch_scc1 Lside_k4_c
Lside_k4_r:
  v_mfma_f32_16x16x32_bf16 v[84:87], a[28:31], a[84:87], v[84:87]
  v_mfma_f32_16x16x32_bf16 v[80:83], a[24:27], a[84:87], v[80:83]
  v_mfma_f32_16x16x32_bf16 v[80:83], a[4:7], a[60:63], v[80:83]
  s_waitcnt lgkmcnt(15)
  v_mfma_f32_16x16x32_bf16 v[0:3], a[128:131], a[92:95], v[0:3]
  s_mul_i32 s45, s44, 393216
  v_mfma_f32_16x16x32_bf16 v[0:3], a[152:155], a[112:115], v[0:3]
  s_add_u32 s69, s45, s60
  v_mfma_f32_16x16x32_bf16 v[4:7], a[152:155], a[116:119], v[4:7]
  s_add_u32 s70, s69, 4096
  v_mfma_f32_16x16x32_bf16 v[4:7], a[128:131], a[96:99], v[4:7]
  v_mfma_f32_16x16x32_bf16 v[8:11], a[128:131], a[100:103], v[8:11]
  s_waitcnt vmcnt(10) lgkmcnt(0)
  s_barrier
  ds_read_b64_tr_b16 a[40:41], v116 offset:0
  v_mfma_f32_16x16x32_bf16 v[8:11], a[152:155], a[120:123], v[8:11]
  ds_read_b64_tr_b16 a[42:43], v116 offset:6144
  v_mfma_f32_16x16x32_bf16 v[12:15], a[152:155], a[124:127], v[12:15]
  s_add_u32 m0, s62, 106496
  ds_read_b64_tr_b16 a[64:65], v116 offset:12288
  v_mfma_f32_16x16x32_bf16 v[12:15], a[128:131], a[104:107], v[12:15]
  buffer_load_dwordx4 v120, s[28:31], s68 offen offset:0 sc1  lds
  v_mfma_f32_16x16x32_bf16 v[28:31], a[132:135], a[104:107], v[28:31]
  ds_read_b64_tr_b16 a[66:67], v116 offset:18432
  v_mfma_f32_16x16x32_bf16 v[28:31], a[156:159], a[124:127], v[28:31]
  ds_read_b128 a[4:7], v112 offset:0
  v_mfma_f32_16x16x32_bf16 v[24:27], a[156:159], a[120:123], v[24:27]
  ds_read_b128 a[24:27], v113 offset:0
  v_mfma_f32_16x16x32_bf16 v[24:27], a[132:135], a[100:103], v[24:27]
  buffer_load_dwordx4 v121, s[28:31], s68 offen offset:1024 sc1  lds
  v_mfma_f32_16x16x32_bf16 v[20:23], a[132:135], a[96:99], v[20:23]
  ds_read_b128 a[8:11], v112 offset:2048
  v_mfma_f32_16x16x32_bf16 v[20:23], a[156:159], a[116:119], v[20:23]
  ds_read_b128 a[28:31], v113 offset:2048
  v_mfma_f32_16x16x32_bf16 v[16:19], a[156:159], a[112:115], v[16:19]
  ds_read_b128 a[12:15], v112 offset:4096
  v_mfma_f32_16x16x32_bf16 v[16:19], a[132:135], a[92:95], v[16:19]
  buffer_load_dwordx4 v122, s[28:31], s68 offen offset:2048 sc1  lds
  v_mfma_f32_16x16x32_bf16 v[96:99], a[136:139], a[88:91], v[96:99]
  ds_read_b128 a[32:35], v113 offset:4096
  v_mfma_f32_16x16x32_bf16 v[96:99], a[160:163], a[108:111], v[96:99]
  ds_read_b128 a[16:19], v112 offset:6144
  v_mfma_f32_16x16x32_bf16 v[32:35], a[160:163], a[112:115], v[32:35]
  ds_read_b128 a[36:39], v113 offset:6144
  v_mfma_f32_16x16x32_bf16 v[32:35], a[136:139], a[92:95], v[32:35]
  buffer_load_dwordx4 v123, s[28:31], s68 offen offset:3072 sc1  lds
  v_mfma_f32_16x16x32_bf16 v[36:39], a[136:139], a[96:99], v[36:39]
  ds_read_b64_tr_b16 a[44:45], v117 offset:0
  v_mfma_f32_16x16x32_bf16 v[36:39], a[160:163], a[116:119], v[36:39]
  ds_read_b64_tr_b16 a[46:47], v117 offset:6144
  v_mfma_f32_16x16x32_bf16 v[40:43], a[160:163], a[120:123], v[40:43]
  s_add_u32 m0, s63, 49152
  ds_read_b64_tr_b16 a[68:69], v117 offset:12288
  v_mfma_f32_16x16x32_bf16 v[40:43], a[136:139], a[100:103], v[40:43]
  buffer_load_dwordx4 v124, s[8:11], s69 offen offset:0  lds
  v_mfma_f32_16x16x32_bf16 v[44:47], a[136:139], a[104:107], v[44:47]
  s_add_u32 s44, s44, 1
  ds_read_b64_tr_b16 a[70:71], v117 offset:18432
  v_mfma_f32_16x16x32_bf16 v[44:47], a[160:163], a[124:127], v[44:47]
  s_and_b32 s44, s44, 15
  ds_read_b128 a[0:3], v114 offset:6144
  v_add_u32 v114, 6144, v114
  v_mfma_f32_16x16x32_bf16 v[60:63], a[164:167], a[124:127], v[60:63]
  s_add_u32 s66, s66, 1
  ds_read_b128 a[20:23], v115 offset:6144
  v_add_u32 v115, 6144, v115
  v_mfma_f32_16x16x32_bf16 v[60:63], a[140:143], a[104:107], v[60:63]
  s_mul_i32 s45, s44, s61
  buffer_load_dwordx4 v125, s[8:11], s69 offen offset:1024  lds
  v_mfma_f32_16x16x32_bf16 v[56:59], a[140:143], a[100:103], v[56:59]
  s_add_u32 s68, s45, s59
  ds_read_b64_tr_b16 a[48:49], v116 offset:2048
  v_mfma_f32_16x16x32_bf16 v[56:59], a[164:167], a[120:123], v[56:59]
  ds_read_b64_tr_b16 a[50:51], v116 offset:8192
  v_mfma_f32_16x16x32_bf16 v[52:55], a[164:167], a[116:119], v[52:55]
  ds_read_b64_tr_b16 a[72:73], v116 offset:14336
  v_mfma_f32_16x16x32_bf16 v[52:55], a[140:143], a[96:99], v[52:55]
  buffer_load_dwordx4 v124, s[8:11], s69 offen offset:2048  lds
  v_mfma_f32_16x16x32_bf16 v[48:51], a[140:143], a[92:95], v[48:51]
  ds_read_b64_tr_b16 a[74:75], v116 offset:20480
  v_mfma_f32_16x16x32_bf16 v[48:51], a[164:167], a[112:115], v[48:51]
  ds_read_b64_tr_b16 a[52:53], v117 offset:2048
  v_mfma_f32_16x16x32_bf16 v[100:103], a[108:111], a[168:171], v[100:103]
  ds_read_b64_tr_b16 a[54:55], v117 offset:8192
  v_mfma_f32_16x16x32_bf16 v[100:103], a[88:91], a[144:147], v[100:103]
  buffer_load_dwordx4 v125, s[8:11], s69 offen offset:3072  lds
  v_mfma_f32_16x16x32_bf16 v[64:67], a[92:95], a[144:147], v[64:67]
  ds_read_b64_tr_b16 a[76:77], v117 offset:14336
  v_mfma_f32_16x16x32_bf16 v[64:67], a[112:115], a[168:171], v[64:67]
  ds_read_b64_tr_b16 a[78:79], v117 offset:20480
  v_mfma_f32_16x16x32_bf16 v[68:71], a[116:119], a[168:171], v[68:71]
  s_add_u32 m0, s63, 53248
  ds_read_b64_tr_b16 a[56:57], v116 offset:4096
  v_mfma_f32_16x16x32_bf16 v[68:71], a[96:99], a[144:147], v[68:71]
  buffer_load_dwordx4 v124, s[8:11], s70 offen offset:0  lds
  v_mfma_f32_16x16x32_bf16 v[72:75], a[100:103], a[144:147], v[72:75]
  ds_read_b64_tr_b16 a[58:59], v116 offset:10240
  v_mfma_f32_16x16x32_bf16 v[72:75], a[120:123], a[168:171], v[72:75]
  ds_read_b64_tr_b16 a[80:81], v116 offset:16384
  v_mfma_f32_16x16x32_bf16 v[76:79], a[124:127], a[168:171], v[76:79]
  ds_read_b64_tr_b16 a[82:83], v116 offset:22528
  v_mfma_f32_16x16x32_bf16 v[76:79], a[104:107], a[144:147], v[76:79]
  buffer_load_dwordx4 v125, s[8:11], s70 offen offset:1024  lds
  v_mfma_f32_16x16x32_bf16 v[92:95], a[104:107], a[148:151], v[92:95]
  ds_read_b64_tr_b16 a[60:61], v117 offset:4096
  v_mfma_f32_16x16x32_bf16 v[92:95], a[124:127], a[172:175], v[92:95]
  ds_read_b64_tr_b16 a[62:63], v117 offset:10240
  v_mfma_f32_16x16x32_bf16 v[88:91], a[120:123], a[172:175], v[88:91]
  ds_read_b64_tr_b16 a[84:85], v117 offset:16384
  v_mfma_f32_16x16x32_bf16 v[88:91], a[100:103], a[148:151], v[88:91]
  ds_read_b64_tr_b16 a[86:87], v117 offset:22528
  v_mfma_f32_16x16x32_bf16 v[84:87], a[96:99], a[148:151], v[84:87]
  s_cmp_eq_u32 s66, s88
  s_cbranch_scc1 Lside_k5_c
Lside_k5_r:
  v_mfma_f32_16x16x32_bf16 v[84:87], a[116:119], a[172:175], v[84:87]
  s_sub_u32 s56, s56, 1
  v_mfma_f32_16x16x32_bf16 v[80:83], a[112:115], a[172:175], v[80:83]
  s_cmp_lg_u32 s56, 0
  v_mfma_f32_16x16x32_bf16 v[80:83], a[92:95], a[148:151], v[80:83]
  s_cbranch_scc1 Lp1_loop
Lmk_Lp1_loop_tail:
  s_waitcnt lgkmcnt(15)
  v_mfma_f32_16x16x32_bf16 v[0:3], a[40:43], a[4:7], v[0:3]
  s_mul_i32 s45, s44, 393216
  v_and_b32 v240, 1, v253
  v_lshlrev_b32 v240, 7, v240
  v_mfma_f32_16x16x32_bf16 v[0:3], a[64:67], a[24:27], v[0:3]
  s_add_u32 s69, s45, s60
  v_mfma_f32_16x16x32_bf16 v[4:7], a[64:67], a[28:31], v[4:7]
  s_add_u32 s70, s69, 4096
  buffer_load_dword v127, v240, s[36:39], 0 offen sc1
  v_mfma_f32_16x16x32_bf16 v[4:7], a[40:43], a[8:11], v[4:7]
  s_lshl_b32 s43, s57, 2
  v_mfma_f32_16x16x32_bf16 v[8:11], a[40:43], a[12:15], v[8:11]
  s_waitcnt vmcnt(11) lgkmcnt(0)
  s_barrier
  ds_read_b64_tr_b16 a[128:129], v116 offset:24576
  v_mfma_f32_16x16x32_bf16 v[8:11], a[64:67], a[32:35], v[8:11]
  s_add_u32 s74, s71, s43
  ds_read_b64_tr_b16 a[130:131], v116 offset:30720
  v_mfma_f32_16x16x32_bf16 v[12:15], a[64:67], a[36:39], v[12:15]
  s_add_u32 m0, s62, 73728
  ds_read_b64_tr_b16 a[152:153], v116 offset:36864
  v_mfma_f32_16x16x32_bf16 v[12:15], a[40:43], a[16:19], v[12:15]
  s_add_u32 s45, s42, 27262976
  buffer_load_dwordx4 v120, s[28:31], s68 offen offset:0 sc1  lds
  v_mfma_f32_16x16x32_bf16 v[28:31], a[44:47], a[16:19], v[28:31]
  s_lshl_b32 s44, s72, 11
  ds_read_b64_tr_b16 a[154:155], v116 offset:43008
  v_mfma_f32_16x16x32_bf16 v[28:31], a[68:71], a[36:39], v[28:31]
  s_add_u32 s77, s44, s45
  ds_read_b128 a[92:95], v112 offset:16384
  v_mfma_f32_16x16x32_bf16 v[24:27], a[68:71], a[32:35], v[24:27]
  s_lshl_b32 s44, s40, 1
  ds_read_b128 a[112:115], v113 offset:16384
  v_mfma_f32_16x16x32_bf16 v[24:27], a[44:47], a[12:15], v[24:27]
  s_add_u32 s44, s44, s71
  buffer_load_dwordx4 v121, s[28:31], s68 offen offset:1024 sc1  lds
  v_mfma_f32_16x16x32_bf16 v[20:23], a[44:47], a[8:11], v[20:23]
  s_lshl_b32 s44, s44, 11
  ds_read_b128 a[96:99], v112 offset:18432
  v_mfma_f32_16x16x32_bf16 v[20:23], a[68:71], a[28:31], v[20:23]
  s_add_u32 s78, s44, s45
  ds_read_b128 a[116:119], v113 offset:18432
  v_mfma_f32_16x16x32_bf16 v[16:19], a[68:71], a[24:27], v[16:19]
  s_lshl_b32 s43, s51, 1
  ds_read_b128 a[100:103], v112 offset:20480
  v_mfma_f32_16x16x32_bf16 v[16:19], a[44:47], a[4:7], v[16:19]
  s_add_u32 s75, s43, s58
  buffer_load_dwordx4 v122, s[28:31], s68 offen offset:2048 sc1  lds
  v_mfma_f32_16x16x32_bf16 v[96:99], a[48:51], a[0:3], v[96:99]
  s_lshl_b32 s43, s75, 7
  ds_read_b128 a[120:123], v113 offset:20480
  v_mfma_f32_16x16x32_bf16 v[96:99], a[72:75], a[20:23], v[96:99]
  s_add_u32 s46, s43, 27983872
  ds_read_b128 a[104:107], v112 offset:22528
  v_mfma_f32_16x16x32_bf16 v[32:35], a[72:75], a[24:27], v[32:35]
  s_lshl_b32 s43, s57, 6
  ds_read_b128 a[124:127], v113 offset:22528
  v_mfma_f32_16x16x32_bf16 v[32:35], a[48:51], a[4:7], v[32:35]
  buffer_load_dwordx4 v123, s[28:31], s68 offen offset:3072 sc1  lds
  v_mfma_f32_16x16x32_bf16 v[36:39], a[48:51], a[8:11], v[36:39]
  ds_read_b64_tr_b16 a[132:133], v117 offset:24576
  v_mfma_f32_16x16x32_bf16 v[36:39], a[72:75], a[28:31], v[36:39]
  ds_read_b64_tr_b16 a[134:135], v117 offset:30720
  v_mfma_f32_16x16x32_bf16 v[40:43], a[72:75], a[32:35], v[40:43]
  s_add_u32 m0, s63, 0
  ds_read_b64_tr_b16 a[156:157], v117 offset:36864
  v_mfma_f32_16x16x32_bf16 v[40:43], a[48:51], a[12:15], v[40:43]
  buffer_load_dwordx4 v124, s[8:11], s69 offen offset:0  lds
  v_mfma_f32_16x16x32_bf16 v[44:47], a[48:51], a[16:19], v[44:47]
  ds_read_b64_tr_b16 a[158:159], v117 offset:43008
  v_mfma_f32_16x16x32_bf16 v[44:47], a[72:75], a[36:39], v[44:47]
  ds_read_b128 a[88:91], v114 offset:1024
  v_mfma_f32_16x16x32_bf16 v[60:63], a[76:79], a[36:39], v[60:63]
  ds_read_b128 a[108:111], v115 offset:1024
  v_mfma_f32_16x16x32_bf16 v[60:63], a[52:55], a[16:19], v[60:63]
  buffer_load_dwordx4 v125, s[8:11], s69 offen offset:1024  lds
  v_mfma_f32_16x16x32_bf16 v[56:59], a[52:55], a[12:15], v[56:59]
  ds_read_b64_tr_b16 a[136:137], v116 offset:26624
  v_mfma_f32_16x16x32_bf16 v[56:59], a[76:79], a[32:35], v[56:59]
  ds_read_b64_tr_b16 a[138:139], v116 offset:32768
  v_mfma_f32_16x16x32_bf16 v[52:55], a[76:79], a[28:31], v[52:55]
  ds_read_b64_tr_b16 a[160:161], v116 offset:38912
  v_lshlrev_b32 v105, 3, v253
  v_mfma_f32_16x16x32_bf16 v[52:55], a[52:55], a[8:11], v[52:55]
  buffer_load_dwordx4 v124, s[8:11], s69 offen offset:2048  lds
  v_mfma_f32_16x16x32_bf16 v[48:51], a[52:55], a[4:7], v[48:51]
  ds_read_b64_tr_b16 a[162:163], v116 offset:45056
  v_lshlrev_b32 v104, 4, v253
  v_mfma_f32_16x16x32_bf16 v[48:51], a[76:79], a[24:27], v[48:51]
  ds_read_b64_tr_b16 a[140:141], v117 offset:26624
  v_xor_b32 v126, s43, v104
  v_mfma_f32_16x16x32_bf16 v[100:103], a[20:23], a[80:83], v[100:103]
  ds_read_b64_tr_b16 a[142:143], v117 offset:32768
  v_add_u32 v126, s76, v126
  v_mfma_f32_16x16x32_bf16 v[100:103], a[0:3], a[56:59], v[100:103]
  buffer_load_dwordx4 v125, s[8:11], s69 offen offset:3072  lds
  v_mfma_f32_16x16x32_bf16 v[64:67], a[4:7], a[56:59], v[64:67]
  ds_read_b64_tr_b16 a[164:165], v117 offset:38912
  v_bfe_u32 v106, v253, 3, 2
  v_mfma_f32_16x16x32_bf16 v[64:67], a[24:27], a[80:83], v[64:67]
  ds_read_b64_tr_b16 a[166:167], v117 offset:45056
  v_lshrrev_b32 v107, 5, v253
  v_mfma_f32_16x16x32_bf16 v[68:71], a[28:31], a[80:83], v[68:71]
  s_add_u32 m0, s63, 4096
  ds_read_b64_tr_b16 a[144:145], v116 offset:28672
  v_mad_u32_u24 v106, v107, 3, v106
  v_mfma_f32_16x16x32_bf16 v[68:71], a[8:11], a[56:59], v[68:71]
  buffer_load_dwordx4 v124, s[8:11], s70 offen offset:0  lds
  v_mfma_f32_16x16x32_bf16 v[72:75], a[12:15], a[56:59], v[72:75]
  ds_read_b64_tr_b16 a[146:147], v116 offset:34816
  v_and_b32 v107, 7, v253
  v_mfma_f32_16x16x32_bf16 v[72:75], a[32:35], a[80:83], v[72:75]
  ds_read_b64_tr_b16 a[168:169], v116 offset:40960
  v_lshlrev_b32 v107, 4, v107
  v_mfma_f32_16x16x32_bf16 v[76:79], a[36:39], a[80:83], v[76:79]
  ds_read_b64_tr_b16 a[170:171], v116 offset:47104
  v_lshl_add_u32 v106, v106, 12, v107
  v_mfma_f32_16x16x32_bf16 v[76:79], a[16:19], a[56:59], v[76:79]
  buffer_load_dwordx4 v125, s[8:11], s70 offen offset:1024  lds
  v_mfma_f32_16x16x32_bf16 v[92:95], a[16:19], a[60:63], v[92:95]
  ds_read_b64_tr_b16 a[148:149], v117 offset:28672
  v_mfma_f32_16x16x32_bf16 v[92:95], a[36:39], a[84:87], v[92:95]
  ds_read_b64_tr_b16 a[150:151], v117 offset:34816
  v_mfma_f32_16x16x32_bf16 v[88:91], a[32:35], a[84:87], v[88:91]
  ds_read_b64_tr_b16 a[172:173], v117 offset:40960
  v_mfma_f32_16x16x32_bf16 v[88:91], a[12:15], a[60:63], v[88:91]
  s_waitcnt vmcnt(10)
  v_cmp_gt_u32 vcc, 128, v127
  s_cbranch_vccnz Lchk3_c
Lchk3_r:
  v_mfma_f32_16x16x32_bf16 v[84:87], a[8:11], a[60:63], v[84:87]
  ds_read_b64_tr_b16 a[174:175], v117 offset:47104
  v_mfma_f32_16x16x32_bf16 v[84:87], a[28:31], a[84:87], v[84:87]
  v_mfma_f32_16x16x32_bf16 v[80:83], a[24:27], a[84:87], v[80:83]
  v_mfma_f32_16x16x32_bf16 v[80:83], a[4:7], a[60:63], v[80:83]
  s_waitcnt lgkmcnt(15)
  v_mfma_f32_16x16x32_bf16 v[0:3], a[128:131], a[92:95], v[0:3]
  s_cmp_eq_u32 s41, 0
  s_cbranch_scc1 Lc4_c
Lc4_r:
  v_mfma_f32_16x16x32_bf16 v[0:3], a[152:155], a[112:115], v[0:3]
  s_lshl_b32 s92, s53, 7
  s_lshl_b32 s93, s40, 14
  s_add_u32 s92, s92, s93
  v_mfma_f32_16x16x32_bf16 v[4:7], a[152:155], a[116:119], v[4:7]
  s_lshl_b32 s89, s40, 10
  v_add_u32 v186, s92, v252
  s_bfe_u32 s88, s2, 0x5
  v_mfma_f32_16x16x32_bf16 v[4:7], a[128:131], a[96:99], v[4:7]
  s_lshl_b32 s88, s88, 21
  buffer_load_dwordx2 v[128:129], v105, s[4:7], s78 offen offset:0 sc1
  v_mfma_f32_16x16x32_bf16 v[8:11], a[128:131], a[100:103], v[8:11]
  s_waitcnt lgkmcnt(0)
  s_barrier
  ds_read_b64_tr_b16 a[40:41], v118 offset:0
  v_mfma_f32_16x16x32_bf16 v[8:11], a[152:155], a[120:123], v[8:11]
  ds_read_b64_tr_b16 a[42:43], v118 offset:6144
  v_mfma_f32_16x16x32_bf16 v[12:15], a[152:155], a[124:127], v[12:15]
  s_cmp_eq_u32 s41, 0
  s_cbranch_scc1 Lc5_c
Lc5_r:
  ds_read_b64_tr_b16 a[64:65], v118 offset:12288
  v_mfma_f32_16x16x32_bf16 v[12:15], a[128:131], a[104:107], v[12:15]
  buffer_load_dwordx2 v[130:131], v105, s[4:7], s78 offen offset:512 sc1
  v_mfma_f32_16x16x32_bf16 v[28:31], a[132:135], a[104:107], v[28:31]
  ds_read_b64_tr_b16 a[66:67], v118 offset:18432
  v_mfma_f32_16x16x32_bf16 v[28:31], a[156:159], a[124:127], v[28:31]
  ds_read_b128 a[4:7], v112 offset:32768
  v_mfma_f32_16x16x32_bf16 v[24:27], a[156:159], a[120:123], v[24:27]
  ds_read_b128 a[24:27], v113 offset:32768
  v_mfma_f32_16x16x32_bf16 v[24:27], a[132:135], a[100:103], v[24:27]
  buffer_load_dwordx2 v[132:133], v105, s[4:7], s78 offen offset:1024 sc1
  v_mfma_f32_16x16x32_bf16 v[20:23], a[132:135], a[96:99], v[20:23]
  s_cmp_eq_u32 s41, 0
  s_cbranch_scc1 Lc6_c
Lc6_r:
  ds_read_b128 a[8:11], v112 offset:34816
  v_mfma_f32_16x16x32_bf16 v[20:23], a[156:159], a[116:119], v[20:23]
  ds_read_b128 a[28:31], v113 offset:34816
  v_mfma_f32_16x16x32_bf16 v[16:19], a[156:159], a[112:115], v[16:19]
  ds_read_b128 a[12:15], v112 offset:36864
  v_mfma_f32_16x16x32_bf16 v[16:19], a[132:135], a[92:95], v[16:19]
  buffer_load_dwordx2 v[134:135], v105, s[4:7], s78 offen offset:1536 sc1
  v_mfma_f32_16x16x32_bf16 v[96:99], a[136:139], a[88:91], v[96:99]
  ds_read_b128 a[32:35], v113 offset:36864
  v_mfma_f32_16x16x32_bf16 v[96:99], a[160:163], a[108:111], v[96:99]
  ds_read_b128 a[16:19], v112 offset:38912
  v_mfma_f32_16x16x32_bf16 v[32:35], a[160:163], a[112:115], v[32:35]
  s_cmp_eq_u32 s41, 0
  s_cbranch_scc1 Lc7_c
Lc7_r:
  ds_read_b128 a[36:39], v113 offset:38912
  v_mfma_f32_16x16x32_bf16 v[32:35], a[136:139], a[92:95], v[32:35]
  buffer_load_dwordx2 v[136:137], v105, s[4:7], s78 offen offset:2048 sc1
  v_mfma_f32_16x16x32_bf16 v[36:39], a[136:139], a[96:99], v[36:39]
  ds_read_b64_tr_b16 a[44:45], v119 offset:0
  v_mfma_f32_16x16x32_bf16 v[36:39], a[160:163], a[116:119], v[36:39]
  ds_read_b64_tr_b16 a[46:47], v119 offset:6144
  v_mfma_f32_16x16x32_bf16 v[40:43], a[160:163], a[120:123], v[40:43]
  ds_read_b64_tr_b16 a[68:69], v119 offset:12288
  v_mfma_f32_16x16x32_bf16 v[40:43], a[136:139], a[100:103], v[40:43]
  buffer_load_dwordx2 v[138:139], v105, s[4:7], s78 offen offset:2560 sc1
  v_mfma_f32_16x16x32_bf16 v[44:47], a[136:139], a[104:107], v[44:47]
  ds_read_b64_tr_b16 a[70:71], v119 offset:18432
  v_lshrrev_b32 v240, 4, v253
  v_mfma_f32_16x16x32_bf16 v[44:47], a[160:163], a[124:127], v[44:47]
  ds_read_b128 a[0:3], v114 offset:2048
  v_lshlrev_b32 v124, 4, v240
  v_mfma_f32_16x16x32_bf16 v[60:63], a[164:167], a[124:127], v[60:63]
  ds_read_b128 a[20:23], v115 offset:2048
  v_and_b32 v125, 15, v253
  v_mfma_f32_16x16x32_bf16 v[60:63], a[140:143], a[104:107], v[60:63]
  buffer_load_dwordx2 v[140:141], v105, s[4:7], s78 offen offset:3072 sc1
  v_mfma_f32_16x16x32_bf16 v[56:59], a[140:143], a[100:103], v[56:59]
  ds_read_b64_tr_b16 a[48:49], v118 offset:2048
  v_lshlrev_b32 v125, 2, v125
  v_mfma_f32_16x16x32_bf16 v[56:59], a[164:167], a[120:123], v[56:59]
  s_lshl_b32 s43, s57, 9
  ds_read_b64_tr_b16 a[50:51], v118 offset:8192
  v_add_u32 v164, 155648, v124
  v_mfma_f32_16x16x32_bf16 v[52:55], a[164:167], a[116:119], v[52:55]
  ds_read_b64_tr_b16 a[72:73], v118 offset:14336
  v_add_u32 v166, 155648, v125
  v_mfma_f32_16x16x32_bf16 v[52:55], a[140:143], a[96:99], v[52:55]
  buffer_load_dwordx2 v[142:143], v105, s[4:7], s78 offen offset:3584 sc1
  v_mfma_f32_16x16x32_bf16 v[48:51], a[140:143], a[92:95], v[48:51]
  ds_read_b64_tr_b16 a[74:75], v118 offset:20480
  v_add_u32 v165, s43, v164
  v_mfma_f32_16x16x32_bf16 v[48:51], a[164:167], a[112:115], v[48:51]
  ds_read_b64_tr_b16 a[52:53], v119 offset:2048
  v_add_u32 v167, s43, v166
  v_mfma_f32_16x16x32_bf16 v[100:103], a[108:111], a[168:171], v[100:103]
  s_lshl_b32 s43, s40, 1
  ds_read_b64_tr_b16 a[54:55], v119 offset:8192
  v_mfma_f32_16x16x32_bf16 v[100:103], a[88:91], a[144:147], v[100:103]
  s_add_u32 s43, s43, 1
  buffer_load_dwordx2 v[144:145], v105, s[4:7], s77 offen offset:0 sc1
  v_mfma_f32_16x16x32_bf16 v[64:67], a[92:95], a[144:147], v[64:67]
  ds_read_b64_tr_b16 a[76:77], v119 offset:14336
  v_add_u32 v241, s43, v240
  v_mfma_f32_16x16x32_bf16 v[64:67], a[112:115], a[168:171], v[64:67]
  ds_read_b64_tr_b16 a[78:79], v119 offset:20480
  v_cmp_gt_u32 vcc, 2, v240
  v_mfma_f32_16x16x32_bf16 v[68:71], a[116:119], a[168:171], v[68:71]
  ds_read_b64_tr_b16 a[56:57], v118 offset:4096
  v_and_b32 v240, 1, v240
  v_mfma_f32_16x16x32_bf16 v[68:71], a[96:99], a[144:147], v[68:71]
  buffer_load_dwordx2 v[146:147], v105, s[4:7], s77 offen offset:512 sc1
  v_mfma_f32_16x16x32_bf16 v[72:75], a[100:103], a[144:147], v[72:75]
  ds_read_b64_tr_b16 a[58:59], v118 offset:10240
  v_mul_u32_u24 v240, 9, v240
  v_mfma_f32_16x16x32_bf16 v[72:75], a[120:123], a[168:171], v[72:75]
  ds_read_b64_tr_b16 a[80:81], v118 offset:16384
  v_cndmask_b32 v240, v240, v241, vcc
  v_mfma_f32_16x16x32_bf16 v[76:79], a[124:127], a[168:171], v[76:79]
  ds_read_b64_tr_b16 a[82:83], v118 offset:22528
  v_lshl_add_u32 v106, v240, 7, v166
  v_mfma_f32_16x16x32_bf16 v[76:79], a[104:107], a[144:147], v[76:79]
  buffer_load_dwordx2 v[148:149], v105, s[4:7], s77 offen offset:1024 sc1
  v_mfma_f32_16x16x32_bf16 v[92:95], a[104:107], a[148:151], v[92:95]
  ds_read_b64_tr_b16 a[60:61], v119 offset:4096
  v_add_u32 v124, s76, v124
  v_mfma_f32_16x16x32_bf16 v[92:95], a[124:127], a[172:175], v[92:95]
  ds_read_b64_tr_b16 a[62:63], v119 offset:10240
  v_add_u32 v125, s76, v125
  v_mfma_f32_16x16x32_bf16 v[88:91], a[120:123], a[172:175], v[88:91]
  ds_read_b64_tr_b16 a[84:85], v119 offset:16384
  v_add_u32 v107, 149504, v104
  v_mfma_f32_16x16x32_bf16 v[88:91], a[100:103], a[148:151], v[88:91]
  buffer_load_dwordx2 v[150:151], v105, s[4:7], s77 offen offset:1536 sc1
  v_mfma_f32_16x16x32_bf16 v[84:87], a[96:99], a[148:151], v[84:87]
  ds_read_b64_tr_b16 a[86:87], v119 offset:22528
  v_mfma_f32_16x16x32_bf16 v[84:87], a[116:119], a[172:175], v[84:87]
  v_mfma_f32_16x16x32_bf16 v[80:83], a[112:115], a[172:175], v[80:83]
  v_mfma_f32_16x16x32_bf16 v[80:83], a[92:95], a[148:151], v[80:83]
  s_waitcnt lgkmcnt(15)
  v_mfma_f32_16x16x32_bf16 v[0:3], a[40:43], a[4:7], v[0:3]
  s_lshl_b32 s44, s2, 2
  s_add_u32 s44, s44, s40
  s_lshl_b32 s44, s44, 12
  v_mfma_f32_16x16x32_bf16 v[0:3], a[64:67], a[24:27], v[0:3]
  s_add_u32 s44, s44, s42
  v_mfma_f32_16x16x32_bf16 v[4:7], a[64:67], a[28:31], v[4:7]
  s_add_u32 s44, s44, 28311552
  v_mov_b32 v246, -1
  v_mov_b32 v247, -1
  v_mfma_f32_16x16x32_bf16 v[4:7], a[40:43], a[8:11], v[4:7]
  v_mov_b32 v248, -1
  v_mov_b32 v249, -1
  v_mfma_f32_16x16x32_bf16 v[8:11], a[40:43], a[12:15], v[8:11]
  s_waitcnt vmcnt(12) lgkmcnt(0)
  s_barrier
  ds_read_b64_tr_b16 a[128:129], v116 offset:0
  v_mfma_f32_16x16x32_bf16 v[8:11], a[64:67], a[32:35], v[8:11]
  ds_read_b64_tr_b16 a[130:131], v116 offset:6144
  v_mfma_f32_16x16x32_bf16 v[12:15], a[64:67], a[36:39], v[12:15]
  s_waitcnt vmcnt(8)
  ds_read_b64_tr_b16 a[152:153], v116 offset:12288
  v_add_u32 v198, 1024, v125
  v_mfma_f32_16x16x32_bf16 v[12:15], a[40:43], a[16:19], v[12:15]
  ds_read_b64_tr_b16 a[154:155], v116 offset:18432
  v_add_f32 v128, v128, v130
  v_mfma_f32_16x16x32_bf16 v[28:31], a[44:47], a[16:19], v[28:31]
  buffer_store_dwordx4 v[246:249], v104, s[4:7], s44 offen offset:0 sc1
  v_mfma_f32_16x16x32_bf16 v[28:31], a[68:71], a[36:39], v[28:31]
  ds_read_b128 a[92:95], v112 offset:0
  v_add_f32 v129, v129, v131
  v_mfma_f32_16x16x32_bf16 v[24:27], a[68:71], a[32:35], v[24:27]
  ds_read_b128 a[112:115], v113 offset:0
  v_add_f32 v132, v132, v134
  v_mfma_f32_16x16x32_bf16 v[24:27], a[44:47], a[12:15], v[24:27]
  ds_read_b128 a[96:99], v112 offset:2048
  v_add_f32 v133, v133, v135
  v_mfma_f32_16x16x32_bf16 v[20:23], a[44:47], a[8:11], v[20:23]
  buffer_store_dwordx4 v[246:249], v104, s[4:7], s44 offen offset:1024 sc1
  v_mfma_f32_16x16x32_bf16 v[20:23], a[68:71], a[28:31], v[20:23]
  ds_read_b128 a[116:119], v113 offset:2048
  v_add_f32 v128, v128, v132
  v_mfma_f32_16x16x32_bf16 v[16:19], a[68:71], a[24:27], v[16:19]
  ds_read_b128 a[100:103], v112 offset:4096
  v_add_f32 v129, v129, v133
  v_mfma_f32_16x16x32_bf16 v[16:19], a[44:47], a[4:7], v[16:19]
  s_waitcnt vmcnt(6)
  ds_read_b128 a[120:123], v113 offset:4096
  s_cmp_eq_u32 s41, 0
  s_cbranch_scc1 Lc8_c
Lc8_r:
  v_mfma_f32_16x16x32_bf16 v[96:99], a[48:51], a[0:3], v[96:99]
  buffer_store_dwordx4 v[246:249], v104, s[4:7], s44 offen offset:2048 sc1
  v_mfma_f32_16x16x32_bf16 v[96:99], a[72:75], a[20:23], v[96:99]
  ds_read_b128 a[104:107], v112 offset:6144
  ds_read_b128 v[168:171], v124 offset:1024
  v_mfma_f32_16x16x32_bf16 v[32:35], a[72:75], a[24:27], v[32:35]
  ds_read_b128 a[124:127], v113 offset:6144
  ds_read_b128 v[172:175], v124 offset:1088
  v_mfma_f32_16x16x32_bf16 v[32:35], a[48:51], a[4:7], v[32:35]
  ds_read_b64_tr_b16 a[132:133], v117 offset:0
  ds_read_b128 v[176:179], v124 offset:1152
  v_mfma_f32_16x16x32_bf16 v[36:39], a[48:51], a[8:11], v[36:39]
  buffer_store_dwordx4 v[246:249], v104, s[4:7], s44 offen offset:3072 sc1
  v_mfma_f32_16x16x32_bf16 v[36:39], a[72:75], a[28:31], v[36:39]
  ds_read_b64_tr_b16 a[134:135], v117 offset:6144
  ds_read_b128 v[180:183], v124 offset:1216
  v_mfma_f32_16x16x32_bf16 v[40:43], a[72:75], a[32:35], v[40:43]
  ds_read_b64_tr_b16 a[156:157], v117 offset:12288
  ds_read2_b32 v[184:185], v198 offset0:64 offset1:80
  v_mfma_f32_16x16x32_bf16 v[40:43], a[48:51], a[12:15], v[40:43]
  s_add_u32 m0, s62, 90112
  ds_read_b64_tr_b16 a[158:159], v117 offset:18432
  s_xor_b32 s47, s40, 2
  v_mfma_f32_16x16x32_bf16 v[44:47], a[48:51], a[16:19], v[44:47]
  s_mul_i32 s47, s47, 6144
  buffer_load_dwordx4 v120, s[28:31], s64 offen offset:0 sc1 lds
  v_mfma_f32_16x16x32_bf16 v[44:47], a[72:75], a[36:39], v[44:47]
  s_add_u32 s47, s47, 139264
  ds_read_b128 a[88:91], v114 offset:3072
  s_add_u32 s49, s47, 3072
  v_mfma_f32_16x16x32_bf16 v[60:63], a[76:79], a[36:39], v[60:63]
  s_add_u32 s79, s47, 2048
  ds_read_b128 a[108:111], v115 offset:3072
  v_mfma_f32_16x16x32_bf16 v[60:63], a[52:55], a[16:19], v[60:63]
  s_cmp_eq_u32 s57, 0
  s_cselect_b32 s49, s76, s49
  s_cselect_b32 s79, s47, s79
  ds_read_b64_tr_b16 a[136:137], v116 offset:2048
  v_add_u32 v198, s49, v105
  v_mfma_f32_16x16x32_bf16 v[56:59], a[52:55], a[12:15], v[56:59]
  ds_read_b64_tr_b16 a[138:139], v116 offset:8192
  v_add_u32 v199, s79, v105
  v_mfma_f32_16x16x32_bf16 v[56:59], a[76:79], a[32:35], v[56:59]
  ds_read_b64_tr_b16 a[160:161], v116 offset:14336
  v_add_u32 v105, s76, v105
  v_mfma_f32_16x16x32_bf16 v[52:55], a[76:79], a[28:31], v[52:55]
  ds_read_b64_tr_b16 a[162:163], v116 offset:20480
  v_add_f32 v136, v136, v138
  v_mfma_f32_16x16x32_bf16 v[52:55], a[52:55], a[8:11], v[52:55]
  ds_read_b64_tr_b16 a[140:141], v117 offset:2048
  v_add_f32 v137, v137, v139
  v_mfma_f32_16x16x32_bf16 v[48:51], a[52:55], a[4:7], v[48:51]
  buffer_load_dwordx4 v121, s[28:31], s64 offen offset:1024 sc1 lds
  v_mfma_f32_16x16x32_bf16 v[48:51], a[76:79], a[24:27], v[48:51]
  ds_read_b64_tr_b16 a[142:143], v117 offset:8192
  v_add_f32 v140, v140, v142
  v_mfma_f32_16x16x32_bf16 v[100:103], a[20:23], a[80:83], v[100:103]
  ds_read_b64_tr_b16 a[164:165], v117 offset:14336
  v_add_f32 v141, v141, v143
  v_mfma_f32_16x16x32_bf16 v[100:103], a[0:3], a[56:59], v[100:103]
  ds_read_b64_tr_b16 a[166:167], v117 offset:20480
  v_add_f32 v136, v136, v140
  v_mfma_f32_16x16x32_bf16 v[64:67], a[4:7], a[56:59], v[64:67]
  ds_read_b64_tr_b16 a[144:145], v116 offset:4096
  v_add_f32 v137, v137, v141
  v_mfma_f32_16x16x32_bf16 v[64:67], a[24:27], a[80:83], v[64:67]
  s_waitcnt vmcnt(6)
  ds_read_b64_tr_b16 a[146:147], v116 offset:10240
  v_add_f32 v144, v144, v146
  v_mfma_f32_16x16x32_bf16 v[68:71], a[28:31], a[80:83], v[68:71]
  ds_read_b64_tr_b16 a[168:169], v116 offset:16384
  v_add_f32 v145, v145, v147
  v_mfma_f32_16x16x32_bf16 v[68:71], a[8:11], a[56:59], v[68:71]
  ds_read_b64_tr_b16 a[170:171], v116 offset:22528
  v_add_f32 v148, v148, v150
  v_mfma_f32_16x16x32_bf16 v[72:75], a[12:15], a[56:59], v[72:75]
  buffer_load_dwordx4 v122, s[28:31], s64 offen offset:2048 sc1 lds
  v_mfma_f32_16x16x32_bf16 v[72:75], a[32:35], a[80:83], v[72:75]
  ds_read_b64_tr_b16 a[148:149], v117 offset:4096
  v_add_f32 v149, v149, v151
  v_mfma_f32_16x16x32_bf16 v[76:79], a[36:39], a[80:83], v[76:79]
  ds_read_b64_tr_b16 a[150:151], v117 offset:10240
  v_add_f32 v144, v144, v148
  v_mfma_f32_16x16x32_bf16 v[76:79], a[16:19], a[56:59], v[76:79]
  ds_read_b64_tr_b16 a[172:173], v117 offset:16384
  v_add_f32 v145, v145, v149
  v_mfma_f32_16x16x32_bf16 v[92:95], a[16:19], a[60:63], v[92:95]
  s_mov_b32 s48, 0x3a800000
  ds_read_b64_tr_b16 a[174:175], v117 offset:22528
  v_mov_b32 v240, 0x3727c5ac
  v_mfma_f32_16x16x32_bf16 v[92:95], a[36:39], a[84:87], v[92:95]
  v_permlane32_swap_b32 v136, v130
  v_permlane32_swap_b32 v137, v131
  v_mfma_f32_16x16x32_bf16 v[88:91], a[32:35], a[84:87], v[88:91]
  v_permlane32_swap_b32 v128, v144
  v_permlane32_swap_b32 v129, v145
  v_mfma_f32_16x16x32_bf16 v[88:91], a[12:15], a[60:63], v[88:91]
  v_add_f32 v136, v136, v130
  v_add_f32 v128, v128, v144
  v_mfma_f32_16x16x32_bf16 v[84:87], a[8:11], a[60:63], v[84:87]
  buffer_load_dwordx4 v123, s[28:31], s64 offen offset:3072 sc1 lds
  v_mfma_f32_16x16x32_bf16 v[84:87], a[28:31], a[84:87], v[84:87]
  v_add_f32 v137, v137, v131
  v_add_f32 v129, v129, v145
  v_mfma_f32_16x16x32_bf16 v[80:83], a[24:27], a[84:87], v[80:83]
  v_permlane16_swap_b32 v128, v136
  v_mfma_f32_16x16x32_bf16 v[80:83], a[4:7], a[60:63], v[80:83]
  s_nop 0
  v_permlane16_swap_b32 v129, v137
  v_add_f32 v128, v128, v136
  s_waitcnt lgkmcnt(15)
  v_mfma_f32_16x16x32_bf16 v[0:3], a[128:131], a[92:95], v[0:3]
  v_add_f32 v129, v129, v137
  v_mul_f32 v128, 0xba800000, v128
  v_mfma_f32_16x16x32_bf16 v[0:3], a[152:155], a[112:115], v[0:3]
  s_add_u32 m0, s89, 40960
  v_fma_f32 v129, v129, s48, v240
  v_fma_f32 v129, -v128, v128, v129
  v_mfma_f32_16x16x32_bf16 v[4:7], a[152:155], a[116:119], v[4:7]
  s_xor_b32 s92, s88, 655360
  v_max_f32 v129, v129, v240
  v_rsq_f32 v129, v129
  v_mfma_f32_16x16x32_bf16 v[4:7], a[128:131], a[96:99], v[4:7]
  s_nop 0
  buffer_load_dwordx4 v186, s[12:15], s92 offen lds
  v_mfma_f32_16x16x32_bf16 v[8:11], a[128:131], a[100:103], v[8:11]
  ds_write2_b32 v106, v128, v129 offset0:0 offset1:16
  v_mfma_f32_16x16x32_bf16 v[8:11], a[152:155], a[120:123], v[8:11]
  v_mfma_f32_16x16x32_bf16 v[12:15], a[152:155], a[124:127], v[12:15]
  s_add_u32 m0, s89, 45056
  v_mfma_f32_16x16x32_bf16 v[12:15], a[128:131], a[104:107], v[12:15]
  s_xor_b32 s92, s88, 720896
  v_mfma_f32_16x16x32_bf16 v[28:31], a[132:135], a[104:107], v[28:31]
  buffer_load_dwordx4 v186, s[12:15], s92 offen lds
  v_mfma_f32_16x16x32_bf16 v[28:31], a[156:159], a[124:127], v[28:31]
  v_mfma_f32_16x16x32_bf16 v[24:27], a[156:159], a[120:123], v[24:27]
  s_waitcnt lgkmcnt(0)
  s_barrier
  ds_read2_b32 v[190:191], v167 offset0:32 offset1:48
  ds_read2_b32 v[192:193], v167 offset0:64 offset1:80
  v_mfma_f32_16x16x32_bf16 v[24:27], a[132:135], a[100:103], v[24:27]
  s_add_u32 m0, s89, 49152
  ds_read2_b32 v[194:195], v167 offset0:96 offset1:112
  ds_read2_b32 v[196:197], v167 offset0:128 offset1:144
  v_mfma_f32_16x16x32_bf16 v[20:23], a[132:135], a[96:99], v[20:23]
  s_xor_b32 s92, s88, 786432
  ds_read2_b32 v[188:189], v166 offset0:0 offset1:16
  ds_read_b128 v[128:131], v107
  v_mfma_f32_16x16x32_bf16 v[20:23], a[156:159], a[116:119], v[20:23]
  buffer_load_dwordx4 v186, s[12:15], s92 offen lds
  v_mfma_f32_16x16x32_bf16 v[16:19], a[156:159], a[112:115], v[16:19]
  ds_read_b128 v[132:135], v107 offset:1024
  ds_read_b128 v[200:203], v164 offset:0
  v_mfma_f32_16x16x32_bf16 v[16:19], a[132:135], a[92:95], v[16:19]
  ds_read_b128 v[220:223], v164 offset:64
  ds_read_b128 v[216:219], v165 offset:512
  v_mfma_f32_16x16x32_bf16 v[96:99], a[136:139], a[88:91], v[96:99]
  s_add_u32 m0, s89, 53248
  ds_read_b128 v[236:239], v165 offset:576
  ds_read_b128 v[204:207], v165 offset:128
  v_mfma_f32_16x16x32_bf16 v[96:99], a[160:163], a[108:111], v[96:99]
  s_xor_b32 s92, s88, 851968
  ds_read_b128 v[224:227], v165 offset:192
  ds_read_b128 v[208:211], v165 offset:256
  v_mfma_f32_16x16x32_bf16 v[32:35], a[160:163], a[112:115], v[32:35]
  buffer_load_dwordx4 v186, s[12:15], s92 offen lds
  v_mfma_f32_16x16x32_bf16 v[32:35], a[136:139], a[92:95], v[32:35]
  ds_read_b128 v[228:231], v165 offset:320
  ds_read_b128 v[212:215], v165 offset:384
  v_mfma_f32_16x16x32_bf16 v[36:39], a[136:139], a[96:99], v[36:39]
  ds_read_b128 v[232:235], v165 offset:448
  s_and_b32 s43, s50, 7
  v_mfma_f32_16x16x32_bf16 v[36:39], a[160:163], a[116:119], v[36:39]
  s_add_u32 m0, s89, 57344
  s_or_b32 s43, s43, s57
  s_cselect_b64 s[46:47], -1, 0
  v_mfma_f32_16x16x32_bf16 v[40:43], a[160:163], a[120:123], v[40:43]
  s_xor_b32 s92, s88, 917504
  v_mov_b32 v245, 0xf149f2ca
  v_mfma_f32_16x16x32_bf16 v[40:43], a[136:139], a[100:103], v[40:43]
  s_waitcnt lgkmcnt(10)
  buffer_load_dwordx4 v186, s[12:15], s92 offen lds
  v_mfma_f32_16x16x32_bf16 v[44:47], a[136:139], a[104:107], v[44:47]
  v_fmac_f32 v12, v168, v196
  v_fmac_f32 v13, v169, v196
  v_mfma_f32_16x16x32_bf16 v[44:47], a[160:163], a[124:127], v[44:47]
  v_fmac_f32 v14, v170, v196
  v_fmac_f32 v15, v171, v196
  v_mfma_f32_16x16x32_bf16 v[60:63], a[164:167], a[124:127], v[60:63]
  s_add_u32 m0, s89, 61440
  v_fmac_f32 v28, v172, v196
  v_fmac_f32 v29, v173, v196
  v_mfma_f32_16x16x32_bf16 v[60:63], a[140:143], a[104:107], v[60:63]
  s_xor_b32 s92, s88, 983040
  v_fmac_f32 v30, v174, v196
  v_fmac_f32 v31, v175, v196
  v_mfma_f32_16x16x32_bf16 v[56:59], a[140:143], a[100:103], v[56:59]
  buffer_load_dwordx4 v186, s[12:15], s92 offen lds
  v_mfma_f32_16x16x32_bf16 v[56:59], a[164:167], a[120:123], v[56:59]
  v_cvt_pk_bf16_f32 v12, v12, v13
  v_cvt_pk_bf16_f32 v13, v14, v15
  v_mfma_f32_16x16x32_bf16 v[52:55], a[164:167], a[116:119], v[52:55]
  v_cvt_pk_bf16_f32 v14, v28, v29
  v_cvt_pk_bf16_f32 v15, v30, v31
  v_mfma_f32_16x16x32_bf16 v[52:55], a[140:143], a[96:99], v[52:55]
  s_add_u32 m0, s89, 65536
  v_fmac_f32 v8, v168, v194
  v_fmac_f32 v9, v169, v194
  v_mfma_f32_16x16x32_bf16 v[48:51], a[140:143], a[92:95], v[48:51]
  s_xor_b32 s92, s88, 1048576
  v_fmac_f32 v10, v170, v194
  v_fmac_f32 v11, v171, v194
  v_mfma_f32_16x16x32_bf16 v[48:51], a[164:167], a[112:115], v[48:51]
  buffer_load_dwordx4 v186, s[12:15], s92 offen lds
  v_mfma_f32_16x16x32_bf16 v[100:103], a[108:111], a[168:171], v[100:103]
  v_fmac_f32 v24, v172, v194
  v_fmac_f32 v25, v173, v194
  v_mfma_f32_16x16x32_bf16 v[100:103], a[88:91], a[144:147], v[100:103]
  v_fmac_f32 v26, v174, v194
  v_fmac_f32 v27, v175, v194
  v_mfma_f32_16x16x32_bf16 v[64:67], a[92:95], a[144:147], v[64:67]
  s_add_u32 m0, s89, 69632
  v_cvt_pk_bf16_f32 v8, v8, v9
  v_cvt_pk_bf16_f32 v9, v10, v11
  v_mfma_f32_16x16x32_bf16 v[64:67], a[112:115], a[168:171], v[64:67]
  s_xor_b32 s92, s88, 1114112
  v_cvt_pk_bf16_f32 v10, v24, v25
  v_cvt_pk_bf16_f32 v11, v26, v27
  v_mfma_f32_16x16x32_bf16 v[68:71], a[116:119], a[168:171], v[68:71]
  buffer_load_dwordx4 v186, s[12:15], s92 offen lds
  v_mfma_f32_16x16x32_bf16 v[68:71], a[96:99], a[144:147], v[68:71]
  v_fmac_f32 v4, v168, v192
  v_fmac_f32 v5, v169, v192
  v_mfma_f32_16x16x32_bf16 v[72:75], a[100:103], a[144:147], v[72:75]
  v_fmac_f32 v6, v170, v192
  v_fmac_f32 v7, v171, v192
  v_mfma_f32_16x16x32_bf16 v[72:75], a[120:123], a[168:171], v[72:75]
  s_add_u32 m0, s89, 0
  v_fmac_f32 v20, v172, v192
  v_fmac_f32 v21, v173, v192
  v_mfma_f32_16x16x32_bf16 v[76:79], a[124:127], a[168:171], v[76:79]
  s_xor_b32 s92, s88, 0
  v_fmac_f32 v22, v174, v192
  v_fmac_f32 v23, v175, v192
  v_mfma_f32_16x16x32_bf16 v[76:79], a[104:107], a[144:147], v[76:79]
  buffer_load_dwordx4 v186, s[12:15], s92 offen lds
  v_mfma_f32_16x16x32_bf16 v[92:95], a[104:107], a[148:151], v[92:95]
  v_cvt_pk_bf16_f32 v4, v4, v5
  v_cvt_pk_bf16_f32 v5, v6, v7
  v_mfma_f32_16x16x32_bf16 v[92:95], a[124:127], a[172:175], v[92:95]
  v_cvt_pk_bf16_f32 v6, v20, v21
  v_cvt_pk_bf16_f32 v7, v22, v23
  v_mfma_f32_16x16x32_bf16 v[88:91], a[120:123], a[172:175], v[88:91]
  s_add_u32 m0, s89, 4096
  v_fmac_f32 v0, v168, v190
  v_fmac_f32 v1, v169, v190
  v_mfma_f32_16x16x32_bf16 v[88:91], a[100:103], a[148:151], v[88:91]
  s_xor_b32 s92, s88, 65536
  v_fmac_f32 v2, v170, v190
  v_fmac_f32 v3, v171, v190
  v_mfma_f32_16x16x32_bf16 v[84:87], a[96:99], a[148:151], v[84:87]
  buffer_load_dwordx4 v186, s[12:15], s92 offen lds
  v_mfma_f32_16x16x32_bf16 v[84:87], a[116:119], a[172:175], v[84:87]
  v_fmac_f32 v16, v172, v190
  v_fmac_f32 v17, v173, v190
  v_mfma_f32_16x16x32_bf16 v[80:83], a[112:115], a[172:175], v[80:83]
  v_fmac_f32 v18, v174, v190
  v_fmac_f32 v19, v175, v190
  v_mfma_f32_16x16x32_bf16 v[80:83], a[92:95], a[148:151], v[80:83]
  v_cvt_pk_bf16_f32 v0, v0, v1
  v_cvt_pk_bf16_f32 v1, v2, v3
Lmk_p1epi:
  v_cvt_pk_bf16_f32 v2, v16, v17
  v_cvt_pk_bf16_f32 v3, v18, v19
  v_cndmask_b32 v136, v245, v132, s[46:47]
  v_mov_b32 v160, 0x3f803f80
  v_mul_f32 v108, 0x3e8293ee, v191
  v_cndmask_b32 v137, v245, v133, s[46:47]
  v_mov_b32 v161, 0x3f803f80
  v_mul_f32 v109, 0x3e8293ee, v193
  v_cndmask_b32 v138, v245, v134, s[46:47]
  v_mov_b32 v162, 0x3f803f80
  v_mul_f32 v110, 0x3e8293ee, v195
  v_cndmask_b32 v139, v245, v135, s[46:47]
  v_mov_b32 v163, 0x3f803f80
  v_mul_f32 v111, 0x3e8293ee, v197
  s_waitcnt lgkmcnt(0)
  v_pk_fma_f32 v[96:97], v[176:177], v[188:189], v[96:97] op_sel:[0,0,0] op_sel_hi:[1,0,1]
  v_pk_fma_f32 v[98:99], v[178:179], v[188:189], v[98:99] op_sel:[0,0,0] op_sel_hi:[1,0,1]
  v_pk_mul_f32 v[96:97], v[96:97], v[188:189] op_sel:[0,1] op_sel_hi:[1,1]
  v_pk_mul_f32 v[98:99], v[98:99], v[188:189] op_sel:[0,1] op_sel_hi:[1,1]
  v_cvt_pk_bf16_f32 v96, v96, v97
  v_cvt_pk_bf16_f32 v97, v98, v99
  v_pk_fma_f32 v[44:45], v[176:177], v[196:197], v[44:45] op_sel:[0,0,0] op_sel_hi:[1,0,1]
  v_pk_fma_f32 v[46:47], v[178:179], v[196:197], v[46:47] op_sel:[0,0,0] op_sel_hi:[1,0,1]
  v_pk_fma_f32 v[60:61], v[180:181], v[196:197], v[60:61] op_sel:[0,0,0] op_sel_hi:[1,0,1]
  v_pk_fma_f32 v[62:63], v[182:183], v[196:197], v[62:63] op_sel:[0,0,0] op_sel_hi:[1,0,1]
  v_pk_mul_f32 v[44:45], v[44:45], v[196:197] op_sel:[0,1] op_sel_hi:[1,1]
  v_pk_mul_f32 v[46:47], v[46:47], v[196:197] op_sel:[0,1] op_sel_hi:[1,1]
  v_pk_mul_f32 v[60:61], v[60:61], v[196:197] op_sel:[0,1] op_sel_hi:[1,1]
  v_pk_mul_f32 v[62:63], v[62:63], v[196:197] op_sel:[0,1] op_sel_hi:[1,1]
  v_cvt_pk_bf16_f32 v44, v44, v45
  v_cvt_pk_bf16_f32 v45, v46, v47
  v_cvt_pk_bf16_f32 v46, v60, v61
  v_cvt_pk_bf16_f32 v47, v62, v63
  v_pk_fma_f32 v[100:101], v[200:201], v[184:185], v[100:101] op_sel:[0,0,0] op_sel_hi:[1,0,1]
  v_pk_fma_f32 v[102:103], v[202:203], v[184:185], v[102:103] op_sel:[0,0,0] op_sel_hi:[1,0,1]
  v_pk_mul_f32 v[100:101], v[100:101], v[220:221]
  v_pk_mul_f32 v[102:103], v[102:103], v[222:223]
  v_cvt_pk_bf16_f32 v100, v100, v101
  v_cvt_pk_bf16_f32 v101, v102, v103
  v_pk_fma_f32 v[76:77], v[216:217], v[184:185], v[76:77] op_sel:[0,0,0] op_sel_hi:[1,0,1]
  v_pk_fma_f32 v[78:79], v[218:219], v[184:185], v[78:79] op_sel:[0,0,0] op_sel_hi:[1,0,1]
  v_pk_fma_f32 v[92:93], v[216:217], v[184:185], v[92:93] op_sel:[0,1,0] op_sel_hi:[1,1,1]
  v_pk_fma_f32 v[94:95], v[218:219], v[184:185], v[94:95] op_sel:[0,1,0] op_sel_hi:[1,1,1]
  v_pk_mul_f32 v[76:77], v[76:77], v[236:237]
  v_pk_mul_f32 v[78:79], v[78:79], v[238:239]
  v_pk_mul_f32 v[92:93], v[92:93], v[236:237]
  v_pk_mul_f32 v[94:95], v[94:95], v[238:239]
  v_cvt_pk_bf16_f32 v148, v76, v77
  v_cvt_pk_bf16_f32 v149, v78, v79
  v_cvt_pk_bf16_f32 v158, v92, v93
  v_cvt_pk_bf16_f32 v159, v94, v95
  ds_write2st64_b64 v105, v[96:97], v[100:101] offset0:0 offset1:1
  ds_write2st64_b64 v105, v[44:45], v[148:149] offset0:4 offset1:5
  ds_write2st64_b64 v105, v[46:47], v[158:159] offset0:6 offset1:7
  s_add_u32 m0, s89, 8192
  s_xor_b32 s92, s88, 131072
  buffer_load_dwordx4 v186, s[12:15], s92 offen lds
  v_pk_fma_f32 v[40:41], v[176:177], v[194:195], v[40:41] op_sel:[0,0,0] op_sel_hi:[1,0,1]
  v_pk_fma_f32 v[42:43], v[178:179], v[194:195], v[42:43] op_sel:[0,0,0] op_sel_hi:[1,0,1]
  v_pk_fma_f32 v[56:57], v[180:181], v[194:195], v[56:57] op_sel:[0,0,0] op_sel_hi:[1,0,1]
  v_pk_fma_f32 v[58:59], v[182:183], v[194:195], v[58:59] op_sel:[0,0,0] op_sel_hi:[1,0,1]
  v_pk_mul_f32 v[40:41], v[40:41], v[194:195] op_sel:[0,1] op_sel_hi:[1,1]
  v_pk_mul_f32 v[42:43], v[42:43], v[194:195] op_sel:[0,1] op_sel_hi:[1,1]
  v_pk_mul_f32 v[56:57], v[56:57], v[194:195] op_sel:[0,1] op_sel_hi:[1,1]
  v_pk_mul_f32 v[58:59], v[58:59], v[194:195] op_sel:[0,1] op_sel_hi:[1,1]
  v_cvt_pk_bf16_f32 v40, v40, v41
  v_cvt_pk_bf16_f32 v41, v42, v43
  v_cvt_pk_bf16_f32 v42, v56, v57
  v_cvt_pk_bf16_f32 v43, v58, v59
  s_add_u32 m0, s89, 12288
  s_xor_b32 s92, s88, 196608
  buffer_load_dwordx4 v186, s[12:15], s92 offen lds
  v_pk_fma_f32 v[36:37], v[176:177], v[192:193], v[36:37] op_sel:[0,0,0] op_sel_hi:[1,0,1]
  v_pk_fma_f32 v[38:39], v[178:179], v[192:193], v[38:39] op_sel:[0,0,0] op_sel_hi:[1,0,1]
  v_pk_fma_f32 v[52:53], v[180:181], v[192:193], v[52:53] op_sel:[0,0,0] op_sel_hi:[1,0,1]
  v_pk_fma_f32 v[54:55], v[182:183], v[192:193], v[54:55] op_sel:[0,0,0] op_sel_hi:[1,0,1]
  v_pk_mul_f32 v[36:37], v[36:37], v[192:193] op_sel:[0,1] op_sel_hi:[1,1]
  v_pk_mul_f32 v[38:39], v[38:39], v[192:193] op_sel:[0,1] op_sel_hi:[1,1]
  v_pk_mul_f32 v[52:53], v[52:53], v[192:193] op_sel:[0,1] op_sel_hi:[1,1]
  v_pk_mul_f32 v[54:55], v[54:55], v[192:193] op_sel:[0,1] op_sel_hi:[1,1]
  v_cvt_pk_bf16_f32 v36, v36, v37
  v_cvt_pk_bf16_f32 v37, v38, v39
  v_cvt_pk_bf16_f32 v38, v52, v53
  v_cvt_pk_bf16_f32 v39, v54, v55
  s_add_u32 m0, s89, 16384
  s_xor_b32 s92, s88, 262144
  buffer_load_dwordx4 v186, s[12:15], s92 offen lds
  v_pk_fma_f32 v[32:33], v[176:177], v[190:191], v[32:33] op_sel:[0,0,0] op_sel_hi:[1,0,1]
  v_pk_fma_f32 v[34:35], v[178:179], v[190:191], v[34:35] op_sel:[0,0,0] op_sel_hi:[1,0,1]
  v_pk_fma_f32 v[48:49], v[180:181], v[190:191], v[48:49] op_sel:[0,0,0] op_sel_hi:[1,0,1]
  v_pk_fma_f32 v[50:51], v[182:183], v[190:191], v[50:51] op_sel:[0,0,0] op_sel_hi:[1,0,1]
  v_pk_mul_f32 v[32:33], v[32:33], v[190:191] op_sel:[0,1] op_sel_hi:[1,1]
  v_pk_mul_f32 v[34:35], v[34:35], v[190:191] op_sel:[0,1] op_sel_hi:[1,1]
  v_pk_mul_f32 v[48:49], v[48:49], v[190:191] op_sel:[0,1] op_sel_hi:[1,1]
  v_pk_mul_f32 v[50:51], v[50:51], v[190:191] op_sel:[0,1] op_sel_hi:[1,1]
  v_cvt_pk_bf16_f32 v32, v32, v33
  v_cvt_pk_bf16_f32 v33, v34, v35
  v_cvt_pk_bf16_f32 v34, v48, v49
  v_cvt_pk_bf16_f32 v35, v50, v51
  s_waitcnt lgkmcnt(0)
  s_barrier
  ds_read_b64 v[120:121], v198
  ds_read_b64 v[122:123], v199
  ds_read_b64 v[140:141], v198 offset:512
  ds_read_b64 v[150:151], v199 offset:512
  v_mfma_f32_16x16x32_bf16 v[60:63], v[44:47], v[12:15], v[128:131]
  v_mfma_f32_16x16x32_bf16 v[28:31], v[40:43], v[12:15], v[132:135]
  v_mfma_f32_16x16x32_bf16 v[56:59], v[40:43], v[8:11], v[128:131]
  v_mfma_f32_16x16x32_bf16 v[24:27], v[36:39], v[8:11], v[132:135]
  v_mfma_f32_16x16x32_bf16 v[52:55], v[36:39], v[4:7], v[128:131]
  v_mfma_f32_16x16x32_bf16 v[20:23], v[32:35], v[4:7], v[132:135]
  v_mfma_f32_16x16x32_bf16 v[48:51], v[32:35], v[0:3], v[128:131]
  s_waitcnt lgkmcnt(0)
  v_mfma_f32_16x16x32_bf16 v[16:19], v[120:123], v[0:3], v[136:139]
  s_add_u32 m0, s89, 20480
  s_xor_b32 s92, s88, 327680
  buffer_load_dwordx4 v186, s[12:15], s92 offen lds
  v_pk_fma_f32 v[64:65], v[204:205], v[184:185], v[64:65] op_sel:[0,0,0] op_sel_hi:[1,0,1]
  v_pk_fma_f32 v[66:67], v[206:207], v[184:185], v[66:67] op_sel:[0,0,0] op_sel_hi:[1,0,1]
  v_pk_fma_f32 v[80:81], v[204:205], v[184:185], v[80:81] op_sel:[0,1,0] op_sel_hi:[1,1,1]
  v_pk_fma_f32 v[82:83], v[206:207], v[184:185], v[82:83] op_sel:[0,1,0] op_sel_hi:[1,1,1]
  v_pk_mul_f32 v[64:65], v[64:65], v[224:225]
  v_pk_mul_f32 v[66:67], v[66:67], v[226:227]
  v_pk_mul_f32 v[80:81], v[80:81], v[224:225]
  v_pk_mul_f32 v[82:83], v[82:83], v[226:227]
  v_cvt_pk_bf16_f32 v142, v64, v65
  v_cvt_pk_bf16_f32 v143, v66, v67
  v_cvt_pk_bf16_f32 v152, v80, v81
  v_cvt_pk_bf16_f32 v153, v82, v83
  v_pk_fma_f32 v[68:69], v[208:209], v[184:185], v[68:69] op_sel:[0,0,0] op_sel_hi:[1,0,1]
  v_pk_fma_f32 v[70:71], v[210:211], v[184:185], v[70:71] op_sel:[0,0,0] op_sel_hi:[1,0,1]
  v_pk_fma_f32 v[84:85], v[208:209], v[184:185], v[84:85] op_sel:[0,1,0] op_sel_hi:[1,1,1]
  v_pk_fma_f32 v[86:87], v[210:211], v[184:185], v[86:87] op_sel:[0,1,0] op_sel_hi:[1,1,1]
  v_pk_mul_f32 v[68:69], v[68:69], v[228:229]
  v_pk_mul_f32 v[70:71], v[70:71], v[230:231]
  v_pk_mul_f32 v[84:85], v[84:85], v[228:229]
  v_pk_mul_f32 v[86:87], v[86:87], v[230:231]
  v_cvt_pk_bf16_f32 v144, v68, v69
  v_cvt_pk_bf16_f32 v145, v70, v71
  v_cvt_pk_bf16_f32 v154, v84, v85
  v_cvt_pk_bf16_f32 v155, v86, v87
  v_pk_fma_f32 v[72:73], v[212:213], v[184:185], v[72:73] op_sel:[0,0,0] op_sel_hi:[1,0,1]
  v_pk_fma_f32 v[74:75], v[214:215], v[184:185], v[74:75] op_sel:[0,0,0] op_sel_hi:[1,0,1]
  v_pk_fma_f32 v[88:89], v[212:213], v[184:185], v[88:89] op_sel:[0,1,0] op_sel_hi:[1,1,1]
  v_pk_fma_f32 v[90:91], v[214:215], v[184:185], v[90:91] op_sel:[0,1,0] op_sel_hi:[1,1,1]
  v_pk_mul_f32 v[72:73], v[72:73], v[232:233]
  v_pk_mul_f32 v[74:75], v[74:75], v[234:235]
  v_pk_mul_f32 v[88:89], v[88:89], v[232:233]
  v_pk_mul_f32 v[90:91], v[90:91], v[234:235]
  v_cvt_pk_bf16_f32 v146, v72, v73
  v_cvt_pk_bf16_f32 v147, v74, v75
  v_cvt_pk_bf16_f32 v156, v88, v89
  v_cvt_pk_bf16_f32 v157, v90, v91
  s_cmp_eq_u32 s57, 0
  s_cbranch_scc1 Lp1_nsw
  v_swap_b32 v140, v150
  v_swap_b32 v141, v151
  v_swap_b32 v142, v152
  v_swap_b32 v143, v153
  v_swap_b32 v144, v154
  v_swap_b32 v145, v155
  v_swap_b32 v146, v156
  v_swap_b32 v147, v157
  v_swap_b32 v148, v158
  v_swap_b32 v149, v159
Lp1_nsw:
  v_max3_f32 v240, v16, v17, v18
  v_max3_f32 v241, v20, v21, v22
  v_max3_f32 v242, v24, v25, v26
  v_max3_f32 v243, v28, v29, v30
  v_max3_f32 v240, v240, v19, v48
  v_max3_f32 v241, v241, v23, v52
  v_max3_f32 v242, v242, v27, v56
  v_max3_f32 v243, v243, v31, v60
  v_max3_f32 v240, v240, v49, v50
  v_max3_f32 v241, v241, v53, v54
  v_max3_f32 v242, v242, v57, v58
  v_max3_f32 v243, v243, v61, v62
  v_max_f32 v240, v240, v51
  v_max_f32 v241, v241, v55
  v_max_f32 v242, v242, v59
  v_max_f32 v243, v243, v63
  v_mov_b32 v244, v240
  v_mov_b32 v245, v241
  v_mov_b32 v246, v242
  v_mov_b32 v247, v243
  v_permlane32_swap_b32 v240, v244
  v_permlane32_swap_b32 v241, v245
  v_permlane32_swap_b32 v242, v246
  v_permlane32_swap_b32 v243, v247
  v_max_f32 v240, v240, v244
  v_max_f32 v241, v241, v245
  v_max_f32 v242, v242, v246
  v_max_f32 v243, v243, v247
  v_mov_b32 v244, v240
  v_mov_b32 v245, v241
  v_mov_b32 v246, v242
  v_mov_b32 v247, v243
  v_permlane16_swap_b32 v240, v244
  v_permlane16_swap_b32 v241, v245
  v_permlane16_swap_b32 v242, v246
  v_permlane16_swap_b32 v243, v247
  v_max_f32 v240, v240, v244
  v_max_f32 v241, v241, v245
  v_max_f32 v242, v242, v246
  v_max_f32 v243, v243, v247
  v_pk_mul_f32 v[240:241], v[240:241], v[108:109] neg_lo:[0,1] neg_hi:[0,1]
  v_pk_mul_f32 v[242:243], v[242:243], v[110:111] neg_lo:[0,1] neg_hi:[0,1]
  v_pk_fma_f32 v[16:17], v[16:17], v[108:109], v[240:241] op_sel:[0,0,0] op_sel_hi:[1,0,0]
  v_pk_fma_f32 v[18:19], v[18:19], v[108:109], v[240:241] op_sel:[0,0,0] op_sel_hi:[1,0,0]
  v_pk_fma_f32 v[48:49], v[48:49], v[108:109], v[240:241] op_sel:[0,0,0] op_sel_hi:[1,0,0]
  v_pk_fma_f32 v[50:51], v[50:51], v[108:109], v[240:241] op_sel:[0,0,0] op_sel_hi:[1,0,0]
  v_exp_f32 v16, v16
  v_exp_f32 v17, v17
  v_exp_f32 v18, v18
  v_exp_f32 v19, v19
  v_exp_f32 v48, v48
  v_exp_f32 v49, v49
  v_exp_f32 v50, v50
  v_exp_f32 v51, v51
  v_cvt_pk_bf16_f32 v0, v16, v17
  v_cvt_pk_bf16_f32 v1, v18, v19
  v_cvt_pk_bf16_f32 v2, v48, v49
  v_cvt_pk_bf16_f32 v3, v50, v51
  v_pk_fma_f32 v[20:21], v[20:21], v[108:109], v[240:241] op_sel:[0,1,1] op_sel_hi:[1,1,1]
  v_pk_fma_f32 v[22:23], v[22:23], v[108:109], v[240:241] op_sel:[0,1,1] op_sel_hi:[1,1,1]
  v_pk_fma_f32 v[52:53], v[52:53], v[108:109], v[240:241] op_sel:[0,1,1] op_sel_hi:[1,1,1]
  v_pk_fma_f32 v[54:55], v[54:55], v[108:109], v[240:241] op_sel:[0,1,1] op_sel_hi:[1,1,1]
  v_exp_f32 v20, v20
  v_exp_f32 v21, v21
  v_exp_f32 v22, v22
  v_exp_f32 v23, v23
  v_exp_f32 v52, v52
  v_exp_f32 v53, v53
  v_exp_f32 v54, v54
  v_exp_f32 v55, v55
  v_cvt_pk_bf16_f32 v4, v20, v21
  v_cvt_pk_bf16_f32 v5, v22, v23
  v_cvt_pk_bf16_f32 v6, v52, v53
  v_cvt_pk_bf16_f32 v7, v54, v55
  v_pk_fma_f32 v[24:25], v[24:25], v[110:111], v[242:243] op_sel:[0,0,0] op_sel_hi:[1,0,0]
  v_pk_fma_f32 v[26:27], v[26:27], v[110:111], v[242:243] op_sel:[0,0,0] op_sel_hi:[1,0,0]
  v_pk_fma_f32 v[56:57], v[56:57], v[110:111], v[242:243] op_sel:[0,0,0] op_sel_hi:[1,0,0]
  v_pk_fma_f32 v[58:59], v[58:59], v[110:111], v[242:243] op_sel:[0,0,0] op_sel_hi:[1,0,0]
  v_exp_f32 v24, v24
  v_exp_f32 v25, v25
  v_exp_f32 v26, v26
  v_exp_f32 v27, v27
  v_exp_f32 v56, v56
  v_exp_f32 v57, v57
  v_exp_f32 v58, v58
  v_exp_f32 v59, v59
  v_cvt_pk_bf16_f32 v8, v24, v25
  v_cvt_pk_bf16_f32 v9, v26, v27
  v_cvt_pk_bf16_f32 v10, v56, v57
  v_cvt_pk_bf16_f32 v11, v58, v59
  v_pk_fma_f32 v[28:29], v[28:29], v[110:111], v[242:243] op_sel:[0,1,1] op_sel_hi:[1,1,1]
  v_pk_fma_f32 v[30:31], v[30:31], v[110:111], v[242:243] op_sel:[0,1,1] op_sel_hi:[1,1,1]
  v_pk_fma_f32 v[60:61], v[60:61], v[110:111], v[242:243] op_sel:[0,1,1] op_sel_hi:[1,1,1]
  v_pk_fma_f32 v[62:63], v[62:63], v[110:111], v[242:243] op_sel:[0,1,1] op_sel_hi:[1,1,1]
  v_exp_f32 v28, v28
  v_exp_f32 v29, v29
  v_exp_f32 v30, v30
  v_exp_f32 v31, v31
  v_exp_f32 v60, v60
  v_exp_f32 v61, v61
  v_exp_f32 v62, v62
  v_exp_f32 v63, v63
  v_cvt_pk_bf16_f32 v12, v28, v29
  v_cvt_pk_bf16_f32 v13, v30, v31
  v_cvt_pk_bf16_f32 v14, v60, v61
  v_cvt_pk_bf16_f32 v15, v62, v63
  v_mfma_f32_16x16x32_bf16 v[32:35], v[160:163], v[0:3], 0
  s_lshl_b32 s43, s74, 15
  s_lshl_b32 s44, s75, 10
  v_mfma_f32_16x16x32_bf16 v[36:39], v[160:163], v[4:7], 0
  s_add_u32 s43, s43, s44
  s_add_u32 s43, s43, s42
  v_mfma_f32_16x16x32_bf16 v[40:43], v[160:163], v[8:11], 0
  s_add_u32 s46, s43, 8388608
  s_add_u32 s47, s46, 32768
  v_mfma_f32_16x16x32_bf16 v[44:47], v[160:163], v[12:15], 0
  s_add_u32 s48, s47, 32768
  s_add_u32 s49, s48, 32768
  v_mfma_f32_16x16x32_bf16 v[64:67], v[140:143], v[0:3], 0
  s_lshl_b32 s77, s50, 1
  v_mfma_f32_16x16x32_bf16 v[80:83], v[150:153], v[0:3], 0
  s_lshr_b32 s43, s51, 3
  v_mfma_f32_16x16x32_bf16 v[68:71], v[142:145], v[4:7], 0
  s_add_u32 s77, s77, s43
  v_mfma_f32_16x16x32_bf16 v[84:87], v[152:155], v[4:7], 0
  s_lshl_b32 s77, s77, 7
  v_mfma_f32_16x16x32_bf16 v[72:75], v[144:147], v[8:11], 0
  s_add_u32 s77, s77, s42
  v_rcp_f32 v32, v32
  v_mfma_f32_16x16x32_bf16 v[88:91], v[154:157], v[8:11], 0
  s_add_u32 s77, s77, 27787264
  v_rcp_f32 v36, v36
  v_mfma_f32_16x16x32_bf16 v[76:79], v[146:149], v[12:15], 0
  v_rcp_f32 v40, v40
  v_mfma_f32_16x16x32_bf16 v[92:95], v[156:159], v[12:15], 0
  v_rcp_f32 v44, v44
  v_pk_mul_f32 v[64:65], v[64:65], v[32:33] op_sel:[0,0] op_sel_hi:[1,0]
  v_pk_mul_f32 v[66:67], v[66:67], v[32:33] op_sel:[0,0] op_sel_hi:[1,0]
  v_pk_mul_f32 v[80:81], v[80:81], v[32:33] op_sel:[0,0] op_sel_hi:[1,0]
  v_pk_mul_f32 v[82:83], v[82:83], v[32:33] op_sel:[0,0] op_sel_hi:[1,0]
  v_cvt_pk_bf16_f32 v16, v64, v65
  v_cvt_pk_bf16_f32 v17, v66, v67
  v_cvt_pk_bf16_f32 v18, v80, v81
  v_cvt_pk_bf16_f32 v19, v82, v83
  buffer_store_dwordx4 v[16:19], v104, s[4:7], s46 offen sc1
  v_pk_mul_f32 v[68:69], v[68:69], v[36:37] op_sel:[0,0] op_sel_hi:[1,0]
  v_pk_mul_f32 v[70:71], v[70:71], v[36:37] op_sel:[0,0] op_sel_hi:[1,0]
  v_pk_mul_f32 v[84:85], v[84:85], v[36:37] op_sel:[0,0] op_sel_hi:[1,0]
  v_pk_mul_f32 v[86:87], v[86:87], v[36:37] op_sel:[0,0] op_sel_hi:[1,0]
  v_cvt_pk_bf16_f32 v20, v68, v69
  v_cvt_pk_bf16_f32 v21, v70, v71
  v_cvt_pk_bf16_f32 v22, v84, v85
  v_cvt_pk_bf16_f32 v23, v86, v87
  buffer_store_dwordx4 v[20:23], v104, s[4:7], s47 offen sc1
  v_pk_mul_f32 v[72:73], v[72:73], v[40:41] op_sel:[0,0] op_sel_hi:[1,0]
  v_pk_mul_f32 v[74:75], v[74:75], v[40:41] op_sel:[0,0] op_sel_hi:[1,0]
  v_pk_mul_f32 v[88:89], v[88:89], v[40:41] op_sel:[0,0] op_sel_hi:[1,0]
  v_pk_mul_f32 v[90:91], v[90:91], v[40:41] op_sel:[0,0] op_sel_hi:[1,0]
  v_cvt_pk_bf16_f32 v24, v72, v73
  v_cvt_pk_bf16_f32 v25, v74, v75
  v_cvt_pk_bf16_f32 v26, v88, v89
  v_cvt_pk_bf16_f32 v27, v90, v91
  buffer_store_dwordx4 v[24:27], v104, s[4:7], s48 offen sc1
  v_pk_mul_f32 v[76:77], v[76:77], v[44:45] op_sel:[0,0] op_sel_hi:[1,0]
  v_pk_mul_f32 v[78:79], v[78:79], v[44:45] op_sel:[0,0] op_sel_hi:[1,0]
  v_pk_mul_f32 v[92:93], v[92:93], v[44:45] op_sel:[0,0] op_sel_hi:[1,0]
  v_pk_mul_f32 v[94:95], v[94:95], v[44:45] op_sel:[0,0] op_sel_hi:[1,0]
  v_cvt_pk_bf16_f32 v28, v76, v77
  v_cvt_pk_bf16_f32 v29, v78, v79
  v_cvt_pk_bf16_f32 v30, v92, v93
  v_cvt_pk_bf16_f32 v31, v94, v95
  buffer_store_dwordx4 v[28:31], v104, s[4:7], s49 offen sc1
Lmk_p1end:
  s_lshl_b32 s44, s52, 3
  s_lshl_b32 s43, s40, 1
  s_add_u32 s44, s44, s43
  s_lshl_b32 s45, s44, 15
  s_add_u32 s57, s45, s42
  s_add_u32 s57, s57, 8388608
  s_lshl_b32 s43, s53, 11
  s_add_u32 s45, s45, s43
  s_add_u32 s45, s45, s42
  s_add_u32 s58, s45, 4194304
  s_add_u32 s59, s58, 32768
  s_lshl_b32 s44, s44, 11
  s_lshl_b32 s43, s53, 7
  s_add_u32 s44, s44, s43
  s_add_u32 s44, s44, s42
  s_add_u32 s60, s44, 27525120
  v_lshlrev_b32 v48, 4, v253
  v_add_u32 v49, 32768, v48
  s_cmp_eq_u32 s41, 0
  s_cselect_b32 s44, 32, 8
  s_cselect_b32 s45, 64, 0x400
  s_lshl_b32 s43, s40, 12
  s_add_u32 s43, s43, 90112
  v_xor_b32 v3, s44, v187
  v_xor_b32 v4, s45, v187
  v_xor_b32 v5, s45, v3
  v_add_u32 v2, s43, v187
  v_add_u32 v3, s43, v3
  v_add_u32 v4, s43, v4
  v_add_u32 v5, s43, v5
  s_waitcnt vmcnt(18)
  ds_read_b64 v[52:53], v2 offset:0
  ds_read_b64 v[54:55], v3 offset:0
  ds_read_b64 v[56:57], v4 offset:0
  ds_read_b64 v[58:59], v5 offset:0
  ds_read_b64 v[60:61], v2 offset:2048
  ds_read_b64 v[62:63], v3 offset:2048
  ds_read_b64 v[64:65], v4 offset:2048
  ds_read_b64 v[66:67], v5 offset:2048
  v_lshrrev_b32 v2, 2, v253
  v_bfe_u32 v3, v253, 3, 2
  v_and_b32 v4, 3, v253
  v_lshlrev_b32 v4, 3, v4
  v_lshl_add_u32 v4, v2, 7, v4
  v_xor_b32 v5, 0, v3
  v_lshl_add_u32 v40, v5, 5, v4
  v_xor_b32 v5, 1, v3
  v_lshl_add_u32 v41, v5, 5, v4
  v_xor_b32 v5, 2, v3
  v_lshl_add_u32 v42, v5, 5, v4
  v_xor_b32 v5, 3, v3
  v_lshl_add_u32 v43, v5, 5, v4
  s_cmp_lg_u32 s3, 0
  s_cbranch_scc1 Lc10_c
Lc10_r:
  s_waitcnt lgkmcnt(0)
  s_waitcnt vmcnt(0)
  s_barrier
  s_cmp_lg_u32 s40, 0
  s_cbranch_scc1 Lsig9
  v_mov_b32 v250, 1
  s_mov_b64 exec, 1
  buffer_atomic_add v250, v251, s[4:7], s77 offen sc1
  s_mov_b64 exec, -1
Lsig9:
  s_add_u32 m0, s89, 24576
  s_xor_b32 s92, s88, 393216
  buffer_load_dwordx4 v186, s[12:15], s92 offen lds
  s_add_u32 m0, s89, 28672
  s_xor_b32 s92, s88, 458752
  buffer_load_dwordx4 v186, s[12:15], s92 offen lds
  s_add_u32 m0, s89, 32768
  s_xor_b32 s92, s88, 524288
  buffer_load_dwordx4 v186, s[12:15], s92 offen lds
  s_add_u32 m0, s89, 36864
  s_xor_b32 s92, s88, 589824
  buffer_load_dwordx4 v186, s[12:15], s92 offen lds
  s_add_u32 m0, s89, 73728
  s_xor_b32 s92, s88, 1179648
  buffer_load_dwordx4 v186, s[12:15], s92 offen lds
  s_add_u32 m0, s89, 77824
  s_xor_b32 s92, s88, 1245184
  buffer_load_dwordx4 v186, s[12:15], s92 offen lds
  s_add_u32 m0, s89, 81920
  s_xor_b32 s92, s88, 1310720
  buffer_load_dwordx4 v186, s[12:15], s92 offen lds
  s_add_u32 m0, s89, 86016
  s_xor_b32 s92, s88, 1376256
  buffer_load_dwordx4 v186, s[12:15], s92 offen lds
  s_add_u32 m0, s89, 90112
  s_xor_b32 s92, s88, 1441792
  buffer_load_dwordx4 v186, s[12:15], s92 offen lds
  s_add_u32 m0, s89, 94208
  s_xor_b32 s92, s88, 1507328
  buffer_load_dwordx4 v186, s[12:15], s92 offen lds
  s_add_u32 m0, s89, 98304
  s_xor_b32 s92, s88, 1572864
  buffer_load_dwordx4 v186, s[12:15], s92 offen lds
  s_add_u32 m0, s89, 102400
  s_xor_b32 s92, s88, 1638400
  buffer_load_dwordx4 v186, s[12:15], s92 offen lds
  s_add_u32 m0, s89, 106496
  s_xor_b32 s92, s88, 1703936
  buffer_load_dwordx4 v186, s[12:15], s92 offen lds
  s_add_u32 m0, s89, 110592
  s_xor_b32 s92, s88, 1769472
  buffer_load_dwordx4 v186, s[12:15], s92 offen lds
  s_add_u32 m0, s89, 114688
  s_xor_b32 s92, s88, 1835008
  buffer_load_dwordx4 v186, s[12:15], s92 offen lds
  s_add_u32 m0, s89, 118784
  s_xor_b32 s92, s88, 1900544
  buffer_load_dwordx4 v186, s[12:15], s92 offen lds
  s_add_u32 m0, s89, 122880
  s_xor_b32 s92, s88, 1966080
  buffer_load_dwordx4 v186, s[12:15], s92 offen lds
  s_add_u32 m0, s89, 126976
  s_xor_b32 s92, s88, 2031616
  buffer_load_dwordx4 v186, s[12:15], s92 offen lds
  v_lshlrev_b32 v0, 16, v52
  v_and_b32 v1, 0xffff0000, v52
  v_lshlrev_b32 v2, 16, v53
  v_and_b32 v3, 0xffff0000, v53
  v_lshlrev_b32 v8, 16, v54
  v_and_b32 v9, 0xffff0000, v54
  v_lshlrev_b32 v10, 16, v55
  v_and_b32 v11, 0xffff0000, v55
  v_lshlrev_b32 v16, 16, v56
  v_and_b32 v17, 0xffff0000, v56
  v_lshlrev_b32 v18, 16, v57
  v_and_b32 v19, 0xffff0000, v57
  v_lshlrev_b32 v24, 16, v58
  v_and_b32 v25, 0xffff0000, v58
  v_lshlrev_b32 v26, 16, v59
  v_and_b32 v27, 0xffff0000, v59
  v_lshlrev_b32 v4, 16, v60
  v_and_b32 v5, 0xffff0000, v60
  v_lshlrev_b32 v6, 16, v61
  v_and_b32 v7, 0xffff0000, v61
  v_lshlrev_b32 v12, 16, v62
  v_and_b32 v13, 0xffff0000, v62
  v_lshlrev_b32 v14, 16, v63
  v_and_b32 v15, 0xffff0000, v63
  v_lshlrev_b32 v20, 16, v64
  v_and_b32 v21, 0xffff0000, v64
  v_lshlrev_b32 v22, 16, v65
  v_and_b32 v23, 0xffff0000, v65
  v_lshlrev_b32 v28, 16, v66
  v_and_b32 v29, 0xffff0000, v66
  v_lshlrev_b32 v30, 16, v67
  v_and_b32 v31, 0xffff0000, v67
  v_and_b32 v92, 15, v253
  v_lshrrev_b32 v93, 4, v253
  v_lshrrev_b32 v72, 2, v92
  v_cmp_eq_u32 vcc, v72, v93
  v_and_b32 v72, 3, v92
  v_lshlrev_b32 v92, 3, v92
  v_mov_b32 v93, 0x7ffffff0
  v_cndmask_b32 v92, v93, v92, vcc
  v_cmp_eq_u32 s[64:65], 1, v72
  v_cmp_eq_u32 s[66:67], 2, v72
  v_cmp_eq_u32 s[68:69], 3, v72
  v_mov_b32 v72, 0x3f803f80
  v_mov_b32 v73, 0x3f803f80
  v_mov_b32 v74, 0x3f803f80
  v_mov_b32 v75, 0x3f803f80
  s_cmp_lg_u32 s3, 0
  s_cbranch_scc1 Lc11_c
Lc11_r:
  s_lshl_b32 s77, s52, 8
  s_add_u32 s77, s77, 27787264
  v_lshlrev_b32 v249, 7, v253
  s_add_u32 s77, s77, s42
  s_cmp_lg_u32 s40, 0
  s_cbranch_scc1 Lpdn13
  s_mov_b32 s43, 0x40000
  s_mov_b64 exec, 3
Lpol12:
  buffer_load_dword v250, v249, s[4:7], s77 offen  sc1
  s_waitcnt vmcnt(0)
  v_cmp_gt_u32 vcc, 8, v250
  s_cbranch_vccz Lpdn13x
  s_sub_u32 s43, s43, 1
  s_cmp_lg_u32 s43, 0
  s_cbranch_scc1 Lpol12
Lpdn13x:
  s_mov_b64 exec, -1
Lpdn13:
  s_waitcnt vmcnt(0) lgkmcnt(0)
  s_barrier
  s_lshr_b32 s88, s88, 6
  s_xor_b32 s93, s57, s88
  buffer_load_dwordx4 a[0:3], v48, s[4:7], s93 offen offset:0 sc1
  buffer_load_dwordx4 a[4:7], v49, s[4:7], s93 offen offset:0 sc1
  buffer_load_dwordx4 a[8:11], v48, s[4:7], s93 offen offset:1024 sc1
  buffer_load_dwordx4 a[12:15], v49, s[4:7], s93 offen offset:1024 sc1
  buffer_load_dwordx4 a[16:19], v48, s[4:7], s93 offen offset:2048 sc1
  buffer_load_dwordx4 a[20:23], v49, s[4:7], s93 offen offset:2048 sc1
  buffer_load_dwordx4 a[24:27], v48, s[4:7], s93 offen offset:3072 sc1
  buffer_load_dwordx4 a[28:31], v49, s[4:7], s93 offen offset:3072 sc1
  s_add_u32 s57, s57, 4096
  s_xor_b32 s93, s57, s88
  buffer_load_dwordx4 a[32:35], v48, s[4:7], s93 offen offset:0 sc1
  buffer_load_dwordx4 a[36:39], v49, s[4:7], s93 offen offset:0 sc1
  buffer_load_dwordx4 a[40:43], v48, s[4:7], s93 offen offset:1024 sc1
  buffer_load_dwordx4 a[44:47], v49, s[4:7], s93 offen offset:1024 sc1
  s_cmp_eq_u32 s40, 1
  s_cselect_b32 s3, s3, 0
  s_cmp_lg_u32 s3, 0
  s_cbranch_scc1 Lc14_c
Lc14_r:
  ds_read_b64_tr_b16 a[128:129], v40 offset:0
  ds_read_b64_tr_b16 a[130:131], v40 offset:2048
  ds_read_b64_tr_b16 a[144:145], v40 offset:4096
  ds_read_b64_tr_b16 a[146:147], v40 offset:6144
  ds_read_b64_tr_b16 a[132:133], v41 offset:0
  ds_read_b64_tr_b16 a[134:135], v41 offset:2048
  ds_read_b64_tr_b16 a[148:149], v41 offset:4096
  ds_read_b64_tr_b16 a[150:151], v41 offset:6144
  ds_read_b64_tr_b16 a[136:137], v42 offset:0
  ds_read_b64_tr_b16 a[138:139], v42 offset:2048
  ds_read_b64_tr_b16 a[152:153], v42 offset:4096
  ds_read_b64_tr_b16 a[154:155], v42 offset:6144
  ds_read_b64_tr_b16 a[140:141], v43 offset:0
  ds_read_b64_tr_b16 a[142:143], v43 offset:2048
  ds_read_b64_tr_b16 a[156:157], v43 offset:4096
  ds_read_b64_tr_b16 a[158:159], v43 offset:6144
  s_and_b32 s43, s53, 0
  s_mul_i32 s77, s52, 1
  s_add_u32 s77, s77, s43
  s_lshl_b32 s77, s77, 7
  s_add_u32 s77, s77, s42
  s_add_u32 s77, s77, 27791360
  s_mov_b32 s56, 3
.p2align 3
Lp2_loop:
  s_waitcnt vmcnt(8) lgkmcnt(8)
  v_mfma_f32_16x16x32_bf16 v[0:3], a[128:131], a[0:3], v[0:3]
  ds_read_b64_tr_b16 a[160:161], v40 offset:8192
  v_mfma_f32_16x16x32_bf16 v[0:3], a[144:147], a[8:11], v[0:3]
  buffer_load_dwordx4 a[48:51], v48, s[4:7], s93 offen offset:2048 sc1
  v_mfma_f32_16x16x32_bf16 v[4:7], a[144:147], a[12:15], v[4:7]
  ds_read_b64_tr_b16 a[162:163], v40 offset:10240
  ds_read_b64_tr_b16 a[176:177], v40 offset:12288
  v_mfma_f32_16x16x32_bf16 v[4:7], a[128:131], a[4:7], v[4:7]
  ds_read_b64_tr_b16 a[178:179], v40 offset:14336
  v_mfma_f32_16x16x32_bf16 v[12:15], a[132:135], a[4:7], v[12:15]
  ds_read_b64_tr_b16 a[164:165], v41 offset:8192
  v_mfma_f32_16x16x32_bf16 v[12:15], a[148:151], a[12:15], v[12:15]
  buffer_load_dwordx4 a[52:55], v49, s[4:7], s93 offen offset:2048 sc1
  v_mfma_f32_16x16x32_bf16 v[8:11], a[148:151], a[8:11], v[8:11]
  ds_read_b64_tr_b16 a[166:167], v41 offset:10240
  ds_read_b64_tr_b16 a[180:181], v41 offset:12288
  v_mfma_f32_16x16x32_bf16 v[8:11], a[132:135], a[0:3], v[8:11]
  ds_read_b64_tr_b16 a[182:183], v41 offset:14336
  s_waitcnt lgkmcnt(8)
  v_mfma_f32_16x16x32_bf16 v[16:19], a[136:139], a[0:3], v[16:19]
  ds_read_b64_tr_b16 a[168:169], v42 offset:8192
  v_mfma_f32_16x16x32_bf16 v[16:19], a[152:155], a[8:11], v[16:19]
  buffer_load_dwordx4 a[56:59], v48, s[4:7], s93 offen offset:3072 sc1
  v_mfma_f32_16x16x32_bf16 v[20:23], a[152:155], a[12:15], v[20:23]
  ds_read_b64_tr_b16 a[170:171], v42 offset:10240
  ds_read_b64_tr_b16 a[184:185], v42 offset:12288
  v_mfma_f32_16x16x32_bf16 v[20:23], a[136:139], a[4:7], v[20:23]
  ds_read_b64_tr_b16 a[186:187], v42 offset:14336
  v_mfma_f32_16x16x32_bf16 v[28:31], a[140:143], a[4:7], v[28:31]
  ds_read_b64_tr_b16 a[172:173], v43 offset:8192
  v_mfma_f32_16x16x32_bf16 v[28:31], a[156:159], a[12:15], v[28:31]
  buffer_load_dwordx4 a[60:63], v49, s[4:7], s93 offen offset:3072 sc1
  v_mfma_f32_16x16x32_bf16 v[24:27], a[156:159], a[8:11], v[24:27]
  ds_read_b64_tr_b16 a[174:175], v43 offset:10240
  ds_read_b64_tr_b16 a[188:189], v43 offset:12288
  v_mfma_f32_16x16x32_bf16 v[24:27], a[140:143], a[0:3], v[24:27]
  ds_read_b64_tr_b16 a[190:191], v43 offset:14336
  s_waitcnt vmcnt(8) lgkmcnt(8)
  v_mfma_f32_16x16x32_bf16 v[0:3], a[160:163], a[16:19], v[0:3]
  ds_read_b64_tr_b16 a[128:129], v40 offset:16384
  v_mfma_f32_16x16x32_bf16 v[0:3], a[176:179], a[24:27], v[0:3]
  s_add_u32 s57, s57, 4096
  s_xor_b32 s93, s57, s88
  buffer_load_dwordx4 a[0:3], v48, s[4:7], s93 offen offset:0 sc1
  v_mfma_f32_16x16x32_bf16 v[4:7], a[176:179], a[28:31], v[4:7]
  ds_read_b64_tr_b16 a[130:131], v40 offset:18432
  ds_read_b64_tr_b16 a[144:145], v40 offset:20480
  v_mfma_f32_16x16x32_bf16 v[4:7], a[160:163], a[20:23], v[4:7]
  ds_read_b64_tr_b16 a[146:147], v40 offset:22528
  v_mfma_f32_16x16x32_bf16 v[12:15], a[164:167], a[20:23], v[12:15]
  ds_read_b64_tr_b16 a[132:133], v41 offset:16384
  v_mfma_f32_16x16x32_bf16 v[12:15], a[180:183], a[28:31], v[12:15]
  buffer_load_dwordx4 a[4:7], v49, s[4:7], s93 offen offset:0 sc1
  v_mfma_f32_16x16x32_bf16 v[8:11], a[180:183], a[24:27], v[8:11]
  ds_read_b64_tr_b16 a[134:135], v41 offset:18432
  ds_read_b64_tr_b16 a[148:149], v41 offset:20480
  v_mfma_f32_16x16x32_bf16 v[8:11], a[164:167], a[16:19], v[8:11]
  ds_read_b64_tr_b16 a[150:151], v41 offset:22528
  s_waitcnt lgkmcnt(8)
  v_mfma_f32_16x16x32_bf16 v[16:19], a[168:171], a[16:19], v[16:19]
  ds_read_b64_tr_b16 a[136:137], v42 offset:16384
  v_mfma_f32_16x16x32_bf16 v[16:19], a[184:187], a[24:27], v[16:19]
  buffer_load_dwordx4 a[8:11], v48, s[4:7], s93 offen offset:1024 sc1
  v_mfma_f32_16x16x32_bf16 v[20:23], a[184:187], a[28:31], v[20:23]
  ds_read_b64_tr_b16 a[138:139], v42 offset:18432
  ds_read_b64_tr_b16 a[152:153], v42 offset:20480
  v_mfma_f32_16x16x32_bf16 v[20:23], a[168:171], a[20:23], v[20:23]
  ds_read_b64_tr_b16 a[154:155], v42 offset:22528
  v_mfma_f32_16x16x32_bf16 v[28:31], a[172:175], a[20:23], v[28:31]
  ds_read_b64_tr_b16 a[140:141], v43 offset:16384
  v_mfma_f32_16x16x32_bf16 v[28:31], a[188:191], a[28:31], v[28:31]
  buffer_load_dwordx4 a[12:15], v49, s[4:7], s93 offen offset:1024 sc1
  v_mfma_f32_16x16x32_bf16 v[24:27], a[188:191], a[24:27], v[24:27]
  ds_read_b64_tr_b16 a[142:143], v43 offset:18432
  ds_read_b64_tr_b16 a[156:157], v43 offset:20480
  v_mfma_f32_16x16x32_bf16 v[24:27], a[172:175], a[16:19], v[24:27]
  ds_read_b64_tr_b16 a[158:159], v43 offset:22528
  s_waitcnt vmcnt(8) lgkmcnt(8)
  v_mfma_f32_16x16x32_bf16 v[0:3], a[128:131], a[32:35], v[0:3]
  ds_read_b64_tr_b16 a[160:161], v40 offset:24576
  v_mfma_f32_16x16x32_bf16 v[0:3], a[144:147], a[40:43], v[0:3]
  buffer_load_dwordx4 a[16:19], v48, s[4:7], s93 offen offset:2048 sc1
  v_mfma_f32_16x16x32_bf16 v[4:7], a[144:147], a[44:47], v[4:7]
  ds_read_b64_tr_b16 a[162:163], v40 offset:26624
  ds_read_b64_tr_b16 a[176:177], v40 offset:28672
  v_mfma_f32_16x16x32_bf16 v[4:7], a[128:131], a[36:39], v[4:7]
  ds_read_b64_tr_b16 a[178:179], v40 offset:30720
  v_add_u32 v40, 32768, v40
  v_mfma_f32_16x16x32_bf16 v[12:15], a[132:135], a[36:39], v[12:15]
  ds_read_b64_tr_b16 a[164:165], v41 offset:24576
  v_mfma_f32_16x16x32_bf16 v[12:15], a[148:151], a[44:47], v[12:15]
  buffer_load_dwordx4 a[20:23], v49, s[4:7], s93 offen offset:2048 sc1
  v_mfma_f32_16x16x32_bf16 v[8:11], a[148:151], a[40:43], v[8:11]
  ds_read_b64_tr_b16 a[166:167], v41 offset:26624
  ds_read_b64_tr_b16 a[180:181], v41 offset:28672
  v_mfma_f32_16x16x32_bf16 v[8:11], a[132:135], a[32:35], v[8:11]
  s_waitcnt lgkmcnt(7)
  ds_read_b64_tr_b16 a[182:183], v41 offset:30720
  v_add_u32 v41, 32768, v41
  v_mfma_f32_16x16x32_bf16 v[16:19], a[136:139], a[32:35], v[16:19]
  ds_read_b64_tr_b16 a[168:169], v42 offset:24576
  v_mfma_f32_16x16x32_bf16 v[16:19], a[152:155], a[40:43], v[16:19]
  buffer_load_dwordx4 a[24:27], v48, s[4:7], s93 offen offset:3072 sc1
  v_mfma_f32_16x16x32_bf16 v[20:23], a[152:155], a[44:47], v[20:23]
  ds_read_b64_tr_b16 a[170:171], v42 offset:26624
  ds_read_b64_tr_b16 a[184:185], v42 offset:28672
  v_mfma_f32_16x16x32_bf16 v[20:23], a[136:139], a[36:39], v[20:23]
  ds_read_b64_tr_b16 a[186:187], v42 offset:30720
  v_add_u32 v42, 32768, v42
  v_mfma_f32_16x16x32_bf16 v[28:31], a[140:143], a[36:39], v[28:31]
  ds_read_b64_tr_b16 a[172:173], v43 offset:24576
  v_mfma_f32_16x16x32_bf16 v[28:31], a[156:159], a[44:47], v[28:31]
  buffer_load_dwordx4 a[28:31], v49, s[4:7], s93 offen offset:3072 sc1
  v_mfma_f32_16x16x32_bf16 v[24:27], a[156:159], a[40:43], v[24:27]
  ds_read_b64_tr_b16 a[174:175], v43 offset:26624
  ds_read_b64_tr_b16 a[188:189], v43 offset:28672
  v_mfma_f32_16x16x32_bf16 v[24:27], a[140:143], a[32:35], v[24:27]
  s_waitcnt vmcnt(8) lgkmcnt(7)
  ds_read_b64_tr_b16 a[190:191], v43 offset:30720
  v_add_u32 v43, 32768, v43
  v_mfma_f32_16x16x32_bf16 v[0:3], a[160:163], a[48:51], v[0:3]
  ds_read_b64_tr_b16 a[128:129], v40 offset:0
  v_mfma_f32_16x16x32_bf16 v[0:3], a[176:179], a[56:59], v[0:3]
  s_add_u32 s57, s57, 4096
  s_xor_b32 s93, s57, s88
  buffer_load_dwordx4 a[32:35], v48, s[4:7], s93 offen offset:0 sc1
  v_mfma_f32_16x16x32_bf16 v[4:7], a[176:179], a[60:63], v[4:7]
  ds_read_b64_tr_b16 a[130:131], v40 offset:2048
  ds_read_b64_tr_b16 a[144:145], v40 offset:4096
  v_mfma_f32_16x16x32_bf16 v[4:7], a[160:163], a[52:55], v[4:7]
  ds_read_b64_tr_b16 a[146:147], v40 offset:6144
  v_mfma_f32_16x16x32_bf16 v[12:15], a[164:167], a[52:55], v[12:15]
  ds_read_b64_tr_b16 a[132:133], v41 offset:0
  v_mfma_f32_16x16x32_bf16 v[12:15], a[180:183], a[60:63], v[12:15]
  buffer_load_dwordx4 a[36:39], v49, s[4:7], s93 offen offset:0 sc1
  v_mfma_f32_16x16x32_bf16 v[8:11], a[180:183], a[56:59], v[8:11]
  ds_read_b64_tr_b16 a[134:135], v41 offset:2048
  ds_read_b64_tr_b16 a[148:149], v41 offset:4096
  v_mfma_f32_16x16x32_bf16 v[8:11], a[164:167], a[48:51], v[8:11]
  ds_read_b64_tr_b16 a[150:151], v41 offset:6144
  s_waitcnt lgkmcnt(8)
  v_mfma_f32_16x16x32_bf16 v[16:19], a[168:171], a[48:51], v[16:19]
  ds_read_b64_tr_b16 a[136:137], v42 offset:0
  v_mfma_f32_16x16x32_bf16 v[16:19], a[184:187], a[56:59], v[16:19]
  buffer_load_dwordx4 a[40:43], v48, s[4:7], s93 offen offset:1024 sc1
  v_mfma_f32_16x16x32_bf16 v[20:23], a[184:187], a[60:63], v[20:23]
  ds_read_b64_tr_b16 a[138:139], v42 offset:2048
  ds_read_b64_tr_b16 a[152:153], v42 offset:4096
  v_mfma_f32_16x16x32_bf16 v[20:23], a[168:171], a[52:55], v[20:23]
  ds_read_b64_tr_b16 a[154:155], v42 offset:6144
  v_mfma_f32_16x16x32_bf16 v[28:31], a[172:175], a[52:55], v[28:31]
  ds_read_b64_tr_b16 a[140:141], v43 offset:0
  v_mfma_f32_16x16x32_bf16 v[28:31], a[188:191], a[60:63], v[28:31]
  s_sub_u32 s56, s56, 1
  buffer_load_dwordx4 a[44:47], v49, s[4:7], s93 offen offset:1024 sc1
  v_mfma_f32_16x16x32_bf16 v[24:27], a[188:191], a[56:59], v[24:27]
  s_cmp_lg_u32 s56, 0
  ds_read_b64_tr_b16 a[142:143], v43 offset:2048
  ds_read_b64_tr_b16 a[156:157], v43 offset:4096
  v_mfma_f32_16x16x32_bf16 v[24:27], a[172:175], a[48:51], v[24:27]
  ds_read_b64_tr_b16 a[158:159], v43 offset:6144
  s_cbranch_scc1 Lp2_loop
Lmk_Lp2_loop_tail:
  s_waitcnt vmcnt(8) lgkmcnt(8)
  v_mfma_f32_16x16x32_bf16 v[0:3], a[128:131], a[0:3], v[0:3]
  ds_read_b64_tr_b16 a[160:161], v40 offset:8192
  v_mfma_f32_16x16x32_bf16 v[0:3], a[144:147], a[8:11], v[0:3]
  buffer_load_dwordx4 a[48:51], v48, s[4:7], s93 offen offset:2048 sc1
  v_mfma_f32_16x16x32_bf16 v[4:7], a[144:147], a[12:15], v[4:7]
  ds_read_b64_tr_b16 a[162:163], v40 offset:10240
  ds_read_b64_tr_b16 a[176:177], v40 offset:12288
  v_mfma_f32_16x16x32_bf16 v[4:7], a[128:131], a[4:7], v[4:7]
  ds_read_b64_tr_b16 a[178:179], v40 offset:14336
  v_mfma_f32_16x16x32_bf16 v[12:15], a[132:135], a[4:7], v[12:15]
  ds_read_b64_tr_b16 a[164:165], v41 offset:8192
  v_mfma_f32_16x16x32_bf16 v[12:15], a[148:151], a[12:15], v[12:15]
  buffer_load_dwordx4 a[52:55], v49, s[4:7], s93 offen offset:2048 sc1
  v_mfma_f32_16x16x32_bf16 v[8:11], a[148:151], a[8:11], v[8:11]
  ds_read_b64_tr_b16 a[166:167], v41 offset:10240
  ds_read_b64_tr_b16 a[180:181], v41 offset:12288
  v_mfma_f32_16x16x32_bf16 v[8:11], a[132:135], a[0:3], v[8:11]
  ds_read_b64_tr_b16 a[182:183], v41 offset:14336
  s_waitcnt lgkmcnt(8)
  v_mfma_f32_16x16x32_bf16 v[16:19], a[136:139], a[0:3], v[16:19]
  ds_read_b64_tr_b16 a[168:169], v42 offset:8192
  v_mfma_f32_16x16x32_bf16 v[16:19], a[152:155], a[8:11], v[16:19]
  buffer_load_dwordx4 a[56:59], v48, s[4:7], s93 offen offset:3072 sc1
  v_mfma_f32_16x16x32_bf16 v[20:23], a[152:155], a[12:15], v[20:23]
  ds_read_b64_tr_b16 a[170:171], v42 offset:10240
  ds_read_b64_tr_b16 a[184:185], v42 offset:12288
  v_mfma_f32_16x16x32_bf16 v[20:23], a[136:139], a[4:7], v[20:23]
  ds_read_b64_tr_b16 a[186:187], v42 offset:14336
  v_mfma_f32_16x16x32_bf16 v[28:31], a[140:143], a[4:7], v[28:31]
  ds_read_b64_tr_b16 a[172:173], v43 offset:8192
  v_mfma_f32_16x16x32_bf16 v[28:31], a[156:159], a[12:15], v[28:31]
  buffer_load_dwordx4 a[60:63], v49, s[4:7], s93 offen offset:3072 sc1
  v_mfma_f32_16x16x32_bf16 v[24:27], a[156:159], a[8:11], v[24:27]
  ds_read_b64_tr_b16 a[174:175], v43 offset:10240
  ds_read_b64_tr_b16 a[188:189], v43 offset:12288
  v_mfma_f32_16x16x32_bf16 v[24:27], a[140:143], a[0:3], v[24:27]
  ds_read_b64_tr_b16 a[190:191], v43 offset:14336
  s_waitcnt vmcnt(8) lgkmcnt(8)
  v_mfma_f32_16x16x32_bf16 v[0:3], a[160:163], a[16:19], v[0:3]
  ds_read_b64_tr_b16 a[128:129], v40 offset:16384
  v_mfma_f32_16x16x32_bf16 v[0:3], a[176:179], a[24:27], v[0:3]
  ds_read_b64_tr_b16 a[130:131], v40 offset:18432
  v_mfma_f32_16x16x32_bf16 v[4:7], a[176:179], a[28:31], v[4:7]
  ds_read_b64_tr_b16 a[144:145], v40 offset:20480
  v_mfma_f32_16x16x32_bf16 v[4:7], a[160:163], a[20:23], v[4:7]
  ds_read_b64_tr_b16 a[146:147], v40 offset:22528
  v_mfma_f32_16x16x32_bf16 v[12:15], a[164:167], a[20:23], v[12:15]
  ds_read_b64_tr_b16 a[132:133], v41 offset:16384
  v_mfma_f32_16x16x32_bf16 v[12:15], a[180:183], a[28:31], v[12:15]
  ds_read_b64_tr_b16 a[134:135], v41 offset:18432
  v_mfma_f32_16x16x32_bf16 v[8:11], a[180:183], a[24:27], v[8:11]
  ds_read_b64_tr_b16 a[148:149], v41 offset:20480
  v_mfma_f32_16x16x32_bf16 v[8:11], a[164:167], a[16:19], v[8:11]
  ds_read_b64_tr_b16 a[150:151], v41 offset:22528
  s_waitcnt lgkmcnt(8)
  v_mfma_f32_16x16x32_bf16 v[16:19], a[168:171], a[16:19], v[16:19]
  ds_read_b64_tr_b16 a[136:137], v42 offset:16384
  v_mfma_f32_16x16x32_bf16 v[16:19], a[184:187], a[24:27], v[16:19]
  ds_read_b64_tr_b16 a[138:139], v42 offset:18432
  v_mfma_f32_16x16x32_bf16 v[20:23], a[184:187], a[28:31], v[20:23]
  ds_read_b64_tr_b16 a[152:153], v42 offset:20480
  v_mfma_f32_16x16x32_bf16 v[20:23], a[168:171], a[20:23], v[20:23]
  ds_read_b64_tr_b16 a[154:155], v42 offset:22528
  v_mfma_f32_16x16x32_bf16 v[28:31], a[172:175], a[20:23], v[28:31]
  ds_read_b64_tr_b16 a[140:141], v43 offset:16384
  v_mfma_f32_16x16x32_bf16 v[28:31], a[188:191], a[28:31], v[28:31]
  ds_read_b64_tr_b16 a[142:143], v43 offset:18432
  v_mfma_f32_16x16x32_bf16 v[24:27], a[188:191], a[24:27], v[24:27]
  ds_read_b64_tr_b16 a[156:157], v43 offset:20480
  v_mfma_f32_16x16x32_bf16 v[24:27], a[172:175], a[16:19], v[24:27]
  ds_read_b64_tr_b16 a[158:159], v43 offset:22528
  s_waitcnt vmcnt(4) lgkmcnt(8)
  v_mfma_f32_16x16x32_bf16 v[0:3], a[128:131], a[32:35], v[0:3]
  ds_read_b64_tr_b16 a[160:161], v40 offset:24576
  v_mfma_f32_16x16x32_bf16 v[0:3], a[144:147], a[40:43], v[0:3]
  ds_read_b64_tr_b16 a[162:163], v40 offset:26624
  v_mfma_f32_16x16x32_bf16 v[4:7], a[144:147], a[44:47], v[4:7]
  ds_read_b64_tr_b16 a[176:177], v40 offset:28672
  v_mfma_f32_16x16x32_bf16 v[4:7], a[128:131], a[36:39], v[4:7]
  ds_read_b64_tr_b16 a[178:179], v40 offset:30720
  v_add_u32 v40, 32768, v40
  v_mfma_f32_16x16x32_bf16 v[12:15], a[132:135], a[36:39], v[12:15]
  ds_read_b64_tr_b16 a[164:165], v41 offset:24576
  v_mfma_f32_16x16x32_bf16 v[12:15], a[148:151], a[44:47], v[12:15]
  ds_read_b64_tr_b16 a[166:167], v41 offset:26624
  v_mfma_f32_16x16x32_bf16 v[8:11], a[148:151], a[40:43], v[8:11]
  ds_read_b64_tr_b16 a[180:181], v41 offset:28672
  v_mfma_f32_16x16x32_bf16 v[8:11], a[132:135], a[32:35], v[8:11]
  s_waitcnt lgkmcnt(7)
  ds_read_b64_tr_b16 a[182:183], v41 offset:30720
  v_add_u32 v41, 32768, v41
  v_mfma_f32_16x16x32_bf16 v[16:19], a[136:139], a[32:35], v[16:19]
  ds_read_b64_tr_b16 a[168:169], v42 offset:24576
  v_mfma_f32_16x16x32_bf16 v[16:19], a[152:155], a[40:43], v[16:19]
  ds_read_b64_tr_b16 a[170:171], v42 offset:26624
  v_mfma_f32_16x16x32_bf16 v[20:23], a[152:155], a[44:47], v[20:23]
  ds_read_b64_tr_b16 a[184:185], v42 offset:28672
  v_mfma_f32_16x16x32_bf16 v[20:23], a[136:139], a[36:39], v[20:23]
  ds_read_b64_tr_b16 a[186:187], v42 offset:30720
  v_add_u32 v42, 32768, v42
  v_mfma_f32_16x16x32_bf16 v[28:31], a[140:143], a[36:39], v[28:31]
  ds_read_b64_tr_b16 a[172:173], v43 offset:24576
  v_mfma_f32_16x16x32_bf16 v[28:31], a[156:159], a[44:47], v[28:31]
  ds_read_b64_tr_b16 a[174:175], v43 offset:26624
  v_mfma_f32_16x16x32_bf16 v[24:27], a[156:159], a[40:43], v[24:27]
  ds_read_b64_tr_b16 a[188:189], v43 offset:28672
  v_mfma_f32_16x16x32_bf16 v[24:27], a[140:143], a[32:35], v[24:27]
  s_waitcnt vmcnt(0) lgkmcnt(7)
  ds_read_b64_tr_b16 a[190:191], v43 offset:30720
  v_add_u32 v43, 32768, v43
  v_mfma_f32_16x16x32_bf16 v[0:3], a[160:163], a[48:51], v[0:3]
  v_mfma_f32_16x16x32_bf16 v[0:3], a[176:179], a[56:59], v[0:3]
  v_mfma_f32_16x16x32_bf16 v[4:7], a[176:179], a[60:63], v[4:7]
  v_mfma_f32_16x16x32_bf16 v[4:7], a[160:163], a[52:55], v[4:7]
  v_mfma_f32_16x16x32_bf16 v[12:15], a[164:167], a[52:55], v[12:15]
  v_mfma_f32_16x16x32_bf16 v[12:15], a[180:183], a[60:63], v[12:15]
  v_mfma_f32_16x16x32_bf16 v[8:11], a[180:183], a[56:59], v[8:11]
  v_mfma_f32_16x16x32_bf16 v[8:11], a[164:167], a[48:51], v[8:11]
  s_waitcnt lgkmcnt(0)
  v_mfma_f32_16x16x32_bf16 v[16:19], a[168:171], a[48:51], v[16:19]
  s_nop 0
  v_mfma_f32_16x16x32_bf16 v[16:19], a[184:187], a[56:59], v[16:19]
  s_nop 0
  v_mfma_f32_16x16x32_bf16 v[20:23], a[184:187], a[60:63], v[20:23]
  s_nop 0
  v_mfma_f32_16x16x32_bf16 v[20:23], a[168:171], a[52:55], v[20:23]
  v_cvt_pk_bf16_f32 v60, v4, v5
  v_cvt_pk_bf16_f32 v61, v6, v7
  v_mfma_f32_16x16x32_bf16 v[28:31], a[172:175], a[52:55], v[28:31]
  v_cvt_pk_bf16_f32 v62, v12, v13
  v_cvt_pk_bf16_f32 v63, v14, v15
  v_mfma_f32_16x16x32_bf16 v[28:31], a[188:191], a[60:63], v[28:31]
  buffer_store_dwordx4 v[60:63], v48, s[4:7], s59 offen offset:0 sc1
  v_mfma_f32_16x16x32_bf16 v[24:27], a[188:191], a[56:59], v[24:27]
  v_cvt_pk_bf16_f32 v52, v0, v1
  v_cvt_pk_bf16_f32 v53, v2, v3
  v_mfma_f32_16x16x32_bf16 v[24:27], a[172:175], a[48:51], v[24:27]
  v_cvt_pk_bf16_f32 v54, v8, v9
  v_cvt_pk_bf16_f32 v55, v10, v11
  v_mfma_f32_16x16x32_bf16 v[88:91], v[60:63], v[60:63], 0
  buffer_store_dwordx4 v[52:55], v48, s[4:7], s58 offen offset:0 sc1
  v_mfma_f32_16x16x32_bf16 v[84:87], v[72:75], v[60:63], 0
  v_cvt_pk_bf16_f32 v64, v20, v21
  v_mfma_f32_16x16x32_bf16 v[80:83], v[52:55], v[52:55], 0
  v_cvt_pk_bf16_f32 v65, v22, v23
  v_cvt_pk_bf16_f32 v66, v28, v29
  v_cvt_pk_bf16_f32 v67, v30, v31
  v_mfma_f32_16x16x32_bf16 v[76:79], v[72:75], v[52:55], 0
  buffer_store_dwordx4 v[64:67], v48, s[4:7], s59 offen offset:1024 sc1
  v_cvt_pk_bf16_f32 v56, v16, v17
  v_cvt_pk_bf16_f32 v57, v18, v19
  v_cvt_pk_bf16_f32 v58, v24, v25
  v_cvt_pk_bf16_f32 v59, v26, v27
  buffer_store_dwordx4 v[56:59], v48, s[4:7], s58 offen offset:1024 sc1
  s_nop 0
  v_mfma_f32_16x16x32_bf16 v[88:91], v[64:67], v[64:67], v[88:91]
  v_mfma_f32_16x16x32_bf16 v[84:87], v[72:75], v[64:67], v[84:87]
  v_mfma_f32_16x16x32_bf16 v[80:83], v[56:59], v[56:59], v[80:83]
  v_mfma_f32_16x16x32_bf16 v[76:79], v[72:75], v[56:59], v[76:79]
  s_nop 5
  v_cndmask_b32 v85, v88, v89, s[64:65]
  v_cndmask_b32 v85, v85, v90, s[66:67]
  v_cndmask_b32 v85, v85, v91, s[68:69]
  buffer_store_dwordx2 v[84:85], v92, s[4:7], s60 offen offset:2048 sc1
  v_cndmask_b32 v77, v80, v81, s[64:65]
  v_cndmask_b32 v77, v77, v82, s[66:67]
  v_cndmask_b32 v77, v77, v83, s[68:69]
  buffer_store_dwordx2 v[76:77], v92, s[4:7], s60 offen offset:0 sc1
  s_and_b32 s66, s55, 1
  v_lshrrev_b32 v2, 4, v253
  v_bfe_u32 v3, v253, 1, 3
  v_and_b32 v4, 1, v253
  v_lshlrev_b32 v4, 4, v4
  v_mul_u32_u24 v5, 7168, v2
  v_add_u32 v5, v5, v4
  s_cmp_eq_u32 s66, 0
  s_cselect_b32 s44, 7, 0
  v_mov_b32 v7, 0x40000000
  v_add_u32 v6, 0, v2
  v_xor_b32 v6, v6, v3
  v_cmp_eq_u32 vcc, s44, v6
  v_lshl_add_u32 v6, v6, 5, v5
  v_add_u32 v6, 0, v6
  v_cndmask_b32 v232, v6, v7, vcc
  v_add_u32 v6, 4, v2
  v_xor_b32 v6, v6, v3
  v_cmp_eq_u32 vcc, s44, v6
  v_lshl_add_u32 v6, v6, 5, v5
  v_add_u32 v6, 27648, v6
  v_cndmask_b32 v233, v6, v7, vcc
  v_add_u32 v6, 0, v2
  v_xor_b32 v6, v6, v3
  v_cmp_eq_u32 vcc, s44, v6
  v_lshl_add_u32 v6, v6, 5, v5
  v_add_u32 v6, 55296, v6
  v_cndmask_b32 v234, v6, v7, vcc
  v_add_u32 v6, 4, v2
  v_xor_b32 v6, v6, v3
  v_cmp_eq_u32 vcc, s44, v6
  v_lshl_add_u32 v6, v6, 5, v5
  v_add_u32 v6, 82944, v6
  v_cndmask_b32 v235, v6, v7, vcc
  s_mul_i32 s67, s55, 224
  s_and_b32 s67, s67, 0xffffffc0
  s_mul_i32 s43, s40, 114688
  s_add_u32 s67, s67, s43
  s_lshl_b32 s68, s40, 12
  v_lshlrev_b32 v231, 4, v253
  s_lshl_b32 s43, s41, 30
  v_or_b32 v236, s43, v231
  s_lshl_b32 s43, s2, 2
  s_add_u32 s43, s43, s40
  s_mul_i32 s70, s43, 7168
  s_lshl_b32 s69, s54, 2
  s_add_u32 s69, s69, s40
  s_lshl_b32 s72, s69, 17
  s_add_u32 s72, s72, s42
  s_add_u32 s72, s72, 4194304
  s_add_u32 s73, s72, 32768
  s_add_u32 s74, s73, 32768
  s_add_u32 s75, s74, 32768
  s_lshl_b32 s71, s40, 11
  s_add_u32 s71, s71, 131072
  v_lshrrev_b32 v2, 2, v253
  v_and_b32 v3, 7, v2
  v_and_b32 v4, 3, v253
  v_lshlrev_b32 v5, 3, v4
  v_lshl_add_u32 v5, v2, 8, v5
  s_lshl_b32 s43, s66, 1
  s_cmp_eq_u32 s66, 0
  s_cselect_b32 s45, 6, 1
  s_add_u32 s46, s43, 0
  v_xor_b32 v6, s46, v3
  v_lshl_add_u32 v224, v6, 5, v5
  s_add_u32 s46, s43, 1
  v_xor_b32 v6, s46, v3
  v_lshl_add_u32 v225, v6, 5, v5
  s_add_u32 s46, s43, 2
  v_xor_b32 v6, s46, v3
  v_lshl_add_u32 v226, v6, 5, v5
  s_add_u32 s46, s43, 3
  v_xor_b32 v6, s46, v3
  v_lshl_add_u32 v227, v6, 5, v5
  s_add_u32 s46, s43, 4
  v_xor_b32 v6, s46, v3
  v_lshl_add_u32 v228, v6, 5, v5
  s_add_u32 s46, s43, 5
  v_xor_b32 v6, s46, v3
  v_lshl_add_u32 v229, v6, 5, v5
  v_xor_b32 v6, s45, v3
  v_lshl_add_u32 v230, v6, 5, v5
  s_mul_i32 s46, s55, 448
  s_add_u32 s46, s46, 27918336
  s_add_u32 s47, s46, 28672
  s_lshr_b32 s48, s55, 3
  s_lshl_b32 s48, s48, 7
  s_add_u32 s48, s48, 27794432
  s_lshl_b32 s44, s69, 13
  s_add_u32 s44, s44, s42
  s_add_u32 s44, s44, 27525120
  s_add_u32 s45, s44, 4096
  s_waitcnt vmcnt(0)
  s_barrier
  s_cmp_lg_u32 s40, 0
  s_cbranch_scc1 Lsig15
  v_mov_b32 v250, 1
  s_mov_b64 exec, 1
  buffer_atomic_add v250, v251, s[4:7], s77 offen sc1
  s_mov_b64 exec, -1
Lsig15:
  s_cmp_lg_u32 s3, 0
  s_cbranch_scc1 Lc16_c
Lc16_r:
  s_add_u32 m0, s68, 0
  s_nop 0
  buffer_load_dwordx4 v232, s[16:19], s67 offen offset:0  lds
  buffer_load_dwordx4 v233, s[16:19], s67 offen offset:1024  lds
  buffer_load_dwordx4 v234, s[16:19], s67 offen offset:2048  lds
  buffer_load_dwordx4 v235, s[16:19], s67 offen offset:3072  lds
  s_add_u32 m0, s68, 16384
  s_nop 0
  buffer_load_dwordx4 v232, s[20:23], s67 offen offset:0  lds
  buffer_load_dwordx4 v233, s[20:23], s67 offen offset:1024  lds
  buffer_load_dwordx4 v234, s[20:23], s67 offen offset:2048  lds
  buffer_load_dwordx4 v235, s[20:23], s67 offen offset:3072  lds
  s_add_u32 s67, s67, 458752
  s_add_u32 m0, s68, 32768
  s_nop 0
  buffer_load_dwordx4 v232, s[16:19], s67 offen offset:0  lds
  buffer_load_dwordx4 v233, s[16:19], s67 offen offset:1024  lds
  buffer_load_dwordx4 v234, s[16:19], s67 offen offset:2048  lds
  buffer_load_dwordx4 v235, s[16:19], s67 offen offset:3072  lds
  s_add_u32 m0, s68, 49152
  s_nop 0
  buffer_load_dwordx4 v232, s[20:23], s67 offen offset:0  lds
  buffer_load_dwordx4 v233, s[20:23], s67 offen offset:1024  lds
  buffer_load_dwordx4 v234, s[20:23], s67 offen offset:2048  lds
  buffer_load_dwordx4 v235, s[20:23], s67 offen offset:3072  lds
  s_add_u32 s67, s67, 458752
  s_xor_b32 s68, s68, 0x10000
  s_mul_i32 s77, s54, 256
  s_add_u32 s77, s77, s42
  s_add_u32 s77, s77, 27791360
  v_lshlrev_b32 v249, 7, v253
  s_cmp_lg_u32 s40, 0
  s_cbranch_scc1 Lpdn18
  s_mov_b32 s43, 0x40000
  s_mov_b64 exec, 3
Lpol17:
  buffer_load_dword v250, v249, s[4:7], s77 offen  sc1
  s_waitcnt vmcnt(0)
  v_cmp_gt_u32 vcc, 16, v250
  s_cbranch_vccz Lpdn18x
  s_sub_u32 s43, s43, 1
  s_cmp_lg_u32 s43, 0
  s_cbranch_scc1 Lpol17
Lpdn18x:
  s_mov_b64 exec, -1
Lpdn18:
  s_waitcnt vmcnt(0) lgkmcnt(0)
  s_barrier
  buffer_load_dwordx4 a[0:3], v231, s[4:7], s72 offen offset:0 sc1
  buffer_load_dwordx4 a[16:19], v231, s[4:7], s72 offen offset:1024 sc1
  buffer_load_dwordx4 a[4:7], v231, s[4:7], s73 offen offset:0 sc1
  buffer_load_dwordx4 a[20:23], v231, s[4:7], s73 offen offset:1024 sc1
  buffer_load_dwordx4 a[8:11], v231, s[4:7], s74 offen offset:0 sc1
  buffer_load_dwordx4 a[24:27], v231, s[4:7], s74 offen offset:1024 sc1
  buffer_load_dwordx4 a[12:15], v231, s[4:7], s75 offen offset:0 sc1
  buffer_load_dwordx4 a[28:31], v231, s[4:7], s75 offen offset:1024 sc1
  ds_read_b64_tr_b16 a[64:65], v224 offset:0
  ds_read_b64_tr_b16 a[66:67], v224 offset:4096
  ds_read_b64_tr_b16 a[68:69], v224 offset:8192
  ds_read_b64_tr_b16 a[70:71], v224 offset:12288
  ds_read_b64_tr_b16 a[72:73], v224 offset:16384
  ds_read_b64_tr_b16 a[74:75], v224 offset:20480
  ds_read_b64_tr_b16 a[76:77], v224 offset:24576
  ds_read_b64_tr_b16 a[78:79], v224 offset:28672
Lmk_p3s0:
  s_waitcnt vmcnt(6) lgkmcnt(4)
  v_mfma_f32_16x16x32_bf16 v[0:3], a[64:67], a[0:3], 0
  ds_read_b64_tr_b16 a[80:81], v225 offset:0
  v_mfma_f32_16x16x32_bf16 v[0:3], a[68:71], a[16:19], v[0:3]
  ds_read_b64_tr_b16 a[82:83], v225 offset:4096
  s_waitcnt vmcnt(4)
  v_mfma_f32_16x16x32_bf16 v[4:7], a[68:71], a[20:23], 0
  v_mfma_f32_16x16x32_bf16 v[4:7], a[64:67], a[4:7], v[4:7]
  s_waitcnt vmcnt(2)
  v_mfma_f32_16x16x32_bf16 v[8:11], a[64:67], a[8:11], 0
  ds_read_b64_tr_b16 a[84:85], v225 offset:8192
  v_mfma_f32_16x16x32_bf16 v[8:11], a[68:71], a[24:27], v[8:11]
  ds_read_b64_tr_b16 a[86:87], v225 offset:12288
  s_waitcnt vmcnt(0)
  v_mfma_f32_16x16x32_bf16 v[12:15], a[68:71], a[28:31], 0
  v_mfma_f32_16x16x32_bf16 v[12:15], a[64:67], a[12:15], v[12:15]
  s_waitcnt lgkmcnt(4)
  v_mfma_f32_16x16x32_bf16 v[28:31], a[72:75], a[12:15], 0
  ds_read_b64_tr_b16 a[88:89], v225 offset:16384
  v_mfma_f32_16x16x32_bf16 v[28:31], a[76:79], a[28:31], v[28:31]
  ds_read_b64_tr_b16 a[90:91], v225 offset:20480
  v_mfma_f32_16x16x32_bf16 v[24:27], a[76:79], a[24:27], 0
  buffer_load_dwordx4 a[32:35], v231, s[4:7], s72 offen offset:2048 sc1
  v_mfma_f32_16x16x32_bf16 v[24:27], a[72:75], a[8:11], v[24:27]
  v_mfma_f32_16x16x32_bf16 v[20:23], a[72:75], a[4:7], 0
  ds_read_b64_tr_b16 a[92:93], v225 offset:24576
  v_mfma_f32_16x16x32_bf16 v[20:23], a[76:79], a[20:23], v[20:23]
  ds_read_b64_tr_b16 a[94:95], v225 offset:28672
  v_mfma_f32_16x16x32_bf16 v[16:19], a[76:79], a[16:19], 0
  buffer_load_dwordx4 a[48:51], v231, s[4:7], s72 offen offset:3072 sc1
  v_mfma_f32_16x16x32_bf16 v[16:19], a[72:75], a[0:3], v[16:19]
  s_add_u32 s72, s72, 4096
  s_waitcnt lgkmcnt(4)
  v_mfma_f32_16x16x32_bf16 v[32:35], a[80:83], a[0:3], 0
  ds_read_b64_tr_b16 a[64:65], v226 offset:0
  v_mfma_f32_16x16x32_bf16 v[32:35], a[84:87], a[16:19], v[32:35]
  ds_read_b64_tr_b16 a[66:67], v226 offset:4096
  v_mfma_f32_16x16x32_bf16 v[36:39], a[84:87], a[20:23], 0
  buffer_load_dwordx4 a[36:39], v231, s[4:7], s73 offen offset:2048 sc1
  v_mfma_f32_16x16x32_bf16 v[36:39], a[80:83], a[4:7], v[36:39]
  v_mfma_f32_16x16x32_bf16 v[40:43], a[80:83], a[8:11], 0
  ds_read_b64_tr_b16 a[68:69], v226 offset:8192
  v_mfma_f32_16x16x32_bf16 v[40:43], a[84:87], a[24:27], v[40:43]
  ds_read_b64_tr_b16 a[70:71], v226 offset:12288
  v_mfma_f32_16x16x32_bf16 v[44:47], a[84:87], a[28:31], 0
  buffer_load_dwordx4 a[52:55], v231, s[4:7], s73 offen offset:3072 sc1
  v_mfma_f32_16x16x32_bf16 v[44:47], a[80:83], a[12:15], v[44:47]
  s_add_u32 s73, s73, 4096
  s_waitcnt lgkmcnt(4)
  v_mfma_f32_16x16x32_bf16 v[60:63], a[88:91], a[12:15], 0
  ds_read_b64_tr_b16 a[72:73], v226 offset:16384
  v_mfma_f32_16x16x32_bf16 v[60:63], a[92:95], a[28:31], v[60:63]
  ds_read_b64_tr_b16 a[74:75], v226 offset:20480
  v_mfma_f32_16x16x32_bf16 v[56:59], a[92:95], a[24:27], 0
  buffer_load_dwordx4 a[40:43], v231, s[4:7], s74 offen offset:2048 sc1
  v_mfma_f32_16x16x32_bf16 v[56:59], a[88:91], a[8:11], v[56:59]
  v_mfma_f32_16x16x32_bf16 v[52:55], a[88:91], a[4:7], 0
  ds_read_b64_tr_b16 a[76:77], v226 offset:24576
  v_mfma_f32_16x16x32_bf16 v[52:55], a[92:95], a[20:23], v[52:55]
  ds_read_b64_tr_b16 a[78:79], v226 offset:28672
  v_mfma_f32_16x16x32_bf16 v[48:51], a[92:95], a[16:19], 0
  buffer_load_dwordx4 a[56:59], v231, s[4:7], s74 offen offset:3072 sc1
  v_mfma_f32_16x16x32_bf16 v[48:51], a[88:91], a[0:3], v[48:51]
  s_add_u32 s74, s74, 4096
  s_waitcnt lgkmcnt(4)
  v_mfma_f32_16x16x32_bf16 v[64:67], a[64:67], a[0:3], 0
  ds_read_b64_tr_b16 a[80:81], v227 offset:0
  v_mfma_f32_16x16x32_bf16 v[64:67], a[68:71], a[16:19], v[64:67]
  ds_read_b64_tr_b16 a[82:83], v227 offset:4096
  v_mfma_f32_16x16x32_bf16 v[68:71], a[68:71], a[20:23], 0
  buffer_load_dwordx4 a[44:47], v231, s[4:7], s75 offen offset:2048 sc1
  v_mfma_f32_16x16x32_bf16 v[68:71], a[64:67], a[4:7], v[68:71]
  v_mfma_f32_16x16x32_bf16 v[72:75], a[64:67], a[8:11], 0
  ds_read_b64_tr_b16 a[84:85], v227 offset:8192
  v_mfma_f32_16x16x32_bf16 v[72:75], a[68:71], a[24:27], v[72:75]
  ds_read_b64_tr_b16 a[86:87], v227 offset:12288
  v_mfma_f32_16x16x32_bf16 v[76:79], a[68:71], a[28:31], 0
  buffer_load_dwordx4 a[60:63], v231, s[4:7], s75 offen offset:3072 sc1
  v_mfma_f32_16x16x32_bf16 v[76:79], a[64:67], a[12:15], v[76:79]
  s_add_u32 s75, s75, 4096
  s_waitcnt lgkmcnt(4)
  v_mfma_f32_16x16x32_bf16 v[92:95], a[72:75], a[12:15], 0
  ds_read_b64_tr_b16 a[88:89], v227 offset:16384
  v_mfma_f32_16x16x32_bf16 v[92:95], a[76:79], a[28:31], v[92:95]
  ds_read_b64_tr_b16 a[90:91], v227 offset:20480
  s_add_u32 m0, s68, 32768
  v_mfma_f32_16x16x32_bf16 v[88:91], a[76:79], a[24:27], 0
  buffer_load_dwordx4 v231, s[4:7], s44 offen offset:0 sc1 lds
  v_mfma_f32_16x16x32_bf16 v[88:91], a[72:75], a[8:11], v[88:91]
  v_mfma_f32_16x16x32_bf16 v[84:87], a[72:75], a[4:7], 0
  ds_read_b64_tr_b16 a[92:93], v227 offset:24576
  v_mfma_f32_16x16x32_bf16 v[84:87], a[76:79], a[20:23], v[84:87]
  ds_read_b64_tr_b16 a[94:95], v227 offset:28672
  v_mfma_f32_16x16x32_bf16 v[80:83], a[76:79], a[16:19], 0
  buffer_load_dwordx4 v231, s[4:7], s44 offen offset:1024 sc1 lds
  v_mfma_f32_16x16x32_bf16 v[80:83], a[72:75], a[0:3], v[80:83]
  s_waitcnt lgkmcnt(4)
  v_mfma_f32_16x16x32_bf16 v[96:99], a[80:83], a[0:3], 0
  ds_read_b64_tr_b16 a[64:65], v228 offset:0
  v_mfma_f32_16x16x32_bf16 v[96:99], a[84:87], a[16:19], v[96:99]
  ds_read_b64_tr_b16 a[66:67], v228 offset:4096
  v_mfma_f32_16x16x32_bf16 v[100:103], a[84:87], a[20:23], 0
  buffer_load_dwordx4 v231, s[4:7], s44 offen offset:2048 sc1 lds
  v_mfma_f32_16x16x32_bf16 v[100:103], a[80:83], a[4:7], v[100:103]
  v_mfma_f32_16x16x32_bf16 v[104:107], a[80:83], a[8:11], 0
  ds_read_b64_tr_b16 a[68:69], v228 offset:8192
  v_mfma_f32_16x16x32_bf16 v[104:107], a[84:87], a[24:27], v[104:107]
  ds_read_b64_tr_b16 a[70:71], v228 offset:12288
  v_mfma_f32_16x16x32_bf16 v[108:111], a[84:87], a[28:31], 0
  buffer_load_dwordx4 v231, s[4:7], s44 offen offset:3072 sc1 lds
  v_mfma_f32_16x16x32_bf16 v[108:111], a[80:83], a[12:15], v[108:111]
  s_waitcnt lgkmcnt(4)
  v_mfma_f32_16x16x32_bf16 v[124:127], a[88:91], a[12:15], 0
  ds_read_b64_tr_b16 a[72:73], v228 offset:16384
  v_mfma_f32_16x16x32_bf16 v[124:127], a[92:95], a[28:31], v[124:127]
  ds_read_b64_tr_b16 a[74:75], v228 offset:20480
  s_add_u32 m0, s68, 49152
  v_mfma_f32_16x16x32_bf16 v[120:123], a[92:95], a[24:27], 0
  buffer_load_dwordx4 v231, s[4:7], s45 offen offset:0 sc1 lds
  v_mfma_f32_16x16x32_bf16 v[120:123], a[88:91], a[8:11], v[120:123]
  v_mfma_f32_16x16x32_bf16 v[116:119], a[88:91], a[4:7], 0
  ds_read_b64_tr_b16 a[76:77], v228 offset:24576
  v_mfma_f32_16x16x32_bf16 v[116:119], a[92:95], a[20:23], v[116:119]
  ds_read_b64_tr_b16 a[78:79], v228 offset:28672
  v_mfma_f32_16x16x32_bf16 v[112:115], a[92:95], a[16:19], 0
  buffer_load_dwordx4 v231, s[4:7], s45 offen offset:1024 sc1 lds
  v_mfma_f32_16x16x32_bf16 v[112:115], a[88:91], a[0:3], v[112:115]
  s_waitcnt lgkmcnt(4)
  v_mfma_f32_16x16x32_bf16 v[128:131], a[64:67], a[0:3], 0
  ds_read_b64_tr_b16 a[80:81], v229 offset:0
  v_mfma_f32_16x16x32_bf16 v[128:131], a[68:71], a[16:19], v[128:131]
  ds_read_b64_tr_b16 a[82:83], v229 offset:4096
  v_mfma_f32_16x16x32_bf16 v[132:135], a[68:71], a[20:23], 0
  buffer_load_dwordx4 v231, s[4:7], s45 offen offset:2048 sc1 lds
  v_mfma_f32_16x16x32_bf16 v[132:135], a[64:67], a[4:7], v[132:135]
  v_mfma_f32_16x16x32_bf16 v[136:139], a[64:67], a[8:11], 0
  ds_read_b64_tr_b16 a[84:85], v229 offset:8192
  v_mfma_f32_16x16x32_bf16 v[136:139], a[68:71], a[24:27], v[136:139]
  ds_read_b64_tr_b16 a[86:87], v229 offset:12288
  v_mfma_f32_16x16x32_bf16 v[140:143], a[68:71], a[28:31], 0
  buffer_load_dwordx4 v231, s[4:7], s45 offen offset:3072 sc1 lds
  v_mfma_f32_16x16x32_bf16 v[140:143], a[64:67], a[12:15], v[140:143]
  s_waitcnt lgkmcnt(4)
  v_mfma_f32_16x16x32_bf16 v[156:159], a[72:75], a[12:15], 0
  ds_read_b64_tr_b16 a[88:89], v229 offset:16384
  v_mfma_f32_16x16x32_bf16 v[156:159], a[76:79], a[28:31], v[156:159]
  ds_read_b64_tr_b16 a[90:91], v229 offset:20480
  s_add_u32 m0, s68, 0
  v_mfma_f32_16x16x32_bf16 v[152:155], a[76:79], a[24:27], 0
  buffer_load_dwordx4 v232, s[16:19], s67 offen offset:0  lds
  v_mfma_f32_16x16x32_bf16 v[152:155], a[72:75], a[8:11], v[152:155]
  v_mfma_f32_16x16x32_bf16 v[148:151], a[72:75], a[4:7], 0
  ds_read_b64_tr_b16 a[92:93], v229 offset:24576
  v_mfma_f32_16x16x32_bf16 v[148:151], a[76:79], a[20:23], v[148:151]
  ds_read_b64_tr_b16 a[94:95], v229 offset:28672
  v_mfma_f32_16x16x32_bf16 v[144:147], a[76:79], a[16:19], 0
  buffer_load_dwordx4 v233, s[16:19], s67 offen offset:1024  lds
  v_mfma_f32_16x16x32_bf16 v[144:147], a[72:75], a[0:3], v[144:147]
  s_waitcnt lgkmcnt(4)
  v_mfma_f32_16x16x32_bf16 v[160:163], a[80:83], a[0:3], 0
  ds_read_b64_tr_b16 a[64:65], v230 offset:0
  v_mfma_f32_16x16x32_bf16 v[160:163], a[84:87], a[16:19], v[160:163]
  ds_read_b64_tr_b16 a[66:67], v230 offset:4096
  v_mfma_f32_16x16x32_bf16 v[164:167], a[84:87], a[20:23], 0
  buffer_load_dwordx4 v234, s[16:19], s67 offen offset:2048  lds
  v_mfma_f32_16x16x32_bf16 v[164:167], a[80:83], a[4:7], v[164:167]
  v_mfma_f32_16x16x32_bf16 v[168:171], a[80:83], a[8:11], 0
  ds_read_b64_tr_b16 a[68:69], v230 offset:8192
  v_mfma_f32_16x16x32_bf16 v[168:171], a[84:87], a[24:27], v[168:171]
  ds_read_b64_tr_b16 a[70:71], v230 offset:12288
  v_mfma_f32_16x16x32_bf16 v[172:175], a[84:87], a[28:31], 0
  buffer_load_dwordx4 v235, s[16:19], s67 offen offset:3072  lds
  v_mfma_f32_16x16x32_bf16 v[172:175], a[80:83], a[12:15], v[172:175]
  s_waitcnt lgkmcnt(4)
  v_mfma_f32_16x16x32_bf16 v[188:191], a[88:91], a[12:15], 0
  ds_read_b64_tr_b16 a[72:73], v230 offset:16384
  v_mfma_f32_16x16x32_bf16 v[188:191], a[92:95], a[28:31], v[188:191]
  ds_read_b64_tr_b16 a[74:75], v230 offset:20480
  s_add_u32 m0, s68, 16384
  v_mfma_f32_16x16x32_bf16 v[184:187], a[92:95], a[24:27], 0
  buffer_load_dwordx4 v232, s[20:23], s67 offen offset:0  lds
  v_mfma_f32_16x16x32_bf16 v[184:187], a[88:91], a[8:11], v[184:187]
  v_mfma_f32_16x16x32_bf16 v[180:183], a[88:91], a[4:7], 0
  ds_read_b64_tr_b16 a[76:77], v230 offset:24576
  v_mfma_f32_16x16x32_bf16 v[180:183], a[92:95], a[20:23], v[180:183]
  ds_read_b64_tr_b16 a[78:79], v230 offset:28672
  v_mfma_f32_16x16x32_bf16 v[176:179], a[92:95], a[16:19], 0
  buffer_load_dwordx4 v233, s[20:23], s67 offen offset:1024  lds
  v_mfma_f32_16x16x32_bf16 v[176:179], a[88:91], a[0:3], v[176:179]
  s_waitcnt lgkmcnt(4)
  v_mfma_f32_16x16x32_bf16 v[192:195], a[64:67], a[0:3], 0
  s_barrier
  ds_read_b64_tr_b16 a[80:81], v224 offset:32768
  v_mfma_f32_16x16x32_bf16 v[192:195], a[68:71], a[16:19], v[192:195]
  ds_read_b64_tr_b16 a[82:83], v224 offset:36864
  v_mfma_f32_16x16x32_bf16 v[196:199], a[68:71], a[20:23], 0
  buffer_load_dwordx4 v234, s[20:23], s67 offen offset:2048  lds
  v_mfma_f32_16x16x32_bf16 v[196:199], a[64:67], a[4:7], v[196:199]
  v_mfma_f32_16x16x32_bf16 v[200:203], a[64:67], a[8:11], 0
  ds_read_b64_tr_b16 a[84:85], v224 offset:40960
  v_mfma_f32_16x16x32_bf16 v[200:203], a[68:71], a[24:27], v[200:203]
  ds_read_b64_tr_b16 a[86:87], v224 offset:45056
  v_mfma_f32_16x16x32_bf16 v[204:207], a[68:71], a[28:31], 0
  buffer_load_dwordx4 v235, s[20:23], s67 offen offset:3072  lds
  v_mfma_f32_16x16x32_bf16 v[204:207], a[64:67], a[12:15], v[204:207]
  s_add_u32 s67, s67, 458752
  s_waitcnt lgkmcnt(4)
  v_mfma_f32_16x16x32_bf16 v[220:223], a[72:75], a[12:15], 0
  ds_read_b64_tr_b16 a[88:89], v224 offset:49152
  v_mfma_f32_16x16x32_bf16 v[220:223], a[76:79], a[28:31], v[220:223]
  ds_read_b64_tr_b16 a[90:91], v224 offset:53248
  v_mfma_f32_16x16x32_bf16 v[216:219], a[76:79], a[24:27], 0
  buffer_load_dwordx4 a[96:99], v236, s[24:27], s70 offen
  v_mfma_f32_16x16x32_bf16 v[216:219], a[72:75], a[8:11], v[216:219]
  s_add_u32 s70, s70, 1024
  v_mfma_f32_16x16x32_bf16 v[212:215], a[72:75], a[4:7], 0
  ds_read_b64_tr_b16 a[92:93], v224 offset:57344
  v_mfma_f32_16x16x32_bf16 v[212:215], a[76:79], a[20:23], v[212:215]
  ds_read_b64_tr_b16 a[94:95], v224 offset:61440
  v_xor_b32 v224, 0x10000, v224
  v_mfma_f32_16x16x32_bf16 v[208:211], a[76:79], a[16:19], 0
  v_mfma_f32_16x16x32_bf16 v[208:211], a[72:75], a[0:3], v[208:211]
Lmk_p3s1:
  s_waitcnt vmcnt(17) lgkmcnt(4)
  v_mfma_f32_16x16x32_bf16 v[0:3], a[80:83], a[32:35], v[0:3]
  ds_read_b64_tr_b16 a[64:65], v225 offset:32768
  s_add_u32 s43, s68, 32768
  v_mfma_f32_16x16x32_bf16 v[0:3], a[84:87], a[48:51], v[0:3]
  ds_read_b64_tr_b16 a[66:67], v225 offset:36864
  v_lshlrev_b32 v250, 3, v253
  v_mfma_f32_16x16x32_bf16 v[4:7], a[84:87], a[52:55], v[4:7]
  buffer_load_dwordx4 a[0:3], v231, s[4:7], s72 offen offset:0 sc1
  v_mfma_f32_16x16x32_bf16 v[4:7], a[80:83], a[36:39], v[4:7]
  v_add_u32 v250, s43, v250
  v_mfma_f32_16x16x32_bf16 v[8:11], a[80:83], a[40:43], v[8:11]
  ds_read_b64_tr_b16 a[68:69], v225 offset:40960
  v_mfma_f32_16x16x32_bf16 v[8:11], a[84:87], a[56:59], v[8:11]
  ds_read_b64_tr_b16 a[70:71], v225 offset:45056
  v_mfma_f32_16x16x32_bf16 v[12:15], a[84:87], a[60:63], v[12:15]
  s_waitcnt vmcnt(10)
  ds_read_b64 v[238:239], v250 offset:0
  ds_read_b64 v[240:241], v250 offset:2048
  v_mfma_f32_16x16x32_bf16 v[12:15], a[80:83], a[44:47], v[12:15]
  s_waitcnt lgkmcnt(6)
  ds_read_b64 v[242:243], v250 offset:16384
  ds_read_b64 v[244:245], v250 offset:18432
  v_mfma_f32_16x16x32_bf16 v[28:31], a[88:91], a[44:47], v[28:31]
  ds_read_b64_tr_b16 a[72:73], v225 offset:49152
  v_mfma_f32_16x16x32_bf16 v[28:31], a[92:95], a[60:63], v[28:31]
  ds_read_b64_tr_b16 a[74:75], v225 offset:53248
  v_mfma_f32_16x16x32_bf16 v[24:27], a[92:95], a[56:59], v[24:27]
  buffer_load_dwordx4 a[16:19], v231, s[4:7], s72 offen offset:1024 sc1
  v_mfma_f32_16x16x32_bf16 v[24:27], a[88:91], a[40:43], v[24:27]
  ds_read_b64 v[246:247], v250 offset:512
  v_mfma_f32_16x16x32_bf16 v[20:23], a[88:91], a[36:39], v[20:23]
  ds_read_b64_tr_b16 a[76:77], v225 offset:57344
  v_mfma_f32_16x16x32_bf16 v[20:23], a[92:95], a[52:55], v[20:23]
  ds_read_b64_tr_b16 a[78:79], v225 offset:61440
  v_xor_b32 v225, 0x10000, v225
  v_mfma_f32_16x16x32_bf16 v[16:19], a[92:95], a[48:51], v[16:19]
  v_mfma_f32_16x16x32_bf16 v[16:19], a[88:91], a[32:35], v[16:19]
  ds_read_b64 v[248:249], v250 offset:2560
  s_waitcnt lgkmcnt(10)
  v_mfma_f32_16x16x32_bf16 v[32:35], a[64:67], a[32:35], v[32:35]
  s_waitcnt lgkmcnt(3)
  ds_read_b64_tr_b16 a[80:81], v226 offset:32768
  v_add_f32 v238, v238, v246
  v_mfma_f32_16x16x32_bf16 v[32:35], a[68:71], a[48:51], v[32:35]
  ds_read_b64_tr_b16 a[82:83], v226 offset:36864
  v_add_f32 v239, v239, v247
  v_mfma_f32_16x16x32_bf16 v[36:39], a[68:71], a[52:55], v[36:39]
  buffer_load_dwordx4 a[4:7], v231, s[4:7], s73 offen offset:0 sc1
  v_mfma_f32_16x16x32_bf16 v[36:39], a[64:67], a[36:39], v[36:39]
  ds_read_b64 v[246:247], v250 offset:16896
  v_mfma_f32_16x16x32_bf16 v[40:43], a[64:67], a[40:43], v[40:43]
  s_waitcnt lgkmcnt(3)
  ds_read_b64_tr_b16 a[84:85], v226 offset:40960
  v_add_f32 v240, v240, v248
  v_mfma_f32_16x16x32_bf16 v[40:43], a[68:71], a[56:59], v[40:43]
  ds_read_b64_tr_b16 a[86:87], v226 offset:45056
  v_add_f32 v241, v241, v249
  v_mfma_f32_16x16x32_bf16 v[44:47], a[68:71], a[60:63], v[44:47]
  buffer_load_dwordx4 a[20:23], v231, s[4:7], s73 offen offset:1024 sc1
  v_mfma_f32_16x16x32_bf16 v[44:47], a[64:67], a[44:47], v[44:47]
  ds_read_b64 v[248:249], v250 offset:18944
  v_mfma_f32_16x16x32_bf16 v[60:63], a[72:75], a[44:47], v[60:63]
  s_waitcnt lgkmcnt(3)
  ds_read_b64_tr_b16 a[88:89], v226 offset:49152
  v_add_f32 v242, v242, v246
  v_mfma_f32_16x16x32_bf16 v[60:63], a[76:79], a[60:63], v[60:63]
  ds_read_b64_tr_b16 a[90:91], v226 offset:53248
  v_add_f32 v243, v243, v247
  v_mfma_f32_16x16x32_bf16 v[56:59], a[76:79], a[56:59], v[56:59]
  v_mfma_f32_16x16x32_bf16 v[56:59], a[72:75], a[40:43], v[56:59]
  ds_read_b64 v[246:247], v250 offset:1024
  v_mfma_f32_16x16x32_bf16 v[52:55], a[72:75], a[36:39], v[52:55]
  s_waitcnt lgkmcnt(3)
  ds_read_b64_tr_b16 a[92:93], v226 offset:57344
  v_add_f32 v244, v244, v248
  v_mfma_f32_16x16x32_bf16 v[52:55], a[76:79], a[52:55], v[52:55]
  ds_read_b64_tr_b16 a[94:95], v226 offset:61440
  v_xor_b32 v226, 0x10000, v226
  v_add_f32 v245, v245, v249
  v_mfma_f32_16x16x32_bf16 v[48:51], a[76:79], a[48:51], v[48:51]
  buffer_load_dwordx4 a[8:11], v231, s[4:7], s74 offen offset:0 sc1
  v_mfma_f32_16x16x32_bf16 v[48:51], a[72:75], a[32:35], v[48:51]
  ds_read_b64 v[248:249], v250 offset:3072
  v_mfma_f32_16x16x32_bf16 v[64:67], a[80:83], a[32:35], v[64:67]
  s_waitcnt lgkmcnt(3)
  ds_read_b64_tr_b16 a[64:65], v227 offset:32768
  v_add_f32 v238, v238, v246
  v_mfma_f32_16x16x32_bf16 v[64:67], a[84:87], a[48:51], v[64:67]
  ds_read_b64_tr_b16 a[66:67], v227 offset:36864
  v_add_f32 v239, v239, v247
  v_mfma_f32_16x16x32_bf16 v[68:71], a[84:87], a[52:55], v[68:71]
  v_mfma_f32_16x16x32_bf16 v[68:71], a[80:83], a[36:39], v[68:71]
  ds_read_b64 v[246:247], v250 offset:17408
  v_mfma_f32_16x16x32_bf16 v[72:75], a[80:83], a[40:43], v[72:75]
  s_waitcnt lgkmcnt(3)
  ds_read_b64_tr_b16 a[68:69], v227 offset:40960
  v_add_f32 v240, v240, v248
  v_mfma_f32_16x16x32_bf16 v[72:75], a[84:87], a[56:59], v[72:75]
  ds_read_b64_tr_b16 a[70:71], v227 offset:45056
  v_add_f32 v241, v241, v249
  v_mfma_f32_16x16x32_bf16 v[76:79], a[84:87], a[60:63], v[76:79]
  buffer_load_dwordx4 a[24:27], v231, s[4:7], s74 offen offset:1024 sc1
  v_mfma_f32_16x16x32_bf16 v[76:79], a[80:83], a[44:47], v[76:79]
  ds_read_b64 v[248:249], v250 offset:19456
  v_mfma_f32_16x16x32_bf16 v[92:95], a[88:91], a[44:47], v[92:95]
  s_waitcnt lgkmcnt(3)
  ds_read_b64_tr_b16 a[72:73], v227 offset:49152
  v_add_f32 v242, v242, v246
  v_mfma_f32_16x16x32_bf16 v[92:95], a[92:95], a[60:63], v[92:95]
  ds_read_b64_tr_b16 a[74:75], v227 offset:53248
  v_add_f32 v243, v243, v247
  v_mfma_f32_16x16x32_bf16 v[88:91], a[92:95], a[56:59], v[88:91]
  buffer_load_dword v237, v251, s[4:7], s48 offen sc1
  v_mfma_f32_16x16x32_bf16 v[88:91], a[88:91], a[40:43], v[88:91]
  ds_read_b64 v[246:247], v250 offset:1536
  v_mfma_f32_16x16x32_bf16 v[84:87], a[88:91], a[36:39], v[84:87]
  s_waitcnt lgkmcnt(3)
  ds_read_b64_tr_b16 a[76:77], v227 offset:57344
  v_add_f32 v244, v244, v248
  v_mfma_f32_16x16x32_bf16 v[84:87], a[92:95], a[52:55], v[84:87]
  ds_read_b64_tr_b16 a[78:79], v227 offset:61440
  v_xor_b32 v227, 0x10000, v227
  v_add_f32 v245, v245, v249
  v_mfma_f32_16x16x32_bf16 v[80:83], a[92:95], a[48:51], v[80:83]
  buffer_load_dwordx4 a[12:15], v231, s[4:7], s75 offen offset:0 sc1
  v_mfma_f32_16x16x32_bf16 v[80:83], a[88:91], a[32:35], v[80:83]
  ds_read_b64 v[248:249], v250 offset:3584
  v_mfma_f32_16x16x32_bf16 v[96:99], a[64:67], a[32:35], v[96:99]
  s_waitcnt lgkmcnt(3)
  ds_read_b64_tr_b16 a[80:81], v228 offset:32768
  v_add_f32 v238, v238, v246
  v_mfma_f32_16x16x32_bf16 v[96:99], a[68:71], a[48:51], v[96:99]
  ds_read_b64_tr_b16 a[82:83], v228 offset:36864
  v_add_f32 v239, v239, v247
  v_mfma_f32_16x16x32_bf16 v[100:103], a[68:71], a[52:55], v[100:103]
  buffer_load_dwordx4 a[96:99], v236, s[24:27], s70 offen
  v_mfma_f32_16x16x32_bf16 v[100:103], a[64:67], a[36:39], v[100:103]
  s_add_u32 s70, s70, 1024
  ds_read_b64 v[246:247], v250 offset:17920
  v_mfma_f32_16x16x32_bf16 v[104:107], a[64:67], a[40:43], v[104:107]
  s_waitcnt lgkmcnt(3)
  ds_read_b64_tr_b16 a[84:85], v228 offset:40960
  v_add_f32 v240, v240, v248
  v_mfma_f32_16x16x32_bf16 v[104:107], a[68:71], a[56:59], v[104:107]
  ds_read_b64_tr_b16 a[86:87], v228 offset:45056
  v_add_f32 v241, v241, v249
  v_mfma_f32_16x16x32_bf16 v[108:111], a[68:71], a[60:63], v[108:111]
  buffer_load_dwordx4 a[28:31], v231, s[4:7], s75 offen offset:1024 sc1
  v_mfma_f32_16x16x32_bf16 v[108:111], a[64:67], a[44:47], v[108:111]
  ds_read_b64 v[248:249], v250 offset:19968
  v_mfma_f32_16x16x32_bf16 v[124:127], a[72:75], a[44:47], v[124:127]
  s_waitcnt lgkmcnt(3)
  ds_read_b64_tr_b16 a[88:89], v228 offset:49152
  v_add_f32 v242, v242, v246
  v_mfma_f32_16x16x32_bf16 v[124:127], a[76:79], a[60:63], v[124:127]
  ds_read_b64_tr_b16 a[90:91], v228 offset:53248
  v_add_f32 v243, v243, v247
  v_mfma_f32_16x16x32_bf16 v[120:123], a[76:79], a[56:59], v[120:123]
  v_mfma_f32_16x16x32_bf16 v[120:123], a[72:75], a[40:43], v[120:123]
  v_mfma_f32_16x16x32_bf16 v[116:119], a[72:75], a[36:39], v[116:119]
  s_waitcnt lgkmcnt(2)
  ds_read_b64_tr_b16 a[92:93], v228 offset:57344
  v_add_f32 v244, v244, v248
  v_mfma_f32_16x16x32_bf16 v[116:119], a[76:79], a[52:55], v[116:119]
  ds_read_b64_tr_b16 a[94:95], v228 offset:61440
  v_xor_b32 v228, 0x10000, v228
  v_mfma_f32_16x16x32_bf16 v[112:115], a[76:79], a[48:51], v[112:115]
  s_mov_b32 s43, 0x3a800000
  v_add_f32 v245, v245, v249
  v_mov_b32 v250, 0x3727c5ac
  v_mfma_f32_16x16x32_bf16 v[112:115], a[72:75], a[32:35], v[112:115]
  v_lshlrev_b32 v246, 2, v253
  v_add_u32 v246, s71, v246
  v_mfma_f32_16x16x32_bf16 v[128:131], a[80:83], a[32:35], v[128:131]
  ds_read_b64_tr_b16 a[64:65], v229 offset:32768
  v_permlane32_swap_b32 v238, v242
  v_mfma_f32_16x16x32_bf16 v[128:131], a[84:87], a[48:51], v[128:131]
  ds_read_b64_tr_b16 a[66:67], v229 offset:36864
  s_add_u32 m0, s68, 32768
  v_mfma_f32_16x16x32_bf16 v[132:135], a[84:87], a[52:55], v[132:135]
  buffer_load_dwordx4 v232, s[16:19], s67 offen offset:0  lds
  v_mfma_f32_16x16x32_bf16 v[132:135], a[80:83], a[36:39], v[132:135]
  v_permlane32_swap_b32 v239, v243
  v_permlane32_swap_b32 v240, v244
  v_mfma_f32_16x16x32_bf16 v[136:139], a[80:83], a[40:43], v[136:139]
  ds_read_b64_tr_b16 a[68:69], v229 offset:40960
  v_permlane32_swap_b32 v241, v245
  v_mfma_f32_16x16x32_bf16 v[136:139], a[84:87], a[56:59], v[136:139]
  ds_read_b64_tr_b16 a[70:71], v229 offset:45056
  v_add_f32 v238, v238, v242
  v_mfma_f32_16x16x32_bf16 v[140:143], a[84:87], a[60:63], v[140:143]
  buffer_load_dwordx4 v233, s[16:19], s67 offen offset:1024  lds
  v_mfma_f32_16x16x32_bf16 v[140:143], a[80:83], a[44:47], v[140:143]
  s_waitcnt lgkmcnt(4)
  v_add_f32 v240, v240, v244
  v_add_f32 v239, v239, v243
  v_mfma_f32_16x16x32_bf16 v[156:159], a[88:91], a[44:47], v[156:159]
  ds_read_b64_tr_b16 a[72:73], v229 offset:49152
  v_add_f32 v241, v241, v245
  v_mfma_f32_16x16x32_bf16 v[156:159], a[92:95], a[60:63], v[156:159]
  ds_read_b64_tr_b16 a[74:75], v229 offset:53248
  v_and_b32 v247, 0xffffff3f, v246
  v_mfma_f32_16x16x32_bf16 v[152:155], a[92:95], a[56:59], v[152:155]
  buffer_load_dwordx4 v234, s[16:19], s67 offen offset:2048  lds
  v_mfma_f32_16x16x32_bf16 v[152:155], a[88:91], a[40:43], v[152:155]
  v_permlane16_swap_b32 v238, v240
  v_permlane16_swap_b32 v239, v241
  v_mfma_f32_16x16x32_bf16 v[148:151], a[88:91], a[36:39], v[148:151]
  ds_read_b64_tr_b16 a[76:77], v229 offset:57344
  v_add_f32 v238, v238, v240
  v_mfma_f32_16x16x32_bf16 v[148:151], a[92:95], a[52:55], v[148:151]
  ds_read_b64_tr_b16 a[78:79], v229 offset:61440
  v_xor_b32 v229, 0x10000, v229
  v_add_f32 v239, v239, v241
  v_mfma_f32_16x16x32_bf16 v[144:147], a[92:95], a[48:51], v[144:147]
  v_add_u32 v247, 1024, v247
  v_mul_f32 v238, 0xba800000, v238
  v_mfma_f32_16x16x32_bf16 v[144:147], a[88:91], a[32:35], v[144:147]
  s_waitcnt lgkmcnt(4)
  v_fma_f32 v239, v239, s43, v250
  v_fma_f32 v239, -v238, v238, v239
  v_mfma_f32_16x16x32_bf16 v[160:163], a[64:67], a[32:35], v[160:163]
  ds_read_b64_tr_b16 a[80:81], v230 offset:32768
  v_max_f32 v239, v239, v250
  v_mfma_f32_16x16x32_bf16 v[160:163], a[68:71], a[48:51], v[160:163]
  ds_read_b64_tr_b16 a[82:83], v230 offset:36864
  v_rsq_f32 v240, v239
  v_mfma_f32_16x16x32_bf16 v[164:167], a[68:71], a[52:55], v[164:167]
  buffer_load_dwordx4 v235, s[16:19], s67 offen offset:3072  lds
  v_mfma_f32_16x16x32_bf16 v[164:167], a[64:67], a[36:39], v[164:167]
  ds_write_b32 v246, v238 offset:1024
  ds_write_b32 v246, v239 offset:1536
  v_mfma_f32_16x16x32_bf16 v[168:171], a[64:67], a[40:43], v[168:171]
  ds_read_b64_tr_b16 a[84:85], v230 offset:40960
  v_mul_f32 v240, 0xbfb8aa3b, v240
  v_mfma_f32_16x16x32_bf16 v[168:171], a[68:71], a[56:59], v[168:171]
  ds_read_b64_tr_b16 a[86:87], v230 offset:45056
  s_add_u32 m0, s68, 49152
  v_mfma_f32_16x16x32_bf16 v[172:175], a[68:71], a[60:63], v[172:175]
  buffer_load_dwordx4 v232, s[20:23], s67 offen offset:0  lds
  v_mfma_f32_16x16x32_bf16 v[172:175], a[64:67], a[44:47], v[172:175]
  s_waitcnt lgkmcnt(6)
  ds_write_b32 v246, v240 offset:1280
  ds_read2_b32 v[238:239], v247 offset0:0 offset1:16
  v_mfma_f32_16x16x32_bf16 v[188:191], a[72:75], a[44:47], v[188:191]
  ds_read_b64_tr_b16 a[88:89], v230 offset:49152
  ds_read2_b32 v[240:241], v247 offset0:32 offset1:48
  v_mfma_f32_16x16x32_bf16 v[188:191], a[76:79], a[60:63], v[188:191]
  ds_read_b64_tr_b16 a[90:91], v230 offset:53248
  v_lshrrev_b32 v250, 3, v253
  v_mfma_f32_16x16x32_bf16 v[184:187], a[76:79], a[56:59], v[184:187]
  v_add_u32 v250, s66, v250
  v_cmp_ne_u32 vcc, 7, v250
  v_mfma_f32_16x16x32_bf16 v[184:187], a[72:75], a[40:43], v[184:187]
  v_bfe_u32 v242, v253, 2, 1
  v_mul_u32_u24 v242, 14336, v242
  v_mfma_f32_16x16x32_bf16 v[180:183], a[72:75], a[36:39], v[180:183]
  ds_read_b64_tr_b16 a[92:93], v230 offset:57344
  v_cndmask_b32 v250, 0, v250, vcc
  v_mfma_f32_16x16x32_bf16 v[180:183], a[76:79], a[52:55], v[180:183]
  ds_read_b64_tr_b16 a[94:95], v230 offset:61440
  v_xor_b32 v230, 0x10000, v230
  v_lshl_add_u32 v250, v250, 6, v242
  v_mfma_f32_16x16x32_bf16 v[176:179], a[76:79], a[48:51], v[176:179]
  buffer_load_dwordx4 v233, s[20:23], s67 offen offset:1024  lds
  v_mfma_f32_16x16x32_bf16 v[176:179], a[72:75], a[32:35], v[176:179]
  s_waitcnt lgkmcnt(7)
  v_and_b32 v242, 3, v253
  v_lshl_add_u32 v250, v242, 4, v250
  v_mfma_f32_16x16x32_bf16 v[192:195], a[80:83], a[32:35], v[192:195]
  s_waitcnt vmcnt(17)
  s_barrier
  ds_read_b64_tr_b16 a[64:65], v224 offset:0
  s_waitcnt vmcnt(9)
  v_cmp_gt_u32 vcc, 56, v237
  s_cbranch_vccnz Lchk19_c
Lchk19_r:
  v_mfma_f32_16x16x32_bf16 v[192:195], a[84:87], a[48:51], v[192:195]
  ds_read_b64_tr_b16 a[66:67], v224 offset:4096
  buffer_load_dwordx4 v[242:245], v250, s[4:7], s46 offen sc1
  v_mfma_f32_16x16x32_bf16 v[196:199], a[84:87], a[52:55], v[196:199]
  buffer_load_dwordx4 v[246:249], v250, s[4:7], s47 offen sc1
  v_lshrrev_b32 v237, 4, v253
  v_mfma_f32_16x16x32_bf16 v[196:199], a[80:83], a[36:39], v[196:199]
  v_lshlrev_b32 v237, 4, v237
  v_add_u32 v237, s71, v237
  v_mfma_f32_16x16x32_bf16 v[200:203], a[80:83], a[40:43], v[200:203]
  ds_read_b64_tr_b16 a[68:69], v224 offset:8192
  v_add_u32 v250, s71, v231
  v_mfma_f32_16x16x32_bf16 v[200:203], a[84:87], a[56:59], v[200:203]
  ds_read_b64_tr_b16 a[70:71], v224 offset:12288
  v_mfma_f32_16x16x32_bf16 v[204:207], a[84:87], a[60:63], v[204:207]
  buffer_load_dwordx4 v234, s[20:23], s67 offen offset:2048  lds
  v_mfma_f32_16x16x32_bf16 v[204:207], a[80:83], a[44:47], v[204:207]
  s_waitcnt lgkmcnt(4)
  v_mfma_f32_16x16x32_bf16 v[220:223], a[88:91], a[44:47], v[220:223]
  ds_read_b64_tr_b16 a[72:73], v224 offset:16384
  v_mfma_f32_16x16x32_bf16 v[220:223], a[92:95], a[60:63], v[220:223]
  ds_read_b64_tr_b16 a[74:75], v224 offset:20480
  v_mfma_f32_16x16x32_bf16 v[216:219], a[92:95], a[56:59], v[216:219]
  buffer_load_dwordx4 v235, s[20:23], s67 offen offset:3072  lds
  v_mfma_f32_16x16x32_bf16 v[216:219], a[88:91], a[40:43], v[216:219]
  s_add_u32 s67, s67, 458752
  s_xor_b32 s68, s68, 0x10000
  v_mfma_f32_16x16x32_bf16 v[212:215], a[88:91], a[36:39], v[212:215]
  ds_read_b64_tr_b16 a[76:77], v224 offset:24576
  v_mfma_f32_16x16x32_bf16 v[212:215], a[92:95], a[52:55], v[212:215]
  ds_read_b64_tr_b16 a[78:79], v224 offset:28672
  v_mfma_f32_16x16x32_bf16 v[208:211], a[92:95], a[48:51], v[208:211]
  v_mfma_f32_16x16x32_bf16 v[208:211], a[88:91], a[32:35], v[208:211]
  s_mov_b32 s56, 5
.p2align 3
Lp3_loop:
  s_waitcnt vmcnt(8) lgkmcnt(4)
  v_mfma_f32_16x16x32_bf16 v[0:3], a[64:67], a[0:3], v[0:3]
  ds_read_b64_tr_b16 a[80:81], v225 offset:0
  v_mfma_f32_16x16x32_bf16 v[0:3], a[68:71], a[16:19], v[0:3]
  ds_read_b64_tr_b16 a[82:83], v225 offset:4096
  v_mfma_f32_16x16x32_bf16 v[4:7], a[68:71], a[20:23], v[4:7]
  buffer_load_dwordx4 a[32:35], v231, s[4:7], s72 offen offset:2048 sc1
  v_mfma_f32_16x16x32_bf16 v[4:7], a[64:67], a[4:7], v[4:7]
  v_mfma_f32_16x16x32_bf16 v[8:11], a[64:67], a[8:11], v[8:11]
  ds_read_b64_tr_b16 a[84:85], v225 offset:8192
  v_mfma_f32_16x16x32_bf16 v[8:11], a[68:71], a[24:27], v[8:11]
  ds_read_b64_tr_b16 a[86:87], v225 offset:12288
  v_mfma_f32_16x16x32_bf16 v[12:15], a[68:71], a[28:31], v[12:15]
  v_mfma_f32_16x16x32_bf16 v[12:15], a[64:67], a[12:15], v[12:15]
  s_waitcnt lgkmcnt(4)
  v_mfma_f32_16x16x32_bf16 v[28:31], a[72:75], a[12:15], v[28:31]
  ds_read_b64_tr_b16 a[88:89], v225 offset:16384
  v_mfma_f32_16x16x32_bf16 v[28:31], a[76:79], a[28:31], v[28:31]
  ds_read_b64_tr_b16 a[90:91], v225 offset:20480
  v_mfma_f32_16x16x32_bf16 v[24:27], a[76:79], a[24:27], v[24:27]
  buffer_load_dwordx4 a[48:51], v231, s[4:7], s72 offen offset:3072 sc1
  v_mfma_f32_16x16x32_bf16 v[24:27], a[72:75], a[8:11], v[24:27]
  s_add_u32 s72, s72, 4096
  v_mfma_f32_16x16x32_bf16 v[20:23], a[72:75], a[4:7], v[20:23]
  ds_read_b64_tr_b16 a[92:93], v225 offset:24576
  v_mfma_f32_16x16x32_bf16 v[20:23], a[76:79], a[20:23], v[20:23]
  ds_read_b64_tr_b16 a[94:95], v225 offset:28672
  v_mfma_f32_16x16x32_bf16 v[16:19], a[76:79], a[16:19], v[16:19]
  v_mfma_f32_16x16x32_bf16 v[16:19], a[72:75], a[0:3], v[16:19]
  s_waitcnt lgkmcnt(4)
  v_mfma_f32_16x16x32_bf16 v[32:35], a[80:83], a[0:3], v[32:35]
  ds_read_b64_tr_b16 a[64:65], v226 offset:0
  v_mfma_f32_16x16x32_bf16 v[32:35], a[84:87], a[16:19], v[32:35]
  ds_read_b64_tr_b16 a[66:67], v226 offset:4096
  v_mfma_f32_16x16x32_bf16 v[36:39], a[84:87], a[20:23], v[36:39]
  buffer_load_dwordx4 a[36:39], v231, s[4:7], s73 offen offset:2048 sc1
  v_mfma_f32_16x16x32_bf16 v[36:39], a[80:83], a[4:7], v[36:39]
  v_mfma_f32_16x16x32_bf16 v[40:43], a[80:83], a[8:11], v[40:43]
  ds_read_b64_tr_b16 a[68:69], v226 offset:8192
  v_mfma_f32_16x16x32_bf16 v[40:43], a[84:87], a[24:27], v[40:43]
  ds_read_b64_tr_b16 a[70:71], v226 offset:12288
  v_mfma_f32_16x16x32_bf16 v[44:47], a[84:87], a[28:31], v[44:47]
  buffer_load_dwordx4 a[52:55], v231, s[4:7], s73 offen offset:3072 sc1
  v_mfma_f32_16x16x32_bf16 v[44:47], a[80:83], a[12:15], v[44:47]
  s_add_u32 s73, s73, 4096
  s_waitcnt lgkmcnt(4)
  v_mfma_f32_16x16x32_bf16 v[60:63], a[88:91], a[12:15], v[60:63]
  ds_read_b64_tr_b16 a[72:73], v226 offset:16384
  v_mfma_f32_16x16x32_bf16 v[60:63], a[92:95], a[28:31], v[60:63]
  ds_read_b64_tr_b16 a[74:75], v226 offset:20480
  v_mfma_f32_16x16x32_bf16 v[56:59], a[92:95], a[24:27], v[56:59]
  v_mfma_f32_16x16x32_bf16 v[56:59], a[88:91], a[8:11], v[56:59]
  v_mfma_f32_16x16x32_bf16 v[52:55], a[88:91], a[4:7], v[52:55]
  ds_read_b64_tr_b16 a[76:77], v226 offset:24576
  v_mfma_f32_16x16x32_bf16 v[52:55], a[92:95], a[20:23], v[52:55]
  ds_read_b64_tr_b16 a[78:79], v226 offset:28672
  v_mfma_f32_16x16x32_bf16 v[48:51], a[92:95], a[16:19], v[48:51]
  buffer_load_dwordx4 a[40:43], v231, s[4:7], s74 offen offset:2048 sc1
  v_mfma_f32_16x16x32_bf16 v[48:51], a[88:91], a[0:3], v[48:51]
  s_waitcnt lgkmcnt(4)
  v_mfma_f32_16x16x32_bf16 v[64:67], a[64:67], a[0:3], v[64:67]
  ds_read_b64_tr_b16 a[80:81], v227 offset:0
  v_mfma_f32_16x16x32_bf16 v[64:67], a[68:71], a[16:19], v[64:67]
  ds_read_b64_tr_b16 a[82:83], v227 offset:4096
  v_mfma_f32_16x16x32_bf16 v[68:71], a[68:71], a[20:23], v[68:71]
  v_mfma_f32_16x16x32_bf16 v[68:71], a[64:67], a[4:7], v[68:71]
  v_mfma_f32_16x16x32_bf16 v[72:75], a[64:67], a[8:11], v[72:75]
  ds_read_b64_tr_b16 a[84:85], v227 offset:8192
  v_mfma_f32_16x16x32_bf16 v[72:75], a[68:71], a[24:27], v[72:75]
  ds_read_b64_tr_b16 a[86:87], v227 offset:12288
  v_mfma_f32_16x16x32_bf16 v[76:79], a[68:71], a[28:31], v[76:79]
  buffer_load_dwordx4 a[56:59], v231, s[4:7], s74 offen offset:3072 sc1
  v_mfma_f32_16x16x32_bf16 v[76:79], a[64:67], a[12:15], v[76:79]
  s_add_u32 s74, s74, 4096
  s_waitcnt lgkmcnt(4)
  v_mfma_f32_16x16x32_bf16 v[92:95], a[72:75], a[12:15], v[92:95]
  ds_read_b64_tr_b16 a[88:89], v227 offset:16384
  v_mfma_f32_16x16x32_bf16 v[92:95], a[76:79], a[28:31], v[92:95]
  ds_read_b64_tr_b16 a[90:91], v227 offset:20480
  v_mfma_f32_16x16x32_bf16 v[88:91], a[76:79], a[24:27], v[88:91]
  v_mfma_f32_16x16x32_bf16 v[88:91], a[72:75], a[8:11], v[88:91]
  v_mfma_f32_16x16x32_bf16 v[84:87], a[72:75], a[4:7], v[84:87]
  ds_read_b64_tr_b16 a[92:93], v227 offset:24576
  v_mfma_f32_16x16x32_bf16 v[84:87], a[76:79], a[20:23], v[84:87]
  ds_read_b64_tr_b16 a[94:95], v227 offset:28672
  v_mfma_f32_16x16x32_bf16 v[80:83], a[76:79], a[16:19], v[80:83]
  buffer_load_dwordx4 a[44:47], v231, s[4:7], s75 offen offset:2048 sc1
  v_mfma_f32_16x16x32_bf16 v[80:83], a[72:75], a[0:3], v[80:83]
  s_waitcnt lgkmcnt(4)
  v_mfma_f32_16x16x32_bf16 v[96:99], a[80:83], a[0:3], v[96:99]
  ds_read_b64_tr_b16 a[64:65], v228 offset:0
  v_mfma_f32_16x16x32_bf16 v[96:99], a[84:87], a[16:19], v[96:99]
  ds_read_b64_tr_b16 a[66:67], v228 offset:4096
  v_mfma_f32_16x16x32_bf16 v[100:103], a[84:87], a[20:23], v[100:103]
  buffer_load_dwordx4 a[96:99], v236, s[24:27], s70 offen
  v_mfma_f32_16x16x32_bf16 v[100:103], a[80:83], a[4:7], v[100:103]
  s_add_u32 s70, s70, 1024
  v_mfma_f32_16x16x32_bf16 v[104:107], a[80:83], a[8:11], v[104:107]
  ds_read_b64_tr_b16 a[68:69], v228 offset:8192
  v_mfma_f32_16x16x32_bf16 v[104:107], a[84:87], a[24:27], v[104:107]
  ds_read_b64_tr_b16 a[70:71], v228 offset:12288
  v_mfma_f32_16x16x32_bf16 v[108:111], a[84:87], a[28:31], v[108:111]
  buffer_load_dwordx4 a[60:63], v231, s[4:7], s75 offen offset:3072 sc1
  v_mfma_f32_16x16x32_bf16 v[108:111], a[80:83], a[12:15], v[108:111]
  s_add_u32 s75, s75, 4096
  s_waitcnt lgkmcnt(4)
  v_mfma_f32_16x16x32_bf16 v[124:127], a[88:91], a[12:15], v[124:127]
  ds_read_b64_tr_b16 a[72:73], v228 offset:16384
  v_mfma_f32_16x16x32_bf16 v[124:127], a[92:95], a[28:31], v[124:127]
  ds_read_b64_tr_b16 a[74:75], v228 offset:20480
  s_add_u32 m0, s68, 0
  v_mfma_f32_16x16x32_bf16 v[120:123], a[92:95], a[24:27], v[120:123]
  buffer_load_dwordx4 v232, s[16:19], s67 offen offset:0  lds
  v_mfma_f32_16x16x32_bf16 v[120:123], a[88:91], a[8:11], v[120:123]
  v_mfma_f32_16x16x32_bf16 v[116:119], a[88:91], a[4:7], v[116:119]
  ds_read_b64_tr_b16 a[76:77], v228 offset:24576
  v_mfma_f32_16x16x32_bf16 v[116:119], a[92:95], a[20:23], v[116:119]
  ds_read_b64_tr_b16 a[78:79], v228 offset:28672
  v_mfma_f32_16x16x32_bf16 v[112:115], a[92:95], a[16:19], v[112:115]
  v_mfma_f32_16x16x32_bf16 v[112:115], a[88:91], a[0:3], v[112:115]
  s_waitcnt lgkmcnt(4)
  v_mfma_f32_16x16x32_bf16 v[128:131], a[64:67], a[0:3], v[128:131]
  ds_read_b64_tr_b16 a[80:81], v229 offset:0
  v_mfma_f32_16x16x32_bf16 v[128:131], a[68:71], a[16:19], v[128:131]
  ds_read_b64_tr_b16 a[82:83], v229 offset:4096
  v_mfma_f32_16x16x32_bf16 v[132:135], a[68:71], a[20:23], v[132:135]
  buffer_load_dwordx4 v233, s[16:19], s67 offen offset:1024  lds
  v_mfma_f32_16x16x32_bf16 v[132:135], a[64:67], a[4:7], v[132:135]
  v_mfma_f32_16x16x32_bf16 v[136:139], a[64:67], a[8:11], v[136:139]
  ds_read_b64_tr_b16 a[84:85], v229 offset:8192
  v_mfma_f32_16x16x32_bf16 v[136:139], a[68:71], a[24:27], v[136:139]
  ds_read_b64_tr_b16 a[86:87], v229 offset:12288
  v_mfma_f32_16x16x32_bf16 v[140:143], a[68:71], a[28:31], v[140:143]
  v_mfma_f32_16x16x32_bf16 v[140:143], a[64:67], a[12:15], v[140:143]
  s_waitcnt lgkmcnt(4)
  v_mfma_f32_16x16x32_bf16 v[156:159], a[72:75], a[12:15], v[156:159]
  ds_read_b64_tr_b16 a[88:89], v229 offset:16384
  v_mfma_f32_16x16x32_bf16 v[156:159], a[76:79], a[28:31], v[156:159]
  ds_read_b64_tr_b16 a[90:91], v229 offset:20480
  v_mfma_f32_16x16x32_bf16 v[152:155], a[76:79], a[24:27], v[152:155]
  buffer_load_dwordx4 v234, s[16:19], s67 offen offset:2048  lds
  v_mfma_f32_16x16x32_bf16 v[152:155], a[72:75], a[8:11], v[152:155]
  v_mfma_f32_16x16x32_bf16 v[148:151], a[72:75], a[4:7], v[148:151]
  ds_read_b64_tr_b16 a[92:93], v229 offset:24576
  v_mfma_f32_16x16x32_bf16 v[148:151], a[76:79], a[20:23], v[148:151]
  ds_read_b64_tr_b16 a[94:95], v229 offset:28672
  v_mfma_f32_16x16x32_bf16 v[144:147], a[76:79], a[16:19], v[144:147]
  buffer_load_dwordx4 v235, s[16:19], s67 offen offset:3072  lds
  v_mfma_f32_16x16x32_bf16 v[144:147], a[72:75], a[0:3], v[144:147]
  s_waitcnt lgkmcnt(4)
  v_mfma_f32_16x16x32_bf16 v[160:163], a[80:83], a[0:3], v[160:163]
  ds_read_b64_tr_b16 a[64:65], v230 offset:0
  v_mfma_f32_16x16x32_bf16 v[160:163], a[84:87], a[16:19], v[160:163]
  ds_read_b64_tr_b16 a[66:67], v230 offset:4096
  v_mfma_f32_16x16x32_bf16 v[164:167], a[84:87], a[20:23], v[164:167]
  v_mfma_f32_16x16x32_bf16 v[164:167], a[80:83], a[4:7], v[164:167]
  v_mfma_f32_16x16x32_bf16 v[168:171], a[80:83], a[8:11], v[168:171]
  ds_read_b64_tr_b16 a[68:69], v230 offset:8192
  v_mfma_f32_16x16x32_bf16 v[168:171], a[84:87], a[24:27], v[168:171]
  ds_read_b64_tr_b16 a[70:71], v230 offset:12288
  s_add_u32 m0, s68, 16384
  v_mfma_f32_16x16x32_bf16 v[172:175], a[84:87], a[28:31], v[172:175]
  buffer_load_dwordx4 v232, s[20:23], s67 offen offset:0  lds
  v_mfma_f32_16x16x32_bf16 v[172:175], a[80:83], a[12:15], v[172:175]
  s_waitcnt lgkmcnt(4)
  v_mfma_f32_16x16x32_bf16 v[188:191], a[88:91], a[12:15], v[188:191]
  ds_read_b64_tr_b16 a[72:73], v230 offset:16384
  v_mfma_f32_16x16x32_bf16 v[188:191], a[92:95], a[28:31], v[188:191]
  ds_read_b64_tr_b16 a[74:75], v230 offset:20480
  v_mfma_f32_16x16x32_bf16 v[184:187], a[92:95], a[24:27], v[184:187]
  v_mfma_f32_16x16x32_bf16 v[184:187], a[88:91], a[8:11], v[184:187]
  v_mfma_f32_16x16x32_bf16 v[180:183], a[88:91], a[4:7], v[180:183]
  ds_read_b64_tr_b16 a[76:77], v230 offset:24576
  v_mfma_f32_16x16x32_bf16 v[180:183], a[92:95], a[20:23], v[180:183]
  ds_read_b64_tr_b16 a[78:79], v230 offset:28672
  v_mfma_f32_16x16x32_bf16 v[176:179], a[92:95], a[16:19], v[176:179]
  buffer_load_dwordx4 v233, s[20:23], s67 offen offset:1024  lds
  v_mfma_f32_16x16x32_bf16 v[176:179], a[88:91], a[0:3], v[176:179]
  s_waitcnt lgkmcnt(4)
  v_mfma_f32_16x16x32_bf16 v[192:195], a[64:67], a[0:3], v[192:195]
  s_waitcnt vmcnt(15)
  s_barrier
  ds_read_b64_tr_b16 a[80:81], v224 offset:32768
  v_mfma_f32_16x16x32_bf16 v[192:195], a[68:71], a[16:19], v[192:195]
  ds_read_b64_tr_b16 a[82:83], v224 offset:36864
  v_mfma_f32_16x16x32_bf16 v[196:199], a[68:71], a[20:23], v[196:199]
  v_mfma_f32_16x16x32_bf16 v[196:199], a[64:67], a[4:7], v[196:199]
  v_mfma_f32_16x16x32_bf16 v[200:203], a[64:67], a[8:11], v[200:203]
  ds_read_b64_tr_b16 a[84:85], v224 offset:40960
  v_mfma_f32_16x16x32_bf16 v[200:203], a[68:71], a[24:27], v[200:203]
  ds_read_b64_tr_b16 a[86:87], v224 offset:45056
  v_mfma_f32_16x16x32_bf16 v[204:207], a[68:71], a[28:31], v[204:207]
  buffer_load_dwordx4 v234, s[20:23], s67 offen offset:2048  lds
  v_mfma_f32_16x16x32_bf16 v[204:207], a[64:67], a[12:15], v[204:207]
  s_waitcnt lgkmcnt(4)
  v_mfma_f32_16x16x32_bf16 v[220:223], a[72:75], a[12:15], v[220:223]
  ds_read_b64_tr_b16 a[88:89], v224 offset:49152
  v_mfma_f32_16x16x32_bf16 v[220:223], a[76:79], a[28:31], v[220:223]
  ds_read_b64_tr_b16 a[90:91], v224 offset:53248
  v_mfma_f32_16x16x32_bf16 v[216:219], a[76:79], a[24:27], v[216:219]
  buffer_load_dwordx4 v235, s[20:23], s67 offen offset:3072  lds
  v_mfma_f32_16x16x32_bf16 v[216:219], a[72:75], a[8:11], v[216:219]
  s_add_u32 s67, s67, 458752
  v_mfma_f32_16x16x32_bf16 v[212:215], a[72:75], a[4:7], v[212:215]
  ds_read_b64_tr_b16 a[92:93], v224 offset:57344
  v_mfma_f32_16x16x32_bf16 v[212:215], a[76:79], a[20:23], v[212:215]
  ds_read_b64_tr_b16 a[94:95], v224 offset:61440
  v_xor_b32 v224, 0x10000, v224
  v_mfma_f32_16x16x32_bf16 v[208:211], a[76:79], a[16:19], v[208:211]
  v_mfma_f32_16x16x32_bf16 v[208:211], a[72:75], a[0:3], v[208:211]
  s_waitcnt vmcnt(8) lgkmcnt(4)
  v_mfma_f32_16x16x32_bf16 v[0:3], a[80:83], a[32:35], v[0:3]
  ds_read_b64_tr_b16 a[64:65], v225 offset:32768
  v_mfma_f32_16x16x32_bf16 v[0:3], a[84:87], a[48:51], v[0:3]
  ds_read_b64_tr_b16 a[66:67], v225 offset:36864
  v_mfma_f32_16x16x32_bf16 v[4:7], a[84:87], a[52:55], v[4:7]
  buffer_load_dwordx4 a[0:3], v231, s[4:7], s72 offen offset:0 sc1
  v_mfma_f32_16x16x32_bf16 v[4:7], a[80:83], a[36:39], v[4:7]
  v_mfma_f32_16x16x32_bf16 v[8:11], a[80:83], a[40:43], v[8:11]
  ds_read_b64_tr_b16 a[68:69], v225 offset:40960
  v_mfma_f32_16x16x32_bf16 v[8:11], a[84:87], a[56:59], v[8:11]
  ds_read_b64_tr_b16 a[70:71], v225 offset:45056
  v_mfma_f32_16x16x32_bf16 v[12:15], a[84:87], a[60:63], v[12:15]
  v_mfma_f32_16x16x32_bf16 v[12:15], a[80:83], a[44:47], v[12:15]
  s_waitcnt lgkmcnt(4)
  v_mfma_f32_16x16x32_bf16 v[28:31], a[88:91], a[44:47], v[28:31]
  ds_read_b64_tr_b16 a[72:73], v225 offset:49152
  v_mfma_f32_16x16x32_bf16 v[28:31], a[92:95], a[60:63], v[28:31]
  ds_read_b64_tr_b16 a[74:75], v225 offset:53248
  v_mfma_f32_16x16x32_bf16 v[24:27], a[92:95], a[56:59], v[24:27]
  buffer_load_dwordx4 a[16:19], v231, s[4:7], s72 offen offset:1024 sc1
  v_mfma_f32_16x16x32_bf16 v[24:27], a[88:91], a[40:43], v[24:27]
  v_mfma_f32_16x16x32_bf16 v[20:23], a[88:91], a[36:39], v[20:23]
  ds_read_b64_tr_b16 a[76:77], v225 offset:57344
  v_mfma_f32_16x16x32_bf16 v[20:23], a[92:95], a[52:55], v[20:23]
  ds_read_b64_tr_b16 a[78:79], v225 offset:61440
  v_xor_b32 v225, 0x10000, v225
  v_mfma_f32_16x16x32_bf16 v[16:19], a[92:95], a[48:51], v[16:19]
  v_mfma_f32_16x16x32_bf16 v[16:19], a[88:91], a[32:35], v[16:19]
  s_waitcnt lgkmcnt(4)
  v_mfma_f32_16x16x32_bf16 v[32:35], a[64:67], a[32:35], v[32:35]
  ds_read_b64_tr_b16 a[80:81], v226 offset:32768
  v_mfma_f32_16x16x32_bf16 v[32:35], a[68:71], a[48:51], v[32:35]
  ds_read_b64_tr_b16 a[82:83], v226 offset:36864
  v_mfma_f32_16x16x32_bf16 v[36:39], a[68:71], a[52:55], v[36:39]
  buffer_load_dwordx4 a[4:7], v231, s[4:7], s73 offen offset:0 sc1
  v_mfma_f32_16x16x32_bf16 v[36:39], a[64:67], a[36:39], v[36:39]
  v_mfma_f32_16x16x32_bf16 v[40:43], a[64:67], a[40:43], v[40:43]
  ds_read_b64_tr_b16 a[84:85], v226 offset:40960
  v_mfma_f32_16x16x32_bf16 v[40:43], a[68:71], a[56:59], v[40:43]
  ds_read_b64_tr_b16 a[86:87], v226 offset:45056
  v_mfma_f32_16x16x32_bf16 v[44:47], a[68:71], a[60:63], v[44:47]
  buffer_load_dwordx4 a[20:23], v231, s[4:7], s73 offen offset:1024 sc1
  v_mfma_f32_16x16x32_bf16 v[44:47], a[64:67], a[44:47], v[44:47]
  s_waitcnt lgkmcnt(4)
  v_mfma_f32_16x16x32_bf16 v[60:63], a[72:75], a[44:47], v[60:63]
  ds_read_b64_tr_b16 a[88:89], v226 offset:49152
  v_mfma_f32_16x16x32_bf16 v[60:63], a[76:79], a[60:63], v[60:63]
  ds_read_b64_tr_b16 a[90:91], v226 offset:53248
  v_mfma_f32_16x16x32_bf16 v[56:59], a[76:79], a[56:59], v[56:59]
  v_mfma_f32_16x16x32_bf16 v[56:59], a[72:75], a[40:43], v[56:59]
  v_mfma_f32_16x16x32_bf16 v[52:55], a[72:75], a[36:39], v[52:55]
  ds_read_b64_tr_b16 a[92:93], v226 offset:57344
  v_mfma_f32_16x16x32_bf16 v[52:55], a[76:79], a[52:55], v[52:55]
  ds_read_b64_tr_b16 a[94:95], v226 offset:61440
  v_xor_b32 v226, 0x10000, v226
  v_mfma_f32_16x16x32_bf16 v[48:51], a[76:79], a[48:51], v[48:51]
  buffer_load_dwordx4 a[8:11], v231, s[4:7], s74 offen offset:0 sc1
  v_mfma_f32_16x16x32_bf16 v[48:51], a[72:75], a[32:35], v[48:51]
  s_waitcnt lgkmcnt(4)
  v_mfma_f32_16x16x32_bf16 v[64:67], a[80:83], a[32:35], v[64:67]
  ds_read_b64_tr_b16 a[64:65], v227 offset:32768
  v_mfma_f32_16x16x32_bf16 v[64:67], a[84:87], a[48:51], v[64:67]
  ds_read_b64_tr_b16 a[66:67], v227 offset:36864
  v_mfma_f32_16x16x32_bf16 v[68:71], a[84:87], a[52:55], v[68:71]
  v_mfma_f32_16x16x32_bf16 v[68:71], a[80:83], a[36:39], v[68:71]
  v_mfma_f32_16x16x32_bf16 v[72:75], a[80:83], a[40:43], v[72:75]
  ds_read_b64_tr_b16 a[68:69], v227 offset:40960
  v_mfma_f32_16x16x32_bf16 v[72:75], a[84:87], a[56:59], v[72:75]
  ds_read_b64_tr_b16 a[70:71], v227 offset:45056
  v_mfma_f32_16x16x32_bf16 v[76:79], a[84:87], a[60:63], v[76:79]
  buffer_load_dwordx4 a[24:27], v231, s[4:7], s74 offen offset:1024 sc1
  v_mfma_f32_16x16x32_bf16 v[76:79], a[80:83], a[44:47], v[76:79]
  s_waitcnt lgkmcnt(4)
  v_mfma_f32_16x16x32_bf16 v[92:95], a[88:91], a[44:47], v[92:95]
  ds_read_b64_tr_b16 a[72:73], v227 offset:49152
  v_mfma_f32_16x16x32_bf16 v[92:95], a[92:95], a[60:63], v[92:95]
  ds_read_b64_tr_b16 a[74:75], v227 offset:53248
  v_mfma_f32_16x16x32_bf16 v[88:91], a[92:95], a[56:59], v[88:91]
  v_mfma_f32_16x16x32_bf16 v[88:91], a[88:91], a[40:43], v[88:91]
  v_mfma_f32_16x16x32_bf16 v[84:87], a[88:91], a[36:39], v[84:87]
  ds_read_b64_tr_b16 a[76:77], v227 offset:57344
  v_mfma_f32_16x16x32_bf16 v[84:87], a[92:95], a[52:55], v[84:87]
  ds_read_b64_tr_b16 a[78:79], v227 offset:61440
  v_xor_b32 v227, 0x10000, v227
  v_mfma_f32_16x16x32_bf16 v[80:83], a[92:95], a[48:51], v[80:83]
  buffer_load_dwordx4 a[12:15], v231, s[4:7], s75 offen offset:0 sc1
  v_mfma_f32_16x16x32_bf16 v[80:83], a[88:91], a[32:35], v[80:83]
  s_waitcnt lgkmcnt(4)
  v_mfma_f32_16x16x32_bf16 v[96:99], a[64:67], a[32:35], v[96:99]
  ds_read_b64_tr_b16 a[80:81], v228 offset:32768
  v_mfma_f32_16x16x32_bf16 v[96:99], a[68:71], a[48:51], v[96:99]
  ds_read_b64_tr_b16 a[82:83], v228 offset:36864
  v_mfma_f32_16x16x32_bf16 v[100:103], a[68:71], a[52:55], v[100:103]
  v_mfma_f32_16x16x32_bf16 v[100:103], a[64:67], a[36:39], v[100:103]
  v_mfma_f32_16x16x32_bf16 v[104:107], a[64:67], a[40:43], v[104:107]
  ds_read_b64_tr_b16 a[84:85], v228 offset:40960
  v_mfma_f32_16x16x32_bf16 v[104:107], a[68:71], a[56:59], v[104:107]
  ds_read_b64_tr_b16 a[86:87], v228 offset:45056
  v_mfma_f32_16x16x32_bf16 v[108:111], a[68:71], a[60:63], v[108:111]
  buffer_load_dwordx4 a[28:31], v231, s[4:7], s75 offen offset:1024 sc1
  v_mfma_f32_16x16x32_bf16 v[108:111], a[64:67], a[44:47], v[108:111]
  s_waitcnt lgkmcnt(4)
  v_mfma_f32_16x16x32_bf16 v[124:127], a[72:75], a[44:47], v[124:127]
  ds_read_b64_tr_b16 a[88:89], v228 offset:49152
  v_mfma_f32_16x16x32_bf16 v[124:127], a[76:79], a[60:63], v[124:127]
  ds_read_b64_tr_b16 a[90:91], v228 offset:53248
  s_add_u32 m0, s68, 32768
  v_mfma_f32_16x16x32_bf16 v[120:123], a[76:79], a[56:59], v[120:123]
  buffer_load_dwordx4 v232, s[16:19], s67 offen offset:0  lds
  v_mfma_f32_16x16x32_bf16 v[120:123], a[72:75], a[40:43], v[120:123]
  v_mfma_f32_16x16x32_bf16 v[116:119], a[72:75], a[36:39], v[116:119]
  ds_read_b64_tr_b16 a[92:93], v228 offset:57344
  v_mfma_f32_16x16x32_bf16 v[116:119], a[76:79], a[52:55], v[116:119]
  ds_read_b64_tr_b16 a[94:95], v228 offset:61440
  v_xor_b32 v228, 0x10000, v228
  v_mfma_f32_16x16x32_bf16 v[112:115], a[76:79], a[48:51], v[112:115]
  v_mfma_f32_16x16x32_bf16 v[112:115], a[72:75], a[32:35], v[112:115]
  s_waitcnt lgkmcnt(4)
  v_mfma_f32_16x16x32_bf16 v[128:131], a[80:83], a[32:35], v[128:131]
  ds_read_b64_tr_b16 a[64:65], v229 offset:32768
  v_mfma_f32_16x16x32_bf16 v[128:131], a[84:87], a[48:51], v[128:131]
  ds_read_b64_tr_b16 a[66:67], v229 offset:36864
  v_mfma_f32_16x16x32_bf16 v[132:135], a[84:87], a[52:55], v[132:135]
  buffer_load_dwordx4 v233, s[16:19], s67 offen offset:1024  lds
  v_mfma_f32_16x16x32_bf16 v[132:135], a[80:83], a[36:39], v[132:135]
  v_mfma_f32_16x16x32_bf16 v[136:139], a[80:83], a[40:43], v[136:139]
  ds_read_b64_tr_b16 a[68:69], v229 offset:40960
  v_mfma_f32_16x16x32_bf16 v[136:139], a[84:87], a[56:59], v[136:139]
  ds_read_b64_tr_b16 a[70:71], v229 offset:45056
  v_mfma_f32_16x16x32_bf16 v[140:143], a[84:87], a[60:63], v[140:143]
  v_mfma_f32_16x16x32_bf16 v[140:143], a[80:83], a[44:47], v[140:143]
  s_waitcnt lgkmcnt(4)
  v_mfma_f32_16x16x32_bf16 v[156:159], a[88:91], a[44:47], v[156:159]
  ds_read_b64_tr_b16 a[72:73], v229 offset:49152
  v_mfma_f32_16x16x32_bf16 v[156:159], a[92:95], a[60:63], v[156:159]
  ds_read_b64_tr_b16 a[74:75], v229 offset:53248
  v_mfma_f32_16x16x32_bf16 v[152:155], a[92:95], a[56:59], v[152:155]
  buffer_load_dwordx4 v234, s[16:19], s67 offen offset:2048  lds
  v_mfma_f32_16x16x32_bf16 v[152:155], a[88:91], a[40:43], v[152:155]
  v_mfma_f32_16x16x32_bf16 v[148:151], a[88:91], a[36:39], v[148:151]
  ds_read_b64_tr_b16 a[76:77], v229 offset:57344
  v_mfma_f32_16x16x32_bf16 v[148:151], a[92:95], a[52:55], v[148:151]
  ds_read_b64_tr_b16 a[78:79], v229 offset:61440
  v_xor_b32 v229, 0x10000, v229
  v_mfma_f32_16x16x32_bf16 v[144:147], a[92:95], a[48:51], v[144:147]
  buffer_load_dwordx4 v235, s[16:19], s67 offen offset:3072  lds
  v_mfma_f32_16x16x32_bf16 v[144:147], a[88:91], a[32:35], v[144:147]
  s_waitcnt lgkmcnt(4)
  v_mfma_f32_16x16x32_bf16 v[160:163], a[64:67], a[32:35], v[160:163]
  ds_read_b64_tr_b16 a[80:81], v230 offset:32768
  v_mfma_f32_16x16x32_bf16 v[160:163], a[68:71], a[48:51], v[160:163]
  ds_read_b64_tr_b16 a[82:83], v230 offset:36864
  v_mfma_f32_16x16x32_bf16 v[164:167], a[68:71], a[52:55], v[164:167]
  v_mfma_f32_16x16x32_bf16 v[164:167], a[64:67], a[36:39], v[164:167]
  v_mfma_f32_16x16x32_bf16 v[168:171], a[64:67], a[40:43], v[168:171]
  ds_read_b64_tr_b16 a[84:85], v230 offset:40960
  v_mfma_f32_16x16x32_bf16 v[168:171], a[68:71], a[56:59], v[168:171]
  ds_read_b64_tr_b16 a[86:87], v230 offset:45056
  s_add_u32 m0, s68, 49152
  v_mfma_f32_16x16x32_bf16 v[172:175], a[68:71], a[60:63], v[172:175]
  buffer_load_dwordx4 v232, s[20:23], s67 offen offset:0  lds
  v_mfma_f32_16x16x32_bf16 v[172:175], a[64:67], a[44:47], v[172:175]
  s_waitcnt lgkmcnt(4)
  v_mfma_f32_16x16x32_bf16 v[188:191], a[72:75], a[44:47], v[188:191]
  ds_read_b64_tr_b16 a[88:89], v230 offset:49152
  v_mfma_f32_16x16x32_bf16 v[188:191], a[76:79], a[60:63], v[188:191]
  ds_read_b64_tr_b16 a[90:91], v230 offset:53248
  v_mfma_f32_16x16x32_bf16 v[184:187], a[76:79], a[56:59], v[184:187]
  v_mfma_f32_16x16x32_bf16 v[184:187], a[72:75], a[40:43], v[184:187]
  v_mfma_f32_16x16x32_bf16 v[180:183], a[72:75], a[36:39], v[180:183]
  ds_read_b64_tr_b16 a[92:93], v230 offset:57344
  v_mfma_f32_16x16x32_bf16 v[180:183], a[76:79], a[52:55], v[180:183]
  ds_read_b64_tr_b16 a[94:95], v230 offset:61440
  v_xor_b32 v230, 0x10000, v230
  v_mfma_f32_16x16x32_bf16 v[176:179], a[76:79], a[48:51], v[176:179]
  buffer_load_dwordx4 v233, s[20:23], s67 offen offset:1024  lds
  v_mfma_f32_16x16x32_bf16 v[176:179], a[72:75], a[32:35], v[176:179]
  s_waitcnt lgkmcnt(4)
  v_mfma_f32_16x16x32_bf16 v[192:195], a[80:83], a[32:35], v[192:195]
  s_waitcnt vmcnt(14)
  s_barrier
  ds_read_b64_tr_b16 a[64:65], v224 offset:0
  v_mfma_f32_16x16x32_bf16 v[192:195], a[84:87], a[48:51], v[192:195]
  ds_read_b64_tr_b16 a[66:67], v224 offset:4096
  v_mfma_f32_16x16x32_bf16 v[196:199], a[84:87], a[52:55], v[196:199]
  v_mfma_f32_16x16x32_bf16 v[196:199], a[80:83], a[36:39], v[196:199]
  v_mfma_f32_16x16x32_bf16 v[200:203], a[80:83], a[40:43], v[200:203]
  ds_read_b64_tr_b16 a[68:69], v224 offset:8192
  v_mfma_f32_16x16x32_bf16 v[200:203], a[84:87], a[56:59], v[200:203]
  ds_read_b64_tr_b16 a[70:71], v224 offset:12288
  v_mfma_f32_16x16x32_bf16 v[204:207], a[84:87], a[60:63], v[204:207]
  buffer_load_dwordx4 v234, s[20:23], s67 offen offset:2048  lds
  v_mfma_f32_16x16x32_bf16 v[204:207], a[80:83], a[44:47], v[204:207]
  s_waitcnt lgkmcnt(4)
  v_mfma_f32_16x16x32_bf16 v[220:223], a[88:91], a[44:47], v[220:223]
  ds_read_b64_tr_b16 a[72:73], v224 offset:16384
  v_mfma_f32_16x16x32_bf16 v[220:223], a[92:95], a[60:63], v[220:223]
  ds_read_b64_tr_b16 a[74:75], v224 offset:20480
  v_mfma_f32_16x16x32_bf16 v[216:219], a[92:95], a[56:59], v[216:219]
  buffer_load_dwordx4 v235, s[20:23], s67 offen offset:3072  lds
  v_mfma_f32_16x16x32_bf16 v[216:219], a[88:91], a[40:43], v[216:219]
  s_add_u32 s67, s67, 458752
  s_xor_b32 s68, s68, 0x10000
  v_mfma_f32_16x16x32_bf16 v[212:215], a[88:91], a[36:39], v[212:215]
  ds_read_b64_tr_b16 a[76:77], v224 offset:24576
  v_mfma_f32_16x16x32_bf16 v[212:215], a[92:95], a[52:55], v[212:215]
  s_sub_u32 s56, s56, 1
  ds_read_b64_tr_b16 a[78:79], v224 offset:28672
  v_mfma_f32_16x16x32_bf16 v[208:211], a[92:95], a[48:51], v[208:211]
  s_cmp_lg_u32 s56, 0
  v_mfma_f32_16x16x32_bf16 v[208:211], a[88:91], a[32:35], v[208:211]
  s_cbranch_scc1 Lp3_loop
Lmk_Lp3_loop_tail:
  s_waitcnt vmcnt(8) lgkmcnt(4)
  v_mfma_f32_16x16x32_bf16 v[0:3], a[64:67], a[0:3], v[0:3]
  ds_read_b64_tr_b16 a[80:81], v225 offset:0
  v_add_f32 v242, v242, v246
  v_mfma_f32_16x16x32_bf16 v[0:3], a[68:71], a[16:19], v[0:3]
  ds_read_b64_tr_b16 a[82:83], v225 offset:4096
  v_add_f32 v243, v243, v247
  v_mfma_f32_16x16x32_bf16 v[4:7], a[68:71], a[20:23], v[4:7]
  buffer_load_dwordx4 a[32:35], v231, s[4:7], s72 offen offset:2048 sc1
  v_mfma_f32_16x16x32_bf16 v[4:7], a[64:67], a[4:7], v[4:7]
  v_add_f32 v244, v244, v248
  v_add_f32 v245, v245, v249
  v_mfma_f32_16x16x32_bf16 v[8:11], a[64:67], a[8:11], v[8:11]
  ds_read_b64_tr_b16 a[84:85], v225 offset:8192
  ds_write_b128 v250, v[242:245]
  v_mfma_f32_16x16x32_bf16 v[8:11], a[68:71], a[24:27], v[8:11]
  ds_read_b64_tr_b16 a[86:87], v225 offset:12288
  v_mfma_f32_16x16x32_bf16 v[12:15], a[68:71], a[28:31], v[12:15]
  buffer_load_dwordx4 a[48:51], v231, s[4:7], s72 offen offset:3072 sc1
  v_mfma_f32_16x16x32_bf16 v[12:15], a[64:67], a[12:15], v[12:15]
  s_add_u32 s72, s72, 4096
  s_waitcnt lgkmcnt(5)
  v_mfma_f32_16x16x32_bf16 v[28:31], a[72:75], a[12:15], v[28:31]
  ds_read_b64_tr_b16 a[88:89], v225 offset:16384
  v_mfma_f32_16x16x32_bf16 v[28:31], a[76:79], a[28:31], v[28:31]
  ds_read_b64_tr_b16 a[90:91], v225 offset:20480
  v_mfma_f32_16x16x32_bf16 v[24:27], a[76:79], a[24:27], v[24:27]
  buffer_load_dwordx4 a[36:39], v231, s[4:7], s73 offen offset:2048 sc1
  v_mfma_f32_16x16x32_bf16 v[24:27], a[72:75], a[8:11], v[24:27]
  ds_read_b128 v[246:249], v237 offset:384
  v_mfma_f32_16x16x32_bf16 v[20:23], a[72:75], a[4:7], v[20:23]
  ds_read_b64_tr_b16 a[92:93], v225 offset:24576
  v_mfma_f32_16x16x32_bf16 v[20:23], a[76:79], a[20:23], v[20:23]
  ds_read_b64_tr_b16 a[94:95], v225 offset:28672
  v_mfma_f32_16x16x32_bf16 v[16:19], a[76:79], a[16:19], v[16:19]
  buffer_load_dwordx4 a[52:55], v231, s[4:7], s73 offen offset:3072 sc1
  v_mfma_f32_16x16x32_bf16 v[16:19], a[72:75], a[0:3], v[16:19]
  s_add_u32 s73, s73, 4096
  s_waitcnt lgkmcnt(5)
  v_mfma_f32_16x16x32_bf16 v[32:35], a[80:83], a[0:3], v[32:35]
  s_waitcnt lgkmcnt(2)
  ds_read_b64_tr_b16 a[64:65], v226 offset:0
  v_fmac_f32 v96, v246, v238
  v_mfma_f32_16x16x32_bf16 v[32:35], a[84:87], a[16:19], v[32:35]
  ds_read_b64_tr_b16 a[66:67], v226 offset:4096
  v_fmac_f32 v97, v247, v238
  v_mfma_f32_16x16x32_bf16 v[36:39], a[84:87], a[20:23], v[36:39]
  v_fmac_f32 v98, v248, v238
  v_fmac_f32 v99, v249, v238
  v_mfma_f32_16x16x32_bf16 v[36:39], a[80:83], a[4:7], v[36:39]
  ds_read_b128 v[242:245], v237 offset:0
  v_fmac_f32 v100, v246, v239
  v_mfma_f32_16x16x32_bf16 v[40:43], a[80:83], a[8:11], v[40:43]
  s_xor_b32 s93, s53, 1
  ds_read_b64_tr_b16 a[68:69], v226 offset:8192
  v_fmac_f32 v101, v247, v239
  v_mfma_f32_16x16x32_bf16 v[40:43], a[84:87], a[24:27], v[40:43]
  s_lshl_b32 s93, s93, 7
  ds_read_b64_tr_b16 a[70:71], v226 offset:12288
  v_fmac_f32 v102, v248, v239
  v_mfma_f32_16x16x32_bf16 v[44:47], a[84:87], a[28:31], v[44:47]
  s_add_u32 s80, s24, s93
  s_addc_u32 s81, s25, 0
  buffer_load_dwordx4 a[40:43], v231, s[4:7], s74 offen offset:2048 sc1
  v_mfma_f32_16x16x32_bf16 v[44:47], a[80:83], a[12:15], v[44:47]
  s_sub_u32 s82, 7340032, s93
  v_fmac_f32 v103, v249, v239
  v_fmac_f32 v104, v246, v240
  s_waitcnt lgkmcnt(5)
  v_mfma_f32_16x16x32_bf16 v[60:63], a[88:91], a[12:15], v[60:63]
  s_mov_b32 s83, 0x20000
  ds_read_b64_tr_b16 a[72:73], v226 offset:16384
  v_fmac_f32 v105, v247, v240
  v_mfma_f32_16x16x32_bf16 v[60:63], a[92:95], a[28:31], v[60:63]
  s_lshl_b32 s93, s53, 7
  ds_read_b64_tr_b16 a[74:75], v226 offset:20480
  v_fmac_f32 v106, v248, v240
  v_mfma_f32_16x16x32_bf16 v[56:59], a[92:95], a[24:27], v[56:59]
  s_add_u32 s84, s24, s93
  s_addc_u32 s85, s25, 0
  buffer_load_dwordx4 a[56:59], v231, s[4:7], s74 offen offset:3072 sc1
  v_mfma_f32_16x16x32_bf16 v[56:59], a[88:91], a[8:11], v[56:59]
  s_add_u32 s74, s74, 4096
  v_fmac_f32 v107, v249, v240
  v_fmac_f32 v108, v246, v241
  v_mfma_f32_16x16x32_bf16 v[52:55], a[88:91], a[4:7], v[52:55]
  s_sub_u32 s84, s84, 1024
  s_subb_u32 s85, s85, 0
  ds_read_b64_tr_b16 a[76:77], v226 offset:24576
  v_fmac_f32 v109, v247, v241
  v_mfma_f32_16x16x32_bf16 v[52:55], a[92:95], a[20:23], v[52:55]
  s_sub_u32 s86, 7341056, s93
  ds_read_b64_tr_b16 a[78:79], v226 offset:28672
  v_fmac_f32 v110, v248, v241
  v_mfma_f32_16x16x32_bf16 v[48:51], a[92:95], a[16:19], v[48:51]
  s_mov_b32 s87, 0x20000
  buffer_load_dwordx4 a[44:47], v231, s[4:7], s75 offen offset:2048 sc1
  v_mfma_f32_16x16x32_bf16 v[48:51], a[88:91], a[0:3], v[48:51]
  s_and_b32 s93, s53, 1
  v_fmac_f32 v111, v249, v241
  s_waitcnt lgkmcnt(4)
  v_mfma_f32_16x16x32_bf16 v[64:67], a[64:67], a[0:3], v[64:67]
  ds_read_b64_tr_b16 a[80:81], v227 offset:0
  v_fmac_f32 v0, v242, v238
  v_mfma_f32_16x16x32_bf16 v[64:67], a[68:71], a[16:19], v[64:67]
  s_mul_i32 s92, s93, 3670016
  ds_read_b64_tr_b16 a[82:83], v227 offset:4096
  v_fmac_f32 v1, v243, v238
  v_mfma_f32_16x16x32_bf16 v[68:71], a[68:71], a[20:23], v[68:71]
  s_lshl_b32 s93, s40, 14
  buffer_load_dwordx4 a[60:63], v231, s[4:7], s75 offen offset:3072 sc1
  v_mfma_f32_16x16x32_bf16 v[68:71], a[64:67], a[4:7], v[68:71]
  s_add_u32 s75, s75, 4096
  ds_read_b128 v[246:249], v237 offset:64
  v_fmac_f32 v2, v244, v238
  v_mfma_f32_16x16x32_bf16 v[72:75], a[64:67], a[8:11], v[72:75]
  s_add_u32 s92, s92, s93
  ds_read_b64_tr_b16 a[84:85], v227 offset:8192
  v_fmac_f32 v3, v245, v238
  v_mfma_f32_16x16x32_bf16 v[72:75], a[68:71], a[24:27], v[72:75]
  s_lshl_b32 s79, s40, 11
  ds_read_b64_tr_b16 a[86:87], v227 offset:12288
  v_fmac_f32 v4, v242, v239
  v_mfma_f32_16x16x32_bf16 v[76:79], a[68:71], a[28:31], v[76:79]
  s_lshr_b32 s93, s53, 1
  v_fmac_f32 v5, v243, v239
  v_fmac_f32 v6, v244, v239
  v_mfma_f32_16x16x32_bf16 v[76:79], a[64:67], a[12:15], v[76:79]
  s_add_u32 s93, s93, s52
  v_fmac_f32 v7, v245, v239
  v_fmac_f32 v8, v242, v240
  s_waitcnt lgkmcnt(5)
  v_mfma_f32_16x16x32_bf16 v[92:95], a[72:75], a[12:15], v[92:95]
  s_and_b32 s93, s93, 3
  ds_read_b64_tr_b16 a[88:89], v227 offset:16384
  v_fmac_f32 v9, v243, v240
  v_mfma_f32_16x16x32_bf16 v[92:95], a[76:79], a[28:31], v[92:95]
  s_add_u32 m0, s68, 0
  ds_read_b64_tr_b16 a[90:91], v227 offset:20480
  v_fmac_f32 v10, v244, v240
  v_mfma_f32_16x16x32_bf16 v[88:91], a[76:79], a[24:27], v[88:91]
  s_cmp_eq_u32 s93, 0
  s_cselect_b32 s88, 917504, 0
  buffer_load_dwordx4 v232, s[16:19], s67 offen offset:0  lds
  v_mfma_f32_16x16x32_bf16 v[88:91], a[72:75], a[8:11], v[88:91]
  s_cmp_eq_u32 s93, 1
  s_cselect_b32 s89, 917504, 0
  v_fmac_f32 v11, v245, v240
  v_fmac_f32 v12, v242, v241
  v_mfma_f32_16x16x32_bf16 v[84:87], a[72:75], a[4:7], v[84:87]
  s_cmp_eq_u32 s93, 2
  s_cselect_b32 s90, 917504, 0
  ds_read_b64_tr_b16 a[92:93], v227 offset:24576
  v_fmac_f32 v13, v243, v241
  v_mfma_f32_16x16x32_bf16 v[84:87], a[76:79], a[20:23], v[84:87]
  s_cmp_eq_u32 s93, 3
  s_cselect_b32 s91, 917504, 0
  ds_read_b64_tr_b16 a[94:95], v227 offset:28672
  v_fmac_f32 v14, v244, v241
  v_mfma_f32_16x16x32_bf16 v[80:83], a[76:79], a[16:19], v[80:83]
  s_cmp_eq_u32 s40, 1
  s_cselect_b32 s78, 16384, 0
  buffer_load_dwordx4 v233, s[16:19], s67 offen offset:1024  lds
  v_mfma_f32_16x16x32_bf16 v[80:83], a[72:75], a[0:3], v[80:83]
  s_cmp_eq_u32 s40, 2
  s_cselect_b32 s78, -16384, s78
  v_fmac_f32 v15, v245, v241
  s_waitcnt lgkmcnt(4)
  v_mfma_f32_16x16x32_bf16 v[96:99], a[80:83], a[0:3], v[96:99]
  ds_read_b64_tr_b16 a[64:65], v228 offset:0
  v_fmac_f32 v16, v246, v238
  v_mfma_f32_16x16x32_bf16 v[96:99], a[84:87], a[16:19], v[96:99]
  s_mul_i32 s43, s69, 458752
  ds_read_b64_tr_b16 a[66:67], v228 offset:4096
  v_fmac_f32 v17, v247, v238
  v_mfma_f32_16x16x32_bf16 v[100:103], a[84:87], a[20:23], v[100:103]
  s_lshr_b32 s45, s55, 4
  buffer_load_dwordx4 v234, s[16:19], s67 offen offset:2048  lds
  v_mfma_f32_16x16x32_bf16 v[100:103], a[80:83], a[4:7], v[100:103]
  s_mul_i32 s45, s45, 57344
  ds_read_b128 v[242:245], v237 offset:128
  v_fmac_f32 v18, v248, v238
  v_mfma_f32_16x16x32_bf16 v[104:107], a[80:83], a[8:11], v[104:107]
  s_add_u32 s43, s43, s45
  ds_read_b64_tr_b16 a[68:69], v228 offset:8192
  v_fmac_f32 v19, v249, v238
  v_mfma_f32_16x16x32_bf16 v[104:107], a[84:87], a[24:27], v[104:107]
  s_add_u32 s43, s43, s42
  ds_read_b64_tr_b16 a[70:71], v228 offset:12288
  v_fmac_f32 v20, v246, v239
  v_mfma_f32_16x16x32_bf16 v[108:111], a[84:87], a[28:31], v[108:111]
  s_add_u32 s43, s43, 12582912
  buffer_load_dwordx4 v235, s[16:19], s67 offen offset:3072  lds
  v_mfma_f32_16x16x32_bf16 v[108:111], a[80:83], a[12:15], v[108:111]
  s_and_b32 s44, s55, 15
  v_fmac_f32 v21, v247, v239
  v_fmac_f32 v22, v248, v239
  s_waitcnt lgkmcnt(5)
  v_mfma_f32_16x16x32_bf16 v[124:127], a[88:91], a[12:15], v[124:127]
  s_lshl_b32 s45, s44, 10
  ds_read_b64_tr_b16 a[72:73], v228 offset:16384
  v_fmac_f32 v23, v249, v239
  v_mfma_f32_16x16x32_bf16 v[124:127], a[92:95], a[28:31], v[124:127]
  s_add_u32 s57, s43, s45
  ds_read_b64_tr_b16 a[74:75], v228 offset:20480
  v_fmac_f32 v24, v246, v240
  v_mfma_f32_16x16x32_bf16 v[120:123], a[92:95], a[24:27], v[120:123]
  s_lshl_b32 s45, s44, 9
  v_fmac_f32 v25, v247, v240
  v_fmac_f32 v26, v248, v240
  v_mfma_f32_16x16x32_bf16 v[120:123], a[88:91], a[8:11], v[120:123]
  s_add_u32 s61, s43, s45
  v_fmac_f32 v27, v249, v240
  v_fmac_f32 v28, v246, v241
  v_mfma_f32_16x16x32_bf16 v[116:119], a[88:91], a[4:7], v[116:119]
  s_add_u32 s61, s61, 49152
  ds_read_b64_tr_b16 a[76:77], v228 offset:24576
  v_fmac_f32 v29, v247, v241
  v_mfma_f32_16x16x32_bf16 v[116:119], a[92:95], a[20:23], v[116:119]
  s_add_u32 m0, s68, 16384
  ds_read_b64_tr_b16 a[78:79], v228 offset:28672
  v_fmac_f32 v30, v248, v241
  v_mfma_f32_16x16x32_bf16 v[112:115], a[92:95], a[16:19], v[112:115]
  s_add_u32 s62, s61, 229376
  buffer_load_dwordx4 v232, s[20:23], s67 offen offset:0  lds
  v_mfma_f32_16x16x32_bf16 v[112:115], a[88:91], a[0:3], v[112:115]
  s_add_u32 s58, s57, 114688
  v_fmac_f32 v31, v249, v241
  s_waitcnt lgkmcnt(4)
  v_mfma_f32_16x16x32_bf16 v[128:131], a[64:67], a[0:3], v[128:131]
  ds_read_b64_tr_b16 a[80:81], v229 offset:0
  v_fmac_f32 v32, v242, v238
  v_mfma_f32_16x16x32_bf16 v[128:131], a[68:71], a[16:19], v[128:131]
  s_add_u32 s59, s58, 114688
  ds_read_b64_tr_b16 a[82:83], v229 offset:4096
  v_fmac_f32 v33, v243, v238
  v_mfma_f32_16x16x32_bf16 v[132:135], a[68:71], a[20:23], v[132:135]
  s_add_u32 s60, s59, 114688
  buffer_load_dwordx4 v233, s[20:23], s67 offen offset:1024  lds
  v_mfma_f32_16x16x32_bf16 v[132:135], a[64:67], a[4:7], v[132:135]
  s_lshl_b32 s77, s54, 1
  ds_read_b128 v[246:249], v237 offset:192
  v_fmac_f32 v34, v244, v238
  v_mfma_f32_16x16x32_bf16 v[136:139], a[64:67], a[8:11], v[136:139]
  s_lshr_b32 s43, s55, 4
  ds_read_b64_tr_b16 a[84:85], v229 offset:8192
  v_fmac_f32 v35, v245, v238
  v_mfma_f32_16x16x32_bf16 v[136:139], a[68:71], a[24:27], v[136:139]
  s_add_u32 s77, s77, s43
  ds_read_b64_tr_b16 a[86:87], v229 offset:12288
  v_fmac_f32 v36, v242, v239
  v_mfma_f32_16x16x32_bf16 v[140:143], a[68:71], a[28:31], v[140:143]
  s_lshl_b32 s77, s77, 7
  buffer_load_dwordx4 v234, s[20:23], s67 offen offset:2048  lds
  v_mfma_f32_16x16x32_bf16 v[140:143], a[64:67], a[12:15], v[140:143]
  s_add_u32 s77, s77, s42
  v_fmac_f32 v37, v243, v239
  v_fmac_f32 v38, v244, v239
  s_waitcnt lgkmcnt(5)
  v_mfma_f32_16x16x32_bf16 v[156:159], a[72:75], a[12:15], v[156:159]
  s_add_u32 s77, s77, 27795456
  ds_read_b64_tr_b16 a[88:89], v229 offset:16384
  v_fmac_f32 v39, v245, v239
  v_mfma_f32_16x16x32_bf16 v[156:159], a[76:79], a[28:31], v[156:159]
  s_and_b32 s43, s53, 1
  ds_read_b64_tr_b16 a[90:91], v229 offset:20480
  v_fmac_f32 v40, v242, v240
  v_mfma_f32_16x16x32_bf16 v[152:155], a[76:79], a[24:27], v[152:155]
  s_and_b32 s64, s52, 14
  buffer_load_dwordx4 v235, s[20:23], s67 offen offset:3072  lds
  v_mfma_f32_16x16x32_bf16 v[152:155], a[72:75], a[8:11], v[152:155]
  s_add_u32 s67, s67, 458752
  v_fmac_f32 v41, v243, v240
  v_fmac_f32 v42, v244, v240
  v_mfma_f32_16x16x32_bf16 v[148:151], a[72:75], a[4:7], v[148:151]
  s_add_u32 s64, s64, s43
  ds_read_b64_tr_b16 a[92:93], v229 offset:24576
  v_fmac_f32 v43, v245, v240
  v_mfma_f32_16x16x32_bf16 v[148:151], a[76:79], a[20:23], v[148:151]
  s_lshl_b32 s64, s64, 7
  ds_read_b64_tr_b16 a[94:95], v229 offset:28672
  v_fmac_f32 v44, v242, v241
  v_mfma_f32_16x16x32_bf16 v[144:147], a[76:79], a[16:19], v[144:147]
  s_add_u32 s64, s64, s42
  v_fmac_f32 v45, v243, v241
  v_fmac_f32 v46, v244, v241
  v_mfma_f32_16x16x32_bf16 v[144:147], a[72:75], a[0:3], v[144:147]
  s_add_u32 s64, s64, 27795456
  v_fmac_f32 v47, v245, v241
  s_waitcnt lgkmcnt(4)
  v_mfma_f32_16x16x32_bf16 v[160:163], a[80:83], a[0:3], v[160:163]
  ds_read_b64_tr_b16 a[64:65], v230 offset:0
  v_fmac_f32 v48, v246, v238
  v_mfma_f32_16x16x32_bf16 v[160:163], a[84:87], a[16:19], v[160:163]
  s_lshl_b32 s49, s52, 3
  ds_read_b64_tr_b16 a[66:67], v230 offset:4096
  v_fmac_f32 v49, v247, v238
  v_mfma_f32_16x16x32_bf16 v[164:167], a[84:87], a[20:23], v[164:167]
  s_lshl_b32 s43, s40, 1
  buffer_load_dwordx4 a[96:99], v231, s[4:7], s72 offen offset:0 sc1
  v_mfma_f32_16x16x32_bf16 v[164:167], a[80:83], a[4:7], v[164:167]
  s_add_u32 s49, s49, s43
  ds_read_b128 v[242:245], v237 offset:256
  v_fmac_f32 v50, v248, v238
  v_mfma_f32_16x16x32_bf16 v[168:171], a[80:83], a[8:11], v[168:171]
  s_lshl_b32 s76, s49, 15
  ds_read_b64_tr_b16 a[68:69], v230 offset:8192
  v_fmac_f32 v51, v249, v238
  v_mfma_f32_16x16x32_bf16 v[168:171], a[84:87], a[24:27], v[168:171]
  s_lshl_b32 s43, s53, 11
  ds_read_b64_tr_b16 a[70:71], v230 offset:12288
  v_fmac_f32 v52, v246, v239
  v_mfma_f32_16x16x32_bf16 v[172:175], a[84:87], a[28:31], v[172:175]
  s_add_u32 s76, s76, s43
  buffer_load_dwordx4 a[112:115], v231, s[4:7], s72 offen offset:1024 sc1
  v_mfma_f32_16x16x32_bf16 v[172:175], a[80:83], a[12:15], v[172:175]
  s_add_u32 s76, s76, s42
  v_fmac_f32 v53, v247, v239
  v_fmac_f32 v54, v248, v239
  s_waitcnt lgkmcnt(5)
  v_mfma_f32_16x16x32_bf16 v[188:191], a[88:91], a[12:15], v[188:191]
  s_add_u32 s46, s76, 4194304
  ds_read_b64_tr_b16 a[72:73], v230 offset:16384
  v_fmac_f32 v55, v249, v239
  v_mfma_f32_16x16x32_bf16 v[188:191], a[92:95], a[28:31], v[188:191]
  s_add_u32 s47, s46, 32768
  ds_read_b64_tr_b16 a[74:75], v230 offset:20480
  v_fmac_f32 v56, v246, v240
  v_mfma_f32_16x16x32_bf16 v[184:187], a[92:95], a[24:27], v[184:187]
  s_mul_i32 s48, s49, 114688
  buffer_load_dwordx4 a[100:103], v231, s[4:7], s73 offen offset:0 sc1
  v_mfma_f32_16x16x32_bf16 v[184:187], a[88:91], a[8:11], v[184:187]
  s_and_b32 s43, s53, 1
  v_fmac_f32 v57, v247, v240
  v_fmac_f32 v58, v248, v240
  v_mfma_f32_16x16x32_bf16 v[180:183], a[88:91], a[4:7], v[180:183]
  s_mul_i32 s44, s43, 57344
  ds_read_b64_tr_b16 a[76:77], v230 offset:24576
  v_fmac_f32 v59, v249, v240
  v_mfma_f32_16x16x32_bf16 v[180:183], a[92:95], a[20:23], v[180:183]
  s_add_u32 s48, s48, s44
  ds_read_b64_tr_b16 a[78:79], v230 offset:28672
  v_fmac_f32 v60, v246, v241
  v_mfma_f32_16x16x32_bf16 v[176:179], a[92:95], a[16:19], v[176:179]
  s_add_u32 s48, s48, s42
  buffer_load_dwordx4 a[116:119], v231, s[4:7], s73 offen offset:1024 sc1
  v_mfma_f32_16x16x32_bf16 v[176:179], a[88:91], a[0:3], v[176:179]
  s_add_u32 s48, s48, 12582912
  v_fmac_f32 v61, v247, v241
  v_fmac_f32 v62, v248, v241
  v_fmac_f32 v63, v249, v241
  s_waitcnt lgkmcnt(4)
  v_mfma_f32_16x16x32_bf16 v[192:195], a[64:67], a[0:3], v[192:195]
  s_waitcnt vmcnt(20)
  s_barrier
  ds_read_b64_tr_b16 a[80:81], v224 offset:32768
  v_mfma_f32_16x16x32_bf16 v[192:195], a[68:71], a[16:19], v[192:195]
  ds_read_b64_tr_b16 a[82:83], v224 offset:36864
  v_fmac_f32 v64, v242, v238
  v_mfma_f32_16x16x32_bf16 v[196:199], a[68:71], a[20:23], v[196:199]
  v_fmac_f32 v65, v243, v238
  v_fmac_f32 v66, v244, v238
  v_mfma_f32_16x16x32_bf16 v[196:199], a[64:67], a[4:7], v[196:199]
  ds_read_b128 v[246:249], v237 offset:320
  v_fmac_f32 v67, v245, v238
  v_mfma_f32_16x16x32_bf16 v[200:203], a[64:67], a[8:11], v[200:203]
  ds_read_b64_tr_b16 a[84:85], v224 offset:40960
  v_fmac_f32 v68, v242, v239
  v_mfma_f32_16x16x32_bf16 v[200:203], a[68:71], a[24:27], v[200:203]
  ds_read_b64_tr_b16 a[86:87], v224 offset:45056
  v_fmac_f32 v69, v243, v239
  v_mfma_f32_16x16x32_bf16 v[204:207], a[68:71], a[28:31], v[204:207]
  buffer_load_dwordx4 a[104:107], v231, s[4:7], s74 offen offset:0 sc1
  v_mfma_f32_16x16x32_bf16 v[204:207], a[64:67], a[12:15], v[204:207]
  s_waitcnt lgkmcnt(5)
  v_fmac_f32 v70, v244, v239
  v_fmac_f32 v71, v245, v239
  v_mfma_f32_16x16x32_bf16 v[220:223], a[72:75], a[12:15], v[220:223]
  ds_read_b64_tr_b16 a[88:89], v224 offset:49152
  v_fmac_f32 v72, v242, v240
  v_mfma_f32_16x16x32_bf16 v[220:223], a[76:79], a[28:31], v[220:223]
  ds_read_b64_tr_b16 a[90:91], v224 offset:53248
  v_fmac_f32 v73, v243, v240
  v_mfma_f32_16x16x32_bf16 v[216:219], a[76:79], a[24:27], v[216:219]
  buffer_load_dwordx4 a[120:123], v231, s[4:7], s74 offen offset:1024 sc1
  v_mfma_f32_16x16x32_bf16 v[216:219], a[72:75], a[8:11], v[216:219]
  v_fmac_f32 v74, v244, v240
  v_fmac_f32 v75, v245, v240
  v_mfma_f32_16x16x32_bf16 v[212:215], a[72:75], a[4:7], v[212:215]
  ds_read_b64_tr_b16 a[92:93], v224 offset:57344
  v_fmac_f32 v76, v242, v241
  v_mfma_f32_16x16x32_bf16 v[212:215], a[76:79], a[20:23], v[212:215]
  ds_read_b64_tr_b16 a[94:95], v224 offset:61440
  v_xor_b32 v224, 0x10000, v224
  v_fmac_f32 v77, v243, v241
  v_mfma_f32_16x16x32_bf16 v[208:211], a[76:79], a[16:19], v[208:211]
  buffer_load_dwordx4 a[108:111], v231, s[4:7], s75 offen offset:0 sc1
  v_mfma_f32_16x16x32_bf16 v[208:211], a[72:75], a[0:3], v[208:211]
  s_waitcnt vmcnt(21) lgkmcnt(4)
  v_fmac_f32 v78, v244, v241
  v_fmac_f32 v79, v245, v241
  v_mfma_f32_16x16x32_bf16 v[0:3], a[80:83], a[32:35], v[0:3]
  ds_read_b64_tr_b16 a[64:65], v225 offset:32768
  v_fmac_f32 v80, v246, v238
  v_mfma_f32_16x16x32_bf16 v[0:3], a[84:87], a[48:51], v[0:3]
  s_waitcnt vmcnt(19)
  ds_read_b64_tr_b16 a[66:67], v225 offset:36864
  v_fmac_f32 v81, v247, v238
  v_mfma_f32_16x16x32_bf16 v[4:7], a[84:87], a[52:55], v[4:7]
  buffer_load_dwordx4 a[124:127], v231, s[4:7], s75 offen offset:1024 sc1
  v_mfma_f32_16x16x32_bf16 v[4:7], a[80:83], a[36:39], v[4:7]
  s_waitcnt vmcnt(18)
  ds_read_b128 v[242:245], v237 offset:448
  v_fmac_f32 v82, v248, v238
  v_mfma_f32_16x16x32_bf16 v[8:11], a[80:83], a[40:43], v[8:11]
  ds_read_b64_tr_b16 a[68:69], v225 offset:40960
  v_fmac_f32 v83, v249, v238
  v_mfma_f32_16x16x32_bf16 v[8:11], a[84:87], a[56:59], v[8:11]
  s_waitcnt vmcnt(16)
  ds_read_b64_tr_b16 a[70:71], v225 offset:45056
  v_fmac_f32 v84, v246, v239
  v_mfma_f32_16x16x32_bf16 v[12:15], a[84:87], a[60:63], v[12:15]
  v_fmac_f32 v85, v247, v239
  v_fmac_f32 v86, v248, v239
  v_mfma_f32_16x16x32_bf16 v[12:15], a[80:83], a[44:47], v[12:15]
  s_waitcnt lgkmcnt(5)
  v_fmac_f32 v87, v249, v239
  v_fmac_f32 v88, v246, v240
  v_mfma_f32_16x16x32_bf16 v[28:31], a[88:91], a[44:47], v[28:31]
  ds_read_b64_tr_b16 a[72:73], v225 offset:49152
  v_fmac_f32 v89, v247, v240
  v_mfma_f32_16x16x32_bf16 v[28:31], a[92:95], a[60:63], v[28:31]
  s_add_u32 m0, s68, 32768
  ds_read_b64_tr_b16 a[74:75], v225 offset:53248
  v_fmac_f32 v90, v248, v240
  v_mfma_f32_16x16x32_bf16 v[24:27], a[92:95], a[56:59], v[24:27]
  buffer_load_dwordx4 v232, s[16:19], s67 offen offset:0  lds
  v_mfma_f32_16x16x32_bf16 v[24:27], a[88:91], a[40:43], v[24:27]
  v_fmac_f32 v91, v249, v240
  v_fmac_f32 v92, v246, v241
  v_mfma_f32_16x16x32_bf16 v[20:23], a[88:91], a[36:39], v[20:23]
  ds_read_b64_tr_b16 a[76:77], v225 offset:57344
  v_fmac_f32 v93, v247, v241
  v_mfma_f32_16x16x32_bf16 v[20:23], a[92:95], a[52:55], v[20:23]
  ds_read_b64_tr_b16 a[78:79], v225 offset:61440
  v_xor_b32 v225, 0x10000, v225
  v_fmac_f32 v94, v248, v241
  v_mfma_f32_16x16x32_bf16 v[16:19], a[92:95], a[48:51], v[16:19]
  buffer_load_dwordx4 v233, s[16:19], s67 offen offset:1024  lds
  v_mfma_f32_16x16x32_bf16 v[16:19], a[88:91], a[32:35], v[16:19]
  v_fmac_f32 v95, v249, v241
  s_waitcnt lgkmcnt(4)
  v_mfma_f32_16x16x32_bf16 v[32:35], a[64:67], a[32:35], v[32:35]
  ds_read_b64_tr_b16 a[80:81], v226 offset:32768
  v_fmac_f32 v112, v242, v238
  v_mfma_f32_16x16x32_bf16 v[32:35], a[68:71], a[48:51], v[32:35]
  ds_read_b64_tr_b16 a[82:83], v226 offset:36864
  v_fmac_f32 v113, v243, v238
  v_mfma_f32_16x16x32_bf16 v[36:39], a[68:71], a[52:55], v[36:39]
  buffer_load_dwordx4 v234, s[16:19], s67 offen offset:2048  lds
  v_mfma_f32_16x16x32_bf16 v[36:39], a[64:67], a[36:39], v[36:39]
  ds_read_b128 v[246:249], v237 offset:512
  v_fmac_f32 v114, v244, v238
  v_mfma_f32_16x16x32_bf16 v[40:43], a[64:67], a[40:43], v[40:43]
  ds_read_b64_tr_b16 a[84:85], v226 offset:40960
  v_fmac_f32 v115, v245, v238
  v_mfma_f32_16x16x32_bf16 v[40:43], a[68:71], a[56:59], v[40:43]
  ds_read_b64_tr_b16 a[86:87], v226 offset:45056
  v_fmac_f32 v116, v242, v239
  v_mfma_f32_16x16x32_bf16 v[44:47], a[68:71], a[60:63], v[44:47]
  buffer_load_dwordx4 v235, s[16:19], s67 offen offset:3072  lds
  v_mfma_f32_16x16x32_bf16 v[44:47], a[64:67], a[44:47], v[44:47]
  s_waitcnt lgkmcnt(5)
  v_fmac_f32 v117, v243, v239
  v_fmac_f32 v118, v244, v239
  v_mfma_f32_16x16x32_bf16 v[60:63], a[72:75], a[44:47], v[60:63]
  ds_read_b64_tr_b16 a[88:89], v226 offset:49152
  v_fmac_f32 v119, v245, v239
  v_mfma_f32_16x16x32_bf16 v[60:63], a[76:79], a[60:63], v[60:63]
  ds_read_b64_tr_b16 a[90:91], v226 offset:53248
  v_fmac_f32 v120, v242, v240
  v_mfma_f32_16x16x32_bf16 v[56:59], a[76:79], a[56:59], v[56:59]
  v_fmac_f32 v121, v243, v240
  v_fmac_f32 v122, v244, v240
  v_mfma_f32_16x16x32_bf16 v[56:59], a[72:75], a[40:43], v[56:59]
  v_fmac_f32 v123, v245, v240
  v_fmac_f32 v124, v242, v241
  v_mfma_f32_16x16x32_bf16 v[52:55], a[72:75], a[36:39], v[52:55]
  ds_read_b64_tr_b16 a[92:93], v226 offset:57344
  v_fmac_f32 v125, v243, v241
  v_mfma_f32_16x16x32_bf16 v[52:55], a[76:79], a[52:55], v[52:55]
  s_add_u32 m0, s68, 49152
  ds_read_b64_tr_b16 a[94:95], v226 offset:61440
  v_xor_b32 v226, 0x10000, v226
  v_fmac_f32 v126, v244, v241
  v_mfma_f32_16x16x32_bf16 v[48:51], a[76:79], a[48:51], v[48:51]
  buffer_load_dwordx4 v232, s[20:23], s67 offen offset:0  lds
  v_mfma_f32_16x16x32_bf16 v[48:51], a[72:75], a[32:35], v[48:51]
  v_fmac_f32 v127, v245, v241
  s_waitcnt lgkmcnt(4)
  v_mfma_f32_16x16x32_bf16 v[64:67], a[80:83], a[32:35], v[64:67]
  ds_read_b64_tr_b16 a[64:65], v227 offset:32768
  v_fmac_f32 v128, v246, v238
  v_mfma_f32_16x16x32_bf16 v[64:67], a[84:87], a[48:51], v[64:67]
  ds_read_b64_tr_b16 a[66:67], v227 offset:36864
  v_fmac_f32 v129, v247, v238
  v_mfma_f32_16x16x32_bf16 v[68:71], a[84:87], a[52:55], v[68:71]
  buffer_load_dwordx4 v233, s[20:23], s67 offen offset:1024  lds
  v_mfma_f32_16x16x32_bf16 v[68:71], a[80:83], a[36:39], v[68:71]
  ds_read_b128 v[242:245], v237 offset:576
  v_fmac_f32 v130, v248, v238
  v_mfma_f32_16x16x32_bf16 v[72:75], a[80:83], a[40:43], v[72:75]
  ds_read_b64_tr_b16 a[68:69], v227 offset:40960
  v_fmac_f32 v131, v249, v238
  v_mfma_f32_16x16x32_bf16 v[72:75], a[84:87], a[56:59], v[72:75]
  ds_read_b64_tr_b16 a[70:71], v227 offset:45056
  v_fmac_f32 v132, v246, v239
  v_mfma_f32_16x16x32_bf16 v[76:79], a[84:87], a[60:63], v[76:79]
  buffer_load_dwordx4 v234, s[20:23], s67 offen offset:2048  lds
  v_mfma_f32_16x16x32_bf16 v[76:79], a[80:83], a[44:47], v[76:79]
  s_waitcnt lgkmcnt(5)
  v_fmac_f32 v133, v247, v239
  v_fmac_f32 v134, v248, v239
  v_mfma_f32_16x16x32_bf16 v[92:95], a[88:91], a[44:47], v[92:95]
  ds_read_b64_tr_b16 a[72:73], v227 offset:49152
  v_fmac_f32 v135, v249, v239
  v_mfma_f32_16x16x32_bf16 v[92:95], a[92:95], a[60:63], v[92:95]
  ds_read_b64_tr_b16 a[74:75], v227 offset:53248
  v_fmac_f32 v136, v246, v240
  v_mfma_f32_16x16x32_bf16 v[88:91], a[92:95], a[56:59], v[88:91]
  buffer_load_dwordx4 v235, s[20:23], s67 offen offset:3072  lds
  v_mfma_f32_16x16x32_bf16 v[88:91], a[88:91], a[40:43], v[88:91]
  s_add_u32 s67, s67, 458752
  s_xor_b32 s68, s68, 0x10000
  v_fmac_f32 v137, v247, v240
  v_mfma_f32_16x16x32_bf16 v[84:87], a[88:91], a[36:39], v[84:87]
  ds_read_b64_tr_b16 a[76:77], v227 offset:57344
  v_fmac_f32 v138, v248, v240
  v_mfma_f32_16x16x32_bf16 v[84:87], a[92:95], a[52:55], v[84:87]
  ds_read_b64_tr_b16 a[78:79], v227 offset:61440
  v_xor_b32 v227, 0x10000, v227
  v_fmac_f32 v139, v249, v240
  v_mfma_f32_16x16x32_bf16 v[80:83], a[92:95], a[48:51], v[80:83]
  v_fmac_f32 v140, v246, v241
  v_fmac_f32 v141, v247, v241
  v_mfma_f32_16x16x32_bf16 v[80:83], a[88:91], a[32:35], v[80:83]
  s_waitcnt lgkmcnt(4)
  v_fmac_f32 v142, v248, v241
  v_fmac_f32 v143, v249, v241
  v_mfma_f32_16x16x32_bf16 v[96:99], a[64:67], a[32:35], v[96:99]
  s_waitcnt vmcnt(16)
  s_barrier
  ds_read_b64_tr_b16 a[80:81], v224 offset:0
  v_mfma_f32_16x16x32_bf16 v[96:99], a[68:71], a[48:51], v[96:99]
  ds_read_b64_tr_b16 a[82:83], v224 offset:4096
  v_fmac_f32 v144, v242, v238
  v_mfma_f32_16x16x32_bf16 v[100:103], a[68:71], a[52:55], v[100:103]
  buffer_load_dwordx4 a[0:3], v231, s[4:7], s72 offen offset:2048 sc1
  v_mfma_f32_16x16x32_bf16 v[100:103], a[64:67], a[36:39], v[100:103]
  ds_read_b128 v[246:249], v237 offset:640
  v_fmac_f32 v145, v243, v238
  v_mfma_f32_16x16x32_bf16 v[104:107], a[64:67], a[40:43], v[104:107]
  ds_read_b64_tr_b16 a[84:85], v224 offset:8192
  v_fmac_f32 v146, v244, v238
  v_mfma_f32_16x16x32_bf16 v[104:107], a[68:71], a[56:59], v[104:107]
  ds_read_b64_tr_b16 a[86:87], v224 offset:12288
  v_fmac_f32 v147, v245, v238
  v_mfma_f32_16x16x32_bf16 v[108:111], a[68:71], a[60:63], v[108:111]
  buffer_load_dwordx4 a[16:19], v231, s[4:7], s72 offen offset:3072 sc1
  v_mfma_f32_16x16x32_bf16 v[108:111], a[64:67], a[44:47], v[108:111]
  s_add_u32 s72, s72, 4096
  v_fmac_f32 v148, v242, v239
  v_fmac_f32 v149, v243, v239
  s_waitcnt lgkmcnt(5)
  v_mfma_f32_16x16x32_bf16 v[124:127], a[72:75], a[44:47], v[124:127]
  ds_read_b64_tr_b16 a[88:89], v224 offset:16384
  v_fmac_f32 v150, v244, v239
  v_mfma_f32_16x16x32_bf16 v[124:127], a[76:79], a[60:63], v[124:127]
  ds_read_b64_tr_b16 a[90:91], v224 offset:20480
  v_fmac_f32 v151, v245, v239
  v_mfma_f32_16x16x32_bf16 v[120:123], a[76:79], a[56:59], v[120:123]
  buffer_load_dwordx4 a[4:7], v231, s[4:7], s73 offen offset:2048 sc1
  v_mfma_f32_16x16x32_bf16 v[120:123], a[72:75], a[40:43], v[120:123]
  v_fmac_f32 v152, v242, v240
  v_fmac_f32 v153, v243, v240
  v_mfma_f32_16x16x32_bf16 v[116:119], a[72:75], a[36:39], v[116:119]
  ds_read_b64_tr_b16 a[92:93], v224 offset:24576
  v_fmac_f32 v154, v244, v240
  v_mfma_f32_16x16x32_bf16 v[116:119], a[76:79], a[52:55], v[116:119]
  ds_read_b64_tr_b16 a[94:95], v224 offset:28672
  v_fmac_f32 v155, v245, v240
  v_mfma_f32_16x16x32_bf16 v[112:115], a[76:79], a[48:51], v[112:115]
  buffer_load_dwordx4 a[20:23], v231, s[4:7], s73 offen offset:3072 sc1
  v_mfma_f32_16x16x32_bf16 v[112:115], a[72:75], a[32:35], v[112:115]
  s_add_u32 s73, s73, 4096
  v_fmac_f32 v156, v242, v241
  v_fmac_f32 v157, v243, v241
  v_fmac_f32 v158, v244, v241
  v_fmac_f32 v159, v245, v241
  s_waitcnt vmcnt(18) lgkmcnt(4)
  v_mfma_f32_16x16x32_bf16 v[0:3], a[80:83], a[96:99], v[0:3]
  ds_read_b64_tr_b16 a[64:65], v225 offset:0
  v_fmac_f32 v160, v246, v238
  v_mfma_f32_16x16x32_bf16 v[0:3], a[84:87], a[112:115], v[0:3]
  s_waitcnt vmcnt(16)
  ds_read_b64_tr_b16 a[66:67], v225 offset:4096
  v_fmac_f32 v161, v247, v238
  v_mfma_f32_16x16x32_bf16 v[4:7], a[84:87], a[116:119], v[4:7]
  v_fmac_f32 v162, v248, v238
  v_fmac_f32 v163, v249, v238
  v_mfma_f32_16x16x32_bf16 v[4:7], a[80:83], a[100:103], v[4:7]
  s_waitcnt vmcnt(14)
  ds_read_b128 v[242:245], v237 offset:704
  v_fmac_f32 v164, v246, v239
  v_mfma_f32_16x16x32_bf16 v[8:11], a[80:83], a[104:107], v[8:11]
  ds_read_b64_tr_b16 a[68:69], v225 offset:8192
  v_fmac_f32 v165, v247, v239
  v_mfma_f32_16x16x32_bf16 v[8:11], a[84:87], a[120:123], v[8:11]
  s_waitcnt vmcnt(12)
  ds_read_b64_tr_b16 a[70:71], v225 offset:12288
  v_fmac_f32 v166, v248, v239
  v_mfma_f32_16x16x32_bf16 v[12:15], a[84:87], a[124:127], v[12:15]
  buffer_load_dwordx4 a[8:11], v231, s[4:7], s74 offen offset:2048 sc1
  v_mfma_f32_16x16x32_bf16 v[12:15], a[80:83], a[108:111], v[12:15]
  s_waitcnt lgkmcnt(5)
  v_fmac_f32 v167, v249, v239
  v_fmac_f32 v168, v246, v240
  v_mfma_f32_16x16x32_bf16 v[28:31], a[88:91], a[108:111], v[28:31]
  ds_read_b64_tr_b16 a[72:73], v225 offset:16384
  v_fmac_f32 v169, v247, v240
  v_mfma_f32_16x16x32_bf16 v[28:31], a[92:95], a[124:127], v[28:31]
  ds_read_b64_tr_b16 a[74:75], v225 offset:20480
  v_fmac_f32 v170, v248, v240
  v_mfma_f32_16x16x32_bf16 v[24:27], a[92:95], a[120:123], v[24:27]
  buffer_load_dwordx4 a[24:27], v231, s[4:7], s74 offen offset:3072 sc1
  v_mfma_f32_16x16x32_bf16 v[24:27], a[88:91], a[104:107], v[24:27]
  s_add_u32 s74, s74, 4096
  v_fmac_f32 v171, v249, v240
  v_fmac_f32 v172, v246, v241
  v_mfma_f32_16x16x32_bf16 v[20:23], a[88:91], a[100:103], v[20:23]
  ds_read_b64_tr_b16 a[76:77], v225 offset:24576
  v_fmac_f32 v173, v247, v241
  v_mfma_f32_16x16x32_bf16 v[20:23], a[92:95], a[116:119], v[20:23]
  ds_read_b64_tr_b16 a[78:79], v225 offset:28672
  v_fmac_f32 v174, v248, v241
  v_mfma_f32_16x16x32_bf16 v[16:19], a[92:95], a[112:115], v[16:19]
  buffer_load_dwordx4 a[12:15], v231, s[4:7], s75 offen offset:2048 sc1
  v_mfma_f32_16x16x32_bf16 v[16:19], a[88:91], a[96:99], v[16:19]
  v_fmac_f32 v175, v249, v241
  s_waitcnt lgkmcnt(4)
  v_mfma_f32_16x16x32_bf16 v[32:35], a[64:67], a[96:99], v[32:35]
  ds_read_b64_tr_b16 a[80:81], v226 offset:0
  v_fmac_f32 v176, v242, v238
  v_mfma_f32_16x16x32_bf16 v[32:35], a[68:71], a[112:115], v[32:35]
  ds_read_b64_tr_b16 a[82:83], v226 offset:4096
  v_fmac_f32 v177, v243, v238
  v_mfma_f32_16x16x32_bf16 v[36:39], a[68:71], a[116:119], v[36:39]
  buffer_load_dwordx4 a[28:31], v231, s[4:7], s75 offen offset:3072 sc1
  v_mfma_f32_16x16x32_bf16 v[36:39], a[64:67], a[100:103], v[36:39]
  s_add_u32 s75, s75, 4096
  ds_read_b128 v[246:249], v237 offset:768
  v_fmac_f32 v178, v244, v238
  v_mfma_f32_16x16x32_bf16 v[40:43], a[64:67], a[104:107], v[40:43]
  ds_read_b64_tr_b16 a[84:85], v226 offset:8192
  v_fmac_f32 v179, v245, v238
  v_mfma_f32_16x16x32_bf16 v[40:43], a[68:71], a[120:123], v[40:43]
  ds_read_b64_tr_b16 a[86:87], v226 offset:12288
  v_fmac_f32 v180, v242, v239
  v_mfma_f32_16x16x32_bf16 v[44:47], a[68:71], a[124:127], v[44:47]
  v_fmac_f32 v181, v243, v239
  v_fmac_f32 v182, v244, v239
  v_mfma_f32_16x16x32_bf16 v[44:47], a[64:67], a[108:111], v[44:47]
  s_waitcnt lgkmcnt(5)
  v_fmac_f32 v183, v245, v239
  v_fmac_f32 v184, v242, v240
  v_mfma_f32_16x16x32_bf16 v[60:63], a[72:75], a[108:111], v[60:63]
  ds_read_b64_tr_b16 a[88:89], v226 offset:16384
  v_fmac_f32 v185, v243, v240
  v_mfma_f32_16x16x32_bf16 v[60:63], a[76:79], a[124:127], v[60:63]
  ds_read_b64_tr_b16 a[90:91], v226 offset:20480
  v_fmac_f32 v186, v244, v240
  v_mfma_f32_16x16x32_bf16 v[56:59], a[76:79], a[120:123], v[56:59]
  v_fmac_f32 v187, v245, v240
  v_fmac_f32 v188, v242, v241
  v_mfma_f32_16x16x32_bf16 v[56:59], a[72:75], a[104:107], v[56:59]
  v_fmac_f32 v189, v243, v241
  v_fmac_f32 v190, v244, v241
  v_mfma_f32_16x16x32_bf16 v[52:55], a[72:75], a[100:103], v[52:55]
  s_add_u32 m0, s79, 0
  ds_read_b64_tr_b16 a[92:93], v226 offset:24576
  v_fmac_f32 v191, v245, v241
  v_mfma_f32_16x16x32_bf16 v[52:55], a[76:79], a[116:119], v[52:55]
  s_add_u32 s92, s92, 0
  s_add_u32 s93, s92, s88
  ds_read_b64_tr_b16 a[94:95], v226 offset:28672
  v_mfma_f32_16x16x32_bf16 v[48:51], a[76:79], a[112:115], v[48:51]
  buffer_load_dwordx4 v252, s[80:83], s93 offen lds
  v_mfma_f32_16x16x32_bf16 v[48:51], a[72:75], a[96:99], v[48:51]
  s_waitcnt lgkmcnt(4)
  v_mfma_f32_16x16x32_bf16 v[64:67], a[80:83], a[96:99], v[64:67]
  ds_read_b64_tr_b16 a[64:65], v228 offset:32768
  v_fmac_f32 v192, v246, v238
  v_mfma_f32_16x16x32_bf16 v[64:67], a[84:87], a[112:115], v[64:67]
  ds_read_b64_tr_b16 a[66:67], v228 offset:36864
  v_fmac_f32 v193, v247, v238
  v_mfma_f32_16x16x32_bf16 v[68:71], a[84:87], a[116:119], v[68:71]
  buffer_load_dwordx4 v252, s[84:87], s93 offen offset:1024 lds
  v_mfma_f32_16x16x32_bf16 v[68:71], a[80:83], a[100:103], v[68:71]
  ds_read_b128 v[242:245], v237 offset:832
  v_fmac_f32 v194, v248, v238
  v_mfma_f32_16x16x32_bf16 v[72:75], a[80:83], a[104:107], v[72:75]
  ds_read_b64_tr_b16 a[68:69], v228 offset:40960
  v_fmac_f32 v195, v249, v238
  v_mfma_f32_16x16x32_bf16 v[72:75], a[84:87], a[120:123], v[72:75]
  ds_read_b64_tr_b16 a[70:71], v228 offset:45056
  v_fmac_f32 v196, v246, v239
  v_mfma_f32_16x16x32_bf16 v[76:79], a[84:87], a[124:127], v[76:79]
  v_fmac_f32 v197, v247, v239
  v_fmac_f32 v198, v248, v239
  v_mfma_f32_16x16x32_bf16 v[76:79], a[80:83], a[108:111], v[76:79]
  s_waitcnt lgkmcnt(5)
  v_fmac_f32 v199, v249, v239
  v_fmac_f32 v200, v246, v240
  v_mfma_f32_16x16x32_bf16 v[92:95], a[88:91], a[108:111], v[92:95]
  s_add_u32 m0, s79, 8192
  ds_read_b64_tr_b16 a[72:73], v228 offset:49152
  v_fmac_f32 v201, v247, v240
  v_mfma_f32_16x16x32_bf16 v[92:95], a[92:95], a[124:127], v[92:95]
  s_add_u32 s92, s92, 262144
  s_add_u32 s93, s92, s89
  ds_read_b64_tr_b16 a[74:75], v228 offset:53248
  v_fmac_f32 v202, v248, v240
  v_mfma_f32_16x16x32_bf16 v[88:91], a[92:95], a[120:123], v[88:91]
  buffer_load_dwordx4 v252, s[80:83], s93 offen lds
  v_mfma_f32_16x16x32_bf16 v[88:91], a[88:91], a[104:107], v[88:91]
  v_fmac_f32 v203, v249, v240
  v_fmac_f32 v204, v246, v241
  v_mfma_f32_16x16x32_bf16 v[84:87], a[88:91], a[100:103], v[84:87]
  ds_read_b64_tr_b16 a[76:77], v228 offset:57344
  v_fmac_f32 v205, v247, v241
  v_mfma_f32_16x16x32_bf16 v[84:87], a[92:95], a[116:119], v[84:87]
  ds_read_b64_tr_b16 a[78:79], v228 offset:61440
  v_xor_b32 v228, 0x10000, v228
  v_fmac_f32 v206, v248, v241
  v_mfma_f32_16x16x32_bf16 v[80:83], a[92:95], a[112:115], v[80:83]
  buffer_load_dwordx4 v252, s[84:87], s93 offen offset:1024 lds
  v_mfma_f32_16x16x32_bf16 v[80:83], a[88:91], a[96:99], v[80:83]
  v_fmac_f32 v207, v249, v241
  s_waitcnt lgkmcnt(4)
  v_mfma_f32_16x16x32_bf16 v[128:131], a[64:67], a[32:35], v[128:131]
  s_waitcnt vmcnt(12)
  s_barrier
  ds_read_b64_tr_b16 a[80:81], v224 offset:32768
  v_mfma_f32_16x16x32_bf16 v[128:131], a[68:71], a[48:51], v[128:131]
  ds_read_b64_tr_b16 a[82:83], v224 offset:36864
  v_fmac_f32 v208, v242, v238
  v_mfma_f32_16x16x32_bf16 v[132:135], a[68:71], a[52:55], v[132:135]
  v_fmac_f32 v209, v243, v238
  v_fmac_f32 v210, v244, v238
  v_mfma_f32_16x16x32_bf16 v[132:135], a[64:67], a[36:39], v[132:135]
  v_fmac_f32 v211, v245, v238
  v_fmac_f32 v212, v242, v239
  v_mfma_f32_16x16x32_bf16 v[136:139], a[64:67], a[40:43], v[136:139]
  s_add_u32 m0, s79, 16384
  ds_read_b64_tr_b16 a[84:85], v224 offset:40960
  v_fmac_f32 v213, v243, v239
  v_mfma_f32_16x16x32_bf16 v[136:139], a[68:71], a[56:59], v[136:139]
  s_add_u32 s92, s92, 196608
  s_add_u32 s93, s92, s90
  ds_read_b64_tr_b16 a[86:87], v224 offset:45056
  v_fmac_f32 v214, v244, v239
  v_mfma_f32_16x16x32_bf16 v[140:143], a[68:71], a[60:63], v[140:143]
  buffer_load_dwordx4 v252, s[80:83], s93 offen lds
  v_mfma_f32_16x16x32_bf16 v[140:143], a[64:67], a[44:47], v[140:143]
  s_waitcnt lgkmcnt(4)
  v_fmac_f32 v215, v245, v239
  v_fmac_f32 v216, v242, v240
  v_mfma_f32_16x16x32_bf16 v[156:159], a[72:75], a[44:47], v[156:159]
  ds_read_b64_tr_b16 a[88:89], v224 offset:49152
  v_fmac_f32 v217, v243, v240
  v_mfma_f32_16x16x32_bf16 v[156:159], a[76:79], a[60:63], v[156:159]
  ds_read_b64_tr_b16 a[90:91], v224 offset:53248
  v_fmac_f32 v218, v244, v240
  v_mfma_f32_16x16x32_bf16 v[152:155], a[76:79], a[56:59], v[152:155]
  buffer_load_dwordx4 v252, s[84:87], s93 offen offset:1024 lds
  v_mfma_f32_16x16x32_bf16 v[152:155], a[72:75], a[40:43], v[152:155]
  v_fmac_f32 v219, v245, v240
  v_fmac_f32 v220, v242, v241
  v_mfma_f32_16x16x32_bf16 v[148:151], a[72:75], a[36:39], v[148:151]
  ds_read_b64_tr_b16 a[92:93], v224 offset:57344
  v_fmac_f32 v221, v243, v241
  v_mfma_f32_16x16x32_bf16 v[148:151], a[76:79], a[52:55], v[148:151]
  ds_read_b64_tr_b16 a[94:95], v224 offset:61440
  v_fmac_f32 v222, v244, v241
  v_mfma_f32_16x16x32_bf16 v[144:147], a[76:79], a[48:51], v[144:147]
  v_fmac_f32 v223, v245, v241
  v_mfma_f32_16x16x32_bf16 v[144:147], a[72:75], a[32:35], v[144:147]
  s_waitcnt vmcnt(12) lgkmcnt(4)
  v_mfma_f32_16x16x32_bf16 v[0:3], a[80:83], a[0:3], v[0:3]
  s_add_u32 m0, s79, 24576
  ds_read_b64_tr_b16 a[64:65], v229 offset:32768
  v_and_b32 v236, 31, v253
  v_mfma_f32_16x16x32_bf16 v[0:3], a[84:87], a[16:19], v[0:3]
  s_add_u32 s92, s92, 262144
  s_add_u32 s93, s92, s91
  ds_read_b64_tr_b16 a[66:67], v229 offset:36864
  v_lshlrev_b32 v236, 4, v236
  s_waitcnt vmcnt(10)
  v_mfma_f32_16x16x32_bf16 v[4:7], a[84:87], a[20:23], v[4:7]
  buffer_load_dwordx4 v252, s[80:83], s93 offen lds
  v_mfma_f32_16x16x32_bf16 v[4:7], a[80:83], a[4:7], v[4:7]
  v_lshrrev_b32 v250, 5, v253
  s_waitcnt vmcnt(9)
  v_mfma_f32_16x16x32_bf16 v[8:11], a[80:83], a[8:11], v[8:11]
  s_mov_b32 s43, 114688
  ds_read_b64_tr_b16 a[68:69], v229 offset:40960
  v_mad_u32_u24 v236, v250, s43, v236
  v_mfma_f32_16x16x32_bf16 v[8:11], a[84:87], a[24:27], v[8:11]
  s_waitcnt vmcnt(7)
  ds_read_b64_tr_b16 a[70:71], v229 offset:45056
  v_and_b32 v250, 15, v253
  v_mfma_f32_16x16x32_bf16 v[12:15], a[84:87], a[28:31], v[12:15]
  s_add_u32 s43, s71, 1024
  buffer_load_dwordx4 v252, s[84:87], s93 offen offset:1024 lds
  v_mfma_f32_16x16x32_bf16 v[12:15], a[80:83], a[12:15], v[12:15]
  s_waitcnt lgkmcnt(4)
  v_lshl_add_u32 v250, v250, 2, s43
  v_mfma_f32_16x16x32_bf16 v[28:31], a[88:91], a[12:15], v[28:31]
  ds_read2_b32 v[238:239], v250 offset0:64 offset1:80
  ds_read_b64_tr_b16 a[72:73], v229 offset:49152
  v_mfma_f32_16x16x32_bf16 v[28:31], a[92:95], a[28:31], v[28:31]
  ds_read2_b32 v[240:241], v250 offset0:96 offset1:112
  ds_read_b64_tr_b16 a[74:75], v229 offset:53248
  v_mfma_f32_16x16x32_bf16 v[24:27], a[92:95], a[24:27], v[24:27]
  ds_read2_b32 v[232:233], v250 offset0:128 offset1:144
  v_mfma_f32_16x16x32_bf16 v[24:27], a[88:91], a[8:11], v[24:27]
  ds_read2_b32 v[234:235], v250 offset0:160 offset1:176
  v_mfma_f32_16x16x32_bf16 v[20:23], a[88:91], a[4:7], v[20:23]
  ds_read_b64_tr_b16 a[76:77], v229 offset:57344
  v_mfma_f32_16x16x32_bf16 v[20:23], a[92:95], a[20:23], v[20:23]
  ds_read_b64_tr_b16 a[78:79], v229 offset:61440
  v_xor_b32 v229, 0x10000, v229
  v_mfma_f32_16x16x32_bf16 v[16:19], a[92:95], a[16:19], v[16:19]
  v_mfma_f32_16x16x32_bf16 v[16:19], a[88:91], a[0:3], v[16:19]
  s_waitcnt lgkmcnt(8)
  v_mfma_f32_16x16x32_bf16 v[160:163], a[64:67], a[32:35], v[160:163]
  ds_read_b64_tr_b16 a[80:81], v225 offset:32768
  v_mfma_f32_16x16x32_bf16 v[160:163], a[68:71], a[48:51], v[160:163]
  ds_read_b64_tr_b16 a[82:83], v225 offset:36864
  v_mfma_f32_16x16x32_bf16 v[164:167], a[68:71], a[52:55], v[164:167]
  s_waitcnt lgkmcnt(4)
  v_mfma_f32_16x16x32_bf16 v[164:167], a[64:67], a[36:39], v[164:167]
  v_pk_mul_f32 v[242:243], v[0:1], v[238:239] op_sel:[0,0] op_sel_hi:[1,0]
  v_pk_mul_f32 v[244:245], v[2:3], v[238:239] op_sel:[0,0] op_sel_hi:[1,0]
  v_pk_mul_f32 v[0:1], v[0:1], v[16:17]
  v_pk_mul_f32 v[2:3], v[2:3], v[18:19]
  v_mfma_f32_16x16x32_bf16 v[168:171], a[64:67], a[40:43], v[168:171]
  ds_read_b64_tr_b16 a[84:85], v225 offset:40960
  v_mfma_f32_16x16x32_bf16 v[168:171], a[68:71], a[56:59], v[168:171]
  ds_read_b64_tr_b16 a[86:87], v225 offset:45056
  v_mfma_f32_16x16x32_bf16 v[172:175], a[68:71], a[60:63], v[172:175]
  v_mfma_f32_16x16x32_bf16 v[172:175], a[64:67], a[44:47], v[172:175]
  s_waitcnt lgkmcnt(4)
  v_mfma_f32_16x16x32_bf16 v[188:191], a[72:75], a[44:47], v[188:191]
  v_exp_f32 v242, v242
  v_mfma_f32_16x16x32_bf16 v[188:191], a[76:79], a[60:63], v[188:191]
  v_exp_f32 v243, v243
  v_mfma_f32_16x16x32_bf16 v[184:187], a[76:79], a[56:59], v[184:187]
  ds_read_b64_tr_b16 a[88:89], v225 offset:49152
  ds_read_b64_tr_b16 a[90:91], v225 offset:53248
  v_mfma_f32_16x16x32_bf16 v[184:187], a[72:75], a[40:43], v[184:187]
  v_exp_f32 v244, v244
  v_exp_f32 v245, v245
  s_nop 0
  v_pk_fma_f32 v[242:243], v[242:243], v[232:233], v[232:233] op_sel:[0,0,0] op_sel_hi:[1,0,0]
  v_pk_fma_f32 v[244:245], v[244:245], v[232:233], v[232:233] op_sel:[0,0,0] op_sel_hi:[1,0,0]
  v_pk_mul_f32 v[246:247], v[4:5], v[238:239] op_sel:[0,1] op_sel_hi:[1,1]
  v_pk_mul_f32 v[248:249], v[6:7], v[238:239] op_sel:[0,1] op_sel_hi:[1,1]
  v_pk_mul_f32 v[4:5], v[4:5], v[20:21]
  v_pk_mul_f32 v[6:7], v[6:7], v[22:23]
  v_rcp_f32 v242, v242
  v_mfma_f32_16x16x32_bf16 v[180:183], a[72:75], a[36:39], v[180:183]
  v_rcp_f32 v243, v243
  v_mfma_f32_16x16x32_bf16 v[180:183], a[76:79], a[52:55], v[180:183]
  v_rcp_f32 v244, v244
  v_mfma_f32_16x16x32_bf16 v[176:179], a[76:79], a[48:51], v[176:179]
  ds_read_b64_tr_b16 a[92:93], v225 offset:57344
  v_mfma_f32_16x16x32_bf16 v[176:179], a[72:75], a[32:35], v[176:179]
  ds_read_b64_tr_b16 a[94:95], v225 offset:61440
  s_waitcnt lgkmcnt(4)
  v_mfma_f32_16x16x32_bf16 v[32:35], a[80:83], a[0:3], v[32:35]
  v_exp_f32 v246, v246
  v_mfma_f32_16x16x32_bf16 v[32:35], a[84:87], a[16:19], v[32:35]
  v_exp_f32 v247, v247
  v_mfma_f32_16x16x32_bf16 v[36:39], a[84:87], a[20:23], v[36:39]
  ds_read_b64_tr_b16 a[64:65], v230 offset:32768
  ds_read_b64_tr_b16 a[66:67], v230 offset:36864
  v_mfma_f32_16x16x32_bf16 v[36:39], a[80:83], a[4:7], v[36:39]
  v_exp_f32 v248, v248
  v_exp_f32 v249, v249
  v_rcp_f32 v245, v245
  v_pk_fma_f32 v[246:247], v[246:247], v[232:233], v[232:233] op_sel:[0,1,1] op_sel_hi:[1,1,1]
  v_pk_fma_f32 v[248:249], v[248:249], v[232:233], v[232:233] op_sel:[0,1,1] op_sel_hi:[1,1,1]
  v_pk_mul_f32 v[0:1], v[0:1], v[242:243]
  v_pk_mul_f32 v[2:3], v[2:3], v[244:245]
  v_pk_mul_f32 v[242:243], v[8:9], v[240:241] op_sel:[0,0] op_sel_hi:[1,0]
  v_pk_mul_f32 v[244:245], v[10:11], v[240:241] op_sel:[0,0] op_sel_hi:[1,0]
  v_pk_mul_f32 v[8:9], v[8:9], v[24:25]
  v_pk_mul_f32 v[10:11], v[10:11], v[26:27]
  v_rcp_f32 v246, v246
  v_mfma_f32_16x16x32_bf16 v[40:43], a[80:83], a[8:11], v[40:43]
  v_rcp_f32 v247, v247
  v_mfma_f32_16x16x32_bf16 v[40:43], a[84:87], a[24:27], v[40:43]
  v_rcp_f32 v248, v248
  v_mfma_f32_16x16x32_bf16 v[44:47], a[84:87], a[28:31], v[44:47]
  ds_read_b64_tr_b16 a[68:69], v230 offset:40960
  v_cvt_pk_bf16_f32 v16, v0, v1
  v_mfma_f32_16x16x32_bf16 v[44:47], a[80:83], a[12:15], v[44:47]
  s_waitcnt lgkmcnt(3)
  ds_read_b64_tr_b16 a[70:71], v230 offset:45056
  v_cvt_pk_bf16_f32 v17, v2, v3
  v_mfma_f32_16x16x32_bf16 v[60:63], a[88:91], a[12:15], v[60:63]
  v_exp_f32 v242, v242
  v_mfma_f32_16x16x32_bf16 v[60:63], a[92:95], a[28:31], v[60:63]
  v_exp_f32 v243, v243
  v_mfma_f32_16x16x32_bf16 v[56:59], a[92:95], a[24:27], v[56:59]
  ds_read_b64_tr_b16 a[72:73], v230 offset:49152
  ds_read_b64_tr_b16 a[74:75], v230 offset:53248
  v_mfma_f32_16x16x32_bf16 v[56:59], a[88:91], a[8:11], v[56:59]
  v_exp_f32 v244, v244
  v_exp_f32 v245, v245
  v_rcp_f32 v249, v249
  v_pk_fma_f32 v[242:243], v[242:243], v[234:235], v[234:235] op_sel:[0,0,0] op_sel_hi:[1,0,0]
  v_pk_fma_f32 v[244:245], v[244:245], v[234:235], v[234:235] op_sel:[0,0,0] op_sel_hi:[1,0,0]
  v_pk_mul_f32 v[4:5], v[4:5], v[246:247]
  v_pk_mul_f32 v[6:7], v[6:7], v[248:249]
  v_pk_mul_f32 v[246:247], v[12:13], v[240:241] op_sel:[0,1] op_sel_hi:[1,1]
  v_pk_mul_f32 v[248:249], v[14:15], v[240:241] op_sel:[0,1] op_sel_hi:[1,1]
  v_pk_mul_f32 v[12:13], v[12:13], v[28:29]
  v_pk_mul_f32 v[14:15], v[14:15], v[30:31]
  v_rcp_f32 v242, v242
  v_mfma_f32_16x16x32_bf16 v[52:55], a[88:91], a[4:7], v[52:55]
  v_rcp_f32 v243, v243
  v_mfma_f32_16x16x32_bf16 v[52:55], a[92:95], a[20:23], v[52:55]
  v_rcp_f32 v244, v244
  v_mfma_f32_16x16x32_bf16 v[48:51], a[92:95], a[16:19], v[48:51]
  ds_read_b64_tr_b16 a[76:77], v230 offset:57344
  v_cvt_pk_bf16_f32 v20, v4, v5
  v_mfma_f32_16x16x32_bf16 v[48:51], a[88:91], a[0:3], v[48:51]
  s_waitcnt lgkmcnt(3)
  ds_read_b64_tr_b16 a[78:79], v230 offset:61440
  v_xor_b32 v230, 0x10000, v230
  v_cvt_pk_bf16_f32 v21, v6, v7
  v_mfma_f32_16x16x32_bf16 v[192:195], a[64:67], a[32:35], v[192:195]
  v_exp_f32 v246, v246
  v_mfma_f32_16x16x32_bf16 v[192:195], a[68:71], a[48:51], v[192:195]
  v_exp_f32 v247, v247
  v_mfma_f32_16x16x32_bf16 v[196:199], a[68:71], a[52:55], v[196:199]
  ds_read_b64_tr_b16 a[80:81], v226 offset:32768
  ds_read_b64_tr_b16 a[82:83], v226 offset:36864
  v_mfma_f32_16x16x32_bf16 v[196:199], a[64:67], a[36:39], v[196:199]
  v_exp_f32 v248, v248
  v_exp_f32 v249, v249
  v_rcp_f32 v245, v245
  v_pk_fma_f32 v[246:247], v[246:247], v[234:235], v[234:235] op_sel:[0,1,1] op_sel_hi:[1,1,1]
  v_pk_fma_f32 v[248:249], v[248:249], v[234:235], v[234:235] op_sel:[0,1,1] op_sel_hi:[1,1,1]
  v_pk_mul_f32 v[8:9], v[8:9], v[242:243]
  v_pk_mul_f32 v[10:11], v[10:11], v[244:245]
  v_pk_mul_f32 v[242:243], v[32:33], v[238:239] op_sel:[0,0] op_sel_hi:[1,0]
  v_pk_mul_f32 v[244:245], v[34:35], v[238:239] op_sel:[0,0] op_sel_hi:[1,0]
  v_pk_mul_f32 v[32:33], v[32:33], v[48:49]
  v_pk_mul_f32 v[34:35], v[34:35], v[50:51]
  v_rcp_f32 v246, v246
  v_mfma_f32_16x16x32_bf16 v[200:203], a[64:67], a[40:43], v[200:203]
  v_rcp_f32 v247, v247
  v_mfma_f32_16x16x32_bf16 v[200:203], a[68:71], a[56:59], v[200:203]
  v_rcp_f32 v248, v248
  v_mfma_f32_16x16x32_bf16 v[204:207], a[68:71], a[60:63], v[204:207]
  ds_read_b64_tr_b16 a[84:85], v226 offset:40960
  v_cvt_pk_bf16_f32 v24, v8, v9
  v_mfma_f32_16x16x32_bf16 v[204:207], a[64:67], a[44:47], v[204:207]
  s_waitcnt lgkmcnt(3)
  ds_read_b64_tr_b16 a[86:87], v226 offset:45056
  v_cvt_pk_bf16_f32 v25, v10, v11
  v_mfma_f32_16x16x32_bf16 v[220:223], a[72:75], a[44:47], v[220:223]
  v_exp_f32 v242, v242
  v_mfma_f32_16x16x32_bf16 v[220:223], a[76:79], a[60:63], v[220:223]
  v_exp_f32 v243, v243
  v_mfma_f32_16x16x32_bf16 v[216:219], a[76:79], a[56:59], v[216:219]
  ds_read_b64_tr_b16 a[88:89], v226 offset:49152
  ds_read_b64_tr_b16 a[90:91], v226 offset:53248
  v_mfma_f32_16x16x32_bf16 v[216:219], a[72:75], a[40:43], v[216:219]
  v_exp_f32 v244, v244
  v_exp_f32 v245, v245
  v_rcp_f32 v249, v249
  v_pk_fma_f32 v[242:243], v[242:243], v[232:233], v[232:233] op_sel:[0,0,0] op_sel_hi:[1,0,0]
  v_pk_fma_f32 v[244:245], v[244:245], v[232:233], v[232:233] op_sel:[0,0,0] op_sel_hi:[1,0,0]
  v_pk_mul_f32 v[12:13], v[12:13], v[246:247]
  v_pk_mul_f32 v[14:15], v[14:15], v[248:249]
  v_pk_mul_f32 v[246:247], v[36:37], v[238:239] op_sel:[0,1] op_sel_hi:[1,1]
  v_pk_mul_f32 v[248:249], v[38:39], v[238:239] op_sel:[0,1] op_sel_hi:[1,1]
  v_pk_mul_f32 v[36:37], v[36:37], v[52:53]
  v_pk_mul_f32 v[38:39], v[38:39], v[54:55]
  v_rcp_f32 v242, v242
  v_mfma_f32_16x16x32_bf16 v[212:215], a[72:75], a[36:39], v[212:215]
  v_rcp_f32 v243, v243
  v_mfma_f32_16x16x32_bf16 v[212:215], a[76:79], a[52:55], v[212:215]
  v_rcp_f32 v244, v244
  v_mfma_f32_16x16x32_bf16 v[208:211], a[76:79], a[48:51], v[208:211]
  ds_read_b64_tr_b16 a[92:93], v226 offset:57344
  v_cvt_pk_bf16_f32 v28, v12, v13
  v_mfma_f32_16x16x32_bf16 v[208:211], a[72:75], a[32:35], v[208:211]
  s_waitcnt lgkmcnt(3)
  ds_read_b64_tr_b16 a[94:95], v226 offset:61440
  v_cvt_pk_bf16_f32 v29, v14, v15
  v_mfma_f32_16x16x32_bf16 v[64:67], a[80:83], a[0:3], v[64:67]
  v_exp_f32 v246, v246
  v_mfma_f32_16x16x32_bf16 v[64:67], a[84:87], a[16:19], v[64:67]
  v_exp_f32 v247, v247
  v_mfma_f32_16x16x32_bf16 v[68:71], a[84:87], a[20:23], v[68:71]
  ds_read_b64_tr_b16 a[64:65], v227 offset:0
  ds_read_b64_tr_b16 a[66:67], v227 offset:4096
  v_mfma_f32_16x16x32_bf16 v[68:71], a[80:83], a[4:7], v[68:71]
  v_exp_f32 v248, v248
  v_exp_f32 v249, v249
  v_rcp_f32 v245, v245
  v_pk_fma_f32 v[246:247], v[246:247], v[232:233], v[232:233] op_sel:[0,1,1] op_sel_hi:[1,1,1]
  v_pk_fma_f32 v[248:249], v[248:249], v[232:233], v[232:233] op_sel:[0,1,1] op_sel_hi:[1,1,1]
  v_pk_mul_f32 v[32:33], v[32:33], v[242:243]
  v_pk_mul_f32 v[34:35], v[34:35], v[244:245]
  v_pk_mul_f32 v[242:243], v[40:41], v[240:241] op_sel:[0,0] op_sel_hi:[1,0]
  v_pk_mul_f32 v[244:245], v[42:43], v[240:241] op_sel:[0,0] op_sel_hi:[1,0]
  v_pk_mul_f32 v[40:41], v[40:41], v[56:57]
  v_pk_mul_f32 v[42:43], v[42:43], v[58:59]
  v_rcp_f32 v246, v246
  v_mfma_f32_16x16x32_bf16 v[72:75], a[80:83], a[8:11], v[72:75]
  v_rcp_f32 v247, v247
  v_mfma_f32_16x16x32_bf16 v[72:75], a[84:87], a[24:27], v[72:75]
  v_rcp_f32 v248, v248
  v_mfma_f32_16x16x32_bf16 v[76:79], a[84:87], a[28:31], v[76:79]
  ds_read_b64_tr_b16 a[68:69], v227 offset:8192
  v_cvt_pk_bf16_f32 v18, v32, v33
  v_mfma_f32_16x16x32_bf16 v[76:79], a[80:83], a[12:15], v[76:79]
  s_waitcnt lgkmcnt(3)
  ds_read_b64_tr_b16 a[70:71], v227 offset:12288
  v_cvt_pk_bf16_f32 v19, v34, v35
  v_mfma_f32_16x16x32_bf16 v[92:95], a[88:91], a[12:15], v[92:95]
  buffer_store_dwordx4 v[16:19], v231, s[4:7], s57 offen sc1
  s_add_u32 s57, s57, 16384
  v_exp_f32 v242, v242
  v_mfma_f32_16x16x32_bf16 v[92:95], a[92:95], a[28:31], v[92:95]
  v_exp_f32 v243, v243
  v_mfma_f32_16x16x32_bf16 v[88:91], a[92:95], a[24:27], v[88:91]
  ds_read_b64_tr_b16 a[72:73], v227 offset:16384
  ds_read_b64_tr_b16 a[74:75], v227 offset:20480
  v_mfma_f32_16x16x32_bf16 v[88:91], a[88:91], a[8:11], v[88:91]
  v_exp_f32 v244, v244
  v_exp_f32 v245, v245
  v_rcp_f32 v249, v249
  v_pk_fma_f32 v[242:243], v[242:243], v[234:235], v[234:235] op_sel:[0,0,0] op_sel_hi:[1,0,0]
  v_pk_fma_f32 v[244:245], v[244:245], v[234:235], v[234:235] op_sel:[0,0,0] op_sel_hi:[1,0,0]
  v_pk_mul_f32 v[36:37], v[36:37], v[246:247]
  v_pk_mul_f32 v[38:39], v[38:39], v[248:249]
  v_pk_mul_f32 v[246:247], v[44:45], v[240:241] op_sel:[0,1] op_sel_hi:[1,1]
  v_pk_mul_f32 v[248:249], v[46:47], v[240:241] op_sel:[0,1] op_sel_hi:[1,1]
  v_pk_mul_f32 v[44:45], v[44:45], v[60:61]
  v_pk_mul_f32 v[46:47], v[46:47], v[62:63]
  v_rcp_f32 v242, v242
  v_mfma_f32_16x16x32_bf16 v[84:87], a[88:91], a[4:7], v[84:87]
  v_rcp_f32 v243, v243
  v_mfma_f32_16x16x32_bf16 v[84:87], a[92:95], a[20:23], v[84:87]
  v_rcp_f32 v244, v244
  v_mfma_f32_16x16x32_bf16 v[80:83], a[92:95], a[16:19], v[80:83]
  ds_read_b64_tr_b16 a[76:77], v227 offset:24576
  v_cvt_pk_bf16_f32 v22, v36, v37
  v_mfma_f32_16x16x32_bf16 v[80:83], a[88:91], a[0:3], v[80:83]
  s_waitcnt lgkmcnt(3)
  ds_read_b64_tr_b16 a[78:79], v227 offset:28672
  v_cvt_pk_bf16_f32 v23, v38, v39
  v_mfma_f32_16x16x32_bf16 v[96:99], a[64:67], a[96:99], v[96:99]
  buffer_store_dwordx4 v[20:23], v231, s[4:7], s58 offen sc1
  s_add_u32 s58, s58, 16384
  v_exp_f32 v246, v246
  v_mfma_f32_16x16x32_bf16 v[96:99], a[68:71], a[112:115], v[96:99]
  v_exp_f32 v247, v247
  v_mfma_f32_16x16x32_bf16 v[100:103], a[68:71], a[116:119], v[100:103]
  ds_read_b64_tr_b16 a[80:81], v227 offset:32768
  ds_read_b64_tr_b16 a[82:83], v227 offset:36864
  v_mfma_f32_16x16x32_bf16 v[100:103], a[64:67], a[100:103], v[100:103]
  v_exp_f32 v248, v248
  v_exp_f32 v249, v249
  v_rcp_f32 v245, v245
  v_pk_fma_f32 v[246:247], v[246:247], v[234:235], v[234:235] op_sel:[0,1,1] op_sel_hi:[1,1,1]
  v_pk_fma_f32 v[248:249], v[248:249], v[234:235], v[234:235] op_sel:[0,1,1] op_sel_hi:[1,1,1]
  v_pk_mul_f32 v[40:41], v[40:41], v[242:243]
  v_pk_mul_f32 v[42:43], v[42:43], v[244:245]
  v_pk_mul_f32 v[242:243], v[64:65], v[238:239] op_sel:[0,0] op_sel_hi:[1,0]
  v_pk_mul_f32 v[244:245], v[66:67], v[238:239] op_sel:[0,0] op_sel_hi:[1,0]
  v_pk_mul_f32 v[64:65], v[64:65], v[80:81]
  v_pk_mul_f32 v[66:67], v[66:67], v[82:83]
  v_rcp_f32 v246, v246
  v_mfma_f32_16x16x32_bf16 v[104:107], a[64:67], a[104:107], v[104:107]
  v_rcp_f32 v247, v247
  v_mfma_f32_16x16x32_bf16 v[104:107], a[68:71], a[120:123], v[104:107]
  v_rcp_f32 v248, v248
  v_mfma_f32_16x16x32_bf16 v[108:111], a[68:71], a[124:127], v[108:111]
  ds_read_b64_tr_b16 a[84:85], v227 offset:40960
  v_cvt_pk_bf16_f32 v26, v40, v41
  v_mfma_f32_16x16x32_bf16 v[108:111], a[64:67], a[108:111], v[108:111]
  s_waitcnt lgkmcnt(3)
  ds_read_b64_tr_b16 a[86:87], v227 offset:45056
  v_cvt_pk_bf16_f32 v27, v42, v43
  v_mfma_f32_16x16x32_bf16 v[124:127], a[72:75], a[108:111], v[124:127]
  buffer_store_dwordx4 v[24:27], v231, s[4:7], s59 offen sc1
  s_add_u32 s59, s59, 16384
  v_exp_f32 v242, v242
  v_mfma_f32_16x16x32_bf16 v[124:127], a[76:79], a[124:127], v[124:127]
  v_exp_f32 v243, v243
  v_mfma_f32_16x16x32_bf16 v[120:123], a[76:79], a[120:123], v[120:123]
  ds_read_b64_tr_b16 a[88:89], v227 offset:49152
  ds_read_b64_tr_b16 a[90:91], v227 offset:53248
  v_mfma_f32_16x16x32_bf16 v[120:123], a[72:75], a[104:107], v[120:123]
  v_exp_f32 v244, v244
  v_exp_f32 v245, v245
  v_rcp_f32 v249, v249
  v_pk_fma_f32 v[242:243], v[242:243], v[232:233], v[232:233] op_sel:[0,0,0] op_sel_hi:[1,0,0]
  v_pk_fma_f32 v[244:245], v[244:245], v[232:233], v[232:233] op_sel:[0,0,0] op_sel_hi:[1,0,0]
  v_pk_mul_f32 v[44:45], v[44:45], v[246:247]
  v_pk_mul_f32 v[46:47], v[46:47], v[248:249]
  v_pk_mul_f32 v[246:247], v[68:69], v[238:239] op_sel:[0,1] op_sel_hi:[1,1]
  v_pk_mul_f32 v[248:249], v[70:71], v[238:239] op_sel:[0,1] op_sel_hi:[1,1]
  v_pk_mul_f32 v[68:69], v[68:69], v[84:85]
  v_pk_mul_f32 v[70:71], v[70:71], v[86:87]
  v_rcp_f32 v242, v242
  v_mfma_f32_16x16x32_bf16 v[116:119], a[72:75], a[100:103], v[116:119]
  v_rcp_f32 v243, v243
  v_mfma_f32_16x16x32_bf16 v[116:119], a[76:79], a[116:119], v[116:119]
  v_rcp_f32 v244, v244
  v_mfma_f32_16x16x32_bf16 v[112:115], a[76:79], a[112:115], v[112:115]
  ds_read_b64_tr_b16 a[92:93], v227 offset:57344
  v_cvt_pk_bf16_f32 v30, v44, v45
  v_mfma_f32_16x16x32_bf16 v[112:115], a[72:75], a[96:99], v[112:115]
  s_waitcnt lgkmcnt(3)
  ds_read_b64_tr_b16 a[94:95], v227 offset:61440
  v_cvt_pk_bf16_f32 v31, v46, v47
  v_mfma_f32_16x16x32_bf16 v[96:99], a[80:83], a[0:3], v[96:99]
  buffer_store_dwordx4 v[28:31], v231, s[4:7], s60 offen sc1
  s_add_u32 s60, s60, 16384
  v_exp_f32 v246, v246
  v_mfma_f32_16x16x32_bf16 v[96:99], a[84:87], a[16:19], v[96:99]
  v_exp_f32 v247, v247
  v_mfma_f32_16x16x32_bf16 v[100:103], a[84:87], a[20:23], v[100:103]
  ds_read_b64_tr_b16 a[64:65], v228 offset:0
  ds_read_b64_tr_b16 a[66:67], v228 offset:4096
  v_mfma_f32_16x16x32_bf16 v[100:103], a[80:83], a[4:7], v[100:103]
  v_exp_f32 v248, v248
  v_exp_f32 v249, v249
  v_rcp_f32 v245, v245
  v_pk_fma_f32 v[246:247], v[246:247], v[232:233], v[232:233] op_sel:[0,1,1] op_sel_hi:[1,1,1]
  v_pk_fma_f32 v[248:249], v[248:249], v[232:233], v[232:233] op_sel:[0,1,1] op_sel_hi:[1,1,1]
  v_pk_mul_f32 v[64:65], v[64:65], v[242:243]
  v_pk_mul_f32 v[66:67], v[66:67], v[244:245]
  v_pk_mul_f32 v[242:243], v[72:73], v[240:241] op_sel:[0,0] op_sel_hi:[1,0]
  v_pk_mul_f32 v[244:245], v[74:75], v[240:241] op_sel:[0,0] op_sel_hi:[1,0]
  v_pk_mul_f32 v[72:73], v[72:73], v[88:89]
  v_pk_mul_f32 v[74:75], v[74:75], v[90:91]
  v_rcp_f32 v246, v246
  v_mfma_f32_16x16x32_bf16 v[104:107], a[80:83], a[8:11], v[104:107]
  v_rcp_f32 v247, v247
  v_lshlrev_b32 v8, 4, v253
  v_mfma_f32_16x16x32_bf16 v[104:107], a[84:87], a[24:27], v[104:107]
  v_rcp_f32 v248, v248
  v_add_u32 v9, 114688, v8
  v_mfma_f32_16x16x32_bf16 v[108:111], a[84:87], a[28:31], v[108:111]
  ds_read_b64_tr_b16 a[68:69], v228 offset:8192
  v_cvt_pk_bf16_f32 v80, v64, v65
  v_mfma_f32_16x16x32_bf16 v[108:111], a[80:83], a[12:15], v[108:111]
  s_waitcnt lgkmcnt(3)
  ds_read_b64_tr_b16 a[70:71], v228 offset:12288
  v_cvt_pk_bf16_f32 v81, v66, v67
  v_mfma_f32_16x16x32_bf16 v[124:127], a[88:91], a[12:15], v[124:127]
  buffer_load_dwordx4 v[16:19], v8, s[4:7], s46 offen offset:0 sc1
  v_exp_f32 v242, v242
  v_mfma_f32_16x16x32_bf16 v[124:127], a[92:95], a[28:31], v[124:127]
  buffer_load_dwordx4 v[20:23], v8, s[4:7], s46 offen offset:1024 sc1
  v_exp_f32 v243, v243
  v_mfma_f32_16x16x32_bf16 v[120:123], a[92:95], a[24:27], v[120:123]
  ds_read_b64_tr_b16 a[72:73], v228 offset:16384
  ds_read_b64_tr_b16 a[74:75], v228 offset:20480
  v_mfma_f32_16x16x32_bf16 v[120:123], a[88:91], a[8:11], v[120:123]
  v_exp_f32 v244, v244
  v_exp_f32 v245, v245
  v_rcp_f32 v249, v249
  v_pk_fma_f32 v[242:243], v[242:243], v[234:235], v[234:235] op_sel:[0,0,0] op_sel_hi:[1,0,0]
  v_pk_fma_f32 v[244:245], v[244:245], v[234:235], v[234:235] op_sel:[0,0,0] op_sel_hi:[1,0,0]
  v_pk_mul_f32 v[68:69], v[68:69], v[246:247]
  v_pk_mul_f32 v[70:71], v[70:71], v[248:249]
  v_pk_mul_f32 v[246:247], v[76:77], v[240:241] op_sel:[0,1] op_sel_hi:[1,1]
  v_pk_mul_f32 v[248:249], v[78:79], v[240:241] op_sel:[0,1] op_sel_hi:[1,1]
  v_pk_mul_f32 v[76:77], v[76:77], v[92:93]
  v_pk_mul_f32 v[78:79], v[78:79], v[94:95]
  v_rcp_f32 v242, v242
  v_mfma_f32_16x16x32_bf16 v[116:119], a[88:91], a[4:7], v[116:119]
  buffer_load_dwordx4 v[24:27], v8, s[4:7], s47 offen offset:0 sc1
  v_rcp_f32 v243, v243
  v_mfma_f32_16x16x32_bf16 v[116:119], a[92:95], a[20:23], v[116:119]
  buffer_load_dwordx4 v[28:31], v8, s[4:7], s47 offen offset:1024 sc1
  v_rcp_f32 v244, v244
  v_mfma_f32_16x16x32_bf16 v[112:115], a[92:95], a[16:19], v[112:115]
  ds_read_b64_tr_b16 a[76:77], v228 offset:24576
  v_cvt_pk_bf16_f32 v84, v68, v69
  v_mfma_f32_16x16x32_bf16 v[112:115], a[88:91], a[0:3], v[112:115]
  s_waitcnt lgkmcnt(3)
  ds_read_b64_tr_b16 a[78:79], v228 offset:28672
  v_cvt_pk_bf16_f32 v85, v70, v71
  v_mfma_f32_16x16x32_bf16 v[128:131], a[64:67], a[96:99], v[128:131]
  v_exp_f32 v246, v246
  v_bfe_u32 v11, v253, 2, 3
  v_mfma_f32_16x16x32_bf16 v[128:131], a[68:71], a[112:115], v[128:131]
  v_exp_f32 v247, v247
  v_bfe_u32 v12, v253, 3, 2
  v_mfma_f32_16x16x32_bf16 v[132:135], a[68:71], a[116:119], v[132:135]
  ds_read_b64_tr_b16 a[80:81], v228 offset:32768
  ds_read_b64_tr_b16 a[82:83], v228 offset:36864
  v_mfma_f32_16x16x32_bf16 v[132:135], a[64:67], a[100:103], v[132:135]
  v_exp_f32 v248, v248
  v_exp_f32 v249, v249
  v_rcp_f32 v245, v245
  v_pk_fma_f32 v[246:247], v[246:247], v[234:235], v[234:235] op_sel:[0,1,1] op_sel_hi:[1,1,1]
  v_pk_fma_f32 v[248:249], v[248:249], v[234:235], v[234:235] op_sel:[0,1,1] op_sel_hi:[1,1,1]
  v_pk_mul_f32 v[72:73], v[72:73], v[242:243]
  v_pk_mul_f32 v[74:75], v[74:75], v[244:245]
  v_pk_mul_f32 v[242:243], v[96:97], v[238:239] op_sel:[0,0] op_sel_hi:[1,0]
  v_pk_mul_f32 v[244:245], v[98:99], v[238:239] op_sel:[0,0] op_sel_hi:[1,0]
  v_pk_mul_f32 v[96:97], v[96:97], v[112:113]
  v_pk_mul_f32 v[98:99], v[98:99], v[114:115]
  v_rcp_f32 v246, v246
  v_mfma_f32_16x16x32_bf16 v[136:139], a[64:67], a[104:107], v[136:139]
  v_rcp_f32 v247, v247
  v_and_b32 v13, 3, v253
  v_mfma_f32_16x16x32_bf16 v[136:139], a[68:71], a[120:123], v[136:139]
  v_rcp_f32 v248, v248
  v_lshlrev_b32 v13, 3, v13
  v_mfma_f32_16x16x32_bf16 v[140:143], a[68:71], a[124:127], v[140:143]
  ds_read_b64_tr_b16 a[84:85], v228 offset:40960
  v_cvt_pk_bf16_f32 v88, v72, v73
  v_mfma_f32_16x16x32_bf16 v[140:143], a[64:67], a[108:111], v[140:143]
  s_waitcnt lgkmcnt(3)
  ds_read_b64_tr_b16 a[86:87], v228 offset:45056
  v_cvt_pk_bf16_f32 v89, v74, v75
  v_mfma_f32_16x16x32_bf16 v[156:159], a[72:75], a[108:111], v[156:159]
  v_exp_f32 v242, v242
  v_lshl_add_u32 v13, v11, 7, v13
  v_mfma_f32_16x16x32_bf16 v[156:159], a[76:79], a[124:127], v[156:159]
  v_exp_f32 v243, v243
  v_lshrrev_b32 v11, 5, v253
  v_mfma_f32_16x16x32_bf16 v[152:155], a[76:79], a[120:123], v[152:155]
  ds_read_b64_tr_b16 a[88:89], v228 offset:49152
  ds_read_b64_tr_b16 a[90:91], v228 offset:53248
  v_mfma_f32_16x16x32_bf16 v[152:155], a[72:75], a[104:107], v[152:155]
  v_exp_f32 v244, v244
  v_exp_f32 v245, v245
  v_rcp_f32 v249, v249
  v_pk_fma_f32 v[242:243], v[242:243], v[232:233], v[232:233] op_sel:[0,0,0] op_sel_hi:[1,0,0]
  v_pk_fma_f32 v[244:245], v[244:245], v[232:233], v[232:233] op_sel:[0,0,0] op_sel_hi:[1,0,0]
  v_pk_mul_f32 v[76:77], v[76:77], v[246:247]
  v_pk_mul_f32 v[78:79], v[78:79], v[248:249]
  v_pk_mul_f32 v[246:247], v[100:101], v[238:239] op_sel:[0,1] op_sel_hi:[1,1]
  v_pk_mul_f32 v[248:249], v[102:103], v[238:239] op_sel:[0,1] op_sel_hi:[1,1]
  v_pk_mul_f32 v[100:101], v[100:101], v[116:117]
  v_pk_mul_f32 v[102:103], v[102:103], v[118:119]
  v_rcp_f32 v242, v242
  v_mfma_f32_16x16x32_bf16 v[148:151], a[72:75], a[100:103], v[148:151]
  s_waitcnt vmcnt(4)
  s_barrier
  s_cmp_lg_u32 s40, 0
  s_cbranch_scc1 Lsgf20
  v_mov_b32 v250, 1
  s_mov_b64 exec, 1
  buffer_atomic_add v250, v251, s[4:7], s77 offen sc1
  s_mov_b64 exec, -1
Lsgf20:
  s_add_u32 s77, s77, 4096
  v_rcp_f32 v243, v243
  v_lshl_add_u32 v13, v11, 11, v13
  v_mfma_f32_16x16x32_bf16 v[148:151], a[76:79], a[116:119], v[148:151]
  s_add_u32 m0, s79, 32768
  v_rcp_f32 v244, v244
  v_xor_b32 v11, 0, v12
  v_mfma_f32_16x16x32_bf16 v[144:147], a[76:79], a[112:115], v[144:147]
  s_add_u32 s92, s92, 196608
  s_add_u32 s93, s92, s88
  ds_read_b64_tr_b16 a[92:93], v228 offset:57344
  v_cvt_pk_bf16_f32 v92, v76, v77
  v_mfma_f32_16x16x32_bf16 v[144:147], a[72:75], a[96:99], v[144:147]
  s_waitcnt lgkmcnt(3)
  ds_read_b64_tr_b16 a[94:95], v228 offset:61440
  v_cvt_pk_bf16_f32 v93, v78, v79
  v_mfma_f32_16x16x32_bf16 v[128:131], a[80:83], a[0:3], v[128:131]
  buffer_load_dwordx4 v252, s[80:83], s93 offen lds
  v_exp_f32 v246, v246
  v_mfma_f32_16x16x32_bf16 v[128:131], a[84:87], a[16:19], v[128:131]
  buffer_load_dwordx4 v252, s[84:87], s93 offen offset:1024 lds
  v_exp_f32 v247, v247
  v_mfma_f32_16x16x32_bf16 v[132:135], a[84:87], a[20:23], v[132:135]
  ds_read_b64_tr_b16 a[64:65], v229 offset:0
  ds_read_b64_tr_b16 a[66:67], v229 offset:4096
  v_mfma_f32_16x16x32_bf16 v[132:135], a[80:83], a[4:7], v[132:135]
  v_exp_f32 v248, v248
  v_exp_f32 v249, v249
  v_rcp_f32 v245, v245
  v_pk_fma_f32 v[246:247], v[246:247], v[232:233], v[232:233] op_sel:[0,1,1] op_sel_hi:[1,1,1]
  v_pk_fma_f32 v[248:249], v[248:249], v[232:233], v[232:233] op_sel:[0,1,1] op_sel_hi:[1,1,1]
  v_pk_mul_f32 v[96:97], v[96:97], v[242:243]
  v_pk_mul_f32 v[98:99], v[98:99], v[244:245]
  v_pk_mul_f32 v[242:243], v[104:105], v[240:241] op_sel:[0,0] op_sel_hi:[1,0]
  v_pk_mul_f32 v[244:245], v[106:107], v[240:241] op_sel:[0,0] op_sel_hi:[1,0]
  v_pk_mul_f32 v[104:105], v[104:105], v[120:121]
  v_pk_mul_f32 v[106:107], v[106:107], v[122:123]
  v_rcp_f32 v246, v246
  v_mfma_f32_16x16x32_bf16 v[136:139], a[80:83], a[8:11], v[136:139]
  s_add_u32 m0, s79, 40960
  v_rcp_f32 v247, v247
  v_lshl_add_u32 v0, v11, 5, v13
  v_mfma_f32_16x16x32_bf16 v[136:139], a[84:87], a[24:27], v[136:139]
  s_add_u32 s92, s92, 262144
  s_add_u32 s93, s92, s89
  buffer_load_dwordx4 v252, s[80:83], s93 offen lds
  v_rcp_f32 v248, v248
  v_mfma_f32_16x16x32_bf16 v[140:143], a[84:87], a[28:31], v[140:143]
  ds_read_b64_tr_b16 a[68:69], v229 offset:8192
  v_cvt_pk_bf16_f32 v82, v96, v97
  v_mfma_f32_16x16x32_bf16 v[140:143], a[80:83], a[12:15], v[140:143]
  s_waitcnt lgkmcnt(3)
  ds_read_b64_tr_b16 a[70:71], v229 offset:12288
  v_cvt_pk_bf16_f32 v83, v98, v99
  v_mfma_f32_16x16x32_bf16 v[156:159], a[88:91], a[12:15], v[156:159]
  buffer_load_dwordx4 v252, s[84:87], s93 offen offset:1024 lds
  buffer_store_dwordx4 v[80:83], v231, s[4:7], s57 offen sc1
  s_add_u32 s57, s57, 16384
  v_exp_f32 v242, v242
  v_mfma_f32_16x16x32_bf16 v[156:159], a[92:95], a[28:31], v[156:159]
  v_exp_f32 v243, v243
  v_add_u32 v4, 0x10000, v0
  v_mfma_f32_16x16x32_bf16 v[152:155], a[92:95], a[24:27], v[152:155]
  ds_read_b64_tr_b16 a[72:73], v229 offset:16384
  ds_read_b64_tr_b16 a[74:75], v229 offset:20480
  v_mfma_f32_16x16x32_bf16 v[152:155], a[88:91], a[8:11], v[152:155]
  v_exp_f32 v244, v244
  v_exp_f32 v245, v245
  v_rcp_f32 v249, v249
  v_pk_fma_f32 v[242:243], v[242:243], v[234:235], v[234:235] op_sel:[0,0,0] op_sel_hi:[1,0,0]
  v_pk_fma_f32 v[244:245], v[244:245], v[234:235], v[234:235] op_sel:[0,0,0] op_sel_hi:[1,0,0]
  v_pk_mul_f32 v[100:101], v[100:101], v[246:247]
  v_pk_mul_f32 v[102:103], v[102:103], v[248:249]
  v_pk_mul_f32 v[246:247], v[108:109], v[240:241] op_sel:[0,1] op_sel_hi:[1,1]
  v_pk_mul_f32 v[248:249], v[110:111], v[240:241] op_sel:[0,1] op_sel_hi:[1,1]
  v_pk_mul_f32 v[108:109], v[108:109], v[124:125]
  v_pk_mul_f32 v[110:111], v[110:111], v[126:127]
  v_rcp_f32 v242, v242
  v_mfma_f32_16x16x32_bf16 v[148:151], a[88:91], a[4:7], v[148:151]
  s_add_u32 m0, s79, 49152
  v_rcp_f32 v243, v243
  v_xor_b32 v11, 1, v12
  v_mfma_f32_16x16x32_bf16 v[148:151], a[92:95], a[20:23], v[148:151]
  s_add_u32 s92, s92, 196608
  s_add_u32 s93, s92, s90
  buffer_load_dwordx4 v252, s[80:83], s93 offen lds
  v_rcp_f32 v244, v244
  v_mfma_f32_16x16x32_bf16 v[144:147], a[92:95], a[16:19], v[144:147]
  ds_read_b64_tr_b16 a[76:77], v229 offset:24576
  v_cvt_pk_bf16_f32 v86, v100, v101
  v_mfma_f32_16x16x32_bf16 v[144:147], a[88:91], a[0:3], v[144:147]
  s_waitcnt lgkmcnt(3)
  ds_read_b64_tr_b16 a[78:79], v229 offset:28672
  v_cvt_pk_bf16_f32 v87, v102, v103
  v_mfma_f32_16x16x32_bf16 v[160:163], a[64:67], a[96:99], v[160:163]
  buffer_load_dwordx4 v252, s[84:87], s93 offen offset:1024 lds
  buffer_store_dwordx4 v[84:87], v231, s[4:7], s58 offen sc1
  s_add_u32 s58, s58, 16384
  v_exp_f32 v246, v246
  v_mfma_f32_16x16x32_bf16 v[160:163], a[68:71], a[112:115], v[160:163]
  v_exp_f32 v247, v247
  v_lshl_add_u32 v1, v11, 5, v13
  v_mfma_f32_16x16x32_bf16 v[164:167], a[68:71], a[116:119], v[164:167]
  ds_read_b64_tr_b16 a[80:81], v229 offset:32768
  ds_read_b64_tr_b16 a[82:83], v229 offset:36864
  v_mfma_f32_16x16x32_bf16 v[164:167], a[64:67], a[100:103], v[164:167]
  v_exp_f32 v248, v248
  v_exp_f32 v249, v249
  v_rcp_f32 v245, v245
  v_pk_fma_f32 v[246:247], v[246:247], v[234:235], v[234:235] op_sel:[0,1,1] op_sel_hi:[1,1,1]
  v_pk_fma_f32 v[248:249], v[248:249], v[234:235], v[234:235] op_sel:[0,1,1] op_sel_hi:[1,1,1]
  v_pk_mul_f32 v[104:105], v[104:105], v[242:243]
  v_pk_mul_f32 v[106:107], v[106:107], v[244:245]
  v_pk_mul_f32 v[242:243], v[128:129], v[238:239] op_sel:[0,0] op_sel_hi:[1,0]
  v_pk_mul_f32 v[244:245], v[130:131], v[238:239] op_sel:[0,0] op_sel_hi:[1,0]
  v_pk_mul_f32 v[128:129], v[128:129], v[144:145]
  v_pk_mul_f32 v[130:131], v[130:131], v[146:147]
  v_rcp_f32 v246, v246
  v_mfma_f32_16x16x32_bf16 v[168:171], a[64:67], a[104:107], v[168:171]
  s_add_u32 m0, s79, 57344
  v_rcp_f32 v247, v247
  v_add_u32 v5, 0x10000, v1
  v_mfma_f32_16x16x32_bf16 v[168:171], a[68:71], a[120:123], v[168:171]
  s_add_u32 s92, s92, 262144
  s_add_u32 s93, s92, s91
  buffer_load_dwordx4 v252, s[80:83], s93 offen lds
  v_rcp_f32 v248, v248
  v_mfma_f32_16x16x32_bf16 v[172:175], a[68:71], a[124:127], v[172:175]
  ds_read_b64_tr_b16 a[84:85], v229 offset:40960
  v_cvt_pk_bf16_f32 v90, v104, v105
  v_mfma_f32_16x16x32_bf16 v[172:175], a[64:67], a[108:111], v[172:175]
  s_waitcnt lgkmcnt(3)
  ds_read_b64_tr_b16 a[86:87], v229 offset:45056
  v_cvt_pk_bf16_f32 v91, v106, v107
  v_mfma_f32_16x16x32_bf16 v[188:191], a[72:75], a[108:111], v[188:191]
  buffer_load_dwordx4 v252, s[84:87], s93 offen offset:1024 lds
  buffer_store_dwordx4 v[88:91], v231, s[4:7], s59 offen sc1
  s_add_u32 s59, s59, 16384
  v_exp_f32 v242, v242
  v_mfma_f32_16x16x32_bf16 v[188:191], a[76:79], a[124:127], v[188:191]
  v_exp_f32 v243, v243
  v_xor_b32 v11, 2, v12
  v_mfma_f32_16x16x32_bf16 v[184:187], a[76:79], a[120:123], v[184:187]
  ds_read_b64_tr_b16 a[88:89], v229 offset:49152
  ds_read_b64_tr_b16 a[90:91], v229 offset:53248
  v_mfma_f32_16x16x32_bf16 v[184:187], a[72:75], a[104:107], v[184:187]
  v_exp_f32 v244, v244
  v_exp_f32 v245, v245
  v_rcp_f32 v249, v249
  v_pk_fma_f32 v[242:243], v[242:243], v[232:233], v[232:233] op_sel:[0,0,0] op_sel_hi:[1,0,0]
  v_pk_fma_f32 v[244:245], v[244:245], v[232:233], v[232:233] op_sel:[0,0,0] op_sel_hi:[1,0,0]
  v_pk_mul_f32 v[108:109], v[108:109], v[246:247]
  v_pk_mul_f32 v[110:111], v[110:111], v[248:249]
  v_pk_mul_f32 v[246:247], v[132:133], v[238:239] op_sel:[0,1] op_sel_hi:[1,1]
  v_pk_mul_f32 v[248:249], v[134:135], v[238:239] op_sel:[0,1] op_sel_hi:[1,1]
  v_pk_mul_f32 v[132:133], v[132:133], v[148:149]
  v_pk_mul_f32 v[134:135], v[134:135], v[150:151]
  v_rcp_f32 v242, v242
  v_mfma_f32_16x16x32_bf16 v[180:183], a[72:75], a[100:103], v[180:183]
  v_rcp_f32 v243, v243
  v_lshl_add_u32 v2, v11, 5, v13
  v_mfma_f32_16x16x32_bf16 v[180:183], a[76:79], a[116:119], v[180:183]
  v_rcp_f32 v244, v244
  v_add_u32 v6, 0x10000, v2
  v_mfma_f32_16x16x32_bf16 v[176:179], a[76:79], a[112:115], v[176:179]
  ds_read_b64_tr_b16 a[92:93], v229 offset:57344
  v_cvt_pk_bf16_f32 v94, v108, v109
  v_mfma_f32_16x16x32_bf16 v[176:179], a[72:75], a[96:99], v[176:179]
  s_waitcnt lgkmcnt(3)
  ds_read_b64_tr_b16 a[94:95], v229 offset:61440
  v_cvt_pk_bf16_f32 v95, v110, v111
  v_mfma_f32_16x16x32_bf16 v[160:163], a[80:83], a[0:3], v[160:163]
  buffer_store_dwordx4 v[92:95], v231, s[4:7], s60 offen sc1
  s_add_u32 s60, s60, 16384
  v_exp_f32 v246, v246
  v_mfma_f32_16x16x32_bf16 v[160:163], a[84:87], a[16:19], v[160:163]
  v_exp_f32 v247, v247
  v_xor_b32 v11, 3, v12
  v_mfma_f32_16x16x32_bf16 v[164:167], a[84:87], a[20:23], v[164:167]
  ds_read_b64_tr_b16 a[64:65], v230 offset:0
  ds_read_b64_tr_b16 a[66:67], v230 offset:4096
  v_mfma_f32_16x16x32_bf16 v[164:167], a[80:83], a[4:7], v[164:167]
  v_exp_f32 v248, v248
  v_exp_f32 v249, v249
  v_rcp_f32 v245, v245
  v_pk_fma_f32 v[246:247], v[246:247], v[232:233], v[232:233] op_sel:[0,1,1] op_sel_hi:[1,1,1]
  v_pk_fma_f32 v[248:249], v[248:249], v[232:233], v[232:233] op_sel:[0,1,1] op_sel_hi:[1,1,1]
  v_pk_mul_f32 v[128:129], v[128:129], v[242:243]
  v_pk_mul_f32 v[130:131], v[130:131], v[244:245]
  v_pk_mul_f32 v[242:243], v[136:137], v[240:241] op_sel:[0,0] op_sel_hi:[1,0]
  v_pk_mul_f32 v[244:245], v[138:139], v[240:241] op_sel:[0,0] op_sel_hi:[1,0]
  v_pk_mul_f32 v[136:137], v[136:137], v[152:153]
  v_pk_mul_f32 v[138:139], v[138:139], v[154:155]
  v_rcp_f32 v246, v246
  v_mfma_f32_16x16x32_bf16 v[168:171], a[80:83], a[8:11], v[168:171]
  buffer_load_dword v10, v251, s[4:7], s64 offen sc1
  v_rcp_f32 v247, v247
  v_mfma_f32_16x16x32_bf16 v[168:171], a[84:87], a[24:27], v[168:171]
  v_rcp_f32 v248, v248
  v_lshl_add_u32 v3, v11, 5, v13
  v_mfma_f32_16x16x32_bf16 v[172:175], a[84:87], a[28:31], v[172:175]
  ds_read_b64_tr_b16 a[68:69], v230 offset:8192
  v_cvt_pk_bf16_f32 v144, v128, v129
  v_mfma_f32_16x16x32_bf16 v[172:175], a[80:83], a[12:15], v[172:175]
  s_waitcnt lgkmcnt(3)
  ds_read_b64_tr_b16 a[70:71], v230 offset:12288
  v_cvt_pk_bf16_f32 v145, v130, v131
  v_mfma_f32_16x16x32_bf16 v[188:191], a[88:91], a[12:15], v[188:191]
  v_exp_f32 v242, v242
  v_add_u32 v7, 0x10000, v3
  v_mfma_f32_16x16x32_bf16 v[188:191], a[92:95], a[28:31], v[188:191]
  v_exp_f32 v243, v243
  v_mfma_f32_16x16x32_bf16 v[184:187], a[92:95], a[24:27], v[184:187]
  ds_read_b64_tr_b16 a[72:73], v230 offset:16384
  ds_read_b64_tr_b16 a[74:75], v230 offset:20480
  v_mfma_f32_16x16x32_bf16 v[184:187], a[88:91], a[8:11], v[184:187]
  v_exp_f32 v244, v244
  v_exp_f32 v245, v245
  v_rcp_f32 v249, v249
  v_pk_fma_f32 v[242:243], v[242:243], v[234:235], v[234:235] op_sel:[0,0,0] op_sel_hi:[1,0,0]
  v_pk_fma_f32 v[244:245], v[244:245], v[234:235], v[234:235] op_sel:[0,0,0] op_sel_hi:[1,0,0]
  v_pk_mul_f32 v[132:133], v[132:133], v[246:247]
  v_pk_mul_f32 v[134:135], v[134:135], v[248:249]
  v_pk_mul_f32 v[246:247], v[140:141], v[240:241] op_sel:[0,1] op_sel_hi:[1,1]
  v_pk_mul_f32 v[248:249], v[142:143], v[240:241] op_sel:[0,1] op_sel_hi:[1,1]
  v_pk_mul_f32 v[140:141], v[140:141], v[156:157]
  v_pk_mul_f32 v[142:143], v[142:143], v[158:159]
  v_rcp_f32 v242, v242
  v_mfma_f32_16x16x32_bf16 v[180:183], a[88:91], a[4:7], v[180:183]
  v_rcp_f32 v243, v243
  v_mfma_f32_16x16x32_bf16 v[180:183], a[92:95], a[20:23], v[180:183]
  v_rcp_f32 v244, v244
  v_mfma_f32_16x16x32_bf16 v[176:179], a[92:95], a[16:19], v[176:179]
  ds_read_b64_tr_b16 a[76:77], v230 offset:24576
  v_cvt_pk_bf16_f32 v148, v132, v133
  v_mfma_f32_16x16x32_bf16 v[176:179], a[88:91], a[0:3], v[176:179]
  s_waitcnt lgkmcnt(3)
  ds_read_b64_tr_b16 a[78:79], v230 offset:28672
  v_cvt_pk_bf16_f32 v149, v134, v135
  v_mfma_f32_16x16x32_bf16 v[192:195], a[64:67], a[96:99], v[192:195]
  v_exp_f32 v246, v246
  v_mfma_f32_16x16x32_bf16 v[192:195], a[68:71], a[112:115], v[192:195]
  v_exp_f32 v247, v247
  v_mfma_f32_16x16x32_bf16 v[196:199], a[68:71], a[116:119], v[196:199]
  ds_read_b64_tr_b16 a[80:81], v230 offset:32768
  ds_read_b64_tr_b16 a[82:83], v230 offset:36864
  v_mfma_f32_16x16x32_bf16 v[196:199], a[64:67], a[100:103], v[196:199]
  v_exp_f32 v248, v248
  v_exp_f32 v249, v249
  v_rcp_f32 v245, v245
  v_pk_fma_f32 v[246:247], v[246:247], v[234:235], v[234:235] op_sel:[0,1,1] op_sel_hi:[1,1,1]
  v_pk_fma_f32 v[248:249], v[248:249], v[234:235], v[234:235] op_sel:[0,1,1] op_sel_hi:[1,1,1]
  v_pk_mul_f32 v[136:137], v[136:137], v[242:243]
  v_pk_mul_f32 v[138:139], v[138:139], v[244:245]
  v_pk_mul_f32 v[242:243], v[160:161], v[238:239] op_sel:[0,0] op_sel_hi:[1,0]
  v_pk_mul_f32 v[244:245], v[162:163], v[238:239] op_sel:[0,0] op_sel_hi:[1,0]
  v_pk_mul_f32 v[160:161], v[160:161], v[176:177]
  v_pk_mul_f32 v[162:163], v[162:163], v[178:179]
  v_rcp_f32 v246, v246
  v_mfma_f32_16x16x32_bf16 v[200:203], a[64:67], a[104:107], v[200:203]
  v_rcp_f32 v247, v247
  v_mfma_f32_16x16x32_bf16 v[200:203], a[68:71], a[120:123], v[200:203]
  v_rcp_f32 v248, v248
  v_mfma_f32_16x16x32_bf16 v[204:207], a[68:71], a[124:127], v[204:207]
  ds_read_b64_tr_b16 a[84:85], v230 offset:40960
  v_cvt_pk_bf16_f32 v152, v136, v137
  v_mfma_f32_16x16x32_bf16 v[204:207], a[64:67], a[108:111], v[204:207]
  s_waitcnt lgkmcnt(3)
  ds_read_b64_tr_b16 a[86:87], v230 offset:45056
  v_cvt_pk_bf16_f32 v153, v138, v139
  v_mfma_f32_16x16x32_bf16 v[220:223], a[72:75], a[108:111], v[220:223]
  v_exp_f32 v242, v242
  v_mfma_f32_16x16x32_bf16 v[220:223], a[76:79], a[124:127], v[220:223]
  v_exp_f32 v243, v243
  v_mfma_f32_16x16x32_bf16 v[216:219], a[76:79], a[120:123], v[216:219]
  ds_read_b64_tr_b16 a[88:89], v230 offset:49152
  ds_read_b64_tr_b16 a[90:91], v230 offset:53248
  v_mfma_f32_16x16x32_bf16 v[216:219], a[72:75], a[104:107], v[216:219]
  v_exp_f32 v244, v244
  v_exp_f32 v245, v245
  v_rcp_f32 v249, v249
  v_pk_fma_f32 v[242:243], v[242:243], v[232:233], v[232:233] op_sel:[0,0,0] op_sel_hi:[1,0,0]
  v_pk_fma_f32 v[244:245], v[244:245], v[232:233], v[232:233] op_sel:[0,0,0] op_sel_hi:[1,0,0]
  v_pk_mul_f32 v[140:141], v[140:141], v[246:247]
  v_pk_mul_f32 v[142:143], v[142:143], v[248:249]
  v_pk_mul_f32 v[246:247], v[164:165], v[238:239] op_sel:[0,1] op_sel_hi:[1,1]
  v_pk_mul_f32 v[248:249], v[166:167], v[238:239] op_sel:[0,1] op_sel_hi:[1,1]
  v_pk_mul_f32 v[164:165], v[164:165], v[180:181]
  v_pk_mul_f32 v[166:167], v[166:167], v[182:183]
  v_rcp_f32 v242, v242
  v_mfma_f32_16x16x32_bf16 v[212:215], a[72:75], a[100:103], v[212:215]
  s_waitcnt vmcnt(0)
  v_cmp_gt_u32 vcc, 16, v10
  s_cbranch_vccnz Lp4a_c
Lp4a_r:
  s_add_u32 s64, s64, 4096
  v_rcp_f32 v243, v243
  v_mfma_f32_16x16x32_bf16 v[212:215], a[76:79], a[116:119], v[212:215]
  s_min_u32 s63, s88, 4096
  s_add_u32 s63, s63, s48
  buffer_load_dwordx4 a[128:131], v8, s[4:7], s63 offen offset:0 sc1
  v_rcp_f32 v244, v244
  v_mfma_f32_16x16x32_bf16 v[208:211], a[76:79], a[112:115], v[208:211]
  ds_read_b64_tr_b16 a[92:93], v230 offset:57344
  v_cvt_pk_bf16_f32 v156, v140, v141
  v_mfma_f32_16x16x32_bf16 v[208:211], a[72:75], a[96:99], v[208:211]
  s_waitcnt lgkmcnt(3)
  ds_read_b64_tr_b16 a[94:95], v230 offset:61440
  v_cvt_pk_bf16_f32 v157, v142, v143
  v_mfma_f32_16x16x32_bf16 v[192:195], a[80:83], a[0:3], v[192:195]
  buffer_load_dwordx4 a[132:135], v9, s[4:7], s63 offen offset:0 sc1
  v_mfma_f32_16x16x32_bf16 v[192:195], a[84:87], a[16:19], v[192:195]
  s_min_u32 s63, s89, 4096
  s_add_u32 s63, s63, s48
  buffer_load_dwordx4 a[136:139], v8, s[4:7], s63 offen offset:1024 sc1
  v_exp_f32 v246, v246
  v_mfma_f32_16x16x32_bf16 v[196:199], a[84:87], a[20:23], v[196:199]
  v_exp_f32 v247, v247
  v_mfma_f32_16x16x32_bf16 v[196:199], a[80:83], a[4:7], v[196:199]
  buffer_load_dwordx4 a[140:143], v9, s[4:7], s63 offen offset:1024 sc1
  v_exp_f32 v248, v248
  v_exp_f32 v249, v249
  v_rcp_f32 v245, v245
  v_pk_fma_f32 v[246:247], v[246:247], v[232:233], v[232:233] op_sel:[0,1,1] op_sel_hi:[1,1,1]
  v_pk_fma_f32 v[248:249], v[248:249], v[232:233], v[232:233] op_sel:[0,1,1] op_sel_hi:[1,1,1]
  v_pk_mul_f32 v[160:161], v[160:161], v[242:243]
  v_pk_mul_f32 v[162:163], v[162:163], v[244:245]
  v_pk_mul_f32 v[242:243], v[168:169], v[240:241] op_sel:[0,0] op_sel_hi:[1,0]
  v_pk_mul_f32 v[244:245], v[170:171], v[240:241] op_sel:[0,0] op_sel_hi:[1,0]
  v_pk_mul_f32 v[168:169], v[168:169], v[184:185]
  v_pk_mul_f32 v[170:171], v[170:171], v[186:187]
  v_rcp_f32 v246, v246
  v_mfma_f32_16x16x32_bf16 v[200:203], a[80:83], a[8:11], v[200:203]
  s_barrier
  s_cmp_lg_u32 s40, 0
  s_cbranch_scc1 Lsgf21
  v_mov_b32 v250, 1
  s_mov_b64 exec, 1
  buffer_atomic_add v250, v251, s[4:7], s77 offen sc1
  s_mov_b64 exec, -1
Lsgf21:
  s_add_u32 s77, s77, 4096
  v_mfma_f32_16x16x32_bf16 v[200:203], a[84:87], a[24:27], v[200:203]
  s_min_u32 s63, s90, 4096
  s_add_u32 s63, s63, s48
  buffer_load_dwordx4 a[144:147], v8, s[4:7], s63 offen offset:2048 sc1
  v_rcp_f32 v247, v247
  v_mfma_f32_16x16x32_bf16 v[204:207], a[84:87], a[28:31], v[204:207]
  v_rcp_f32 v248, v248
  v_cvt_pk_bf16_f32 v146, v160, v161
  v_cvt_pk_bf16_f32 v147, v162, v163
  v_mfma_f32_16x16x32_bf16 v[204:207], a[80:83], a[12:15], v[204:207]
  s_waitcnt lgkmcnt(0)
  buffer_load_dwordx4 a[148:151], v9, s[4:7], s63 offen offset:2048 sc1
  v_mfma_f32_16x16x32_bf16 v[220:223], a[88:91], a[12:15], v[220:223]
  buffer_store_dwordx4 v[144:147], v231, s[4:7], s57 offen sc1
  s_add_u32 s57, s57, 16384
  v_mfma_f32_16x16x32_bf16 v[220:223], a[92:95], a[28:31], v[220:223]
  s_min_u32 s63, s91, 4096
  s_add_u32 s63, s63, s48
  buffer_load_dwordx4 a[152:155], v8, s[4:7], s63 offen offset:3072 sc1
  v_exp_f32 v242, v242
  v_mfma_f32_16x16x32_bf16 v[216:219], a[92:95], a[24:27], v[216:219]
  v_exp_f32 v243, v243
  v_mfma_f32_16x16x32_bf16 v[216:219], a[88:91], a[8:11], v[216:219]
  buffer_load_dwordx4 a[156:159], v9, s[4:7], s63 offen offset:3072 sc1
  v_exp_f32 v244, v244
  v_exp_f32 v245, v245
  v_rcp_f32 v249, v249
  v_pk_fma_f32 v[242:243], v[242:243], v[234:235], v[234:235] op_sel:[0,0,0] op_sel_hi:[1,0,0]
  v_pk_fma_f32 v[244:245], v[244:245], v[234:235], v[234:235] op_sel:[0,0,0] op_sel_hi:[1,0,0]
  v_pk_mul_f32 v[164:165], v[164:165], v[246:247]
  v_pk_mul_f32 v[166:167], v[166:167], v[248:249]
  v_pk_mul_f32 v[246:247], v[172:173], v[240:241] op_sel:[0,1] op_sel_hi:[1,1]
  v_pk_mul_f32 v[248:249], v[174:175], v[240:241] op_sel:[0,1] op_sel_hi:[1,1]
  v_pk_mul_f32 v[172:173], v[172:173], v[188:189]
  v_pk_mul_f32 v[174:175], v[174:175], v[190:191]
  v_mfma_f32_16x16x32_bf16 v[212:215], a[88:91], a[4:7], v[212:215]
  v_rcp_f32 v242, v242
  v_mfma_f32_16x16x32_bf16 v[212:215], a[92:95], a[20:23], v[212:215]
  v_mfma_f32_16x16x32_bf16 v[208:211], a[92:95], a[16:19], v[208:211]
  v_mfma_f32_16x16x32_bf16 v[208:211], a[88:91], a[0:3], v[208:211]
  ds_read_b64_tr_b16 a[0:1], v0 offset:0
  ds_read_b64_tr_b16 a[2:3], v0 offset:4096
  ds_read_b64_tr_b16 a[16:17], v0 offset:8192
  ds_read_b64_tr_b16 a[18:19], v0 offset:12288
  ds_read_b64_tr_b16 a[4:5], v1 offset:0
  ds_read_b64_tr_b16 a[6:7], v1 offset:4096
  ds_read_b64_tr_b16 a[20:21], v1 offset:8192
  ds_read_b64_tr_b16 a[22:23], v1 offset:12288
  ds_read_b64_tr_b16 a[8:9], v2 offset:0
  ds_read_b64_tr_b16 a[10:11], v2 offset:4096
  ds_read_b64_tr_b16 a[24:25], v2 offset:8192
  ds_read_b64_tr_b16 a[26:27], v2 offset:12288
  ds_read_b64_tr_b16 a[12:13], v3 offset:0
  ds_read_b64_tr_b16 a[14:15], v3 offset:4096
  ds_read_b64_tr_b16 a[28:29], v3 offset:8192
  ds_read_b64_tr_b16 a[30:31], v3 offset:12288
  s_add_u32 s48, s48, 4096
  s_min_u32 s63, s88, 4096
  s_add_u32 s63, s63, s48
  buffer_load_dwordx4 a[160:163], v8, s[4:7], s63 offen offset:0 sc1
  buffer_load_dwordx4 a[164:167], v9, s[4:7], s63 offen offset:0 sc1
  v_rcp_f32 v243, v243
  v_rcp_f32 v244, v244
  v_cvt_pk_bf16_f32 v150, v164, v165
  v_cvt_pk_bf16_f32 v151, v166, v167
  s_min_u32 s63, s89, 4096
  s_add_u32 s63, s63, s48
  buffer_load_dwordx4 a[168:171], v8, s[4:7], s63 offen offset:1024 sc1
  buffer_load_dwordx4 a[172:175], v9, s[4:7], s63 offen offset:1024 sc1
  buffer_store_dwordx4 v[148:151], v231, s[4:7], s58 offen sc1
  s_add_u32 s58, s58, 16384
  v_exp_f32 v246, v246
  v_exp_f32 v247, v247
  v_exp_f32 v248, v248
  v_exp_f32 v249, v249
  v_rcp_f32 v245, v245
  v_pk_fma_f32 v[246:247], v[246:247], v[234:235], v[234:235] op_sel:[0,1,1] op_sel_hi:[1,1,1]
  v_pk_fma_f32 v[248:249], v[248:249], v[234:235], v[234:235] op_sel:[0,1,1] op_sel_hi:[1,1,1]
  v_pk_mul_f32 v[168:169], v[168:169], v[242:243]
  v_pk_mul_f32 v[170:171], v[170:171], v[244:245]
  v_pk_mul_f32 v[242:243], v[192:193], v[238:239] op_sel:[0,0] op_sel_hi:[1,0]
  v_pk_mul_f32 v[244:245], v[194:195], v[238:239] op_sel:[0,0] op_sel_hi:[1,0]
  v_pk_mul_f32 v[192:193], v[192:193], v[208:209]
  v_pk_mul_f32 v[194:195], v[194:195], v[210:211]
  v_rcp_f32 v246, v246
  s_min_u32 s63, s90, 4096
  s_add_u32 s63, s63, s48
  buffer_load_dwordx4 a[176:179], v8, s[4:7], s63 offen offset:2048 sc1
  buffer_load_dwordx4 a[180:183], v9, s[4:7], s63 offen offset:2048 sc1
  v_rcp_f32 v247, v247
  v_rcp_f32 v248, v248
  v_cvt_pk_bf16_f32 v154, v168, v169
  v_cvt_pk_bf16_f32 v155, v170, v171
  s_min_u32 s63, s91, 4096
  s_add_u32 s63, s63, s48
  buffer_load_dwordx4 a[184:187], v8, s[4:7], s63 offen offset:3072 sc1
  buffer_load_dwordx4 a[188:191], v9, s[4:7], s63 offen offset:3072 sc1
  buffer_store_dwordx4 v[152:155], v231, s[4:7], s59 offen sc1
  s_add_u32 s59, s59, 16384
  v_exp_f32 v242, v242
  v_exp_f32 v243, v243
  v_exp_f32 v244, v244
  v_exp_f32 v245, v245
  v_rcp_f32 v249, v249
  v_pk_fma_f32 v[242:243], v[242:243], v[232:233], v[232:233] op_sel:[0,0,0] op_sel_hi:[1,0,0]
  v_pk_fma_f32 v[244:245], v[244:245], v[232:233], v[232:233] op_sel:[0,0,0] op_sel_hi:[1,0,0]
  v_pk_mul_f32 v[172:173], v[172:173], v[246:247]
  v_pk_mul_f32 v[174:175], v[174:175], v[248:249]
  v_pk_mul_f32 v[246:247], v[196:197], v[238:239] op_sel:[0,1] op_sel_hi:[1,1]
  v_pk_mul_f32 v[248:249], v[198:199], v[238:239] op_sel:[0,1] op_sel_hi:[1,1]
  v_pk_mul_f32 v[196:197], v[196:197], v[212:213]
  v_pk_mul_f32 v[198:199], v[198:199], v[214:215]
  v_rcp_f32 v242, v242
  s_add_u32 m0, s79, 65536
  s_add_u32 s92, s92, 196608
  s_add_u32 s93, s92, s88
  v_rcp_f32 v243, v243
  v_rcp_f32 v244, v244
  v_cvt_pk_bf16_f32 v158, v172, v173
  v_cvt_pk_bf16_f32 v159, v174, v175
  buffer_load_dwordx4 v252, s[80:83], s93 offen lds
  buffer_load_dwordx4 v252, s[84:87], s93 offen offset:1024 lds
  buffer_store_dwordx4 v[156:159], v231, s[4:7], s60 offen sc1
  s_add_u32 s60, s60, 16384
  v_exp_f32 v246, v246
  v_exp_f32 v247, v247
  v_exp_f32 v248, v248
  v_exp_f32 v249, v249
  v_rcp_f32 v245, v245
  v_pk_fma_f32 v[246:247], v[246:247], v[232:233], v[232:233] op_sel:[0,1,1] op_sel_hi:[1,1,1]
  v_pk_fma_f32 v[248:249], v[248:249], v[232:233], v[232:233] op_sel:[0,1,1] op_sel_hi:[1,1,1]
  v_pk_mul_f32 v[192:193], v[192:193], v[242:243]
  v_pk_mul_f32 v[194:195], v[194:195], v[244:245]
  v_pk_mul_f32 v[242:243], v[200:201], v[240:241] op_sel:[0,0] op_sel_hi:[1,0]
  v_pk_mul_f32 v[244:245], v[202:203], v[240:241] op_sel:[0,0] op_sel_hi:[1,0]
  v_pk_mul_f32 v[200:201], v[200:201], v[216:217]
  v_pk_mul_f32 v[202:203], v[202:203], v[218:219]
  v_rcp_f32 v246, v246
  s_add_u32 m0, s79, 73728
  s_add_u32 s92, s92, 262144
  s_add_u32 s93, s92, s89
  v_rcp_f32 v247, v247
  v_rcp_f32 v248, v248
  v_cvt_pk_bf16_f32 v208, v192, v193
  v_cvt_pk_bf16_f32 v209, v194, v195
  buffer_load_dwordx4 v252, s[80:83], s93 offen lds
  buffer_load_dwordx4 v252, s[84:87], s93 offen offset:1024 lds
  v_exp_f32 v242, v242
  v_exp_f32 v243, v243
  v_exp_f32 v244, v244
  v_exp_f32 v245, v245
  v_rcp_f32 v249, v249
  v_pk_fma_f32 v[242:243], v[242:243], v[234:235], v[234:235] op_sel:[0,0,0] op_sel_hi:[1,0,0]
  v_pk_fma_f32 v[244:245], v[244:245], v[234:235], v[234:235] op_sel:[0,0,0] op_sel_hi:[1,0,0]
  v_pk_mul_f32 v[196:197], v[196:197], v[246:247]
  v_pk_mul_f32 v[198:199], v[198:199], v[248:249]
  v_pk_mul_f32 v[246:247], v[204:205], v[240:241] op_sel:[0,1] op_sel_hi:[1,1]
  v_pk_mul_f32 v[248:249], v[206:207], v[240:241] op_sel:[0,1] op_sel_hi:[1,1]
  v_pk_mul_f32 v[204:205], v[204:205], v[220:221]
  v_pk_mul_f32 v[206:207], v[206:207], v[222:223]
  v_rcp_f32 v242, v242
  s_add_u32 m0, s79, 81920
  s_add_u32 s92, s92, 196608
  s_add_u32 s93, s92, s90
  v_rcp_f32 v243, v243
  v_rcp_f32 v244, v244
  v_cvt_pk_bf16_f32 v210, v196, v197
  v_cvt_pk_bf16_f32 v211, v198, v199
  buffer_load_dwordx4 v252, s[80:83], s93 offen lds
  buffer_load_dwordx4 v252, s[84:87], s93 offen offset:1024 lds
  s_nop 1
  v_permlane32_swap_b32 v208, v210
  v_permlane32_swap_b32 v209, v211
  buffer_store_dwordx4 v[208:211], v236, s[4:7], s61 offen sc1
  v_exp_f32 v246, v246
  v_exp_f32 v247, v247
  v_exp_f32 v248, v248
  v_exp_f32 v249, v249
  v_rcp_f32 v245, v245
  v_pk_fma_f32 v[246:247], v[246:247], v[234:235], v[234:235] op_sel:[0,1,1] op_sel_hi:[1,1,1]
  v_pk_fma_f32 v[248:249], v[248:249], v[234:235], v[234:235] op_sel:[0,1,1] op_sel_hi:[1,1,1]
  v_pk_mul_f32 v[200:201], v[200:201], v[242:243]
  v_pk_mul_f32 v[202:203], v[202:203], v[244:245]
  v_rcp_f32 v246, v246
  s_add_u32 m0, s79, 90112
  s_add_u32 s92, s92, 262144
  s_add_u32 s93, s92, s91
  v_rcp_f32 v247, v247
  v_rcp_f32 v248, v248
  v_cvt_pk_bf16_f32 v216, v200, v201
  v_cvt_pk_bf16_f32 v217, v202, v203
  buffer_load_dwordx4 v252, s[80:83], s93 offen lds
  buffer_load_dwordx4 v252, s[84:87], s93 offen offset:1024 lds
  v_rcp_f32 v249, v249
  s_nop 0
  v_pk_mul_f32 v[204:205], v[204:205], v[246:247]
  v_pk_mul_f32 v[206:207], v[206:207], v[248:249]
  v_cvt_pk_bf16_f32 v218, v204, v205
  v_cvt_pk_bf16_f32 v219, v206, v207
  s_nop 1
  v_permlane32_swap_b32 v216, v218
  v_permlane32_swap_b32 v217, v219
  buffer_store_dwordx4 v[216:219], v236, s[4:7], s62 offen sc1
  v_pk_mul_f32 v[32:33], v[250:251], 0 op_sel:[1,0] op_sel_hi:[1,0]
  v_pk_mul_f32 v[34:35], v[250:251], 0 op_sel:[1,0] op_sel_hi:[1,0]
  v_pk_mul_f32 v[36:37], v[250:251], 0 op_sel:[1,0] op_sel_hi:[1,0]
  v_pk_mul_f32 v[38:39], v[250:251], 0 op_sel:[1,0] op_sel_hi:[1,0]
  v_pk_mul_f32 v[40:41], v[250:251], 0 op_sel:[1,0] op_sel_hi:[1,0]
  v_pk_mul_f32 v[42:43], v[250:251], 0 op_sel:[1,0] op_sel_hi:[1,0]
  v_pk_mul_f32 v[44:45], v[250:251], 0 op_sel:[1,0] op_sel_hi:[1,0]
  v_pk_mul_f32 v[46:47], v[250:251], 0 op_sel:[1,0] op_sel_hi:[1,0]
  v_pk_mul_f32 v[48:49], v[250:251], 0 op_sel:[1,0] op_sel_hi:[1,0]
  v_pk_mul_f32 v[50:51], v[250:251], 0 op_sel:[1,0] op_sel_hi:[1,0]
  v_pk_mul_f32 v[52:53], v[250:251], 0 op_sel:[1,0] op_sel_hi:[1,0]
  v_pk_mul_f32 v[54:55], v[250:251], 0 op_sel:[1,0] op_sel_hi:[1,0]
  v_pk_mul_f32 v[56:57], v[250:251], 0 op_sel:[1,0] op_sel_hi:[1,0]
  v_pk_mul_f32 v[58:59], v[250:251], 0 op_sel:[1,0] op_sel_hi:[1,0]
  v_pk_mul_f32 v[60:61], v[250:251], 0 op_sel:[1,0] op_sel_hi:[1,0]
  v_pk_mul_f32 v[62:63], v[250:251], 0 op_sel:[1,0] op_sel_hi:[1,0]
  v_lshlrev_b32 v64, 16, v16
  v_and_b32 v65, 0xffff0000, v16
  v_lshlrev_b32 v66, 16, v17
  v_and_b32 v67, 0xffff0000, v17
  v_lshlrev_b32 v72, 16, v18
  v_and_b32 v73, 0xffff0000, v18
  v_lshlrev_b32 v74, 16, v19
  v_and_b32 v75, 0xffff0000, v19
  v_lshlrev_b32 v80, 16, v20
  v_and_b32 v81, 0xffff0000, v20
  v_lshlrev_b32 v82, 16, v21
  v_and_b32 v83, 0xffff0000, v21
  v_lshlrev_b32 v88, 16, v22
  v_and_b32 v89, 0xffff0000, v22
  v_lshlrev_b32 v90, 16, v23
  v_and_b32 v91, 0xffff0000, v23
  v_lshlrev_b32 v68, 16, v24
  v_and_b32 v69, 0xffff0000, v24
  v_lshlrev_b32 v70, 16, v25
  v_and_b32 v71, 0xffff0000, v25
  v_lshlrev_b32 v76, 16, v26
  v_and_b32 v77, 0xffff0000, v26
  v_lshlrev_b32 v78, 16, v27
  v_and_b32 v79, 0xffff0000, v27
  v_lshlrev_b32 v84, 16, v28
  v_and_b32 v85, 0xffff0000, v28
  v_lshlrev_b32 v86, 16, v29
  v_and_b32 v87, 0xffff0000, v29
  v_lshlrev_b32 v92, 16, v30
  v_and_b32 v93, 0xffff0000, v30
  v_lshlrev_b32 v94, 16, v31
  v_and_b32 v95, 0xffff0000, v31
  s_mov_b32 s56, 2
.p2align 3
Lp4_loop:
  s_waitcnt vmcnt(24) lgkmcnt(8)
  v_mfma_f32_16x16x32_bf16 v[32:35], a[0:3], a[128:131], v[32:35]
  s_waitcnt vmcnt(26)
  s_barrier
  ds_read_b64_tr_b16 a[32:33], v0 offset:1024
  s_add_u32 m0, s79, 98304
  s_add_u32 s92, s92, 196608
  s_cmp_lg_u32 s88, 0
  v_mfma_f32_16x16x32_bf16 v[32:35], a[16:19], a[136:139], v[32:35]
  s_cselect_b32 s93, -2686976, 0
  ds_read_b64_tr_b16 a[34:35], v0 offset:5120
  s_add_u32 s93, s93, s92
  v_mfma_f32_16x16x32_bf16 v[36:39], a[16:19], a[140:143], v[36:39]
  buffer_load_dwordx4 v252, s[80:83], s93 offen lds
  v_mfma_f32_16x16x32_bf16 v[36:39], a[0:3], a[132:135], v[36:39]
  ds_read_b64_tr_b16 a[48:49], v0 offset:9216
  ds_read_b64_tr_b16 a[50:51], v0 offset:13312
  v_mfma_f32_16x16x32_bf16 v[44:47], a[4:7], a[132:135], v[44:47]
  ds_read_b64_tr_b16 a[36:37], v1 offset:1024
  v_mfma_f32_16x16x32_bf16 v[44:47], a[20:23], a[140:143], v[44:47]
  ds_read_b64_tr_b16 a[38:39], v1 offset:5120
  v_mfma_f32_16x16x32_bf16 v[40:43], a[20:23], a[136:139], v[40:43]
  buffer_load_dwordx4 v252, s[84:87], s93 offen offset:1024 lds
  v_mfma_f32_16x16x32_bf16 v[40:43], a[4:7], a[128:131], v[40:43]
  s_waitcnt lgkmcnt(6)
  ds_read_b64_tr_b16 a[52:53], v1 offset:9216
  ds_read_b64_tr_b16 a[54:55], v1 offset:13312
  v_mfma_f32_16x16x32_bf16 v[48:51], a[8:11], a[128:131], v[48:51]
  ds_read_b64_tr_b16 a[40:41], v2 offset:1024
  v_mfma_f32_16x16x32_bf16 v[48:51], a[24:27], a[136:139], v[48:51]
  s_add_u32 s48, s48, 4096
  ds_read_b64_tr_b16 a[42:43], v2 offset:5120
  s_min_u32 s63, s88, 4096
  v_mfma_f32_16x16x32_bf16 v[52:55], a[24:27], a[140:143], v[52:55]
  s_add_u32 s63, s63, s48
  buffer_load_dwordx4 a[192:195], v8, s[4:7], s63 offen offset:0 sc1
  v_mfma_f32_16x16x32_bf16 v[52:55], a[8:11], a[132:135], v[52:55]
  ds_read_b64_tr_b16 a[56:57], v2 offset:9216
  ds_read_b64_tr_b16 a[58:59], v2 offset:13312
  v_mfma_f32_16x16x32_bf16 v[60:63], a[12:15], a[132:135], v[60:63]
  ds_read_b64_tr_b16 a[44:45], v3 offset:1024
  v_mfma_f32_16x16x32_bf16 v[60:63], a[28:31], a[140:143], v[60:63]
  ds_read_b64_tr_b16 a[46:47], v3 offset:5120
  v_mfma_f32_16x16x32_bf16 v[56:59], a[28:31], a[136:139], v[56:59]
  buffer_load_dwordx4 a[196:199], v9, s[4:7], s63 offen offset:0 sc1
  v_mfma_f32_16x16x32_bf16 v[56:59], a[12:15], a[128:131], v[56:59]
  s_waitcnt lgkmcnt(6)
  ds_read_b64_tr_b16 a[60:61], v3 offset:9216
  ds_read_b64_tr_b16 a[62:63], v3 offset:13312
  v_mfma_f32_16x16x32_bf16 v[64:67], a[32:35], a[128:131], v[64:67]
  s_add_u32 m0, s79, 106496
  ds_read_b64_tr_b16 a[0:1], v0 offset:16384
  buffer_load_dword v10, v251, s[4:7], s64 offen sc1
  s_add_u32 s92, s92, 262144
  s_cmp_lg_u32 s89, 0
  v_mfma_f32_16x16x32_bf16 v[64:67], a[48:51], a[136:139], v[64:67]
  s_cselect_b32 s93, -2686976, 0
  ds_read_b64_tr_b16 a[2:3], v0 offset:20480
  s_add_u32 s93, s93, s92
  v_mfma_f32_16x16x32_bf16 v[68:71], a[48:51], a[140:143], v[68:71]
  buffer_load_dwordx4 v252, s[80:83], s93 offen lds
  v_mfma_f32_16x16x32_bf16 v[68:71], a[32:35], a[132:135], v[68:71]
  ds_read_b64_tr_b16 a[16:17], v0 offset:24576
  ds_read_b64_tr_b16 a[18:19], v0 offset:28672
  v_mfma_f32_16x16x32_bf16 v[76:79], a[36:39], a[132:135], v[76:79]
  ds_read_b64_tr_b16 a[4:5], v1 offset:16384
  v_mfma_f32_16x16x32_bf16 v[76:79], a[52:55], a[140:143], v[76:79]
  ds_read_b64_tr_b16 a[6:7], v1 offset:20480
  v_mfma_f32_16x16x32_bf16 v[72:75], a[52:55], a[136:139], v[72:75]
  buffer_load_dwordx4 v252, s[84:87], s93 offen offset:1024 lds
  v_mfma_f32_16x16x32_bf16 v[72:75], a[36:39], a[128:131], v[72:75]
  s_waitcnt lgkmcnt(6)
  ds_read_b64_tr_b16 a[20:21], v1 offset:24576
  ds_read_b64_tr_b16 a[22:23], v1 offset:28672
  v_mfma_f32_16x16x32_bf16 v[80:83], a[40:43], a[128:131], v[80:83]
  ds_read_b64_tr_b16 a[8:9], v2 offset:16384
  v_mfma_f32_16x16x32_bf16 v[80:83], a[56:59], a[136:139], v[80:83]
  s_min_u32 s63, s89, 4096
  ds_read_b64_tr_b16 a[10:11], v2 offset:20480
  s_add_u32 s63, s63, s48
  v_mfma_f32_16x16x32_bf16 v[84:87], a[56:59], a[140:143], v[84:87]
  buffer_load_dwordx4 a[200:203], v8, s[4:7], s63 offen offset:1024 sc1
  v_mfma_f32_16x16x32_bf16 v[84:87], a[40:43], a[132:135], v[84:87]
  ds_read_b64_tr_b16 a[24:25], v2 offset:24576
  ds_read_b64_tr_b16 a[26:27], v2 offset:28672
  v_mfma_f32_16x16x32_bf16 v[92:95], a[44:47], a[132:135], v[92:95]
  ds_read_b64_tr_b16 a[12:13], v3 offset:16384
  v_mfma_f32_16x16x32_bf16 v[92:95], a[60:63], a[140:143], v[92:95]
  ds_read_b64_tr_b16 a[14:15], v3 offset:20480
  v_mfma_f32_16x16x32_bf16 v[88:91], a[60:63], a[136:139], v[88:91]
  buffer_load_dwordx4 a[204:207], v9, s[4:7], s63 offen offset:1024 sc1
  v_mfma_f32_16x16x32_bf16 v[88:91], a[44:47], a[128:131], v[88:91]
  s_waitcnt vmcnt(25) lgkmcnt(6)
  ds_read_b64_tr_b16 a[28:29], v3 offset:24576
  ds_read_b64_tr_b16 a[30:31], v3 offset:28672
  v_mfma_f32_16x16x32_bf16 v[32:35], a[0:3], a[144:147], v[32:35]
  s_add_u32 m0, s79, 114688
  ds_read_b64_tr_b16 a[32:33], v0 offset:17408
  s_add_u32 s92, s92, 196608
  s_cmp_lg_u32 s90, 0
  v_mfma_f32_16x16x32_bf16 v[32:35], a[16:19], a[152:155], v[32:35]
  s_cselect_b32 s93, -2686976, 0
  ds_read_b64_tr_b16 a[34:35], v0 offset:21504
  s_add_u32 s93, s93, s92
  v_mfma_f32_16x16x32_bf16 v[36:39], a[16:19], a[156:159], v[36:39]
  buffer_load_dwordx4 v252, s[80:83], s93 offen lds
  v_mfma_f32_16x16x32_bf16 v[36:39], a[0:3], a[148:151], v[36:39]
  ds_read_b64_tr_b16 a[48:49], v0 offset:25600
  ds_read_b64_tr_b16 a[50:51], v0 offset:29696
  v_mfma_f32_16x16x32_bf16 v[44:47], a[4:7], a[148:151], v[44:47]
  ds_read_b64_tr_b16 a[36:37], v1 offset:17408
  v_mfma_f32_16x16x32_bf16 v[44:47], a[20:23], a[156:159], v[44:47]
  ds_read_b64_tr_b16 a[38:39], v1 offset:21504
  v_mfma_f32_16x16x32_bf16 v[40:43], a[20:23], a[152:155], v[40:43]
  buffer_load_dwordx4 v252, s[84:87], s93 offen offset:1024 lds
  v_mfma_f32_16x16x32_bf16 v[40:43], a[4:7], a[144:147], v[40:43]
  s_waitcnt lgkmcnt(6)
  ds_read_b64_tr_b16 a[52:53], v1 offset:25600
  ds_read_b64_tr_b16 a[54:55], v1 offset:29696
  v_mfma_f32_16x16x32_bf16 v[48:51], a[8:11], a[144:147], v[48:51]
  ds_read_b64_tr_b16 a[40:41], v2 offset:17408
  v_mfma_f32_16x16x32_bf16 v[48:51], a[24:27], a[152:155], v[48:51]
  s_min_u32 s63, s90, 4096
  ds_read_b64_tr_b16 a[42:43], v2 offset:21504
  s_add_u32 s63, s63, s48
  v_mfma_f32_16x16x32_bf16 v[52:55], a[24:27], a[156:159], v[52:55]
  buffer_load_dwordx4 a[208:211], v8, s[4:7], s63 offen offset:2048 sc1
  v_mfma_f32_16x16x32_bf16 v[52:55], a[8:11], a[148:151], v[52:55]
  ds_read_b64_tr_b16 a[56:57], v2 offset:25600
  ds_read_b64_tr_b16 a[58:59], v2 offset:29696
  v_mfma_f32_16x16x32_bf16 v[60:63], a[12:15], a[148:151], v[60:63]
  ds_read_b64_tr_b16 a[44:45], v3 offset:17408
  v_mfma_f32_16x16x32_bf16 v[60:63], a[28:31], a[156:159], v[60:63]
  ds_read_b64_tr_b16 a[46:47], v3 offset:21504
  v_mfma_f32_16x16x32_bf16 v[56:59], a[28:31], a[152:155], v[56:59]
  buffer_load_dwordx4 a[212:215], v9, s[4:7], s63 offen offset:2048 sc1
  v_mfma_f32_16x16x32_bf16 v[56:59], a[12:15], a[144:147], v[56:59]
  s_waitcnt lgkmcnt(6)
  ds_read_b64_tr_b16 a[60:61], v3 offset:25600
  ds_read_b64_tr_b16 a[62:63], v3 offset:29696
  v_mfma_f32_16x16x32_bf16 v[64:67], a[32:35], a[144:147], v[64:67]
  s_add_u32 m0, s79, 122880
  ds_read_b64_tr_b16 a[0:1], v0 offset:32768
  s_add_u32 s92, s92, 262144
  s_cmp_lg_u32 s91, 0
  v_mfma_f32_16x16x32_bf16 v[64:67], a[48:51], a[152:155], v[64:67]
  s_cselect_b32 s93, -2686976, 0
  ds_read_b64_tr_b16 a[2:3], v0 offset:36864
  s_add_u32 s93, s93, s92
  v_mfma_f32_16x16x32_bf16 v[68:71], a[48:51], a[156:159], v[68:71]
  buffer_load_dwordx4 v252, s[80:83], s93 offen lds
  v_mfma_f32_16x16x32_bf16 v[68:71], a[32:35], a[148:151], v[68:71]
  ds_read_b64_tr_b16 a[16:17], v0 offset:40960
  ds_read_b64_tr_b16 a[18:19], v0 offset:45056
  v_mfma_f32_16x16x32_bf16 v[76:79], a[36:39], a[148:151], v[76:79]
  ds_read_b64_tr_b16 a[4:5], v1 offset:32768
  v_mfma_f32_16x16x32_bf16 v[76:79], a[52:55], a[156:159], v[76:79]
  ds_read_b64_tr_b16 a[6:7], v1 offset:36864
  v_mfma_f32_16x16x32_bf16 v[72:75], a[52:55], a[152:155], v[72:75]
  buffer_load_dwordx4 v252, s[84:87], s93 offen offset:1024 lds
  v_mfma_f32_16x16x32_bf16 v[72:75], a[36:39], a[144:147], v[72:75]
  s_waitcnt lgkmcnt(6)
  ds_read_b64_tr_b16 a[20:21], v1 offset:40960
  ds_read_b64_tr_b16 a[22:23], v1 offset:45056
  v_mfma_f32_16x16x32_bf16 v[80:83], a[40:43], a[144:147], v[80:83]
  ds_read_b64_tr_b16 a[8:9], v2 offset:32768
  v_mfma_f32_16x16x32_bf16 v[80:83], a[56:59], a[152:155], v[80:83]
  s_min_u32 s63, s91, 4096
  ds_read_b64_tr_b16 a[10:11], v2 offset:36864
  s_add_u32 s63, s63, s48
  v_mfma_f32_16x16x32_bf16 v[84:87], a[56:59], a[156:159], v[84:87]
  buffer_load_dwordx4 a[216:219], v8, s[4:7], s63 offen offset:3072 sc1
  v_mfma_f32_16x16x32_bf16 v[84:87], a[40:43], a[148:151], v[84:87]
  ds_read_b64_tr_b16 a[24:25], v2 offset:40960
  ds_read_b64_tr_b16 a[26:27], v2 offset:45056
  v_mfma_f32_16x16x32_bf16 v[92:95], a[44:47], a[148:151], v[92:95]
  ds_read_b64_tr_b16 a[12:13], v3 offset:32768
  v_mfma_f32_16x16x32_bf16 v[92:95], a[60:63], a[156:159], v[92:95]
  ds_read_b64_tr_b16 a[14:15], v3 offset:36864
  v_mfma_f32_16x16x32_bf16 v[88:91], a[60:63], a[152:155], v[88:91]
  buffer_load_dwordx4 a[220:223], v9, s[4:7], s63 offen offset:3072 sc1
  v_mfma_f32_16x16x32_bf16 v[88:91], a[44:47], a[144:147], v[88:91]
  s_waitcnt vmcnt(25) lgkmcnt(6)
  ds_read_b64_tr_b16 a[28:29], v3 offset:40960
  ds_read_b64_tr_b16 a[30:31], v3 offset:45056
  v_mfma_f32_16x16x32_bf16 v[32:35], a[0:3], a[160:163], v[32:35]
  s_waitcnt vmcnt(23)
  s_barrier
  ds_read_b64_tr_b16 a[32:33], v0 offset:33792
  s_waitcnt vmcnt(12)
  v_cmp_gt_u32 vcc, 16, v10
  s_cbranch_vccnz Lp4b_c
Lp4b_r:
  s_add_u32 s64, s64, 4096
  v_mfma_f32_16x16x32_bf16 v[32:35], a[16:19], a[168:171], v[32:35]
  s_add_u32 m0, s79, 0
  ds_read_b64_tr_b16 a[34:35], v0 offset:37888
  s_add_u32 s92, s92, -3407872
  v_mfma_f32_16x16x32_bf16 v[36:39], a[16:19], a[172:175], v[36:39]
  s_add_u32 s93, s92, s88
  buffer_load_dwordx4 v252, s[80:83], s93 offen lds
  v_mfma_f32_16x16x32_bf16 v[36:39], a[0:3], a[164:167], v[36:39]
  ds_read_b64_tr_b16 a[48:49], v0 offset:41984
  ds_read_b64_tr_b16 a[50:51], v0 offset:46080
  v_mfma_f32_16x16x32_bf16 v[44:47], a[4:7], a[164:167], v[44:47]
  ds_read_b64_tr_b16 a[36:37], v1 offset:33792
  v_mfma_f32_16x16x32_bf16 v[44:47], a[20:23], a[172:175], v[44:47]
  ds_read_b64_tr_b16 a[38:39], v1 offset:37888
  v_mfma_f32_16x16x32_bf16 v[40:43], a[20:23], a[168:171], v[40:43]
  buffer_load_dwordx4 v252, s[84:87], s93 offen offset:1024 lds
  v_mfma_f32_16x16x32_bf16 v[40:43], a[4:7], a[160:163], v[40:43]
  s_waitcnt lgkmcnt(6)
  ds_read_b64_tr_b16 a[52:53], v1 offset:41984
  ds_read_b64_tr_b16 a[54:55], v1 offset:46080
  v_mfma_f32_16x16x32_bf16 v[48:51], a[8:11], a[160:163], v[48:51]
  ds_read_b64_tr_b16 a[40:41], v2 offset:33792
  v_mfma_f32_16x16x32_bf16 v[48:51], a[24:27], a[168:171], v[48:51]
  s_add_u32 s48, s48, 4096
  ds_read_b64_tr_b16 a[42:43], v2 offset:37888
  s_min_u32 s63, s88, 4096
  v_mfma_f32_16x16x32_bf16 v[52:55], a[24:27], a[172:175], v[52:55]
  s_add_u32 s63, s63, s48
  buffer_load_dwordx4 a[224:227], v8, s[4:7], s63 offen offset:0 sc1
  v_mfma_f32_16x16x32_bf16 v[52:55], a[8:11], a[164:167], v[52:55]
  ds_read_b64_tr_b16 a[56:57], v2 offset:41984
  ds_read_b64_tr_b16 a[58:59], v2 offset:46080
  v_mfma_f32_16x16x32_bf16 v[60:63], a[12:15], a[164:167], v[60:63]
  ds_read_b64_tr_b16 a[44:45], v3 offset:33792
  v_mfma_f32_16x16x32_bf16 v[60:63], a[28:31], a[172:175], v[60:63]
  ds_read_b64_tr_b16 a[46:47], v3 offset:37888
  v_mfma_f32_16x16x32_bf16 v[56:59], a[28:31], a[168:171], v[56:59]
  buffer_load_dwordx4 a[228:231], v9, s[4:7], s63 offen offset:0 sc1
  v_mfma_f32_16x16x32_bf16 v[56:59], a[12:15], a[160:163], v[56:59]
  s_waitcnt lgkmcnt(6)
  ds_read_b64_tr_b16 a[60:61], v3 offset:41984
  ds_read_b64_tr_b16 a[62:63], v3 offset:46080
  v_mfma_f32_16x16x32_bf16 v[64:67], a[32:35], a[160:163], v[64:67]
  ds_read_b64_tr_b16 a[0:1], v0 offset:49152
  s_add_u32 m0, s79, 8192
  v_mfma_f32_16x16x32_bf16 v[64:67], a[48:51], a[168:171], v[64:67]
  s_add_u32 s92, s92, 262144
  ds_read_b64_tr_b16 a[2:3], v0 offset:53248
  s_add_u32 s93, s92, s89
  v_mfma_f32_16x16x32_bf16 v[68:71], a[48:51], a[172:175], v[68:71]
  buffer_load_dwordx4 v252, s[80:83], s93 offen lds
  v_mfma_f32_16x16x32_bf16 v[68:71], a[32:35], a[164:167], v[68:71]
  ds_read_b64_tr_b16 a[16:17], v0 offset:57344
  ds_read_b64_tr_b16 a[18:19], v0 offset:61440
  v_mfma_f32_16x16x32_bf16 v[76:79], a[36:39], a[164:167], v[76:79]
  ds_read_b64_tr_b16 a[4:5], v1 offset:49152
  v_mfma_f32_16x16x32_bf16 v[76:79], a[52:55], a[172:175], v[76:79]
  ds_read_b64_tr_b16 a[6:7], v1 offset:53248
  v_mfma_f32_16x16x32_bf16 v[72:75], a[52:55], a[168:171], v[72:75]
  buffer_load_dwordx4 v252, s[84:87], s93 offen offset:1024 lds
  v_mfma_f32_16x16x32_bf16 v[72:75], a[36:39], a[160:163], v[72:75]
  s_waitcnt lgkmcnt(6)
  ds_read_b64_tr_b16 a[20:21], v1 offset:57344
  ds_read_b64_tr_b16 a[22:23], v1 offset:61440
  v_mfma_f32_16x16x32_bf16 v[80:83], a[40:43], a[160:163], v[80:83]
  ds_read_b64_tr_b16 a[8:9], v2 offset:49152
  v_mfma_f32_16x16x32_bf16 v[80:83], a[56:59], a[168:171], v[80:83]
  s_min_u32 s63, s89, 4096
  ds_read_b64_tr_b16 a[10:11], v2 offset:53248
  s_add_u32 s63, s63, s48
  v_mfma_f32_16x16x32_bf16 v[84:87], a[56:59], a[172:175], v[84:87]
  buffer_load_dwordx4 a[232:235], v8, s[4:7], s63 offen offset:1024 sc1
  v_mfma_f32_16x16x32_bf16 v[84:87], a[40:43], a[164:167], v[84:87]
  ds_read_b64_tr_b16 a[24:25], v2 offset:57344
  ds_read_b64_tr_b16 a[26:27], v2 offset:61440
  v_mfma_f32_16x16x32_bf16 v[92:95], a[44:47], a[164:167], v[92:95]
  ds_read_b64_tr_b16 a[12:13], v3 offset:49152
  v_mfma_f32_16x16x32_bf16 v[92:95], a[60:63], a[172:175], v[92:95]
  ds_read_b64_tr_b16 a[14:15], v3 offset:53248
  v_mfma_f32_16x16x32_bf16 v[88:91], a[60:63], a[168:171], v[88:91]
  buffer_load_dwordx4 a[236:239], v9, s[4:7], s63 offen offset:1024 sc1
  v_mfma_f32_16x16x32_bf16 v[88:91], a[44:47], a[160:163], v[88:91]
  s_waitcnt vmcnt(25) lgkmcnt(6)
  ds_read_b64_tr_b16 a[28:29], v3 offset:57344
  ds_read_b64_tr_b16 a[30:31], v3 offset:61440
  v_mfma_f32_16x16x32_bf16 v[32:35], a[0:3], a[176:179], v[32:35]
  ds_read_b64_tr_b16 a[32:33], v0 offset:50176
  s_add_u32 m0, s79, 16384
  v_mfma_f32_16x16x32_bf16 v[32:35], a[16:19], a[184:187], v[32:35]
  s_add_u32 s92, s92, 196608
  ds_read_b64_tr_b16 a[34:35], v0 offset:54272
  s_add_u32 s93, s92, s90
  v_mfma_f32_16x16x32_bf16 v[36:39], a[16:19], a[188:191], v[36:39]
  buffer_load_dwordx4 v252, s[80:83], s93 offen lds
  v_mfma_f32_16x16x32_bf16 v[36:39], a[0:3], a[180:183], v[36:39]
  ds_read_b64_tr_b16 a[48:49], v0 offset:58368
  ds_read_b64_tr_b16 a[50:51], v0 offset:62464
  v_mfma_f32_16x16x32_bf16 v[44:47], a[4:7], a[180:183], v[44:47]
  ds_read_b64_tr_b16 a[36:37], v1 offset:50176
  v_mfma_f32_16x16x32_bf16 v[44:47], a[20:23], a[188:191], v[44:47]
  ds_read_b64_tr_b16 a[38:39], v1 offset:54272
  v_mfma_f32_16x16x32_bf16 v[40:43], a[20:23], a[184:187], v[40:43]
  buffer_load_dwordx4 v252, s[84:87], s93 offen offset:1024 lds
  v_mfma_f32_16x16x32_bf16 v[40:43], a[4:7], a[176:179], v[40:43]
  s_waitcnt lgkmcnt(6)
  ds_read_b64_tr_b16 a[52:53], v1 offset:58368
  ds_read_b64_tr_b16 a[54:55], v1 offset:62464
  v_mfma_f32_16x16x32_bf16 v[48:51], a[8:11], a[176:179], v[48:51]
  ds_read_b64_tr_b16 a[40:41], v2 offset:50176
  v_mfma_f32_16x16x32_bf16 v[48:51], a[24:27], a[184:187], v[48:51]
  s_min_u32 s63, s90, 4096
  ds_read_b64_tr_b16 a[42:43], v2 offset:54272
  s_add_u32 s63, s63, s48
  v_mfma_f32_16x16x32_bf16 v[52:55], a[24:27], a[188:191], v[52:55]
  buffer_load_dwordx4 a[240:243], v8, s[4:7], s63 offen offset:2048 sc1
  v_mfma_f32_16x16x32_bf16 v[52:55], a[8:11], a[180:183], v[52:55]
  ds_read_b64_tr_b16 a[56:57], v2 offset:58368
  ds_read_b64_tr_b16 a[58:59], v2 offset:62464
  v_mfma_f32_16x16x32_bf16 v[60:63], a[12:15], a[180:183], v[60:63]
  ds_read_b64_tr_b16 a[44:45], v3 offset:50176
  v_mfma_f32_16x16x32_bf16 v[60:63], a[28:31], a[188:191], v[60:63]
  ds_read_b64_tr_b16 a[46:47], v3 offset:54272
  v_mfma_f32_16x16x32_bf16 v[56:59], a[28:31], a[184:187], v[56:59]
  buffer_load_dwordx4 a[244:247], v9, s[4:7], s63 offen offset:2048 sc1
  v_mfma_f32_16x16x32_bf16 v[56:59], a[12:15], a[176:179], v[56:59]
  s_waitcnt lgkmcnt(6)
  ds_read_b64_tr_b16 a[60:61], v3 offset:58368
  ds_read_b64_tr_b16 a[62:63], v3 offset:62464
  v_mfma_f32_16x16x32_bf16 v[64:67], a[32:35], a[176:179], v[64:67]
  ds_read_b64_tr_b16 a[0:1], v4 offset:0
  s_add_u32 m0, s79, 24576
  v_mfma_f32_16x16x32_bf16 v[64:67], a[48:51], a[184:187], v[64:67]
  s_add_u32 s92, s92, 262144
  ds_read_b64_tr_b16 a[2:3], v4 offset:4096
  s_add_u32 s93, s92, s91
  v_mfma_f32_16x16x32_bf16 v[68:71], a[48:51], a[188:191], v[68:71]
  buffer_load_dwordx4 v252, s[80:83], s93 offen lds
  v_mfma_f32_16x16x32_bf16 v[68:71], a[32:35], a[180:183], v[68:71]
  ds_read_b64_tr_b16 a[16:17], v4 offset:8192
  ds_read_b64_tr_b16 a[18:19], v4 offset:12288
  v_mfma_f32_16x16x32_bf16 v[76:79], a[36:39], a[180:183], v[76:79]
  ds_read_b64_tr_b16 a[4:5], v5 offset:0
  v_mfma_f32_16x16x32_bf16 v[76:79], a[52:55], a[188:191], v[76:79]
  ds_read_b64_tr_b16 a[6:7], v5 offset:4096
  v_mfma_f32_16x16x32_bf16 v[72:75], a[52:55], a[184:187], v[72:75]
  buffer_load_dwordx4 v252, s[84:87], s93 offen offset:1024 lds
  v_mfma_f32_16x16x32_bf16 v[72:75], a[36:39], a[176:179], v[72:75]
  s_waitcnt lgkmcnt(6)
  ds_read_b64_tr_b16 a[20:21], v5 offset:8192
  ds_read_b64_tr_b16 a[22:23], v5 offset:12288
  v_mfma_f32_16x16x32_bf16 v[80:83], a[40:43], a[176:179], v[80:83]
  ds_read_b64_tr_b16 a[8:9], v6 offset:0
  v_mfma_f32_16x16x32_bf16 v[80:83], a[56:59], a[184:187], v[80:83]
  s_min_u32 s63, s91, 4096
  ds_read_b64_tr_b16 a[10:11], v6 offset:4096
  s_add_u32 s63, s63, s48
  v_mfma_f32_16x16x32_bf16 v[84:87], a[56:59], a[188:191], v[84:87]
  buffer_load_dwordx4 a[248:251], v8, s[4:7], s63 offen offset:3072 sc1
  v_mfma_f32_16x16x32_bf16 v[84:87], a[40:43], a[180:183], v[84:87]
  ds_read_b64_tr_b16 a[24:25], v6 offset:8192
  ds_read_b64_tr_b16 a[26:27], v6 offset:12288
  v_mfma_f32_16x16x32_bf16 v[92:95], a[44:47], a[180:183], v[92:95]
  ds_read_b64_tr_b16 a[12:13], v7 offset:0
  v_mfma_f32_16x16x32_bf16 v[92:95], a[60:63], a[188:191], v[92:95]
  ds_read_b64_tr_b16 a[14:15], v7 offset:4096
  v_mfma_f32_16x16x32_bf16 v[88:91], a[60:63], a[184:187], v[88:91]
  buffer_load_dwordx4 a[252:255], v9, s[4:7], s63 offen offset:3072 sc1
  v_mfma_f32_16x16x32_bf16 v[88:91], a[44:47], a[176:179], v[88:91]
  s_waitcnt vmcnt(24) lgkmcnt(6)
  ds_read_b64_tr_b16 a[28:29], v7 offset:8192
  ds_read_b64_tr_b16 a[30:31], v7 offset:12288
  v_mfma_f32_16x16x32_bf16 v[32:35], a[0:3], a[192:195], v[32:35]
  s_waitcnt vmcnt(26)
  s_barrier
  s_xor_b32 s43, s56, 2
  s_or_b32 s43, s43, s40
  s_cbranch_scc0 Lp3_sgl_c
Lp3_sgl_r:
  ds_read_b64_tr_b16 a[32:33], v4 offset:1024
  v_mfma_f32_16x16x32_bf16 v[32:35], a[16:19], a[200:203], v[32:35]
  s_add_u32 m0, s79, 32768
  ds_read_b64_tr_b16 a[34:35], v4 offset:5120
  s_add_u32 s92, s92, 196608
  v_mfma_f32_16x16x32_bf16 v[36:39], a[16:19], a[204:207], v[36:39]
  s_add_u32 s93, s92, s88
  buffer_load_dwordx4 v252, s[80:83], s93 offen lds
  v_mfma_f32_16x16x32_bf16 v[36:39], a[0:3], a[196:199], v[36:39]
  ds_read_b64_tr_b16 a[48:49], v4 offset:9216
  ds_read_b64_tr_b16 a[50:51], v4 offset:13312
  v_mfma_f32_16x16x32_bf16 v[44:47], a[4:7], a[196:199], v[44:47]
  ds_read_b64_tr_b16 a[36:37], v5 offset:1024
  v_mfma_f32_16x16x32_bf16 v[44:47], a[20:23], a[204:207], v[44:47]
  ds_read_b64_tr_b16 a[38:39], v5 offset:5120
  v_mfma_f32_16x16x32_bf16 v[40:43], a[20:23], a[200:203], v[40:43]
  buffer_load_dwordx4 v252, s[84:87], s93 offen offset:1024 lds
  v_mfma_f32_16x16x32_bf16 v[40:43], a[4:7], a[192:195], v[40:43]
  s_waitcnt lgkmcnt(6)
  ds_read_b64_tr_b16 a[52:53], v5 offset:9216
  ds_read_b64_tr_b16 a[54:55], v5 offset:13312
  v_mfma_f32_16x16x32_bf16 v[48:51], a[8:11], a[192:195], v[48:51]
  ds_read_b64_tr_b16 a[40:41], v6 offset:1024
  v_mfma_f32_16x16x32_bf16 v[48:51], a[24:27], a[200:203], v[48:51]
  s_add_u32 s48, s48, 4096
  ds_read_b64_tr_b16 a[42:43], v6 offset:5120
  s_min_u32 s63, s88, 4096
  v_mfma_f32_16x16x32_bf16 v[52:55], a[24:27], a[204:207], v[52:55]
  s_add_u32 s63, s63, s48
  buffer_load_dwordx4 a[128:131], v8, s[4:7], s63 offen offset:0 sc1
  v_mfma_f32_16x16x32_bf16 v[52:55], a[8:11], a[196:199], v[52:55]
  ds_read_b64_tr_b16 a[56:57], v6 offset:9216
  ds_read_b64_tr_b16 a[58:59], v6 offset:13312
  v_mfma_f32_16x16x32_bf16 v[60:63], a[12:15], a[196:199], v[60:63]
  ds_read_b64_tr_b16 a[44:45], v7 offset:1024
  v_mfma_f32_16x16x32_bf16 v[60:63], a[28:31], a[204:207], v[60:63]
  ds_read_b64_tr_b16 a[46:47], v7 offset:5120
  v_mfma_f32_16x16x32_bf16 v[56:59], a[28:31], a[200:203], v[56:59]
  buffer_load_dwordx4 a[132:135], v9, s[4:7], s63 offen offset:0 sc1
  v_mfma_f32_16x16x32_bf16 v[56:59], a[12:15], a[192:195], v[56:59]
  s_waitcnt lgkmcnt(6)
  ds_read_b64_tr_b16 a[60:61], v7 offset:9216
  ds_read_b64_tr_b16 a[62:63], v7 offset:13312
  v_mfma_f32_16x16x32_bf16 v[64:67], a[32:35], a[192:195], v[64:67]
  ds_read_b64_tr_b16 a[0:1], v4 offset:16384
  s_add_u32 m0, s79, 40960
  v_mfma_f32_16x16x32_bf16 v[64:67], a[48:51], a[200:203], v[64:67]
  s_add_u32 s92, s92, 262144
  ds_read_b64_tr_b16 a[2:3], v4 offset:20480
  s_add_u32 s93, s92, s89
  v_mfma_f32_16x16x32_bf16 v[68:71], a[48:51], a[204:207], v[68:71]
  buffer_load_dwordx4 v252, s[80:83], s93 offen lds
  v_mfma_f32_16x16x32_bf16 v[68:71], a[32:35], a[196:199], v[68:71]
  ds_read_b64_tr_b16 a[16:17], v4 offset:24576
  ds_read_b64_tr_b16 a[18:19], v4 offset:28672
  v_mfma_f32_16x16x32_bf16 v[76:79], a[36:39], a[196:199], v[76:79]
  ds_read_b64_tr_b16 a[4:5], v5 offset:16384
  v_mfma_f32_16x16x32_bf16 v[76:79], a[52:55], a[204:207], v[76:79]
  ds_read_b64_tr_b16 a[6:7], v5 offset:20480
  v_mfma_f32_16x16x32_bf16 v[72:75], a[52:55], a[200:203], v[72:75]
  buffer_load_dwordx4 v252, s[84:87], s93 offen offset:1024 lds
  v_mfma_f32_16x16x32_bf16 v[72:75], a[36:39], a[192:195], v[72:75]
  s_waitcnt lgkmcnt(6)
  ds_read_b64_tr_b16 a[20:21], v5 offset:24576
  ds_read_b64_tr_b16 a[22:23], v5 offset:28672
  v_mfma_f32_16x16x32_bf16 v[80:83], a[40:43], a[192:195], v[80:83]
  ds_read_b64_tr_b16 a[8:9], v6 offset:16384
  v_mfma_f32_16x16x32_bf16 v[80:83], a[56:59], a[200:203], v[80:83]
  s_min_u32 s63, s89, 4096
  ds_read_b64_tr_b16 a[10:11], v6 offset:20480
  s_add_u32 s63, s63, s48
  v_mfma_f32_16x16x32_bf16 v[84:87], a[56:59], a[204:207], v[84:87]
  buffer_load_dwordx4 a[136:139], v8, s[4:7], s63 offen offset:1024 sc1
  v_mfma_f32_16x16x32_bf16 v[84:87], a[40:43], a[196:199], v[84:87]
  ds_read_b64_tr_b16 a[24:25], v6 offset:24576
  ds_read_b64_tr_b16 a[26:27], v6 offset:28672
  v_mfma_f32_16x16x32_bf16 v[92:95], a[44:47], a[196:199], v[92:95]
  ds_read_b64_tr_b16 a[12:13], v7 offset:16384
  v_mfma_f32_16x16x32_bf16 v[92:95], a[60:63], a[204:207], v[92:95]
  ds_read_b64_tr_b16 a[14:15], v7 offset:20480
  v_mfma_f32_16x16x32_bf16 v[88:91], a[60:63], a[200:203], v[88:91]
  buffer_load_dwordx4 a[140:143], v9, s[4:7], s63 offen offset:1024 sc1
  v_mfma_f32_16x16x32_bf16 v[88:91], a[44:47], a[192:195], v[88:91]
  s_waitcnt vmcnt(24) lgkmcnt(6)
  ds_read_b64_tr_b16 a[28:29], v7 offset:24576
  ds_read_b64_tr_b16 a[30:31], v7 offset:28672
  v_mfma_f32_16x16x32_bf16 v[32:35], a[0:3], a[208:211], v[32:35]
  ds_read_b64_tr_b16 a[32:33], v4 offset:17408
  s_add_u32 m0, s79, 49152
  v_mfma_f32_16x16x32_bf16 v[32:35], a[16:19], a[216:219], v[32:35]
  s_add_u32 s92, s92, 196608
  ds_read_b64_tr_b16 a[34:35], v4 offset:21504
  s_add_u32 s93, s92, s90
  v_mfma_f32_16x16x32_bf16 v[36:39], a[16:19], a[220:223], v[36:39]
  buffer_load_dwordx4 v252, s[80:83], s93 offen lds
  v_mfma_f32_16x16x32_bf16 v[36:39], a[0:3], a[212:215], v[36:39]
  ds_read_b64_tr_b16 a[48:49], v4 offset:25600
  ds_read_b64_tr_b16 a[50:51], v4 offset:29696
  v_mfma_f32_16x16x32_bf16 v[44:47], a[4:7], a[212:215], v[44:47]
  ds_read_b64_tr_b16 a[36:37], v5 offset:17408
  v_mfma_f32_16x16x32_bf16 v[44:47], a[20:23], a[220:223], v[44:47]
  ds_read_b64_tr_b16 a[38:39], v5 offset:21504
  v_mfma_f32_16x16x32_bf16 v[40:43], a[20:23], a[216:219], v[40:43]
  buffer_load_dwordx4 v252, s[84:87], s93 offen offset:1024 lds
  v_mfma_f32_16x16x32_bf16 v[40:43], a[4:7], a[208:211], v[40:43]
  s_waitcnt lgkmcnt(6)
  ds_read_b64_tr_b16 a[52:53], v5 offset:25600
  ds_read_b64_tr_b16 a[54:55], v5 offset:29696
  v_mfma_f32_16x16x32_bf16 v[48:51], a[8:11], a[208:211], v[48:51]
  ds_read_b64_tr_b16 a[40:41], v6 offset:17408
  v_mfma_f32_16x16x32_bf16 v[48:51], a[24:27], a[216:219], v[48:51]
  s_min_u32 s63, s90, 4096
  ds_read_b64_tr_b16 a[42:43], v6 offset:21504
  s_add_u32 s63, s63, s48
  v_mfma_f32_16x16x32_bf16 v[52:55], a[24:27], a[220:223], v[52:55]
  buffer_load_dwordx4 a[144:147], v8, s[4:7], s63 offen offset:2048 sc1
  v_mfma_f32_16x16x32_bf16 v[52:55], a[8:11], a[212:215], v[52:55]
  ds_read_b64_tr_b16 a[56:57], v6 offset:25600
  ds_read_b64_tr_b16 a[58:59], v6 offset:29696
  v_mfma_f32_16x16x32_bf16 v[60:63], a[12:15], a[212:215], v[60:63]
  ds_read_b64_tr_b16 a[44:45], v7 offset:17408
  v_mfma_f32_16x16x32_bf16 v[60:63], a[28:31], a[220:223], v[60:63]
  ds_read_b64_tr_b16 a[46:47], v7 offset:21504
  v_mfma_f32_16x16x32_bf16 v[56:59], a[28:31], a[216:219], v[56:59]
  buffer_load_dwordx4 a[148:151], v9, s[4:7], s63 offen offset:2048 sc1
  v_mfma_f32_16x16x32_bf16 v[56:59], a[12:15], a[208:211], v[56:59]
  s_waitcnt lgkmcnt(6)
  ds_read_b64_tr_b16 a[60:61], v7 offset:25600
  ds_read_b64_tr_b16 a[62:63], v7 offset:29696
  v_mfma_f32_16x16x32_bf16 v[64:67], a[32:35], a[208:211], v[64:67]
  ds_read_b64_tr_b16 a[0:1], v4 offset:32768
  s_add_u32 m0, s79, 57344
  v_mfma_f32_16x16x32_bf16 v[64:67], a[48:51], a[216:219], v[64:67]
  s_add_u32 s92, s92, 262144
  ds_read_b64_tr_b16 a[2:3], v4 offset:36864
  s_add_u32 s93, s92, s91
  v_mfma_f32_16x16x32_bf16 v[68:71], a[48:51], a[220:223], v[68:71]
  buffer_load_dwordx4 v252, s[80:83], s93 offen lds
  v_mfma_f32_16x16x32_bf16 v[68:71], a[32:35], a[212:215], v[68:71]
  ds_read_b64_tr_b16 a[16:17], v4 offset:40960
  ds_read_b64_tr_b16 a[18:19], v4 offset:45056
  v_mfma_f32_16x16x32_bf16 v[76:79], a[36:39], a[212:215], v[76:79]
  ds_read_b64_tr_b16 a[4:5], v5 offset:32768
  v_mfma_f32_16x16x32_bf16 v[76:79], a[52:55], a[220:223], v[76:79]
  ds_read_b64_tr_b16 a[6:7], v5 offset:36864
  v_mfma_f32_16x16x32_bf16 v[72:75], a[52:55], a[216:219], v[72:75]
  buffer_load_dwordx4 v252, s[84:87], s93 offen offset:1024 lds
  v_mfma_f32_16x16x32_bf16 v[72:75], a[36:39], a[208:211], v[72:75]
  s_waitcnt lgkmcnt(6)
  ds_read_b64_tr_b16 a[20:21], v5 offset:40960
  ds_read_b64_tr_b16 a[22:23], v5 offset:45056
  v_mfma_f32_16x16x32_bf16 v[80:83], a[40:43], a[208:211], v[80:83]
  ds_read_b64_tr_b16 a[8:9], v6 offset:32768
  v_mfma_f32_16x16x32_bf16 v[80:83], a[56:59], a[216:219], v[80:83]
  s_min_u32 s63, s91, 4096
  ds_read_b64_tr_b16 a[10:11], v6 offset:36864
  s_add_u32 s63, s63, s48
  v_mfma_f32_16x16x32_bf16 v[84:87], a[56:59], a[220:223], v[84:87]
  buffer_load_dwordx4 a[152:155], v8, s[4:7], s63 offen offset:3072 sc1
  v_mfma_f32_16x16x32_bf16 v[84:87], a[40:43], a[212:215], v[84:87]
  ds_read_b64_tr_b16 a[24:25], v6 offset:40960
  ds_read_b64_tr_b16 a[26:27], v6 offset:45056
  v_mfma_f32_16x16x32_bf16 v[92:95], a[44:47], a[212:215], v[92:95]
  ds_read_b64_tr_b16 a[12:13], v7 offset:32768
  v_mfma_f32_16x16x32_bf16 v[92:95], a[60:63], a[220:223], v[92:95]
  ds_read_b64_tr_b16 a[14:15], v7 offset:36864
  v_mfma_f32_16x16x32_bf16 v[88:91], a[60:63], a[216:219], v[88:91]
  buffer_load_dwordx4 a[156:159], v9, s[4:7], s63 offen offset:3072 sc1
  v_mfma_f32_16x16x32_bf16 v[88:91], a[44:47], a[208:211], v[88:91]
  s_waitcnt vmcnt(24) lgkmcnt(6)
  ds_read_b64_tr_b16 a[28:29], v7 offset:40960
  ds_read_b64_tr_b16 a[30:31], v7 offset:45056
  v_mfma_f32_16x16x32_bf16 v[32:35], a[0:3], a[224:227], v[32:35]
  s_waitcnt vmcnt(26)
  s_barrier
  ds_read_b64_tr_b16 a[32:33], v4 offset:33792
  v_mfma_f32_16x16x32_bf16 v[32:35], a[16:19], a[232:235], v[32:35]
  s_add_u32 m0, s79, 65536
  ds_read_b64_tr_b16 a[34:35], v4 offset:37888
  s_add_u32 s92, s92, 196608
  v_mfma_f32_16x16x32_bf16 v[36:39], a[16:19], a[236:239], v[36:39]
  s_add_u32 s93, s92, s88
  buffer_load_dwordx4 v252, s[80:83], s93 offen lds
  v_mfma_f32_16x16x32_bf16 v[36:39], a[0:3], a[228:231], v[36:39]
  ds_read_b64_tr_b16 a[48:49], v4 offset:41984
  ds_read_b64_tr_b16 a[50:51], v4 offset:46080
  v_mfma_f32_16x16x32_bf16 v[44:47], a[4:7], a[228:231], v[44:47]
  ds_read_b64_tr_b16 a[36:37], v5 offset:33792
  v_mfma_f32_16x16x32_bf16 v[44:47], a[20:23], a[236:239], v[44:47]
  ds_read_b64_tr_b16 a[38:39], v5 offset:37888
  v_mfma_f32_16x16x32_bf16 v[40:43], a[20:23], a[232:235], v[40:43]
  buffer_load_dwordx4 v252, s[84:87], s93 offen offset:1024 lds
  v_mfma_f32_16x16x32_bf16 v[40:43], a[4:7], a[224:227], v[40:43]
  s_waitcnt lgkmcnt(6)
  ds_read_b64_tr_b16 a[52:53], v5 offset:41984
  ds_read_b64_tr_b16 a[54:55], v5 offset:46080
  v_mfma_f32_16x16x32_bf16 v[48:51], a[8:11], a[224:227], v[48:51]
  ds_read_b64_tr_b16 a[40:41], v6 offset:33792
  v_mfma_f32_16x16x32_bf16 v[48:51], a[24:27], a[232:235], v[48:51]
  s_add_u32 s48, s48, 4096
  ds_read_b64_tr_b16 a[42:43], v6 offset:37888
  s_min_u32 s63, s88, 4096
  v_mfma_f32_16x16x32_bf16 v[52:55], a[24:27], a[236:239], v[52:55]
  s_add_u32 s63, s63, s48
  buffer_load_dwordx4 a[160:163], v8, s[4:7], s63 offen offset:0 sc1
  v_mfma_f32_16x16x32_bf16 v[52:55], a[8:11], a[228:231], v[52:55]
  ds_read_b64_tr_b16 a[56:57], v6 offset:41984
  ds_read_b64_tr_b16 a[58:59], v6 offset:46080
  v_mfma_f32_16x16x32_bf16 v[60:63], a[12:15], a[228:231], v[60:63]
  ds_read_b64_tr_b16 a[44:45], v7 offset:33792
  v_mfma_f32_16x16x32_bf16 v[60:63], a[28:31], a[236:239], v[60:63]
  ds_read_b64_tr_b16 a[46:47], v7 offset:37888
  v_mfma_f32_16x16x32_bf16 v[56:59], a[28:31], a[232:235], v[56:59]
  buffer_load_dwordx4 a[164:167], v9, s[4:7], s63 offen offset:0 sc1
  v_mfma_f32_16x16x32_bf16 v[56:59], a[12:15], a[224:227], v[56:59]
  s_waitcnt lgkmcnt(6)
  ds_read_b64_tr_b16 a[60:61], v7 offset:41984
  ds_read_b64_tr_b16 a[62:63], v7 offset:46080
  v_mfma_f32_16x16x32_bf16 v[64:67], a[32:35], a[224:227], v[64:67]
  ds_read_b64_tr_b16 a[0:1], v4 offset:49152
  s_add_u32 m0, s79, 73728
  v_mfma_f32_16x16x32_bf16 v[64:67], a[48:51], a[232:235], v[64:67]
  s_add_u32 s92, s92, 262144
  ds_read_b64_tr_b16 a[2:3], v4 offset:53248
  s_add_u32 s93, s92, s89
  v_mfma_f32_16x16x32_bf16 v[68:71], a[48:51], a[236:239], v[68:71]
  buffer_load_dwordx4 v252, s[80:83], s93 offen lds
  v_mfma_f32_16x16x32_bf16 v[68:71], a[32:35], a[228:231], v[68:71]
  ds_read_b64_tr_b16 a[16:17], v4 offset:57344
  ds_read_b64_tr_b16 a[18:19], v4 offset:61440
  v_mfma_f32_16x16x32_bf16 v[76:79], a[36:39], a[228:231], v[76:79]
  ds_read_b64_tr_b16 a[4:5], v5 offset:49152
  v_mfma_f32_16x16x32_bf16 v[76:79], a[52:55], a[236:239], v[76:79]
  ds_read_b64_tr_b16 a[6:7], v5 offset:53248
  v_mfma_f32_16x16x32_bf16 v[72:75], a[52:55], a[232:235], v[72:75]
  buffer_load_dwordx4 v252, s[84:87], s93 offen offset:1024 lds
  v_mfma_f32_16x16x32_bf16 v[72:75], a[36:39], a[224:227], v[72:75]
  s_waitcnt lgkmcnt(6)
  ds_read_b64_tr_b16 a[20:21], v5 offset:57344
  ds_read_b64_tr_b16 a[22:23], v5 offset:61440
  v_mfma_f32_16x16x32_bf16 v[80:83], a[40:43], a[224:227], v[80:83]
  ds_read_b64_tr_b16 a[8:9], v6 offset:49152
  v_mfma_f32_16x16x32_bf16 v[80:83], a[56:59], a[232:235], v[80:83]
  s_min_u32 s63, s89, 4096
  ds_read_b64_tr_b16 a[10:11], v6 offset:53248
  s_add_u32 s63, s63, s48
  v_mfma_f32_16x16x32_bf16 v[84:87], a[56:59], a[236:239], v[84:87]
  buffer_load_dwordx4 a[168:171], v8, s[4:7], s63 offen offset:1024 sc1
  v_mfma_f32_16x16x32_bf16 v[84:87], a[40:43], a[228:231], v[84:87]
  ds_read_b64_tr_b16 a[24:25], v6 offset:57344
  ds_read_b64_tr_b16 a[26:27], v6 offset:61440
  v_mfma_f32_16x16x32_bf16 v[92:95], a[44:47], a[228:231], v[92:95]
  ds_read_b64_tr_b16 a[12:13], v7 offset:49152
  v_mfma_f32_16x16x32_bf16 v[92:95], a[60:63], a[236:239], v[92:95]
  ds_read_b64_tr_b16 a[14:15], v7 offset:53248
  v_mfma_f32_16x16x32_bf16 v[88:91], a[60:63], a[232:235], v[88:91]
  buffer_load_dwordx4 a[172:175], v9, s[4:7], s63 offen offset:1024 sc1
  v_mfma_f32_16x16x32_bf16 v[88:91], a[44:47], a[224:227], v[88:91]
  s_waitcnt vmcnt(24) lgkmcnt(6)
  ds_read_b64_tr_b16 a[28:29], v7 offset:57344
  ds_read_b64_tr_b16 a[30:31], v7 offset:61440
  v_mfma_f32_16x16x32_bf16 v[32:35], a[0:3], a[240:243], v[32:35]
  ds_read_b64_tr_b16 a[32:33], v4 offset:50176
  s_add_u32 m0, s79, 81920
  v_mfma_f32_16x16x32_bf16 v[32:35], a[16:19], a[248:251], v[32:35]
  s_add_u32 s92, s92, 196608
  ds_read_b64_tr_b16 a[34:35], v4 offset:54272
  s_add_u32 s93, s92, s90
  v_mfma_f32_16x16x32_bf16 v[36:39], a[16:19], a[252:255], v[36:39]
  buffer_load_dwordx4 v252, s[80:83], s93 offen lds
  v_mfma_f32_16x16x32_bf16 v[36:39], a[0:3], a[244:247], v[36:39]
  ds_read_b64_tr_b16 a[48:49], v4 offset:58368
  ds_read_b64_tr_b16 a[50:51], v4 offset:62464
  v_mfma_f32_16x16x32_bf16 v[44:47], a[4:7], a[244:247], v[44:47]
  ds_read_b64_tr_b16 a[36:37], v5 offset:50176
  v_mfma_f32_16x16x32_bf16 v[44:47], a[20:23], a[252:255], v[44:47]
  ds_read_b64_tr_b16 a[38:39], v5 offset:54272
  v_mfma_f32_16x16x32_bf16 v[40:43], a[20:23], a[248:251], v[40:43]
  buffer_load_dwordx4 v252, s[84:87], s93 offen offset:1024 lds
  v_mfma_f32_16x16x32_bf16 v[40:43], a[4:7], a[240:243], v[40:43]
  s_waitcnt lgkmcnt(6)
  ds_read_b64_tr_b16 a[52:53], v5 offset:58368
  ds_read_b64_tr_b16 a[54:55], v5 offset:62464
  v_mfma_f32_16x16x32_bf16 v[48:51], a[8:11], a[240:243], v[48:51]
  ds_read_b64_tr_b16 a[40:41], v6 offset:50176
  v_mfma_f32_16x16x32_bf16 v[48:51], a[24:27], a[248:251], v[48:51]
  s_min_u32 s63, s90, 4096
  ds_read_b64_tr_b16 a[42:43], v6 offset:54272
  s_add_u32 s63, s63, s48
  v_mfma_f32_16x16x32_bf16 v[52:55], a[24:27], a[252:255], v[52:55]
  buffer_load_dwordx4 a[176:179], v8, s[4:7], s63 offen offset:2048 sc1
  v_mfma_f32_16x16x32_bf16 v[52:55], a[8:11], a[244:247], v[52:55]
  ds_read_b64_tr_b16 a[56:57], v6 offset:58368
  ds_read_b64_tr_b16 a[58:59], v6 offset:62464
  v_mfma_f32_16x16x32_bf16 v[60:63], a[12:15], a[244:247], v[60:63]
  ds_read_b64_tr_b16 a[44:45], v7 offset:50176
  v_mfma_f32_16x16x32_bf16 v[60:63], a[28:31], a[252:255], v[60:63]
  ds_read_b64_tr_b16 a[46:47], v7 offset:54272
  v_mfma_f32_16x16x32_bf16 v[56:59], a[28:31], a[248:251], v[56:59]
  buffer_load_dwordx4 a[180:183], v9, s[4:7], s63 offen offset:2048 sc1
  v_mfma_f32_16x16x32_bf16 v[56:59], a[12:15], a[240:243], v[56:59]
  s_waitcnt lgkmcnt(6)
  ds_read_b64_tr_b16 a[60:61], v7 offset:58368
  ds_read_b64_tr_b16 a[62:63], v7 offset:62464
  v_mfma_f32_16x16x32_bf16 v[64:67], a[32:35], a[240:243], v[64:67]
  ds_read_b64_tr_b16 a[0:1], v0 offset:0
  s_add_u32 m0, s79, 90112
  v_mfma_f32_16x16x32_bf16 v[64:67], a[48:51], a[248:251], v[64:67]
  s_add_u32 s92, s92, 262144
  ds_read_b64_tr_b16 a[2:3], v0 offset:4096
  s_add_u32 s93, s92, s91
  v_mfma_f32_16x16x32_bf16 v[68:71], a[48:51], a[252:255], v[68:71]
  buffer_load_dwordx4 v252, s[80:83], s93 offen lds
  v_mfma_f32_16x16x32_bf16 v[68:71], a[32:35], a[244:247], v[68:71]
  ds_read_b64_tr_b16 a[16:17], v0 offset:8192
  ds_read_b64_tr_b16 a[18:19], v0 offset:12288
  v_mfma_f32_16x16x32_bf16 v[76:79], a[36:39], a[244:247], v[76:79]
  ds_read_b64_tr_b16 a[4:5], v1 offset:0
  v_mfma_f32_16x16x32_bf16 v[76:79], a[52:55], a[252:255], v[76:79]
  ds_read_b64_tr_b16 a[6:7], v1 offset:4096
  v_mfma_f32_16x16x32_bf16 v[72:75], a[52:55], a[248:251], v[72:75]
  buffer_load_dwordx4 v252, s[84:87], s93 offen offset:1024 lds
  v_mfma_f32_16x16x32_bf16 v[72:75], a[36:39], a[240:243], v[72:75]
  s_waitcnt lgkmcnt(6)
  ds_read_b64_tr_b16 a[20:21], v1 offset:8192
  ds_read_b64_tr_b16 a[22:23], v1 offset:12288
  v_mfma_f32_16x16x32_bf16 v[80:83], a[40:43], a[240:243], v[80:83]
  ds_read_b64_tr_b16 a[8:9], v2 offset:0
  v_mfma_f32_16x16x32_bf16 v[80:83], a[56:59], a[248:251], v[80:83]
  s_min_u32 s63, s91, 4096
  ds_read_b64_tr_b16 a[10:11], v2 offset:4096
  s_add_u32 s63, s63, s48
  v_mfma_f32_16x16x32_bf16 v[84:87], a[56:59], a[252:255], v[84:87]
  buffer_load_dwordx4 a[184:187], v8, s[4:7], s63 offen offset:3072 sc1
  v_mfma_f32_16x16x32_bf16 v[84:87], a[40:43], a[244:247], v[84:87]
  ds_read_b64_tr_b16 a[24:25], v2 offset:8192
  ds_read_b64_tr_b16 a[26:27], v2 offset:12288
  v_mfma_f32_16x16x32_bf16 v[92:95], a[44:47], a[244:247], v[92:95]
  ds_read_b64_tr_b16 a[12:13], v3 offset:0
  v_mfma_f32_16x16x32_bf16 v[92:95], a[60:63], a[252:255], v[92:95]
  s_sub_u32 s56, s56, 1
  ds_read_b64_tr_b16 a[14:15], v3 offset:4096
  v_mfma_f32_16x16x32_bf16 v[88:91], a[60:63], a[248:251], v[88:91]
  s_cmp_lg_u32 s56, 0
  buffer_load_dwordx4 a[188:191], v9, s[4:7], s63 offen offset:3072 sc1
  ds_read_b64_tr_b16 a[28:29], v3 offset:8192
  v_mfma_f32_16x16x32_bf16 v[88:91], a[44:47], a[240:243], v[88:91]
  ds_read_b64_tr_b16 a[30:31], v3 offset:12288
  s_cbranch_scc1 Lp4_loop
Lmk_Lp4_loop_tail:
  s_waitcnt vmcnt(24) lgkmcnt(8)
  v_mfma_f32_16x16x32_bf16 v[32:35], a[0:3], a[128:131], v[32:35]
  s_waitcnt vmcnt(26)
  s_barrier
  ds_read_b64_tr_b16 a[32:33], v0 offset:1024
  s_add_u32 m0, s79, 98304
  s_add_u32 s92, s92, 196608
  s_cmp_lg_u32 s88, 0
  s_cselect_b32 s93, -2686976, 0
  s_cselect_b32 s43, s78, 0
  v_mfma_f32_16x16x32_bf16 v[32:35], a[16:19], a[136:139], v[32:35]
  s_add_u32 s93, s93, s43
  ds_read_b64_tr_b16 a[34:35], v0 offset:5120
  s_add_u32 s93, s93, s92
  v_mfma_f32_16x16x32_bf16 v[36:39], a[16:19], a[140:143], v[36:39]
  buffer_load_dwordx4 v252, s[80:83], s93 offen lds
  v_mfma_f32_16x16x32_bf16 v[36:39], a[0:3], a[132:135], v[36:39]
  ds_read_b64_tr_b16 a[48:49], v0 offset:9216
  ds_read_b64_tr_b16 a[50:51], v0 offset:13312
  v_mfma_f32_16x16x32_bf16 v[44:47], a[4:7], a[132:135], v[44:47]
  ds_read_b64_tr_b16 a[36:37], v1 offset:1024
  v_mfma_f32_16x16x32_bf16 v[44:47], a[20:23], a[140:143], v[44:47]
  ds_read_b64_tr_b16 a[38:39], v1 offset:5120
  v_mfma_f32_16x16x32_bf16 v[40:43], a[20:23], a[136:139], v[40:43]
  buffer_load_dwordx4 v252, s[84:87], s93 offen offset:1024 lds
  v_mfma_f32_16x16x32_bf16 v[40:43], a[4:7], a[128:131], v[40:43]
  s_waitcnt lgkmcnt(6)
  ds_read_b64_tr_b16 a[52:53], v1 offset:9216
  ds_read_b64_tr_b16 a[54:55], v1 offset:13312
  v_mfma_f32_16x16x32_bf16 v[48:51], a[8:11], a[128:131], v[48:51]
  ds_read_b64_tr_b16 a[40:41], v2 offset:1024
  v_mfma_f32_16x16x32_bf16 v[48:51], a[24:27], a[136:139], v[48:51]
  s_add_u32 s48, s48, 4096
  ds_read_b64_tr_b16 a[42:43], v2 offset:5120
  s_min_u32 s63, s88, 4096
  v_mfma_f32_16x16x32_bf16 v[52:55], a[24:27], a[140:143], v[52:55]
  s_add_u32 s63, s63, s48
  buffer_load_dwordx4 a[192:195], v8, s[4:7], s63 offen offset:0 sc1
  v_mfma_f32_16x16x32_bf16 v[52:55], a[8:11], a[132:135], v[52:55]
  ds_read_b64_tr_b16 a[56:57], v2 offset:9216
  ds_read_b64_tr_b16 a[58:59], v2 offset:13312
  v_mfma_f32_16x16x32_bf16 v[60:63], a[12:15], a[132:135], v[60:63]
  ds_read_b64_tr_b16 a[44:45], v3 offset:1024
  v_mfma_f32_16x16x32_bf16 v[60:63], a[28:31], a[140:143], v[60:63]
  ds_read_b64_tr_b16 a[46:47], v3 offset:5120
  v_mfma_f32_16x16x32_bf16 v[56:59], a[28:31], a[136:139], v[56:59]
  buffer_load_dwordx4 a[196:199], v9, s[4:7], s63 offen offset:0 sc1
  v_mfma_f32_16x16x32_bf16 v[56:59], a[12:15], a[128:131], v[56:59]
  s_waitcnt lgkmcnt(6)
  ds_read_b64_tr_b16 a[60:61], v3 offset:9216
  ds_read_b64_tr_b16 a[62:63], v3 offset:13312
  v_mfma_f32_16x16x32_bf16 v[64:67], a[32:35], a[128:131], v[64:67]
  s_add_u32 m0, s79, 106496
  ds_read_b64_tr_b16 a[0:1], v0 offset:16384
  s_add_u32 s92, s92, 262144
  s_cmp_lg_u32 s89, 0
  s_cselect_b32 s93, -2490368, 0
  s_cselect_b32 s43, s78, 0
  v_mfma_f32_16x16x32_bf16 v[64:67], a[48:51], a[136:139], v[64:67]
  s_add_u32 s93, s93, s43
  ds_read_b64_tr_b16 a[2:3], v0 offset:20480
  s_add_u32 s93, s93, s92
  v_mfma_f32_16x16x32_bf16 v[68:71], a[48:51], a[140:143], v[68:71]
  buffer_load_dwordx4 v252, s[80:83], s93 offen lds
  v_mfma_f32_16x16x32_bf16 v[68:71], a[32:35], a[132:135], v[68:71]
  ds_read_b64_tr_b16 a[16:17], v0 offset:24576
  ds_read_b64_tr_b16 a[18:19], v0 offset:28672
  v_mfma_f32_16x16x32_bf16 v[76:79], a[36:39], a[132:135], v[76:79]
  ds_read_b64_tr_b16 a[4:5], v1 offset:16384
  v_mfma_f32_16x16x32_bf16 v[76:79], a[52:55], a[140:143], v[76:79]
  ds_read_b64_tr_b16 a[6:7], v1 offset:20480
  v_mfma_f32_16x16x32_bf16 v[72:75], a[52:55], a[136:139], v[72:75]
  buffer_load_dwordx4 v252, s[84:87], s93 offen offset:1024 lds
  v_mfma_f32_16x16x32_bf16 v[72:75], a[36:39], a[128:131], v[72:75]
  s_waitcnt lgkmcnt(6)
  ds_read_b64_tr_b16 a[20:21], v1 offset:24576
  ds_read_b64_tr_b16 a[22:23], v1 offset:28672
  v_mfma_f32_16x16x32_bf16 v[80:83], a[40:43], a[128:131], v[80:83]
  ds_read_b64_tr_b16 a[8:9], v2 offset:16384
  v_mfma_f32_16x16x32_bf16 v[80:83], a[56:59], a[136:139], v[80:83]
  s_min_u32 s63, s89, 4096
  ds_read_b64_tr_b16 a[10:11], v2 offset:20480
  s_add_u32 s63, s63, s48
  v_mfma_f32_16x16x32_bf16 v[84:87], a[56:59], a[140:143], v[84:87]
  buffer_load_dwordx4 a[200:203], v8, s[4:7], s63 offen offset:1024 sc1
  v_mfma_f32_16x16x32_bf16 v[84:87], a[40:43], a[132:135], v[84:87]
  ds_read_b64_tr_b16 a[24:25], v2 offset:24576
  ds_read_b64_tr_b16 a[26:27], v2 offset:28672
  v_mfma_f32_16x16x32_bf16 v[92:95], a[44:47], a[132:135], v[92:95]
  ds_read_b64_tr_b16 a[12:13], v3 offset:16384
  v_mfma_f32_16x16x32_bf16 v[92:95], a[60:63], a[140:143], v[92:95]
  ds_read_b64_tr_b16 a[14:15], v3 offset:20480
  v_mfma_f32_16x16x32_bf16 v[88:91], a[60:63], a[136:139], v[88:91]
  buffer_load_dwordx4 a[204:207], v9, s[4:7], s63 offen offset:1024 sc1
  v_mfma_f32_16x16x32_bf16 v[88:91], a[44:47], a[128:131], v[88:91]
  s_waitcnt vmcnt(24) lgkmcnt(6)
  ds_read_b64_tr_b16 a[28:29], v3 offset:24576
  ds_read_b64_tr_b16 a[30:31], v3 offset:28672
  v_mfma_f32_16x16x32_bf16 v[32:35], a[0:3], a[144:147], v[32:35]
  s_add_u32 m0, s79, 114688
  ds_read_b64_tr_b16 a[32:33], v0 offset:17408
  s_add_u32 s92, s92, 196608
  s_cmp_lg_u32 s90, 0
  s_cselect_b32 s93, -2228224, 0
  s_cselect_b32 s43, s78, 0
  v_mfma_f32_16x16x32_bf16 v[32:35], a[16:19], a[152:155], v[32:35]
  s_add_u32 s93, s93, s43
  ds_read_b64_tr_b16 a[34:35], v0 offset:21504
  s_add_u32 s93, s93, s92
  v_mfma_f32_16x16x32_bf16 v[36:39], a[16:19], a[156:159], v[36:39]
  buffer_load_dwordx4 v252, s[80:83], s93 offen lds
  v_mfma_f32_16x16x32_bf16 v[36:39], a[0:3], a[148:151], v[36:39]
  ds_read_b64_tr_b16 a[48:49], v0 offset:25600
  ds_read_b64_tr_b16 a[50:51], v0 offset:29696
  v_mfma_f32_16x16x32_bf16 v[44:47], a[4:7], a[148:151], v[44:47]
  ds_read_b64_tr_b16 a[36:37], v1 offset:17408
  v_mfma_f32_16x16x32_bf16 v[44:47], a[20:23], a[156:159], v[44:47]
  ds_read_b64_tr_b16 a[38:39], v1 offset:21504
  v_mfma_f32_16x16x32_bf16 v[40:43], a[20:23], a[152:155], v[40:43]
  buffer_load_dwordx4 v252, s[84:87], s93 offen offset:1024 lds
  v_mfma_f32_16x16x32_bf16 v[40:43], a[4:7], a[144:147], v[40:43]
  s_waitcnt lgkmcnt(6)
  ds_read_b64_tr_b16 a[52:53], v1 offset:25600
  ds_read_b64_tr_b16 a[54:55], v1 offset:29696
  v_mfma_f32_16x16x32_bf16 v[48:51], a[8:11], a[144:147], v[48:51]
  ds_read_b64_tr_b16 a[40:41], v2 offset:17408
  v_mfma_f32_16x16x32_bf16 v[48:51], a[24:27], a[152:155], v[48:51]
  s_min_u32 s63, s90, 4096
  ds_read_b64_tr_b16 a[42:43], v2 offset:21504
  s_add_u32 s63, s63, s48
  v_mfma_f32_16x16x32_bf16 v[52:55], a[24:27], a[156:159], v[52:55]
  buffer_load_dwordx4 a[208:211], v8, s[4:7], s63 offen offset:2048 sc1
  v_mfma_f32_16x16x32_bf16 v[52:55], a[8:11], a[148:151], v[52:55]
  ds_read_b64_tr_b16 a[56:57], v2 offset:25600
  ds_read_b64_tr_b16 a[58:59], v2 offset:29696
  v_mfma_f32_16x16x32_bf16 v[60:63], a[12:15], a[148:151], v[60:63]
  ds_read_b64_tr_b16 a[44:45], v3 offset:17408
  v_mfma_f32_16x16x32_bf16 v[60:63], a[28:31], a[156:159], v[60:63]
  ds_read_b64_tr_b16 a[46:47], v3 offset:21504
  v_mfma_f32_16x16x32_bf16 v[56:59], a[28:31], a[152:155], v[56:59]
  buffer_load_dwordx4 a[212:215], v9, s[4:7], s63 offen offset:2048 sc1
  v_mfma_f32_16x16x32_bf16 v[56:59], a[12:15], a[144:147], v[56:59]
  s_waitcnt lgkmcnt(6)
  ds_read_b64_tr_b16 a[60:61], v3 offset:25600
  ds_read_b64_tr_b16 a[62:63], v3 offset:29696
  v_mfma_f32_16x16x32_bf16 v[64:67], a[32:35], a[144:147], v[64:67]
  s_add_u32 m0, s79, 122880
  ds_read_b64_tr_b16 a[0:1], v0 offset:32768
  s_add_u32 s92, s92, 262144
  s_cmp_lg_u32 s91, 0
  s_cselect_b32 s93, -2031616, 0
  s_cselect_b32 s43, s78, 0
  v_mfma_f32_16x16x32_bf16 v[64:67], a[48:51], a[152:155], v[64:67]
  s_add_u32 s93, s93, s43
  ds_read_b64_tr_b16 a[2:3], v0 offset:36864
  s_add_u32 s93, s93, s92
  v_mfma_f32_16x16x32_bf16 v[68:71], a[48:51], a[156:159], v[68:71]
  buffer_load_dwordx4 v252, s[80:83], s93 offen lds
  v_mfma_f32_16x16x32_bf16 v[68:71], a[32:35], a[148:151], v[68:71]
  ds_read_b64_tr_b16 a[16:17], v0 offset:40960
  ds_read_b64_tr_b16 a[18:19], v0 offset:45056
  v_mfma_f32_16x16x32_bf16 v[76:79], a[36:39], a[148:151], v[76:79]
  ds_read_b64_tr_b16 a[4:5], v1 offset:32768
  v_mfma_f32_16x16x32_bf16 v[76:79], a[52:55], a[156:159], v[76:79]
  ds_read_b64_tr_b16 a[6:7], v1 offset:36864
  v_mfma_f32_16x16x32_bf16 v[72:75], a[52:55], a[152:155], v[72:75]
  buffer_load_dwordx4 v252, s[84:87], s93 offen offset:1024 lds
  v_mfma_f32_16x16x32_bf16 v[72:75], a[36:39], a[144:147], v[72:75]
  s_waitcnt lgkmcnt(6)
  ds_read_b64_tr_b16 a[20:21], v1 offset:40960
  ds_read_b64_tr_b16 a[22:23], v1 offset:45056
  v_mfma_f32_16x16x32_bf16 v[80:83], a[40:43], a[144:147], v[80:83]
  ds_read_b64_tr_b16 a[8:9], v2 offset:32768
  v_mfma_f32_16x16x32_bf16 v[80:83], a[56:59], a[152:155], v[80:83]
  s_min_u32 s63, s91, 4096
  ds_read_b64_tr_b16 a[10:11], v2 offset:36864
  s_add_u32 s63, s63, s48
  v_mfma_f32_16x16x32_bf16 v[84:87], a[56:59], a[156:159], v[84:87]
  buffer_load_dwordx4 a[216:219], v8, s[4:7], s63 offen offset:3072 sc1
  v_mfma_f32_16x16x32_bf16 v[84:87], a[40:43], a[148:151], v[84:87]
  ds_read_b64_tr_b16 a[24:25], v2 offset:40960
  ds_read_b64_tr_b16 a[26:27], v2 offset:45056
  v_mfma_f32_16x16x32_bf16 v[92:95], a[44:47], a[148:151], v[92:95]
  ds_read_b64_tr_b16 a[12:13], v3 offset:32768
  v_mfma_f32_16x16x32_bf16 v[92:95], a[60:63], a[156:159], v[92:95]
  ds_read_b64_tr_b16 a[14:15], v3 offset:36864
  v_mfma_f32_16x16x32_bf16 v[88:91], a[60:63], a[152:155], v[88:91]
  buffer_load_dwordx4 a[220:223], v9, s[4:7], s63 offen offset:3072 sc1
  v_mfma_f32_16x16x32_bf16 v[88:91], a[44:47], a[144:147], v[88:91]
  s_waitcnt vmcnt(24) lgkmcnt(6)
  ds_read_b64_tr_b16 a[28:29], v3 offset:40960
  ds_read_b64_tr_b16 a[30:31], v3 offset:45056
  v_mfma_f32_16x16x32_bf16 v[32:35], a[0:3], a[160:163], v[32:35]
  s_waitcnt vmcnt(26)
  s_barrier
  ds_read_b64_tr_b16 a[32:33], v0 offset:33792
  s_add_u32 m0, s79, 0
  s_add_u32 s92, s92, -3407872
  s_add_u32 s92, s92, s78
  s_cmp_lg_u32 s88, 0
  v_mfma_f32_16x16x32_bf16 v[32:35], a[16:19], a[168:171], v[32:35]
  s_cselect_b32 s93, 1835008, 0
  ds_read_b64_tr_b16 a[34:35], v0 offset:37888
  s_add_u32 s93, s93, s92
  v_mfma_f32_16x16x32_bf16 v[36:39], a[16:19], a[172:175], v[36:39]
  buffer_load_dwordx4 v252, s[80:83], s93 offen lds
  v_mfma_f32_16x16x32_bf16 v[36:39], a[0:3], a[164:167], v[36:39]
  ds_read_b64_tr_b16 a[48:49], v0 offset:41984
  ds_read_b64_tr_b16 a[50:51], v0 offset:46080
  v_mfma_f32_16x16x32_bf16 v[44:47], a[4:7], a[164:167], v[44:47]
  ds_read_b64_tr_b16 a[36:37], v1 offset:33792
  v_mfma_f32_16x16x32_bf16 v[44:47], a[20:23], a[172:175], v[44:47]
  ds_read_b64_tr_b16 a[38:39], v1 offset:37888
  v_mfma_f32_16x16x32_bf16 v[40:43], a[20:23], a[168:171], v[40:43]
  buffer_load_dwordx4 v252, s[84:87], s93 offen offset:1024 lds
  v_mfma_f32_16x16x32_bf16 v[40:43], a[4:7], a[160:163], v[40:43]
  s_waitcnt lgkmcnt(6)
  ds_read_b64_tr_b16 a[52:53], v1 offset:41984
  ds_read_b64_tr_b16 a[54:55], v1 offset:46080
  v_mfma_f32_16x16x32_bf16 v[48:51], a[8:11], a[160:163], v[48:51]
  ds_read_b64_tr_b16 a[40:41], v2 offset:33792
  v_mfma_f32_16x16x32_bf16 v[48:51], a[24:27], a[168:171], v[48:51]
  s_add_u32 s48, s48, 4096
  ds_read_b64_tr_b16 a[42:43], v2 offset:37888
  s_min_u32 s63, s88, 4096
  v_mfma_f32_16x16x32_bf16 v[52:55], a[24:27], a[172:175], v[52:55]
  s_add_u32 s63, s63, s48
  buffer_load_dwordx4 a[224:227], v8, s[4:7], s63 offen offset:0 sc1
  v_mfma_f32_16x16x32_bf16 v[52:55], a[8:11], a[164:167], v[52:55]
  ds_read_b64_tr_b16 a[56:57], v2 offset:41984
  ds_read_b64_tr_b16 a[58:59], v2 offset:46080
  v_mfma_f32_16x16x32_bf16 v[60:63], a[12:15], a[164:167], v[60:63]
  ds_read_b64_tr_b16 a[44:45], v3 offset:33792
  v_mfma_f32_16x16x32_bf16 v[60:63], a[28:31], a[172:175], v[60:63]
  ds_read_b64_tr_b16 a[46:47], v3 offset:37888
  v_mfma_f32_16x16x32_bf16 v[56:59], a[28:31], a[168:171], v[56:59]
  buffer_load_dwordx4 a[228:231], v9, s[4:7], s63 offen offset:0 sc1
  v_mfma_f32_16x16x32_bf16 v[56:59], a[12:15], a[160:163], v[56:59]
  s_waitcnt lgkmcnt(6)
  ds_read_b64_tr_b16 a[60:61], v3 offset:41984
  ds_read_b64_tr_b16 a[62:63], v3 offset:46080
  v_mfma_f32_16x16x32_bf16 v[64:67], a[32:35], a[160:163], v[64:67]
  s_add_u32 m0, s79, 8192
  ds_read_b64_tr_b16 a[0:1], v0 offset:49152
  s_add_u32 s92, s92, 458752
  s_cmp_lg_u32 s89, 0
  v_mfma_f32_16x16x32_bf16 v[64:67], a[48:51], a[168:171], v[64:67]
  s_cselect_b32 s93, 1835008, 0
  ds_read_b64_tr_b16 a[2:3], v0 offset:53248
  s_add_u32 s93, s93, s92
  v_mfma_f32_16x16x32_bf16 v[68:71], a[48:51], a[172:175], v[68:71]
  buffer_load_dwordx4 v252, s[80:83], s93 offen lds
  v_mfma_f32_16x16x32_bf16 v[68:71], a[32:35], a[164:167], v[68:71]
  ds_read_b64_tr_b16 a[16:17], v0 offset:57344
  ds_read_b64_tr_b16 a[18:19], v0 offset:61440
  v_mfma_f32_16x16x32_bf16 v[76:79], a[36:39], a[164:167], v[76:79]
  ds_read_b64_tr_b16 a[4:5], v1 offset:49152
  v_mfma_f32_16x16x32_bf16 v[76:79], a[52:55], a[172:175], v[76:79]
  ds_read_b64_tr_b16 a[6:7], v1 offset:53248
  v_mfma_f32_16x16x32_bf16 v[72:75], a[52:55], a[168:171], v[72:75]
  buffer_load_dwordx4 v252, s[84:87], s93 offen offset:1024 lds
  v_mfma_f32_16x16x32_bf16 v[72:75], a[36:39], a[160:163], v[72:75]
  s_waitcnt lgkmcnt(6)
  ds_read_b64_tr_b16 a[20:21], v1 offset:57344
  ds_read_b64_tr_b16 a[22:23], v1 offset:61440
  v_mfma_f32_16x16x32_bf16 v[80:83], a[40:43], a[160:163], v[80:83]
  ds_read_b64_tr_b16 a[8:9], v2 offset:49152
  v_mfma_f32_16x16x32_bf16 v[80:83], a[56:59], a[168:171], v[80:83]
  s_min_u32 s63, s89, 4096
  ds_read_b64_tr_b16 a[10:11], v2 offset:53248
  s_add_u32 s63, s63, s48
  v_mfma_f32_16x16x32_bf16 v[84:87], a[56:59], a[172:175], v[84:87]
  buffer_load_dwordx4 a[232:235], v8, s[4:7], s63 offen offset:1024 sc1
  v_mfma_f32_16x16x32_bf16 v[84:87], a[40:43], a[164:167], v[84:87]
  ds_read_b64_tr_b16 a[24:25], v2 offset:57344
  ds_read_b64_tr_b16 a[26:27], v2 offset:61440
  v_mfma_f32_16x16x32_bf16 v[92:95], a[44:47], a[164:167], v[92:95]
  ds_read_b64_tr_b16 a[12:13], v3 offset:49152
  v_mfma_f32_16x16x32_bf16 v[92:95], a[60:63], a[172:175], v[92:95]
  ds_read_b64_tr_b16 a[14:15], v3 offset:53248
  v_mfma_f32_16x16x32_bf16 v[88:91], a[60:63], a[168:171], v[88:91]
  buffer_load_dwordx4 a[236:239], v9, s[4:7], s63 offen offset:1024 sc1
  v_mfma_f32_16x16x32_bf16 v[88:91], a[44:47], a[160:163], v[88:91]
  s_waitcnt vmcnt(24) lgkmcnt(6)
  ds_read_b64_tr_b16 a[28:29], v3 offset:57344
  ds_read_b64_tr_b16 a[30:31], v3 offset:61440
  v_mfma_f32_16x16x32_bf16 v[32:35], a[0:3], a[176:179], v[32:35]
  s_add_u32 m0, s79, 16384
  ds_read_b64_tr_b16 a[32:33], v0 offset:50176
  s_add_u32 s92, s92, 458752
  s_cmp_lg_u32 s90, 0
  v_mfma_f32_16x16x32_bf16 v[32:35], a[16:19], a[184:187], v[32:35]
  s_cselect_b32 s93, 1835008, 0
  ds_read_b64_tr_b16 a[34:35], v0 offset:54272
  s_add_u32 s93, s93, s92
  v_mfma_f32_16x16x32_bf16 v[36:39], a[16:19], a[188:191], v[36:39]
  buffer_load_dwordx4 v252, s[80:83], s93 offen lds
  v_mfma_f32_16x16x32_bf16 v[36:39], a[0:3], a[180:183], v[36:39]
  ds_read_b64_tr_b16 a[48:49], v0 offset:58368
  ds_read_b64_tr_b16 a[50:51], v0 offset:62464
  v_mfma_f32_16x16x32_bf16 v[44:47], a[4:7], a[180:183], v[44:47]
  ds_read_b64_tr_b16 a[36:37], v1 offset:50176
  v_mfma_f32_16x16x32_bf16 v[44:47], a[20:23], a[188:191], v[44:47]
  ds_read_b64_tr_b16 a[38:39], v1 offset:54272
  v_mfma_f32_16x16x32_bf16 v[40:43], a[20:23], a[184:187], v[40:43]
  buffer_load_dwordx4 v252, s[84:87], s93 offen offset:1024 lds
  v_mfma_f32_16x16x32_bf16 v[40:43], a[4:7], a[176:179], v[40:43]
  s_waitcnt lgkmcnt(6)
  ds_read_b64_tr_b16 a[52:53], v1 offset:58368
  ds_read_b64_tr_b16 a[54:55], v1 offset:62464
  v_mfma_f32_16x16x32_bf16 v[48:51], a[8:11], a[176:179], v[48:51]
  ds_read_b64_tr_b16 a[40:41], v2 offset:50176
  v_mfma_f32_16x16x32_bf16 v[48:51], a[24:27], a[184:187], v[48:51]
  s_min_u32 s63, s90, 4096
  ds_read_b64_tr_b16 a[42:43], v2 offset:54272
  s_add_u32 s63, s63, s48
  v_mfma_f32_16x16x32_bf16 v[52:55], a[24:27], a[188:191], v[52:55]
  buffer_load_dwordx4 a[240:243], v8, s[4:7], s63 offen offset:2048 sc1
  v_mfma_f32_16x16x32_bf16 v[52:55], a[8:11], a[180:183], v[52:55]
  ds_read_b64_tr_b16 a[56:57], v2 offset:58368
  ds_read_b64_tr_b16 a[58:59], v2 offset:62464
  v_mfma_f32_16x16x32_bf16 v[60:63], a[12:15], a[180:183], v[60:63]
  ds_read_b64_tr_b16 a[44:45], v3 offset:50176
  v_mfma_f32_16x16x32_bf16 v[60:63], a[28:31], a[188:191], v[60:63]
  ds_read_b64_tr_b16 a[46:47], v3 offset:54272
  v_mfma_f32_16x16x32_bf16 v[56:59], a[28:31], a[184:187], v[56:59]
  buffer_load_dwordx4 a[244:247], v9, s[4:7], s63 offen offset:2048 sc1
  v_mfma_f32_16x16x32_bf16 v[56:59], a[12:15], a[176:179], v[56:59]
  s_waitcnt lgkmcnt(6)
  ds_read_b64_tr_b16 a[60:61], v3 offset:58368
  ds_read_b64_tr_b16 a[62:63], v3 offset:62464
  v_mfma_f32_16x16x32_bf16 v[64:67], a[32:35], a[176:179], v[64:67]
  s_add_u32 m0, s79, 24576
  ds_read_b64_tr_b16 a[0:1], v4 offset:0
  s_add_u32 s92, s92, 458752
  s_cmp_lg_u32 s91, 0
  v_mfma_f32_16x16x32_bf16 v[64:67], a[48:51], a[184:187], v[64:67]
  s_cselect_b32 s93, 1835008, 0
  ds_read_b64_tr_b16 a[2:3], v4 offset:4096
  s_add_u32 s93, s93, s92
  v_mfma_f32_16x16x32_bf16 v[68:71], a[48:51], a[188:191], v[68:71]
  buffer_load_dwordx4 v252, s[80:83], s93 offen lds
  v_mfma_f32_16x16x32_bf16 v[68:71], a[32:35], a[180:183], v[68:71]
  ds_read_b64_tr_b16 a[16:17], v4 offset:8192
  ds_read_b64_tr_b16 a[18:19], v4 offset:12288
  v_mfma_f32_16x16x32_bf16 v[76:79], a[36:39], a[180:183], v[76:79]
  ds_read_b64_tr_b16 a[4:5], v5 offset:0
  v_mfma_f32_16x16x32_bf16 v[76:79], a[52:55], a[188:191], v[76:79]
  ds_read_b64_tr_b16 a[6:7], v5 offset:4096
  v_mfma_f32_16x16x32_bf16 v[72:75], a[52:55], a[184:187], v[72:75]
  buffer_load_dwordx4 v252, s[84:87], s93 offen offset:1024 lds
  v_mfma_f32_16x16x32_bf16 v[72:75], a[36:39], a[176:179], v[72:75]
  s_waitcnt lgkmcnt(6)
  ds_read_b64_tr_b16 a[20:21], v5 offset:8192
  ds_read_b64_tr_b16 a[22:23], v5 offset:12288
  v_mfma_f32_16x16x32_bf16 v[80:83], a[40:43], a[176:179], v[80:83]
  ds_read_b64_tr_b16 a[8:9], v6 offset:0
  v_mfma_f32_16x16x32_bf16 v[80:83], a[56:59], a[184:187], v[80:83]
  s_min_u32 s63, s91, 4096
  ds_read_b64_tr_b16 a[10:11], v6 offset:4096
  s_add_u32 s63, s63, s48
  v_mfma_f32_16x16x32_bf16 v[84:87], a[56:59], a[188:191], v[84:87]
  buffer_load_dwordx4 a[248:251], v8, s[4:7], s63 offen offset:3072 sc1
  v_mfma_f32_16x16x32_bf16 v[84:87], a[40:43], a[180:183], v[84:87]
  ds_read_b64_tr_b16 a[24:25], v6 offset:8192
  ds_read_b64_tr_b16 a[26:27], v6 offset:12288
  v_mfma_f32_16x16x32_bf16 v[92:95], a[44:47], a[180:183], v[92:95]
  ds_read_b64_tr_b16 a[12:13], v7 offset:0
  v_mfma_f32_16x16x32_bf16 v[92:95], a[60:63], a[188:191], v[92:95]
  ds_read_b64_tr_b16 a[14:15], v7 offset:4096
  v_mfma_f32_16x16x32_bf16 v[88:91], a[60:63], a[184:187], v[88:91]
  buffer_load_dwordx4 a[252:255], v9, s[4:7], s63 offen offset:3072 sc1
  v_mfma_f32_16x16x32_bf16 v[88:91], a[44:47], a[176:179], v[88:91]
  s_waitcnt vmcnt(24) lgkmcnt(6)
  ds_read_b64_tr_b16 a[28:29], v7 offset:8192
  ds_read_b64_tr_b16 a[30:31], v7 offset:12288
  v_mfma_f32_16x16x32_bf16 v[32:35], a[0:3], a[192:195], v[32:35]
  s_waitcnt vmcnt(26)
  s_barrier
  ds_read_b64_tr_b16 a[32:33], v4 offset:1024
  s_add_u32 m0, s79, 32768
  s_add_u32 s92, s92, 458752
  s_cmp_lg_u32 s88, 0
  s_cselect_b32 s93, -2031616, 0
  s_cselect_b32 s43, s78, 0
  v_mfma_f32_16x16x32_bf16 v[32:35], a[16:19], a[200:203], v[32:35]
  s_sub_u32 s93, s93, s43
  ds_read_b64_tr_b16 a[34:35], v4 offset:5120
  s_add_u32 s93, s93, s92
  v_mfma_f32_16x16x32_bf16 v[36:39], a[16:19], a[204:207], v[36:39]
  buffer_load_dwordx4 v252, s[80:83], s93 offen lds
  v_mfma_f32_16x16x32_bf16 v[36:39], a[0:3], a[196:199], v[36:39]
  ds_read_b64_tr_b16 a[48:49], v4 offset:9216
  ds_read_b64_tr_b16 a[50:51], v4 offset:13312
  v_mfma_f32_16x16x32_bf16 v[44:47], a[4:7], a[196:199], v[44:47]
  ds_read_b64_tr_b16 a[36:37], v5 offset:1024
  v_mfma_f32_16x16x32_bf16 v[44:47], a[20:23], a[204:207], v[44:47]
  ds_read_b64_tr_b16 a[38:39], v5 offset:5120
  v_mfma_f32_16x16x32_bf16 v[40:43], a[20:23], a[200:203], v[40:43]
  buffer_load_dwordx4 v252, s[84:87], s93 offen offset:1024 lds
  v_mfma_f32_16x16x32_bf16 v[40:43], a[4:7], a[192:195], v[40:43]
  s_waitcnt lgkmcnt(6)
  ds_read_b64_tr_b16 a[52:53], v5 offset:9216
  ds_read_b64_tr_b16 a[54:55], v5 offset:13312
  v_mfma_f32_16x16x32_bf16 v[48:51], a[8:11], a[192:195], v[48:51]
  ds_read_b64_tr_b16 a[40:41], v6 offset:1024
  v_mfma_f32_16x16x32_bf16 v[48:51], a[24:27], a[200:203], v[48:51]
  s_add_u32 s48, s48, 4096
  ds_read_b64_tr_b16 a[42:43], v6 offset:5120
  s_min_u32 s63, s88, 4096
  v_mfma_f32_16x16x32_bf16 v[52:55], a[24:27], a[204:207], v[52:55]
  s_add_u32 s63, s63, s48
  buffer_load_dwordx4 a[128:131], v8, s[4:7], s63 offen offset:0 sc1
  v_mfma_f32_16x16x32_bf16 v[52:55], a[8:11], a[196:199], v[52:55]
  ds_read_b64_tr_b16 a[56:57], v6 offset:9216
  ds_read_b64_tr_b16 a[58:59], v6 offset:13312
  v_mfma_f32_16x16x32_bf16 v[60:63], a[12:15], a[196:199], v[60:63]
  ds_read_b64_tr_b16 a[44:45], v7 offset:1024
  v_mfma_f32_16x16x32_bf16 v[60:63], a[28:31], a[204:207], v[60:63]
  ds_read_b64_tr_b16 a[46:47], v7 offset:5120
  v_mfma_f32_16x16x32_bf16 v[56:59], a[28:31], a[200:203], v[56:59]
  buffer_load_dwordx4 a[132:135], v9, s[4:7], s63 offen offset:0 sc1
  v_mfma_f32_16x16x32_bf16 v[56:59], a[12:15], a[192:195], v[56:59]
  s_waitcnt lgkmcnt(6)
  ds_read_b64_tr_b16 a[60:61], v7 offset:9216
  ds_read_b64_tr_b16 a[62:63], v7 offset:13312
  v_mfma_f32_16x16x32_bf16 v[64:67], a[32:35], a[192:195], v[64:67]
  s_add_u32 m0, s79, 40960
  ds_read_b64_tr_b16 a[0:1], v4 offset:16384
  s_add_u32 s92, s92, 458752
  s_cmp_lg_u32 s89, 0
  s_cselect_b32 s93, -2228224, 0
  s_cselect_b32 s43, s78, 0
  v_mfma_f32_16x16x32_bf16 v[64:67], a[48:51], a[200:203], v[64:67]
  s_sub_u32 s93, s93, s43
  ds_read_b64_tr_b16 a[2:3], v4 offset:20480
  s_add_u32 s93, s93, s92
  v_mfma_f32_16x16x32_bf16 v[68:71], a[48:51], a[204:207], v[68:71]
  buffer_load_dwordx4 v252, s[80:83], s93 offen lds
  v_mfma_f32_16x16x32_bf16 v[68:71], a[32:35], a[196:199], v[68:71]
  ds_read_b64_tr_b16 a[16:17], v4 offset:24576
  ds_read_b64_tr_b16 a[18:19], v4 offset:28672
  v_mfma_f32_16x16x32_bf16 v[76:79], a[36:39], a[196:199], v[76:79]
  ds_read_b64_tr_b16 a[4:5], v5 offset:16384
  v_mfma_f32_16x16x32_bf16 v[76:79], a[52:55], a[204:207], v[76:79]
  ds_read_b64_tr_b16 a[6:7], v5 offset:20480
  v_mfma_f32_16x16x32_bf16 v[72:75], a[52:55], a[200:203], v[72:75]
  buffer_load_dwordx4 v252, s[84:87], s93 offen offset:1024 lds
  v_mfma_f32_16x16x32_bf16 v[72:75], a[36:39], a[192:195], v[72:75]
  s_waitcnt lgkmcnt(6)
  ds_read_b64_tr_b16 a[20:21], v5 offset:24576
  ds_read_b64_tr_b16 a[22:23], v5 offset:28672
  v_mfma_f32_16x16x32_bf16 v[80:83], a[40:43], a[192:195], v[80:83]
  ds_read_b64_tr_b16 a[8:9], v6 offset:16384
  v_mfma_f32_16x16x32_bf16 v[80:83], a[56:59], a[200:203], v[80:83]
  s_min_u32 s63, s89, 4096
  ds_read_b64_tr_b16 a[10:11], v6 offset:20480
  s_add_u32 s63, s63, s48
  v_mfma_f32_16x16x32_bf16 v[84:87], a[56:59], a[204:207], v[84:87]
  buffer_load_dwordx4 a[136:139], v8, s[4:7], s63 offen offset:1024 sc1
  v_mfma_f32_16x16x32_bf16 v[84:87], a[40:43], a[196:199], v[84:87]
  ds_read_b64_tr_b16 a[24:25], v6 offset:24576
  ds_read_b64_tr_b16 a[26:27], v6 offset:28672
  v_mfma_f32_16x16x32_bf16 v[92:95], a[44:47], a[196:199], v[92:95]
  ds_read_b64_tr_b16 a[12:13], v7 offset:16384
  v_mfma_f32_16x16x32_bf16 v[92:95], a[60:63], a[204:207], v[92:95]
  ds_read_b64_tr_b16 a[14:15], v7 offset:20480
  v_mfma_f32_16x16x32_bf16 v[88:91], a[60:63], a[200:203], v[88:91]
  buffer_load_dwordx4 a[140:143], v9, s[4:7], s63 offen offset:1024 sc1
  v_mfma_f32_16x16x32_bf16 v[88:91], a[44:47], a[192:195], v[88:91]
  s_waitcnt vmcnt(24) lgkmcnt(6)
  ds_read_b64_tr_b16 a[28:29], v7 offset:24576
  ds_read_b64_tr_b16 a[30:31], v7 offset:28672
  v_mfma_f32_16x16x32_bf16 v[32:35], a[0:3], a[208:211], v[32:35]
  s_add_u32 m0, s79, 49152
  ds_read_b64_tr_b16 a[32:33], v4 offset:32768
  s_add_u32 s92, s92, 458752
  s_cmp_lg_u32 s90, 0
  s_cselect_b32 s93, -2490368, 0
  s_cselect_b32 s43, s78, 0
  v_mfma_f32_16x16x32_bf16 v[32:35], a[16:19], a[216:219], v[32:35]
  s_sub_u32 s93, s93, s43
  ds_read_b64_tr_b16 a[34:35], v4 offset:36864
  s_add_u32 s93, s93, s92
  v_mfma_f32_16x16x32_bf16 v[36:39], a[16:19], a[220:223], v[36:39]
  ds_read_b64_tr_b16 a[48:49], v4 offset:40960
  buffer_load_dwordx4 v252, s[80:83], s93 offen lds
  v_mfma_f32_16x16x32_bf16 v[36:39], a[0:3], a[212:215], v[36:39]
  ds_read_b64_tr_b16 a[50:51], v4 offset:45056
  v_mfma_f32_16x16x32_bf16 v[44:47], a[4:7], a[212:215], v[44:47]
  ds_read_b64_tr_b16 a[36:37], v5 offset:32768
  buffer_load_dwordx4 v252, s[84:87], s93 offen offset:1024 lds
  v_mfma_f32_16x16x32_bf16 v[44:47], a[20:23], a[220:223], v[44:47]
  s_min_u32 s63, s90, 4096
  ds_read_b64_tr_b16 a[38:39], v5 offset:36864
  s_add_u32 s63, s63, s48
  v_mfma_f32_16x16x32_bf16 v[40:43], a[20:23], a[216:219], v[40:43]
  ds_read_b64_tr_b16 a[52:53], v5 offset:40960
  buffer_load_dwordx4 a[144:147], v8, s[4:7], s63 offen offset:2048 sc1
  v_mfma_f32_16x16x32_bf16 v[40:43], a[4:7], a[208:211], v[40:43]
  ds_read_b64_tr_b16 a[54:55], v5 offset:45056
  s_waitcnt lgkmcnt(8)
  v_mfma_f32_16x16x32_bf16 v[48:51], a[8:11], a[208:211], v[48:51]
  s_add_u32 m0, s79, 57344
  ds_read_b64_tr_b16 a[40:41], v6 offset:32768
  buffer_load_dwordx4 a[148:151], v9, s[4:7], s63 offen offset:2048 sc1
  s_add_u32 s92, s92, 458752
  s_cmp_lg_u32 s91, 0
  s_cselect_b32 s93, -2686976, 0
  s_cselect_b32 s43, s78, 0
  v_mfma_f32_16x16x32_bf16 v[48:51], a[24:27], a[216:219], v[48:51]
  s_sub_u32 s93, s93, s43
  ds_read_b64_tr_b16 a[42:43], v6 offset:36864
  s_add_u32 s93, s93, s92
  v_mfma_f32_16x16x32_bf16 v[52:55], a[24:27], a[220:223], v[52:55]
  ds_read_b64_tr_b16 a[56:57], v6 offset:40960
  buffer_load_dwordx4 v252, s[80:83], s93 offen lds
  v_mfma_f32_16x16x32_bf16 v[52:55], a[8:11], a[212:215], v[52:55]
  ds_read_b64_tr_b16 a[58:59], v6 offset:45056
  v_mfma_f32_16x16x32_bf16 v[60:63], a[12:15], a[212:215], v[60:63]
  ds_read_b64_tr_b16 a[44:45], v7 offset:32768
  buffer_load_dwordx4 v252, s[84:87], s93 offen offset:1024 lds
  v_mfma_f32_16x16x32_bf16 v[60:63], a[28:31], a[220:223], v[60:63]
  s_min_u32 s63, s91, 4096
  ds_read_b64_tr_b16 a[46:47], v7 offset:36864
  s_add_u32 s63, s63, s48
  v_mfma_f32_16x16x32_bf16 v[56:59], a[28:31], a[216:219], v[56:59]
  ds_read_b64_tr_b16 a[60:61], v7 offset:40960
  buffer_load_dwordx4 a[152:155], v8, s[4:7], s63 offen offset:3072 sc1
  v_mfma_f32_16x16x32_bf16 v[56:59], a[12:15], a[208:211], v[56:59]
  s_waitcnt vmcnt(23) lgkmcnt(7)
  ds_read_b64_tr_b16 a[62:63], v7 offset:45056
  buffer_load_dwordx4 a[156:159], v9, s[4:7], s63 offen offset:3072 sc1
  v_mfma_f32_16x16x32_bf16 v[32:35], a[32:35], a[224:227], v[32:35]
  s_waitcnt vmcnt(26)
  s_barrier
  ds_read_b64_tr_b16 a[0:1], v4 offset:49152
  v_mfma_f32_16x16x32_bf16 v[32:35], a[48:51], a[232:235], v[32:35]
  s_add_u32 s48, s48, 4096
  ds_read_b64_tr_b16 a[2:3], v4 offset:53248
  s_min_u32 s63, s88, 4096
  s_mul_i32 s63, s63, -13
  v_mfma_f32_16x16x32_bf16 v[36:39], a[48:51], a[236:239], v[36:39]
  s_add_u32 s63, s63, s48
  ds_read_b64_tr_b16 a[16:17], v4 offset:57344
  buffer_load_dwordx4 a[160:163], v8, s[4:7], s63 offen offset:0 sc1
  v_mfma_f32_16x16x32_bf16 v[36:39], a[32:35], a[228:231], v[36:39]
  ds_read_b64_tr_b16 a[18:19], v4 offset:61440
  v_mfma_f32_16x16x32_bf16 v[44:47], a[36:39], a[228:231], v[44:47]
  ds_read_b64_tr_b16 a[4:5], v5 offset:49152
  v_mfma_f32_16x16x32_bf16 v[44:47], a[52:55], a[236:239], v[44:47]
  ds_read_b64_tr_b16 a[6:7], v5 offset:53248
  v_mfma_f32_16x16x32_bf16 v[40:43], a[52:55], a[232:235], v[40:43]
  ds_read_b64_tr_b16 a[20:21], v5 offset:57344
  buffer_load_dwordx4 a[164:167], v9, s[4:7], s63 offen offset:0 sc1
  v_mfma_f32_16x16x32_bf16 v[40:43], a[36:39], a[224:227], v[40:43]
  ds_read_b64_tr_b16 a[22:23], v5 offset:61440
  s_waitcnt lgkmcnt(8)
  v_mfma_f32_16x16x32_bf16 v[48:51], a[40:43], a[224:227], v[48:51]
  ds_read_b64_tr_b16 a[8:9], v6 offset:49152
  v_mfma_f32_16x16x32_bf16 v[48:51], a[56:59], a[232:235], v[48:51]
  s_min_u32 s63, s89, 4096
  ds_read_b64_tr_b16 a[10:11], v6 offset:53248
  s_mul_i32 s63, s63, -13
  v_mfma_f32_16x16x32_bf16 v[52:55], a[56:59], a[236:239], v[52:55]
  s_add_u32 s63, s63, s48
  ds_read_b64_tr_b16 a[24:25], v6 offset:57344
  buffer_load_dwordx4 a[168:171], v8, s[4:7], s63 offen offset:1024 sc1
  v_mfma_f32_16x16x32_bf16 v[52:55], a[40:43], a[228:231], v[52:55]
  ds_read_b64_tr_b16 a[26:27], v6 offset:61440
  v_mfma_f32_16x16x32_bf16 v[60:63], a[44:47], a[228:231], v[60:63]
  ds_read_b64_tr_b16 a[12:13], v7 offset:49152
  v_mfma_f32_16x16x32_bf16 v[60:63], a[60:63], a[236:239], v[60:63]
  ds_read_b64_tr_b16 a[14:15], v7 offset:53248
  v_mfma_f32_16x16x32_bf16 v[56:59], a[60:63], a[232:235], v[56:59]
  ds_read_b64_tr_b16 a[28:29], v7 offset:57344
  buffer_load_dwordx4 a[172:175], v9, s[4:7], s63 offen offset:1024 sc1
  v_mfma_f32_16x16x32_bf16 v[56:59], a[44:47], a[224:227], v[56:59]
  ds_read_b64_tr_b16 a[30:31], v7 offset:61440
  s_waitcnt vmcnt(20) lgkmcnt(8)
  v_mfma_f32_16x16x32_bf16 v[32:35], a[0:3], a[240:243], v[32:35]
  ds_read_b64_tr_b16 a[32:33], v0 offset:0
  v_mfma_f32_16x16x32_bf16 v[32:35], a[16:19], a[248:251], v[32:35]
  s_min_u32 s63, s90, 4096
  ds_read_b64_tr_b16 a[34:35], v0 offset:4096
  s_mul_i32 s63, s63, -13
  v_mfma_f32_16x16x32_bf16 v[36:39], a[16:19], a[252:255], v[36:39]
  s_add_u32 s63, s63, s48
  ds_read_b64_tr_b16 a[48:49], v0 offset:8192
  buffer_load_dwordx4 a[176:179], v8, s[4:7], s63 offen offset:2048 sc1
  v_mfma_f32_16x16x32_bf16 v[36:39], a[0:3], a[244:247], v[36:39]
  ds_read_b64_tr_b16 a[50:51], v0 offset:12288
  v_mfma_f32_16x16x32_bf16 v[44:47], a[4:7], a[244:247], v[44:47]
  ds_read_b64_tr_b16 a[36:37], v1 offset:0
  v_mfma_f32_16x16x32_bf16 v[44:47], a[20:23], a[252:255], v[44:47]
  ds_read_b64_tr_b16 a[38:39], v1 offset:4096
  v_mfma_f32_16x16x32_bf16 v[40:43], a[20:23], a[248:251], v[40:43]
  ds_read_b64_tr_b16 a[52:53], v1 offset:8192
  buffer_load_dwordx4 a[180:183], v9, s[4:7], s63 offen offset:2048 sc1
  v_mfma_f32_16x16x32_bf16 v[40:43], a[4:7], a[240:243], v[40:43]
  ds_read_b64_tr_b16 a[54:55], v1 offset:12288
  s_waitcnt lgkmcnt(8)
  v_mfma_f32_16x16x32_bf16 v[48:51], a[8:11], a[240:243], v[48:51]
  ds_read_b64_tr_b16 a[40:41], v2 offset:0
  v_mfma_f32_16x16x32_bf16 v[48:51], a[24:27], a[248:251], v[48:51]
  s_min_u32 s63, s91, 4096
  ds_read_b64_tr_b16 a[42:43], v2 offset:4096
  s_mul_i32 s63, s63, -13
  v_mfma_f32_16x16x32_bf16 v[52:55], a[24:27], a[252:255], v[52:55]
  s_add_u32 s63, s63, s48
  ds_read_b64_tr_b16 a[56:57], v2 offset:8192
  buffer_load_dwordx4 a[184:187], v8, s[4:7], s63 offen offset:3072 sc1
  v_mfma_f32_16x16x32_bf16 v[52:55], a[8:11], a[244:247], v[52:55]
  ds_read_b64_tr_b16 a[58:59], v2 offset:12288
  v_mfma_f32_16x16x32_bf16 v[60:63], a[12:15], a[244:247], v[60:63]
  ds_read_b64_tr_b16 a[44:45], v3 offset:0
  v_mfma_f32_16x16x32_bf16 v[60:63], a[28:31], a[252:255], v[60:63]
  ds_read_b64_tr_b16 a[46:47], v3 offset:4096
  v_mfma_f32_16x16x32_bf16 v[56:59], a[28:31], a[248:251], v[56:59]
  ds_read_b64_tr_b16 a[60:61], v3 offset:8192
  buffer_load_dwordx4 a[188:191], v9, s[4:7], s63 offen offset:3072 sc1
  v_mfma_f32_16x16x32_bf16 v[56:59], a[12:15], a[240:243], v[56:59]
  ds_read_b64_tr_b16 a[62:63], v3 offset:12288
  s_waitcnt vmcnt(16) lgkmcnt(8)
  v_mfma_f32_16x16x32_bf16 v[32:35], a[32:35], a[128:131], v[32:35]
  s_waitcnt vmcnt(18)
  s_barrier
  ds_read_b64_tr_b16 a[0:1], v0 offset:16384
  v_mfma_f32_16x16x32_bf16 v[32:35], a[48:51], a[136:139], v[32:35]
  ds_read_b64_tr_b16 a[2:3], v0 offset:20480
  v_mfma_f32_16x16x32_bf16 v[36:39], a[48:51], a[140:143], v[36:39]
  ds_read_b64_tr_b16 a[16:17], v0 offset:24576
  v_mfma_f32_16x16x32_bf16 v[36:39], a[32:35], a[132:135], v[36:39]
  ds_read_b64_tr_b16 a[18:19], v0 offset:28672
  v_mfma_f32_16x16x32_bf16 v[44:47], a[36:39], a[132:135], v[44:47]
  ds_read_b64_tr_b16 a[4:5], v1 offset:16384
  v_mfma_f32_16x16x32_bf16 v[44:47], a[52:55], a[140:143], v[44:47]
  ds_read_b64_tr_b16 a[6:7], v1 offset:20480
  v_mfma_f32_16x16x32_bf16 v[40:43], a[52:55], a[136:139], v[40:43]
  ds_read_b64_tr_b16 a[20:21], v1 offset:24576
  v_mfma_f32_16x16x32_bf16 v[40:43], a[36:39], a[128:131], v[40:43]
  ds_read_b64_tr_b16 a[22:23], v1 offset:28672
  s_waitcnt lgkmcnt(8)
  v_mfma_f32_16x16x32_bf16 v[48:51], a[40:43], a[128:131], v[48:51]
  ds_read_b64_tr_b16 a[8:9], v2 offset:16384
  v_mfma_f32_16x16x32_bf16 v[48:51], a[56:59], a[136:139], v[48:51]
  ds_read_b64_tr_b16 a[10:11], v2 offset:20480
  v_mfma_f32_16x16x32_bf16 v[52:55], a[56:59], a[140:143], v[52:55]
  ds_read_b64_tr_b16 a[24:25], v2 offset:24576
  v_mfma_f32_16x16x32_bf16 v[52:55], a[40:43], a[132:135], v[52:55]
  ds_read_b64_tr_b16 a[26:27], v2 offset:28672
  v_mfma_f32_16x16x32_bf16 v[60:63], a[44:47], a[132:135], v[60:63]
  ds_read_b64_tr_b16 a[12:13], v3 offset:16384
  v_mfma_f32_16x16x32_bf16 v[60:63], a[60:63], a[140:143], v[60:63]
  ds_read_b64_tr_b16 a[14:15], v3 offset:20480
  v_mfma_f32_16x16x32_bf16 v[56:59], a[60:63], a[136:139], v[56:59]
  ds_read_b64_tr_b16 a[28:29], v3 offset:24576
  v_mfma_f32_16x16x32_bf16 v[56:59], a[44:47], a[128:131], v[56:59]
  ds_read_b64_tr_b16 a[30:31], v3 offset:28672
  s_waitcnt vmcnt(8) lgkmcnt(8)
  v_mfma_f32_16x16x32_bf16 v[32:35], a[0:3], a[144:147], v[32:35]
  ds_read_b64_tr_b16 a[32:33], v0 offset:32768
  v_mfma_f32_16x16x32_bf16 v[32:35], a[16:19], a[152:155], v[32:35]
  ds_read_b64_tr_b16 a[34:35], v0 offset:36864
  v_mfma_f32_16x16x32_bf16 v[36:39], a[16:19], a[156:159], v[36:39]
  ds_read_b64_tr_b16 a[48:49], v0 offset:40960
  v_mfma_f32_16x16x32_bf16 v[36:39], a[0:3], a[148:151], v[36:39]
  ds_read_b64_tr_b16 a[50:51], v0 offset:45056
  v_mfma_f32_16x16x32_bf16 v[44:47], a[4:7], a[148:151], v[44:47]
  ds_read_b64_tr_b16 a[36:37], v1 offset:32768
  v_mfma_f32_16x16x32_bf16 v[44:47], a[20:23], a[156:159], v[44:47]
  ds_read_b64_tr_b16 a[38:39], v1 offset:36864
  v_mfma_f32_16x16x32_bf16 v[40:43], a[20:23], a[152:155], v[40:43]
  ds_read_b64_tr_b16 a[52:53], v1 offset:40960
  v_mfma_f32_16x16x32_bf16 v[40:43], a[4:7], a[144:147], v[40:43]
  ds_read_b64_tr_b16 a[54:55], v1 offset:45056
  s_waitcnt lgkmcnt(8)
  v_mfma_f32_16x16x32_bf16 v[48:51], a[8:11], a[144:147], v[48:51]
  ds_read_b64_tr_b16 a[40:41], v2 offset:32768
  v_mfma_f32_16x16x32_bf16 v[48:51], a[24:27], a[152:155], v[48:51]
  ds_read_b64_tr_b16 a[42:43], v2 offset:36864
  v_mfma_f32_16x16x32_bf16 v[52:55], a[24:27], a[156:159], v[52:55]
  ds_read_b64_tr_b16 a[56:57], v2 offset:40960
  v_mfma_f32_16x16x32_bf16 v[52:55], a[8:11], a[148:151], v[52:55]
  ds_read_b64_tr_b16 a[58:59], v2 offset:45056
  v_mfma_f32_16x16x32_bf16 v[60:63], a[12:15], a[148:151], v[60:63]
  ds_read_b64_tr_b16 a[44:45], v3 offset:32768
  v_mfma_f32_16x16x32_bf16 v[60:63], a[28:31], a[156:159], v[60:63]
  ds_read_b64_tr_b16 a[46:47], v3 offset:36864
  v_mfma_f32_16x16x32_bf16 v[56:59], a[28:31], a[152:155], v[56:59]
  ds_read_b64_tr_b16 a[60:61], v3 offset:40960
  v_mfma_f32_16x16x32_bf16 v[56:59], a[12:15], a[144:147], v[56:59]
  ds_read_b64_tr_b16 a[62:63], v3 offset:45056
  s_waitcnt vmcnt(4) lgkmcnt(8)
  v_mfma_f32_16x16x32_bf16 v[32:35], a[32:35], a[160:163], v[32:35]
  s_waitcnt vmcnt(10)
  s_barrier
  ds_read_b64_tr_b16 a[0:1], v0 offset:49152
  v_mfma_f32_16x16x32_bf16 v[32:35], a[48:51], a[168:171], v[32:35]
  ds_read_b64_tr_b16 a[2:3], v0 offset:53248
  v_mfma_f32_16x16x32_bf16 v[36:39], a[48:51], a[172:175], v[36:39]
  ds_read_b64_tr_b16 a[16:17], v0 offset:57344
  v_mfma_f32_16x16x32_bf16 v[36:39], a[32:35], a[164:167], v[36:39]
  ds_read_b64_tr_b16 a[18:19], v0 offset:61440
  v_mfma_f32_16x16x32_bf16 v[44:47], a[36:39], a[164:167], v[44:47]
  ds_read_b64_tr_b16 a[4:5], v1 offset:49152
  v_mfma_f32_16x16x32_bf16 v[44:47], a[52:55], a[172:175], v[44:47]
  ds_read_b64_tr_b16 a[6:7], v1 offset:53248
  v_mfma_f32_16x16x32_bf16 v[40:43], a[52:55], a[168:171], v[40:43]
  ds_read_b64_tr_b16 a[20:21], v1 offset:57344
  v_mfma_f32_16x16x32_bf16 v[40:43], a[36:39], a[160:163], v[40:43]
  ds_read_b64_tr_b16 a[22:23], v1 offset:61440
  s_waitcnt lgkmcnt(8)
  v_mfma_f32_16x16x32_bf16 v[48:51], a[40:43], a[160:163], v[48:51]
  ds_read_b64_tr_b16 a[8:9], v2 offset:49152
  v_mfma_f32_16x16x32_bf16 v[48:51], a[56:59], a[168:171], v[48:51]
  ds_read_b64_tr_b16 a[10:11], v2 offset:53248
  v_mfma_f32_16x16x32_bf16 v[52:55], a[56:59], a[172:175], v[52:55]
  ds_read_b64_tr_b16 a[24:25], v2 offset:57344
  v_mfma_f32_16x16x32_bf16 v[52:55], a[40:43], a[164:167], v[52:55]
  ds_read_b64_tr_b16 a[26:27], v2 offset:61440
  v_mfma_f32_16x16x32_bf16 v[60:63], a[44:47], a[164:167], v[60:63]
  ds_read_b64_tr_b16 a[12:13], v3 offset:49152
  v_mfma_f32_16x16x32_bf16 v[60:63], a[60:63], a[172:175], v[60:63]
  ds_read_b64_tr_b16 a[14:15], v3 offset:53248
  v_mfma_f32_16x16x32_bf16 v[56:59], a[60:63], a[168:171], v[56:59]
  ds_read_b64_tr_b16 a[28:29], v3 offset:57344
  v_mfma_f32_16x16x32_bf16 v[56:59], a[44:47], a[160:163], v[56:59]
  ds_read_b64_tr_b16 a[30:31], v3 offset:61440
  s_waitcnt vmcnt(0) lgkmcnt(8)
  v_mfma_f32_16x16x32_bf16 v[32:35], a[0:3], a[176:179], v[32:35]
  ds_read_b64_tr_b16 a[32:33], v4 offset:17408
  v_mfma_f32_16x16x32_bf16 v[32:35], a[16:19], a[184:187], v[32:35]
  ds_read_b64_tr_b16 a[34:35], v4 offset:21504
  v_mfma_f32_16x16x32_bf16 v[36:39], a[16:19], a[188:191], v[36:39]
  ds_read_b64_tr_b16 a[48:49], v4 offset:25600
  v_mfma_f32_16x16x32_bf16 v[36:39], a[0:3], a[180:183], v[36:39]
  ds_read_b64_tr_b16 a[50:51], v4 offset:29696
  v_mfma_f32_16x16x32_bf16 v[44:47], a[4:7], a[180:183], v[44:47]
  ds_read_b64_tr_b16 a[36:37], v5 offset:17408
  v_mfma_f32_16x16x32_bf16 v[44:47], a[20:23], a[188:191], v[44:47]
  ds_read_b64_tr_b16 a[38:39], v5 offset:21504
  v_mfma_f32_16x16x32_bf16 v[40:43], a[20:23], a[184:187], v[40:43]
  ds_read_b64_tr_b16 a[52:53], v5 offset:25600
  v_mfma_f32_16x16x32_bf16 v[40:43], a[4:7], a[176:179], v[40:43]
  ds_read_b64_tr_b16 a[54:55], v5 offset:29696
  s_waitcnt lgkmcnt(8)
  v_mfma_f32_16x16x32_bf16 v[48:51], a[8:11], a[176:179], v[48:51]
  ds_read_b64_tr_b16 a[40:41], v6 offset:17408
  v_mfma_f32_16x16x32_bf16 v[48:51], a[24:27], a[184:187], v[48:51]
  ds_read_b64_tr_b16 a[42:43], v6 offset:21504
  v_mfma_f32_16x16x32_bf16 v[52:55], a[24:27], a[188:191], v[52:55]
  ds_read_b64_tr_b16 a[56:57], v6 offset:25600
  v_mfma_f32_16x16x32_bf16 v[52:55], a[8:11], a[180:183], v[52:55]
  ds_read_b64_tr_b16 a[58:59], v6 offset:29696
  v_mfma_f32_16x16x32_bf16 v[60:63], a[12:15], a[180:183], v[60:63]
  ds_read_b64_tr_b16 a[44:45], v7 offset:17408
  v_mfma_f32_16x16x32_bf16 v[60:63], a[28:31], a[188:191], v[60:63]
  ds_read_b64_tr_b16 a[46:47], v7 offset:21504
  v_mfma_f32_16x16x32_bf16 v[56:59], a[28:31], a[184:187], v[56:59]
  ds_read_b64_tr_b16 a[60:61], v7 offset:25600
  v_mfma_f32_16x16x32_bf16 v[56:59], a[12:15], a[176:179], v[56:59]
  ds_read_b64_tr_b16 a[62:63], v7 offset:29696
  s_waitcnt lgkmcnt(8)
  v_mfma_f32_16x16x32_bf16 v[64:67], a[32:35], a[208:211], v[64:67]
  s_lshl_b32 s45, s2, 2
  ds_read_b64_tr_b16 a[0:1], v4 offset:33792
  s_add_u32 s45, s45, s40
  v_mfma_f32_16x16x32_bf16 v[64:67], a[48:51], a[216:219], v[64:67]
  s_lshl_b32 s45, s45, 12
  ds_read_b64_tr_b16 a[2:3], v4 offset:37888
  s_xor_b32 s44, s45, 32768
  v_mfma_f32_16x16x32_bf16 v[68:71], a[48:51], a[220:223], v[68:71]
  s_add_u32 s43, s42, 28311552
  ds_read_b64_tr_b16 a[16:17], v4 offset:41984
  s_add_u32 s44, s44, s43
  v_mfma_f32_16x16x32_bf16 v[68:71], a[32:35], a[212:215], v[68:71]
  s_add_u32 s45, s45, s43
  ds_read_b64_tr_b16 a[18:19], v4 offset:46080
  v_cvt_pk_bf16_f32 v16, v32, v33
  v_mfma_f32_16x16x32_bf16 v[76:79], a[36:39], a[212:215], v[76:79]
  ds_read_b64_tr_b16 a[4:5], v5 offset:33792
  v_cvt_pk_bf16_f32 v17, v34, v35
  v_mfma_f32_16x16x32_bf16 v[76:79], a[52:55], a[220:223], v[76:79]
  ds_read_b64_tr_b16 a[6:7], v5 offset:37888
  v_cvt_pk_bf16_f32 v18, v40, v41
  v_cvt_pk_bf16_f32 v19, v42, v43
  v_mfma_f32_16x16x32_bf16 v[72:75], a[52:55], a[216:219], v[72:75]
  buffer_store_dwordx4 v[16:19], v8, s[4:7], s44 offen offset:0 sc1
  ds_read_b64_tr_b16 a[20:21], v5 offset:41984
  v_cvt_pk_bf16_f32 v24, v36, v37
  v_cvt_pk_bf16_f32 v25, v38, v39
  v_mfma_f32_16x16x32_bf16 v[72:75], a[36:39], a[208:211], v[72:75]
  s_waitcnt lgkmcnt(7)
  ds_read_b64_tr_b16 a[22:23], v5 offset:46080
  v_cvt_pk_bf16_f32 v26, v44, v45
  v_cvt_pk_bf16_f32 v27, v46, v47
  v_mfma_f32_16x16x32_bf16 v[80:83], a[40:43], a[208:211], v[80:83]
  ds_read_b64_tr_b16 a[8:9], v6 offset:33792
  buffer_store_dwordx4 v[24:27], v8, s[4:7], s44 offen offset:2048 sc1
  v_cvt_pk_bf16_f32 v20, v48, v49
  v_mfma_f32_16x16x32_bf16 v[80:83], a[56:59], a[216:219], v[80:83]
  ds_read_b64_tr_b16 a[10:11], v6 offset:37888
  v_cvt_pk_bf16_f32 v21, v50, v51
  v_mfma_f32_16x16x32_bf16 v[84:87], a[56:59], a[220:223], v[84:87]
  ds_read_b64_tr_b16 a[24:25], v6 offset:41984
  v_cvt_pk_bf16_f32 v22, v56, v57
  v_cvt_pk_bf16_f32 v23, v58, v59
  v_mfma_f32_16x16x32_bf16 v[84:87], a[40:43], a[212:215], v[84:87]
  buffer_store_dwordx4 v[20:23], v8, s[4:7], s44 offen offset:1024 sc1
  ds_read_b64_tr_b16 a[26:27], v6 offset:46080
  v_cvt_pk_bf16_f32 v28, v52, v53
  v_cvt_pk_bf16_f32 v29, v54, v55
  v_mfma_f32_16x16x32_bf16 v[92:95], a[44:47], a[212:215], v[92:95]
  ds_read_b64_tr_b16 a[12:13], v7 offset:33792
  v_cvt_pk_bf16_f32 v30, v60, v61
  v_cvt_pk_bf16_f32 v31, v62, v63
  v_mfma_f32_16x16x32_bf16 v[92:95], a[60:63], a[220:223], v[92:95]
  ds_read_b64_tr_b16 a[14:15], v7 offset:37888
  buffer_store_dwordx4 v[28:31], v8, s[4:7], s44 offen offset:3072 sc1
  v_mfma_f32_16x16x32_bf16 v[88:91], a[60:63], a[216:219], v[88:91]
  ds_read_b64_tr_b16 a[28:29], v7 offset:41984
  v_mfma_f32_16x16x32_bf16 v[88:91], a[44:47], a[208:211], v[88:91]
  ds_read_b64_tr_b16 a[30:31], v7 offset:46080
  s_waitcnt lgkmcnt(8)
  v_mfma_f32_16x16x32_bf16 v[64:67], a[0:3], a[224:227], v[64:67]
  ds_read_b64_tr_b16 a[32:33], v4 offset:50176
  v_and_b32 v148, 15, v253
  v_mfma_f32_16x16x32_bf16 v[64:67], a[16:19], a[232:235], v[64:67]
  ds_read_b64_tr_b16 a[34:35], v4 offset:54272
  v_lshrrev_b32 v149, 4, v253
  v_mfma_f32_16x16x32_bf16 v[68:71], a[16:19], a[236:239], v[68:71]
  ds_read_b64_tr_b16 a[48:49], v4 offset:58368
  v_lshrrev_b32 v128, 2, v148
  v_mfma_f32_16x16x32_bf16 v[68:71], a[0:3], a[228:231], v[68:71]
  ds_read_b64_tr_b16 a[50:51], v4 offset:62464
  v_cmp_eq_u32 vcc, v128, v149
  v_mfma_f32_16x16x32_bf16 v[76:79], a[4:7], a[228:231], v[76:79]
  ds_read_b64_tr_b16 a[36:37], v5 offset:50176
  v_and_b32 v128, 3, v148
  v_mfma_f32_16x16x32_bf16 v[76:79], a[20:23], a[236:239], v[76:79]
  ds_read_b64_tr_b16 a[38:39], v5 offset:54272
  v_lshlrev_b32 v148, 3, v148
  v_mfma_f32_16x16x32_bf16 v[72:75], a[20:23], a[232:235], v[72:75]
  ds_read_b64_tr_b16 a[52:53], v5 offset:58368
  v_mov_b32 v149, 0x7ffffff0
  v_mfma_f32_16x16x32_bf16 v[72:75], a[4:7], a[224:227], v[72:75]
  s_waitcnt lgkmcnt(7)
  ds_read_b64_tr_b16 a[54:55], v5 offset:62464
  v_cndmask_b32 v148, v149, v148, vcc
  v_mfma_f32_16x16x32_bf16 v[80:83], a[8:11], a[224:227], v[80:83]
  ds_read_b64_tr_b16 a[40:41], v6 offset:50176
  v_cmp_eq_u32 s[66:67], 1, v128
  v_mfma_f32_16x16x32_bf16 v[80:83], a[24:27], a[232:235], v[80:83]
  ds_read_b64_tr_b16 a[42:43], v6 offset:54272
  v_cmp_eq_u32 s[68:69], 2, v128
  v_mfma_f32_16x16x32_bf16 v[84:87], a[24:27], a[236:239], v[84:87]
  ds_read_b64_tr_b16 a[56:57], v6 offset:58368
  v_cmp_eq_u32 s[70:71], 3, v128
  v_mfma_f32_16x16x32_bf16 v[84:87], a[8:11], a[228:231], v[84:87]
  ds_read_b64_tr_b16 a[58:59], v6 offset:62464
  v_mov_b32 v128, 0x3f803f80
  v_mfma_f32_16x16x32_bf16 v[92:95], a[12:15], a[228:231], v[92:95]
  ds_read_b64_tr_b16 a[44:45], v7 offset:50176
  v_mov_b32 v129, 0x3f803f80
  v_mfma_f32_16x16x32_bf16 v[92:95], a[28:31], a[236:239], v[92:95]
  ds_read_b64_tr_b16 a[46:47], v7 offset:54272
  v_mov_b32 v130, 0x3f803f80
  v_mfma_f32_16x16x32_bf16 v[88:91], a[28:31], a[232:235], v[88:91]
  ds_read_b64_tr_b16 a[60:61], v7 offset:58368
  v_mov_b32 v131, 0x3f803f80
  v_mfma_f32_16x16x32_bf16 v[88:91], a[12:15], a[224:227], v[88:91]
  ds_read_b64_tr_b16 a[62:63], v7 offset:62464
  s_waitcnt lgkmcnt(8)
  v_mfma_f32_16x16x32_bf16 v[64:67], a[32:35], a[240:243], v[64:67]
  ds_read_b64_tr_b16 a[0:1], v0 offset:1024
  v_and_b32 v152, 15, v253
  v_lshrrev_b32 v153, 4, v253
  v_mfma_f32_16x16x32_bf16 v[64:67], a[48:51], a[248:251], v[64:67]
  ds_read_b64_tr_b16 a[2:3], v0 offset:5120
  v_lshrrev_b32 v155, 1, v153
  v_and_b32 v153, 1, v153
  v_mfma_f32_16x16x32_bf16 v[68:71], a[48:51], a[252:255], v[68:71]
  ds_read_b64_tr_b16 a[16:17], v0 offset:9216
  v_lshl_add_u32 v153, v153, 1, v155
  v_and_b32 v155, 7, v253
  v_mfma_f32_16x16x32_bf16 v[68:71], a[32:35], a[244:247], v[68:71]
  ds_read_b64_tr_b16 a[18:19], v0 offset:13312
  v_xor_b32 v153, v153, v155
  v_lshlrev_b32 v153, 4, v153
  v_mfma_f32_16x16x32_bf16 v[76:79], a[36:39], a[244:247], v[76:79]
  s_lshl_b32 s43, s40, 12
  ds_read_b64_tr_b16 a[4:5], v1 offset:1024
  v_lshl_add_u32 v152, v152, 7, v153
  v_mfma_f32_16x16x32_bf16 v[76:79], a[52:55], a[252:255], v[76:79]
  ds_read_b64_tr_b16 a[6:7], v1 offset:5120
  v_add_u32 v152, s43, v152
  v_xor_b32 v153, 64, v152
  v_mfma_f32_16x16x32_bf16 v[72:75], a[52:55], a[248:251], v[72:75]
  ds_read_b64_tr_b16 a[20:21], v1 offset:9216
  v_lshrrev_b32 v156, 3, v253
  v_xor_b32 v154, v156, v155
  v_mfma_f32_16x16x32_bf16 v[72:75], a[36:39], a[240:243], v[72:75]
  s_waitcnt lgkmcnt(7)
  ds_read_b64_tr_b16 a[22:23], v1 offset:13312
  v_lshlrev_b32 v154, 4, v154
  v_lshl_add_u32 v154, v156, 7, v154
  v_mfma_f32_16x16x32_bf16 v[80:83], a[40:43], a[240:243], v[80:83]
  ds_read_b64_tr_b16 a[8:9], v2 offset:1024
  v_add_u32 v154, s43, v154
  v_mfma_f32_16x16x32_bf16 v[80:83], a[56:59], a[248:251], v[80:83]
  ds_read_b64_tr_b16 a[10:11], v2 offset:5120
  v_lshlrev_b32 v155, 4, v155
  v_mfma_f32_16x16x32_bf16 v[84:87], a[56:59], a[252:255], v[84:87]
  ds_read_b64_tr_b16 a[24:25], v2 offset:9216
  v_lshl_add_u32 v155, v156, 12, v155
  v_mfma_f32_16x16x32_bf16 v[84:87], a[40:43], a[244:247], v[84:87]
  ds_read_b64_tr_b16 a[26:27], v2 offset:13312
  v_mfma_f32_16x16x32_bf16 v[92:95], a[44:47], a[244:247], v[92:95]
  ds_read_b64_tr_b16 a[12:13], v3 offset:1024
  v_mfma_f32_16x16x32_bf16 v[92:95], a[60:63], a[252:255], v[92:95]
  ds_read_b64_tr_b16 a[14:15], v3 offset:5120
  v_mfma_f32_16x16x32_bf16 v[88:91], a[60:63], a[248:251], v[88:91]
  ds_read_b64_tr_b16 a[28:29], v3 offset:9216
  v_mfma_f32_16x16x32_bf16 v[88:91], a[44:47], a[240:243], v[88:91]
  ds_read_b64_tr_b16 a[30:31], v3 offset:13312
  s_waitcnt lgkmcnt(8)
  v_mfma_f32_16x16x32_bf16 v[64:67], a[0:3], a[128:131], v[64:67]
  s_add_u32 s46, s76, 41943040
  ds_read_b64_tr_b16 a[32:33], v0 offset:17408
  s_add_u32 s47, s46, 32768
  v_mfma_f32_16x16x32_bf16 v[64:67], a[16:19], a[136:139], v[64:67]
  s_lshl_b32 s48, s49, 11
  ds_read_b64_tr_b16 a[34:35], v0 offset:21504
  s_lshl_b32 s43, s53, 7
  v_mfma_f32_16x16x32_bf16 v[68:71], a[16:19], a[140:143], v[68:71]
  s_add_u32 s48, s48, s43
  ds_read_b64_tr_b16 a[48:49], v0 offset:25600
  s_add_u32 s48, s48, 69206016
  v_mfma_f32_16x16x32_bf16 v[68:71], a[0:3], a[132:135], v[68:71]
  s_and_b32 s57, s49, 63
  ds_read_b64_tr_b16 a[50:51], v0 offset:29696
  s_lshl_b32 s57, s57, 16
  v_mfma_f32_16x16x32_bf16 v[76:79], a[4:7], a[132:135], v[76:79]
  s_add_u32 s57, s57, s43
  ds_read_b64_tr_b16 a[36:37], v1 offset:17408
  s_lshr_b32 s43, s49, 6
  v_mfma_f32_16x16x32_bf16 v[76:79], a[20:23], a[140:143], v[76:79]
  s_lshl_b32 s43, s43, 11
  ds_read_b64_tr_b16 a[38:39], v1 offset:21504
  s_add_u32 s57, s57, s43
  v_mfma_f32_16x16x32_bf16 v[72:75], a[20:23], a[136:139], v[72:75]
  s_and_b32 s43, s53, 0
  ds_read_b64_tr_b16 a[52:53], v1 offset:25600
  s_mul_i32 s77, s52, 1
  v_mfma_f32_16x16x32_bf16 v[72:75], a[4:7], a[128:131], v[72:75]
  s_add_u32 s77, s77, s43
  ds_read_b64_tr_b16 a[54:55], v1 offset:29696
  s_lshl_b32 s77, s77, 7
  s_waitcnt lgkmcnt(8)
  v_mfma_f32_16x16x32_bf16 v[80:83], a[8:11], a[128:131], v[80:83]
  ds_read_b64_tr_b16 a[40:41], v2 offset:17408
  s_add_u32 s77, s77, 27815936
  v_mfma_f32_16x16x32_bf16 v[80:83], a[24:27], a[136:139], v[80:83]
  ds_read_b64_tr_b16 a[42:43], v2 offset:21504
  v_mfma_f32_16x16x32_bf16 v[84:87], a[24:27], a[140:143], v[84:87]
  ds_read_b64_tr_b16 a[56:57], v2 offset:25600
  v_mfma_f32_16x16x32_bf16 v[84:87], a[8:11], a[132:135], v[84:87]
  ds_read_b64_tr_b16 a[58:59], v2 offset:29696
  v_mfma_f32_16x16x32_bf16 v[92:95], a[12:15], a[132:135], v[92:95]
  ds_read_b64_tr_b16 a[44:45], v3 offset:17408
  v_mfma_f32_16x16x32_bf16 v[92:95], a[28:31], a[140:143], v[92:95]
  ds_read_b64_tr_b16 a[46:47], v3 offset:21504
  v_mfma_f32_16x16x32_bf16 v[88:91], a[28:31], a[136:139], v[88:91]
  ds_read_b64_tr_b16 a[60:61], v3 offset:25600
  v_mfma_f32_16x16x32_bf16 v[88:91], a[12:15], a[128:131], v[88:91]
  ds_read_b64_tr_b16 a[62:63], v3 offset:29696
  s_waitcnt lgkmcnt(8)
  v_mfma_f32_16x16x32_bf16 v[64:67], a[32:35], a[144:147], v[64:67]
  ds_read_b64_tr_b16 a[0:1], v0 offset:33792
  v_mfma_f32_16x16x32_bf16 v[64:67], a[48:51], a[152:155], v[64:67]
  ds_read_b64_tr_b16 a[2:3], v0 offset:37888
  v_mfma_f32_16x16x32_bf16 v[68:71], a[48:51], a[156:159], v[68:71]
  ds_read_b64_tr_b16 a[16:17], v0 offset:41984
  v_mfma_f32_16x16x32_bf16 v[68:71], a[32:35], a[148:151], v[68:71]
  ds_read_b64_tr_b16 a[18:19], v0 offset:46080
  v_mfma_f32_16x16x32_bf16 v[76:79], a[36:39], a[148:151], v[76:79]
  ds_read_b64_tr_b16 a[4:5], v1 offset:33792
  buffer_load_dwordx4 v[96:99], v8, s[4:7], s45 offen offset:0 sc1
  v_mfma_f32_16x16x32_bf16 v[76:79], a[52:55], a[156:159], v[76:79]
  buffer_load_dwordx4 v[100:103], v8, s[4:7], s45 offen offset:1024 sc1
  ds_read_b64_tr_b16 a[6:7], v1 offset:37888
  v_mfma_f32_16x16x32_bf16 v[72:75], a[52:55], a[152:155], v[72:75]
  ds_read_b64_tr_b16 a[20:21], v1 offset:41984
  buffer_load_dwordx4 v[104:107], v8, s[4:7], s45 offen offset:2048 sc1
  buffer_load_dwordx4 v[108:111], v8, s[4:7], s45 offen offset:3072 sc1
  v_mfma_f32_16x16x32_bf16 v[72:75], a[36:39], a[144:147], v[72:75]
  ds_read_b64_tr_b16 a[22:23], v1 offset:46080
  s_waitcnt lgkmcnt(8)
  v_mfma_f32_16x16x32_bf16 v[80:83], a[40:43], a[144:147], v[80:83]
  ds_read_b64_tr_b16 a[8:9], v2 offset:33792
  v_mfma_f32_16x16x32_bf16 v[80:83], a[56:59], a[152:155], v[80:83]
  ds_read_b64_tr_b16 a[10:11], v2 offset:37888
  v_mfma_f32_16x16x32_bf16 v[84:87], a[56:59], a[156:159], v[84:87]
  ds_read_b64_tr_b16 a[24:25], v2 offset:41984
  v_mfma_f32_16x16x32_bf16 v[84:87], a[40:43], a[148:151], v[84:87]
  ds_read_b64_tr_b16 a[26:27], v2 offset:46080
  v_mfma_f32_16x16x32_bf16 v[92:95], a[44:47], a[148:151], v[92:95]
  ds_read_b64_tr_b16 a[12:13], v3 offset:33792
  v_mfma_f32_16x16x32_bf16 v[92:95], a[60:63], a[156:159], v[92:95]
  ds_read_b64_tr_b16 a[14:15], v3 offset:37888
  v_mfma_f32_16x16x32_bf16 v[88:91], a[60:63], a[152:155], v[88:91]
  ds_read_b64_tr_b16 a[28:29], v3 offset:41984
  v_mfma_f32_16x16x32_bf16 v[88:91], a[44:47], a[144:147], v[88:91]
  ds_read_b64_tr_b16 a[30:31], v3 offset:46080
  s_waitcnt lgkmcnt(8)
  v_mfma_f32_16x16x32_bf16 v[64:67], a[0:3], a[160:163], v[64:67]
  ds_read_b64_tr_b16 a[32:33], v0 offset:50176
  v_mfma_f32_16x16x32_bf16 v[64:67], a[16:19], a[168:171], v[64:67]
  ds_read_b64_tr_b16 a[34:35], v0 offset:54272
  v_mfma_f32_16x16x32_bf16 v[68:71], a[16:19], a[172:175], v[68:71]
  ds_read_b64_tr_b16 a[48:49], v0 offset:58368
  v_mfma_f32_16x16x32_bf16 v[68:71], a[0:3], a[164:167], v[68:71]
  ds_read_b64_tr_b16 a[50:51], v0 offset:62464
  v_mfma_f32_16x16x32_bf16 v[76:79], a[4:7], a[164:167], v[76:79]
  ds_read_b64_tr_b16 a[36:37], v1 offset:50176
  v_mfma_f32_16x16x32_bf16 v[76:79], a[20:23], a[172:175], v[76:79]
  ds_read_b64_tr_b16 a[38:39], v1 offset:54272
  v_mfma_f32_16x16x32_bf16 v[72:75], a[20:23], a[168:171], v[72:75]
  ds_read_b64_tr_b16 a[52:53], v1 offset:58368
  v_mfma_f32_16x16x32_bf16 v[72:75], a[4:7], a[160:163], v[72:75]
  ds_read_b64_tr_b16 a[54:55], v1 offset:62464
  s_waitcnt lgkmcnt(8)
  v_mfma_f32_16x16x32_bf16 v[80:83], a[8:11], a[160:163], v[80:83]
  ds_read_b64_tr_b16 a[40:41], v2 offset:50176
  v_mfma_f32_16x16x32_bf16 v[80:83], a[24:27], a[168:171], v[80:83]
  ds_read_b64_tr_b16 a[42:43], v2 offset:54272
  v_mfma_f32_16x16x32_bf16 v[84:87], a[24:27], a[172:175], v[84:87]
  ds_read_b64_tr_b16 a[56:57], v2 offset:58368
  v_mfma_f32_16x16x32_bf16 v[84:87], a[8:11], a[164:167], v[84:87]
  ds_read_b64_tr_b16 a[58:59], v2 offset:62464
  v_mfma_f32_16x16x32_bf16 v[92:95], a[12:15], a[164:167], v[92:95]
  ds_read_b64_tr_b16 a[44:45], v3 offset:50176
  v_mfma_f32_16x16x32_bf16 v[92:95], a[28:31], a[172:175], v[92:95]
  ds_read_b64_tr_b16 a[46:47], v3 offset:54272
  v_mfma_f32_16x16x32_bf16 v[88:91], a[28:31], a[168:171], v[88:91]
  ds_read_b64_tr_b16 a[60:61], v3 offset:58368
  v_mfma_f32_16x16x32_bf16 v[88:91], a[12:15], a[160:163], v[88:91]
  s_waitcnt vmcnt(0)
  ds_read_b64_tr_b16 a[62:63], v3 offset:62464
  v_max3_u32 v112, v96, v97, v98
  v_max3_u32 v113, v99, v100, v101
  v_max3_u32 v112, v112, v102, v103
  v_max3_u32 v113, v113, v104, v105
  v_max3_u32 v112, v112, v106, v107
  v_max3_u32 v113, v113, v108, v109
  v_max3_u32 v112, v112, v110, v111
  v_max_u32 v112, v112, v113
  v_cmp_eq_u32 vcc, -1, v112
  s_cbranch_vccnz Lp4_mb_c
Lp4_mb_r:
  s_waitcnt lgkmcnt(8)
  v_mfma_f32_16x16x32_bf16 v[64:67], a[32:35], a[176:179], v[64:67]
  v_lshlrev_b32 v32, 16, v96
  v_and_b32 v33, 0xffff0000, v96
  v_mfma_f32_16x16x32_bf16 v[64:67], a[48:51], a[184:187], v[64:67]
  v_lshlrev_b32 v34, 16, v97
  v_and_b32 v35, 0xffff0000, v97
  v_mfma_f32_16x16x32_bf16 v[68:71], a[48:51], a[188:191], v[68:71]
  v_lshlrev_b32 v40, 16, v98
  v_and_b32 v41, 0xffff0000, v98
  v_mfma_f32_16x16x32_bf16 v[68:71], a[32:35], a[180:183], v[68:71]
  v_lshlrev_b32 v42, 16, v99
  v_and_b32 v43, 0xffff0000, v99
  v_mfma_f32_16x16x32_bf16 v[76:79], a[36:39], a[180:183], v[76:79]
  v_lshlrev_b32 v36, 16, v104
  v_and_b32 v37, 0xffff0000, v104
  v_mfma_f32_16x16x32_bf16 v[76:79], a[52:55], a[188:191], v[76:79]
  v_lshlrev_b32 v38, 16, v105
  v_and_b32 v39, 0xffff0000, v105
  v_mfma_f32_16x16x32_bf16 v[72:75], a[52:55], a[184:187], v[72:75]
  v_lshlrev_b32 v44, 16, v106
  v_and_b32 v45, 0xffff0000, v106
  v_mfma_f32_16x16x32_bf16 v[72:75], a[36:39], a[176:179], v[72:75]
  s_waitcnt lgkmcnt(0)
  v_lshlrev_b32 v46, 16, v107
  v_and_b32 v47, 0xffff0000, v107
  v_mfma_f32_16x16x32_bf16 v[80:83], a[40:43], a[176:179], v[80:83]
  v_lshlrev_b32 v48, 16, v100
  v_and_b32 v49, 0xffff0000, v100
  v_mfma_f32_16x16x32_bf16 v[80:83], a[56:59], a[184:187], v[80:83]
  s_barrier
  v_lshlrev_b32 v50, 16, v101
  v_mfma_f32_16x16x32_bf16 v[84:87], a[56:59], a[188:191], v[84:87]
  v_and_b32 v51, 0xffff0000, v101
  v_lshlrev_b32 v56, 16, v102
  v_mfma_f32_16x16x32_bf16 v[84:87], a[40:43], a[180:183], v[84:87]
  v_and_b32 v57, 0xffff0000, v102
  v_lshlrev_b32 v58, 16, v103
  v_mfma_f32_16x16x32_bf16 v[92:95], a[44:47], a[180:183], v[92:95]
  v_and_b32 v59, 0xffff0000, v103
  v_lshlrev_b32 v52, 16, v108
  v_mfma_f32_16x16x32_bf16 v[92:95], a[60:63], a[188:191], v[92:95]
  v_and_b32 v53, 0xffff0000, v108
  v_lshlrev_b32 v54, 16, v109
  v_mfma_f32_16x16x32_bf16 v[88:91], a[60:63], a[184:187], v[88:91]
  v_and_b32 v55, 0xffff0000, v109
  v_lshlrev_b32 v60, 16, v110
  v_mfma_f32_16x16x32_bf16 v[88:91], a[44:47], a[176:179], v[88:91]
  v_and_b32 v61, 0xffff0000, v110
  v_lshlrev_b32 v62, 16, v111
  v_and_b32 v63, 0xffff0000, v111
  v_pk_add_f32 v[68:69], v[68:69], v[36:37]
  v_pk_add_f32 v[70:71], v[70:71], v[38:39]
  v_pk_add_f32 v[76:77], v[76:77], v[44:45]
  v_pk_add_f32 v[78:79], v[78:79], v[46:47]
  v_cvt_pk_bf16_f32 v24, v68, v69
  v_cvt_pk_bf16_f32 v25, v70, v71
  v_cvt_pk_bf16_f32 v26, v76, v77
  v_cvt_pk_bf16_f32 v27, v78, v79
  v_pk_add_f32 v[64:65], v[64:65], v[32:33]
  v_pk_add_f32 v[66:67], v[66:67], v[34:35]
  v_pk_add_f32 v[72:73], v[72:73], v[40:41]
  v_pk_add_f32 v[74:75], v[74:75], v[42:43]
  v_cvt_pk_bf16_f32 v16, v64, v65
  v_cvt_pk_bf16_f32 v17, v66, v67
  v_cvt_pk_bf16_f32 v18, v72, v73
  v_cvt_pk_bf16_f32 v19, v74, v75
  v_pk_add_f32 v[84:85], v[84:85], v[52:53]
  v_pk_add_f32 v[86:87], v[86:87], v[54:55]
  v_pk_add_f32 v[92:93], v[92:93], v[60:61]
  v_pk_add_f32 v[94:95], v[94:95], v[62:63]
  v_cvt_pk_bf16_f32 v28, v84, v85
  v_cvt_pk_bf16_f32 v29, v86, v87
  v_cvt_pk_bf16_f32 v30, v92, v93
  v_cvt_pk_bf16_f32 v31, v94, v95
  v_pk_add_f32 v[80:81], v[80:81], v[48:49]
  v_pk_add_f32 v[82:83], v[82:83], v[50:51]
  v_pk_add_f32 v[88:89], v[88:89], v[56:57]
  v_pk_add_f32 v[90:91], v[90:91], v[58:59]
  v_cvt_pk_bf16_f32 v20, v80, v81
  v_cvt_pk_bf16_f32 v21, v82, v83
  v_cvt_pk_bf16_f32 v22, v88, v89
  v_cvt_pk_bf16_f32 v23, v90, v91
  s_cmp_eq_u32 s41, 0
  s_cbranch_scc1 Lp4_mid
  v_permlane16_swap_b32 v16, v18
  v_permlane16_swap_b32 v17, v19
  v_permlane16_swap_b32 v20, v22
  v_permlane16_swap_b32 v21, v23
  ds_write_b128 v152, v[16:19] offset:0
  ds_write_b128 v153, v[20:23] offset:0
  ds_read_b128 v[96:99], v154 offset:0
  ds_read_b128 v[100:103], v154 offset:1024
  v_permlane16_swap_b32 v24, v26
  v_permlane16_swap_b32 v25, v27
  v_permlane16_swap_b32 v28, v30
  v_permlane16_swap_b32 v29, v31
  ds_write_b128 v152, v[24:27] offset:2048
  ds_write_b128 v153, v[28:31] offset:2048
  ds_read_b128 v[104:107], v154 offset:2048
  ds_read_b128 v[108:111], v154 offset:3072
  s_waitcnt lgkmcnt(5)
  buffer_store_dwordx4 v[96:99], v155, s[32:35], s57 offen nt
  s_add_u32 s57, s57, 32768
  s_waitcnt lgkmcnt(4)
  buffer_store_dwordx4 v[100:103], v155, s[32:35], s57 offen nt
  s_add_u32 s57, s57, 32768
  s_waitcnt lgkmcnt(1)
  buffer_store_dwordx4 v[104:107], v155, s[32:35], s57 offen nt
  s_add_u32 s57, s57, 32768
  s_waitcnt lgkmcnt(0)
  buffer_store_dwordx4 v[108:111], v155, s[32:35], s57 offen nt
  s_add_u32 s57, s57, 32768
  s_endpgm
Lp4_mid:
  buffer_store_dwordx4 v[16:19], v8, s[4:7], s46 offen offset:0 sc1
  buffer_store_dwordx4 v[24:27], v8, s[4:7], s47 offen offset:0 sc1
  v_mfma_f32_16x16x32_bf16 v[144:147], v[24:27], v[24:27], 0
  v_mfma_f32_16x16x32_bf16 v[140:143], v[128:131], v[24:27], 0
  v_mfma_f32_16x16x32_bf16 v[136:139], v[16:19], v[16:19], 0
  v_mfma_f32_16x16x32_bf16 v[132:135], v[128:131], v[16:19], 0
  buffer_store_dwordx4 v[20:23], v8, s[4:7], s46 offen offset:1024 sc1
  v_mfma_f32_16x16x32_bf16 v[144:147], v[28:31], v[28:31], v[144:147]
  buffer_store_dwordx4 v[28:31], v8, s[4:7], s47 offen offset:1024 sc1
  v_mfma_f32_16x16x32_bf16 v[140:143], v[128:131], v[28:31], v[140:143]
  v_mfma_f32_16x16x32_bf16 v[136:139], v[20:23], v[20:23], v[136:139]
  v_mfma_f32_16x16x32_bf16 v[132:135], v[128:131], v[20:23], v[132:135]
  s_nop 5
  v_cndmask_b32 v141, v144, v145, s[66:67]
  v_cndmask_b32 v141, v141, v146, s[68:69]
  v_cndmask_b32 v141, v141, v147, s[70:71]
  buffer_store_dwordx2 v[140:141], v148, s[4:7], s48 offen offset:2048 sc1
  v_cndmask_b32 v133, v136, v137, s[66:67]
  v_cndmask_b32 v133, v133, v138, s[68:69]
  v_cndmask_b32 v133, v133, v139, s[70:71]
  buffer_store_dwordx2 v[132:133], v148, s[4:7], s48 offen offset:0 sc1
  s_mov_b32 s41, 1
  s_mov_b32 s42, 0x2800000
  s_mov_b32 s28, s4
  s_mov_b32 s29, s5
  s_mov_b32 s30, 0x10000000
  s_lshr_b32 s57, s40, 1
  s_and_b32 s58, s40, 1
  s_lshl_b32 s71, s50, 3
  s_add_u32 s67, s50, s51
  s_and_b32 s67, s67, 0
  s_lshl_b32 s67, s67, 3
  s_lshl_b32 s62, s40, 12
  s_mul_i32 s63, s40, 6144
  s_add_u32 s76, s63, 139264
  s_and_b32 s43, s50, 7
  s_cmp_lg_u32 s43, 0
  s_cselect_b32 s43, 1, 0
  s_sub_u32 s72, s71, s43
  v_lshrrev_b32 v2, 3, v253
  v_bfe_u32 v3, v253, 1, 2
  v_lshrrev_b32 v4, 4, v253
  v_xor_b32 v3, v3, v4
  v_and_b32 v5, 1, v253
  v_mov_b32 v6, v2
  s_lshl_b32 s43, s40, 4
  v_mul_u32_u24 v6, 6144, v6
  v_lshl_add_u32 v6, v3, 5, v6
  v_lshl_add_u32 v124, v5, 4, v6
  v_add_u32 v125, 48128, v124
  s_mul_i32 s43, s43, 6144
  s_lshl_b32 s60, s51, 7
  s_add_u32 s60, s60, s43
  v_and_b32 v3, 7, v253
  s_lshl_b32 s43, s40, 1
  s_add_u32 s43, s43, s71
  v_lshlrev_b32 v120, 4, v253
  v_mov_b32 v121, v120
  v_add_u32 v122, 30720, v120
  v_add_u32 v123, 30720, v120
  v_lshlrev_b32 v5, 8, v2
  v_lshl_add_u32 v5, v3, 4, v5
  v_add_u32 v126, 128, v5
  s_lshl_b32 s43, s43, 15
  s_mov_b32 s44, 41943040
  s_add_u32 s59, s43, s44
  s_lshl_b32 s43, s72, 15
  s_add_u32 s73, s43, s44
  s_movk_i32 s61, 2048
  v_and_b32 v2, 15, v253
  v_lshrrev_b32 v3, 4, v253
  v_and_b32 v4, 7, v253
  v_lshlrev_b32 v6, 4, v253
  v_add_u32 v7, 1024, v6
  v_lshlrev_b32 v5, 7, v3
  v_lshl_add_u32 v8, v4, 4, v5
  v_add_u32 v9, 512, v8
  s_lshl_b32 s43, s57, 13
  s_add_u32 s43, s43, 73728
  v_add_u32 v112, s43, v6
  v_add_u32 v113, s43, v7
  v_add_u32 v114, 122880, v8
  v_add_u32 v115, 122880, v9
  s_lshl_b32 s43, s52, 3
  s_lshl_b32 s44, s40, 1
  s_add_u32 s43, s43, s44
  v_mov_b32 v187, v6
  s_lshl_b32 s43, s43, 15
  s_lshl_b32 s44, s53, 11
  s_add_u32 s43, s43, s44
  s_add_u32 s64, s43, 41943040
  v_lshrrev_b32 v2, 2, v253
  v_bfe_u32 v3, v253, 3, 2
  v_and_b32 v4, 3, v253
  v_lshlrev_b32 v4, 3, v4
  v_lshl_add_u32 v4, v2, 7, v4
  s_lshl_b32 s43, s58, 1
  s_or_b32 s43, s43, s57
  v_xor_b32 v5, s43, v3
  v_lshl_add_u32 v116, v5, 5, v4
  v_xor_b32 v5, 1, v5
  v_lshl_add_u32 v117, v5, 5, v4
  v_add_u32 v118, 49152, v116
  v_add_u32 v119, 49152, v117
  s_mov_b32 s84, s16
  s_mov_b32 s85, s17
  s_mov_b32 s86, 7340032
  s_mov_b32 s87, 0x20000
  s_mov_b32 s3, 0
  s_mov_b32 s88, 63
  s_mov_b32 s100, 0
  v_mov_b32 v238, 0x40000000
  s_waitcnt vmcnt(0)
  s_barrier
  s_cmp_lg_u32 s40, 0
  s_cbranch_scc1 Lsig22
  v_mov_b32 v250, 1
  s_mov_b64 exec, 1
  buffer_atomic_add v250, v251, s[4:7], s77 offen sc1
  s_mov_b64 exec, -1
Lsig22:
  s_add_u32 s44, s67, 0
  s_and_b32 s44, s44, 15
  s_mul_i32 s45, s44, 393216
  s_add_u32 s69, s45, s60
  s_add_u32 s70, s69, 4096
  s_add_u32 m0, s63, 0
  s_nop 0
  buffer_load_dwordx4 v124, s[8:11], s69 offen offset:0  lds
  buffer_load_dwordx4 v125, s[8:11], s69 offen offset:1024  lds
  buffer_load_dwordx4 v124, s[8:11], s69 offen offset:2048  lds
  buffer_load_dwordx4 v125, s[8:11], s69 offen offset:3072  lds
  s_add_u32 m0, s63, 4096
  s_nop 0
  buffer_load_dwordx4 v124, s[8:11], s70 offen offset:0  lds
  buffer_load_dwordx4 v125, s[8:11], s70 offen offset:1024  lds
  s_add_u32 s44, s67, 1
  s_and_b32 s44, s44, 15
  s_mul_i32 s45, s44, 393216
  s_add_u32 s69, s45, s60
  s_add_u32 s70, s69, 4096
  s_add_u32 m0, s63, 24576
  s_nop 0
  buffer_load_dwordx4 v124, s[8:11], s69 offen offset:0  lds
  buffer_load_dwordx4 v125, s[8:11], s69 offen offset:1024  lds
  buffer_load_dwordx4 v124, s[8:11], s69 offen offset:2048  lds
  buffer_load_dwordx4 v125, s[8:11], s69 offen offset:3072  lds
  s_add_u32 m0, s63, 28672
  s_nop 0
  buffer_load_dwordx4 v124, s[8:11], s70 offen offset:0  lds
  buffer_load_dwordx4 v125, s[8:11], s70 offen offset:1024  lds
  s_add_u32 s44, s67, 2
  s_and_b32 s44, s44, 15
  s_mul_i32 s45, s44, 393216
  s_add_u32 s69, s45, s60
  s_add_u32 s70, s69, 4096
  s_add_u32 m0, s63, 49152
  s_nop 0
  buffer_load_dwordx4 v124, s[8:11], s69 offen offset:0  lds
  buffer_load_dwordx4 v125, s[8:11], s69 offen offset:1024  lds
  buffer_load_dwordx4 v124, s[8:11], s69 offen offset:2048  lds
  buffer_load_dwordx4 v125, s[8:11], s69 offen offset:3072  lds
  s_add_u32 m0, s63, 53248
  s_nop 0
  buffer_load_dwordx4 v124, s[8:11], s70 offen offset:0  lds
  buffer_load_dwordx4 v125, s[8:11], s70 offen offset:1024  lds
  v_pk_mul_f32 v[0:1], v[250:251], 0 op_sel:[1,0] op_sel_hi:[1,0]
  v_pk_mul_f32 v[2:3], v[250:251], 0 op_sel:[1,0] op_sel_hi:[1,0]
  v_pk_mul_f32 v[4:5], v[250:251], 0 op_sel:[1,0] op_sel_hi:[1,0]
  v_pk_mul_f32 v[6:7], v[250:251], 0 op_sel:[1,0] op_sel_hi:[1,0]
  v_pk_mul_f32 v[8:9], v[250:251], 0 op_sel:[1,0] op_sel_hi:[1,0]
  v_pk_mul_f32 v[10:11], v[250:251], 0 op_sel:[1,0] op_sel_hi:[1,0]
  v_pk_mul_f32 v[12:13], v[250:251], 0 op_sel:[1,0] op_sel_hi:[1,0]
  v_pk_mul_f32 v[14:15], v[250:251], 0 op_sel:[1,0] op_sel_hi:[1,0]
  v_pk_mul_f32 v[16:17], v[250:251], 0 op_sel:[1,0] op_sel_hi:[1,0]
  v_pk_mul_f32 v[18:19], v[250:251], 0 op_sel:[1,0] op_sel_hi:[1,0]
  v_pk_mul_f32 v[20:21], v[250:251], 0 op_sel:[1,0] op_sel_hi:[1,0]
  v_pk_mul_f32 v[22:23], v[250:251], 0 op_sel:[1,0] op_sel_hi:[1,0]
  v_pk_mul_f32 v[24:25], v[250:251], 0 op_sel:[1,0] op_sel_hi:[1,0]
  v_pk_mul_f32 v[26:27], v[250:251], 0 op_sel:[1,0] op_sel_hi:[1,0]
  v_pk_mul_f32 v[28:29], v[250:251], 0 op_sel:[1,0] op_sel_hi:[1,0]
  v_pk_mul_f32 v[30:31], v[250:251], 0 op_sel:[1,0] op_sel_hi:[1,0]
  v_pk_mul_f32 v[32:33], v[250:251], 0 op_sel:[1,0] op_sel_hi:[1,0]
  v_pk_mul_f32 v[34:35], v[250:251], 0 op_sel:[1,0] op_sel_hi:[1,0]
  v_pk_mul_f32 v[36:37], v[250:251], 0 op_sel:[1,0] op_sel_hi:[1,0]
  v_pk_mul_f32 v[38:39], v[250:251], 0 op_sel:[1,0] op_sel_hi:[1,0]
  v_pk_mul_f32 v[40:41], v[250:251], 0 op_sel:[1,0] op_sel_hi:[1,0]
  v_pk_mul_f32 v[42:43], v[250:251], 0 op_sel:[1,0] op_sel_hi:[1,0]
  v_pk_mul_f32 v[44:45], v[250:251], 0 op_sel:[1,0] op_sel_hi:[1,0]
  v_pk_mul_f32 v[46:47], v[250:251], 0 op_sel:[1,0] op_sel_hi:[1,0]
  v_pk_mul_f32 v[48:49], v[250:251], 0 op_sel:[1,0] op_sel_hi:[1,0]
  v_pk_mul_f32 v[50:51], v[250:251], 0 op_sel:[1,0] op_sel_hi:[1,0]
  v_pk_mul_f32 v[52:53], v[250:251], 0 op_sel:[1,0] op_sel_hi:[1,0]
  v_pk_mul_f32 v[54:55], v[250:251], 0 op_sel:[1,0] op_sel_hi:[1,0]
  v_pk_mul_f32 v[56:57], v[250:251], 0 op_sel:[1,0] op_sel_hi:[1,0]
  v_pk_mul_f32 v[58:59], v[250:251], 0 op_sel:[1,0] op_sel_hi:[1,0]
  v_pk_mul_f32 v[60:61], v[250:251], 0 op_sel:[1,0] op_sel_hi:[1,0]
  v_pk_mul_f32 v[62:63], v[250:251], 0 op_sel:[1,0] op_sel_hi:[1,0]
  v_pk_mul_f32 v[64:65], v[250:251], 0 op_sel:[1,0] op_sel_hi:[1,0]
  v_pk_mul_f32 v[66:67], v[250:251], 0 op_sel:[1,0] op_sel_hi:[1,0]
  v_pk_mul_f32 v[68:69], v[250:251], 0 op_sel:[1,0] op_sel_hi:[1,0]
  v_pk_mul_f32 v[70:71], v[250:251], 0 op_sel:[1,0] op_sel_hi:[1,0]
  v_pk_mul_f32 v[72:73], v[250:251], 0 op_sel:[1,0] op_sel_hi:[1,0]
  v_pk_mul_f32 v[74:75], v[250:251], 0 op_sel:[1,0] op_sel_hi:[1,0]
  v_pk_mul_f32 v[76:77], v[250:251], 0 op_sel:[1,0] op_sel_hi:[1,0]
  v_pk_mul_f32 v[78:79], v[250:251], 0 op_sel:[1,0] op_sel_hi:[1,0]
  v_pk_mul_f32 v[80:81], v[250:251], 0 op_sel:[1,0] op_sel_hi:[1,0]
  v_pk_mul_f32 v[82:83], v[250:251], 0 op_sel:[1,0] op_sel_hi:[1,0]
  v_pk_mul_f32 v[84:85], v[250:251], 0 op_sel:[1,0] op_sel_hi:[1,0]
  v_pk_mul_f32 v[86:87], v[250:251], 0 op_sel:[1,0] op_sel_hi:[1,0]
  v_pk_mul_f32 v[88:89], v[250:251], 0 op_sel:[1,0] op_sel_hi:[1,0]
  v_pk_mul_f32 v[90:91], v[250:251], 0 op_sel:[1,0] op_sel_hi:[1,0]
  v_pk_mul_f32 v[92:93], v[250:251], 0 op_sel:[1,0] op_sel_hi:[1,0]
  v_pk_mul_f32 v[94:95], v[250:251], 0 op_sel:[1,0] op_sel_hi:[1,0]
  v_pk_mul_f32 v[96:97], v[250:251], 0 op_sel:[1,0] op_sel_hi:[1,0]
  v_pk_mul_f32 v[98:99], v[250:251], 0 op_sel:[1,0] op_sel_hi:[1,0]
  v_pk_mul_f32 v[100:101], v[250:251], 0 op_sel:[1,0] op_sel_hi:[1,0]
  v_pk_mul_f32 v[102:103], v[250:251], 0 op_sel:[1,0] op_sel_hi:[1,0]
  s_mul_i32 s77, s50, 128
  s_add_u32 s77, s77, 27815808
  s_and_b32 s43, s50, 7
  s_cmp_eq_u32 s43, 0
  s_cselect_b32 s43, 128, 0
  v_lshlrev_b32 v249, 7, v253
  v_or_b32 v249, s43, v249
  s_branch Llayer
Lend:
  s_endpgm
Lside_sub:
  s_cmp_eq_u32 s90, 1
  s_cbranch_scc0 Lside_l
  s_cmp_lg_u32 s40, 0
  s_cbranch_scc1 Lside_a
  s_and_b32 s43, s2, 1
  s_lshl_b32 s43, s43, 7
  v_mov_b32 v250, 1
  s_mov_b64 exec, 1
  buffer_atomic_add v250, v251, s[36:39], s43 offen sc1
  s_mov_b64 exec, -1
Lside_a:
  s_add_u32 s88, s88, 3
  s_add_u32 s90, s90, 1
  s_setpc_b64 s[78:79]
Lside_l:
  buffer_load_dwordx4 a[240:243], v239, s[12:15], s89 offen
  s_add_u32 s89, s89, 1024
  s_cmp_eq_u32 s90, 0
  s_cbranch_scc0 Lside_b
  buffer_load_dwordx4 a[176:179], v238, s[84:87], s100 offen
  s_add_u32 s100, s100, 57344
  buffer_load_dwordx4 a[180:183], v238, s[84:87], s100 offen
  s_add_u32 s100, s100, 57344
  buffer_load_dwordx4 a[184:187], v238, s[84:87], s100 offen
  s_add_u32 s100, s100, 57344
  buffer_load_dwordx4 a[188:191], v238, s[84:87], s100 offen
  s_add_u32 s100, s100, 57344
  buffer_load_dwordx4 a[192:195], v238, s[84:87], s100 offen
  s_add_u32 s100, s100, 57344
  buffer_load_dwordx4 a[196:199], v238, s[84:87], s100 offen
  s_add_u32 s100, s100, 57344
  buffer_load_dwordx4 a[200:203], v238, s[84:87], s100 offen
  s_add_u32 s100, s100, 57344
  buffer_load_dwordx4 a[204:207], v238, s[84:87], s100 offen
  s_add_u32 s100, s100, 57344
  s_add_u32 s100, s100, 3211264
  s_add_u32 s88, s88, 3
  s_add_u32 s90, s90, 1
  s_setpc_b64 s[78:79]
Lside_b:
  buffer_load_dwordx4 a[208:211], v238, s[84:87], s100 offen
  s_add_u32 s100, s100, 57344
  buffer_load_dwordx4 a[212:215], v238, s[84:87], s100 offen
  s_add_u32 s100, s100, 57344
  buffer_load_dwordx4 a[216:219], v238, s[84:87], s100 offen
  s_add_u32 s100, s100, 57344
  buffer_load_dwordx4 a[220:223], v238, s[84:87], s100 offen
  s_add_u32 s100, s100, 57344
  buffer_load_dwordx4 a[224:227], v238, s[84:87], s100 offen
  s_add_u32 s100, s100, 57344
  buffer_load_dwordx4 a[228:231], v238, s[84:87], s100 offen
  s_add_u32 s100, s100, 57344
  buffer_load_dwordx4 a[232:235], v238, s[84:87], s100 offen
  s_add_u32 s100, s100, 57344
  buffer_load_dwordx4 a[236:239], v238, s[84:87], s100 offen
  s_add_u32 s100, s100, 57344
  s_mov_b32 s88, 63
  s_setpc_b64 s[78:79]
Lside_k9_c:
  s_call_b64 s[78:79], Lside_sub
  s_branch Lside_k9_r
Lside_k0_c:
  s_call_b64 s[78:79], Lside_sub
  s_branch Lside_k0_r
Lside_k1_c:
  s_call_b64 s[78:79], Lside_sub
  s_branch Lside_k1_r
Lside_k2_c:
  s_call_b64 s[78:79], Lside_sub
  s_branch Lside_k2_r
Lside_k3_c:
  s_call_b64 s[78:79], Lside_sub
  s_branch Lside_k3_r
Lside_k4_c:
  s_call_b64 s[78:79], Lside_sub
  s_branch Lside_k4_r
Lside_k5_c:
  s_call_b64 s[78:79], Lside_sub
  s_branch Lside_k5_r
Lchk3_c:
  s_mov_b32 s43, 0x40000
Lchk3_s:
  buffer_load_dword v127, v240, s[36:39], 0 offen sc1
  s_waitcnt vmcnt(0)
  v_cmp_gt_u32 vcc, 128, v127
  s_cbranch_vccz Lchk3_r
  s_sub_u32 s43, s43, 1
  s_cmp_lg_u32 s43, 0
  s_cbranch_scc1 Lchk3_s
  s_branch Lchk3_r
Lc4_c:
  buffer_load_dwordx4 v[200:203], v106, s[4:7], s46 offen sc1
  s_add_u32 s46, s46, 24576
  buffer_load_dwordx4 v[204:207], v106, s[4:7], s46 offen sc1
  s_add_u32 s46, s46, 24576
  s_branch Lc4_r
Lc5_c:
  buffer_load_dwordx4 v[208:211], v106, s[4:7], s46 offen sc1
  s_add_u32 s46, s46, 24576
  buffer_load_dwordx4 v[212:215], v106, s[4:7], s46 offen sc1
  s_add_u32 s46, s46, 24576
  s_branch Lc5_r
Lc6_c:
  buffer_load_dwordx4 v[216:219], v106, s[4:7], s46 offen sc1
  s_add_u32 s46, s46, 24576
  buffer_load_dwordx4 v[220:223], v106, s[4:7], s46 offen sc1
  s_add_u32 s46, s46, 24576
  s_branch Lc6_r
Lc7_c:
  buffer_load_dwordx4 v[224:227], v106, s[4:7], s46 offen sc1
  s_add_u32 s46, s46, 24576
  buffer_load_dwordx4 v[228:231], v106, s[4:7], s46 offen sc1
  s_add_u32 s46, s46, 24576
  s_branch Lc7_r
Lc8_c:
  v_pk_add_f32 v[200:201], v[200:201], v[216:217]
  v_pk_add_f32 v[202:203], v[202:203], v[218:219]
  v_pk_add_f32 v[204:205], v[204:205], v[220:221]
  v_pk_add_f32 v[206:207], v[206:207], v[222:223]
  v_pk_add_f32 v[208:209], v[208:209], v[224:225]
  v_pk_add_f32 v[210:211], v[210:211], v[226:227]
  v_pk_add_f32 v[212:213], v[212:213], v[228:229]
  v_pk_add_f32 v[214:215], v[214:215], v[230:231]
  v_pk_add_f32 v[200:201], v[200:201], v[208:209]
  v_pk_add_f32 v[202:203], v[202:203], v[210:211]
  v_pk_add_f32 v[204:205], v[204:205], v[212:213]
  v_pk_add_f32 v[206:207], v[206:207], v[214:215]
  v_pk_add_f32 v[200:201], v[200:201], v[204:205]
  v_pk_add_f32 v[202:203], v[202:203], v[206:207]
  v_mov_b32 v204, v200
  v_mov_b32 v205, v201
  v_mov_b32 v206, v202
  v_mov_b32 v207, v203
  v_permlane32_swap_b32 v200, v204
  v_permlane32_swap_b32 v201, v205
  v_permlane32_swap_b32 v202, v206
  v_permlane32_swap_b32 v203, v207
  v_add_f32 v200, v200, v204
  v_add_f32 v201, v201, v205
  v_add_f32 v202, v202, v206
  v_add_f32 v203, v203, v207
  ds_write_b128 v126, v[200:203] offset:1024
  s_branch Lc8_r
Lc10_c:
  v_accvgpr_read_b32 v236, a176
  v_accvgpr_read_b32 v237, a177
  v_accvgpr_read_b32 v238, a178
  v_accvgpr_read_b32 v239, a179
  v_lshlrev_b32 v224, 16, v236
  v_and_b32 v225, 0xffff0000, v236
  v_lshlrev_b32 v226, 16, v237
  v_and_b32 v227, 0xffff0000, v237
  v_lshlrev_b32 v228, 16, v238
  v_and_b32 v229, 0xffff0000, v238
  v_lshlrev_b32 v230, 16, v239
  v_and_b32 v231, 0xffff0000, v239
  v_accvgpr_read_b32 v236, a180
  v_accvgpr_read_b32 v237, a181
  v_accvgpr_read_b32 v238, a182
  v_accvgpr_read_b32 v239, a183
  v_lshlrev_b32 v232, 16, v236
  v_and_b32 v233, 0xffff0000, v236
  v_pk_add_f32 v[224:225], v[224:225], v[232:233]
  v_lshlrev_b32 v232, 16, v237
  v_and_b32 v233, 0xffff0000, v237
  v_pk_add_f32 v[226:227], v[226:227], v[232:233]
  v_lshlrev_b32 v232, 16, v238
  v_and_b32 v233, 0xffff0000, v238
  v_pk_add_f32 v[228:229], v[228:229], v[232:233]
  v_lshlrev_b32 v232, 16, v239
  v_and_b32 v233, 0xffff0000, v239
  v_pk_add_f32 v[230:231], v[230:231], v[232:233]
  v_accvgpr_read_b32 v236, a184
  v_accvgpr_read_b32 v237, a185
  v_accvgpr_read_b32 v238, a186
  v_accvgpr_read_b32 v239, a187
  v_lshlrev_b32 v232, 16, v236
  v_and_b32 v233, 0xffff0000, v236
  v_pk_add_f32 v[224:225], v[224:225], v[232:233]
  v_lshlrev_b32 v232, 16, v237
  v_and_b32 v233, 0xffff0000, v237
  v_pk_add_f32 v[226:227], v[226:227], v[232:233]
  v_lshlrev_b32 v232, 16, v238
  v_and_b32 v233, 0xffff0000, v238
  v_pk_add_f32 v[228:229], v[228:229], v[232:233]
  v_lshlrev_b32 v232, 16, v239
  v_and_b32 v233, 0xffff0000, v239
  v_pk_add_f32 v[230:231], v[230:231], v[232:233]
  v_accvgpr_read_b32 v236, a188
  v_accvgpr_read_b32 v237, a189
  v_accvgpr_read_b32 v238, a190
  v_accvgpr_read_b32 v239, a191
  v_lshlrev_b32 v232, 16, v236
  v_and_b32 v233, 0xffff0000, v236
  v_pk_add_f32 v[224:225], v[224:225], v[232:233]
  v_lshlrev_b32 v232, 16, v237
  v_and_b32 v233, 0xffff0000, v237
  v_pk_add_f32 v[226:227], v[226:227], v[232:233]
  v_lshlrev_b32 v232, 16, v238
  v_and_b32 v233, 0xffff0000, v238
  v_pk_add_f32 v[228:229], v[228:229], v[232:233]
  v_lshlrev_b32 v232, 16, v239
  v_and_b32 v233, 0xffff0000, v239
  v_pk_add_f32 v[230:231], v[230:231], v[232:233]
  v_accvgpr_read_b32 v236, a192
  v_accvgpr_read_b32 v237, a193
  v_accvgpr_read_b32 v238, a194
  v_accvgpr_read_b32 v239, a195
  v_lshlrev_b32 v232, 16, v236
  v_and_b32 v233, 0xffff0000, v236
  v_pk_add_f32 v[224:225], v[224:225], v[232:233]
  v_lshlrev_b32 v232, 16, v237
  v_and_b32 v233, 0xffff0000, v237
  v_pk_add_f32 v[226:227], v[226:227], v[232:233]
  v_lshlrev_b32 v232, 16, v238
  v_and_b32 v233, 0xffff0000, v238
  v_pk_add_f32 v[228:229], v[228:229], v[232:233]
  v_lshlrev_b32 v232, 16, v239
  v_and_b32 v233, 0xffff0000, v239
  v_pk_add_f32 v[230:231], v[230:231], v[232:233]
  v_accvgpr_read_b32 v236, a196
  v_accvgpr_read_b32 v237, a197
  v_accvgpr_read_b32 v238, a198
  v_accvgpr_read_b32 v239, a199
  v_lshlrev_b32 v232, 16, v236
  v_and_b32 v233, 0xffff0000, v236
  v_pk_add_f32 v[224:225], v[224:225], v[232:233]
  v_lshlrev_b32 v232, 16, v237
  v_and_b32 v233, 0xffff0000, v237
  v_pk_add_f32 v[226:227], v[226:227], v[232:233]
  v_lshlrev_b32 v232, 16, v238
  v_and_b32 v233, 0xffff0000, v238
  v_pk_add_f32 v[228:229], v[228:229], v[232:233]
  v_lshlrev_b32 v232, 16, v239
  v_and_b32 v233, 0xffff0000, v239
  v_pk_add_f32 v[230:231], v[230:231], v[232:233]
  v_accvgpr_read_b32 v236, a200
  v_accvgpr_read_b32 v237, a201
  v_accvgpr_read_b32 v238, a202
  v_accvgpr_read_b32 v239, a203
  v_lshlrev_b32 v232, 16, v236
  v_and_b32 v233, 0xffff0000, v236
  v_pk_add_f32 v[224:225], v[224:225], v[232:233]
  v_lshlrev_b32 v232, 16, v237
  v_and_b32 v233, 0xffff0000, v237
  v_pk_add_f32 v[226:227], v[226:227], v[232:233]
  v_lshlrev_b32 v232, 16, v238
  v_and_b32 v233, 0xffff0000, v238
  v_pk_add_f32 v[228:229], v[228:229], v[232:233]
  v_lshlrev_b32 v232, 16, v239
  v_and_b32 v233, 0xffff0000, v239
  v_pk_add_f32 v[230:231], v[230:231], v[232:233]
  v_accvgpr_read_b32 v236, a204
  v_accvgpr_read_b32 v237, a205
  v_accvgpr_read_b32 v238, a206
  v_accvgpr_read_b32 v239, a207
  v_lshlrev_b32 v232, 16, v236
  v_and_b32 v233, 0xffff0000, v236
  v_pk_add_f32 v[224:225], v[224:225], v[232:233]
  v_lshlrev_b32 v232, 16, v237
  v_and_b32 v233, 0xffff0000, v237
  v_pk_add_f32 v[226:227], v[226:227], v[232:233]
  v_lshlrev_b32 v232, 16, v238
  v_and_b32 v233, 0xffff0000, v238
  v_pk_add_f32 v[228:229], v[228:229], v[232:233]
  v_lshlrev_b32 v232, 16, v239
  v_and_b32 v233, 0xffff0000, v239
  v_pk_add_f32 v[230:231], v[230:231], v[232:233]
  s_branch Lc10_r
Lc11_c:
  v_accvgpr_read_b32 v236, a208
  v_accvgpr_read_b32 v237, a209
  v_accvgpr_read_b32 v238, a210
  v_accvgpr_read_b32 v239, a211
  v_lshlrev_b32 v232, 16, v236
  v_and_b32 v233, 0xffff0000, v236
  v_pk_add_f32 v[224:225], v[224:225], v[232:233]
  v_lshlrev_b32 v232, 16, v237
  v_and_b32 v233, 0xffff0000, v237
  v_pk_add_f32 v[226:227], v[226:227], v[232:233]
  v_lshlrev_b32 v232, 16, v238
  v_and_b32 v233, 0xffff0000, v238
  v_pk_add_f32 v[228:229], v[228:229], v[232:233]
  v_lshlrev_b32 v232, 16, v239
  v_and_b32 v233, 0xffff0000, v239
  v_pk_add_f32 v[230:231], v[230:231], v[232:233]
  v_accvgpr_read_b32 v236, a212
  v_accvgpr_read_b32 v237, a213
  v_accvgpr_read_b32 v238, a214
  v_accvgpr_read_b32 v239, a215
  v_lshlrev_b32 v232, 16, v236
  v_and_b32 v233, 0xffff0000, v236
  v_pk_add_f32 v[224:225], v[224:225], v[232:233]
  v_lshlrev_b32 v232, 16, v237
  v_and_b32 v233, 0xffff0000, v237
  v_pk_add_f32 v[226:227], v[226:227], v[232:233]
  v_lshlrev_b32 v232, 16, v238
  v_and_b32 v233, 0xffff0000, v238
  v_pk_add_f32 v[228:229], v[228:229], v[232:233]
  v_lshlrev_b32 v232, 16, v239
  v_and_b32 v233, 0xffff0000, v239
  v_pk_add_f32 v[230:231], v[230:231], v[232:233]
  v_accvgpr_read_b32 v236, a216
  v_accvgpr_read_b32 v237, a217
  v_accvgpr_read_b32 v238, a218
  v_accvgpr_read_b32 v239, a219
  v_lshlrev_b32 v232, 16, v236
  v_and_b32 v233, 0xffff0000, v236
  v_pk_add_f32 v[224:225], v[224:225], v[232:233]
  v_lshlrev_b32 v232, 16, v237
  v_and_b32 v233, 0xffff0000, v237
  v_pk_add_f32 v[226:227], v[226:227], v[232:233]
  v_lshlrev_b32 v232, 16, v238
  v_and_b32 v233, 0xffff0000, v238
  v_pk_add_f32 v[228:229], v[228:229], v[232:233]
  v_lshlrev_b32 v232, 16, v239
  v_and_b32 v233, 0xffff0000, v239
  v_pk_add_f32 v[230:231], v[230:231], v[232:233]
  v_accvgpr_read_b32 v236, a220
  v_accvgpr_read_b32 v237, a221
  v_accvgpr_read_b32 v238, a222
  v_accvgpr_read_b32 v239, a223
  v_lshlrev_b32 v232, 16, v236
  v_and_b32 v233, 0xffff0000, v236
  v_pk_add_f32 v[224:225], v[224:225], v[232:233]
  v_lshlrev_b32 v232, 16, v237
  v_and_b32 v233, 0xffff0000, v237
  v_pk_add_f32 v[226:227], v[226:227], v[232:233]
  v_lshlrev_b32 v232, 16, v238
  v_and_b32 v233, 0xffff0000, v238
  v_pk_add_f32 v[228:229], v[228:229], v[232:233]
  v_lshlrev_b32 v232, 16, v239
  v_and_b32 v233, 0xffff0000, v239
  v_pk_add_f32 v[230:231], v[230:231], v[232:233]
  v_accvgpr_read_b32 v236, a224
  v_accvgpr_read_b32 v237, a225
  v_accvgpr_read_b32 v238, a226
  v_accvgpr_read_b32 v239, a227
  v_lshlrev_b32 v232, 16, v236
  v_and_b32 v233, 0xffff0000, v236
  v_pk_add_f32 v[224:225], v[224:225], v[232:233]
  v_lshlrev_b32 v232, 16, v237
  v_and_b32 v233, 0xffff0000, v237
  v_pk_add_f32 v[226:227], v[226:227], v[232:233]
  v_lshlrev_b32 v232, 16, v238
  v_and_b32 v233, 0xffff0000, v238
  v_pk_add_f32 v[228:229], v[228:229], v[232:233]
  v_lshlrev_b32 v232, 16, v239
  v_and_b32 v233, 0xffff0000, v239
  v_pk_add_f32 v[230:231], v[230:231], v[232:233]
  v_accvgpr_read_b32 v236, a228
  v_accvgpr_read_b32 v237, a229
  v_accvgpr_read_b32 v238, a230
  v_accvgpr_read_b32 v239, a231
  v_lshlrev_b32 v232, 16, v236
  v_and_b32 v233, 0xffff0000, v236
  v_pk_add_f32 v[224:225], v[224:225], v[232:233]
  v_lshlrev_b32 v232, 16, v237
  v_and_b32 v233, 0xffff0000, v237
  v_pk_add_f32 v[226:227], v[226:227], v[232:233]
  v_lshlrev_b32 v232, 16, v238
  v_and_b32 v233, 0xffff0000, v238
  v_pk_add_f32 v[228:229], v[228:229], v[232:233]
  v_lshlrev_b32 v232, 16, v239
  v_and_b32 v233, 0xffff0000, v239
  v_pk_add_f32 v[230:231], v[230:231], v[232:233]
  v_accvgpr_read_b32 v236, a232
  v_accvgpr_read_b32 v237, a233
  v_accvgpr_read_b32 v238, a234
  v_accvgpr_read_b32 v239, a235
  v_lshlrev_b32 v232, 16, v236
  v_and_b32 v233, 0xffff0000, v236
  v_pk_add_f32 v[224:225], v[224:225], v[232:233]
  v_lshlrev_b32 v232, 16, v237
  v_and_b32 v233, 0xffff0000, v237
  v_pk_add_f32 v[226:227], v[226:227], v[232:233]
  v_lshlrev_b32 v232, 16, v238
  v_and_b32 v233, 0xffff0000, v238
  v_pk_add_f32 v[228:229], v[228:229], v[232:233]
  v_lshlrev_b32 v232, 16, v239
  v_and_b32 v233, 0xffff0000, v239
  v_pk_add_f32 v[230:231], v[230:231], v[232:233]
  v_accvgpr_read_b32 v236, a236
  v_accvgpr_read_b32 v237, a237
  v_accvgpr_read_b32 v238, a238
  v_accvgpr_read_b32 v239, a239
  v_lshlrev_b32 v232, 16, v236
  v_and_b32 v233, 0xffff0000, v236
  v_pk_add_f32 v[224:225], v[224:225], v[232:233]
  v_lshlrev_b32 v232, 16, v237
  v_and_b32 v233, 0xffff0000, v237
  v_pk_add_f32 v[226:227], v[226:227], v[232:233]
  v_lshlrev_b32 v232, 16, v238
  v_and_b32 v233, 0xffff0000, v238
  v_pk_add_f32 v[228:229], v[228:229], v[232:233]
  v_lshlrev_b32 v232, 16, v239
  v_and_b32 v233, 0xffff0000, v239
  v_pk_add_f32 v[230:231], v[230:231], v[232:233]
  v_mov_b32 v232, v224
  v_mov_b32 v233, v225
  v_mov_b32 v234, v226
  v_mov_b32 v235, v227
  v_mov_b32 v236, v228
  v_mov_b32 v237, v229
  v_mov_b32 v238, v230
  v_mov_b32 v239, v231
  v_permlane32_swap_b32 v224, v232
  v_permlane32_swap_b32 v225, v233
  v_permlane32_swap_b32 v226, v234
  v_permlane32_swap_b32 v227, v235
  v_permlane32_swap_b32 v228, v236
  v_permlane32_swap_b32 v229, v237
  v_permlane32_swap_b32 v230, v238
  v_permlane32_swap_b32 v231, v239
  v_add_f32 v224, v224, v232
  v_add_f32 v225, v225, v233
  v_add_f32 v226, v226, v234
  v_add_f32 v227, v227, v235
  v_add_f32 v228, v228, v236
  v_add_f32 v229, v229, v237
  v_add_f32 v230, v230, v238
  v_add_f32 v231, v231, v239
  v_mov_b32 v232, v224
  v_mov_b32 v233, v225
  v_mov_b32 v234, v226
  v_mov_b32 v235, v227
  v_mov_b32 v236, v228
  v_mov_b32 v237, v229
  v_mov_b32 v238, v230
  v_mov_b32 v239, v231
  v_permlane16_swap_b32 v224, v232
  v_permlane16_swap_b32 v225, v233
  v_permlane16_swap_b32 v226, v234
  v_permlane16_swap_b32 v227, v235
  v_permlane16_swap_b32 v228, v236
  v_permlane16_swap_b32 v229, v237
  v_permlane16_swap_b32 v230, v238
  v_permlane16_swap_b32 v231, v239
  v_add_f32 v224, v224, v232
  v_add_f32 v225, v225, v233
  v_add_f32 v226, v226, v234
  v_add_f32 v227, v227, v235
  v_add_f32 v228, v228, v236
  v_add_f32 v229, v229, v237
  v_add_f32 v230, v230, v238
  v_add_f32 v231, v231, v239
  v_and_b32 v232, 7, v253
  s_lshl_b32 s43, s40, 8
  s_add_u32 s43, s43, 143360
  v_add_f32_dpp v224, v224, v224 row_ror:8 row_mask:0xf bank_mask:0xf
  v_add_f32_dpp v225, v225, v225 row_ror:8 row_mask:0xf bank_mask:0xf
  v_add_f32_dpp v226, v226, v226 row_ror:8 row_mask:0xf bank_mask:0xf
  v_add_f32_dpp v227, v227, v227 row_ror:8 row_mask:0xf bank_mask:0xf
  v_add_f32_dpp v228, v228, v228 row_ror:8 row_mask:0xf bank_mask:0xf
  v_add_f32_dpp v229, v229, v229 row_ror:8 row_mask:0xf bank_mask:0xf
  v_add_f32_dpp v230, v230, v230 row_ror:8 row_mask:0xf bank_mask:0xf
  v_add_f32_dpp v231, v231, v231 row_ror:8 row_mask:0xf bank_mask:0xf
  v_lshl_add_u32 v232, v232, 5, s43
  ds_write_b128 v232, v[224:227]
  ds_write_b128 v232, v[228:231] offset:16
  s_branch Lc11_r
Lc14_c:
  v_lshlrev_b32 v232, 2, v253
  v_add_u32 v233, 143360, v232
  ds_read_b32 v234, v233 offset:0
  ds_read_b32 v235, v233 offset:256
  ds_read_b32 v236, v233 offset:512
  ds_read_b32 v237, v233 offset:768
  s_waitcnt lgkmcnt(0)
  v_add_f32 v234, v234, v235
  v_add_f32 v236, v236, v237
  v_add_f32 v234, v234, v236
  buffer_store_dword v234, v232, s[4:7], s101 offen sc1
  s_branch Lc14_r
Lc16_c:
  s_bfe_u32 s43, s2, 0x20001
  s_lshl_b32 s43, s43, 7
  s_add_u32 s43, s43, 27794432
  v_mov_b32 v250, 1
  s_mov_b64 exec, 1
  buffer_atomic_add v250, v251, s[4:7], s43 offen sc1
  s_mov_b64 exec, -1
  s_branch Lc16_r
Lchk19_c:
  s_mov_b32 s43, 0x40000
Lchk19_s:
  buffer_load_dword v237, v251, s[4:7], s48 offen sc1
  s_waitcnt vmcnt(0)
  v_cmp_gt_u32 vcc, 56, v237
  s_cbranch_vccz Lchk19_r
  s_sub_u32 s43, s43, 1
  s_cmp_lg_u32 s43, 0
  s_cbranch_scc1 Lchk19_s
  s_branch Lchk19_r
Lp4a_c:
  s_mov_b32 s43, 0x40000
Lp4a_s:
  buffer_load_dword v10, v251, s[4:7], s64 offen sc1
  s_waitcnt vmcnt(0)
  v_cmp_gt_u32 vcc, 16, v10
  s_cbranch_vccz Lp4a_r
  s_sub_u32 s43, s43, 1
  s_cmp_lg_u32 s43, 0
  s_cbranch_scc1 Lp4a_s
  s_branch Lp4a_r
Lp4b_c:
  s_mov_b32 s43, 0x40000
Lp4b_s:
  buffer_load_dword v10, v251, s[4:7], s64 offen sc1
  s_waitcnt vmcnt(0)
  v_cmp_gt_u32 vcc, 16, v10
  s_cbranch_vccz Lp4b_r
  s_sub_u32 s43, s43, 1
  s_cmp_lg_u32 s43, 0
  s_cbranch_scc1 Lp4b_s
  s_branch Lp4b_r
Lp3_sgl_c:
  v_mov_b32 v250, 1
  s_mov_b64 exec, 1
  buffer_atomic_add v250, v251, s[4:7], s77 offen sc1
  s_mov_b64 exec, -1
  s_branch Lp3_sgl_r
Lp4_mb_c:
  s_mov_b32 s43, 0x40000
Lp4_mb_s:
  buffer_load_dwordx4 v[96:99], v8, s[4:7], s45 offen offset:0 sc1
  buffer_load_dwordx4 v[100:103], v8, s[4:7], s45 offen offset:1024 sc1
  buffer_load_dwordx4 v[104:107], v8, s[4:7], s45 offen offset:2048 sc1
  buffer_load_dwordx4 v[108:111], v8, s[4:7], s45 offen offset:3072 sc1
  s_waitcnt vmcnt(0)
  v_max3_u32 v112, v96, v97, v98
  v_max3_u32 v113, v99, v100, v101
  v_max3_u32 v112, v112, v102, v103
  v_max3_u32 v113, v113, v104, v105
  v_max3_u32 v112, v112, v106, v107
  v_max3_u32 v113, v113, v108, v109
  v_max3_u32 v112, v112, v110, v111
  v_max_u32 v112, v112, v113
  v_cmp_eq_u32 vcc, -1, v112
  s_cbranch_vccz Lp4_mb_r
  s_sub_u32 s43, s43, 1
  s_cmp_lg_u32 s43, 0
  s_cbranch_scc1 Lp4_mb_s
  s_branch Lp4_mb_r
Lcode_end:
.fill (Lpc0 + 65536 - Lcode_end)/4, 4, 0xbf810000
.section .rodata,"a"
.p2align 6
.amdhsa_kernel interleave_layers__sliding_local_dilated__swiglu_ffn__prompt_kernel
  .amdhsa_next_free_vgpr 512
  .amdhsa_next_free_sgpr 102
  .amdhsa_accum_offset 256
  .amdhsa_group_segment_fixed_size 0
  .amdhsa_kernarg_size 80
  .amdhsa_user_sgpr_count 2
  .amdhsa_user_sgpr_kernarg_segment_ptr 1
  .amdhsa_system_sgpr_workgroup_id_x 1
  .amdhsa_float_denorm_mode_32 3
.end_amdhsa_kernel
```

```asm
; @launch grid=(256,1,1) block=(256,1,1) lds=163840
.amdgcn_target "amdgcn-amd-amdhsa--gfx950"
.text
.globl interleave_layers__sliding_local_dilated__swiglu_ffn__prompt_kernel
.p2align 8
.type interleave_layers__sliding_local_dilated__swiglu_ffn__prompt_kernel,@function
interleave_layers__sliding_local_dilated__swiglu_ffn__prompt_kernel:
  s_cmp_lt_u32 s2, 256
  s_cbranch_scc1 Lgo
  s_endpgm
Lgo:
  s_load_dwordx2 s[28:29], s[0:1], 0
  s_load_dwordx2 s[8:9], s[0:1], 8
  s_getpc_b64 s[44:45]
Lpc0:
  s_bfe_u32 s43, s2, 0x40003
  s_lshl_b32 s43, s43, 12
  v_lshl_add_u32 v2, v0, 4, s43
  s_and_b32 s44, s44, 0xffffff80
  global_load_dwordx4 a[240:243], v2, s[44:45]
  v_lshrrev_b32 v1, 6, v0
  v_and_b32 v253, 63, v0
  v_readfirstlane_b32 s40, v1
  v_mov_b32 v251, 0
  s_mov_b32 s30, 0x400000
  s_mov_b32 s31, 0x20000
  s_mov_b32 s10, 0x600000
  s_mov_b32 s11, 0x20000
  s_and_b32 s44, s2, 1
  s_bfe_u32 s45, s2, 0x20001
  s_lshr_b32 s46, s2, 3
  s_lshl_b32 s47, s44, 3
  s_and_b32 s43, s46, 7
  s_add_u32 s50, s47, s43
  s_lshl_b32 s43, s45, 2
  s_lshr_b32 s51, s46, 3
  s_add_u32 s51, s51, s43
  s_lshr_b32 s57, s40, 1
  s_and_b32 s58, s40, 1
  s_lshl_b32 s71, s50, 3
  s_add_u32 s67, s50, s51
  s_and_b32 s67, s67, 15
  s_lshl_b32 s62, s40, 12
  s_mul_i32 s63, s40, 6144
  s_add_u32 s76, s63, 139264
  s_and_b32 s43, s50, 7
  s_cmp_lg_u32 s43, 0
  s_cselect_b32 s43, 1, 0
  s_sub_u32 s72, s71, s43
  v_lshrrev_b32 v2, 3, v253
  v_bfe_u32 v3, v253, 1, 2
  v_lshrrev_b32 v4, 4, v253
  v_xor_b32 v3, v3, v4
  v_and_b32 v5, 1, v253
  v_lshrrev_b32 v6, 5, v253
  v_lshl_add_u32 v6, v6, 2, v2
  s_lshl_b32 s43, s57, 5
  s_lshl_b32 s44, s58, 2
  s_add_u32 s43, s43, s44
  v_mul_u32_u24 v6, 6144, v6
  v_lshl_add_u32 v6, v3, 5, v6
  v_lshl_add_u32 v124, v5, 4, v6
  v_add_u32 v125, 97280, v124
  s_mul_i32 s43, s43, 6144
  s_lshl_b32 s60, s51, 7
  s_add_u32 s60, s60, s43
  v_and_b32 v3, 7, v253
  s_lshl_b32 s43, s40, 1
  s_add_u32 s43, s43, s71
  v_add_u32 v5, 0, v4
  v_xor_b32 v5, v5, v3
  v_lshlrev_b32 v5, 4, v5
  v_lshl_add_u32 v5, v2, 12, v5
  v_add_u32 v120, 0, v5
  v_add_u32 v5, 4, v4
  v_xor_b32 v5, v5, v3
  v_lshlrev_b32 v5, 4, v5
  v_lshl_add_u32 v5, v2, 12, v5
  v_add_u32 v121, 31744, v5
  v_add_u32 v5, 0, v4
  v_xor_b32 v5, v5, v3
  v_lshlrev_b32 v5, 4, v5
  v_lshl_add_u32 v5, v2, 12, v5
  v_add_u32 v122, 63488, v5
  v_add_u32 v5, 4, v4
  v_xor_b32 v5, v5, v3
  v_lshlrev_b32 v5, 4, v5
  v_lshl_add_u32 v5, v2, 12, v5
  v_add_u32 v123, 95232, v5
  v_and_b32 v5, 6, v2
  v_xor_b32 v5, v5, v3
  v_lshlrev_b32 v5, 4, v5
  v_lshl_add_u32 v5, v2, 12, v5
  v_add_u32 v126, 32768, v5
  s_lshr_b32 s44, s50, 3
  s_lshl_b32 s44, s44, 11
  s_and_b32 s43, s43, 63
  s_lshl_b32 s43, s43, 16
  s_add_u32 s59, s43, s44
  s_and_b32 s43, s72, 63
  s_lshl_b32 s43, s43, 16
  s_add_u32 s73, s43, s44
  s_movk_i32 s61, 128
  s_waitcnt lgkmcnt(0)
  s_add_u32 s44, s67, 0
  s_and_b32 s44, s44, 15
  s_mul_i32 s45, s44, s61
  s_add_u32 s68, s45, s59
  s_add_u32 m0, s62, 73728
  s_nop 0
  buffer_load_dwordx4 v120, s[28:31], s68 offen offset:0 sc1  lds
  buffer_load_dwordx4 v121, s[28:31], s68 offen offset:1024 sc1  lds
  buffer_load_dwordx4 v122, s[28:31], s68 offen offset:2048 sc1  lds
  buffer_load_dwordx4 v123, s[28:31], s68 offen offset:3072 sc1  lds
  s_add_u32 s44, s67, 0
  s_and_b32 s44, s44, 15
  s_mul_i32 s45, s44, 393216
  s_add_u32 s69, s45, s60
  s_add_u32 s70, s69, 4096
  s_add_u32 m0, s63, 0
  s_nop 0
  buffer_load_dwordx4 v124, s[8:11], s69 offen offset:0  lds
  buffer_load_dwordx4 v125, s[8:11], s69 offen offset:1024  lds
  buffer_load_dwordx4 v124, s[8:11], s69 offen offset:2048  lds
  buffer_load_dwordx4 v125, s[8:11], s69 offen offset:3072  lds
  s_add_u32 m0, s63, 4096
  s_nop 0
  buffer_load_dwordx4 v124, s[8:11], s70 offen offset:0  lds
  buffer_load_dwordx4 v125, s[8:11], s70 offen offset:1024  lds
  s_add_u32 s44, s67, s40
  s_add_u32 s44, s44, 0
  s_and_b32 s44, s44, 15
  s_mul_i32 s44, s44, s61
  s_lshl_b32 s45, s40, 10
  s_add_u32 m0, s45, 122880
  s_add_u32 s44, s44, s73
  buffer_load_dwordx4 v126, s[28:31], s44 offen sc1 lds
  s_load_dwordx2 s[4:5], s[0:1], 72
  s_load_dwordx2 s[12:13], s[0:1], 16
  s_load_dwordx2 s[16:17], s[0:1], 32
  s_load_dwordx2 s[20:21], s[0:1], 40
  s_load_dwordx2 s[24:25], s[0:1], 48
  s_load_dwordx2 s[32:33], s[0:1], 56
  s_load_dwordx2 s[36:37], s[0:1], 64
  s_mov_b32 s6, 0x10000000
  s_mov_b32 s7, 0x20000
  s_mov_b32 s14, 0x200000
  s_mov_b32 s15, 0x20000
  s_mov_b32 s18, 0x700000
  s_mov_b32 s19, 0x20000
  s_mov_b32 s22, 0x700000
  s_mov_b32 s23, 0x20000
  s_mov_b32 s26, 0x700000
  s_mov_b32 s27, 0x20000
  s_mov_b32 s34, 0x400000
  s_mov_b32 s35, 0x20000
  s_mov_b32 s38, 0x100
  s_mov_b32 s39, 0x20000
  s_mov_b32 s41, 0
  s_mov_b32 s42, 0
  s_and_b32 s44, s2, 1
  s_bfe_u32 s45, s2, 0x20001
  s_lshr_b32 s46, s2, 3
  s_lshl_b32 s47, s44, 3
  s_lshr_b32 s43, s45, 1
  s_lshl_b32 s43, s43, 2
  s_add_u32 s52, s47, s43
  s_and_b32 s48, s46, 3
  s_add_u32 s52, s52, s48
  s_and_b32 s43, s45, 1
  s_lshr_b32 s49, s46, 2
  s_lshl_b32 s53, s49, 1
  s_add_u32 s53, s53, s43
  s_lshl_b32 s43, s44, 2
  s_add_u32 s54, s43, s48
  s_lshl_b32 s43, s45, 3
  s_add_u32 s55, s43, s49
  v_lshrrev_b32 v2, 3, v253
  v_bfe_u32 v3, v253, 1, 2
  v_lshrrev_b32 v4, 4, v253
  v_xor_b32 v3, v3, v4
  v_and_b32 v4, 1, v253
  v_lshlrev_b32 v2, 11, v2
  v_lshl_add_u32 v2, v3, 5, v2
  v_lshl_add_u32 v252, v4, 4, v2
  s_waitcnt lgkmcnt(0)
  s_and_b32 s43, s40, 1
  s_mul_i32 s43, s43, 41943040
  s_lshl_b32 s44, s2, 7
  s_add_u32 s43, s43, s44
  s_add_u32 s43, s43, 27787264
  buffer_store_dword v251, v251, s[4:7], s43 offen sc1
  v_and_b32 v2, 15, v253
  v_lshrrev_b32 v3, 4, v253
  v_and_b32 v4, 7, v253
  v_lshrrev_b32 v5, 1, v2
  v_xor_b32 v5, v5, v3
  v_lshlrev_b32 v5, 4, v5
  v_lshl_add_u32 v6, v2, 7, v5
  v_xor_b32 v7, 64, v6
  v_and_b32 v5, 6, v4
  v_xor_b32 v5, v5, v3
  v_lshlrev_b32 v5, 4, v5
  v_lshl_add_u32 v8, v4, 7, v5
  v_xor_b32 v9, 64, v8
  s_lshl_b32 s43, s57, 13
  s_add_u32 s43, s43, 73728
  v_add_u32 v112, s43, v6
  v_add_u32 v113, s43, v7
  v_add_u32 v114, 122880, v8
  v_add_u32 v115, 122880, v9
  s_lshl_b32 s43, s52, 3
  s_lshl_b32 s44, s40, 1
  s_add_u32 s43, s43, s44
  v_lshrrev_b32 v5, 1, v3
  v_lshrrev_b32 v187, 1, v2
  v_xor_b32 v5, v5, v187
  v_lshlrev_b32 v5, 4, v5
  v_lshl_add_u32 v187, v2, 7, v5
  v_and_b32 v5, 1, v3
  v_lshl_add_u32 v187, v5, 3, v187
  s_lshr_b32 s44, s43, 6
  s_lshl_b32 s44, s44, 11
  s_and_b32 s43, s43, 63
  s_lshl_b32 s43, s43, 16
  s_add_u32 s43, s43, s44
  s_lshl_b32 s44, s53, 7
  s_add_u32 s64, s43, s44
  v_lshrrev_b32 v2, 2, v253
  v_bfe_u32 v3, v253, 3, 2
  v_and_b32 v4, 3, v253
  v_lshlrev_b32 v4, 3, v4
  v_lshl_add_u32 v4, v2, 7, v4
  s_lshl_b32 s43, s58, 1
  s_or_b32 s43, s43, s57
  v_xor_b32 v5, s43, v3
  v_lshl_add_u32 v116, v5, 5, v4
  v_xor_b32 v5, 1, v5
  v_lshl_add_u32 v117, v5, 5, v4
  v_add_u32 v118, 49152, v116
  v_add_u32 v119, 49152, v117
  v_and_b32 v235, 15, v253
  v_lshrrev_b32 v236, 4, v253
  v_lshlrev_b32 v236, 2, v236
  v_sub_u32 v235, v235, v236
  v_mov_b32 v237, 0xf149f2ca
  v_subrev_u32 v238, 0, v235
  v_cmp_gt_u32 vcc, 8, v238
  v_add_u32 v238, 16, v238
  v_cmp_gt_u32 s[78:79], 8, v238
  v_cndmask_b32 v132, v237, 0, vcc
  s_nop 0
  v_cndmask_b32 v136, v237, 0, s[78:79]
  v_subrev_u32 v238, 1, v235
  v_cmp_gt_u32 vcc, 8, v238
  v_add_u32 v238, 16, v238
  v_cmp_gt_u32 s[78:79], 8, v238
  v_cndmask_b32 v133, v237, 0, vcc
  s_nop 0
  v_cndmask_b32 v137, v237, 0, s[78:79]
  v_subrev_u32 v238, 2, v235
  v_cmp_gt_u32 vcc, 8, v238
  v_add_u32 v238, 16, v238
  v_cmp_gt_u32 s[78:79], 8, v238
  v_cndmask_b32 v134, v237, 0, vcc
  s_nop 0
  v_cndmask_b32 v138, v237, 0, s[78:79]
  v_subrev_u32 v238, 3, v235
  v_cmp_gt_u32 vcc, 8, v238
  v_add_u32 v238, 16, v238
  v_cmp_gt_u32 s[78:79], 8, v238
  v_cndmask_b32 v135, v237, 0, vcc
  s_nop 0
  v_cndmask_b32 v139, v237, 0, s[78:79]
  v_lshlrev_b32 v232, 4, v253
  v_add_u32 v232, 149504, v232
  ds_write_b128 v232, v[132:135]
  ds_write_b128 v232, v[136:139] offset:1024
  s_lshr_b32 s46, s2, 3
  s_cmp_ge_u32 s46, 14
  s_cselect_b32 s44, 14, 0
  s_cselect_b32 s45, 1, 0
  s_cselect_b32 s84, s20, s16
  s_cselect_b32 s85, s21, s17
  s_mov_b32 s86, 7340032
  s_mov_b32 s87, 0x20000
  s_sub_u32 s44, s46, s44
  s_bfe_u32 s47, s2, 0x20001
  s_mul_i32 s47, s47, 14
  s_add_u32 s44, s44, s47
  s_and_b32 s47, s2, 1
  s_lshl_b32 s48, s47, 1
  s_add_u32 s48, s48, s45
  s_mul_i32 s48, s48, 14336
  s_lshl_b32 s49, s44, 8
  s_add_u32 s48, s48, s49
  s_add_u32 s101, s48, 27918336
  s_lshl_b32 s47, s47, 2
  s_add_u32 s47, s47, s40
  s_mul_i32 s47, s47, 458752
  s_lshl_b32 s44, s44, 7
  s_add_u32 s100, s47, s44
  s_cmp_lt_u32 s46, 28
  s_cselect_b32 s3, 1, 0
  s_cmp_eq_u32 s41, 0
  s_cselect_b32 s3, s3, 0
  v_lshrrev_b32 v238, 3, v253
  v_mul_u32_u24 v238, 7168, v238
  v_and_b32 v239, 7, v253
  v_lshl_add_u32 v238, v239, 4, v238
  s_cmp_eq_u32 s3, 0
  s_cselect_b32 s43, 0x40000000, 0
  v_or_b32 v238, s43, v238
  v_lshlrev_b32 v239, 4, v253
  s_lshl_b32 s43, s2, 2
  s_add_u32 s43, s43, s40
  s_lshl_b32 s89, s43, 11
  s_mul_i32 s43, s46, 43
  s_lshr_b32 s43, s43, 8
  s_mul_i32 s43, s43, 6
  s_sub_u32 s43, s46, s43
  s_add_u32 s43, s43, 5
  s_cmp_eq_u32 s41, 0
  s_cselect_b32 s88, s43, 63
  s_mov_b32 s90, 0
  s_lshl_b32 s43, s58, 12
  v_add_u32 v132, s43, v112
  v_add_u32 v133, s43, v113
  v_and_b32 v128, 15, v253
  v_lshrrev_b32 v129, 4, v253
  v_cmp_eq_u32 vcc, 0, v128
  v_lshlrev_b32 v129, 4, v129
  v_mov_b32 v130, 0x40000000
  v_cndmask_b32 v136, v130, v129, vcc
  v_mov_b32 v156, 0x3f803f80
  v_mov_b32 v157, 0x3f803f80
  v_mov_b32 v158, 0x3f803f80
  v_mov_b32 v159, 0x3f803f80
  s_lshl_b32 s43, s40, 1
  s_add_u32 s43, s43, s71
  s_lshl_b32 s48, s43, 11
  s_lshl_b32 s43, s67, 7
  s_add_u32 s48, s48, s43
  s_add_u32 s48, s48, 27262976
  s_lshl_b32 s43, s51, 2
  s_lshl_b32 s44, s58, 1
  s_add_u32 s43, s43, s44
  s_add_u32 s43, s43, s57
  s_lshl_b32 s43, s43, 6
  s_mul_i32 s49, s67, 12288
  s_add_u32 s49, s49, s43
  s_add_u32 s49, s49, 27983872
  v_and_b32 v212, 15, v253
  v_lshrrev_b32 v213, 4, v253
  v_lshrrev_b32 v192, 2, v212
  v_cmp_eq_u32 vcc, v192, v213
  v_and_b32 v192, 3, v212
  v_lshlrev_b32 v212, 3, v212
  v_mov_b32 v213, 0x7ffffff0
  v_cndmask_b32 v212, v213, v212, vcc
  v_cmp_eq_u32 s[78:79], 1, v192
  v_cmp_eq_u32 s[80:81], 2, v192
  v_cmp_eq_u32 s[82:83], 3, v192
  v_mov_b32 v192, 0x3f803f80
  v_mov_b32 v193, 0x3f803f80
  v_mov_b32 v194, 0x3f803f80
  v_mov_b32 v195, 0x3f803f80
  s_add_u32 s44, s67, 1
  s_and_b32 s44, s44, 15
  s_mul_i32 s45, s44, s61
  s_add_u32 s68, s45, s59
  s_add_u32 m0, s62, 90112
  s_nop 0
  buffer_load_dwordx4 v120, s[28:31], s68 offen offset:0 sc1  lds
  buffer_load_dwordx4 v121, s[28:31], s68 offen offset:1024 sc1  lds
  buffer_load_dwordx4 v122, s[28:31], s68 offen offset:2048 sc1  lds
  buffer_load_dwordx4 v123, s[28:31], s68 offen offset:3072 sc1  lds
  s_waitcnt vmcnt(5)
  s_barrier
  ds_read_b64_tr_b16 a[40:41], v116 offset:0
  ds_read_b64_tr_b16 a[42:43], v116 offset:6144
  ds_read_b64_tr_b16 a[64:65], v116 offset:12288
  ds_read_b64_tr_b16 a[66:67], v116 offset:18432
  ds_read_b128 a[4:7], v112 offset:0
  ds_read_b128 a[24:27], v113 offset:0
  ds_read_b128 a[8:11], v112 offset:2048
  ds_read_b128 a[28:31], v113 offset:2048
  ds_read_b128 a[12:15], v112 offset:4096
  ds_read_b128 a[32:35], v113 offset:4096
  ds_read_b128 a[16:19], v112 offset:6144
  ds_read_b128 a[36:39], v113 offset:6144
  ds_read_b64_tr_b16 a[44:45], v117 offset:0
  ds_read_b64_tr_b16 a[46:47], v117 offset:6144
  ds_read_b64_tr_b16 a[68:69], v117 offset:12288
  ds_read_b64_tr_b16 a[70:71], v117 offset:18432
  ds_read_b128 a[0:3], v114 offset:0
  ds_read_b128 a[20:23], v115 offset:0
  ds_read_b64_tr_b16 a[48:49], v116 offset:2048
  ds_read_b64_tr_b16 a[50:51], v116 offset:8192
  ds_read_b64_tr_b16 a[72:73], v116 offset:14336
  ds_read_b64_tr_b16 a[74:75], v116 offset:20480
  ds_read_b64_tr_b16 a[52:53], v117 offset:2048
  ds_read_b64_tr_b16 a[54:55], v117 offset:8192
  ds_read_b64_tr_b16 a[76:77], v117 offset:14336
  ds_read_b64_tr_b16 a[78:79], v117 offset:20480
  ds_read_b64_tr_b16 a[56:57], v116 offset:4096
  ds_read_b64_tr_b16 a[58:59], v116 offset:10240
  ds_read_b64_tr_b16 a[80:81], v116 offset:16384
  ds_read_b64_tr_b16 a[82:83], v116 offset:22528
  ds_read_b64_tr_b16 a[60:61], v117 offset:4096
  ds_read_b64_tr_b16 a[62:63], v117 offset:10240
  ds_read_b64_tr_b16 a[84:85], v117 offset:16384
  ds_read_b64_tr_b16 a[86:87], v117 offset:22528
  ds_read_b128 v[140:143], v132 offset:0
  ds_read_b128 v[144:147], v133 offset:0
  ds_read_b128 v[148:151], v132 offset:2048
  ds_read_b128 v[152:155], v133 offset:2048
  s_add_u32 s44, s67, 1
  s_and_b32 s44, s44, 15
  s_mul_i32 s45, s44, 393216
  s_add_u32 s69, s45, s60
  s_add_u32 s70, s69, 4096
  s_add_u32 m0, s63, 24576
  s_nop 0
  buffer_load_dwordx4 v124, s[8:11], s69 offen offset:0  lds
  buffer_load_dwordx4 v125, s[8:11], s69 offen offset:1024  lds
  buffer_load_dwordx4 v124, s[8:11], s69 offen offset:2048  lds
  buffer_load_dwordx4 v125, s[8:11], s69 offen offset:3072  lds
  s_add_u32 m0, s63, 28672
  s_nop 0
  buffer_load_dwordx4 v124, s[8:11], s70 offen offset:0  lds
  buffer_load_dwordx4 v125, s[8:11], s70 offen offset:1024  lds
  s_waitcnt lgkmcnt(15)
  v_mfma_f32_16x16x32_bf16 v[0:3], a[40:43], a[4:7], 0
  s_add_u32 s44, s67, 2
  s_and_b32 s44, s44, 15
  s_mul_i32 s45, s44, 393216
  s_add_u32 s69, s45, s60
  s_add_u32 s70, s69, 4096
  s_add_u32 m0, s63, 49152
  s_nop 0
  v_mfma_f32_16x16x32_bf16 v[0:3], a[64:67], a[24:27], v[0:3]
  buffer_load_dwordx4 v124, s[8:11], s69 offen offset:0  lds
  v_mfma_f32_16x16x32_bf16 v[4:7], a[64:67], a[28:31], 0
  v_mfma_f32_16x16x32_bf16 v[4:7], a[40:43], a[8:11], v[4:7]
  buffer_load_dwordx4 v125, s[8:11], s69 offen offset:1024  lds
  v_mfma_f32_16x16x32_bf16 v[8:11], a[40:43], a[12:15], 0
  v_mfma_f32_16x16x32_bf16 v[8:11], a[64:67], a[32:35], v[8:11]
  v_mfma_f32_16x16x32_bf16 v[12:15], a[64:67], a[36:39], 0
  buffer_load_dwordx4 v124, s[8:11], s69 offen offset:2048  lds
  v_mfma_f32_16x16x32_bf16 v[12:15], a[40:43], a[16:19], v[12:15]
  v_mfma_f32_16x16x32_bf16 v[28:31], a[44:47], a[16:19], 0
  buffer_load_dwordx4 v125, s[8:11], s69 offen offset:3072  lds
  v_mfma_f32_16x16x32_bf16 v[28:31], a[68:71], a[36:39], v[28:31]
  s_add_u32 m0, s63, 53248
  s_nop 0
  v_mfma_f32_16x16x32_bf16 v[24:27], a[68:71], a[32:35], 0
  v_mfma_f32_16x16x32_bf16 v[24:27], a[44:47], a[12:15], v[24:27]
  buffer_load_dwordx4 v124, s[8:11], s70 offen offset:0  lds
  v_mfma_f32_16x16x32_bf16 v[20:23], a[44:47], a[8:11], 0
  v_mfma_f32_16x16x32_bf16 v[20:23], a[68:71], a[28:31], v[20:23]
  buffer_load_dwordx4 v125, s[8:11], s70 offen offset:1024  lds
  v_mfma_f32_16x16x32_bf16 v[16:19], a[68:71], a[24:27], 0
  s_add_u32 s44, s67, 2
  s_and_b32 s44, s44, 15
  s_mul_i32 s45, s44, s61
  s_add_u32 s68, s45, s59
  s_add_u32 m0, s62, 106496
  s_nop 0
  v_mfma_f32_16x16x32_bf16 v[16:19], a[44:47], a[4:7], v[16:19]
  v_mfma_f32_16x16x32_bf16 v[96:99], a[48:51], a[0:3], 0
  s_waitcnt vmcnt(6) lgkmcnt(0)
  s_barrier
  ds_read_b64_tr_b16 a[128:129], v116 offset:24576
  v_mfma_f32_16x16x32_bf16 v[96:99], a[72:75], a[20:23], v[96:99]
  ds_read_b64_tr_b16 a[130:131], v116 offset:30720
  buffer_load_dwordx4 v120, s[28:31], s68 offen offset:0 sc1  lds
  v_mfma_f32_16x16x32_bf16 v[32:35], a[72:75], a[24:27], 0
  ds_read_b64_tr_b16 a[152:153], v116 offset:36864
  v_mfma_f32_16x16x32_bf16 v[32:35], a[48:51], a[4:7], v[32:35]
  ds_read_b64_tr_b16 a[154:155], v116 offset:43008
  v_mfma_f32_16x16x32_bf16 v[36:39], a[48:51], a[8:11], 0
  ds_read_b128 a[92:95], v112 offset:16384
  buffer_load_dwordx4 v121, s[28:31], s68 offen offset:1024 sc1  lds
  v_mfma_f32_16x16x32_bf16 v[36:39], a[72:75], a[28:31], v[36:39]
  ds_read_b128 a[112:115], v113 offset:16384
  v_mfma_f32_16x16x32_bf16 v[40:43], a[72:75], a[32:35], 0
  ds_read_b128 a[96:99], v112 offset:18432
  buffer_load_dwordx4 v122, s[28:31], s68 offen offset:2048 sc1  lds
  v_mfma_f32_16x16x32_bf16 v[40:43], a[48:51], a[12:15], v[40:43]
  ds_read_b128 a[116:119], v113 offset:18432
  v_mfma_f32_16x16x32_bf16 v[44:47], a[48:51], a[16:19], 0
  ds_read_b128 a[100:103], v112 offset:20480
  v_mfma_f32_16x16x32_bf16 v[44:47], a[72:75], a[36:39], v[44:47]
  s_add_u32 s44, s67, s40
  ds_read_b128 a[120:123], v113 offset:20480
  buffer_load_dwordx4 v123, s[28:31], s68 offen offset:3072 sc1  lds
  s_add_u32 s44, s44, 4
  s_and_b32 s44, s44, 15
  s_mul_i32 s44, s44, s61
  s_lshl_b32 s45, s40, 10
  v_mfma_f32_16x16x32_bf16 v[60:63], a[76:79], a[36:39], 0
  s_add_u32 m0, s45, 126976
  s_add_u32 s44, s44, s73
  ds_read_b128 a[104:107], v112 offset:22528
  v_mfma_f32_16x16x32_bf16 v[60:63], a[52:55], a[16:19], v[60:63]
  ds_read_b128 a[124:127], v113 offset:22528
  v_mfma_f32_16x16x32_bf16 v[56:59], a[52:55], a[12:15], 0
  ds_read_b64_tr_b16 a[132:133], v117 offset:24576
  buffer_load_dwordx4 v126, s[28:31], s44 offen sc1 lds
  s_add_u32 s44, s67, s40
  s_add_u32 s44, s44, 8
  s_and_b32 s44, s44, 15
  s_mul_i32 s44, s44, s61
  s_lshl_b32 s45, s40, 10
  v_mfma_f32_16x16x32_bf16 v[56:59], a[76:79], a[32:35], v[56:59]
  s_add_u32 m0, s45, 131072
  s_add_u32 s44, s44, s73
  ds_read_b64_tr_b16 a[134:135], v117 offset:30720
  v_mfma_f32_16x16x32_bf16 v[160:163], a[40:43], v[156:159], 0
  ds_read_b64_tr_b16 a[156:157], v117 offset:36864
  v_mfma_f32_16x16x32_bf16 v[164:167], a[48:51], v[156:159], 0
  ds_read_b64_tr_b16 a[158:159], v117 offset:43008
  buffer_load_dwordx4 v126, s[28:31], s44 offen sc1 lds
  s_add_u32 s44, s67, s40
  s_add_u32 s44, s44, 12
  s_and_b32 s44, s44, 15
  s_mul_i32 s44, s44, s61
  s_lshl_b32 s45, s40, 10
  v_mfma_f32_16x16x32_bf16 v[168:171], a[56:59], v[156:159], 0
  s_add_u32 m0, s45, 135168
  s_add_u32 s44, s44, s73
  ds_read_b128 a[88:91], v114 offset:1024
  v_mfma_f32_16x16x32_bf16 v[160:163], a[64:67], v[156:159], v[160:163]
  ds_read_b128 a[108:111], v115 offset:1024
  buffer_load_dwordx4 v126, s[28:31], s44 offen sc1 lds
  s_add_u32 s44, s67, 3
  s_and_b32 s44, s44, 15
  s_mul_i32 s45, s44, s61
  s_add_u32 s68, s45, s59
  s_add_u32 m0, s62, 73728
  s_nop 0
  v_mfma_f32_16x16x32_bf16 v[164:167], a[72:75], v[156:159], v[164:167]
  ds_read_b64_tr_b16 a[136:137], v116 offset:26624
  v_mfma_f32_16x16x32_bf16 v[168:171], a[80:83], v[156:159], v[168:171]
  ds_read_b64_tr_b16 a[138:139], v116 offset:32768
  v_mfma_f32_16x16x32_bf16 v[208:211], v[148:151], v[148:151], 0
  ds_read_b64_tr_b16 a[160:161], v116 offset:38912
  buffer_load_dwordx4 v120, s[28:31], s68 offen offset:0 sc1  lds
  v_mfma_f32_16x16x32_bf16 v[204:207], v[192:195], v[148:151], 0
  ds_read_b64_tr_b16 a[162:163], v116 offset:45056
  v_mfma_f32_16x16x32_bf16 v[200:203], v[140:143], v[140:143], 0
  ds_read_b64_tr_b16 a[140:141], v117 offset:26624
  v_mfma_f32_16x16x32_bf16 v[196:199], v[192:195], v[140:143], 0
  ds_read_b64_tr_b16 a[142:143], v117 offset:32768
  buffer_load_dwordx4 v121, s[28:31], s68 offen offset:1024 sc1  lds
  v_mfma_f32_16x16x32_bf16 v[208:211], v[152:155], v[152:155], v[208:211]
  ds_read_b64_tr_b16 a[164:165], v117 offset:38912
  v_mfma_f32_16x16x32_bf16 v[204:207], v[192:195], v[152:155], v[204:207]
  ds_read_b64_tr_b16 a[166:167], v117 offset:45056
  v_mfma_f32_16x16x32_bf16 v[200:203], v[144:147], v[144:147], v[200:203]
  ds_read_b64_tr_b16 a[144:145], v116 offset:28672
  buffer_load_dwordx4 v122, s[28:31], s68 offen offset:2048 sc1  lds
  v_mfma_f32_16x16x32_bf16 v[196:199], v[192:195], v[144:147], v[196:199]
  ds_read_b64_tr_b16 a[146:147], v116 offset:34816
  v_mfma_f32_16x16x32_bf16 v[52:55], a[76:79], a[28:31], 0
  s_add_u32 s44, s67, 3
  ds_read_b64_tr_b16 a[168:169], v116 offset:40960
  buffer_load_dwordx4 v123, s[28:31], s68 offen offset:3072 sc1  lds
  s_and_b32 s44, s44, 15
  s_mul_i32 s45, s44, 393216
  s_add_u32 s69, s45, s60
  s_add_u32 s70, s69, 4096
  s_add_u32 m0, s63, 0
  s_nop 0
  v_mfma_f32_16x16x32_bf16 v[52:55], a[52:55], a[8:11], v[52:55]
  ds_read_b64_tr_b16 a[170:171], v116 offset:47104
  v_mfma_f32_16x16x32_bf16 v[48:51], a[52:55], a[4:7], 0
  ds_read_b64_tr_b16 a[148:149], v117 offset:28672
  v_mfma_f32_16x16x32_bf16 v[48:51], a[76:79], a[24:27], v[48:51]
  ds_read_b64_tr_b16 a[150:151], v117 offset:34816
  buffer_load_dwordx4 v124, s[8:11], s69 offen offset:0  lds
  v_mfma_f32_16x16x32_bf16 v[100:103], a[20:23], a[80:83], 0
  ds_read_b64_tr_b16 a[172:173], v117 offset:40960
  v_mfma_f32_16x16x32_bf16 v[100:103], a[0:3], a[56:59], v[100:103]
  ds_read_b64_tr_b16 a[174:175], v117 offset:47104
  v_mfma_f32_16x16x32_bf16 v[64:67], a[4:7], a[56:59], 0
  buffer_load_dwordx4 v125, s[8:11], s69 offen offset:1024  lds
  v_mfma_f32_16x16x32_bf16 v[64:67], a[24:27], a[80:83], v[64:67]
  v_cndmask_b32 v205, v208, v209, s[78:79]
  v_cndmask_b32 v205, v205, v210, s[80:81]
  v_cndmask_b32 v205, v205, v211, s[82:83]
  v_mfma_f32_16x16x32_bf16 v[68:71], a[28:31], a[80:83], 0
  buffer_store_dwordx2 v[204:205], v212, s[4:7], s48 offen offset:2048 sc1
  v_cndmask_b32 v197, v200, v201, s[78:79]
  v_mfma_f32_16x16x32_bf16 v[68:71], a[8:11], a[56:59], v[68:71]
  buffer_load_dwordx4 v124, s[8:11], s69 offen offset:2048  lds
  v_mfma_f32_16x16x32_bf16 v[72:75], a[12:15], a[56:59], 0
  v_cndmask_b32 v197, v197, v202, s[80:81]
  v_cndmask_b32 v197, v197, v203, s[82:83]
  v_mfma_f32_16x16x32_bf16 v[72:75], a[32:35], a[80:83], v[72:75]
  buffer_store_dwordx2 v[196:197], v212, s[4:7], s48 offen offset:0 sc1
  buffer_load_dwordx4 v125, s[8:11], s69 offen offset:3072  lds
  s_add_u32 m0, s63, 4096
  s_nop 0
  v_mfma_f32_16x16x32_bf16 v[76:79], a[36:39], a[80:83], 0
  buffer_store_dwordx4 v[160:163], v136, s[4:7], s49 offen sc1
  v_mfma_f32_16x16x32_bf16 v[76:79], a[16:19], a[56:59], v[76:79]
  s_add_u32 s49, s49, 4096
  buffer_store_dwordx4 v[164:167], v136, s[4:7], s49 offen sc1
  v_mfma_f32_16x16x32_bf16 v[92:95], a[16:19], a[60:63], 0
  s_add_u32 s49, s49, 4096
  buffer_load_dwordx4 v124, s[8:11], s70 offen offset:0  lds
  v_mfma_f32_16x16x32_bf16 v[92:95], a[36:39], a[84:87], v[92:95]
  buffer_store_dwordx4 v[168:171], v136, s[4:7], s49 offen sc1
  v_mfma_f32_16x16x32_bf16 v[88:91], a[32:35], a[84:87], 0
  s_add_u32 s49, s49, 4096
  v_mfma_f32_16x16x32_bf16 v[88:91], a[12:15], a[60:63], v[88:91]
  buffer_load_dwordx4 v125, s[8:11], s70 offen offset:1024  lds
  v_mfma_f32_16x16x32_bf16 v[84:87], a[8:11], a[60:63], 0
  v_mfma_f32_16x16x32_bf16 v[84:87], a[28:31], a[84:87], v[84:87]
  v_mfma_f32_16x16x32_bf16 v[80:83], a[24:27], a[84:87], 0
  v_mfma_f32_16x16x32_bf16 v[80:83], a[4:7], a[60:63], v[80:83]
  s_add_u32 s44, s67, 4
  s_and_b32 s44, s44, 15
  s_mul_i32 s45, s44, s61
  s_add_u32 s68, s45, s59
  s_mov_b32 s66, 5
  s_mov_b32 s56, 2
  s_cmp_eq_u32 s66, s88
  s_cbranch_scc1 Lside_k9_c
Lside_k9_r:
  s_branch Lp1_u1
  s_branch Lp1_common
Llayer:
  s_cmp_lg_u32 s40, 0
  s_cbranch_scc1 Lpdn2
  s_mov_b32 s43, 0x40000
  s_mov_b64 exec, 3
Lpol1:
  buffer_load_dword v250, v249, s[4:7], s77 offen  sc1
  s_waitcnt vmcnt(0)
  v_cmp_gt_u32 vcc, 16, v250
  s_cbranch_vccz Lpdn2x
  s_sub_u32 s43, s43, 1
  s_cmp_lg_u32 s43, 0
  s_cbranch_scc1 Lpol1
Lpdn2x:
  s_mov_b64 exec, -1
Lpdn2:
  s_waitcnt vmcnt(0) lgkmcnt(0)
  s_barrier
  s_add_u32 s44, s67, 0
  s_and_b32 s44, s44, 15
  s_mul_i32 s45, s44, s61
  s_add_u32 s68, s45, s59
  s_add_u32 m0, s62, 73728
  s_nop 0
  buffer_load_dwordx4 v120, s[28:31], s68 offen offset:0 sc1  lds
  buffer_load_dwordx4 v121, s[28:31], s68 offen offset:1024 sc1  lds
  buffer_load_dwordx4 v122, s[28:31], s68 offen offset:2048 sc1  lds
  buffer_load_dwordx4 v123, s[28:31], s68 offen offset:3072 sc1  lds
  s_add_u32 s44, s67, s40
  s_add_u32 s44, s44, 0
  s_and_b32 s44, s44, 15
  s_mul_i32 s44, s44, s61
  s_lshl_b32 s45, s40, 10
  s_add_u32 m0, s45, 122880
  s_add_u32 s44, s44, s73
  buffer_load_dwordx4 v126, s[28:31], s44 offen sc1 lds
  s_add_u32 s44, s67, 1
  s_and_b32 s44, s44, 15
  s_mul_i32 s45, s44, s61
  s_add_u32 s68, s45, s59
  s_add_u32 m0, s62, 90112
  s_nop 0
  buffer_load_dwordx4 v120, s[28:31], s68 offen offset:0 sc1  lds
  buffer_load_dwordx4 v121, s[28:31], s68 offen offset:1024 sc1  lds
  buffer_load_dwordx4 v122, s[28:31], s68 offen offset:2048 sc1  lds
  buffer_load_dwordx4 v123, s[28:31], s68 offen offset:3072 sc1  lds
  ds_read_b64_tr_b16 a[40:41], v116 offset:0
  ds_read_b64_tr_b16 a[42:43], v116 offset:6144
  ds_read_b64_tr_b16 a[64:65], v116 offset:12288
  ds_read_b64_tr_b16 a[66:67], v116 offset:18432
  ds_read_b64_tr_b16 a[44:45], v117 offset:0
  ds_read_b64_tr_b16 a[46:47], v117 offset:6144
  ds_read_b64_tr_b16 a[68:69], v117 offset:12288
  ds_read_b64_tr_b16 a[70:71], v117 offset:18432
  ds_read_b64_tr_b16 a[48:49], v116 offset:2048
  ds_read_b64_tr_b16 a[50:51], v116 offset:8192
  ds_read_b64_tr_b16 a[72:73], v116 offset:14336
  ds_read_b64_tr_b16 a[74:75], v116 offset:20480
  ds_read_b64_tr_b16 a[52:53], v117 offset:2048
  ds_read_b64_tr_b16 a[54:55], v117 offset:8192
  ds_read_b64_tr_b16 a[76:77], v117 offset:14336
  ds_read_b64_tr_b16 a[78:79], v117 offset:20480
  ds_read_b64_tr_b16 a[56:57], v116 offset:4096
  ds_read_b64_tr_b16 a[58:59], v116 offset:10240
  ds_read_b64_tr_b16 a[80:81], v116 offset:16384
  ds_read_b64_tr_b16 a[82:83], v116 offset:22528
  ds_read_b64_tr_b16 a[60:61], v117 offset:4096
  ds_read_b64_tr_b16 a[62:63], v117 offset:10240
  ds_read_b64_tr_b16 a[84:85], v117 offset:16384
  ds_read_b64_tr_b16 a[86:87], v117 offset:22528
  s_waitcnt vmcnt(4)
  s_barrier
  ds_read_b128 a[4:7], v112 offset:0
  ds_read_b128 a[24:27], v113 offset:0
  ds_read_b128 a[8:11], v112 offset:2048
  ds_read_b128 a[28:31], v113 offset:2048
  ds_read_b128 a[12:15], v112 offset:4096
  ds_read_b128 a[32:35], v113 offset:4096
  ds_read_b128 a[16:19], v112 offset:6144
  ds_read_b128 a[36:39], v113 offset:6144
  ds_read_b128 a[0:3], v114 offset:0
  ds_read_b128 a[20:23], v115 offset:0
  s_add_u32 s44, s67, s40
  s_add_u32 s44, s44, 4
  s_and_b32 s44, s44, 15
  s_mul_i32 s44, s44, s61
  s_lshl_b32 s45, s40, 10
  s_add_u32 m0, s45, 126976
  s_add_u32 s44, s44, s73
  buffer_load_dwordx4 v126, s[28:31], s44 offen sc1 lds
  s_add_u32 s44, s67, s40
  s_add_u32 s44, s44, 8
  s_and_b32 s44, s44, 15
  s_mul_i32 s44, s44, s61
  s_lshl_b32 s45, s40, 10
  s_add_u32 m0, s45, 131072
  s_add_u32 s44, s44, s73
  buffer_load_dwordx4 v126, s[28:31], s44 offen sc1 lds
  s_add_u32 s44, s67, s40
  s_add_u32 s44, s44, 12
  s_and_b32 s44, s44, 15
  s_mul_i32 s44, s44, s61
  s_lshl_b32 s45, s40, 10
  s_add_u32 m0, s45, 135168
  s_add_u32 s44, s44, s73
  buffer_load_dwordx4 v126, s[28:31], s44 offen sc1 lds
  s_add_u32 s44, s67, 2
  s_and_b32 s44, s44, 15
  s_mul_i32 s45, s44, s61
  s_add_u32 s68, s45, s59
  s_add_u32 m0, s62, 106496
  s_nop 0
  buffer_load_dwordx4 v120, s[28:31], s68 offen offset:0 sc1  lds
  buffer_load_dwordx4 v121, s[28:31], s68 offen offset:1024 sc1  lds
  buffer_load_dwordx4 v122, s[28:31], s68 offen offset:2048 sc1  lds
  buffer_load_dwordx4 v123, s[28:31], s68 offen offset:3072 sc1  lds
  s_waitcnt lgkmcnt(0)
Lp1_common:
  s_mov_b32 s66, 4
  s_add_u32 s44, s67, 3
  s_and_b32 s44, s44, 15
  s_mul_i32 s45, s44, s61
  s_add_u32 s68, s45, s59
  s_mov_b32 s56, 2
.p2align 3
Lp1_loop:
  s_waitcnt lgkmcnt(15)
  v_mfma_f32_16x16x32_bf16 v[0:3], a[40:43], a[4:7], v[0:3]
  s_mul_i32 s45, s44, 393216
  v_mfma_f32_16x16x32_bf16 v[0:3], a[64:67], a[24:27], v[0:3]
  s_add_u32 s69, s45, s60
  v_mfma_f32_16x16x32_bf16 v[4:7], a[64:67], a[28:31], v[4:7]
  s_add_u32 s70, s69, 4096
  v_mfma_f32_16x16x32_bf16 v[4:7], a[40:43], a[8:11], v[4:7]
  v_mfma_f32_16x16x32_bf16 v[8:11], a[40:43], a[12:15], v[8:11]
  s_waitcnt vmcnt(7) lgkmcnt(0)
  s_barrier
  ds_read_b64_tr_b16 a[128:129], v116 offset:24576
  v_mfma_f32_16x16x32_bf16 v[8:11], a[64:67], a[32:35], v[8:11]
  ds_read_b64_tr_b16 a[130:131], v116 offset:30720
  v_mfma_f32_16x16x32_bf16 v[12:15], a[64:67], a[36:39], v[12:15]
  s_add_u32 m0, s62, 73728
  ds_read_b64_tr_b16 a[152:153], v116 offset:36864
  v_mfma_f32_16x16x32_bf16 v[12:15], a[40:43], a[16:19], v[12:15]
  buffer_load_dwordx4 v120, s[28:31], s68 offen offset:0 sc1  lds
  v_mfma_f32_16x16x32_bf16 v[28:31], a[44:47], a[16:19], v[28:31]
  ds_read_b64_tr_b16 a[154:155], v116 offset:43008
  v_mfma_f32_16x16x32_bf16 v[28:31], a[68:71], a[36:39], v[28:31]
  ds_read_b128 a[92:95], v112 offset:16384
  v_mfma_f32_16x16x32_bf16 v[24:27], a[68:71], a[32:35], v[24:27]
  ds_read_b128 a[112:115], v113 offset:16384
  v_mfma_f32_16x16x32_bf16 v[24:27], a[44:47], a[12:15], v[24:27]
  buffer_load_dwordx4 v121, s[28:31], s68 offen offset:1024 sc1  lds
  v_mfma_f32_16x16x32_bf16 v[20:23], a[44:47], a[8:11], v[20:23]
  ds_read_b128 a[96:99], v112 offset:18432
  v_mfma_f32_16x16x32_bf16 v[20:23], a[68:71], a[28:31], v[20:23]
  ds_read_b128 a[116:119], v113 offset:18432
  v_mfma_f32_16x16x32_bf16 v[16:19], a[68:71], a[24:27], v[16:19]
  ds_read_b128 a[100:103], v112 offset:20480
  v_mfma_f32_16x16x32_bf16 v[16:19], a[44:47], a[4:7], v[16:19]
  buffer_load_dwordx4 v122, s[28:31], s68 offen offset:2048 sc1  lds
  v_mfma_f32_16x16x32_bf16 v[96:99], a[48:51], a[0:3], v[96:99]
  ds_read_b128 a[120:123], v113 offset:20480
  v_mfma_f32_16x16x32_bf16 v[96:99], a[72:75], a[20:23], v[96:99]
  ds_read_b128 a[104:107], v112 offset:22528
  v_mfma_f32_16x16x32_bf16 v[32:35], a[72:75], a[24:27], v[32:35]
  ds_read_b128 a[124:127], v113 offset:22528
  v_mfma_f32_16x16x32_bf16 v[32:35], a[48:51], a[4:7], v[32:35]
  buffer_load_dwordx4 v123, s[28:31], s68 offen offset:3072 sc1  lds
  v_mfma_f32_16x16x32_bf16 v[36:39], a[48:51], a[8:11], v[36:39]
  ds_read_b64_tr_b16 a[132:133], v117 offset:24576
  v_mfma_f32_16x16x32_bf16 v[36:39], a[72:75], a[28:31], v[36:39]
  ds_read_b64_tr_b16 a[134:135], v117 offset:30720
  v_mfma_f32_16x16x32_bf16 v[40:43], a[72:75], a[32:35], v[40:43]
  s_add_u32 m0, s63, 0
  ds_read_b64_tr_b16 a[156:157], v117 offset:36864
  v_mfma_f32_16x16x32_bf16 v[40:43], a[48:51], a[12:15], v[40:43]
  buffer_load_dwordx4 v124, s[8:11], s69 offen offset:0  lds
  v_mfma_f32_16x16x32_bf16 v[44:47], a[48:51], a[16:19], v[44:47]
  s_add_u32 s44, s44, 1
  ds_read_b64_tr_b16 a[158:159], v117 offset:43008
  v_mfma_f32_16x16x32_bf16 v[44:47], a[72:75], a[36:39], v[44:47]
  s_and_b32 s44, s44, 15
  ds_read_b128 a[88:91], v114 offset:1024
  v_mfma_f32_16x16x32_bf16 v[60:63], a[76:79], a[36:39], v[60:63]
  s_add_u32 s66, s66, 1
  ds_read_b128 a[108:111], v115 offset:1024
  v_mfma_f32_16x16x32_bf16 v[60:63], a[52:55], a[16:19], v[60:63]
  s_mul_i32 s45, s44, s61
  buffer_load_dwordx4 v125, s[8:11], s69 offen offset:1024  lds
  v_mfma_f32_16x16x32_bf16 v[56:59], a[52:55], a[12:15], v[56:59]
  s_add_u32 s68, s45, s59
  ds_read_b64_tr_b16 a[136:137], v116 offset:26624
  v_mfma_f32_16x16x32_bf16 v[56:59], a[76:79], a[32:35], v[56:59]
  ds_read_b64_tr_b16 a[138:139], v116 offset:32768
  v_mfma_f32_16x16x32_bf16 v[52:55], a[76:79], a[28:31], v[52:55]
  ds_read_b64_tr_b16 a[160:161], v116 offset:38912
  v_mfma_f32_16x16x32_bf16 v[52:55], a[52:55], a[8:11], v[52:55]
  buffer_load_dwordx4 v124, s[8:11], s69 offen offset:2048  lds
  v_mfma_f32_16x16x32_bf16 v[48:51], a[52:55], a[4:7], v[48:51]
  ds_read_b64_tr_b16 a[162:163], v116 offset:45056
  v_mfma_f32_16x16x32_bf16 v[48:51], a[76:79], a[24:27], v[48:51]
  ds_read_b64_tr_b16 a[140:141], v117 offset:26624
  v_mfma_f32_16x16x32_bf16 v[100:103], a[20:23], a[80:83], v[100:103]
  ds_read_b64_tr_b16 a[142:143], v117 offset:32768
  v_mfma_f32_16x16x32_bf16 v[100:103], a[0:3], a[56:59], v[100:103]
  buffer_load_dwordx4 v125, s[8:11], s69 offen offset:3072  lds
  v_mfma_f32_16x16x32_bf16 v[64:67], a[4:7], a[56:59], v[64:67]
  ds_read_b64_tr_b16 a[164:165], v117 offset:38912
  v_mfma_f32_16x16x32_bf16 v[64:67], a[24:27], a[80:83], v[64:67]
  ds_read_b64_tr_b16 a[166:167], v117 offset:45056
  v_mfma_f32_16x16x32_bf16 v[68:71], a[28:31], a[80:83], v[68:71]
  s_add_u32 m0, s63, 4096
  ds_read_b64_tr_b16 a[144:145], v116 offset:28672
  v_mfma_f32_16x16x32_bf16 v[68:71], a[8:11], a[56:59], v[68:71]
  buffer_load_dwordx4 v124, s[8:11], s70 offen offset:0  lds
  v_mfma_f32_16x16x32_bf16 v[72:75], a[12:15], a[56:59], v[72:75]
  ds_read_b64_tr_b16 a[146:147], v116 offset:34816
  v_mfma_f32_16x16x32_bf16 v[72:75], a[32:35], a[80:83], v[72:75]
  ds_read_b64_tr_b16 a[168:169], v116 offset:40960
  v_mfma_f32_16x16x32_bf16 v[76:79], a[36:39], a[80:83], v[76:79]
  ds_read_b64_tr_b16 a[170:171], v116 offset:47104
  v_mfma_f32_16x16x32_bf16 v[76:79], a[16:19], a[56:59], v[76:79]
  buffer_load_dwordx4 v125, s[8:11], s70 offen offset:1024  lds
  v_mfma_f32_16x16x32_bf16 v[92:95], a[16:19], a[60:63], v[92:95]
  ds_read_b64_tr_b16 a[148:149], v117 offset:28672
  v_mfma_f32_16x16x32_bf16 v[92:95], a[36:39], a[84:87], v[92:95]
  ds_read_b64_tr_b16 a[150:151], v117 offset:34816
  v_mfma_f32_16x16x32_bf16 v[88:91], a[32:35], a[84:87], v[88:91]
  ds_read_b64_tr_b16 a[172:173], v117 offset:40960
  v_mfma_f32_16x16x32_bf16 v[88:91], a[12:15], a[60:63], v[88:91]
  ds_read_b64_tr_b16 a[174:175], v117 offset:47104
  v_mfma_f32_16x16x32_bf16 v[84:87], a[8:11], a[60:63], v[84:87]
  s_cmp_eq_u32 s66, s88
  s_cbranch_scc1 Lside_k0_c
Lside_k0_r:
  v_mfma_f32_16x16x32_bf16 v[84:87], a[28:31], a[84:87], v[84:87]
  v_mfma_f32_16x16x32_bf16 v[80:83], a[24:27], a[84:87], v[80:83]
  v_mfma_f32_16x16x32_bf16 v[80:83], a[4:7], a[60:63], v[80:83]
Lp1_u1:
  s_waitcnt lgkmcnt(15)
  v_mfma_f32_16x16x32_bf16 v[0:3], a[128:131], a[92:95], v[0:3]
  s_mul_i32 s45, s44, 393216
  v_mfma_f32_16x16x32_bf16 v[0:3], a[152:155], a[112:115], v[0:3]
  s_add_u32 s69, s45, s60
  v_mfma_f32_16x16x32_bf16 v[4:7], a[152:155], a[116:119], v[4:7]
  s_add_u32 s70, s69, 4096
  v_mfma_f32_16x16x32_bf16 v[4:7], a[128:131], a[96:99], v[4:7]
  v_mfma_f32_16x16x32_bf16 v[8:11], a[128:131], a[100:103], v[8:11]
  s_waitcnt vmcnt(10) lgkmcnt(0)
  s_barrier
  ds_read_b64_tr_b16 a[40:41], v118 offset:0
  v_mfma_f32_16x16x32_bf16 v[8:11], a[152:155], a[120:123], v[8:11]
  ds_read_b64_tr_b16 a[42:43], v118 offset:6144
  v_mfma_f32_16x16x32_bf16 v[12:15], a[152:155], a[124:127], v[12:15]
  s_add_u32 m0, s62, 90112
  ds_read_b64_tr_b16 a[64:65], v118 offset:12288
  v_mfma_f32_16x16x32_bf16 v[12:15], a[128:131], a[104:107], v[12:15]
  buffer_load_dwordx4 v120, s[28:31], s68 offen offset:0 sc1  lds
  v_mfma_f32_16x16x32_bf16 v[28:31], a[132:135], a[104:107], v[28:31]
  ds_read_b64_tr_b16 a[66:67], v118 offset:18432
  v_mfma_f32_16x16x32_bf16 v[28:31], a[156:159], a[124:127], v[28:31]
  ds_read_b128 a[4:7], v112 offset:32768
  v_mfma_f32_16x16x32_bf16 v[24:27], a[156:159], a[120:123], v[24:27]
  ds_read_b128 a[24:27], v113 offset:32768
  v_mfma_f32_16x16x32_bf16 v[24:27], a[132:135], a[100:103], v[24:27]
  buffer_load_dwordx4 v121, s[28:31], s68 offen offset:1024 sc1  lds
  v_mfma_f32_16x16x32_bf16 v[20:23], a[132:135], a[96:99], v[20:23]
  ds_read_b128 a[8:11], v112 offset:34816
  v_mfma_f32_16x16x32_bf16 v[20:23], a[156:159], a[116:119], v[20:23]
  ds_read_b128 a[28:31], v113 offset:34816
  v_mfma_f32_16x16x32_bf16 v[16:19], a[156:159], a[112:115], v[16:19]
  ds_read_b128 a[12:15], v112 offset:36864
  v_mfma_f32_16x16x32_bf16 v[16:19], a[132:135], a[92:95], v[16:19]
  buffer_load_dwordx4 v122, s[28:31], s68 offen offset:2048 sc1  lds
  v_mfma_f32_16x16x32_bf16 v[96:99], a[136:139], a[88:91], v[96:99]
  ds_read_b128 a[32:35], v113 offset:36864
  v_mfma_f32_16x16x32_bf16 v[96:99], a[160:163], a[108:111], v[96:99]
  ds_read_b128 a[16:19], v112 offset:38912
  v_mfma_f32_16x16x32_bf16 v[32:35], a[160:163], a[112:115], v[32:35]
  ds_read_b128 a[36:39], v113 offset:38912
  v_mfma_f32_16x16x32_bf16 v[32:35], a[136:139], a[92:95], v[32:35]
  buffer_load_dwordx4 v123, s[28:31], s68 offen offset:3072 sc1  lds
  v_mfma_f32_16x16x32_bf16 v[36:39], a[136:139], a[96:99], v[36:39]
  ds_read_b64_tr_b16 a[44:45], v119 offset:0
  v_mfma_f32_16x16x32_bf16 v[36:39], a[160:163], a[116:119], v[36:39]
  ds_read_b64_tr_b16 a[46:47], v119 offset:6144
  v_mfma_f32_16x16x32_bf16 v[40:43], a[160:163], a[120:123], v[40:43]
  s_add_u32 m0, s63, 24576
  ds_read_b64_tr_b16 a[68:69], v119 offset:12288
  v_mfma_f32_16x16x32_bf16 v[40:43], a[136:139], a[100:103], v[40:43]
  buffer_load_dwordx4 v124, s[8:11], s69 offen offset:0  lds
  v_mfma_f32_16x16x32_bf16 v[44:47], a[136:139], a[104:107], v[44:47]
  s_add_u32 s44, s44, 1
  ds_read_b64_tr_b16 a[70:71], v119 offset:18432
  v_mfma_f32_16x16x32_bf16 v[44:47], a[160:163], a[124:127], v[44:47]
  s_and_b32 s44, s44, 15
  ds_read_b128 a[0:3], v114 offset:2048
  v_mfma_f32_16x16x32_bf16 v[60:63], a[164:167], a[124:127], v[60:63]
  s_add_u32 s66, s66, 1
  ds_read_b128 a[20:23], v115 offset:2048
  v_mfma_f32_16x16x32_bf16 v[60:63], a[140:143], a[104:107], v[60:63]
  s_mul_i32 s45, s44, s61
  buffer_load_dwordx4 v125, s[8:11], s69 offen offset:1024  lds
  v_mfma_f32_16x16x32_bf16 v[56:59], a[140:143], a[100:103], v[56:59]
  s_add_u32 s68, s45, s59
  ds_read_b64_tr_b16 a[48:49], v118 offset:2048
  v_mfma_f32_16x16x32_bf16 v[56:59], a[164:167], a[120:123], v[56:59]
  ds_read_b64_tr_b16 a[50:51], v118 offset:8192
  v_mfma_f32_16x16x32_bf16 v[52:55], a[164:167], a[116:119], v[52:55]
  ds_read_b64_tr_b16 a[72:73], v118 offset:14336
  v_mfma_f32_16x16x32_bf16 v[52:55], a[140:143], a[96:99], v[52:55]
  buffer_load_dwordx4 v124, s[8:11], s69 offen offset:2048  lds
  v_mfma_f32_16x16x32_bf16 v[48:51], a[140:143], a[92:95], v[48:51]
  ds_read_b64_tr_b16 a[74:75], v118 offset:20480
  v_mfma_f32_16x16x32_bf16 v[48:51], a[164:167], a[112:115], v[48:51]
  ds_read_b64_tr_b16 a[52:53], v119 offset:2048
  v_mfma_f32_16x16x32_bf16 v[100:103], a[108:111], a[168:171], v[100:103]
  ds_read_b64_tr_b16 a[54:55], v119 offset:8192
  v_mfma_f32_16x16x32_bf16 v[100:103], a[88:91], a[144:147], v[100:103]
  buffer_load_dwordx4 v125, s[8:11], s69 offen offset:3072  lds
  v_mfma_f32_16x16x32_bf16 v[64:67], a[92:95], a[144:147], v[64:67]
  ds_read_b64_tr_b16 a[76:77], v119 offset:14336
  v_mfma_f32_16x16x32_bf16 v[64:67], a[112:115], a[168:171], v[64:67]
  ds_read_b64_tr_b16 a[78:79], v119 offset:20480
  v_mfma_f32_16x16x32_bf16 v[68:71], a[116:119], a[168:171], v[68:71]
  s_add_u32 m0, s63, 28672
  ds_read_b64_tr_b16 a[56:57], v118 offset:4096
  v_mfma_f32_16x16x32_bf16 v[68:71], a[96:99], a[144:147], v[68:71]
  buffer_load_dwordx4 v124, s[8:11], s70 offen offset:0  lds
  v_mfma_f32_16x16x32_bf16 v[72:75], a[100:103], a[144:147], v[72:75]
  ds_read_b64_tr_b16 a[58:59], v118 offset:10240
  v_mfma_f32_16x16x32_bf16 v[72:75], a[120:123], a[168:171], v[72:75]
  ds_read_b64_tr_b16 a[80:81], v118 offset:16384
  v_mfma_f32_16x16x32_bf16 v[76:79], a[124:127], a[168:171], v[76:79]
  ds_read_b64_tr_b16 a[82:83], v118 offset:22528
  v_mfma_f32_16x16x32_bf16 v[76:79], a[104:107], a[144:147], v[76:79]
  buffer_load_dwordx4 v125, s[8:11], s70 offen offset:1024  lds
  v_mfma_f32_16x16x32_bf16 v[92:95], a[104:107], a[148:151], v[92:95]
  ds_read_b64_tr_b16 a[60:61], v119 offset:4096
  v_mfma_f32_16x16x32_bf16 v[92:95], a[124:127], a[172:175], v[92:95]
  ds_read_b64_tr_b16 a[62:63], v119 offset:10240
  v_mfma_f32_16x16x32_bf16 v[88:91], a[120:123], a[172:175], v[88:91]
  ds_read_b64_tr_b16 a[84:85], v119 offset:16384
  v_mfma_f32_16x16x32_bf16 v[88:91], a[100:103], a[148:151], v[88:91]
  ds_read_b64_tr_b16 a[86:87], v119 offset:22528
  v_mfma_f32_16x16x32_bf16 v[84:87], a[96:99], a[148:151], v[84:87]
  s_cmp_eq_u32 s66, s88
  s_cbranch_scc1 Lside_k1_c
Lside_k1_r:
  v_mfma_f32_16x16x32_bf16 v[84:87], a[116:119], a[172:175], v[84:87]
  v_mfma_f32_16x16x32_bf16 v[80:83], a[112:115], a[172:175], v[80:83]
  v_mfma_f32_16x16x32_bf16 v[80:83], a[92:95], a[148:151], v[80:83]
  s_waitcnt lgkmcnt(15)
  v_mfma_f32_16x16x32_bf16 v[0:3], a[40:43], a[4:7], v[0:3]
  s_mul_i32 s45, s44, 393216
  v_mfma_f32_16x16x32_bf16 v[0:3], a[64:67], a[24:27], v[0:3]
  s_add_u32 s69, s45, s60
  v_mfma_f32_16x16x32_bf16 v[4:7], a[64:67], a[28:31], v[4:7]
  s_add_u32 s70, s69, 4096
  v_mfma_f32_16x16x32_bf16 v[4:7], a[40:43], a[8:11], v[4:7]
  v_mfma_f32_16x16x32_bf16 v[8:11], a[40:43], a[12:15], v[8:11]
  s_waitcnt vmcnt(10) lgkmcnt(0)
  s_barrier
  ds_read_b64_tr_b16 a[128:129], v116 offset:0
  v_mfma_f32_16x16x32_bf16 v[8:11], a[64:67], a[32:35], v[8:11]
  ds_read_b64_tr_b16 a[130:131], v116 offset:6144
  v_mfma_f32_16x16x32_bf16 v[12:15], a[64:67], a[36:39], v[12:15]
  s_add_u32 m0, s62, 106496
  ds_read_b64_tr_b16 a[152:153], v116 offset:12288
  v_mfma_f32_16x16x32_bf16 v[12:15], a[40:43], a[16:19], v[12:15]
  buffer_load_dwordx4 v120, s[28:31], s68 offen offset:0 sc1  lds
  v_mfma_f32_16x16x32_bf16 v[28:31], a[44:47], a[16:19], v[28:31]
  ds_read_b64_tr_b16 a[154:155], v116 offset:18432
  v_mfma_f32_16x16x32_bf16 v[28:31], a[68:71], a[36:39], v[28:31]
  ds_read_b128 a[92:95], v112 offset:0
  v_mfma_f32_16x16x32_bf16 v[24:27], a[68:71], a[32:35], v[24:27]
  ds_read_b128 a[112:115], v113 offset:0
  v_mfma_f32_16x16x32_bf16 v[24:27], a[44:47], a[12:15], v[24:27]
  buffer_load_dwordx4 v121, s[28:31], s68 offen offset:1024 sc1  lds
  v_mfma_f32_16x16x32_bf16 v[20:23], a[44:47], a[8:11], v[20:23]
  ds_read_b128 a[96:99], v112 offset:2048
  v_mfma_f32_16x16x32_bf16 v[20:23], a[68:71], a[28:31], v[20:23]
  ds_read_b128 a[116:119], v113 offset:2048
  v_mfma_f32_16x16x32_bf16 v[16:19], a[68:71], a[24:27], v[16:19]
  ds_read_b128 a[100:103], v112 offset:4096
  v_mfma_f32_16x16x32_bf16 v[16:19], a[44:47], a[4:7], v[16:19]
  buffer_load_dwordx4 v122, s[28:31], s68 offen offset:2048 sc1  lds
  v_mfma_f32_16x16x32_bf16 v[96:99], a[48:51], a[0:3], v[96:99]
  ds_read_b128 a[120:123], v113 offset:4096
  v_mfma_f32_16x16x32_bf16 v[96:99], a[72:75], a[20:23], v[96:99]
  ds_read_b128 a[104:107], v112 offset:6144
  v_mfma_f32_16x16x32_bf16 v[32:35], a[72:75], a[24:27], v[32:35]
  ds_read_b128 a[124:127], v113 offset:6144
  v_mfma_f32_16x16x32_bf16 v[32:35], a[48:51], a[4:7], v[32:35]
  buffer_load_dwordx4 v123, s[28:31], s68 offen offset:3072 sc1  lds
  v_mfma_f32_16x16x32_bf16 v[36:39], a[48:51], a[8:11], v[36:39]
  ds_read_b64_tr_b16 a[132:133], v117 offset:0
  v_mfma_f32_16x16x32_bf16 v[36:39], a[72:75], a[28:31], v[36:39]
  ds_read_b64_tr_b16 a[134:135], v117 offset:6144
  v_mfma_f32_16x16x32_bf16 v[40:43], a[72:75], a[32:35], v[40:43]
  s_add_u32 m0, s63, 49152
  ds_read_b64_tr_b16 a[156:157], v117 offset:12288
  v_mfma_f32_16x16x32_bf16 v[40:43], a[48:51], a[12:15], v[40:43]
  buffer_load_dwordx4 v124, s[8:11], s69 offen offset:0  lds
  v_mfma_f32_16x16x32_bf16 v[44:47], a[48:51], a[16:19], v[44:47]
  s_add_u32 s44, s44, 1
  ds_read_b64_tr_b16 a[158:159], v117 offset:18432
  v_mfma_f32_16x16x32_bf16 v[44:47], a[72:75], a[36:39], v[44:47]
  s_and_b32 s44, s44, 15
  ds_read_b128 a[88:91], v114 offset:3072
  v_mfma_f32_16x16x32_bf16 v[60:63], a[76:79], a[36:39], v[60:63]
  s_add_u32 s66, s66, 1
  ds_read_b128 a[108:111], v115 offset:3072
  v_mfma_f32_16x16x32_bf16 v[60:63], a[52:55], a[16:19], v[60:63]
  s_mul_i32 s45, s44, s61
  buffer_load_dwordx4 v125, s[8:11], s69 offen offset:1024  lds
  v_mfma_f32_16x16x32_bf16 v[56:59], a[52:55], a[12:15], v[56:59]
  s_add_u32 s68, s45, s59
  ds_read_b64_tr_b16 a[136:137], v116 offset:2048
  v_mfma_f32_16x16x32_bf16 v[56:59], a[76:79], a[32:35], v[56:59]
  ds_read_b64_tr_b16 a[138:139], v116 offset:8192
  v_mfma_f32_16x16x32_bf16 v[52:55], a[76:79], a[28:31], v[52:55]
  ds_read_b64_tr_b16 a[160:161], v116 offset:14336
  v_mfma_f32_16x16x32_bf16 v[52:55], a[52:55], a[8:11], v[52:55]
  buffer_load_dwordx4 v124, s[8:11], s69 offen offset:2048  lds
  v_mfma_f32_16x16x32_bf16 v[48:51], a[52:55], a[4:7], v[48:51]
  ds_read_b64_tr_b16 a[162:163], v116 offset:20480
  v_mfma_f32_16x16x32_bf16 v[48:51], a[76:79], a[24:27], v[48:51]
  ds_read_b64_tr_b16 a[140:141], v117 offset:2048
  v_mfma_f32_16x16x32_bf16 v[100:103], a[20:23], a[80:83], v[100:103]
  ds_read_b64_tr_b16 a[142:143], v117 offset:8192
  v_mfma_f32_16x16x32_bf16 v[100:103], a[0:3], a[56:59], v[100:103]
  buffer_load_dwordx4 v125, s[8:11], s69 offen offset:3072  lds
  v_mfma_f32_16x16x32_bf16 v[64:67], a[4:7], a[56:59], v[64:67]
  ds_read_b64_tr_b16 a[164:165], v117 offset:14336
  v_mfma_f32_16x16x32_bf16 v[64:67], a[24:27], a[80:83], v[64:67]
  ds_read_b64_tr_b16 a[166:167], v117 offset:20480
  v_mfma_f32_16x16x32_bf16 v[68:71], a[28:31], a[80:83], v[68:71]
  s_add_u32 m0, s63, 53248
  ds_read_b64_tr_b16 a[144:145], v116 offset:4096
  v_mfma_f32_16x16x32_bf16 v[68:71], a[8:11], a[56:59], v[68:71]
  buffer_load_dwordx4 v124, s[8:11], s70 offen offset:0  lds
  v_mfma_f32_16x16x32_bf16 v[72:75], a[12:15], a[56:59], v[72:75]
  ds_read_b64_tr_b16 a[146:147], v116 offset:10240
  v_mfma_f32_16x16x32_bf16 v[72:75], a[32:35], a[80:83], v[72:75]
  ds_read_b64_tr_b16 a[168:169], v116 offset:16384
  v_mfma_f32_16x16x32_bf16 v[76:79], a[36:39], a[80:83], v[76:79]
  ds_read_b64_tr_b16 a[170:171], v116 offset:22528
  v_mfma_f32_16x16x32_bf16 v[76:79], a[16:19], a[56:59], v[76:79]
  buffer_load_dwordx4 v125, s[8:11], s70 offen offset:1024  lds
  v_mfma_f32_16x16x32_bf16 v[92:95], a[16:19], a[60:63], v[92:95]
  ds_read_b64_tr_b16 a[148:149], v117 offset:4096
  v_mfma_f32_16x16x32_bf16 v[92:95], a[36:39], a[84:87], v[92:95]
  ds_read_b64_tr_b16 a[150:151], v117 offset:10240
  v_mfma_f32_16x16x32_bf16 v[88:91], a[32:35], a[84:87], v[88:91]
  ds_read_b64_tr_b16 a[172:173], v117 offset:16384
  v_mfma_f32_16x16x32_bf16 v[88:91], a[12:15], a[60:63], v[88:91]
  ds_read_b64_tr_b16 a[174:175], v117 offset:22528
  v_mfma_f32_16x16x32_bf16 v[84:87], a[8:11], a[60:63], v[84:87]
  s_cmp_eq_u32 s66, s88
  s_cbranch_scc1 Lside_k2_c
Lside_k2_r:
  v_mfma_f32_16x16x32_bf16 v[84:87], a[28:31], a[84:87], v[84:87]
  v_mfma_f32_16x16x32_bf16 v[80:83], a[24:27], a[84:87], v[80:83]
  v_mfma_f32_16x16x32_bf16 v[80:83], a[4:7], a[60:63], v[80:83]
  s_waitcnt lgkmcnt(15)
  v_mfma_f32_16x16x32_bf16 v[0:3], a[128:131], a[92:95], v[0:3]
  s_mul_i32 s45, s44, 393216
  v_mfma_f32_16x16x32_bf16 v[0:3], a[152:155], a[112:115], v[0:3]
  s_add_u32 s69, s45, s60
  v_mfma_f32_16x16x32_bf16 v[4:7], a[152:155], a[116:119], v[4:7]
  s_add_u32 s70, s69, 4096
  v_mfma_f32_16x16x32_bf16 v[4:7], a[128:131], a[96:99], v[4:7]
  v_mfma_f32_16x16x32_bf16 v[8:11], a[128:131], a[100:103], v[8:11]
  s_waitcnt vmcnt(10) lgkmcnt(0)
  s_barrier
  ds_read_b64_tr_b16 a[40:41], v116 offset:24576
  v_mfma_f32_16x16x32_bf16 v[8:11], a[152:155], a[120:123], v[8:11]
  ds_read_b64_tr_b16 a[42:43], v116 offset:30720
  v_mfma_f32_16x16x32_bf16 v[12:15], a[152:155], a[124:127], v[12:15]
  s_add_u32 m0, s62, 73728
  ds_read_b64_tr_b16 a[64:65], v116 offset:36864
  v_mfma_f32_16x16x32_bf16 v[12:15], a[128:131], a[104:107], v[12:15]
  buffer_load_dwordx4 v120, s[28:31], s68 offen offset:0 sc1  lds
  v_mfma_f32_16x16x32_bf16 v[28:31], a[132:135], a[104:107], v[28:31]
  ds_read_b64_tr_b16 a[66:67], v116 offset:43008
  v_mfma_f32_16x16x32_bf16 v[28:31], a[156:159], a[124:127], v[28:31]
  ds_read_b128 a[4:7], v112 offset:16384
  v_mfma_f32_16x16x32_bf16 v[24:27], a[156:159], a[120:123], v[24:27]
  ds_read_b128 a[24:27], v113 offset:16384
  v_mfma_f32_16x16x32_bf16 v[24:27], a[132:135], a[100:103], v[24:27]
  buffer_load_dwordx4 v121, s[28:31], s68 offen offset:1024 sc1  lds
  v_mfma_f32_16x16x32_bf16 v[20:23], a[132:135], a[96:99], v[20:23]
  ds_read_b128 a[8:11], v112 offset:18432
  v_mfma_f32_16x16x32_bf16 v[20:23], a[156:159], a[116:119], v[20:23]
  ds_read_b128 a[28:31], v113 offset:18432
  v_mfma_f32_16x16x32_bf16 v[16:19], a[156:159], a[112:115], v[16:19]
  ds_read_b128 a[12:15], v112 offset:20480
  v_mfma_f32_16x16x32_bf16 v[16:19], a[132:135], a[92:95], v[16:19]
  buffer_load_dwordx4 v122, s[28:31], s68 offen offset:2048 sc1  lds
  v_mfma_f32_16x16x32_bf16 v[96:99], a[136:139], a[88:91], v[96:99]
  ds_read_b128 a[32:35], v113 offset:20480
  v_mfma_f32_16x16x32_bf16 v[96:99], a[160:163], a[108:111], v[96:99]
  ds_read_b128 a[16:19], v112 offset:22528
  v_mfma_f32_16x16x32_bf16 v[32:35], a[160:163], a[112:115], v[32:35]
  ds_read_b128 a[36:39], v113 offset:22528
  v_mfma_f32_16x16x32_bf16 v[32:35], a[136:139], a[92:95], v[32:35]
  buffer_load_dwordx4 v123, s[28:31], s68 offen offset:3072 sc1  lds
  v_mfma_f32_16x16x32_bf16 v[36:39], a[136:139], a[96:99], v[36:39]
  ds_read_b64_tr_b16 a[44:45], v117 offset:24576
  v_mfma_f32_16x16x32_bf16 v[36:39], a[160:163], a[116:119], v[36:39]
  ds_read_b64_tr_b16 a[46:47], v117 offset:30720
  v_mfma_f32_16x16x32_bf16 v[40:43], a[160:163], a[120:123], v[40:43]
  s_add_u32 m0, s63, 0
  ds_read_b64_tr_b16 a[68:69], v117 offset:36864
  v_mfma_f32_16x16x32_bf16 v[40:43], a[136:139], a[100:103], v[40:43]
  buffer_load_dwordx4 v124, s[8:11], s69 offen offset:0  lds
  v_mfma_f32_16x16x32_bf16 v[44:47], a[136:139], a[104:107], v[44:47]
  s_add_u32 s44, s44, 1
  ds_read_b64_tr_b16 a[70:71], v117 offset:43008
  v_mfma_f32_16x16x32_bf16 v[44:47], a[160:163], a[124:127], v[44:47]
  s_and_b32 s44, s44, 15
  ds_read_b128 a[0:3], v114 offset:4096
  v_mfma_f32_16x16x32_bf16 v[60:63], a[164:167], a[124:127], v[60:63]
  s_add_u32 s66, s66, 1
  ds_read_b128 a[20:23], v115 offset:4096
  v_mfma_f32_16x16x32_bf16 v[60:63], a[140:143], a[104:107], v[60:63]
  s_mul_i32 s45, s44, s61
  buffer_load_dwordx4 v125, s[8:11], s69 offen offset:1024  lds
  v_mfma_f32_16x16x32_bf16 v[56:59], a[140:143], a[100:103], v[56:59]
  s_add_u32 s68, s45, s59
  ds_read_b64_tr_b16 a[48:49], v116 offset:26624
  v_mfma_f32_16x16x32_bf16 v[56:59], a[164:167], a[120:123], v[56:59]
  ds_read_b64_tr_b16 a[50:51], v116 offset:32768
  v_mfma_f32_16x16x32_bf16 v[52:55], a[164:167], a[116:119], v[52:55]
  ds_read_b64_tr_b16 a[72:73], v116 offset:38912
  v_mfma_f32_16x16x32_bf16 v[52:55], a[140:143], a[96:99], v[52:55]
  buffer_load_dwordx4 v124, s[8:11], s69 offen offset:2048  lds
  v_mfma_f32_16x16x32_bf16 v[48:51], a[140:143], a[92:95], v[48:51]
  ds_read_b64_tr_b16 a[74:75], v116 offset:45056
  v_mfma_f32_16x16x32_bf16 v[48:51], a[164:167], a[112:115], v[48:51]
  ds_read_b64_tr_b16 a[52:53], v117 offset:26624
  v_mfma_f32_16x16x32_bf16 v[100:103], a[108:111], a[168:171], v[100:103]
  ds_read_b64_tr_b16 a[54:55], v117 offset:32768
  v_mfma_f32_16x16x32_bf16 v[100:103], a[88:91], a[144:147], v[100:103]
  buffer_load_dwordx4 v125, s[8:11], s69 offen offset:3072  lds
  v_mfma_f32_16x16x32_bf16 v[64:67], a[92:95], a[144:147], v[64:67]
  ds_read_b64_tr_b16 a[76:77], v117 offset:38912
  v_mfma_f32_16x16x32_bf16 v[64:67], a[112:115], a[168:171], v[64:67]
  ds_read_b64_tr_b16 a[78:79], v117 offset:45056
  v_mfma_f32_16x16x32_bf16 v[68:71], a[116:119], a[168:171], v[68:71]
  s_add_u32 m0, s63, 4096
  ds_read_b64_tr_b16 a[56:57], v116 offset:28672
  v_mfma_f32_16x16x32_bf16 v[68:71], a[96:99], a[144:147], v[68:71]
  buffer_load_dwordx4 v124, s[8:11], s70 offen offset:0  lds
  v_mfma_f32_16x16x32_bf16 v[72:75], a[100:103], a[144:147], v[72:75]
  ds_read_b64_tr_b16 a[58:59], v116 offset:34816
  v_mfma_f32_16x16x32_bf16 v[72:75], a[120:123], a[168:171], v[72:75]
  ds_read_b64_tr_b16 a[80:81], v116 offset:40960
  v_mfma_f32_16x16x32_bf16 v[76:79], a[124:127], a[168:171], v[76:79]
  ds_read_b64_tr_b16 a[82:83], v116 offset:47104
  v_mfma_f32_16x16x32_bf16 v[76:79], a[104:107], a[144:147], v[76:79]
  buffer_load_dwordx4 v125, s[8:11], s70 offen offset:1024  lds
  v_mfma_f32_16x16x32_bf16 v[92:95], a[104:107], a[148:151], v[92:95]
  ds_read_b64_tr_b16 a[60:61], v117 offset:28672
  v_mfma_f32_16x16x32_bf16 v[92:95], a[124:127], a[172:175], v[92:95]
  ds_read_b64_tr_b16 a[62:63], v117 offset:34816
  v_mfma_f32_16x16x32_bf16 v[88:91], a[120:123], a[172:175], v[88:91]
  ds_read_b64_tr_b16 a[84:85], v117 offset:40960
  v_mfma_f32_16x16x32_bf16 v[88:91], a[100:103], a[148:151], v[88:91]
  ds_read_b64_tr_b16 a[86:87], v117 offset:47104
  v_mfma_f32_16x16x32_bf16 v[84:87], a[96:99], a[148:151], v[84:87]
  s_cmp_eq_u32 s66, s88
  s_cbranch_scc1 Lside_k3_c
Lside_k3_r:
  v_mfma_f32_16x16x32_bf16 v[84:87], a[116:119], a[172:175], v[84:87]
  v_mfma_f32_16x16x32_bf16 v[80:83], a[112:115], a[172:175], v[80:83]
  v_mfma_f32_16x16x32_bf16 v[80:83], a[92:95], a[148:151], v[80:83]
  s_waitcnt lgkmcnt(15)
  v_mfma_f32_16x16x32_bf16 v[0:3], a[40:43], a[4:7], v[0:3]
  s_mul_i32 s45, s44, 393216
  v_mfma_f32_16x16x32_bf16 v[0:3], a[64:67], a[24:27], v[0:3]
  s_add_u32 s69, s45, s60
  v_mfma_f32_16x16x32_bf16 v[4:7], a[64:67], a[28:31], v[4:7]
  s_add_u32 s70, s69, 4096
  v_mfma_f32_16x16x32_bf16 v[4:7], a[40:43], a[8:11], v[4:7]
  v_mfma_f32_16x16x32_bf16 v[8:11], a[40:43], a[12:15], v[8:11]
  s_waitcnt vmcnt(10) lgkmcnt(0)
  s_barrier
  ds_read_b64_tr_b16 a[128:129], v118 offset:0
  v_mfma_f32_16x16x32_bf16 v[8:11], a[64:67], a[32:35], v[8:11]
  ds_read_b64_tr_b16 a[130:131], v118 offset:6144
  v_mfma_f32_16x16x32_bf16 v[12:15], a[64:67], a[36:39], v[12:15]
  s_add_u32 m0, s62, 90112
  ds_read_b64_tr_b16 a[152:153], v118 offset:12288
  v_mfma_f32_16x16x32_bf16 v[12:15], a[40:43], a[16:19], v[12:15]
  buffer_load_dwordx4 v120, s[28:31], s68 offen offset:0 sc1  lds
  v_mfma_f32_16x16x32_bf16 v[28:31], a[44:47], a[16:19], v[28:31]
  ds_read_b64_tr_b16 a[154:155], v118 offset:18432
  v_mfma_f32_16x16x32_bf16 v[28:31], a[68:71], a[36:39], v[28:31]
  ds_read_b128 a[92:95], v112 offset:32768
  v_mfma_f32_16x16x32_bf16 v[24:27], a[68:71], a[32:35], v[24:27]
  ds_read_b128 a[112:115], v113 offset:32768
  v_mfma_f32_16x16x32_bf16 v[24:27], a[44:47], a[12:15], v[24:27]
  buffer_load_dwordx4 v121, s[28:31], s68 offen offset:1024 sc1  lds
  v_mfma_f32_16x16x32_bf16 v[20:23], a[44:47], a[8:11], v[20:23]
  ds_read_b128 a[96:99], v112 offset:34816
  v_mfma_f32_16x16x32_bf16 v[20:23], a[68:71], a[28:31], v[20:23]
  ds_read_b128 a[116:119], v113 offset:34816
  v_mfma_f32_16x16x32_bf16 v[16:19], a[68:71], a[24:27], v[16:19]
  ds_read_b128 a[100:103], v112 offset:36864
  v_mfma_f32_16x16x32_bf16 v[16:19], a[44:47], a[4:7], v[16:19]
  buffer_load_dwordx4 v122, s[28:31], s68 offen offset:2048 sc1  lds
  v_mfma_f32_16x16x32_bf16 v[96:99], a[48:51], a[0:3], v[96:99]
  ds_read_b128 a[120:123], v113 offset:36864
  v_mfma_f32_16x16x32_bf16 v[96:99], a[72:75], a[20:23], v[96:99]
  ds_read_b128 a[104:107], v112 offset:38912
  v_mfma_f32_16x16x32_bf16 v[32:35], a[72:75], a[24:27], v[32:35]
  ds_read_b128 a[124:127], v113 offset:38912
  v_mfma_f32_16x16x32_bf16 v[32:35], a[48:51], a[4:7], v[32:35]
  buffer_load_dwordx4 v123, s[28:31], s68 offen offset:3072 sc1  lds
  v_mfma_f32_16x16x32_bf16 v[36:39], a[48:51], a[8:11], v[36:39]
  ds_read_b64_tr_b16 a[132:133], v119 offset:0
  v_mfma_f32_16x16x32_bf16 v[36:39], a[72:75], a[28:31], v[36:39]
  ds_read_b64_tr_b16 a[134:135], v119 offset:6144
  v_mfma_f32_16x16x32_bf16 v[40:43], a[72:75], a[32:35], v[40:43]
  s_add_u32 m0, s63, 24576
  ds_read_b64_tr_b16 a[156:157], v119 offset:12288
  v_mfma_f32_16x16x32_bf16 v[40:43], a[48:51], a[12:15], v[40:43]
  buffer_load_dwordx4 v124, s[8:11], s69 offen offset:0  lds
  v_mfma_f32_16x16x32_bf16 v[44:47], a[48:51], a[16:19], v[44:47]
  s_add_u32 s44, s44, 1
  ds_read_b64_tr_b16 a[158:159], v119 offset:18432
  v_mfma_f32_16x16x32_bf16 v[44:47], a[72:75], a[36:39], v[44:47]
  s_and_b32 s44, s44, 15
  ds_read_b128 a[88:91], v114 offset:5120
  v_mfma_f32_16x16x32_bf16 v[60:63], a[76:79], a[36:39], v[60:63]
  s_add_u32 s66, s66, 1
  ds_read_b128 a[108:111], v115 offset:5120
  v_mfma_f32_16x16x32_bf16 v[60:63], a[52:55], a[16:19], v[60:63]
  s_mul_i32 s45, s44, s61
  buffer_load_dwordx4 v125, s[8:11], s69 offen offset:1024  lds
  v_mfma_f32_16x16x32_bf16 v[56:59], a[52:55], a[12:15], v[56:59]
  s_add_u32 s68, s45, s59
  ds_read_b64_tr_b16 a[136:137], v118 offset:2048
  v_mfma_f32_16x16x32_bf16 v[56:59], a[76:79], a[32:35], v[56:59]
  ds_read_b64_tr_b16 a[138:139], v118 offset:8192
  v_mfma_f32_16x16x32_bf16 v[52:55], a[76:79], a[28:31], v[52:55]
  ds_read_b64_tr_b16 a[160:161], v118 offset:14336
  v_mfma_f32_16x16x32_bf16 v[52:55], a[52:55], a[8:11], v[52:55]
  buffer_load_dwordx4 v124, s[8:11], s69 offen offset:2048  lds
  v_mfma_f32_16x16x32_bf16 v[48:51], a[52:55], a[4:7], v[48:51]
  ds_read_b64_tr_b16 a[162:163], v118 offset:20480
  v_mfma_f32_16x16x32_bf16 v[48:51], a[76:79], a[24:27], v[48:51]
  ds_read_b64_tr_b16 a[140:141], v119 offset:2048
  v_mfma_f32_16x16x32_bf16 v[100:103], a[20:23], a[80:83], v[100:103]
  ds_read_b64_tr_b16 a[142:143], v119 offset:8192
  v_mfma_f32_16x16x32_bf16 v[100:103], a[0:3], a[56:59], v[100:103]
  buffer_load_dwordx4 v125, s[8:11], s69 offen offset:3072  lds
  v_mfma_f32_16x16x32_bf16 v[64:67], a[4:7], a[56:59], v[64:67]
  ds_read_b64_tr_b16 a[164:165], v119 offset:14336
  v_mfma_f32_16x16x32_bf16 v[64:67], a[24:27], a[80:83], v[64:67]
  ds_read_b64_tr_b16 a[166:167], v119 offset:20480
  v_mfma_f32_16x16x32_bf16 v[68:71], a[28:31], a[80:83], v[68:71]
  s_add_u32 m0, s63, 28672
  ds_read_b64_tr_b16 a[144:145], v118 offset:4096
  v_mfma_f32_16x16x32_bf16 v[68:71], a[8:11], a[56:59], v[68:71]
  buffer_load_dwordx4 v124, s[8:11], s70 offen offset:0  lds
  v_mfma_f32_16x16x32_bf16 v[72:75], a[12:15], a[56:59], v[72:75]
  ds_read_b64_tr_b16 a[146:147], v118 offset:10240
  v_mfma_f32_16x16x32_bf16 v[72:75], a[32:35], a[80:83], v[72:75]
  ds_read_b64_tr_b16 a[168:169], v118 offset:16384
  v_mfma_f32_16x16x32_bf16 v[76:79], a[36:39], a[80:83], v[76:79]
  ds_read_b64_tr_b16 a[170:171], v118 offset:22528
  v_mfma_f32_16x16x32_bf16 v[76:79], a[16:19], a[56:59], v[76:79]
  buffer_load_dwordx4 v125, s[8:11], s70 offen offset:1024  lds
  v_mfma_f32_16x16x32_bf16 v[92:95], a[16:19], a[60:63], v[92:95]
  ds_read_b64_tr_b16 a[148:149], v119 offset:4096
  v_mfma_f32_16x16x32_bf16 v[92:95], a[36:39], a[84:87], v[92:95]
  ds_read_b64_tr_b16 a[150:151], v119 offset:10240
  v_mfma_f32_16x16x32_bf16 v[88:91], a[32:35], a[84:87], v[88:91]
  ds_read_b64_tr_b16 a[172:173], v119 offset:16384
  v_mfma_f32_16x16x32_bf16 v[88:91], a[12:15], a[60:63], v[88:91]
  ds_read_b64_tr_b16 a[174:175], v119 offset:22528
  v_mfma_f32_16x16x32_bf16 v[84:87], a[8:11], a[60:63], v[84:87]
  s_cmp_eq_u32 s66, s88
  s_cbranch_scc1 Lside_k4_c
Lside_k4_r:
  v_mfma_f32_16x16x32_bf16 v[84:87], a[28:31], a[84:87], v[84:87]
  v_mfma_f32_16x16x32_bf16 v[80:83], a[24:27], a[84:87], v[80:83]
  v_mfma_f32_16x16x32_bf16 v[80:83], a[4:7], a[60:63], v[80:83]
  s_waitcnt lgkmcnt(15)
  v_mfma_f32_16x16x32_bf16 v[0:3], a[128:131], a[92:95], v[0:3]
  s_mul_i32 s45, s44, 393216
  v_mfma_f32_16x16x32_bf16 v[0:3], a[152:155], a[112:115], v[0:3]
  s_add_u32 s69, s45, s60
  v_mfma_f32_16x16x32_bf16 v[4:7], a[152:155], a[116:119], v[4:7]
  s_add_u32 s70, s69, 4096
  v_mfma_f32_16x16x32_bf16 v[4:7], a[128:131], a[96:99], v[4:7]
  v_mfma_f32_16x16x32_bf16 v[8:11], a[128:131], a[100:103], v[8:11]
  s_waitcnt vmcnt(10) lgkmcnt(0)
  s_barrier
  ds_read_b64_tr_b16 a[40:41], v116 offset:0
  v_mfma_f32_16x16x32_bf16 v[8:11], a[152:155], a[120:123], v[8:11]
  ds_read_b64_tr_b16 a[42:43], v116 offset:6144
  v_mfma_f32_16x16x32_bf16 v[12:15], a[152:155], a[124:127], v[12:15]
  s_add_u32 m0, s62, 106496
  ds_read_b64_tr_b16 a[64:65], v116 offset:12288
  v_mfma_f32_16x16x32_bf16 v[12:15], a[128:131], a[104:107], v[12:15]
  buffer_load_dwordx4 v120, s[28:31], s68 offen offset:0 sc1  lds
  v_mfma_f32_16x16x32_bf16 v[28:31], a[132:135], a[104:107], v[28:31]
  ds_read_b64_tr_b16 a[66:67], v116 offset:18432
  v_mfma_f32_16x16x32_bf16 v[28:31], a[156:159], a[124:127], v[28:31]
  ds_read_b128 a[4:7], v112 offset:0
  v_mfma_f32_16x16x32_bf16 v[24:27], a[156:159], a[120:123], v[24:27]
  ds_read_b128 a[24:27], v113 offset:0
  v_mfma_f32_16x16x32_bf16 v[24:27], a[132:135], a[100:103], v[24:27]
  buffer_load_dwordx4 v121, s[28:31], s68 offen offset:1024 sc1  lds
  v_mfma_f32_16x16x32_bf16 v[20:23], a[132:135], a[96:99], v[20:23]
  ds_read_b128 a[8:11], v112 offset:2048
  v_mfma_f32_16x16x32_bf16 v[20:23], a[156:159], a[116:119], v[20:23]
  ds_read_b128 a[28:31], v113 offset:2048
  v_mfma_f32_16x16x32_bf16 v[16:19], a[156:159], a[112:115], v[16:19]
  ds_read_b128 a[12:15], v112 offset:4096
  v_mfma_f32_16x16x32_bf16 v[16:19], a[132:135], a[92:95], v[16:19]
  buffer_load_dwordx4 v122, s[28:31], s68 offen offset:2048 sc1  lds
  v_mfma_f32_16x16x32_bf16 v[96:99], a[136:139], a[88:91], v[96:99]
  ds_read_b128 a[32:35], v113 offset:4096
  v_mfma_f32_16x16x32_bf16 v[96:99], a[160:163], a[108:111], v[96:99]
  ds_read_b128 a[16:19], v112 offset:6144
  v_mfma_f32_16x16x32_bf16 v[32:35], a[160:163], a[112:115], v[32:35]
  ds_read_b128 a[36:39], v113 offset:6144
  v_mfma_f32_16x16x32_bf16 v[32:35], a[136:139], a[92:95], v[32:35]
  buffer_load_dwordx4 v123, s[28:31], s68 offen offset:3072 sc1  lds
  v_mfma_f32_16x16x32_bf16 v[36:39], a[136:139], a[96:99], v[36:39]
  ds_read_b64_tr_b16 a[44:45], v117 offset:0
  v_mfma_f32_16x16x32_bf16 v[36:39], a[160:163], a[116:119], v[36:39]
  ds_read_b64_tr_b16 a[46:47], v117 offset:6144
  v_mfma_f32_16x16x32_bf16 v[40:43], a[160:163], a[120:123], v[40:43]
  s_add_u32 m0, s63, 49152
  ds_read_b64_tr_b16 a[68:69], v117 offset:12288
  v_mfma_f32_16x16x32_bf16 v[40:43], a[136:139], a[100:103], v[40:43]
  buffer_load_dwordx4 v124, s[8:11], s69 offen offset:0  lds
  v_mfma_f32_16x16x32_bf16 v[44:47], a[136:139], a[104:107], v[44:47]
  s_add_u32 s44, s44, 1
  ds_read_b64_tr_b16 a[70:71], v117 offset:18432
  v_mfma_f32_16x16x32_bf16 v[44:47], a[160:163], a[124:127], v[44:47]
  s_and_b32 s44, s44, 15
  ds_read_b128 a[0:3], v114 offset:6144
  v_add_u32 v114, 6144, v114
  v_mfma_f32_16x16x32_bf16 v[60:63], a[164:167], a[124:127], v[60:63]
  s_add_u32 s66, s66, 1
  ds_read_b128 a[20:23], v115 offset:6144
  v_add_u32 v115, 6144, v115
  v_mfma_f32_16x16x32_bf16 v[60:63], a[140:143], a[104:107], v[60:63]
  s_mul_i32 s45, s44, s61
  buffer_load_dwordx4 v125, s[8:11], s69 offen offset:1024  lds
  v_mfma_f32_16x16x32_bf16 v[56:59], a[140:143], a[100:103], v[56:59]
  s_add_u32 s68, s45, s59
  ds_read_b64_tr_b16 a[48:49], v116 offset:2048
  v_mfma_f32_16x16x32_bf16 v[56:59], a[164:167], a[120:123], v[56:59]
  ds_read_b64_tr_b16 a[50:51], v116 offset:8192
  v_mfma_f32_16x16x32_bf16 v[52:55], a[164:167], a[116:119], v[52:55]
  ds_read_b64_tr_b16 a[72:73], v116 offset:14336
  v_mfma_f32_16x16x32_bf16 v[52:55], a[140:143], a[96:99], v[52:55]
  buffer_load_dwordx4 v124, s[8:11], s69 offen offset:2048  lds
  v_mfma_f32_16x16x32_bf16 v[48:51], a[140:143], a[92:95], v[48:51]
  ds_read_b64_tr_b16 a[74:75], v116 offset:20480
  v_mfma_f32_16x16x32_bf16 v[48:51], a[164:167], a[112:115], v[48:51]
  ds_read_b64_tr_b16 a[52:53], v117 offset:2048
  v_mfma_f32_16x16x32_bf16 v[100:103], a[108:111], a[168:171], v[100:103]
  ds_read_b64_tr_b16 a[54:55], v117 offset:8192
  v_mfma_f32_16x16x32_bf16 v[100:103], a[88:91], a[144:147], v[100:103]
  buffer_load_dwordx4 v125, s[8:11], s69 offen offset:3072  lds
  v_mfma_f32_16x16x32_bf16 v[64:67], a[92:95], a[144:147], v[64:67]
  ds_read_b64_tr_b16 a[76:77], v117 offset:14336
  v_mfma_f32_16x16x32_bf16 v[64:67], a[112:115], a[168:171], v[64:67]
  ds_read_b64_tr_b16 a[78:79], v117 offset:20480
  v_mfma_f32_16x16x32_bf16 v[68:71], a[116:119], a[168:171], v[68:71]
  s_add_u32 m0, s63, 53248
  ds_read_b64_tr_b16 a[56:57], v116 offset:4096
  v_mfma_f32_16x16x32_bf16 v[68:71], a[96:99], a[144:147], v[68:71]
  buffer_load_dwordx4 v124, s[8:11], s70 offen offset:0  lds
  v_mfma_f32_16x16x32_bf16 v[72:75], a[100:103], a[144:147], v[72:75]
  ds_read_b64_tr_b16 a[58:59], v116 offset:10240
  v_mfma_f32_16x16x32_bf16 v[72:75], a[120:123], a[168:171], v[72:75]
  ds_read_b64_tr_b16 a[80:81], v116 offset:16384
  v_mfma_f32_16x16x32_bf16 v[76:79], a[124:127], a[168:171], v[76:79]
  ds_read_b64_tr_b16 a[82:83], v116 offset:22528
  v_mfma_f32_16x16x32_bf16 v[76:79], a[104:107], a[144:147], v[76:79]
  buffer_load_dwordx4 v125, s[8:11], s70 offen offset:1024  lds
  v_mfma_f32_16x16x32_bf16 v[92:95], a[104:107], a[148:151], v[92:95]
  ds_read_b64_tr_b16 a[60:61], v117 offset:4096
  v_mfma_f32_16x16x32_bf16 v[92:95], a[124:127], a[172:175], v[92:95]
  ds_read_b64_tr_b16 a[62:63], v117 offset:10240
  v_mfma_f32_16x16x32_bf16 v[88:91], a[120:123], a[172:175], v[88:91]
  ds_read_b64_tr_b16 a[84:85], v117 offset:16384
  v_mfma_f32_16x16x32_bf16 v[88:91], a[100:103], a[148:151], v[88:91]
  ds_read_b64_tr_b16 a[86:87], v117 offset:22528
  v_mfma_f32_16x16x32_bf16 v[84:87], a[96:99], a[148:151], v[84:87]
  s_cmp_eq_u32 s66, s88
  s_cbranch_scc1 Lside_k5_c
Lside_k5_r:
  v_mfma_f32_16x16x32_bf16 v[84:87], a[116:119], a[172:175], v[84:87]
  s_sub_u32 s56, s56, 1
  v_mfma_f32_16x16x32_bf16 v[80:83], a[112:115], a[172:175], v[80:83]
  s_cmp_lg_u32 s56, 0
  v_mfma_f32_16x16x32_bf16 v[80:83], a[92:95], a[148:151], v[80:83]
  s_cbranch_scc1 Lp1_loop
Lmk_Lp1_loop_tail:
  s_waitcnt lgkmcnt(15)
  v_mfma_f32_16x16x32_bf16 v[0:3], a[40:43], a[4:7], v[0:3]
  s_mul_i32 s45, s44, 393216
  v_and_b32 v240, 1, v253
  v_lshlrev_b32 v240, 7, v240
  v_mfma_f32_16x16x32_bf16 v[0:3], a[64:67], a[24:27], v[0:3]
  s_add_u32 s69, s45, s60
  v_mfma_f32_16x16x32_bf16 v[4:7], a[64:67], a[28:31], v[4:7]
  s_add_u32 s70, s69, 4096
  buffer_load_dword v127, v240, s[36:39], 0 offen sc1
  v_mfma_f32_16x16x32_bf16 v[4:7], a[40:43], a[8:11], v[4:7]
  s_lshl_b32 s43, s57, 2
  v_mfma_f32_16x16x32_bf16 v[8:11], a[40:43], a[12:15], v[8:11]
  s_waitcnt vmcnt(11) lgkmcnt(0)
  s_barrier
  ds_read_b64_tr_b16 a[128:129], v116 offset:24576
  v_mfma_f32_16x16x32_bf16 v[8:11], a[64:67], a[32:35], v[8:11]
  s_add_u32 s74, s71, s43
  ds_read_b64_tr_b16 a[130:131], v116 offset:30720
  v_mfma_f32_16x16x32_bf16 v[12:15], a[64:67], a[36:39], v[12:15]
  s_add_u32 m0, s62, 73728
  ds_read_b64_tr_b16 a[152:153], v116 offset:36864
  v_mfma_f32_16x16x32_bf16 v[12:15], a[40:43], a[16:19], v[12:15]
  s_add_u32 s45, s42, 27262976
  buffer_load_dwordx4 v120, s[28:31], s68 offen offset:0 sc1  lds
  v_mfma_f32_16x16x32_bf16 v[28:31], a[44:47], a[16:19], v[28:31]
  s_lshl_b32 s44, s72, 11
  ds_read_b64_tr_b16 a[154:155], v116 offset:43008
  v_mfma_f32_16x16x32_bf16 v[28:31], a[68:71], a[36:39], v[28:31]
  s_add_u32 s77, s44, s45
  ds_read_b128 a[92:95], v112 offset:16384
  v_mfma_f32_16x16x32_bf16 v[24:27], a[68:71], a[32:35], v[24:27]
  s_lshl_b32 s44, s40, 1
  ds_read_b128 a[112:115], v113 offset:16384
  v_mfma_f32_16x16x32_bf16 v[24:27], a[44:47], a[12:15], v[24:27]
  s_add_u32 s44, s44, s71
  buffer_load_dwordx4 v121, s[28:31], s68 offen offset:1024 sc1  lds
  v_mfma_f32_16x16x32_bf16 v[20:23], a[44:47], a[8:11], v[20:23]
  s_lshl_b32 s44, s44, 11
  ds_read_b128 a[96:99], v112 offset:18432
  v_mfma_f32_16x16x32_bf16 v[20:23], a[68:71], a[28:31], v[20:23]
  s_add_u32 s78, s44, s45
  ds_read_b128 a[116:119], v113 offset:18432
  v_mfma_f32_16x16x32_bf16 v[16:19], a[68:71], a[24:27], v[16:19]
  s_lshl_b32 s43, s51, 1
  ds_read_b128 a[100:103], v112 offset:20480
  v_mfma_f32_16x16x32_bf16 v[16:19], a[44:47], a[4:7], v[16:19]
  s_add_u32 s75, s43, s58
  buffer_load_dwordx4 v122, s[28:31], s68 offen offset:2048 sc1  lds
  v_mfma_f32_16x16x32_bf16 v[96:99], a[48:51], a[0:3], v[96:99]
  s_lshl_b32 s43, s75, 7
  ds_read_b128 a[120:123], v113 offset:20480
  v_mfma_f32_16x16x32_bf16 v[96:99], a[72:75], a[20:23], v[96:99]
  s_add_u32 s46, s43, 27983872
  ds_read_b128 a[104:107], v112 offset:22528
  v_mfma_f32_16x16x32_bf16 v[32:35], a[72:75], a[24:27], v[32:35]
  s_lshl_b32 s43, s57, 6
  ds_read_b128 a[124:127], v113 offset:22528
  v_mfma_f32_16x16x32_bf16 v[32:35], a[48:51], a[4:7], v[32:35]
  buffer_load_dwordx4 v123, s[28:31], s68 offen offset:3072 sc1  lds
  v_mfma_f32_16x16x32_bf16 v[36:39], a[48:51], a[8:11], v[36:39]
  ds_read_b64_tr_b16 a[132:133], v117 offset:24576
  v_mfma_f32_16x16x32_bf16 v[36:39], a[72:75], a[28:31], v[36:39]
  ds_read_b64_tr_b16 a[134:135], v117 offset:30720
  v_mfma_f32_16x16x32_bf16 v[40:43], a[72:75], a[32:35], v[40:43]
  s_add_u32 m0, s63, 0
  ds_read_b64_tr_b16 a[156:157], v117 offset:36864
  v_mfma_f32_16x16x32_bf16 v[40:43], a[48:51], a[12:15], v[40:43]
  buffer_load_dwordx4 v124, s[8:11], s69 offen offset:0  lds
  v_mfma_f32_16x16x32_bf16 v[44:47], a[48:51], a[16:19], v[44:47]
  ds_read_b64_tr_b16 a[158:159], v117 offset:43008
  v_mfma_f32_16x16x32_bf16 v[44:47], a[72:75], a[36:39], v[44:47]
  ds_read_b128 a[88:91], v114 offset:1024
  v_mfma_f32_16x16x32_bf16 v[60:63], a[76:79], a[36:39], v[60:63]
  ds_read_b128 a[108:111], v115 offset:1024
  v_mfma_f32_16x16x32_bf16 v[60:63], a[52:55], a[16:19], v[60:63]
  buffer_load_dwordx4 v125, s[8:11], s69 offen offset:1024  lds
  v_mfma_f32_16x16x32_bf16 v[56:59], a[52:55], a[12:15], v[56:59]
  ds_read_b64_tr_b16 a[136:137], v116 offset:26624
  v_mfma_f32_16x16x32_bf16 v[56:59], a[76:79], a[32:35], v[56:59]
  ds_read_b64_tr_b16 a[138:139], v116 offset:32768
  v_mfma_f32_16x16x32_bf16 v[52:55], a[76:79], a[28:31], v[52:55]
  ds_read_b64_tr_b16 a[160:161], v116 offset:38912
  v_lshlrev_b32 v105, 3, v253
  v_mfma_f32_16x16x32_bf16 v[52:55], a[52:55], a[8:11], v[52:55]
  buffer_load_dwordx4 v124, s[8:11], s69 offen offset:2048  lds
  v_mfma_f32_16x16x32_bf16 v[48:51], a[52:55], a[4:7], v[48:51]
  ds_read_b64_tr_b16 a[162:163], v116 offset:45056
  v_lshlrev_b32 v104, 4, v253
  v_mfma_f32_16x16x32_bf16 v[48:51], a[76:79], a[24:27], v[48:51]
  ds_read_b64_tr_b16 a[140:141], v117 offset:26624
  v_xor_b32 v126, s43, v104
  v_mfma_f32_16x16x32_bf16 v[100:103], a[20:23], a[80:83], v[100:103]
  ds_read_b64_tr_b16 a[142:143], v117 offset:32768
  v_add_u32 v126, s76, v126
  v_mfma_f32_16x16x32_bf16 v[100:103], a[0:3], a[56:59], v[100:103]
  buffer_load_dwordx4 v125, s[8:11], s69 offen offset:3072  lds
  v_mfma_f32_16x16x32_bf16 v[64:67], a[4:7], a[56:59], v[64:67]
  ds_read_b64_tr_b16 a[164:165], v117 offset:38912
  v_bfe_u32 v106, v253, 3, 2
  v_mfma_f32_16x16x32_bf16 v[64:67], a[24:27], a[80:83], v[64:67]
  ds_read_b64_tr_b16 a[166:167], v117 offset:45056
  v_lshrrev_b32 v107, 5, v253
  v_mfma_f32_16x16x32_bf16 v[68:71], a[28:31], a[80:83], v[68:71]
  s_add_u32 m0, s63, 4096
  ds_read_b64_tr_b16 a[144:145], v116 offset:28672
  v_mad_u32_u24 v106, v107, 3, v106
  v_mfma_f32_16x16x32_bf16 v[68:71], a[8:11], a[56:59], v[68:71]
  buffer_load_dwordx4 v124, s[8:11], s70 offen offset:0  lds
  v_mfma_f32_16x16x32_bf16 v[72:75], a[12:15], a[56:59], v[72:75]
  ds_read_b64_tr_b16 a[146:147], v116 offset:34816
  v_and_b32 v107, 7, v253
  v_mfma_f32_16x16x32_bf16 v[72:75], a[32:35], a[80:83], v[72:75]
  ds_read_b64_tr_b16 a[168:169], v116 offset:40960
  v_lshlrev_b32 v107, 4, v107
  v_mfma_f32_16x16x32_bf16 v[76:79], a[36:39], a[80:83], v[76:79]
  ds_read_b64_tr_b16 a[170:171], v116 offset:47104
  v_lshl_add_u32 v106, v106, 12, v107
  v_mfma_f32_16x16x32_bf16 v[76:79], a[16:19], a[56:59], v[76:79]
  buffer_load_dwordx4 v125, s[8:11], s70 offen offset:1024  lds
  v_mfma_f32_16x16x32_bf16 v[92:95], a[16:19], a[60:63], v[92:95]
  ds_read_b64_tr_b16 a[148:149], v117 offset:28672
  v_mfma_f32_16x16x32_bf16 v[92:95], a[36:39], a[84:87], v[92:95]
  ds_read_b64_tr_b16 a[150:151], v117 offset:34816
  v_mfma_f32_16x16x32_bf16 v[88:91], a[32:35], a[84:87], v[88:91]
  ds_read_b64_tr_b16 a[172:173], v117 offset:40960
  v_mfma_f32_16x16x32_bf16 v[88:91], a[12:15], a[60:63], v[88:91]
  s_waitcnt vmcnt(10)
  v_cmp_gt_u32 vcc, 128, v127
  s_cbranch_vccnz Lchk3_c
Lchk3_r:
  v_mfma_f32_16x16x32_bf16 v[84:87], a[8:11], a[60:63], v[84:87]
  ds_read_b64_tr_b16 a[174:175], v117 offset:47104
  v_mfma_f32_16x16x32_bf16 v[84:87], a[28:31], a[84:87], v[84:87]
  v_mfma_f32_16x16x32_bf16 v[80:83], a[24:27], a[84:87], v[80:83]
  v_mfma_f32_16x16x32_bf16 v[80:83], a[4:7], a[60:63], v[80:83]
  s_waitcnt lgkmcnt(15)
  v_mfma_f32_16x16x32_bf16 v[0:3], a[128:131], a[92:95], v[0:3]
  s_cmp_eq_u32 s41, 0
  s_cbranch_scc1 Lc4_c
Lc4_r:
  v_mfma_f32_16x16x32_bf16 v[0:3], a[152:155], a[112:115], v[0:3]
  s_lshl_b32 s92, s53, 7
  s_lshl_b32 s93, s40, 14
  s_add_u32 s92, s92, s93
  v_mfma_f32_16x16x32_bf16 v[4:7], a[152:155], a[116:119], v[4:7]
  s_lshl_b32 s89, s40, 10
  v_add_u32 v186, s92, v252
  s_bfe_u32 s88, s2, 0x5
  v_mfma_f32_16x16x32_bf16 v[4:7], a[128:131], a[96:99], v[4:7]
  s_lshl_b32 s88, s88, 21
  buffer_load_dwordx2 v[128:129], v105, s[4:7], s78 offen offset:0 sc1
  v_mfma_f32_16x16x32_bf16 v[8:11], a[128:131], a[100:103], v[8:11]
  s_waitcnt lgkmcnt(0)
  s_barrier
  ds_read_b64_tr_b16 a[40:41], v118 offset:0
  v_mfma_f32_16x16x32_bf16 v[8:11], a[152:155], a[120:123], v[8:11]
  ds_read_b64_tr_b16 a[42:43], v118 offset:6144
  v_mfma_f32_16x16x32_bf16 v[12:15], a[152:155], a[124:127], v[12:15]
  s_cmp_eq_u32 s41, 0
  s_cbranch_scc1 Lc5_c
Lc5_r:
  ds_read_b64_tr_b16 a[64:65], v118 offset:12288
  v_mfma_f32_16x16x32_bf16 v[12:15], a[128:131], a[104:107], v[12:15]
  buffer_load_dwordx2 v[130:131], v105, s[4:7], s78 offen offset:512 sc1
  v_mfma_f32_16x16x32_bf16 v[28:31], a[132:135], a[104:107], v[28:31]
  ds_read_b64_tr_b16 a[66:67], v118 offset:18432
  v_mfma_f32_16x16x32_bf16 v[28:31], a[156:159], a[124:127], v[28:31]
  ds_read_b128 a[4:7], v112 offset:32768
  v_mfma_f32_16x16x32_bf16 v[24:27], a[156:159], a[120:123], v[24:27]
  ds_read_b128 a[24:27], v113 offset:32768
  v_mfma_f32_16x16x32_bf16 v[24:27], a[132:135], a[100:103], v[24:27]
  buffer_load_dwordx2 v[132:133], v105, s[4:7], s78 offen offset:1024 sc1
  v_mfma_f32_16x16x32_bf16 v[20:23], a[132:135], a[96:99], v[20:23]
  s_cmp_eq_u32 s41, 0
  s_cbranch_scc1 Lc6_c
Lc6_r:
  ds_read_b128 a[8:11], v112 offset:34816
  v_mfma_f32_16x16x32_bf16 v[20:23], a[156:159], a[116:119], v[20:23]
  ds_read_b128 a[28:31], v113 offset:34816
  v_mfma_f32_16x16x32_bf16 v[16:19], a[156:159], a[112:115], v[16:19]
  ds_read_b128 a[12:15], v112 offset:36864
  v_mfma_f32_16x16x32_bf16 v[16:19], a[132:135], a[92:95], v[16:19]
  buffer_load_dwordx2 v[134:135], v105, s[4:7], s78 offen offset:1536 sc1
  v_mfma_f32_16x16x32_bf16 v[96:99], a[136:139], a[88:91], v[96:99]
  ds_read_b128 a[32:35], v113 offset:36864
  v_mfma_f32_16x16x32_bf16 v[96:99], a[160:163], a[108:111], v[96:99]
  ds_read_b128 a[16:19], v112 offset:38912
  v_mfma_f32_16x16x32_bf16 v[32:35], a[160:163], a[112:115], v[32:35]
  s_cmp_eq_u32 s41, 0
  s_cbranch_scc1 Lc7_c
Lc7_r:
  ds_read_b128 a[36:39], v113 offset:38912
  v_mfma_f32_16x16x32_bf16 v[32:35], a[136:139], a[92:95], v[32:35]
  buffer_load_dwordx2 v[136:137], v105, s[4:7], s78 offen offset:2048 sc1
  v_mfma_f32_16x16x32_bf16 v[36:39], a[136:139], a[96:99], v[36:39]
  ds_read_b64_tr_b16 a[44:45], v119 offset:0
  v_mfma_f32_16x16x32_bf16 v[36:39], a[160:163], a[116:119], v[36:39]
  ds_read_b64_tr_b16 a[46:47], v119 offset:6144
  v_mfma_f32_16x16x32_bf16 v[40:43], a[160:163], a[120:123], v[40:43]
  ds_read_b64_tr_b16 a[68:69], v119 offset:12288
  v_mfma_f32_16x16x32_bf16 v[40:43], a[136:139], a[100:103], v[40:43]
  buffer_load_dwordx2 v[138:139], v105, s[4:7], s78 offen offset:2560 sc1
  v_mfma_f32_16x16x32_bf16 v[44:47], a[136:139], a[104:107], v[44:47]
  ds_read_b64_tr_b16 a[70:71], v119 offset:18432
  v_lshrrev_b32 v240, 4, v253
  v_mfma_f32_16x16x32_bf16 v[44:47], a[160:163], a[124:127], v[44:47]
  ds_read_b128 a[0:3], v114 offset:2048
  v_lshlrev_b32 v124, 4, v240
  v_mfma_f32_16x16x32_bf16 v[60:63], a[164:167], a[124:127], v[60:63]
  ds_read_b128 a[20:23], v115 offset:2048
  v_and_b32 v125, 15, v253
  v_mfma_f32_16x16x32_bf16 v[60:63], a[140:143], a[104:107], v[60:63]
  buffer_load_dwordx2 v[140:141], v105, s[4:7], s78 offen offset:3072 sc1
  v_mfma_f32_16x16x32_bf16 v[56:59], a[140:143], a[100:103], v[56:59]
  ds_read_b64_tr_b16 a[48:49], v118 offset:2048
  v_lshlrev_b32 v125, 2, v125
  v_mfma_f32_16x16x32_bf16 v[56:59], a[164:167], a[120:123], v[56:59]
  s_lshl_b32 s43, s57, 9
  ds_read_b64_tr_b16 a[50:51], v118 offset:8192
  v_add_u32 v164, 155648, v124
  v_mfma_f32_16x16x32_bf16 v[52:55], a[164:167], a[116:119], v[52:55]
  ds_read_b64_tr_b16 a[72:73], v118 offset:14336
  v_add_u32 v166, 155648, v125
  v_mfma_f32_16x16x32_bf16 v[52:55], a[140:143], a[96:99], v[52:55]
  buffer_load_dwordx2 v[142:143], v105, s[4:7], s78 offen offset:3584 sc1
  v_mfma_f32_16x16x32_bf16 v[48:51], a[140:143], a[92:95], v[48:51]
  ds_read_b64_tr_b16 a[74:75], v118 offset:20480
  v_add_u32 v165, s43, v164
  v_mfma_f32_16x16x32_bf16 v[48:51], a[164:167], a[112:115], v[48:51]
  ds_read_b64_tr_b16 a[52:53], v119 offset:2048
  v_add_u32 v167, s43, v166
  v_mfma_f32_16x16x32_bf16 v[100:103], a[108:111], a[168:171], v[100:103]
  s_lshl_b32 s43, s40, 1
  ds_read_b64_tr_b16 a[54:55], v119 offset:8192
  v_mfma_f32_16x16x32_bf16 v[100:103], a[88:91], a[144:147], v[100:103]
  s_add_u32 s43, s43, 1
  buffer_load_dwordx2 v[144:145], v105, s[4:7], s77 offen offset:0 sc1
  v_mfma_f32_16x16x32_bf16 v[64:67], a[92:95], a[144:147], v[64:67]
  ds_read_b64_tr_b16 a[76:77], v119 offset:14336
  v_add_u32 v241, s43, v240
  v_mfma_f32_16x16x32_bf16 v[64:67], a[112:115], a[168:171], v[64:67]
  ds_read_b64_tr_b16 a[78:79], v119 offset:20480
  v_cmp_gt_u32 vcc, 2, v240
  v_mfma_f32_16x16x32_bf16 v[68:71], a[116:119], a[168:171], v[68:71]
  ds_read_b64_tr_b16 a[56:57], v118 offset:4096
  v_and_b32 v240, 1, v240
  v_mfma_f32_16x16x32_bf16 v[68:71], a[96:99], a[144:147], v[68:71]
  buffer_load_dwordx2 v[146:147], v105, s[4:7], s77 offen offset:512 sc1
  v_mfma_f32_16x16x32_bf16 v[72:75], a[100:103], a[144:147], v[72:75]
  ds_read_b64_tr_b16 a[58:59], v118 offset:10240
  v_mul_u32_u24 v240, 9, v240
  v_mfma_f32_16x16x32_bf16 v[72:75], a[120:123], a[168:171], v[72:75]
  ds_read_b64_tr_b16 a[80:81], v118 offset:16384
  v_cndmask_b32 v240, v240, v241, vcc
  v_mfma_f32_16x16x32_bf16 v[76:79], a[124:127], a[168:171], v[76:79]
  ds_read_b64_tr_b16 a[82:83], v118 offset:22528
  v_lshl_add_u32 v106, v240, 7, v166
  v_mfma_f32_16x16x32_bf16 v[76:79], a[104:107], a[144:147], v[76:79]
  buffer_load_dwordx2 v[148:149], v105, s[4:7], s77 offen offset:1024 sc1
  v_mfma_f32_16x16x32_bf16 v[92:95], a[104:107], a[148:151], v[92:95]
  ds_read_b64_tr_b16 a[60:61], v119 offset:4096
  v_add_u32 v124, s76, v124
  v_mfma_f32_16x16x32_bf16 v[92:95], a[124:127], a[172:175], v[92:95]
  ds_read_b64_tr_b16 a[62:63], v119 offset:10240
  v_add_u32 v125, s76, v125
  v_mfma_f32_16x16x32_bf16 v[88:91], a[120:123], a[172:175], v[88:91]
  ds_read_b64_tr_b16 a[84:85], v119 offset:16384
  v_add_u32 v107, 149504, v104
  v_mfma_f32_16x16x32_bf16 v[88:91], a[100:103], a[148:151], v[88:91]
  buffer_load_dwordx2 v[150:151], v105, s[4:7], s77 offen offset:1536 sc1
  v_mfma_f32_16x16x32_bf16 v[84:87], a[96:99], a[148:151], v[84:87]
  ds_read_b64_tr_b16 a[86:87], v119 offset:22528
  v_mfma_f32_16x16x32_bf16 v[84:87], a[116:119], a[172:175], v[84:87]
  v_mfma_f32_16x16x32_bf16 v[80:83], a[112:115], a[172:175], v[80:83]
  v_mfma_f32_16x16x32_bf16 v[80:83], a[92:95], a[148:151], v[80:83]
  s_waitcnt lgkmcnt(15)
  v_mfma_f32_16x16x32_bf16 v[0:3], a[40:43], a[4:7], v[0:3]
  s_lshl_b32 s44, s2, 2
  s_add_u32 s44, s44, s40
  s_lshl_b32 s44, s44, 12
  v_mfma_f32_16x16x32_bf16 v[0:3], a[64:67], a[24:27], v[0:3]
  s_add_u32 s44, s44, s42
  v_mfma_f32_16x16x32_bf16 v[4:7], a[64:67], a[28:31], v[4:7]
  s_add_u32 s44, s44, 28311552
  v_mov_b32 v246, -1
  v_mov_b32 v247, -1
  v_mfma_f32_16x16x32_bf16 v[4:7], a[40:43], a[8:11], v[4:7]
  v_mov_b32 v248, -1
  v_mov_b32 v249, -1
  v_mfma_f32_16x16x32_bf16 v[8:11], a[40:43], a[12:15], v[8:11]
  s_waitcnt vmcnt(12) lgkmcnt(0)
  s_barrier
  ds_read_b64_tr_b16 a[128:129], v116 offset:0
  v_mfma_f32_16x16x32_bf16 v[8:11], a[64:67], a[32:35], v[8:11]
  ds_read_b64_tr_b16 a[130:131], v116 offset:6144
  v_mfma_f32_16x16x32_bf16 v[12:15], a[64:67], a[36:39], v[12:15]
  s_waitcnt vmcnt(8)
  ds_read_b64_tr_b16 a[152:153], v116 offset:12288
  v_add_u32 v198, 1024, v125
  v_mfma_f32_16x16x32_bf16 v[12:15], a[40:43], a[16:19], v[12:15]
  ds_read_b64_tr_b16 a[154:155], v116 offset:18432
  v_add_f32 v128, v128, v130
  v_mfma_f32_16x16x32_bf16 v[28:31], a[44:47], a[16:19], v[28:31]
  buffer_store_dwordx4 v[246:249], v104, s[4:7], s44 offen offset:0 sc1
  v_mfma_f32_16x16x32_bf16 v[28:31], a[68:71], a[36:39], v[28:31]
  ds_read_b128 a[92:95], v112 offset:0
  v_add_f32 v129, v129, v131
  v_mfma_f32_16x16x32_bf16 v[24:27], a[68:71], a[32:35], v[24:27]
  ds_read_b128 a[112:115], v113 offset:0
  v_add_f32 v132, v132, v134
  v_mfma_f32_16x16x32_bf16 v[24:27], a[44:47], a[12:15], v[24:27]
  ds_read_b128 a[96:99], v112 offset:2048
  v_add_f32 v133, v133, v135
  v_mfma_f32_16x16x32_bf16 v[20:23], a[44:47], a[8:11], v[20:23]
  buffer_store_dwordx4 v[246:249], v104, s[4:7], s44 offen offset:1024 sc1
  v_mfma_f32_16x16x32_bf16 v[20:23], a[68:71], a[28:31], v[20:23]
  ds_read_b128 a[116:119], v113 offset:2048
  v_add_f32 v128, v128, v132
  v_mfma_f32_16x16x32_bf16 v[16:19], a[68:71], a[24:27], v[16:19]
  ds_read_b128 a[100:103], v112 offset:4096
  v_add_f32 v129, v129, v133
  v_mfma_f32_16x16x32_bf16 v[16:19], a[44:47], a[4:7], v[16:19]
  s_waitcnt vmcnt(6)
  ds_read_b128 a[120:123], v113 offset:4096
  s_cmp_eq_u32 s41, 0
  s_cbranch_scc1 Lc8_c
Lc8_r:
  v_mfma_f32_16x16x32_bf16 v[96:99], a[48:51], a[0:3], v[96:99]
  buffer_store_dwordx4 v[246:249], v104, s[4:7], s44 offen offset:2048 sc1
  v_mfma_f32_16x16x32_bf16 v[96:99], a[72:75], a[20:23], v[96:99]
  ds_read_b128 a[104:107], v112 offset:6144
  ds_read_b128 v[168:171], v124 offset:1024
  v_mfma_f32_16x16x32_bf16 v[32:35], a[72:75], a[24:27], v[32:35]
  ds_read_b128 a[124:127], v113 offset:6144
  ds_read_b128 v[172:175], v124 offset:1088
  v_mfma_f32_16x16x32_bf16 v[32:35], a[48:51], a[4:7], v[32:35]
  ds_read_b64_tr_b16 a[132:133], v117 offset:0
  ds_read_b128 v[176:179], v124 offset:1152
  v_mfma_f32_16x16x32_bf16 v[36:39], a[48:51], a[8:11], v[36:39]
  buffer_store_dwordx4 v[246:249], v104, s[4:7], s44 offen offset:3072 sc1
  v_mfma_f32_16x16x32_bf16 v[36:39], a[72:75], a[28:31], v[36:39]
  ds_read_b64_tr_b16 a[134:135], v117 offset:6144
  ds_read_b128 v[180:183], v124 offset:1216
  v_mfma_f32_16x16x32_bf16 v[40:43], a[72:75], a[32:35], v[40:43]
  ds_read_b64_tr_b16 a[156:157], v117 offset:12288
  ds_read2_b32 v[184:185], v198 offset0:64 offset1:80
  v_mfma_f32_16x16x32_bf16 v[40:43], a[48:51], a[12:15], v[40:43]
  s_add_u32 m0, s62, 90112
  ds_read_b64_tr_b16 a[158:159], v117 offset:18432
  s_xor_b32 s47, s40, 2
  v_mfma_f32_16x16x32_bf16 v[44:47], a[48:51], a[16:19], v[44:47]
  s_mul_i32 s47, s47, 6144
  buffer_load_dwordx4 v120, s[28:31], s64 offen offset:0 sc1 lds
  v_mfma_f32_16x16x32_bf16 v[44:47], a[72:75], a[36:39], v[44:47]
  s_add_u32 s47, s47, 139264
  ds_read_b128 a[88:91], v114 offset:3072
  s_add_u32 s49, s47, 3072
  v_mfma_f32_16x16x32_bf16 v[60:63], a[76:79], a[36:39], v[60:63]
  s_add_u32 s79, s47, 2048
  ds_read_b128 a[108:111], v115 offset:3072
  v_mfma_f32_16x16x32_bf16 v[60:63], a[52:55], a[16:19], v[60:63]
  s_cmp_eq_u32 s57, 0
  s_cselect_b32 s49, s76, s49
  s_cselect_b32 s79, s47, s79
  ds_read_b64_tr_b16 a[136:137], v116 offset:2048
  v_add_u32 v198, s49, v105
  v_mfma_f32_16x16x32_bf16 v[56:59], a[52:55], a[12:15], v[56:59]
  ds_read_b64_tr_b16 a[138:139], v116 offset:8192
  v_add_u32 v199, s79, v105
  v_mfma_f32_16x16x32_bf16 v[56:59], a[76:79], a[32:35], v[56:59]
  ds_read_b64_tr_b16 a[160:161], v116 offset:14336
  v_add_u32 v105, s76, v105
  v_mfma_f32_16x16x32_bf16 v[52:55], a[76:79], a[28:31], v[52:55]
  ds_read_b64_tr_b16 a[162:163], v116 offset:20480
  v_add_f32 v136, v136, v138
  v_mfma_f32_16x16x32_bf16 v[52:55], a[52:55], a[8:11], v[52:55]
  ds_read_b64_tr_b16 a[140:141], v117 offset:2048
  v_add_f32 v137, v137, v139
  v_mfma_f32_16x16x32_bf16 v[48:51], a[52:55], a[4:7], v[48:51]
  buffer_load_dwordx4 v121, s[28:31], s64 offen offset:1024 sc1 lds
  v_mfma_f32_16x16x32_bf16 v[48:51], a[76:79], a[24:27], v[48:51]
  ds_read_b64_tr_b16 a[142:143], v117 offset:8192
  v_add_f32 v140, v140, v142
  v_mfma_f32_16x16x32_bf16 v[100:103], a[20:23], a[80:83], v[100:103]
  ds_read_b64_tr_b16 a[164:165], v117 offset:14336
  v_add_f32 v141, v141, v143
  v_mfma_f32_16x16x32_bf16 v[100:103], a[0:3], a[56:59], v[100:103]
  ds_read_b64_tr_b16 a[166:167], v117 offset:20480
  v_add_f32 v136, v136, v140
  v_mfma_f32_16x16x32_bf16 v[64:67], a[4:7], a[56:59], v[64:67]
  ds_read_b64_tr_b16 a[144:145], v116 offset:4096
  v_add_f32 v137, v137, v141
  v_mfma_f32_16x16x32_bf16 v[64:67], a[24:27], a[80:83], v[64:67]
  s_waitcnt vmcnt(6)
  ds_read_b64_tr_b16 a[146:147], v116 offset:10240
  v_add_f32 v144, v144, v146
  v_mfma_f32_16x16x32_bf16 v[68:71], a[28:31], a[80:83], v[68:71]
  ds_read_b64_tr_b16 a[168:169], v116 offset:16384
  v_add_f32 v145, v145, v147
  v_mfma_f32_16x16x32_bf16 v[68:71], a[8:11], a[56:59], v[68:71]
  ds_read_b64_tr_b16 a[170:171], v116 offset:22528
  v_add_f32 v148, v148, v150
  v_mfma_f32_16x16x32_bf16 v[72:75], a[12:15], a[56:59], v[72:75]
  buffer_load_dwordx4 v122, s[28:31], s64 offen offset:2048 sc1 lds
  v_mfma_f32_16x16x32_bf16 v[72:75], a[32:35], a[80:83], v[72:75]
  ds_read_b64_tr_b16 a[148:149], v117 offset:4096
  v_add_f32 v149, v149, v151
  v_mfma_f32_16x16x32_bf16 v[76:79], a[36:39], a[80:83], v[76:79]
  ds_read_b64_tr_b16 a[150:151], v117 offset:10240
  v_add_f32 v144, v144, v148
  v_mfma_f32_16x16x32_bf16 v[76:79], a[16:19], a[56:59], v[76:79]
  ds_read_b64_tr_b16 a[172:173], v117 offset:16384
  v_add_f32 v145, v145, v149
  v_mfma_f32_16x16x32_bf16 v[92:95], a[16:19], a[60:63], v[92:95]
  s_mov_b32 s48, 0x3a800000
  ds_read_b64_tr_b16 a[174:175], v117 offset:22528
  v_mov_b32 v240, 0x3727c5ac
  v_mfma_f32_16x16x32_bf16 v[92:95], a[36:39], a[84:87], v[92:95]
  v_permlane32_swap_b32 v136, v130
  v_permlane32_swap_b32 v137, v131
  v_mfma_f32_16x16x32_bf16 v[88:91], a[32:35], a[84:87], v[88:91]
  v_permlane32_swap_b32 v128, v144
  v_permlane32_swap_b32 v129, v145
  v_mfma_f32_16x16x32_bf16 v[88:91], a[12:15], a[60:63], v[88:91]
  v_add_f32 v136, v136, v130
  v_add_f32 v128, v128, v144
  v_mfma_f32_16x16x32_bf16 v[84:87], a[8:11], a[60:63], v[84:87]
  buffer_load_dwordx4 v123, s[28:31], s64 offen offset:3072 sc1 lds
  v_mfma_f32_16x16x32_bf16 v[84:87], a[28:31], a[84:87], v[84:87]
  v_add_f32 v137, v137, v131
  v_add_f32 v129, v129, v145
  v_mfma_f32_16x16x32_bf16 v[80:83], a[24:27], a[84:87], v[80:83]
  v_permlane16_swap_b32 v128, v136
  v_mfma_f32_16x16x32_bf16 v[80:83], a[4:7], a[60:63], v[80:83]
  s_nop 0
  v_permlane16_swap_b32 v129, v137
  v_add_f32 v128, v128, v136
  s_waitcnt lgkmcnt(15)
  v_mfma_f32_16x16x32_bf16 v[0:3], a[128:131], a[92:95], v[0:3]
  v_add_f32 v129, v129, v137
  v_mul_f32 v128, 0xba800000, v128
  v_mfma_f32_16x16x32_bf16 v[0:3], a[152:155], a[112:115], v[0:3]
  s_add_u32 m0, s89, 40960
  v_fma_f32 v129, v129, s48, v240
  v_fma_f32 v129, -v128, v128, v129
  v_mfma_f32_16x16x32_bf16 v[4:7], a[152:155], a[116:119], v[4:7]
  s_xor_b32 s92, s88, 655360
  v_max_f32 v129, v129, v240
  v_rsq_f32 v129, v129
  v_mfma_f32_16x16x32_bf16 v[4:7], a[128:131], a[96:99], v[4:7]
  s_nop 0
  buffer_load_dwordx4 v186, s[12:15], s92 offen lds
  v_mfma_f32_16x16x32_bf16 v[8:11], a[128:131], a[100:103], v[8:11]
  ds_write2_b32 v106, v128, v129 offset0:0 offset1:16
  v_mfma_f32_16x16x32_bf16 v[8:11], a[152:155], a[120:123], v[8:11]
  v_mfma_f32_16x16x32_bf16 v[12:15], a[152:155], a[124:127], v[12:15]
  s_add_u32 m0, s89, 45056
  v_mfma_f32_16x16x32_bf16 v[12:15], a[128:131], a[104:107], v[12:15]
  s_xor_b32 s92, s88, 720896
  v_mfma_f32_16x16x32_bf16 v[28:31], a[132:135], a[104:107], v[28:31]
  buffer_load_dwordx4 v186, s[12:15], s92 offen lds
  v_mfma_f32_16x16x32_bf16 v[28:31], a[156:159], a[124:127], v[28:31]
  v_mfma_f32_16x16x32_bf16 v[24:27], a[156:159], a[120:123], v[24:27]
  s_waitcnt lgkmcnt(0)
  s_barrier
  ds_read2_b32 v[190:191], v167 offset0:32 offset1:48
  ds_read2_b32 v[192:193], v167 offset0:64 offset1:80
  v_mfma_f32_16x16x32_bf16 v[24:27], a[132:135], a[100:103], v[24:27]
  s_add_u32 m0, s89, 49152
  ds_read2_b32 v[194:195], v167 offset0:96 offset1:112
  ds_read2_b32 v[196:197], v167 offset0:128 offset1:144
  v_mfma_f32_16x16x32_bf16 v[20:23], a[132:135], a[96:99], v[20:23]
  s_xor_b32 s92, s88, 786432
  ds_read2_b32 v[188:189], v166 offset0:0 offset1:16
  ds_read_b128 v[128:131], v107
  v_mfma_f32_16x16x32_bf16 v[20:23], a[156:159], a[116:119], v[20:23]
  buffer_load_dwordx4 v186, s[12:15], s92 offen lds
  v_mfma_f32_16x16x32_bf16 v[16:19], a[156:159], a[112:115], v[16:19]
  ds_read_b128 v[132:135], v107 offset:1024
  ds_read_b128 v[200:203], v164 offset:0
  v_mfma_f32_16x16x32_bf16 v[16:19], a[132:135], a[92:95], v[16:19]
  ds_read_b128 v[220:223], v164 offset:64
  ds_read_b128 v[216:219], v165 offset:512
  v_mfma_f32_16x16x32_bf16 v[96:99], a[136:139], a[88:91], v[96:99]
  s_add_u32 m0, s89, 53248
  ds_read_b128 v[236:239], v165 offset:576
  ds_read_b128 v[204:207], v165 offset:128
  v_mfma_f32_16x16x32_bf16 v[96:99], a[160:163], a[108:111], v[96:99]
  s_xor_b32 s92, s88, 851968
  ds_read_b128 v[224:227], v165 offset:192
  ds_read_b128 v[208:211], v165 offset:256
  v_mfma_f32_16x16x32_bf16 v[32:35], a[160:163], a[112:115], v[32:35]
  buffer_load_dwordx4 v186, s[12:15], s92 offen lds
  v_mfma_f32_16x16x32_bf16 v[32:35], a[136:139], a[92:95], v[32:35]
  ds_read_b128 v[228:231], v165 offset:320
  ds_read_b128 v[212:215], v165 offset:384
  v_mfma_f32_16x16x32_bf16 v[36:39], a[136:139], a[96:99], v[36:39]
  ds_read_b128 v[232:235], v165 offset:448
  s_and_b32 s43, s50, 7
  v_mfma_f32_16x16x32_bf16 v[36:39], a[160:163], a[116:119], v[36:39]
  s_add_u32 m0, s89, 57344
  s_or_b32 s43, s43, s57
  s_cselect_b64 s[46:47], -1, 0
  v_mfma_f32_16x16x32_bf16 v[40:43], a[160:163], a[120:123], v[40:43]
  s_xor_b32 s92, s88, 917504
  v_mov_b32 v245, 0xf149f2ca
  v_mfma_f32_16x16x32_bf16 v[40:43], a[136:139], a[100:103], v[40:43]
  s_waitcnt lgkmcnt(10)
  buffer_load_dwordx4 v186, s[12:15], s92 offen lds
  v_mfma_f32_16x16x32_bf16 v[44:47], a[136:139], a[104:107], v[44:47]
  v_fmac_f32 v12, v168, v196
  v_fmac_f32 v13, v169, v196
  v_mfma_f32_16x16x32_bf16 v[44:47], a[160:163], a[124:127], v[44:47]
  v_fmac_f32 v14, v170, v196
  v_fmac_f32 v15, v171, v196
  v_mfma_f32_16x16x32_bf16 v[60:63], a[164:167], a[124:127], v[60:63]
  s_add_u32 m0, s89, 61440
  v_fmac_f32 v28, v172, v196
  v_fmac_f32 v29, v173, v196
  v_mfma_f32_16x16x32_bf16 v[60:63], a[140:143], a[104:107], v[60:63]
  s_xor_b32 s92, s88, 983040
  v_fmac_f32 v30, v174, v196
  v_fmac_f32 v31, v175, v196
  v_mfma_f32_16x16x32_bf16 v[56:59], a[140:143], a[100:103], v[56:59]
  buffer_load_dwordx4 v186, s[12:15], s92 offen lds
  v_mfma_f32_16x16x32_bf16 v[56:59], a[164:167], a[120:123], v[56:59]
  v_cvt_pk_bf16_f32 v12, v12, v13
  v_cvt_pk_bf16_f32 v13, v14, v15
  v_mfma_f32_16x16x32_bf16 v[52:55], a[164:167], a[116:119], v[52:55]
  v_cvt_pk_bf16_f32 v14, v28, v29
  v_cvt_pk_bf16_f32 v15, v30, v31
  v_mfma_f32_16x16x32_bf16 v[52:55], a[140:143], a[96:99], v[52:55]
  s_add_u32 m0, s89, 65536
  v_fmac_f32 v8, v168, v194
  v_fmac_f32 v9, v169, v194
  v_mfma_f32_16x16x32_bf16 v[48:51], a[140:143], a[92:95], v[48:51]
  s_xor_b32 s92, s88, 1048576
  v_fmac_f32 v10, v170, v194
  v_fmac_f32 v11, v171, v194
  v_mfma_f32_16x16x32_bf16 v[48:51], a[164:167], a[112:115], v[48:51]
  buffer_load_dwordx4 v186, s[12:15], s92 offen lds
  v_mfma_f32_16x16x32_bf16 v[100:103], a[108:111], a[168:171], v[100:103]
  v_fmac_f32 v24, v172, v194
  v_fmac_f32 v25, v173, v194
  v_mfma_f32_16x16x32_bf16 v[100:103], a[88:91], a[144:147], v[100:103]
  v_fmac_f32 v26, v174, v194
  v_fmac_f32 v27, v175, v194
  v_mfma_f32_16x16x32_bf16 v[64:67], a[92:95], a[144:147], v[64:67]
  s_add_u32 m0, s89, 69632
  v_cvt_pk_bf16_f32 v8, v8, v9
  v_cvt_pk_bf16_f32 v9, v10, v11
  v_mfma_f32_16x16x32_bf16 v[64:67], a[112:115], a[168:171], v[64:67]
  s_xor_b32 s92, s88, 1114112
  v_cvt_pk_bf16_f32 v10, v24, v25
  v_cvt_pk_bf16_f32 v11, v26, v27
  v_mfma_f32_16x16x32_bf16 v[68:71], a[116:119], a[168:171], v[68:71]
  buffer_load_dwordx4 v186, s[12:15], s92 offen lds
  v_mfma_f32_16x16x32_bf16 v[68:71], a[96:99], a[144:147], v[68:71]
  v_fmac_f32 v4, v168, v192
  v_fmac_f32 v5, v169, v192
  v_mfma_f32_16x16x32_bf16 v[72:75], a[100:103], a[144:147], v[72:75]
  v_fmac_f32 v6, v170, v192
  v_fmac_f32 v7, v171, v192
  v_mfma_f32_16x16x32_bf16 v[72:75], a[120:123], a[168:171], v[72:75]
  s_add_u32 m0, s89, 0
  v_fmac_f32 v20, v172, v192
  v_fmac_f32 v21, v173, v192
  v_mfma_f32_16x16x32_bf16 v[76:79], a[124:127], a[168:171], v[76:79]
  s_xor_b32 s92, s88, 0
  v_fmac_f32 v22, v174, v192
  v_fmac_f32 v23, v175, v192
  v_mfma_f32_16x16x32_bf16 v[76:79], a[104:107], a[144:147], v[76:79]
  buffer_load_dwordx4 v186, s[12:15], s92 offen lds
  v_mfma_f32_16x16x32_bf16 v[92:95], a[104:107], a[148:151], v[92:95]
  v_cvt_pk_bf16_f32 v4, v4, v5
  v_cvt_pk_bf16_f32 v5, v6, v7
  v_mfma_f32_16x16x32_bf16 v[92:95], a[124:127], a[172:175], v[92:95]
  v_cvt_pk_bf16_f32 v6, v20, v21
  v_cvt_pk_bf16_f32 v7, v22, v23
  v_mfma_f32_16x16x32_bf16 v[88:91], a[120:123], a[172:175], v[88:91]
  s_add_u32 m0, s89, 4096
  v_fmac_f32 v0, v168, v190
  v_fmac_f32 v1, v169, v190
  v_mfma_f32_16x16x32_bf16 v[88:91], a[100:103], a[148:151], v[88:91]
  s_xor_b32 s92, s88, 65536
  v_fmac_f32 v2, v170, v190
  v_fmac_f32 v3, v171, v190
  v_mfma_f32_16x16x32_bf16 v[84:87], a[96:99], a[148:151], v[84:87]
  buffer_load_dwordx4 v186, s[12:15], s92 offen lds
  v_mfma_f32_16x16x32_bf16 v[84:87], a[116:119], a[172:175], v[84:87]
  v_fmac_f32 v16, v172, v190
  v_fmac_f32 v17, v173, v190
  v_mfma_f32_16x16x32_bf16 v[80:83], a[112:115], a[172:175], v[80:83]
  v_fmac_f32 v18, v174, v190
  v_fmac_f32 v19, v175, v190
  v_mfma_f32_16x16x32_bf16 v[80:83], a[92:95], a[148:151], v[80:83]
  v_cvt_pk_bf16_f32 v0, v0, v1
  v_cvt_pk_bf16_f32 v1, v2, v3
Lmk_p1epi:
  v_cvt_pk_bf16_f32 v2, v16, v17
  v_cvt_pk_bf16_f32 v3, v18, v19
  v_cndmask_b32 v136, v245, v132, s[46:47]
  v_mov_b32 v160, 0x3f803f80
  v_mul_f32 v108, 0x3e8293ee, v191
  v_cndmask_b32 v137, v245, v133, s[46:47]
  v_mov_b32 v161, 0x3f803f80
  v_mul_f32 v109, 0x3e8293ee, v193
  v_cndmask_b32 v138, v245, v134, s[46:47]
  v_mov_b32 v162, 0x3f803f80
  v_mul_f32 v110, 0x3e8293ee, v195
  v_cndmask_b32 v139, v245, v135, s[46:47]
  v_mov_b32 v163, 0x3f803f80
  v_mul_f32 v111, 0x3e8293ee, v197
  s_waitcnt lgkmcnt(0)
  v_pk_fma_f32 v[96:97], v[176:177], v[188:189], v[96:97] op_sel:[0,0,0] op_sel_hi:[1,0,1]
  v_pk_fma_f32 v[98:99], v[178:179], v[188:189], v[98:99] op_sel:[0,0,0] op_sel_hi:[1,0,1]
  v_pk_mul_f32 v[96:97], v[96:97], v[188:189] op_sel:[0,1] op_sel_hi:[1,1]
  v_pk_mul_f32 v[98:99], v[98:99], v[188:189] op_sel:[0,1] op_sel_hi:[1,1]
  v_cvt_pk_bf16_f32 v96, v96, v97
  v_cvt_pk_bf16_f32 v97, v98, v99
  v_pk_fma_f32 v[44:45], v[176:177], v[196:197], v[44:45] op_sel:[0,0,0] op_sel_hi:[1,0,1]
  v_pk_fma_f32 v[46:47], v[178:179], v[196:197], v[46:47] op_sel:[0,0,0] op_sel_hi:[1,0,1]
  v_pk_fma_f32 v[60:61], v[180:181], v[196:197], v[60:61] op_sel:[0,0,0] op_sel_hi:[1,0,1]
  v_pk_fma_f32 v[62:63], v[182:183], v[196:197], v[62:63] op_sel:[0,0,0] op_sel_hi:[1,0,1]
  v_pk_mul_f32 v[44:45], v[44:45], v[196:197] op_sel:[0,1] op_sel_hi:[1,1]
  v_pk_mul_f32 v[46:47], v[46:47], v[196:197] op_sel:[0,1] op_sel_hi:[1,1]
  v_pk_mul_f32 v[60:61], v[60:61], v[196:197] op_sel:[0,1] op_sel_hi:[1,1]
  v_pk_mul_f32 v[62:63], v[62:63], v[196:197] op_sel:[0,1] op_sel_hi:[1,1]
  v_cvt_pk_bf16_f32 v44, v44, v45
  v_cvt_pk_bf16_f32 v45, v46, v47
  v_cvt_pk_bf16_f32 v46, v60, v61
  v_cvt_pk_bf16_f32 v47, v62, v63
  v_pk_fma_f32 v[100:101], v[200:201], v[184:185], v[100:101] op_sel:[0,0,0] op_sel_hi:[1,0,1]
  v_pk_fma_f32 v[102:103], v[202:203], v[184:185], v[102:103] op_sel:[0,0,0] op_sel_hi:[1,0,1]
  v_pk_mul_f32 v[100:101], v[100:101], v[220:221]
  v_pk_mul_f32 v[102:103], v[102:103], v[222:223]
  v_cvt_pk_bf16_f32 v100, v100, v101
  v_cvt_pk_bf16_f32 v101, v102, v103
  v_pk_fma_f32 v[76:77], v[216:217], v[184:185], v[76:77] op_sel:[0,0,0] op_sel_hi:[1,0,1]
  v_pk_fma_f32 v[78:79], v[218:219], v[184:185], v[78:79] op_sel:[0,0,0] op_sel_hi:[1,0,1]
  v_pk_fma_f32 v[92:93], v[216:217], v[184:185], v[92:93] op_sel:[0,1,0] op_sel_hi:[1,1,1]
  v_pk_fma_f32 v[94:95], v[218:219], v[184:185], v[94:95] op_sel:[0,1,0] op_sel_hi:[1,1,1]
  v_pk_mul_f32 v[76:77], v[76:77], v[236:237]
  v_pk_mul_f32 v[78:79], v[78:79], v[238:239]
  v_pk_mul_f32 v[92:93], v[92:93], v[236:237]
  v_pk_mul_f32 v[94:95], v[94:95], v[238:239]
  v_cvt_pk_bf16_f32 v148, v76, v77
  v_cvt_pk_bf16_f32 v149, v78, v79
  v_cvt_pk_bf16_f32 v158, v92, v93
  v_cvt_pk_bf16_f32 v159, v94, v95
  ds_write2st64_b64 v105, v[96:97], v[100:101] offset0:0 offset1:1
  ds_write2st64_b64 v105, v[44:45], v[148:149] offset0:4 offset1:5
  ds_write2st64_b64 v105, v[46:47], v[158:159] offset0:6 offset1:7
  s_add_u32 m0, s89, 8192
  s_xor_b32 s92, s88, 131072
  buffer_load_dwordx4 v186, s[12:15], s92 offen lds
  v_pk_fma_f32 v[40:41], v[176:177], v[194:195], v[40:41] op_sel:[0,0,0] op_sel_hi:[1,0,1]
  v_pk_fma_f32 v[42:43], v[178:179], v[194:195], v[42:43] op_sel:[0,0,0] op_sel_hi:[1,0,1]
  v_pk_fma_f32 v[56:57], v[180:181], v[194:195], v[56:57] op_sel:[0,0,0] op_sel_hi:[1,0,1]
  v_pk_fma_f32 v[58:59], v[182:183], v[194:195], v[58:59] op_sel:[0,0,0] op_sel_hi:[1,0,1]
  v_pk_mul_f32 v[40:41], v[40:41], v[194:195] op_sel:[0,1] op_sel_hi:[1,1]
  v_pk_mul_f32 v[42:43], v[42:43], v[194:195] op_sel:[0,1] op_sel_hi:[1,1]
  v_pk_mul_f32 v[56:57], v[56:57], v[194:195] op_sel:[0,1] op_sel_hi:[1,1]
  v_pk_mul_f32 v[58:59], v[58:59], v[194:195] op_sel:[0,1] op_sel_hi:[1,1]
  v_cvt_pk_bf16_f32 v40, v40, v41
  v_cvt_pk_bf16_f32 v41, v42, v43
  v_cvt_pk_bf16_f32 v42, v56, v57
  v_cvt_pk_bf16_f32 v43, v58, v59
  s_add_u32 m0, s89, 12288
  s_xor_b32 s92, s88, 196608
  buffer_load_dwordx4 v186, s[12:15], s92 offen lds
  v_pk_fma_f32 v[36:37], v[176:177], v[192:193], v[36:37] op_sel:[0,0,0] op_sel_hi:[1,0,1]
  v_pk_fma_f32 v[38:39], v[178:179], v[192:193], v[38:39] op_sel:[0,0,0] op_sel_hi:[1,0,1]
  v_pk_fma_f32 v[52:53], v[180:181], v[192:193], v[52:53] op_sel:[0,0,0] op_sel_hi:[1,0,1]
  v_pk_fma_f32 v[54:55], v[182:183], v[192:193], v[54:55] op_sel:[0,0,0] op_sel_hi:[1,0,1]
  v_pk_mul_f32 v[36:37], v[36:37], v[192:193] op_sel:[0,1] op_sel_hi:[1,1]
  v_pk_mul_f32 v[38:39], v[38:39], v[192:193] op_sel:[0,1] op_sel_hi:[1,1]
  v_pk_mul_f32 v[52:53], v[52:53], v[192:193] op_sel:[0,1] op_sel_hi:[1,1]
  v_pk_mul_f32 v[54:55], v[54:55], v[192:193] op_sel:[0,1] op_sel_hi:[1,1]
  v_cvt_pk_bf16_f32 v36, v36, v37
  v_cvt_pk_bf16_f32 v37, v38, v39
  v_cvt_pk_bf16_f32 v38, v52, v53
  v_cvt_pk_bf16_f32 v39, v54, v55
  s_add_u32 m0, s89, 16384
  s_xor_b32 s92, s88, 262144
  buffer_load_dwordx4 v186, s[12:15], s92 offen lds
  v_pk_fma_f32 v[32:33], v[176:177], v[190:191], v[32:33] op_sel:[0,0,0] op_sel_hi:[1,0,1]
  v_pk_fma_f32 v[34:35], v[178:179], v[190:191], v[34:35] op_sel:[0,0,0] op_sel_hi:[1,0,1]
  v_pk_fma_f32 v[48:49], v[180:181], v[190:191], v[48:49] op_sel:[0,0,0] op_sel_hi:[1,0,1]
  v_pk_fma_f32 v[50:51], v[182:183], v[190:191], v[50:51] op_sel:[0,0,0] op_sel_hi:[1,0,1]
  v_pk_mul_f32 v[32:33], v[32:33], v[190:191] op_sel:[0,1] op_sel_hi:[1,1]
  v_pk_mul_f32 v[34:35], v[34:35], v[190:191] op_sel:[0,1] op_sel_hi:[1,1]
  v_pk_mul_f32 v[48:49], v[48:49], v[190:191] op_sel:[0,1] op_sel_hi:[1,1]
  v_pk_mul_f32 v[50:51], v[50:51], v[190:191] op_sel:[0,1] op_sel_hi:[1,1]
  v_cvt_pk_bf16_f32 v32, v32, v33
  v_cvt_pk_bf16_f32 v33, v34, v35
  v_cvt_pk_bf16_f32 v34, v48, v49
  v_cvt_pk_bf16_f32 v35, v50, v51
  s_waitcnt lgkmcnt(0)
  s_barrier
  ds_read_b64 v[120:121], v198
  ds_read_b64 v[122:123], v199
  ds_read_b64 v[140:141], v198 offset:512
  ds_read_b64 v[150:151], v199 offset:512
  v_mfma_f32_16x16x32_bf16 v[60:63], v[44:47], v[12:15], v[128:131]
  v_mfma_f32_16x16x32_bf16 v[28:31], v[40:43], v[12:15], v[132:135]
  v_mfma_f32_16x16x32_bf16 v[56:59], v[40:43], v[8:11], v[128:131]
  v_mfma_f32_16x16x32_bf16 v[24:27], v[36:39], v[8:11], v[132:135]
  v_mfma_f32_16x16x32_bf16 v[52:55], v[36:39], v[4:7], v[128:131]
  v_mfma_f32_16x16x32_bf16 v[20:23], v[32:35], v[4:7], v[132:135]
  v_mfma_f32_16x16x32_bf16 v[48:51], v[32:35], v[0:3], v[128:131]
  s_waitcnt lgkmcnt(0)
  v_mfma_f32_16x16x32_bf16 v[16:19], v[120:123], v[0:3], v[136:139]
  s_add_u32 m0, s89, 20480
  s_xor_b32 s92, s88, 327680
  buffer_load_dwordx4 v186, s[12:15], s92 offen lds
  v_pk_fma_f32 v[64:65], v[204:205], v[184:185], v[64:65] op_sel:[0,0,0] op_sel_hi:[1,0,1]
  v_pk_fma_f32 v[66:67], v[206:207], v[184:185], v[66:67] op_sel:[0,0,0] op_sel_hi:[1,0,1]
  v_pk_fma_f32 v[80:81], v[204:205], v[184:185], v[80:81] op_sel:[0,1,0] op_sel_hi:[1,1,1]
  v_pk_fma_f32 v[82:83], v[206:207], v[184:185], v[82:83] op_sel:[0,1,0] op_sel_hi:[1,1,1]
  v_pk_mul_f32 v[64:65], v[64:65], v[224:225]
  v_pk_mul_f32 v[66:67], v[66:67], v[226:227]
  v_pk_mul_f32 v[80:81], v[80:81], v[224:225]
  v_pk_mul_f32 v[82:83], v[82:83], v[226:227]
  v_cvt_pk_bf16_f32 v142, v64, v65
  v_cvt_pk_bf16_f32 v143, v66, v67
  v_cvt_pk_bf16_f32 v152, v80, v81
  v_cvt_pk_bf16_f32 v153, v82, v83
  v_pk_fma_f32 v[68:69], v[208:209], v[184:185], v[68:69] op_sel:[0,0,0] op_sel_hi:[1,0,1]
  v_pk_fma_f32 v[70:71], v[210:211], v[184:185], v[70:71] op_sel:[0,0,0] op_sel_hi:[1,0,1]
  v_pk_fma_f32 v[84:85], v[208:209], v[184:185], v[84:85] op_sel:[0,1,0] op_sel_hi:[1,1,1]
  v_pk_fma_f32 v[86:87], v[210:211], v[184:185], v[86:87] op_sel:[0,1,0] op_sel_hi:[1,1,1]
  v_pk_mul_f32 v[68:69], v[68:69], v[228:229]
  v_pk_mul_f32 v[70:71], v[70:71], v[230:231]
  v_pk_mul_f32 v[84:85], v[84:85], v[228:229]
  v_pk_mul_f32 v[86:87], v[86:87], v[230:231]
  v_cvt_pk_bf16_f32 v144, v68, v69
  v_cvt_pk_bf16_f32 v145, v70, v71
  v_cvt_pk_bf16_f32 v154, v84, v85
  v_cvt_pk_bf16_f32 v155, v86, v87
  v_pk_fma_f32 v[72:73], v[212:213], v[184:185], v[72:73] op_sel:[0,0,0] op_sel_hi:[1,0,1]
  v_pk_fma_f32 v[74:75], v[214:215], v[184:185], v[74:75] op_sel:[0,0,0] op_sel_hi:[1,0,1]
  v_pk_fma_f32 v[88:89], v[212:213], v[184:185], v[88:89] op_sel:[0,1,0] op_sel_hi:[1,1,1]
  v_pk_fma_f32 v[90:91], v[214:215], v[184:185], v[90:91] op_sel:[0,1,0] op_sel_hi:[1,1,1]
  v_pk_mul_f32 v[72:73], v[72:73], v[232:233]
  v_pk_mul_f32 v[74:75], v[74:75], v[234:235]
  v_pk_mul_f32 v[88:89], v[88:89], v[232:233]
  v_pk_mul_f32 v[90:91], v[90:91], v[234:235]
  v_cvt_pk_bf16_f32 v146, v72, v73
  v_cvt_pk_bf16_f32 v147, v74, v75
  v_cvt_pk_bf16_f32 v156, v88, v89
  v_cvt_pk_bf16_f32 v157, v90, v91
  s_cmp_eq_u32 s57, 0
  s_cbranch_scc1 Lp1_nsw
  v_swap_b32 v140, v150
  v_swap_b32 v141, v151
  v_swap_b32 v142, v152
  v_swap_b32 v143, v153
  v_swap_b32 v144, v154
  v_swap_b32 v145, v155
  v_swap_b32 v146, v156
  v_swap_b32 v147, v157
  v_swap_b32 v148, v158
  v_swap_b32 v149, v159
Lp1_nsw:
  v_max3_f32 v240, v16, v17, v18
  v_max3_f32 v241, v20, v21, v22
  v_max3_f32 v242, v24, v25, v26
  v_max3_f32 v243, v28, v29, v30
  v_max3_f32 v240, v240, v19, v48
  v_max3_f32 v241, v241, v23, v52
  v_max3_f32 v242, v242, v27, v56
  v_max3_f32 v243, v243, v31, v60
  v_max3_f32 v240, v240, v49, v50
  v_max3_f32 v241, v241, v53, v54
  v_max3_f32 v242, v242, v57, v58
  v_max3_f32 v243, v243, v61, v62
  v_max_f32 v240, v240, v51
  v_max_f32 v241, v241, v55
  v_max_f32 v242, v242, v59
  v_max_f32 v243, v243, v63
  v_mov_b32 v244, v240
  v_mov_b32 v245, v241
  v_mov_b32 v246, v242
  v_mov_b32 v247, v243
  v_permlane32_swap_b32 v240, v244
  v_permlane32_swap_b32 v241, v245
  v_permlane32_swap_b32 v242, v246
  v_permlane32_swap_b32 v243, v247
  v_max_f32 v240, v240, v244
  v_max_f32 v241, v241, v245
  v_max_f32 v242, v242, v246
  v_max_f32 v243, v243, v247
  v_mov_b32 v244, v240
  v_mov_b32 v245, v241
  v_mov_b32 v246, v242
  v_mov_b32 v247, v243
  v_permlane16_swap_b32 v240, v244
  v_permlane16_swap_b32 v241, v245
  v_permlane16_swap_b32 v242, v246
  v_permlane16_swap_b32 v243, v247
  v_max_f32 v240, v240, v244
  v_max_f32 v241, v241, v245
  v_max_f32 v242, v242, v246
  v_max_f32 v243, v243, v247
  v_pk_mul_f32 v[240:241], v[240:241], v[108:109] neg_lo:[0,1] neg_hi:[0,1]
  v_pk_mul_f32 v[242:243], v[242:243], v[110:111] neg_lo:[0,1] neg_hi:[0,1]
  v_pk_fma_f32 v[16:17], v[16:17], v[108:109], v[240:241] op_sel:[0,0,0] op_sel_hi:[1,0,0]
  v_pk_fma_f32 v[18:19], v[18:19], v[108:109], v[240:241] op_sel:[0,0,0] op_sel_hi:[1,0,0]
  v_pk_fma_f32 v[48:49], v[48:49], v[108:109], v[240:241] op_sel:[0,0,0] op_sel_hi:[1,0,0]
  v_pk_fma_f32 v[50:51], v[50:51], v[108:109], v[240:241] op_sel:[0,0,0] op_sel_hi:[1,0,0]
  v_exp_f32 v16, v16
  v_exp_f32 v17, v17
  v_exp_f32 v18, v18
  v_exp_f32 v19, v19
  v_exp_f32 v48, v48
  v_exp_f32 v49, v49
  v_exp_f32 v50, v50
  v_exp_f32 v51, v51
  v_cvt_pk_bf16_f32 v0, v16, v17
  v_cvt_pk_bf16_f32 v1, v18, v19
  v_cvt_pk_bf16_f32 v2, v48, v49
  v_cvt_pk_bf16_f32 v3, v50, v51
  v_pk_fma_f32 v[20:21], v[20:21], v[108:109], v[240:241] op_sel:[0,1,1] op_sel_hi:[1,1,1]
  v_pk_fma_f32 v[22:23], v[22:23], v[108:109], v[240:241] op_sel:[0,1,1] op_sel_hi:[1,1,1]
  v_pk_fma_f32 v[52:53], v[52:53], v[108:109], v[240:241] op_sel:[0,1,1] op_sel_hi:[1,1,1]
  v_pk_fma_f32 v[54:55], v[54:55], v[108:109], v[240:241] op_sel:[0,1,1] op_sel_hi:[1,1,1]
  v_exp_f32 v20, v20
  v_exp_f32 v21, v21
  v_exp_f32 v22, v22
  v_exp_f32 v23, v23
  v_exp_f32 v52, v52
  v_exp_f32 v53, v53
  v_exp_f32 v54, v54
  v_exp_f32 v55, v55
  v_cvt_pk_bf16_f32 v4, v20, v21
  v_cvt_pk_bf16_f32 v5, v22, v23
  v_cvt_pk_bf16_f32 v6, v52, v53
  v_cvt_pk_bf16_f32 v7, v54, v55
  v_pk_fma_f32 v[24:25], v[24:25], v[110:111], v[242:243] op_sel:[0,0,0] op_sel_hi:[1,0,0]
  v_pk_fma_f32 v[26:27], v[26:27], v[110:111], v[242:243] op_sel:[0,0,0] op_sel_hi:[1,0,0]
  v_pk_fma_f32 v[56:57], v[56:57], v[110:111], v[242:243] op_sel:[0,0,0] op_sel_hi:[1,0,0]
  v_pk_fma_f32 v[58:59], v[58:59], v[110:111], v[242:243] op_sel:[0,0,0] op_sel_hi:[1,0,0]
  v_exp_f32 v24, v24
  v_exp_f32 v25, v25
  v_exp_f32 v26, v26
  v_exp_f32 v27, v27
  v_exp_f32 v56, v56
  v_exp_f32 v57, v57
  v_exp_f32 v58, v58
  v_exp_f32 v59, v59
  v_cvt_pk_bf16_f32 v8, v24, v25
  v_cvt_pk_bf16_f32 v9, v26, v27
  v_cvt_pk_bf16_f32 v10, v56, v57
  v_cvt_pk_bf16_f32 v11, v58, v59
  v_pk_fma_f32 v[28:29], v[28:29], v[110:111], v[242:243] op_sel:[0,1,1] op_sel_hi:[1,1,1]
  v_pk_fma_f32 v[30:31], v[30:31], v[110:111], v[242:243] op_sel:[0,1,1] op_sel_hi:[1,1,1]
  v_pk_fma_f32 v[60:61], v[60:61], v[110:111], v[242:243] op_sel:[0,1,1] op_sel_hi:[1,1,1]
  v_pk_fma_f32 v[62:63], v[62:63], v[110:111], v[242:243] op_sel:[0,1,1] op_sel_hi:[1,1,1]
  v_exp_f32 v28, v28
  v_exp_f32 v29, v29
  v_exp_f32 v30, v30
  v_exp_f32 v31, v31
  v_exp_f32 v60, v60
  v_exp_f32 v61, v61
  v_exp_f32 v62, v62
  v_exp_f32 v63, v63
  v_cvt_pk_bf16_f32 v12, v28, v29
  v_cvt_pk_bf16_f32 v13, v30, v31
  v_cvt_pk_bf16_f32 v14, v60, v61
  v_cvt_pk_bf16_f32 v15, v62, v63
  v_mfma_f32_16x16x32_bf16 v[32:35], v[160:163], v[0:3], 0
  s_lshl_b32 s43, s74, 15
  s_lshl_b32 s44, s75, 10
  v_mfma_f32_16x16x32_bf16 v[36:39], v[160:163], v[4:7], 0
  s_add_u32 s43, s43, s44
  s_add_u32 s43, s43, s42
  v_mfma_f32_16x16x32_bf16 v[40:43], v[160:163], v[8:11], 0
  s_add_u32 s46, s43, 8388608
  s_add_u32 s47, s46, 32768
  v_mfma_f32_16x16x32_bf16 v[44:47], v[160:163], v[12:15], 0
  s_add_u32 s48, s47, 32768
  s_add_u32 s49, s48, 32768
  v_mfma_f32_16x16x32_bf16 v[64:67], v[140:143], v[0:3], 0
  s_lshl_b32 s77, s50, 1
  v_mfma_f32_16x16x32_bf16 v[80:83], v[150:153], v[0:3], 0
  s_lshr_b32 s43, s51, 3
  v_mfma_f32_16x16x32_bf16 v[68:71], v[142:145], v[4:7], 0
  s_add_u32 s77, s77, s43
  v_mfma_f32_16x16x32_bf16 v[84:87], v[152:155], v[4:7], 0
  s_lshl_b32 s77, s77, 7
  v_mfma_f32_16x16x32_bf16 v[72:75], v[144:147], v[8:11], 0
  s_add_u32 s77, s77, s42
  v_rcp_f32 v32, v32
  v_mfma_f32_16x16x32_bf16 v[88:91], v[154:157], v[8:11], 0
  s_add_u32 s77, s77, 27787264
  v_rcp_f32 v36, v36
  v_mfma_f32_16x16x32_bf16 v[76:79], v[146:149], v[12:15], 0
  v_rcp_f32 v40, v40
  v_mfma_f32_16x16x32_bf16 v[92:95], v[156:159], v[12:15], 0
  v_rcp_f32 v44, v44
  v_pk_mul_f32 v[64:65], v[64:65], v[32:33] op_sel:[0,0] op_sel_hi:[1,0]
  v_pk_mul_f32 v[66:67], v[66:67], v[32:33] op_sel:[0,0] op_sel_hi:[1,0]
  v_pk_mul_f32 v[80:81], v[80:81], v[32:33] op_sel:[0,0] op_sel_hi:[1,0]
  v_pk_mul_f32 v[82:83], v[82:83], v[32:33] op_sel:[0,0] op_sel_hi:[1,0]
  v_cvt_pk_bf16_f32 v16, v64, v65
  v_cvt_pk_bf16_f32 v17, v66, v67
  v_cvt_pk_bf16_f32 v18, v80, v81
  v_cvt_pk_bf16_f32 v19, v82, v83
  buffer_store_dwordx4 v[16:19], v104, s[4:7], s46 offen sc1
  v_pk_mul_f32 v[68:69], v[68:69], v[36:37] op_sel:[0,0] op_sel_hi:[1,0]
  v_pk_mul_f32 v[70:71], v[70:71], v[36:37] op_sel:[0,0] op_sel_hi:[1,0]
  v_pk_mul_f32 v[84:85], v[84:85], v[36:37] op_sel:[0,0] op_sel_hi:[1,0]
  v_pk_mul_f32 v[86:87], v[86:87], v[36:37] op_sel:[0,0] op_sel_hi:[1,0]
  v_cvt_pk_bf16_f32 v20, v68, v69
  v_cvt_pk_bf16_f32 v21, v70, v71
  v_cvt_pk_bf16_f32 v22, v84, v85
  v_cvt_pk_bf16_f32 v23, v86, v87
  buffer_store_dwordx4 v[20:23], v104, s[4:7], s47 offen sc1
  v_pk_mul_f32 v[72:73], v[72:73], v[40:41] op_sel:[0,0] op_sel_hi:[1,0]
  v_pk_mul_f32 v[74:75], v[74:75], v[40:41] op_sel:[0,0] op_sel_hi:[1,0]
  v_pk_mul_f32 v[88:89], v[88:89], v[40:41] op_sel:[0,0] op_sel_hi:[1,0]
  v_pk_mul_f32 v[90:91], v[90:91], v[40:41] op_sel:[0,0] op_sel_hi:[1,0]
  v_cvt_pk_bf16_f32 v24, v72, v73
  v_cvt_pk_bf16_f32 v25, v74, v75
  v_cvt_pk_bf16_f32 v26, v88, v89
  v_cvt_pk_bf16_f32 v27, v90, v91
  buffer_store_dwordx4 v[24:27], v104, s[4:7], s48 offen sc1
  v_pk_mul_f32 v[76:77], v[76:77], v[44:45] op_sel:[0,0] op_sel_hi:[1,0]
  v_pk_mul_f32 v[78:79], v[78:79], v[44:45] op_sel:[0,0] op_sel_hi:[1,0]
  v_pk_mul_f32 v[92:93], v[92:93], v[44:45] op_sel:[0,0] op_sel_hi:[1,0]
  v_pk_mul_f32 v[94:95], v[94:95], v[44:45] op_sel:[0,0] op_sel_hi:[1,0]
  v_cvt_pk_bf16_f32 v28, v76, v77
  v_cvt_pk_bf16_f32 v29, v78, v79
  v_cvt_pk_bf16_f32 v30, v92, v93
  v_cvt_pk_bf16_f32 v31, v94, v95
  buffer_store_dwordx4 v[28:31], v104, s[4:7], s49 offen sc1
Lmk_p1end:
  s_lshl_b32 s44, s52, 3
  s_lshl_b32 s43, s40, 1
  s_add_u32 s44, s44, s43
  s_lshl_b32 s45, s44, 15
  s_add_u32 s57, s45, s42
  s_add_u32 s57, s57, 8388608
  s_lshl_b32 s43, s53, 11
  s_add_u32 s45, s45, s43
  s_add_u32 s45, s45, s42
  s_add_u32 s58, s45, 4194304
  s_add_u32 s59, s58, 32768
  s_lshl_b32 s44, s44, 11
  s_lshl_b32 s43, s53, 7
  s_add_u32 s44, s44, s43
  s_add_u32 s44, s44, s42
  s_add_u32 s60, s44, 27525120
  v_lshlrev_b32 v48, 4, v253
  v_add_u32 v49, 32768, v48
  s_cmp_eq_u32 s41, 0
  s_cselect_b32 s44, 32, 8
  s_cselect_b32 s45, 64, 0x400
  s_lshl_b32 s43, s40, 12
  s_add_u32 s43, s43, 90112
  v_xor_b32 v3, s44, v187
  v_xor_b32 v4, s45, v187
  v_xor_b32 v5, s45, v3
  v_add_u32 v2, s43, v187
  v_add_u32 v3, s43, v3
  v_add_u32 v4, s43, v4
  v_add_u32 v5, s43, v5
  s_waitcnt vmcnt(18)
  ds_read_b64 v[52:53], v2 offset:0
  ds_read_b64 v[54:55], v3 offset:0
  ds_read_b64 v[56:57], v4 offset:0
  ds_read_b64 v[58:59], v5 offset:0
  ds_read_b64 v[60:61], v2 offset:2048
  ds_read_b64 v[62:63], v3 offset:2048
  ds_read_b64 v[64:65], v4 offset:2048
  ds_read_b64 v[66:67], v5 offset:2048
  v_lshrrev_b32 v2, 2, v253
  v_bfe_u32 v3, v253, 3, 2
  v_and_b32 v4, 3, v253
  v_lshlrev_b32 v4, 3, v4
  v_lshl_add_u32 v4, v2, 7, v4
  v_xor_b32 v5, 0, v3
  v_lshl_add_u32 v40, v5, 5, v4
  v_xor_b32 v5, 1, v3
  v_lshl_add_u32 v41, v5, 5, v4
  v_xor_b32 v5, 2, v3
  v_lshl_add_u32 v42, v5, 5, v4
  v_xor_b32 v5, 3, v3
  v_lshl_add_u32 v43, v5, 5, v4
  s_cmp_lg_u32 s3, 0
  s_cbranch_scc1 Lc10_c
Lc10_r:
  s_waitcnt lgkmcnt(0)
  s_waitcnt vmcnt(0)
  s_barrier
  s_cmp_lg_u32 s40, 0
  s_cbranch_scc1 Lsig9
  v_mov_b32 v250, 1
  s_mov_b64 exec, 1
  buffer_atomic_add v250, v251, s[4:7], s77 offen sc1
  s_mov_b64 exec, -1
Lsig9:
  s_add_u32 m0, s89, 24576
  s_xor_b32 s92, s88, 393216
  buffer_load_dwordx4 v186, s[12:15], s92 offen lds
  s_add_u32 m0, s89, 28672
  s_xor_b32 s92, s88, 458752
  buffer_load_dwordx4 v186, s[12:15], s92 offen lds
  s_add_u32 m0, s89, 32768
  s_xor_b32 s92, s88, 524288
  buffer_load_dwordx4 v186, s[12:15], s92 offen lds
  s_add_u32 m0, s89, 36864
  s_xor_b32 s92, s88, 589824
  buffer_load_dwordx4 v186, s[12:15], s92 offen lds
  s_add_u32 m0, s89, 73728
  s_xor_b32 s92, s88, 1179648
  buffer_load_dwordx4 v186, s[12:15], s92 offen lds
  s_add_u32 m0, s89, 77824
  s_xor_b32 s92, s88, 1245184
  buffer_load_dwordx4 v186, s[12:15], s92 offen lds
  s_add_u32 m0, s89, 81920
  s_xor_b32 s92, s88, 1310720
  buffer_load_dwordx4 v186, s[12:15], s92 offen lds
  s_add_u32 m0, s89, 86016
  s_xor_b32 s92, s88, 1376256
  buffer_load_dwordx4 v186, s[12:15], s92 offen lds
  s_add_u32 m0, s89, 90112
  s_xor_b32 s92, s88, 1441792
  buffer_load_dwordx4 v186, s[12:15], s92 offen lds
  s_add_u32 m0, s89, 94208
  s_xor_b32 s92, s88, 1507328
  buffer_load_dwordx4 v186, s[12:15], s92 offen lds
  s_add_u32 m0, s89, 98304
  s_xor_b32 s92, s88, 1572864
  buffer_load_dwordx4 v186, s[12:15], s92 offen lds
  s_add_u32 m0, s89, 102400
  s_xor_b32 s92, s88, 1638400
  buffer_load_dwordx4 v186, s[12:15], s92 offen lds
  s_add_u32 m0, s89, 106496
  s_xor_b32 s92, s88, 1703936
  buffer_load_dwordx4 v186, s[12:15], s92 offen lds
  s_add_u32 m0, s89, 110592
  s_xor_b32 s92, s88, 1769472
  buffer_load_dwordx4 v186, s[12:15], s92 offen lds
  s_add_u32 m0, s89, 114688
  s_xor_b32 s92, s88, 1835008
  buffer_load_dwordx4 v186, s[12:15], s92 offen lds
  s_add_u32 m0, s89, 118784
  s_xor_b32 s92, s88, 1900544
  buffer_load_dwordx4 v186, s[12:15], s92 offen lds
  s_add_u32 m0, s89, 122880
  s_xor_b32 s92, s88, 1966080
  buffer_load_dwordx4 v186, s[12:15], s92 offen lds
  s_add_u32 m0, s89, 126976
  s_xor_b32 s92, s88, 2031616
  buffer_load_dwordx4 v186, s[12:15], s92 offen lds
  v_lshlrev_b32 v0, 16, v52
  v_and_b32 v1, 0xffff0000, v52
  v_lshlrev_b32 v2, 16, v53
  v_and_b32 v3, 0xffff0000, v53
  v_lshlrev_b32 v8, 16, v54
  v_and_b32 v9, 0xffff0000, v54
  v_lshlrev_b32 v10, 16, v55
  v_and_b32 v11, 0xffff0000, v55
  v_lshlrev_b32 v16, 16, v56
  v_and_b32 v17, 0xffff0000, v56
  v_lshlrev_b32 v18, 16, v57
  v_and_b32 v19, 0xffff0000, v57
  v_lshlrev_b32 v24, 16, v58
  v_and_b32 v25, 0xffff0000, v58
  v_lshlrev_b32 v26, 16, v59
  v_and_b32 v27, 0xffff0000, v59
  v_lshlrev_b32 v4, 16, v60
  v_and_b32 v5, 0xffff0000, v60
  v_lshlrev_b32 v6, 16, v61
  v_and_b32 v7, 0xffff0000, v61
  v_lshlrev_b32 v12, 16, v62
  v_and_b32 v13, 0xffff0000, v62
  v_lshlrev_b32 v14, 16, v63
  v_and_b32 v15, 0xffff0000, v63
  v_lshlrev_b32 v20, 16, v64
  v_and_b32 v21, 0xffff0000, v64
  v_lshlrev_b32 v22, 16, v65
  v_and_b32 v23, 0xffff0000, v65
  v_lshlrev_b32 v28, 16, v66
  v_and_b32 v29, 0xffff0000, v66
  v_lshlrev_b32 v30, 16, v67
  v_and_b32 v31, 0xffff0000, v67
  v_and_b32 v92, 15, v253
  v_lshrrev_b32 v93, 4, v253
  v_lshrrev_b32 v72, 2, v92
  v_cmp_eq_u32 vcc, v72, v93
  v_and_b32 v72, 3, v92
  v_lshlrev_b32 v92, 3, v92
  v_mov_b32 v93, 0x7ffffff0
  v_cndmask_b32 v92, v93, v92, vcc
  v_cmp_eq_u32 s[64:65], 1, v72
  v_cmp_eq_u32 s[66:67], 2, v72
  v_cmp_eq_u32 s[68:69], 3, v72
  v_mov_b32 v72, 0x3f803f80
  v_mov_b32 v73, 0x3f803f80
  v_mov_b32 v74, 0x3f803f80
  v_mov_b32 v75, 0x3f803f80
  s_cmp_lg_u32 s3, 0
  s_cbranch_scc1 Lc11_c
Lc11_r:
  s_lshl_b32 s77, s52, 8
  s_add_u32 s77, s77, 27787264
  v_lshlrev_b32 v249, 7, v253
  s_add_u32 s77, s77, s42
  s_cmp_lg_u32 s40, 0
  s_cbranch_scc1 Lpdn13
  s_mov_b32 s43, 0x40000
  s_mov_b64 exec, 3
Lpol12:
  buffer_load_dword v250, v249, s[4:7], s77 offen  sc1
  s_waitcnt vmcnt(0)
  v_cmp_gt_u32 vcc, 8, v250
  s_cbranch_vccz Lpdn13x
  s_sub_u32 s43, s43, 1
  s_cmp_lg_u32 s43, 0
  s_cbranch_scc1 Lpol12
Lpdn13x:
  s_mov_b64 exec, -1
Lpdn13:
  s_waitcnt vmcnt(0) lgkmcnt(0)
  s_barrier
  s_lshr_b32 s88, s88, 6
  s_xor_b32 s93, s57, s88
  buffer_load_dwordx4 a[0:3], v48, s[4:7], s93 offen offset:0 sc1
  buffer_load_dwordx4 a[4:7], v49, s[4:7], s93 offen offset:0 sc1
  buffer_load_dwordx4 a[8:11], v48, s[4:7], s93 offen offset:1024 sc1
  buffer_load_dwordx4 a[12:15], v49, s[4:7], s93 offen offset:1024 sc1
  buffer_load_dwordx4 a[16:19], v48, s[4:7], s93 offen offset:2048 sc1
  buffer_load_dwordx4 a[20:23], v49, s[4:7], s93 offen offset:2048 sc1
  buffer_load_dwordx4 a[24:27], v48, s[4:7], s93 offen offset:3072 sc1
  buffer_load_dwordx4 a[28:31], v49, s[4:7], s93 offen offset:3072 sc1
  s_add_u32 s57, s57, 4096
  s_xor_b32 s93, s57, s88
  buffer_load_dwordx4 a[32:35], v48, s[4:7], s93 offen offset:0 sc1
  buffer_load_dwordx4 a[36:39], v49, s[4:7], s93 offen offset:0 sc1
  buffer_load_dwordx4 a[40:43], v48, s[4:7], s93 offen offset:1024 sc1
  buffer_load_dwordx4 a[44:47], v49, s[4:7], s93 offen offset:1024 sc1
  s_cmp_eq_u32 s40, 1
  s_cselect_b32 s3, s3, 0
  s_cmp_lg_u32 s3, 0
  s_cbranch_scc1 Lc14_c
Lc14_r:
  ds_read_b64_tr_b16 a[128:129], v40 offset:0
  ds_read_b64_tr_b16 a[130:131], v40 offset:2048
  ds_read_b64_tr_b16 a[144:145], v40 offset:4096
  ds_read_b64_tr_b16 a[146:147], v40 offset:6144
  ds_read_b64_tr_b16 a[132:133], v41 offset:0
  ds_read_b64_tr_b16 a[134:135], v41 offset:2048
  ds_read_b64_tr_b16 a[148:149], v41 offset:4096
  ds_read_b64_tr_b16 a[150:151], v41 offset:6144
  ds_read_b64_tr_b16 a[136:137], v42 offset:0
  ds_read_b64_tr_b16 a[138:139], v42 offset:2048
  ds_read_b64_tr_b16 a[152:153], v42 offset:4096
  ds_read_b64_tr_b16 a[154:155], v42 offset:6144
  ds_read_b64_tr_b16 a[140:141], v43 offset:0
  ds_read_b64_tr_b16 a[142:143], v43 offset:2048
  ds_read_b64_tr_b16 a[156:157], v43 offset:4096
  ds_read_b64_tr_b16 a[158:159], v43 offset:6144
  s_and_b32 s43, s53, 0
  s_mul_i32 s77, s52, 1
  s_add_u32 s77, s77, s43
  s_lshl_b32 s77, s77, 7
  s_add_u32 s77, s77, s42
  s_add_u32 s77, s77, 27791360
  s_mov_b32 s56, 3
.p2align 3
Lp2_loop:
  s_waitcnt vmcnt(8) lgkmcnt(8)
  v_mfma_f32_16x16x32_bf16 v[0:3], a[128:131], a[0:3], v[0:3]
  ds_read_b64_tr_b16 a[160:161], v40 offset:8192
  v_mfma_f32_16x16x32_bf16 v[0:3], a[144:147], a[8:11], v[0:3]
  buffer_load_dwordx4 a[48:51], v48, s[4:7], s93 offen offset:2048 sc1
  v_mfma_f32_16x16x32_bf16 v[4:7], a[144:147], a[12:15], v[4:7]
  ds_read_b64_tr_b16 a[162:163], v40 offset:10240
  ds_read_b64_tr_b16 a[176:177], v40 offset:12288
  v_mfma_f32_16x16x32_bf16 v[4:7], a[128:131], a[4:7], v[4:7]
  ds_read_b64_tr_b16 a[178:179], v40 offset:14336
  v_mfma_f32_16x16x32_bf16 v[12:15], a[132:135], a[4:7], v[12:15]
  ds_read_b64_tr_b16 a[164:165], v41 offset:8192
  v_mfma_f32_16x16x32_bf16 v[12:15], a[148:151], a[12:15], v[12:15]
  buffer_load_dwordx4 a[52:55], v49, s[4:7], s93 offen offset:2048 sc1
  v_mfma_f32_16x16x32_bf16 v[8:11], a[148:151], a[8:11], v[8:11]
  ds_read_b64_tr_b16 a[166:167], v41 offset:10240
  ds_read_b64_tr_b16 a[180:181], v41 offset:12288
  v_mfma_f32_16x16x32_bf16 v[8:11], a[132:135], a[0:3], v[8:11]
  ds_read_b64_tr_b16 a[182:183], v41 offset:14336
  s_waitcnt lgkmcnt(8)
  v_mfma_f32_16x16x32_bf16 v[16:19], a[136:139], a[0:3], v[16:19]
  ds_read_b64_tr_b16 a[168:169], v42 offset:8192
  v_mfma_f32_16x16x32_bf16 v[16:19], a[152:155], a[8:11], v[16:19]
  buffer_load_dwordx4 a[56:59], v48, s[4:7], s93 offen offset:3072 sc1
  v_mfma_f32_16x16x32_bf16 v[20:23], a[152:155], a[12:15], v[20:23]
  ds_read_b64_tr_b16 a[170:171], v42 offset:10240
  ds_read_b64_tr_b16 a[184:185], v42 offset:12288
  v_mfma_f32_16x16x32_bf16 v[20:23], a[136:139], a[4:7], v[20:23]
  ds_read_b64_tr_b16 a[186:187], v42 offset:14336
  v_mfma_f32_16x16x32_bf16 v[28:31], a[140:143], a[4:7], v[28:31]
  ds_read_b64_tr_b16 a[172:173], v43 offset:8192
  v_mfma_f32_16x16x32_bf16 v[28:31], a[156:159], a[12:15], v[28:31]
  buffer_load_dwordx4 a[60:63], v49, s[4:7], s93 offen offset:3072 sc1
  v_mfma_f32_16x16x32_bf16 v[24:27], a[156:159], a[8:11], v[24:27]
  ds_read_b64_tr_b16 a[174:175], v43 offset:10240
  ds_read_b64_tr_b16 a[188:189], v43 offset:12288
  v_mfma_f32_16x16x32_bf16 v[24:27], a[140:143], a[0:3], v[24:27]
  ds_read_b64_tr_b16 a[190:191], v43 offset:14336
  s_waitcnt vmcnt(8) lgkmcnt(8)
  v_mfma_f32_16x16x32_bf16 v[0:3], a[160:163], a[16:19], v[0:3]
  ds_read_b64_tr_b16 a[128:129], v40 offset:16384
  v_mfma_f32_16x16x32_bf16 v[0:3], a[176:179], a[24:27], v[0:3]
  s_add_u32 s57, s57, 4096
  s_xor_b32 s93, s57, s88
  buffer_load_dwordx4 a[0:3], v48, s[4:7], s93 offen offset:0 sc1
  v_mfma_f32_16x16x32_bf16 v[4:7], a[176:179], a[28:31], v[4:7]
  ds_read_b64_tr_b16 a[130:131], v40 offset:18432
  ds_read_b64_tr_b16 a[144:145], v40 offset:20480
  v_mfma_f32_16x16x32_bf16 v[4:7], a[160:163], a[20:23], v[4:7]
  ds_read_b64_tr_b16 a[146:147], v40 offset:22528
  v_mfma_f32_16x16x32_bf16 v[12:15], a[164:167], a[20:23], v[12:15]
  ds_read_b64_tr_b16 a[132:133], v41 offset:16384
  v_mfma_f32_16x16x32_bf16 v[12:15], a[180:183], a[28:31], v[12:15]
  buffer_load_dwordx4 a[4:7], v49, s[4:7], s93 offen offset:0 sc1
  v_mfma_f32_16x16x32_bf16 v[8:11], a[180:183], a[24:27], v[8:11]
  ds_read_b64_tr_b16 a[134:135], v41 offset:18432
  ds_read_b64_tr_b16 a[148:149], v41 offset:20480
  v_mfma_f32_16x16x32_bf16 v[8:11], a[164:167], a[16:19], v[8:11]
  ds_read_b64_tr_b16 a[150:151], v41 offset:22528
  s_waitcnt lgkmcnt(8)
  v_mfma_f32_16x16x32_bf16 v[16:19], a[168:171], a[16:19], v[16:19]
  ds_read_b64_tr_b16 a[136:137], v42 offset:16384
  v_mfma_f32_16x16x32_bf16 v[16:19], a[184:187], a[24:27], v[16:19]
  buffer_load_dwordx4 a[8:11], v48, s[4:7], s93 offen offset:1024 sc1
  v_mfma_f32_16x16x32_bf16 v[20:23], a[184:187], a[28:31], v[20:23]
  ds_read_b64_tr_b16 a[138:139], v42 offset:18432
  ds_read_b64_tr_b16 a[152:153], v42 offset:20480
  v_mfma_f32_16x16x32_bf16 v[20:23], a[168:171], a[20:23], v[20:23]
  ds_read_b64_tr_b16 a[154:155], v42 offset:22528
  v_mfma_f32_16x16x32_bf16 v[28:31], a[172:175], a[20:23], v[28:31]
  ds_read_b64_tr_b16 a[140:141], v43 offset:16384
  v_mfma_f32_16x16x32_bf16 v[28:31], a[188:191], a[28:31], v[28:31]
  buffer_load_dwordx4 a[12:15], v49, s[4:7], s93 offen offset:1024 sc1
  v_mfma_f32_16x16x32_bf16 v[24:27], a[188:191], a[24:27], v[24:27]
  ds_read_b64_tr_b16 a[142:143], v43 offset:18432
  ds_read_b64_tr_b16 a[156:157], v43 offset:20480
  v_mfma_f32_16x16x32_bf16 v[24:27], a[172:175], a[16:19], v[24:27]
  ds_read_b64_tr_b16 a[158:159], v43 offset:22528
  s_waitcnt vmcnt(8) lgkmcnt(8)
  v_mfma_f32_16x16x32_bf16 v[0:3], a[128:131], a[32:35], v[0:3]
  ds_read_b64_tr_b16 a[160:161], v40 offset:24576
  v_mfma_f32_16x16x32_bf16 v[0:3], a[144:147], a[40:43], v[0:3]
  buffer_load_dwordx4 a[16:19], v48, s[4:7], s93 offen offset:2048 sc1
  v_mfma_f32_16x16x32_bf16 v[4:7], a[144:147], a[44:47], v[4:7]
  ds_read_b64_tr_b16 a[162:163], v40 offset:26624
  ds_read_b64_tr_b16 a[176:177], v40 offset:28672
  v_mfma_f32_16x16x32_bf16 v[4:7], a[128:131], a[36:39], v[4:7]
  ds_read_b64_tr_b16 a[178:179], v40 offset:30720
  v_add_u32 v40, 32768, v40
  v_mfma_f32_16x16x32_bf16 v[12:15], a[132:135], a[36:39], v[12:15]
  ds_read_b64_tr_b16 a[164:165], v41 offset:24576
  v_mfma_f32_16x16x32_bf16 v[12:15], a[148:151], a[44:47], v[12:15]
  buffer_load_dwordx4 a[20:23], v49, s[4:7], s93 offen offset:2048 sc1
  v_mfma_f32_16x16x32_bf16 v[8:11], a[148:151], a[40:43], v[8:11]
  ds_read_b64_tr_b16 a[166:167], v41 offset:26624
  ds_read_b64_tr_b16 a[180:181], v41 offset:28672
  v_mfma_f32_16x16x32_bf16 v[8:11], a[132:135], a[32:35], v[8:11]
  s_waitcnt lgkmcnt(7)
  ds_read_b64_tr_b16 a[182:183], v41 offset:30720
  v_add_u32 v41, 32768, v41
  v_mfma_f32_16x16x32_bf16 v[16:19], a[136:139], a[32:35], v[16:19]
  ds_read_b64_tr_b16 a[168:169], v42 offset:24576
  v_mfma_f32_16x16x32_bf16 v[16:19], a[152:155], a[40:43], v[16:19]
  buffer_load_dwordx4 a[24:27], v48, s[4:7], s93 offen offset:3072 sc1
  v_mfma_f32_16x16x32_bf16 v[20:23], a[152:155], a[44:47], v[20:23]
  ds_read_b64_tr_b16 a[170:171], v42 offset:26624
  ds_read_b64_tr_b16 a[184:185], v42 offset:28672
  v_mfma_f32_16x16x32_bf16 v[20:23], a[136:139], a[36:39], v[20:23]
  ds_read_b64_tr_b16 a[186:187], v42 offset:30720
  v_add_u32 v42, 32768, v42
  v_mfma_f32_16x16x32_bf16 v[28:31], a[140:143], a[36:39], v[28:31]
  ds_read_b64_tr_b16 a[172:173], v43 offset:24576
  v_mfma_f32_16x16x32_bf16 v[28:31], a[156:159], a[44:47], v[28:31]
  buffer_load_dwordx4 a[28:31], v49, s[4:7], s93 offen offset:3072 sc1
  v_mfma_f32_16x16x32_bf16 v[24:27], a[156:159], a[40:43], v[24:27]
  ds_read_b64_tr_b16 a[174:175], v43 offset:26624
  ds_read_b64_tr_b16 a[188:189], v43 offset:28672
  v_mfma_f32_16x16x32_bf16 v[24:27], a[140:143], a[32:35], v[24:27]
  s_waitcnt vmcnt(8) lgkmcnt(7)
  ds_read_b64_tr_b16 a[190:191], v43 offset:30720
  v_add_u32 v43, 32768, v43
  v_mfma_f32_16x16x32_bf16 v[0:3], a[160:163], a[48:51], v[0:3]
  ds_read_b64_tr_b16 a[128:129], v40 offset:0
  v_mfma_f32_16x16x32_bf16 v[0:3], a[176:179], a[56:59], v[0:3]
  s_add_u32 s57, s57, 4096
  s_xor_b32 s93, s57, s88
  buffer_load_dwordx4 a[32:35], v48, s[4:7], s93 offen offset:0 sc1
  v_mfma_f32_16x16x32_bf16 v[4:7], a[176:179], a[60:63], v[4:7]
  ds_read_b64_tr_b16 a[130:131], v40 offset:2048
  ds_read_b64_tr_b16 a[144:145], v40 offset:4096
  v_mfma_f32_16x16x32_bf16 v[4:7], a[160:163], a[52:55], v[4:7]
  ds_read_b64_tr_b16 a[146:147], v40 offset:6144
  v_mfma_f32_16x16x32_bf16 v[12:15], a[164:167], a[52:55], v[12:15]
  ds_read_b64_tr_b16 a[132:133], v41 offset:0
  v_mfma_f32_16x16x32_bf16 v[12:15], a[180:183], a[60:63], v[12:15]
  buffer_load_dwordx4 a[36:39], v49, s[4:7], s93 offen offset:0 sc1
  v_mfma_f32_16x16x32_bf16 v[8:11], a[180:183], a[56:59], v[8:11]
  ds_read_b64_tr_b16 a[134:135], v41 offset:2048
  ds_read_b64_tr_b16 a[148:149], v41 offset:4096
  v_mfma_f32_16x16x32_bf16 v[8:11], a[164:167], a[48:51], v[8:11]
  ds_read_b64_tr_b16 a[150:151], v41 offset:6144
  s_waitcnt lgkmcnt(8)
  v_mfma_f32_16x16x32_bf16 v[16:19], a[168:171], a[48:51], v[16:19]
  ds_read_b64_tr_b16 a[136:137], v42 offset:0
  v_mfma_f32_16x16x32_bf16 v[16:19], a[184:187], a[56:59], v[16:19]
  buffer_load_dwordx4 a[40:43], v48, s[4:7], s93 offen offset:1024 sc1
  v_mfma_f32_16x16x32_bf16 v[20:23], a[184:187], a[60:63], v[20:23]
  ds_read_b64_tr_b16 a[138:139], v42 offset:2048
  ds_read_b64_tr_b16 a[152:153], v42 offset:4096
  v_mfma_f32_16x16x32_bf16 v[20:23], a[168:171], a[52:55], v[20:23]
  ds_read_b64_tr_b16 a[154:155], v42 offset:6144
  v_mfma_f32_16x16x32_bf16 v[28:31], a[172:175], a[52:55], v[28:31]
  ds_read_b64_tr_b16 a[140:141], v43 offset:0
  v_mfma_f32_16x16x32_bf16 v[28:31], a[188:191], a[60:63], v[28:31]
  s_sub_u32 s56, s56, 1
  buffer_load_dwordx4 a[44:47], v49, s[4:7], s93 offen offset:1024 sc1
  v_mfma_f32_16x16x32_bf16 v[24:27], a[188:191], a[56:59], v[24:27]
  s_cmp_lg_u32 s56, 0
  ds_read_b64_tr_b16 a[142:143], v43 offset:2048
  ds_read_b64_tr_b16 a[156:157], v43 offset:4096
  v_mfma_f32_16x16x32_bf16 v[24:27], a[172:175], a[48:51], v[24:27]
  ds_read_b64_tr_b16 a[158:159], v43 offset:6144
  s_cbranch_scc1 Lp2_loop
Lmk_Lp2_loop_tail:
  s_waitcnt vmcnt(8) lgkmcnt(8)
  v_mfma_f32_16x16x32_bf16 v[0:3], a[128:131], a[0:3], v[0:3]
  ds_read_b64_tr_b16 a[160:161], v40 offset:8192
  v_mfma_f32_16x16x32_bf16 v[0:3], a[144:147], a[8:11], v[0:3]
  buffer_load_dwordx4 a[48:51], v48, s[4:7], s93 offen offset:2048 sc1
  v_mfma_f32_16x16x32_bf16 v[4:7], a[144:147], a[12:15], v[4:7]
  ds_read_b64_tr_b16 a[162:163], v40 offset:10240
  ds_read_b64_tr_b16 a[176:177], v40 offset:12288
  v_mfma_f32_16x16x32_bf16 v[4:7], a[128:131], a[4:7], v[4:7]
  ds_read_b64_tr_b16 a[178:179], v40 offset:14336
  v_mfma_f32_16x16x32_bf16 v[12:15], a[132:135], a[4:7], v[12:15]
  ds_read_b64_tr_b16 a[164:165], v41 offset:8192
  v_mfma_f32_16x16x32_bf16 v[12:15], a[148:151], a[12:15], v[12:15]
  buffer_load_dwordx4 a[52:55], v49, s[4:7], s93 offen offset:2048 sc1
  v_mfma_f32_16x16x32_bf16 v[8:11], a[148:151], a[8:11], v[8:11]
  ds_read_b64_tr_b16 a[166:167], v41 offset:10240
  ds_read_b64_tr_b16 a[180:181], v41 offset:12288
  v_mfma_f32_16x16x32_bf16 v[8:11], a[132:135], a[0:3], v[8:11]
  ds_read_b64_tr_b16 a[182:183], v41 offset:14336
  s_waitcnt lgkmcnt(8)
  v_mfma_f32_16x16x32_bf16 v[16:19], a[136:139], a[0:3], v[16:19]
  ds_read_b64_tr_b16 a[168:169], v42 offset:8192
  v_mfma_f32_16x16x32_bf16 v[16:19], a[152:155], a[8:11], v[16:19]
  buffer_load_dwordx4 a[56:59], v48, s[4:7], s93 offen offset:3072 sc1
  v_mfma_f32_16x16x32_bf16 v[20:23], a[152:155], a[12:15], v[20:23]
  ds_read_b64_tr_b16 a[170:171], v42 offset:10240
  ds_read_b64_tr_b16 a[184:185], v42 offset:12288
  v_mfma_f32_16x16x32_bf16 v[20:23], a[136:139], a[4:7], v[20:23]
  ds_read_b64_tr_b16 a[186:187], v42 offset:14336
  v_mfma_f32_16x16x32_bf16 v[28:31], a[140:143], a[4:7], v[28:31]
  ds_read_b64_tr_b16 a[172:173], v43 offset:8192
  v_mfma_f32_16x16x32_bf16 v[28:31], a[156:159], a[12:15], v[28:31]
  buffer_load_dwordx4 a[60:63], v49, s[4:7], s93 offen offset:3072 sc1
  v_mfma_f32_16x16x32_bf16 v[24:27], a[156:159], a[8:11], v[24:27]
  ds_read_b64_tr_b16 a[174:175], v43 offset:10240
  ds_read_b64_tr_b16 a[188:189], v43 offset:12288
  v_mfma_f32_16x16x32_bf16 v[24:27], a[140:143], a[0:3], v[24:27]
  ds_read_b64_tr_b16 a[190:191], v43 offset:14336
  s_waitcnt vmcnt(8) lgkmcnt(8)
  v_mfma_f32_16x16x32_bf16 v[0:3], a[160:163], a[16:19], v[0:3]
  ds_read_b64_tr_b16 a[128:129], v40 offset:16384
  v_mfma_f32_16x16x32_bf16 v[0:3], a[176:179], a[24:27], v[0:3]
  ds_read_b64_tr_b16 a[130:131], v40 offset:18432
  v_mfma_f32_16x16x32_bf16 v[4:7], a[176:179], a[28:31], v[4:7]
  ds_read_b64_tr_b16 a[144:145], v40 offset:20480
  v_mfma_f32_16x16x32_bf16 v[4:7], a[160:163], a[20:23], v[4:7]
  ds_read_b64_tr_b16 a[146:147], v40 offset:22528
  v_mfma_f32_16x16x32_bf16 v[12:15], a[164:167], a[20:23], v[12:15]
  ds_read_b64_tr_b16 a[132:133], v41 offset:16384
  v_mfma_f32_16x16x32_bf16 v[12:15], a[180:183], a[28:31], v[12:15]
  ds_read_b64_tr_b16 a[134:135], v41 offset:18432
  v_mfma_f32_16x16x32_bf16 v[8:11], a[180:183], a[24:27], v[8:11]
  ds_read_b64_tr_b16 a[148:149], v41 offset:20480
  v_mfma_f32_16x16x32_bf16 v[8:11], a[164:167], a[16:19], v[8:11]
  ds_read_b64_tr_b16 a[150:151], v41 offset:22528
  s_waitcnt lgkmcnt(8)
  v_mfma_f32_16x16x32_bf16 v[16:19], a[168:171], a[16:19], v[16:19]
  ds_read_b64_tr_b16 a[136:137], v42 offset:16384
  v_mfma_f32_16x16x32_bf16 v[16:19], a[184:187], a[24:27], v[16:19]
  ds_read_b64_tr_b16 a[138:139], v42 offset:18432
  v_mfma_f32_16x16x32_bf16 v[20:23], a[184:187], a[28:31], v[20:23]
  ds_read_b64_tr_b16 a[152:153], v42 offset:20480
  v_mfma_f32_16x16x32_bf16 v[20:23], a[168:171], a[20:23], v[20:23]
  ds_read_b64_tr_b16 a[154:155], v42 offset:22528
  v_mfma_f32_16x16x32_bf16 v[28:31], a[172:175], a[20:23], v[28:31]
  ds_read_b64_tr_b16 a[140:141], v43 offset:16384
  v_mfma_f32_16x16x32_bf16 v[28:31], a[188:191], a[28:31], v[28:31]
  ds_read_b64_tr_b16 a[142:143], v43 offset:18432
  v_mfma_f32_16x16x32_bf16 v[24:27], a[188:191], a[24:27], v[24:27]
  ds_read_b64_tr_b16 a[156:157], v43 offset:20480
  v_mfma_f32_16x16x32_bf16 v[24:27], a[172:175], a[16:19], v[24:27]
  ds_read_b64_tr_b16 a[158:159], v43 offset:22528
  s_waitcnt vmcnt(4) lgkmcnt(8)
  v_mfma_f32_16x16x32_bf16 v[0:3], a[128:131], a[32:35], v[0:3]
  ds_read_b64_tr_b16 a[160:161], v40 offset:24576
  v_mfma_f32_16x16x32_bf16 v[0:3], a[144:147], a[40:43], v[0:3]
  ds_read_b64_tr_b16 a[162:163], v40 offset:26624
  v_mfma_f32_16x16x32_bf16 v[4:7], a[144:147], a[44:47], v[4:7]
  ds_read_b64_tr_b16 a[176:177], v40 offset:28672
  v_mfma_f32_16x16x32_bf16 v[4:7], a[128:131], a[36:39], v[4:7]
  ds_read_b64_tr_b16 a[178:179], v40 offset:30720
  v_add_u32 v40, 32768, v40
  v_mfma_f32_16x16x32_bf16 v[12:15], a[132:135], a[36:39], v[12:15]
  ds_read_b64_tr_b16 a[164:165], v41 offset:24576
  v_mfma_f32_16x16x32_bf16 v[12:15], a[148:151], a[44:47], v[12:15]
  ds_read_b64_tr_b16 a[166:167], v41 offset:26624
  v_mfma_f32_16x16x32_bf16 v[8:11], a[148:151], a[40:43], v[8:11]
  ds_read_b64_tr_b16 a[180:181], v41 offset:28672
  v_mfma_f32_16x16x32_bf16 v[8:11], a[132:135], a[32:35], v[8:11]
  s_waitcnt lgkmcnt(7)
  ds_read_b64_tr_b16 a[182:183], v41 offset:30720
  v_add_u32 v41, 32768, v41
  v_mfma_f32_16x16x32_bf16 v[16:19], a[136:139], a[32:35], v[16:19]
  ds_read_b64_tr_b16 a[168:169], v42 offset:24576
  v_mfma_f32_16x16x32_bf16 v[16:19], a[152:155], a[40:43], v[16:19]
  ds_read_b64_tr_b16 a[170:171], v42 offset:26624
  v_mfma_f32_16x16x32_bf16 v[20:23], a[152:155], a[44:47], v[20:23]
  ds_read_b64_tr_b16 a[184:185], v42 offset:28672
  v_mfma_f32_16x16x32_bf16 v[20:23], a[136:139], a[36:39], v[20:23]
  ds_read_b64_tr_b16 a[186:187], v42 offset:30720
  v_add_u32 v42, 32768, v42
  v_mfma_f32_16x16x32_bf16 v[28:31], a[140:143], a[36:39], v[28:31]
  ds_read_b64_tr_b16 a[172:173], v43 offset:24576
  v_mfma_f32_16x16x32_bf16 v[28:31], a[156:159], a[44:47], v[28:31]
  ds_read_b64_tr_b16 a[174:175], v43 offset:26624
  v_mfma_f32_16x16x32_bf16 v[24:27], a[156:159], a[40:43], v[24:27]
  ds_read_b64_tr_b16 a[188:189], v43 offset:28672
  v_mfma_f32_16x16x32_bf16 v[24:27], a[140:143], a[32:35], v[24:27]
  s_waitcnt vmcnt(0) lgkmcnt(7)
  ds_read_b64_tr_b16 a[190:191], v43 offset:30720
  v_add_u32 v43, 32768, v43
  v_mfma_f32_16x16x32_bf16 v[0:3], a[160:163], a[48:51], v[0:3]
  v_mfma_f32_16x16x32_bf16 v[0:3], a[176:179], a[56:59], v[0:3]
  v_mfma_f32_16x16x32_bf16 v[4:7], a[176:179], a[60:63], v[4:7]
  v_mfma_f32_16x16x32_bf16 v[4:7], a[160:163], a[52:55], v[4:7]
  v_mfma_f32_16x16x32_bf16 v[12:15], a[164:167], a[52:55], v[12:15]
  v_mfma_f32_16x16x32_bf16 v[12:15], a[180:183], a[60:63], v[12:15]
  v_mfma_f32_16x16x32_bf16 v[8:11], a[180:183], a[56:59], v[8:11]
  v_mfma_f32_16x16x32_bf16 v[8:11], a[164:167], a[48:51], v[8:11]
  s_waitcnt lgkmcnt(0)
  v_mfma_f32_16x16x32_bf16 v[16:19], a[168:171], a[48:51], v[16:19]
  s_nop 0
  v_mfma_f32_16x16x32_bf16 v[16:19], a[184:187], a[56:59], v[16:19]
  s_nop 0
  v_mfma_f32_16x16x32_bf16 v[20:23], a[184:187], a[60:63], v[20:23]
  s_nop 0
  v_mfma_f32_16x16x32_bf16 v[20:23], a[168:171], a[52:55], v[20:23]
  v_cvt_pk_bf16_f32 v60, v4, v5
  v_cvt_pk_bf16_f32 v61, v6, v7
  v_mfma_f32_16x16x32_bf16 v[28:31], a[172:175], a[52:55], v[28:31]
  v_cvt_pk_bf16_f32 v62, v12, v13
  v_cvt_pk_bf16_f32 v63, v14, v15
  v_mfma_f32_16x16x32_bf16 v[28:31], a[188:191], a[60:63], v[28:31]
  buffer_store_dwordx4 v[60:63], v48, s[4:7], s59 offen offset:0 sc1
  v_mfma_f32_16x16x32_bf16 v[24:27], a[188:191], a[56:59], v[24:27]
  v_cvt_pk_bf16_f32 v52, v0, v1
  v_cvt_pk_bf16_f32 v53, v2, v3
  v_mfma_f32_16x16x32_bf16 v[24:27], a[172:175], a[48:51], v[24:27]
  v_cvt_pk_bf16_f32 v54, v8, v9
  v_cvt_pk_bf16_f32 v55, v10, v11
  v_mfma_f32_16x16x32_bf16 v[88:91], v[60:63], v[60:63], 0
  buffer_store_dwordx4 v[52:55], v48, s[4:7], s58 offen offset:0 sc1
  v_mfma_f32_16x16x32_bf16 v[84:87], v[72:75], v[60:63], 0
  v_cvt_pk_bf16_f32 v64, v20, v21
  v_mfma_f32_16x16x32_bf16 v[80:83], v[52:55], v[52:55], 0
  v_cvt_pk_bf16_f32 v65, v22, v23
  v_cvt_pk_bf16_f32 v66, v28, v29
  v_cvt_pk_bf16_f32 v67, v30, v31
  v_mfma_f32_16x16x32_bf16 v[76:79], v[72:75], v[52:55], 0
  buffer_store_dwordx4 v[64:67], v48, s[4:7], s59 offen offset:1024 sc1
  v_cvt_pk_bf16_f32 v56, v16, v17
  v_cvt_pk_bf16_f32 v57, v18, v19
  v_cvt_pk_bf16_f32 v58, v24, v25
  v_cvt_pk_bf16_f32 v59, v26, v27
  buffer_store_dwordx4 v[56:59], v48, s[4:7], s58 offen offset:1024 sc1
  s_nop 0
  v_mfma_f32_16x16x32_bf16 v[88:91], v[64:67], v[64:67], v[88:91]
  v_mfma_f32_16x16x32_bf16 v[84:87], v[72:75], v[64:67], v[84:87]
  v_mfma_f32_16x16x32_bf16 v[80:83], v[56:59], v[56:59], v[80:83]
  v_mfma_f32_16x16x32_bf16 v[76:79], v[72:75], v[56:59], v[76:79]
  s_nop 5
  v_cndmask_b32 v85, v88, v89, s[64:65]
  v_cndmask_b32 v85, v85, v90, s[66:67]
  v_cndmask_b32 v85, v85, v91, s[68:69]
  buffer_store_dwordx2 v[84:85], v92, s[4:7], s60 offen offset:2048 sc1
  v_cndmask_b32 v77, v80, v81, s[64:65]
  v_cndmask_b32 v77, v77, v82, s[66:67]
  v_cndmask_b32 v77, v77, v83, s[68:69]
  buffer_store_dwordx2 v[76:77], v92, s[4:7], s60 offen offset:0 sc1
  s_and_b32 s66, s55, 1
  v_lshrrev_b32 v2, 4, v253
  v_bfe_u32 v3, v253, 1, 3
  v_and_b32 v4, 1, v253
  v_lshlrev_b32 v4, 4, v4
  v_mul_u32_u24 v5, 7168, v2
  v_add_u32 v5, v5, v4
  s_cmp_eq_u32 s66, 0
  s_cselect_b32 s44, 7, 0
  v_mov_b32 v7, 0x40000000
  v_add_u32 v6, 0, v2
  v_xor_b32 v6, v6, v3
  v_cmp_eq_u32 vcc, s44, v6
  v_lshl_add_u32 v6, v6, 5, v5
  v_add_u32 v6, 0, v6
  v_cndmask_b32 v232, v6, v7, vcc
  v_add_u32 v6, 4, v2
  v_xor_b32 v6, v6, v3
  v_cmp_eq_u32 vcc, s44, v6
  v_lshl_add_u32 v6, v6, 5, v5
  v_add_u32 v6, 27648, v6
  v_cndmask_b32 v233, v6, v7, vcc
  v_add_u32 v6, 0, v2
  v_xor_b32 v6, v6, v3
  v_cmp_eq_u32 vcc, s44, v6
  v_lshl_add_u32 v6, v6, 5, v5
  v_add_u32 v6, 55296, v6
  v_cndmask_b32 v234, v6, v7, vcc
  v_add_u32 v6, 4, v2
  v_xor_b32 v6, v6, v3
  v_cmp_eq_u32 vcc, s44, v6
  v_lshl_add_u32 v6, v6, 5, v5
  v_add_u32 v6, 82944, v6
  v_cndmask_b32 v235, v6, v7, vcc
  s_mul_i32 s67, s55, 224
  s_and_b32 s67, s67, 0xffffffc0
  s_mul_i32 s43, s40, 114688
  s_add_u32 s67, s67, s43
  s_lshl_b32 s68, s40, 12
  v_lshlrev_b32 v231, 4, v253
  s_lshl_b32 s43, s41, 30
  v_or_b32 v236, s43, v231
  s_lshl_b32 s43, s2, 2
  s_add_u32 s43, s43, s40
  s_mul_i32 s70, s43, 7168
  s_lshl_b32 s69, s54, 2
  s_add_u32 s69, s69, s40
  s_lshl_b32 s72, s69, 17
  s_add_u32 s72, s72, s42
  s_add_u32 s72, s72, 4194304
  s_add_u32 s73, s72, 32768
  s_add_u32 s74, s73, 32768
  s_add_u32 s75, s74, 32768
  s_lshl_b32 s71, s40, 11
  s_add_u32 s71, s71, 131072
  v_lshrrev_b32 v2, 2, v253
  v_and_b32 v3, 7, v2
  v_and_b32 v4, 3, v253
  v_lshlrev_b32 v5, 3, v4
  v_lshl_add_u32 v5, v2, 8, v5
  s_lshl_b32 s43, s66, 1
  s_cmp_eq_u32 s66, 0
  s_cselect_b32 s45, 6, 1
  v_xor_b32 v6, s45, v3
  v_lshl_add_u32 v224, v6, 5, v5
  s_add_u32 s46, s43, 0
  v_xor_b32 v6, s46, v3
  v_lshl_add_u32 v225, v6, 5, v5
  s_add_u32 s46, s43, 1
  v_xor_b32 v6, s46, v3
  v_lshl_add_u32 v226, v6, 5, v5
  s_add_u32 s46, s43, 2
  v_xor_b32 v6, s46, v3
  v_lshl_add_u32 v227, v6, 5, v5
  s_add_u32 s46, s43, 3
  v_xor_b32 v6, s46, v3
  v_lshl_add_u32 v228, v6, 5, v5
  s_add_u32 s46, s43, 4
  v_xor_b32 v6, s46, v3
  v_lshl_add_u32 v229, v6, 5, v5
  s_add_u32 s46, s43, 5
  v_xor_b32 v6, s46, v3
  v_lshl_add_u32 v230, v6, 5, v5
  s_mul_i32 s46, s55, 448
  s_add_u32 s46, s46, 27918336
  s_add_u32 s47, s46, 28672
  s_lshr_b32 s48, s55, 3
  s_lshl_b32 s48, s48, 7
  s_add_u32 s48, s48, 27794432
  s_lshl_b32 s44, s69, 13
  s_add_u32 s44, s44, s42
  s_add_u32 s44, s44, 27525120
  s_add_u32 s45, s44, 4096
  s_waitcnt vmcnt(0)
  s_barrier
  s_cmp_lg_u32 s40, 0
  s_cbranch_scc1 Lsig15
  v_mov_b32 v250, 1
  s_mov_b64 exec, 1
  buffer_atomic_add v250, v251, s[4:7], s77 offen sc1
  s_mov_b64 exec, -1
Lsig15:
  s_cmp_lg_u32 s3, 0
  s_cbranch_scc1 Lc16_c
Lc16_r:
  s_add_u32 m0, s68, 0
  s_nop 0
  buffer_load_dwordx4 v232, s[16:19], s67 offen offset:0  lds
  buffer_load_dwordx4 v233, s[16:19], s67 offen offset:1024  lds
  buffer_load_dwordx4 v234, s[16:19], s67 offen offset:2048  lds
  buffer_load_dwordx4 v235, s[16:19], s67 offen offset:3072  lds
  s_add_u32 m0, s68, 16384
  s_nop 0
  buffer_load_dwordx4 v232, s[20:23], s67 offen offset:0  lds
  buffer_load_dwordx4 v233, s[20:23], s67 offen offset:1024  lds
  buffer_load_dwordx4 v234, s[20:23], s67 offen offset:2048  lds
  buffer_load_dwordx4 v235, s[20:23], s67 offen offset:3072  lds
  s_add_u32 s67, s67, 458752
  s_add_u32 m0, s68, 32768
  s_nop 0
  buffer_load_dwordx4 v232, s[16:19], s67 offen offset:0  lds
  buffer_load_dwordx4 v233, s[16:19], s67 offen offset:1024  lds
  buffer_load_dwordx4 v234, s[16:19], s67 offen offset:2048  lds
  buffer_load_dwordx4 v235, s[16:19], s67 offen offset:3072  lds
  s_add_u32 m0, s68, 49152
  s_nop 0
  buffer_load_dwordx4 v232, s[20:23], s67 offen offset:0  lds
  buffer_load_dwordx4 v233, s[20:23], s67 offen offset:1024  lds
  buffer_load_dwordx4 v234, s[20:23], s67 offen offset:2048  lds
  buffer_load_dwordx4 v235, s[20:23], s67 offen offset:3072  lds
  s_add_u32 s67, s67, 458752
  s_xor_b32 s68, s68, 0x10000
  s_mul_i32 s77, s54, 256
  s_add_u32 s77, s77, s42
  s_add_u32 s77, s77, 27791360
  v_lshlrev_b32 v249, 7, v253
  s_cmp_lg_u32 s40, 0
  s_cbranch_scc1 Lpdn18
  s_mov_b32 s43, 0x40000
  s_mov_b64 exec, 3
Lpol17:
  buffer_load_dword v250, v249, s[4:7], s77 offen  sc1
  s_waitcnt vmcnt(0)
  v_cmp_gt_u32 vcc, 16, v250
  s_cbranch_vccz Lpdn18x
  s_sub_u32 s43, s43, 1
  s_cmp_lg_u32 s43, 0
  s_cbranch_scc1 Lpol17
Lpdn18x:
  s_mov_b64 exec, -1
Lpdn18:
  s_waitcnt vmcnt(0) lgkmcnt(0)
  s_barrier
  buffer_load_dwordx4 a[0:3], v231, s[4:7], s72 offen offset:0 sc1
  buffer_load_dwordx4 a[16:19], v231, s[4:7], s72 offen offset:1024 sc1
  buffer_load_dwordx4 a[4:7], v231, s[4:7], s73 offen offset:0 sc1
  buffer_load_dwordx4 a[20:23], v231, s[4:7], s73 offen offset:1024 sc1
  buffer_load_dwordx4 a[8:11], v231, s[4:7], s74 offen offset:0 sc1
  buffer_load_dwordx4 a[24:27], v231, s[4:7], s74 offen offset:1024 sc1
  buffer_load_dwordx4 a[12:15], v231, s[4:7], s75 offen offset:0 sc1
  buffer_load_dwordx4 a[28:31], v231, s[4:7], s75 offen offset:1024 sc1
  ds_read_b64_tr_b16 a[64:65], v224 offset:0
  ds_read_b64_tr_b16 a[66:67], v224 offset:4096
  ds_read_b64_tr_b16 a[68:69], v224 offset:8192
  ds_read_b64_tr_b16 a[70:71], v224 offset:12288
  ds_read_b64_tr_b16 a[72:73], v224 offset:16384
  ds_read_b64_tr_b16 a[74:75], v224 offset:20480
  ds_read_b64_tr_b16 a[76:77], v224 offset:24576
  ds_read_b64_tr_b16 a[78:79], v224 offset:28672
Lmk_p3s0:
  s_waitcnt vmcnt(6) lgkmcnt(4)
  v_mfma_f32_16x16x32_bf16 v[0:3], a[64:67], a[0:3], 0
  ds_read_b64_tr_b16 a[80:81], v225 offset:0
  v_mfma_f32_16x16x32_bf16 v[0:3], a[68:71], a[16:19], v[0:3]
  ds_read_b64_tr_b16 a[82:83], v225 offset:4096
  s_waitcnt vmcnt(4)
  v_mfma_f32_16x16x32_bf16 v[4:7], a[68:71], a[20:23], 0
  v_mfma_f32_16x16x32_bf16 v[4:7], a[64:67], a[4:7], v[4:7]
  s_waitcnt vmcnt(2)
  v_mfma_f32_16x16x32_bf16 v[8:11], a[64:67], a[8:11], 0
  ds_read_b64_tr_b16 a[84:85], v225 offset:8192
  v_mfma_f32_16x16x32_bf16 v[8:11], a[68:71], a[24:27], v[8:11]
  ds_read_b64_tr_b16 a[86:87], v225 offset:12288
  s_waitcnt vmcnt(0)
  v_mfma_f32_16x16x32_bf16 v[12:15], a[68:71], a[28:31], 0
  v_mfma_f32_16x16x32_bf16 v[12:15], a[64:67], a[12:15], v[12:15]
  s_waitcnt lgkmcnt(4)
  v_mfma_f32_16x16x32_bf16 v[28:31], a[72:75], a[12:15], 0
  ds_read_b64_tr_b16 a[88:89], v225 offset:16384
  v_mfma_f32_16x16x32_bf16 v[28:31], a[76:79], a[28:31], v[28:31]
  ds_read_b64_tr_b16 a[90:91], v225 offset:20480
  v_mfma_f32_16x16x32_bf16 v[24:27], a[76:79], a[24:27], 0
  buffer_load_dwordx4 a[32:35], v231, s[4:7], s72 offen offset:2048 sc1
  v_mfma_f32_16x16x32_bf16 v[24:27], a[72:75], a[8:11], v[24:27]
  v_mfma_f32_16x16x32_bf16 v[20:23], a[72:75], a[4:7], 0
  ds_read_b64_tr_b16 a[92:93], v225 offset:24576
  v_mfma_f32_16x16x32_bf16 v[20:23], a[76:79], a[20:23], v[20:23]
  ds_read_b64_tr_b16 a[94:95], v225 offset:28672
  v_mfma_f32_16x16x32_bf16 v[16:19], a[76:79], a[16:19], 0
  buffer_load_dwordx4 a[48:51], v231, s[4:7], s72 offen offset:3072 sc1
  v_mfma_f32_16x16x32_bf16 v[16:19], a[72:75], a[0:3], v[16:19]
  s_add_u32 s72, s72, 4096
  s_waitcnt lgkmcnt(4)
  v_mfma_f32_16x16x32_bf16 v[32:35], a[80:83], a[0:3], 0
  ds_read_b64_tr_b16 a[64:65], v226 offset:0
  v_mfma_f32_16x16x32_bf16 v[32:35], a[84:87], a[16:19], v[32:35]
  ds_read_b64_tr_b16 a[66:67], v226 offset:4096
  v_mfma_f32_16x16x32_bf16 v[36:39], a[84:87], a[20:23], 0
  buffer_load_dwordx4 a[36:39], v231, s[4:7], s73 offen offset:2048 sc1
  v_mfma_f32_16x16x32_bf16 v[36:39], a[80:83], a[4:7], v[36:39]
  v_mfma_f32_16x16x32_bf16 v[40:43], a[80:83], a[8:11], 0
  ds_read_b64_tr_b16 a[68:69], v226 offset:8192
  v_mfma_f32_16x16x32_bf16 v[40:43], a[84:87], a[24:27], v[40:43]
  ds_read_b64_tr_b16 a[70:71], v226 offset:12288
  v_mfma_f32_16x16x32_bf16 v[44:47], a[84:87], a[28:31], 0
  buffer_load_dwordx4 a[52:55], v231, s[4:7], s73 offen offset:3072 sc1
  v_mfma_f32_16x16x32_bf16 v[44:47], a[80:83], a[12:15], v[44:47]
  s_add_u32 s73, s73, 4096
  s_waitcnt lgkmcnt(4)
  v_mfma_f32_16x16x32_bf16 v[60:63], a[88:91], a[12:15], 0
  ds_read_b64_tr_b16 a[72:73], v226 offset:16384
  v_mfma_f32_16x16x32_bf16 v[60:63], a[92:95], a[28:31], v[60:63]
  ds_read_b64_tr_b16 a[74:75], v226 offset:20480
  v_mfma_f32_16x16x32_bf16 v[56:59], a[92:95], a[24:27], 0
  buffer_load_dwordx4 a[40:43], v231, s[4:7], s74 offen offset:2048 sc1
  v_mfma_f32_16x16x32_bf16 v[56:59], a[88:91], a[8:11], v[56:59]
  v_mfma_f32_16x16x32_bf16 v[52:55], a[88:91], a[4:7], 0
  ds_read_b64_tr_b16 a[76:77], v226 offset:24576
  v_mfma_f32_16x16x32_bf16 v[52:55], a[92:95], a[20:23], v[52:55]
  ds_read_b64_tr_b16 a[78:79], v226 offset:28672
  v_mfma_f32_16x16x32_bf16 v[48:51], a[92:95], a[16:19], 0
  buffer_load_dwordx4 a[56:59], v231, s[4:7], s74 offen offset:3072 sc1
  v_mfma_f32_16x16x32_bf16 v[48:51], a[88:91], a[0:3], v[48:51]
  s_add_u32 s74, s74, 4096
  s_waitcnt lgkmcnt(4)
  v_mfma_f32_16x16x32_bf16 v[64:67], a[64:67], a[0:3], 0
  ds_read_b64_tr_b16 a[80:81], v227 offset:0
  v_mfma_f32_16x16x32_bf16 v[64:67], a[68:71], a[16:19], v[64:67]
  ds_read_b64_tr_b16 a[82:83], v227 offset:4096
  v_mfma_f32_16x16x32_bf16 v[68:71], a[68:71], a[20:23], 0
  buffer_load_dwordx4 a[44:47], v231, s[4:7], s75 offen offset:2048 sc1
  v_mfma_f32_16x16x32_bf16 v[68:71], a[64:67], a[4:7], v[68:71]
  v_mfma_f32_16x16x32_bf16 v[72:75], a[64:67], a[8:11], 0
  ds_read_b64_tr_b16 a[84:85], v227 offset:8192
  v_mfma_f32_16x16x32_bf16 v[72:75], a[68:71], a[24:27], v[72:75]
  ds_read_b64_tr_b16 a[86:87], v227 offset:12288
  v_mfma_f32_16x16x32_bf16 v[76:79], a[68:71], a[28:31], 0
  buffer_load_dwordx4 a[60:63], v231, s[4:7], s75 offen offset:3072 sc1
  v_mfma_f32_16x16x32_bf16 v[76:79], a[64:67], a[12:15], v[76:79]
  s_add_u32 s75, s75, 4096
  s_waitcnt lgkmcnt(4)
  v_mfma_f32_16x16x32_bf16 v[92:95], a[72:75], a[12:15], 0
  ds_read_b64_tr_b16 a[88:89], v227 offset:16384
  v_mfma_f32_16x16x32_bf16 v[92:95], a[76:79], a[28:31], v[92:95]
  ds_read_b64_tr_b16 a[90:91], v227 offset:20480
  s_add_u32 m0, s68, 32768
  v_mfma_f32_16x16x32_bf16 v[88:91], a[76:79], a[24:27], 0
  buffer_load_dwordx4 v231, s[4:7], s44 offen offset:0 sc1 lds
  v_mfma_f32_16x16x32_bf16 v[88:91], a[72:75], a[8:11], v[88:91]
  v_mfma_f32_16x16x32_bf16 v[84:87], a[72:75], a[4:7], 0
  ds_read_b64_tr_b16 a[92:93], v227 offset:24576
  v_mfma_f32_16x16x32_bf16 v[84:87], a[76:79], a[20:23], v[84:87]
  ds_read_b64_tr_b16 a[94:95], v227 offset:28672
  v_mfma_f32_16x16x32_bf16 v[80:83], a[76:79], a[16:19], 0
  buffer_load_dwordx4 v231, s[4:7], s44 offen offset:1024 sc1 lds
  v_mfma_f32_16x16x32_bf16 v[80:83], a[72:75], a[0:3], v[80:83]
  s_waitcnt lgkmcnt(4)
  v_mfma_f32_16x16x32_bf16 v[96:99], a[80:83], a[0:3], 0
  ds_read_b64_tr_b16 a[64:65], v228 offset:0
  v_mfma_f32_16x16x32_bf16 v[96:99], a[84:87], a[16:19], v[96:99]
  ds_read_b64_tr_b16 a[66:67], v228 offset:4096
  v_mfma_f32_16x16x32_bf16 v[100:103], a[84:87], a[20:23], 0
  buffer_load_dwordx4 v231, s[4:7], s44 offen offset:2048 sc1 lds
  v_mfma_f32_16x16x32_bf16 v[100:103], a[80:83], a[4:7], v[100:103]
  v_mfma_f32_16x16x32_bf16 v[104:107], a[80:83], a[8:11], 0
  ds_read_b64_tr_b16 a[68:69], v228 offset:8192
  v_mfma_f32_16x16x32_bf16 v[104:107], a[84:87], a[24:27], v[104:107]
  ds_read_b64_tr_b16 a[70:71], v228 offset:12288
  v_mfma_f32_16x16x32_bf16 v[108:111], a[84:87], a[28:31], 0
  buffer_load_dwordx4 v231, s[4:7], s44 offen offset:3072 sc1 lds
  v_mfma_f32_16x16x32_bf16 v[108:111], a[80:83], a[12:15], v[108:111]
  s_waitcnt lgkmcnt(4)
  v_mfma_f32_16x16x32_bf16 v[124:127], a[88:91], a[12:15], 0
  ds_read_b64_tr_b16 a[72:73], v228 offset:16384
  v_mfma_f32_16x16x32_bf16 v[124:127], a[92:95], a[28:31], v[124:127]
  ds_read_b64_tr_b16 a[74:75], v228 offset:20480
  s_add_u32 m0, s68, 49152
  v_mfma_f32_16x16x32_bf16 v[120:123], a[92:95], a[24:27], 0
  buffer_load_dwordx4 v231, s[4:7], s45 offen offset:0 sc1 lds
  v_mfma_f32_16x16x32_bf16 v[120:123], a[88:91], a[8:11], v[120:123]
  v_mfma_f32_16x16x32_bf16 v[116:119], a[88:91], a[4:7], 0
  ds_read_b64_tr_b16 a[76:77], v228 offset:24576
  v_mfma_f32_16x16x32_bf16 v[116:119], a[92:95], a[20:23], v[116:119]
  ds_read_b64_tr_b16 a[78:79], v228 offset:28672
  v_mfma_f32_16x16x32_bf16 v[112:115], a[92:95], a[16:19], 0
  buffer_load_dwordx4 v231, s[4:7], s45 offen offset:1024 sc1 lds
  v_mfma_f32_16x16x32_bf16 v[112:115], a[88:91], a[0:3], v[112:115]
  s_waitcnt lgkmcnt(4)
  v_mfma_f32_16x16x32_bf16 v[128:131], a[64:67], a[0:3], 0
  ds_read_b64_tr_b16 a[80:81], v229 offset:0
  v_mfma_f32_16x16x32_bf16 v[128:131], a[68:71], a[16:19], v[128:131]
  ds_read_b64_tr_b16 a[82:83], v229 offset:4096
  v_mfma_f32_16x16x32_bf16 v[132:135], a[68:71], a[20:23], 0
  buffer_load_dwordx4 v231, s[4:7], s45 offen offset:2048 sc1 lds
  v_mfma_f32_16x16x32_bf16 v[132:135], a[64:67], a[4:7], v[132:135]
  v_mfma_f32_16x16x32_bf16 v[136:139], a[64:67], a[8:11], 0
  ds_read_b64_tr_b16 a[84:85], v229 offset:8192
  v_mfma_f32_16x16x32_bf16 v[136:139], a[68:71], a[24:27], v[136:139]
  ds_read_b64_tr_b16 a[86:87], v229 offset:12288
  v_mfma_f32_16x16x32_bf16 v[140:143], a[68:71], a[28:31], 0
  buffer_load_dwordx4 v231, s[4:7], s45 offen offset:3072 sc1 lds
  v_mfma_f32_16x16x32_bf16 v[140:143], a[64:67], a[12:15], v[140:143]
  s_waitcnt lgkmcnt(4)
  v_mfma_f32_16x16x32_bf16 v[156:159], a[72:75], a[12:15], 0
  ds_read_b64_tr_b16 a[88:89], v229 offset:16384
  v_mfma_f32_16x16x32_bf16 v[156:159], a[76:79], a[28:31], v[156:159]
  ds_read_b64_tr_b16 a[90:91], v229 offset:20480
  s_add_u32 m0, s68, 0
  v_mfma_f32_16x16x32_bf16 v[152:155], a[76:79], a[24:27], 0
  buffer_load_dwordx4 v232, s[16:19], s67 offen offset:0  lds
  v_mfma_f32_16x16x32_bf16 v[152:155], a[72:75], a[8:11], v[152:155]
  v_mfma_f32_16x16x32_bf16 v[148:151], a[72:75], a[4:7], 0
  ds_read_b64_tr_b16 a[92:93], v229 offset:24576
  v_mfma_f32_16x16x32_bf16 v[148:151], a[76:79], a[20:23], v[148:151]
  ds_read_b64_tr_b16 a[94:95], v229 offset:28672
  v_mfma_f32_16x16x32_bf16 v[144:147], a[76:79], a[16:19], 0
  buffer_load_dwordx4 v233, s[16:19], s67 offen offset:1024  lds
  v_mfma_f32_16x16x32_bf16 v[144:147], a[72:75], a[0:3], v[144:147]
  s_waitcnt lgkmcnt(4)
  v_mfma_f32_16x16x32_bf16 v[160:163], a[80:83], a[0:3], 0
  ds_read_b64_tr_b16 a[64:65], v230 offset:0
  v_mfma_f32_16x16x32_bf16 v[160:163], a[84:87], a[16:19], v[160:163]
  ds_read_b64_tr_b16 a[66:67], v230 offset:4096
  v_mfma_f32_16x16x32_bf16 v[164:167], a[84:87], a[20:23], 0
  buffer_load_dwordx4 v234, s[16:19], s67 offen offset:2048  lds
  v_mfma_f32_16x16x32_bf16 v[164:167], a[80:83], a[4:7], v[164:167]
  v_mfma_f32_16x16x32_bf16 v[168:171], a[80:83], a[8:11], 0
  ds_read_b64_tr_b16 a[68:69], v230 offset:8192
  v_mfma_f32_16x16x32_bf16 v[168:171], a[84:87], a[24:27], v[168:171]
  ds_read_b64_tr_b16 a[70:71], v230 offset:12288
  v_mfma_f32_16x16x32_bf16 v[172:175], a[84:87], a[28:31], 0
  buffer_load_dwordx4 v235, s[16:19], s67 offen offset:3072  lds
  v_mfma_f32_16x16x32_bf16 v[172:175], a[80:83], a[12:15], v[172:175]
  s_waitcnt lgkmcnt(4)
  v_mfma_f32_16x16x32_bf16 v[188:191], a[88:91], a[12:15], 0
  ds_read_b64_tr_b16 a[72:73], v230 offset:16384
  v_mfma_f32_16x16x32_bf16 v[188:191], a[92:95], a[28:31], v[188:191]
  ds_read_b64_tr_b16 a[74:75], v230 offset:20480
  s_add_u32 m0, s68, 16384
  v_mfma_f32_16x16x32_bf16 v[184:187], a[92:95], a[24:27], 0
  buffer_load_dwordx4 v232, s[20:23], s67 offen offset:0  lds
  v_mfma_f32_16x16x32_bf16 v[184:187], a[88:91], a[8:11], v[184:187]
  v_mfma_f32_16x16x32_bf16 v[180:183], a[88:91], a[4:7], 0
  ds_read_b64_tr_b16 a[76:77], v230 offset:24576
  v_mfma_f32_16x16x32_bf16 v[180:183], a[92:95], a[20:23], v[180:183]
  ds_read_b64_tr_b16 a[78:79], v230 offset:28672
  v_mfma_f32_16x16x32_bf16 v[176:179], a[92:95], a[16:19], 0
  buffer_load_dwordx4 v233, s[20:23], s67 offen offset:1024  lds
  v_mfma_f32_16x16x32_bf16 v[176:179], a[88:91], a[0:3], v[176:179]
  s_waitcnt lgkmcnt(4)
  v_mfma_f32_16x16x32_bf16 v[192:195], a[64:67], a[0:3], 0
  s_barrier
  ds_read_b64_tr_b16 a[80:81], v224 offset:32768
  v_mfma_f32_16x16x32_bf16 v[192:195], a[68:71], a[16:19], v[192:195]
  ds_read_b64_tr_b16 a[82:83], v224 offset:36864
  v_mfma_f32_16x16x32_bf16 v[196:199], a[68:71], a[20:23], 0
  buffer_load_dwordx4 v234, s[20:23], s67 offen offset:2048  lds
  v_mfma_f32_16x16x32_bf16 v[196:199], a[64:67], a[4:7], v[196:199]
  v_mfma_f32_16x16x32_bf16 v[200:203], a[64:67], a[8:11], 0
  ds_read_b64_tr_b16 a[84:85], v224 offset:40960
  v_mfma_f32_16x16x32_bf16 v[200:203], a[68:71], a[24:27], v[200:203]
  ds_read_b64_tr_b16 a[86:87], v224 offset:45056
  v_mfma_f32_16x16x32_bf16 v[204:207], a[68:71], a[28:31], 0
  buffer_load_dwordx4 v235, s[20:23], s67 offen offset:3072  lds
  v_mfma_f32_16x16x32_bf16 v[204:207], a[64:67], a[12:15], v[204:207]
  s_add_u32 s67, s67, 458752
  s_waitcnt lgkmcnt(4)
  v_mfma_f32_16x16x32_bf16 v[220:223], a[72:75], a[12:15], 0
  ds_read_b64_tr_b16 a[88:89], v224 offset:49152
  v_mfma_f32_16x16x32_bf16 v[220:223], a[76:79], a[28:31], v[220:223]
  ds_read_b64_tr_b16 a[90:91], v224 offset:53248
  v_mfma_f32_16x16x32_bf16 v[216:219], a[76:79], a[24:27], 0
  buffer_load_dwordx4 a[96:99], v236, s[24:27], s70 offen
  v_mfma_f32_16x16x32_bf16 v[216:219], a[72:75], a[8:11], v[216:219]
  s_add_u32 s70, s70, 1024
  v_mfma_f32_16x16x32_bf16 v[212:215], a[72:75], a[4:7], 0
  ds_read_b64_tr_b16 a[92:93], v224 offset:57344
  v_mfma_f32_16x16x32_bf16 v[212:215], a[76:79], a[20:23], v[212:215]
  ds_read_b64_tr_b16 a[94:95], v224 offset:61440
  v_xor_b32 v224, 0x10000, v224
  v_mfma_f32_16x16x32_bf16 v[208:211], a[76:79], a[16:19], 0
  v_mfma_f32_16x16x32_bf16 v[208:211], a[72:75], a[0:3], v[208:211]
Lmk_p3s1:
  s_waitcnt vmcnt(17) lgkmcnt(4)
  v_mfma_f32_16x16x32_bf16 v[0:3], a[80:83], a[32:35], v[0:3]
  ds_read_b64_tr_b16 a[64:65], v225 offset:32768
  s_add_u32 s43, s68, 32768
  v_mfma_f32_16x16x32_bf16 v[0:3], a[84:87], a[48:51], v[0:3]
  ds_read_b64_tr_b16 a[66:67], v225 offset:36864
  v_lshlrev_b32 v250, 3, v253
  v_mfma_f32_16x16x32_bf16 v[4:7], a[84:87], a[52:55], v[4:7]
  buffer_load_dwordx4 a[0:3], v231, s[4:7], s72 offen offset:0 sc1
  v_mfma_f32_16x16x32_bf16 v[4:7], a[80:83], a[36:39], v[4:7]
  v_add_u32 v250, s43, v250
  v_mfma_f32_16x16x32_bf16 v[8:11], a[80:83], a[40:43], v[8:11]
  ds_read_b64_tr_b16 a[68:69], v225 offset:40960
  v_mfma_f32_16x16x32_bf16 v[8:11], a[84:87], a[56:59], v[8:11]
  ds_read_b64_tr_b16 a[70:71], v225 offset:45056
  v_mfma_f32_16x16x32_bf16 v[12:15], a[84:87], a[60:63], v[12:15]
  s_waitcnt vmcnt(10)
  ds_read_b64 v[238:239], v250 offset:0
  ds_read_b64 v[240:241], v250 offset:2048
  v_mfma_f32_16x16x32_bf16 v[12:15], a[80:83], a[44:47], v[12:15]
  s_waitcnt lgkmcnt(6)
  ds_read_b64 v[242:243], v250 offset:16384
  ds_read_b64 v[244:245], v250 offset:18432
  v_mfma_f32_16x16x32_bf16 v[28:31], a[88:91], a[44:47], v[28:31]
  ds_read_b64_tr_b16 a[72:73], v225 offset:49152
  v_mfma_f32_16x16x32_bf16 v[28:31], a[92:95], a[60:63], v[28:31]
  ds_read_b64_tr_b16 a[74:75], v225 offset:53248
  v_mfma_f32_16x16x32_bf16 v[24:27], a[92:95], a[56:59], v[24:27]
  buffer_load_dwordx4 a[16:19], v231, s[4:7], s72 offen offset:1024 sc1
  v_mfma_f32_16x16x32_bf16 v[24:27], a[88:91], a[40:43], v[24:27]
  ds_read_b64 v[246:247], v250 offset:512
  v_mfma_f32_16x16x32_bf16 v[20:23], a[88:91], a[36:39], v[20:23]
  ds_read_b64_tr_b16 a[76:77], v225 offset:57344
  v_mfma_f32_16x16x32_bf16 v[20:23], a[92:95], a[52:55], v[20:23]
  ds_read_b64_tr_b16 a[78:79], v225 offset:61440
  v_xor_b32 v225, 0x10000, v225
  v_mfma_f32_16x16x32_bf16 v[16:19], a[92:95], a[48:51], v[16:19]
  v_mfma_f32_16x16x32_bf16 v[16:19], a[88:91], a[32:35], v[16:19]
  ds_read_b64 v[248:249], v250 offset:2560
  s_waitcnt lgkmcnt(10)
  v_mfma_f32_16x16x32_bf16 v[32:35], a[64:67], a[32:35], v[32:35]
  s_waitcnt lgkmcnt(3)
  ds_read_b64_tr_b16 a[80:81], v226 offset:32768
  v_add_f32 v238, v238, v246
  v_mfma_f32_16x16x32_bf16 v[32:35], a[68:71], a[48:51], v[32:35]
  ds_read_b64_tr_b16 a[82:83], v226 offset:36864
  v_add_f32 v239, v239, v247
  v_mfma_f32_16x16x32_bf16 v[36:39], a[68:71], a[52:55], v[36:39]
  buffer_load_dwordx4 a[4:7], v231, s[4:7], s73 offen offset:0 sc1
  v_mfma_f32_16x16x32_bf16 v[36:39], a[64:67], a[36:39], v[36:39]
  ds_read_b64 v[246:247], v250 offset:16896
  v_mfma_f32_16x16x32_bf16 v[40:43], a[64:67], a[40:43], v[40:43]
  s_waitcnt lgkmcnt(3)
  ds_read_b64_tr_b16 a[84:85], v226 offset:40960
  v_add_f32 v240, v240, v248
  v_mfma_f32_16x16x32_bf16 v[40:43], a[68:71], a[56:59], v[40:43]
  ds_read_b64_tr_b16 a[86:87], v226 offset:45056
  v_add_f32 v241, v241, v249
  v_mfma_f32_16x16x32_bf16 v[44:47], a[68:71], a[60:63], v[44:47]
  buffer_load_dwordx4 a[20:23], v231, s[4:7], s73 offen offset:1024 sc1
  v_mfma_f32_16x16x32_bf16 v[44:47], a[64:67], a[44:47], v[44:47]
  ds_read_b64 v[248:249], v250 offset:18944
  v_mfma_f32_16x16x32_bf16 v[60:63], a[72:75], a[44:47], v[60:63]
  s_waitcnt lgkmcnt(3)
  ds_read_b64_tr_b16 a[88:89], v226 offset:49152
  v_add_f32 v242, v242, v246
  v_mfma_f32_16x16x32_bf16 v[60:63], a[76:79], a[60:63], v[60:63]
  ds_read_b64_tr_b16 a[90:91], v226 offset:53248
  v_add_f32 v243, v243, v247
  v_mfma_f32_16x16x32_bf16 v[56:59], a[76:79], a[56:59], v[56:59]
  v_mfma_f32_16x16x32_bf16 v[56:59], a[72:75], a[40:43], v[56:59]
  ds_read_b64 v[246:247], v250 offset:1024
  v_mfma_f32_16x16x32_bf16 v[52:55], a[72:75], a[36:39], v[52:55]
  s_waitcnt lgkmcnt(3)
  ds_read_b64_tr_b16 a[92:93], v226 offset:57344
  v_add_f32 v244, v244, v248
  v_mfma_f32_16x16x32_bf16 v[52:55], a[76:79], a[52:55], v[52:55]
  ds_read_b64_tr_b16 a[94:95], v226 offset:61440
  v_xor_b32 v226, 0x10000, v226
  v_add_f32 v245, v245, v249
  v_mfma_f32_16x16x32_bf16 v[48:51], a[76:79], a[48:51], v[48:51]
  buffer_load_dwordx4 a[8:11], v231, s[4:7], s74 offen offset:0 sc1
  v_mfma_f32_16x16x32_bf16 v[48:51], a[72:75], a[32:35], v[48:51]
  ds_read_b64 v[248:249], v250 offset:3072
  v_mfma_f32_16x16x32_bf16 v[64:67], a[80:83], a[32:35], v[64:67]
  s_waitcnt lgkmcnt(3)
  ds_read_b64_tr_b16 a[64:65], v227 offset:32768
  v_add_f32 v238, v238, v246
  v_mfma_f32_16x16x32_bf16 v[64:67], a[84:87], a[48:51], v[64:67]
  ds_read_b64_tr_b16 a[66:67], v227 offset:36864
  v_add_f32 v239, v239, v247
  v_mfma_f32_16x16x32_bf16 v[68:71], a[84:87], a[52:55], v[68:71]
  v_mfma_f32_16x16x32_bf16 v[68:71], a[80:83], a[36:39], v[68:71]
  ds_read_b64 v[246:247], v250 offset:17408
  v_mfma_f32_16x16x32_bf16 v[72:75], a[80:83], a[40:43], v[72:75]
  s_waitcnt lgkmcnt(3)
  ds_read_b64_tr_b16 a[68:69], v227 offset:40960
  v_add_f32 v240, v240, v248
  v_mfma_f32_16x16x32_bf16 v[72:75], a[84:87], a[56:59], v[72:75]
  ds_read_b64_tr_b16 a[70:71], v227 offset:45056
  v_add_f32 v241, v241, v249
  v_mfma_f32_16x16x32_bf16 v[76:79], a[84:87], a[60:63], v[76:79]
  buffer_load_dwordx4 a[24:27], v231, s[4:7], s74 offen offset:1024 sc1
  v_mfma_f32_16x16x32_bf16 v[76:79], a[80:83], a[44:47], v[76:79]
  ds_read_b64 v[248:249], v250 offset:19456
  v_mfma_f32_16x16x32_bf16 v[92:95], a[88:91], a[44:47], v[92:95]
  s_waitcnt lgkmcnt(3)
  ds_read_b64_tr_b16 a[72:73], v227 offset:49152
  v_add_f32 v242, v242, v246
  v_mfma_f32_16x16x32_bf16 v[92:95], a[92:95], a[60:63], v[92:95]
  ds_read_b64_tr_b16 a[74:75], v227 offset:53248
  v_add_f32 v243, v243, v247
  v_mfma_f32_16x16x32_bf16 v[88:91], a[92:95], a[56:59], v[88:91]
  buffer_load_dword v237, v251, s[4:7], s48 offen sc1
  v_mfma_f32_16x16x32_bf16 v[88:91], a[88:91], a[40:43], v[88:91]
  ds_read_b64 v[246:247], v250 offset:1536
  v_mfma_f32_16x16x32_bf16 v[84:87], a[88:91], a[36:39], v[84:87]
  s_waitcnt lgkmcnt(3)
  ds_read_b64_tr_b16 a[76:77], v227 offset:57344
  v_add_f32 v244, v244, v248
  v_mfma_f32_16x16x32_bf16 v[84:87], a[92:95], a[52:55], v[84:87]
  ds_read_b64_tr_b16 a[78:79], v227 offset:61440
  v_xor_b32 v227, 0x10000, v227
  v_add_f32 v245, v245, v249
  v_mfma_f32_16x16x32_bf16 v[80:83], a[92:95], a[48:51], v[80:83]
  buffer_load_dwordx4 a[12:15], v231, s[4:7], s75 offen offset:0 sc1
  v_mfma_f32_16x16x32_bf16 v[80:83], a[88:91], a[32:35], v[80:83]
  ds_read_b64 v[248:249], v250 offset:3584
  v_mfma_f32_16x16x32_bf16 v[96:99], a[64:67], a[32:35], v[96:99]
  s_waitcnt lgkmcnt(3)
  ds_read_b64_tr_b16 a[80:81], v228 offset:32768
  v_add_f32 v238, v238, v246
  v_mfma_f32_16x16x32_bf16 v[96:99], a[68:71], a[48:51], v[96:99]
  ds_read_b64_tr_b16 a[82:83], v228 offset:36864
  v_add_f32 v239, v239, v247
  v_mfma_f32_16x16x32_bf16 v[100:103], a[68:71], a[52:55], v[100:103]
  buffer_load_dwordx4 a[96:99], v236, s[24:27], s70 offen
  v_mfma_f32_16x16x32_bf16 v[100:103], a[64:67], a[36:39], v[100:103]
  s_add_u32 s70, s70, 1024
  ds_read_b64 v[246:247], v250 offset:17920
  v_mfma_f32_16x16x32_bf16 v[104:107], a[64:67], a[40:43], v[104:107]
  s_waitcnt lgkmcnt(3)
  ds_read_b64_tr_b16 a[84:85], v228 offset:40960
  v_add_f32 v240, v240, v248
  v_mfma_f32_16x16x32_bf16 v[104:107], a[68:71], a[56:59], v[104:107]
  ds_read_b64_tr_b16 a[86:87], v228 offset:45056
  v_add_f32 v241, v241, v249
  v_mfma_f32_16x16x32_bf16 v[108:111], a[68:71], a[60:63], v[108:111]
  buffer_load_dwordx4 a[28:31], v231, s[4:7], s75 offen offset:1024 sc1
  v_mfma_f32_16x16x32_bf16 v[108:111], a[64:67], a[44:47], v[108:111]
  ds_read_b64 v[248:249], v250 offset:19968
  v_mfma_f32_16x16x32_bf16 v[124:127], a[72:75], a[44:47], v[124:127]
  s_waitcnt lgkmcnt(3)
  ds_read_b64_tr_b16 a[88:89], v228 offset:49152
  v_add_f32 v242, v242, v246
  v_mfma_f32_16x16x32_bf16 v[124:127], a[76:79], a[60:63], v[124:127]
  ds_read_b64_tr_b16 a[90:91], v228 offset:53248
  v_add_f32 v243, v243, v247
  v_mfma_f32_16x16x32_bf16 v[120:123], a[76:79], a[56:59], v[120:123]
  v_mfma_f32_16x16x32_bf16 v[120:123], a[72:75], a[40:43], v[120:123]
  v_mfma_f32_16x16x32_bf16 v[116:119], a[72:75], a[36:39], v[116:119]
  s_waitcnt lgkmcnt(2)
  ds_read_b64_tr_b16 a[92:93], v228 offset:57344
  v_add_f32 v244, v244, v248
  v_mfma_f32_16x16x32_bf16 v[116:119], a[76:79], a[52:55], v[116:119]
  ds_read_b64_tr_b16 a[94:95], v228 offset:61440
  v_xor_b32 v228, 0x10000, v228
  v_mfma_f32_16x16x32_bf16 v[112:115], a[76:79], a[48:51], v[112:115]
  s_mov_b32 s43, 0x3a800000
  v_add_f32 v245, v245, v249
  v_mov_b32 v250, 0x3727c5ac
  v_mfma_f32_16x16x32_bf16 v[112:115], a[72:75], a[32:35], v[112:115]
  v_lshlrev_b32 v246, 2, v253
  v_add_u32 v246, s71, v246
  v_mfma_f32_16x16x32_bf16 v[128:131], a[80:83], a[32:35], v[128:131]
  ds_read_b64_tr_b16 a[64:65], v229 offset:32768
  v_permlane32_swap_b32 v238, v242
  v_mfma_f32_16x16x32_bf16 v[128:131], a[84:87], a[48:51], v[128:131]
  ds_read_b64_tr_b16 a[66:67], v229 offset:36864
  s_add_u32 m0, s68, 32768
  v_mfma_f32_16x16x32_bf16 v[132:135], a[84:87], a[52:55], v[132:135]
  buffer_load_dwordx4 v232, s[16:19], s67 offen offset:0  lds
  v_mfma_f32_16x16x32_bf16 v[132:135], a[80:83], a[36:39], v[132:135]
  v_permlane32_swap_b32 v239, v243
  v_permlane32_swap_b32 v240, v244
  v_mfma_f32_16x16x32_bf16 v[136:139], a[80:83], a[40:43], v[136:139]
  ds_read_b64_tr_b16 a[68:69], v229 offset:40960
  v_permlane32_swap_b32 v241, v245
  v_mfma_f32_16x16x32_bf16 v[136:139], a[84:87], a[56:59], v[136:139]
  ds_read_b64_tr_b16 a[70:71], v229 offset:45056
  v_add_f32 v238, v238, v242
  v_mfma_f32_16x16x32_bf16 v[140:143], a[84:87], a[60:63], v[140:143]
  buffer_load_dwordx4 v233, s[16:19], s67 offen offset:1024  lds
  v_mfma_f32_16x16x32_bf16 v[140:143], a[80:83], a[44:47], v[140:143]
  s_waitcnt lgkmcnt(4)
  v_add_f32 v240, v240, v244
  v_add_f32 v239, v239, v243
  v_mfma_f32_16x16x32_bf16 v[156:159], a[88:91], a[44:47], v[156:159]
  ds_read_b64_tr_b16 a[72:73], v229 offset:49152
  v_add_f32 v241, v241, v245
  v_mfma_f32_16x16x32_bf16 v[156:159], a[92:95], a[60:63], v[156:159]
  ds_read_b64_tr_b16 a[74:75], v229 offset:53248
  v_and_b32 v247, 0xffffff3f, v246
  v_mfma_f32_16x16x32_bf16 v[152:155], a[92:95], a[56:59], v[152:155]
  buffer_load_dwordx4 v234, s[16:19], s67 offen offset:2048  lds
  v_mfma_f32_16x16x32_bf16 v[152:155], a[88:91], a[40:43], v[152:155]
  v_permlane16_swap_b32 v238, v240
  v_permlane16_swap_b32 v239, v241
  v_mfma_f32_16x16x32_bf16 v[148:151], a[88:91], a[36:39], v[148:151]
  ds_read_b64_tr_b16 a[76:77], v229 offset:57344
  v_add_f32 v238, v238, v240
  v_mfma_f32_16x16x32_bf16 v[148:151], a[92:95], a[52:55], v[148:151]
  ds_read_b64_tr_b16 a[78:79], v229 offset:61440
  v_xor_b32 v229, 0x10000, v229
  v_add_f32 v239, v239, v241
  v_mfma_f32_16x16x32_bf16 v[144:147], a[92:95], a[48:51], v[144:147]
  v_add_u32 v247, 1024, v247
  v_mul_f32 v238, 0xba800000, v238
  v_mfma_f32_16x16x32_bf16 v[144:147], a[88:91], a[32:35], v[144:147]
  s_waitcnt lgkmcnt(4)
  v_fma_f32 v239, v239, s43, v250
  v_fma_f32 v239, -v238, v238, v239
  v_mfma_f32_16x16x32_bf16 v[160:163], a[64:67], a[32:35], v[160:163]
  ds_read_b64_tr_b16 a[80:81], v230 offset:32768
  v_max_f32 v239, v239, v250
  v_mfma_f32_16x16x32_bf16 v[160:163], a[68:71], a[48:51], v[160:163]
  ds_read_b64_tr_b16 a[82:83], v230 offset:36864
  v_rsq_f32 v240, v239
  v_mfma_f32_16x16x32_bf16 v[164:167], a[68:71], a[52:55], v[164:167]
  buffer_load_dwordx4 v235, s[16:19], s67 offen offset:3072  lds
  v_mfma_f32_16x16x32_bf16 v[164:167], a[64:67], a[36:39], v[164:167]
  ds_write_b32 v246, v238 offset:1024
  ds_write_b32 v246, v239 offset:1536
  v_mfma_f32_16x16x32_bf16 v[168:171], a[64:67], a[40:43], v[168:171]
  ds_read_b64_tr_b16 a[84:85], v230 offset:40960
  v_mul_f32 v240, 0xbfb8aa3b, v240
  v_mfma_f32_16x16x32_bf16 v[168:171], a[68:71], a[56:59], v[168:171]
  ds_read_b64_tr_b16 a[86:87], v230 offset:45056
  s_add_u32 m0, s68, 49152
  v_mfma_f32_16x16x32_bf16 v[172:175], a[68:71], a[60:63], v[172:175]
  buffer_load_dwordx4 v232, s[20:23], s67 offen offset:0  lds
  v_mfma_f32_16x16x32_bf16 v[172:175], a[64:67], a[44:47], v[172:175]
  s_waitcnt lgkmcnt(6)
  ds_write_b32 v246, v240 offset:1280
  ds_read2_b32 v[238:239], v247 offset0:0 offset1:16
  v_mfma_f32_16x16x32_bf16 v[188:191], a[72:75], a[44:47], v[188:191]
  ds_read_b64_tr_b16 a[88:89], v230 offset:49152
  ds_read2_b32 v[240:241], v247 offset0:32 offset1:48
  v_mfma_f32_16x16x32_bf16 v[188:191], a[76:79], a[60:63], v[188:191]
  ds_read_b64_tr_b16 a[90:91], v230 offset:53248
  v_lshrrev_b32 v250, 3, v253
  v_mfma_f32_16x16x32_bf16 v[184:187], a[76:79], a[56:59], v[184:187]
  v_add_u32 v250, s66, v250
  v_add_u32 v250, -1, v250
  v_mfma_f32_16x16x32_bf16 v[184:187], a[72:75], a[40:43], v[184:187]
  v_bfe_u32 v242, v253, 2, 1
  v_mul_u32_u24 v242, 14336, v242
  v_mfma_f32_16x16x32_bf16 v[180:183], a[72:75], a[36:39], v[180:183]
  ds_read_b64_tr_b16 a[92:93], v230 offset:57344
  v_min_u32 v250, 6, v250
  v_mfma_f32_16x16x32_bf16 v[180:183], a[76:79], a[52:55], v[180:183]
  ds_read_b64_tr_b16 a[94:95], v230 offset:61440
  v_xor_b32 v230, 0x10000, v230
  v_lshl_add_u32 v250, v250, 6, v242
  v_mfma_f32_16x16x32_bf16 v[176:179], a[76:79], a[48:51], v[176:179]
  buffer_load_dwordx4 v233, s[20:23], s67 offen offset:1024  lds
  v_mfma_f32_16x16x32_bf16 v[176:179], a[72:75], a[32:35], v[176:179]
  s_waitcnt lgkmcnt(7)
  v_and_b32 v242, 3, v253
  v_lshl_add_u32 v250, v242, 4, v250
  v_mfma_f32_16x16x32_bf16 v[192:195], a[80:83], a[32:35], v[192:195]
  s_waitcnt vmcnt(17)
  s_barrier
  ds_read_b64_tr_b16 a[64:65], v224 offset:0
  s_waitcnt vmcnt(9)
  v_cmp_gt_u32 vcc, 56, v237
  s_cbranch_vccnz Lchk19_c
Lchk19_r:
  v_mfma_f32_16x16x32_bf16 v[192:195], a[84:87], a[48:51], v[192:195]
  ds_read_b64_tr_b16 a[66:67], v224 offset:4096
  buffer_load_dwordx4 v[242:245], v250, s[4:7], s46 offen sc1
  v_mfma_f32_16x16x32_bf16 v[196:199], a[84:87], a[52:55], v[196:199]
  buffer_load_dwordx4 v[246:249], v250, s[4:7], s47 offen sc1
  v_lshrrev_b32 v237, 4, v253
  v_mfma_f32_16x16x32_bf16 v[196:199], a[80:83], a[36:39], v[196:199]
  v_lshlrev_b32 v237, 4, v237
  v_add_u32 v237, s71, v237
  v_mfma_f32_16x16x32_bf16 v[200:203], a[80:83], a[40:43], v[200:203]
  ds_read_b64_tr_b16 a[68:69], v224 offset:8192
  v_add_u32 v250, s71, v231
  v_mfma_f32_16x16x32_bf16 v[200:203], a[84:87], a[56:59], v[200:203]
  ds_read_b64_tr_b16 a[70:71], v224 offset:12288
  v_mfma_f32_16x16x32_bf16 v[204:207], a[84:87], a[60:63], v[204:207]
  buffer_load_dwordx4 v234, s[20:23], s67 offen offset:2048  lds
  v_mfma_f32_16x16x32_bf16 v[204:207], a[80:83], a[44:47], v[204:207]
  s_waitcnt lgkmcnt(4)
  v_mfma_f32_16x16x32_bf16 v[220:223], a[88:91], a[44:47], v[220:223]
  ds_read_b64_tr_b16 a[72:73], v224 offset:16384
  v_mfma_f32_16x16x32_bf16 v[220:223], a[92:95], a[60:63], v[220:223]
  ds_read_b64_tr_b16 a[74:75], v224 offset:20480
  v_mfma_f32_16x16x32_bf16 v[216:219], a[92:95], a[56:59], v[216:219]
  buffer_load_dwordx4 v235, s[20:23], s67 offen offset:3072  lds
  v_mfma_f32_16x16x32_bf16 v[216:219], a[88:91], a[40:43], v[216:219]
  s_add_u32 s67, s67, 458752
  s_xor_b32 s68, s68, 0x10000
  v_mfma_f32_16x16x32_bf16 v[212:215], a[88:91], a[36:39], v[212:215]
  ds_read_b64_tr_b16 a[76:77], v224 offset:24576
  v_mfma_f32_16x16x32_bf16 v[212:215], a[92:95], a[52:55], v[212:215]
  ds_read_b64_tr_b16 a[78:79], v224 offset:28672
  v_mfma_f32_16x16x32_bf16 v[208:211], a[92:95], a[48:51], v[208:211]
  v_mfma_f32_16x16x32_bf16 v[208:211], a[88:91], a[32:35], v[208:211]
  s_mov_b32 s56, 5
.p2align 3
Lp3_loop:
  s_waitcnt vmcnt(8) lgkmcnt(4)
  v_mfma_f32_16x16x32_bf16 v[0:3], a[64:67], a[0:3], v[0:3]
  ds_read_b64_tr_b16 a[80:81], v225 offset:0
  v_mfma_f32_16x16x32_bf16 v[0:3], a[68:71], a[16:19], v[0:3]
  ds_read_b64_tr_b16 a[82:83], v225 offset:4096
  v_mfma_f32_16x16x32_bf16 v[4:7], a[68:71], a[20:23], v[4:7]
  buffer_load_dwordx4 a[32:35], v231, s[4:7], s72 offen offset:2048 sc1
  v_mfma_f32_16x16x32_bf16 v[4:7], a[64:67], a[4:7], v[4:7]
  v_mfma_f32_16x16x32_bf16 v[8:11], a[64:67], a[8:11], v[8:11]
  ds_read_b64_tr_b16 a[84:85], v225 offset:8192
  v_mfma_f32_16x16x32_bf16 v[8:11], a[68:71], a[24:27], v[8:11]
  ds_read_b64_tr_b16 a[86:87], v225 offset:12288
  v_mfma_f32_16x16x32_bf16 v[12:15], a[68:71], a[28:31], v[12:15]
  v_mfma_f32_16x16x32_bf16 v[12:15], a[64:67], a[12:15], v[12:15]
  s_waitcnt lgkmcnt(4)
  v_mfma_f32_16x16x32_bf16 v[28:31], a[72:75], a[12:15], v[28:31]
  ds_read_b64_tr_b16 a[88:89], v225 offset:16384
  v_mfma_f32_16x16x32_bf16 v[28:31], a[76:79], a[28:31], v[28:31]
  ds_read_b64_tr_b16 a[90:91], v225 offset:20480
  v_mfma_f32_16x16x32_bf16 v[24:27], a[76:79], a[24:27], v[24:27]
  buffer_load_dwordx4 a[48:51], v231, s[4:7], s72 offen offset:3072 sc1
  v_mfma_f32_16x16x32_bf16 v[24:27], a[72:75], a[8:11], v[24:27]
  s_add_u32 s72, s72, 4096
  v_mfma_f32_16x16x32_bf16 v[20:23], a[72:75], a[4:7], v[20:23]
  ds_read_b64_tr_b16 a[92:93], v225 offset:24576
  v_mfma_f32_16x16x32_bf16 v[20:23], a[76:79], a[20:23], v[20:23]
  ds_read_b64_tr_b16 a[94:95], v225 offset:28672
  v_mfma_f32_16x16x32_bf16 v[16:19], a[76:79], a[16:19], v[16:19]
  v_mfma_f32_16x16x32_bf16 v[16:19], a[72:75], a[0:3], v[16:19]
  s_waitcnt lgkmcnt(4)
  v_mfma_f32_16x16x32_bf16 v[32:35], a[80:83], a[0:3], v[32:35]
  ds_read_b64_tr_b16 a[64:65], v226 offset:0
  v_mfma_f32_16x16x32_bf16 v[32:35], a[84:87], a[16:19], v[32:35]
  ds_read_b64_tr_b16 a[66:67], v226 offset:4096
  v_mfma_f32_16x16x32_bf16 v[36:39], a[84:87], a[20:23], v[36:39]
  buffer_load_dwordx4 a[36:39], v231, s[4:7], s73 offen offset:2048 sc1
  v_mfma_f32_16x16x32_bf16 v[36:39], a[80:83], a[4:7], v[36:39]
  v_mfma_f32_16x16x32_bf16 v[40:43], a[80:83], a[8:11], v[40:43]
  ds_read_b64_tr_b16 a[68:69], v226 offset:8192
  v_mfma_f32_16x16x32_bf16 v[40:43], a[84:87], a[24:27], v[40:43]
  ds_read_b64_tr_b16 a[70:71], v226 offset:12288
  v_mfma_f32_16x16x32_bf16 v[44:47], a[84:87], a[28:31], v[44:47]
  buffer_load_dwordx4 a[52:55], v231, s[4:7], s73 offen offset:3072 sc1
  v_mfma_f32_16x16x32_bf16 v[44:47], a[80:83], a[12:15], v[44:47]
  s_add_u32 s73, s73, 4096
  s_waitcnt lgkmcnt(4)
  v_mfma_f32_16x16x32_bf16 v[60:63], a[88:91], a[12:15], v[60:63]
  ds_read_b64_tr_b16 a[72:73], v226 offset:16384
  v_mfma_f32_16x16x32_bf16 v[60:63], a[92:95], a[28:31], v[60:63]
  ds_read_b64_tr_b16 a[74:75], v226 offset:20480
  v_mfma_f32_16x16x32_bf16 v[56:59], a[92:95], a[24:27], v[56:59]
  v_mfma_f32_16x16x32_bf16 v[56:59], a[88:91], a[8:11], v[56:59]
  v_mfma_f32_16x16x32_bf16 v[52:55], a[88:91], a[4:7], v[52:55]
  ds_read_b64_tr_b16 a[76:77], v226 offset:24576
  v_mfma_f32_16x16x32_bf16 v[52:55], a[92:95], a[20:23], v[52:55]
  ds_read_b64_tr_b16 a[78:79], v226 offset:28672
  v_mfma_f32_16x16x32_bf16 v[48:51], a[92:95], a[16:19], v[48:51]
  buffer_load_dwordx4 a[40:43], v231, s[4:7], s74 offen offset:2048 sc1
  v_mfma_f32_16x16x32_bf16 v[48:51], a[88:91], a[0:3], v[48:51]
  s_waitcnt lgkmcnt(4)
  v_mfma_f32_16x16x32_bf16 v[64:67], a[64:67], a[0:3], v[64:67]
  ds_read_b64_tr_b16 a[80:81], v227 offset:0
  v_mfma_f32_16x16x32_bf16 v[64:67], a[68:71], a[16:19], v[64:67]
  ds_read_b64_tr_b16 a[82:83], v227 offset:4096
  v_mfma_f32_16x16x32_bf16 v[68:71], a[68:71], a[20:23], v[68:71]
  v_mfma_f32_16x16x32_bf16 v[68:71], a[64:67], a[4:7], v[68:71]
  v_mfma_f32_16x16x32_bf16 v[72:75], a[64:67], a[8:11], v[72:75]
  ds_read_b64_tr_b16 a[84:85], v227 offset:8192
  v_mfma_f32_16x16x32_bf16 v[72:75], a[68:71], a[24:27], v[72:75]
  ds_read_b64_tr_b16 a[86:87], v227 offset:12288
  v_mfma_f32_16x16x32_bf16 v[76:79], a[68:71], a[28:31], v[76:79]
  buffer_load_dwordx4 a[56:59], v231, s[4:7], s74 offen offset:3072 sc1
  v_mfma_f32_16x16x32_bf16 v[76:79], a[64:67], a[12:15], v[76:79]
  s_add_u32 s74, s74, 4096
  s_waitcnt lgkmcnt(4)
  v_mfma_f32_16x16x32_bf16 v[92:95], a[72:75], a[12:15], v[92:95]
  ds_read_b64_tr_b16 a[88:89], v227 offset:16384
  v_mfma_f32_16x16x32_bf16 v[92:95], a[76:79], a[28:31], v[92:95]
  ds_read_b64_tr_b16 a[90:91], v227 offset:20480
  v_mfma_f32_16x16x32_bf16 v[88:91], a[76:79], a[24:27], v[88:91]
  v_mfma_f32_16x16x32_bf16 v[88:91], a[72:75], a[8:11], v[88:91]
  v_mfma_f32_16x16x32_bf16 v[84:87], a[72:75], a[4:7], v[84:87]
  ds_read_b64_tr_b16 a[92:93], v227 offset:24576
  v_mfma_f32_16x16x32_bf16 v[84:87], a[76:79], a[20:23], v[84:87]
  ds_read_b64_tr_b16 a[94:95], v227 offset:28672
  v_mfma_f32_16x16x32_bf16 v[80:83], a[76:79], a[16:19], v[80:83]
  buffer_load_dwordx4 a[44:47], v231, s[4:7], s75 offen offset:2048 sc1
  v_mfma_f32_16x16x32_bf16 v[80:83], a[72:75], a[0:3], v[80:83]
  s_waitcnt lgkmcnt(4)
  v_mfma_f32_16x16x32_bf16 v[96:99], a[80:83], a[0:3], v[96:99]
  ds_read_b64_tr_b16 a[64:65], v228 offset:0
  v_mfma_f32_16x16x32_bf16 v[96:99], a[84:87], a[16:19], v[96:99]
  ds_read_b64_tr_b16 a[66:67], v228 offset:4096
  v_mfma_f32_16x16x32_bf16 v[100:103], a[84:87], a[20:23], v[100:103]
  buffer_load_dwordx4 a[96:99], v236, s[24:27], s70 offen
  v_mfma_f32_16x16x32_bf16 v[100:103], a[80:83], a[4:7], v[100:103]
  s_add_u32 s70, s70, 1024
  v_mfma_f32_16x16x32_bf16 v[104:107], a[80:83], a[8:11], v[104:107]
  ds_read_b64_tr_b16 a[68:69], v228 offset:8192
  v_mfma_f32_16x16x32_bf16 v[104:107], a[84:87], a[24:27], v[104:107]
  ds_read_b64_tr_b16 a[70:71], v228 offset:12288
  v_mfma_f32_16x16x32_bf16 v[108:111], a[84:87], a[28:31], v[108:111]
  buffer_load_dwordx4 a[60:63], v231, s[4:7], s75 offen offset:3072 sc1
  v_mfma_f32_16x16x32_bf16 v[108:111], a[80:83], a[12:15], v[108:111]
  s_add_u32 s75, s75, 4096
  s_waitcnt lgkmcnt(4)
  v_mfma_f32_16x16x32_bf16 v[124:127], a[88:91], a[12:15], v[124:127]
  ds_read_b64_tr_b16 a[72:73], v228 offset:16384
  v_mfma_f32_16x16x32_bf16 v[124:127], a[92:95], a[28:31], v[124:127]
  ds_read_b64_tr_b16 a[74:75], v228 offset:20480
  s_add_u32 m0, s68, 0
  v_mfma_f32_16x16x32_bf16 v[120:123], a[92:95], a[24:27], v[120:123]
  buffer_load_dwordx4 v232, s[16:19], s67 offen offset:0  lds
  v_mfma_f32_16x16x32_bf16 v[120:123], a[88:91], a[8:11], v[120:123]
  v_mfma_f32_16x16x32_bf16 v[116:119], a[88:91], a[4:7], v[116:119]
  ds_read_b64_tr_b16 a[76:77], v228 offset:24576
  v_mfma_f32_16x16x32_bf16 v[116:119], a[92:95], a[20:23], v[116:119]
  ds_read_b64_tr_b16 a[78:79], v228 offset:28672
  v_mfma_f32_16x16x32_bf16 v[112:115], a[92:95], a[16:19], v[112:115]
  v_mfma_f32_16x16x32_bf16 v[112:115], a[88:91], a[0:3], v[112:115]
  s_waitcnt lgkmcnt(4)
  v_mfma_f32_16x16x32_bf16 v[128:131], a[64:67], a[0:3], v[128:131]
  ds_read_b64_tr_b16 a[80:81], v229 offset:0
  v_mfma_f32_16x16x32_bf16 v[128:131], a[68:71], a[16:19], v[128:131]
  ds_read_b64_tr_b16 a[82:83], v229 offset:4096
  v_mfma_f32_16x16x32_bf16 v[132:135], a[68:71], a[20:23], v[132:135]
  buffer_load_dwordx4 v233, s[16:19], s67 offen offset:1024  lds
  v_mfma_f32_16x16x32_bf16 v[132:135], a[64:67], a[4:7], v[132:135]
  v_mfma_f32_16x16x32_bf16 v[136:139], a[64:67], a[8:11], v[136:139]
  ds_read_b64_tr_b16 a[84:85], v229 offset:8192
  v_mfma_f32_16x16x32_bf16 v[136:139], a[68:71], a[24:27], v[136:139]
  ds_read_b64_tr_b16 a[86:87], v229 offset:12288
  v_mfma_f32_16x16x32_bf16 v[140:143], a[68:71], a[28:31], v[140:143]
  v_mfma_f32_16x16x32_bf16 v[140:143], a[64:67], a[12:15], v[140:143]
  s_waitcnt lgkmcnt(4)
  v_mfma_f32_16x16x32_bf16 v[156:159], a[72:75], a[12:15], v[156:159]
  ds_read_b64_tr_b16 a[88:89], v229 offset:16384
  v_mfma_f32_16x16x32_bf16 v[156:159], a[76:79], a[28:31], v[156:159]
  ds_read_b64_tr_b16 a[90:91], v229 offset:20480
  v_mfma_f32_16x16x32_bf16 v[152:155], a[76:79], a[24:27], v[152:155]
  buffer_load_dwordx4 v234, s[16:19], s67 offen offset:2048  lds
  v_mfma_f32_16x16x32_bf16 v[152:155], a[72:75], a[8:11], v[152:155]
  v_mfma_f32_16x16x32_bf16 v[148:151], a[72:75], a[4:7], v[148:151]
  ds_read_b64_tr_b16 a[92:93], v229 offset:24576
  v_mfma_f32_16x16x32_bf16 v[148:151], a[76:79], a[20:23], v[148:151]
  ds_read_b64_tr_b16 a[94:95], v229 offset:28672
  v_mfma_f32_16x16x32_bf16 v[144:147], a[76:79], a[16:19], v[144:147]
  buffer_load_dwordx4 v235, s[16:19], s67 offen offset:3072  lds
  v_mfma_f32_16x16x32_bf16 v[144:147], a[72:75], a[0:3], v[144:147]
  s_waitcnt lgkmcnt(4)
  v_mfma_f32_16x16x32_bf16 v[160:163], a[80:83], a[0:3], v[160:163]
  ds_read_b64_tr_b16 a[64:65], v230 offset:0
  v_mfma_f32_16x16x32_bf16 v[160:163], a[84:87], a[16:19], v[160:163]
  ds_read_b64_tr_b16 a[66:67], v230 offset:4096
  v_mfma_f32_16x16x32_bf16 v[164:167], a[84:87], a[20:23], v[164:167]
  v_mfma_f32_16x16x32_bf16 v[164:167], a[80:83], a[4:7], v[164:167]
  v_mfma_f32_16x16x32_bf16 v[168:171], a[80:83], a[8:11], v[168:171]
  ds_read_b64_tr_b16 a[68:69], v230 offset:8192
  v_mfma_f32_16x16x32_bf16 v[168:171], a[84:87], a[24:27], v[168:171]
  ds_read_b64_tr_b16 a[70:71], v230 offset:12288
  s_add_u32 m0, s68, 16384
  v_mfma_f32_16x16x32_bf16 v[172:175], a[84:87], a[28:31], v[172:175]
  buffer_load_dwordx4 v232, s[20:23], s67 offen offset:0  lds
  v_mfma_f32_16x16x32_bf16 v[172:175], a[80:83], a[12:15], v[172:175]
  s_waitcnt lgkmcnt(4)
  v_mfma_f32_16x16x32_bf16 v[188:191], a[88:91], a[12:15], v[188:191]
  ds_read_b64_tr_b16 a[72:73], v230 offset:16384
  v_mfma_f32_16x16x32_bf16 v[188:191], a[92:95], a[28:31], v[188:191]
  ds_read_b64_tr_b16 a[74:75], v230 offset:20480
  v_mfma_f32_16x16x32_bf16 v[184:187], a[92:95], a[24:27], v[184:187]
  v_mfma_f32_16x16x32_bf16 v[184:187], a[88:91], a[8:11], v[184:187]
  v_mfma_f32_16x16x32_bf16 v[180:183], a[88:91], a[4:7], v[180:183]
  ds_read_b64_tr_b16 a[76:77], v230 offset:24576
  v_mfma_f32_16x16x32_bf16 v[180:183], a[92:95], a[20:23], v[180:183]
  ds_read_b64_tr_b16 a[78:79], v230 offset:28672
  v_mfma_f32_16x16x32_bf16 v[176:179], a[92:95], a[16:19], v[176:179]
  buffer_load_dwordx4 v233, s[20:23], s67 offen offset:1024  lds
  v_mfma_f32_16x16x32_bf16 v[176:179], a[88:91], a[0:3], v[176:179]
  s_waitcnt lgkmcnt(4)
  v_mfma_f32_16x16x32_bf16 v[192:195], a[64:67], a[0:3], v[192:195]
  s_waitcnt vmcnt(15)
  s_barrier
  ds_read_b64_tr_b16 a[80:81], v224 offset:32768
  v_mfma_f32_16x16x32_bf16 v[192:195], a[68:71], a[16:19], v[192:195]
  ds_read_b64_tr_b16 a[82:83], v224 offset:36864
  v_mfma_f32_16x16x32_bf16 v[196:199], a[68:71], a[20:23], v[196:199]
  v_mfma_f32_16x16x32_bf16 v[196:199], a[64:67], a[4:7], v[196:199]
  v_mfma_f32_16x16x32_bf16 v[200:203], a[64:67], a[8:11], v[200:203]
  ds_read_b64_tr_b16 a[84:85], v224 offset:40960
  v_mfma_f32_16x16x32_bf16 v[200:203], a[68:71], a[24:27], v[200:203]
  ds_read_b64_tr_b16 a[86:87], v224 offset:45056
  v_mfma_f32_16x16x32_bf16 v[204:207], a[68:71], a[28:31], v[204:207]
  buffer_load_dwordx4 v234, s[20:23], s67 offen offset:2048  lds
  v_mfma_f32_16x16x32_bf16 v[204:207], a[64:67], a[12:15], v[204:207]
  s_waitcnt lgkmcnt(4)
  v_mfma_f32_16x16x32_bf16 v[220:223], a[72:75], a[12:15], v[220:223]
  ds_read_b64_tr_b16 a[88:89], v224 offset:49152
  v_mfma_f32_16x16x32_bf16 v[220:223], a[76:79], a[28:31], v[220:223]
  ds_read_b64_tr_b16 a[90:91], v224 offset:53248
  v_mfma_f32_16x16x32_bf16 v[216:219], a[76:79], a[24:27], v[216:219]
  buffer_load_dwordx4 v235, s[20:23], s67 offen offset:3072  lds
  v_mfma_f32_16x16x32_bf16 v[216:219], a[72:75], a[8:11], v[216:219]
  s_add_u32 s67, s67, 458752
  v_mfma_f32_16x16x32_bf16 v[212:215], a[72:75], a[4:7], v[212:215]
  ds_read_b64_tr_b16 a[92:93], v224 offset:57344
  v_mfma_f32_16x16x32_bf16 v[212:215], a[76:79], a[20:23], v[212:215]
  ds_read_b64_tr_b16 a[94:95], v224 offset:61440
  v_xor_b32 v224, 0x10000, v224
  v_mfma_f32_16x16x32_bf16 v[208:211], a[76:79], a[16:19], v[208:211]
  v_mfma_f32_16x16x32_bf16 v[208:211], a[72:75], a[0:3], v[208:211]
  s_waitcnt vmcnt(8) lgkmcnt(4)
  v_mfma_f32_16x16x32_bf16 v[0:3], a[80:83], a[32:35], v[0:3]
  ds_read_b64_tr_b16 a[64:65], v225 offset:32768
  v_mfma_f32_16x16x32_bf16 v[0:3], a[84:87], a[48:51], v[0:3]
  ds_read_b64_tr_b16 a[66:67], v225 offset:36864
  v_mfma_f32_16x16x32_bf16 v[4:7], a[84:87], a[52:55], v[4:7]
  buffer_load_dwordx4 a[0:3], v231, s[4:7], s72 offen offset:0 sc1
  v_mfma_f32_16x16x32_bf16 v[4:7], a[80:83], a[36:39], v[4:7]
  v_mfma_f32_16x16x32_bf16 v[8:11], a[80:83], a[40:43], v[8:11]
  ds_read_b64_tr_b16 a[68:69], v225 offset:40960
  v_mfma_f32_16x16x32_bf16 v[8:11], a[84:87], a[56:59], v[8:11]
  ds_read_b64_tr_b16 a[70:71], v225 offset:45056
  v_mfma_f32_16x16x32_bf16 v[12:15], a[84:87], a[60:63], v[12:15]
  v_mfma_f32_16x16x32_bf16 v[12:15], a[80:83], a[44:47], v[12:15]
  s_waitcnt lgkmcnt(4)
  v_mfma_f32_16x16x32_bf16 v[28:31], a[88:91], a[44:47], v[28:31]
  ds_read_b64_tr_b16 a[72:73], v225 offset:49152
  v_mfma_f32_16x16x32_bf16 v[28:31], a[92:95], a[60:63], v[28:31]
  ds_read_b64_tr_b16 a[74:75], v225 offset:53248
  v_mfma_f32_16x16x32_bf16 v[24:27], a[92:95], a[56:59], v[24:27]
  buffer_load_dwordx4 a[16:19], v231, s[4:7], s72 offen offset:1024 sc1
  v_mfma_f32_16x16x32_bf16 v[24:27], a[88:91], a[40:43], v[24:27]
  v_mfma_f32_16x16x32_bf16 v[20:23], a[88:91], a[36:39], v[20:23]
  ds_read_b64_tr_b16 a[76:77], v225 offset:57344
  v_mfma_f32_16x16x32_bf16 v[20:23], a[92:95], a[52:55], v[20:23]
  ds_read_b64_tr_b16 a[78:79], v225 offset:61440
  v_xor_b32 v225, 0x10000, v225
  v_mfma_f32_16x16x32_bf16 v[16:19], a[92:95], a[48:51], v[16:19]
  v_mfma_f32_16x16x32_bf16 v[16:19], a[88:91], a[32:35], v[16:19]
  s_waitcnt lgkmcnt(4)
  v_mfma_f32_16x16x32_bf16 v[32:35], a[64:67], a[32:35], v[32:35]
  ds_read_b64_tr_b16 a[80:81], v226 offset:32768
  v_mfma_f32_16x16x32_bf16 v[32:35], a[68:71], a[48:51], v[32:35]
  ds_read_b64_tr_b16 a[82:83], v226 offset:36864
  v_mfma_f32_16x16x32_bf16 v[36:39], a[68:71], a[52:55], v[36:39]
  buffer_load_dwordx4 a[4:7], v231, s[4:7], s73 offen offset:0 sc1
  v_mfma_f32_16x16x32_bf16 v[36:39], a[64:67], a[36:39], v[36:39]
  v_mfma_f32_16x16x32_bf16 v[40:43], a[64:67], a[40:43], v[40:43]
  ds_read_b64_tr_b16 a[84:85], v226 offset:40960
  v_mfma_f32_16x16x32_bf16 v[40:43], a[68:71], a[56:59], v[40:43]
  ds_read_b64_tr_b16 a[86:87], v226 offset:45056
  v_mfma_f32_16x16x32_bf16 v[44:47], a[68:71], a[60:63], v[44:47]
  buffer_load_dwordx4 a[20:23], v231, s[4:7], s73 offen offset:1024 sc1
  v_mfma_f32_16x16x32_bf16 v[44:47], a[64:67], a[44:47], v[44:47]
  s_waitcnt lgkmcnt(4)
  v_mfma_f32_16x16x32_bf16 v[60:63], a[72:75], a[44:47], v[60:63]
  ds_read_b64_tr_b16 a[88:89], v226 offset:49152
  v_mfma_f32_16x16x32_bf16 v[60:63], a[76:79], a[60:63], v[60:63]
  ds_read_b64_tr_b16 a[90:91], v226 offset:53248
  v_mfma_f32_16x16x32_bf16 v[56:59], a[76:79], a[56:59], v[56:59]
  v_mfma_f32_16x16x32_bf16 v[56:59], a[72:75], a[40:43], v[56:59]
  v_mfma_f32_16x16x32_bf16 v[52:55], a[72:75], a[36:39], v[52:55]
  ds_read_b64_tr_b16 a[92:93], v226 offset:57344
  v_mfma_f32_16x16x32_bf16 v[52:55], a[76:79], a[52:55], v[52:55]
  ds_read_b64_tr_b16 a[94:95], v226 offset:61440
  v_xor_b32 v226, 0x10000, v226
  v_mfma_f32_16x16x32_bf16 v[48:51], a[76:79], a[48:51], v[48:51]
  buffer_load_dwordx4 a[8:11], v231, s[4:7], s74 offen offset:0 sc1
  v_mfma_f32_16x16x32_bf16 v[48:51], a[72:75], a[32:35], v[48:51]
  s_waitcnt lgkmcnt(4)
  v_mfma_f32_16x16x32_bf16 v[64:67], a[80:83], a[32:35], v[64:67]
  ds_read_b64_tr_b16 a[64:65], v227 offset:32768
  v_mfma_f32_16x16x32_bf16 v[64:67], a[84:87], a[48:51], v[64:67]
  ds_read_b64_tr_b16 a[66:67], v227 offset:36864
  v_mfma_f32_16x16x32_bf16 v[68:71], a[84:87], a[52:55], v[68:71]
  v_mfma_f32_16x16x32_bf16 v[68:71], a[80:83], a[36:39], v[68:71]
  v_mfma_f32_16x16x32_bf16 v[72:75], a[80:83], a[40:43], v[72:75]
  ds_read_b64_tr_b16 a[68:69], v227 offset:40960
  v_mfma_f32_16x16x32_bf16 v[72:75], a[84:87], a[56:59], v[72:75]
  ds_read_b64_tr_b16 a[70:71], v227 offset:45056
  v_mfma_f32_16x16x32_bf16 v[76:79], a[84:87], a[60:63], v[76:79]
  buffer_load_dwordx4 a[24:27], v231, s[4:7], s74 offen offset:1024 sc1
  v_mfma_f32_16x16x32_bf16 v[76:79], a[80:83], a[44:47], v[76:79]
  s_waitcnt lgkmcnt(4)
  v_mfma_f32_16x16x32_bf16 v[92:95], a[88:91], a[44:47], v[92:95]
  ds_read_b64_tr_b16 a[72:73], v227 offset:49152
  v_mfma_f32_16x16x32_bf16 v[92:95], a[92:95], a[60:63], v[92:95]
  ds_read_b64_tr_b16 a[74:75], v227 offset:53248
  v_mfma_f32_16x16x32_bf16 v[88:91], a[92:95], a[56:59], v[88:91]
  v_mfma_f32_16x16x32_bf16 v[88:91], a[88:91], a[40:43], v[88:91]
  v_mfma_f32_16x16x32_bf16 v[84:87], a[88:91], a[36:39], v[84:87]
  ds_read_b64_tr_b16 a[76:77], v227 offset:57344
  v_mfma_f32_16x16x32_bf16 v[84:87], a[92:95], a[52:55], v[84:87]
  ds_read_b64_tr_b16 a[78:79], v227 offset:61440
  v_xor_b32 v227, 0x10000, v227
  v_mfma_f32_16x16x32_bf16 v[80:83], a[92:95], a[48:51], v[80:83]
  buffer_load_dwordx4 a[12:15], v231, s[4:7], s75 offen offset:0 sc1
  v_mfma_f32_16x16x32_bf16 v[80:83], a[88:91], a[32:35], v[80:83]
  s_waitcnt lgkmcnt(4)
  v_mfma_f32_16x16x32_bf16 v[96:99], a[64:67], a[32:35], v[96:99]
  ds_read_b64_tr_b16 a[80:81], v228 offset:32768
  v_mfma_f32_16x16x32_bf16 v[96:99], a[68:71], a[48:51], v[96:99]
  ds_read_b64_tr_b16 a[82:83], v228 offset:36864
  v_mfma_f32_16x16x32_bf16 v[100:103], a[68:71], a[52:55], v[100:103]
  v_mfma_f32_16x16x32_bf16 v[100:103], a[64:67], a[36:39], v[100:103]
  v_mfma_f32_16x16x32_bf16 v[104:107], a[64:67], a[40:43], v[104:107]
  ds_read_b64_tr_b16 a[84:85], v228 offset:40960
  v_mfma_f32_16x16x32_bf16 v[104:107], a[68:71], a[56:59], v[104:107]
  ds_read_b64_tr_b16 a[86:87], v228 offset:45056
  v_mfma_f32_16x16x32_bf16 v[108:111], a[68:71], a[60:63], v[108:111]
  buffer_load_dwordx4 a[28:31], v231, s[4:7], s75 offen offset:1024 sc1
  v_mfma_f32_16x16x32_bf16 v[108:111], a[64:67], a[44:47], v[108:111]
  s_waitcnt lgkmcnt(4)
  v_mfma_f32_16x16x32_bf16 v[124:127], a[72:75], a[44:47], v[124:127]
  ds_read_b64_tr_b16 a[88:89], v228 offset:49152
  v_mfma_f32_16x16x32_bf16 v[124:127], a[76:79], a[60:63], v[124:127]
  ds_read_b64_tr_b16 a[90:91], v228 offset:53248
  s_add_u32 m0, s68, 32768
  v_mfma_f32_16x16x32_bf16 v[120:123], a[76:79], a[56:59], v[120:123]
  buffer_load_dwordx4 v232, s[16:19], s67 offen offset:0  lds
  v_mfma_f32_16x16x32_bf16 v[120:123], a[72:75], a[40:43], v[120:123]
  v_mfma_f32_16x16x32_bf16 v[116:119], a[72:75], a[36:39], v[116:119]
  ds_read_b64_tr_b16 a[92:93], v228 offset:57344
  v_mfma_f32_16x16x32_bf16 v[116:119], a[76:79], a[52:55], v[116:119]
  ds_read_b64_tr_b16 a[94:95], v228 offset:61440
  v_xor_b32 v228, 0x10000, v228
  v_mfma_f32_16x16x32_bf16 v[112:115], a[76:79], a[48:51], v[112:115]
  v_mfma_f32_16x16x32_bf16 v[112:115], a[72:75], a[32:35], v[112:115]
  s_waitcnt lgkmcnt(4)
  v_mfma_f32_16x16x32_bf16 v[128:131], a[80:83], a[32:35], v[128:131]
  ds_read_b64_tr_b16 a[64:65], v229 offset:32768
  v_mfma_f32_16x16x32_bf16 v[128:131], a[84:87], a[48:51], v[128:131]
  ds_read_b64_tr_b16 a[66:67], v229 offset:36864
  v_mfma_f32_16x16x32_bf16 v[132:135], a[84:87], a[52:55], v[132:135]
  buffer_load_dwordx4 v233, s[16:19], s67 offen offset:1024  lds
  v_mfma_f32_16x16x32_bf16 v[132:135], a[80:83], a[36:39], v[132:135]
  v_mfma_f32_16x16x32_bf16 v[136:139], a[80:83], a[40:43], v[136:139]
  ds_read_b64_tr_b16 a[68:69], v229 offset:40960
  v_mfma_f32_16x16x32_bf16 v[136:139], a[84:87], a[56:59], v[136:139]
  ds_read_b64_tr_b16 a[70:71], v229 offset:45056
  v_mfma_f32_16x16x32_bf16 v[140:143], a[84:87], a[60:63], v[140:143]
  v_mfma_f32_16x16x32_bf16 v[140:143], a[80:83], a[44:47], v[140:143]
  s_waitcnt lgkmcnt(4)
  v_mfma_f32_16x16x32_bf16 v[156:159], a[88:91], a[44:47], v[156:159]
  ds_read_b64_tr_b16 a[72:73], v229 offset:49152
  v_mfma_f32_16x16x32_bf16 v[156:159], a[92:95], a[60:63], v[156:159]
  ds_read_b64_tr_b16 a[74:75], v229 offset:53248
  v_mfma_f32_16x16x32_bf16 v[152:155], a[92:95], a[56:59], v[152:155]
  buffer_load_dwordx4 v234, s[16:19], s67 offen offset:2048  lds
  v_mfma_f32_16x16x32_bf16 v[152:155], a[88:91], a[40:43], v[152:155]
  v_mfma_f32_16x16x32_bf16 v[148:151], a[88:91], a[36:39], v[148:151]
  ds_read_b64_tr_b16 a[76:77], v229 offset:57344
  v_mfma_f32_16x16x32_bf16 v[148:151], a[92:95], a[52:55], v[148:151]
  ds_read_b64_tr_b16 a[78:79], v229 offset:61440
  v_xor_b32 v229, 0x10000, v229
  v_mfma_f32_16x16x32_bf16 v[144:147], a[92:95], a[48:51], v[144:147]
  buffer_load_dwordx4 v235, s[16:19], s67 offen offset:3072  lds
  v_mfma_f32_16x16x32_bf16 v[144:147], a[88:91], a[32:35], v[144:147]
  s_waitcnt lgkmcnt(4)
  v_mfma_f32_16x16x32_bf16 v[160:163], a[64:67], a[32:35], v[160:163]
  ds_read_b64_tr_b16 a[80:81], v230 offset:32768
  v_mfma_f32_16x16x32_bf16 v[160:163], a[68:71], a[48:51], v[160:163]
  ds_read_b64_tr_b16 a[82:83], v230 offset:36864
  v_mfma_f32_16x16x32_bf16 v[164:167], a[68:71], a[52:55], v[164:167]
  v_mfma_f32_16x16x32_bf16 v[164:167], a[64:67], a[36:39], v[164:167]
  v_mfma_f32_16x16x32_bf16 v[168:171], a[64:67], a[40:43], v[168:171]
  ds_read_b64_tr_b16 a[84:85], v230 offset:40960
  v_mfma_f32_16x16x32_bf16 v[168:171], a[68:71], a[56:59], v[168:171]
  ds_read_b64_tr_b16 a[86:87], v230 offset:45056
  s_add_u32 m0, s68, 49152
  v_mfma_f32_16x16x32_bf16 v[172:175], a[68:71], a[60:63], v[172:175]
  buffer_load_dwordx4 v232, s[20:23], s67 offen offset:0  lds
  v_mfma_f32_16x16x32_bf16 v[172:175], a[64:67], a[44:47], v[172:175]
  s_waitcnt lgkmcnt(4)
  v_mfma_f32_16x16x32_bf16 v[188:191], a[72:75], a[44:47], v[188:191]
  ds_read_b64_tr_b16 a[88:89], v230 offset:49152
  v_mfma_f32_16x16x32_bf16 v[188:191], a[76:79], a[60:63], v[188:191]
  ds_read_b64_tr_b16 a[90:91], v230 offset:53248
  v_mfma_f32_16x16x32_bf16 v[184:187], a[76:79], a[56:59], v[184:187]
  v_mfma_f32_16x16x32_bf16 v[184:187], a[72:75], a[40:43], v[184:187]
  v_mfma_f32_16x16x32_bf16 v[180:183], a[72:75], a[36:39], v[180:183]
  ds_read_b64_tr_b16 a[92:93], v230 offset:57344
  v_mfma_f32_16x16x32_bf16 v[180:183], a[76:79], a[52:55], v[180:183]
  ds_read_b64_tr_b16 a[94:95], v230 offset:61440
  v_xor_b32 v230, 0x10000, v230
  v_mfma_f32_16x16x32_bf16 v[176:179], a[76:79], a[48:51], v[176:179]
  buffer_load_dwordx4 v233, s[20:23], s67 offen offset:1024  lds
  v_mfma_f32_16x16x32_bf16 v[176:179], a[72:75], a[32:35], v[176:179]
  s_waitcnt lgkmcnt(4)
  v_mfma_f32_16x16x32_bf16 v[192:195], a[80:83], a[32:35], v[192:195]
  s_waitcnt vmcnt(14)
  s_barrier
  ds_read_b64_tr_b16 a[64:65], v224 offset:0
  v_mfma_f32_16x16x32_bf16 v[192:195], a[84:87], a[48:51], v[192:195]
  ds_read_b64_tr_b16 a[66:67], v224 offset:4096
  v_mfma_f32_16x16x32_bf16 v[196:199], a[84:87], a[52:55], v[196:199]
  v_mfma_f32_16x16x32_bf16 v[196:199], a[80:83], a[36:39], v[196:199]
  v_mfma_f32_16x16x32_bf16 v[200:203], a[80:83], a[40:43], v[200:203]
  ds_read_b64_tr_b16 a[68:69], v224 offset:8192
  v_mfma_f32_16x16x32_bf16 v[200:203], a[84:87], a[56:59], v[200:203]
  ds_read_b64_tr_b16 a[70:71], v224 offset:12288
  v_mfma_f32_16x16x32_bf16 v[204:207], a[84:87], a[60:63], v[204:207]
  buffer_load_dwordx4 v234, s[20:23], s67 offen offset:2048  lds
  v_mfma_f32_16x16x32_bf16 v[204:207], a[80:83], a[44:47], v[204:207]
  s_waitcnt lgkmcnt(4)
  v_mfma_f32_16x16x32_bf16 v[220:223], a[88:91], a[44:47], v[220:223]
  ds_read_b64_tr_b16 a[72:73], v224 offset:16384
  v_mfma_f32_16x16x32_bf16 v[220:223], a[92:95], a[60:63], v[220:223]
  ds_read_b64_tr_b16 a[74:75], v224 offset:20480
  v_mfma_f32_16x16x32_bf16 v[216:219], a[92:95], a[56:59], v[216:219]
  buffer_load_dwordx4 v235, s[20:23], s67 offen offset:3072  lds
  v_mfma_f32_16x16x32_bf16 v[216:219], a[88:91], a[40:43], v[216:219]
  s_add_u32 s67, s67, 458752
  s_xor_b32 s68, s68, 0x10000
  v_mfma_f32_16x16x32_bf16 v[212:215], a[88:91], a[36:39], v[212:215]
  ds_read_b64_tr_b16 a[76:77], v224 offset:24576
  v_mfma_f32_16x16x32_bf16 v[212:215], a[92:95], a[52:55], v[212:215]
  s_sub_u32 s56, s56, 1
  ds_read_b64_tr_b16 a[78:79], v224 offset:28672
  v_mfma_f32_16x16x32_bf16 v[208:211], a[92:95], a[48:51], v[208:211]
  s_cmp_lg_u32 s56, 0
  v_mfma_f32_16x16x32_bf16 v[208:211], a[88:91], a[32:35], v[208:211]
  s_cbranch_scc1 Lp3_loop
Lmk_Lp3_loop_tail:
  s_waitcnt vmcnt(8) lgkmcnt(4)
  v_mfma_f32_16x16x32_bf16 v[0:3], a[64:67], a[0:3], v[0:3]
  ds_read_b64_tr_b16 a[80:81], v225 offset:0
  v_add_f32 v242, v242, v246
  v_mfma_f32_16x16x32_bf16 v[0:3], a[68:71], a[16:19], v[0:3]
  ds_read_b64_tr_b16 a[82:83], v225 offset:4096
  v_add_f32 v243, v243, v247
  v_mfma_f32_16x16x32_bf16 v[4:7], a[68:71], a[20:23], v[4:7]
  buffer_load_dwordx4 a[32:35], v231, s[4:7], s72 offen offset:2048 sc1
  v_mfma_f32_16x16x32_bf16 v[4:7], a[64:67], a[4:7], v[4:7]
  v_add_f32 v244, v244, v248
  v_add_f32 v245, v245, v249
  v_mfma_f32_16x16x32_bf16 v[8:11], a[64:67], a[8:11], v[8:11]
  ds_read_b64_tr_b16 a[84:85], v225 offset:8192
  ds_write_b128 v250, v[242:245]
  v_mfma_f32_16x16x32_bf16 v[8:11], a[68:71], a[24:27], v[8:11]
  ds_read_b64_tr_b16 a[86:87], v225 offset:12288
  v_mfma_f32_16x16x32_bf16 v[12:15], a[68:71], a[28:31], v[12:15]
  buffer_load_dwordx4 a[48:51], v231, s[4:7], s72 offen offset:3072 sc1
  v_mfma_f32_16x16x32_bf16 v[12:15], a[64:67], a[12:15], v[12:15]
  s_add_u32 s72, s72, 4096
  s_waitcnt lgkmcnt(5)
  v_mfma_f32_16x16x32_bf16 v[28:31], a[72:75], a[12:15], v[28:31]
  ds_read_b64_tr_b16 a[88:89], v225 offset:16384
  v_mfma_f32_16x16x32_bf16 v[28:31], a[76:79], a[28:31], v[28:31]
  ds_read_b64_tr_b16 a[90:91], v225 offset:20480
  v_mfma_f32_16x16x32_bf16 v[24:27], a[76:79], a[24:27], v[24:27]
  buffer_load_dwordx4 a[36:39], v231, s[4:7], s73 offen offset:2048 sc1
  v_mfma_f32_16x16x32_bf16 v[24:27], a[72:75], a[8:11], v[24:27]
  ds_read_b128 v[246:249], v237 offset:384
  v_mfma_f32_16x16x32_bf16 v[20:23], a[72:75], a[4:7], v[20:23]
  ds_read_b64_tr_b16 a[92:93], v225 offset:24576
  v_mfma_f32_16x16x32_bf16 v[20:23], a[76:79], a[20:23], v[20:23]
  ds_read_b64_tr_b16 a[94:95], v225 offset:28672
  v_mfma_f32_16x16x32_bf16 v[16:19], a[76:79], a[16:19], v[16:19]
  buffer_load_dwordx4 a[52:55], v231, s[4:7], s73 offen offset:3072 sc1
  v_mfma_f32_16x16x32_bf16 v[16:19], a[72:75], a[0:3], v[16:19]
  s_add_u32 s73, s73, 4096
  s_waitcnt lgkmcnt(5)
  v_mfma_f32_16x16x32_bf16 v[32:35], a[80:83], a[0:3], v[32:35]
  s_waitcnt lgkmcnt(2)
  ds_read_b64_tr_b16 a[64:65], v226 offset:0
  v_fmac_f32 v96, v246, v238
  v_mfma_f32_16x16x32_bf16 v[32:35], a[84:87], a[16:19], v[32:35]
  ds_read_b64_tr_b16 a[66:67], v226 offset:4096
  v_fmac_f32 v97, v247, v238
  v_mfma_f32_16x16x32_bf16 v[36:39], a[84:87], a[20:23], v[36:39]
  v_fmac_f32 v98, v248, v238
  v_fmac_f32 v99, v249, v238
  v_mfma_f32_16x16x32_bf16 v[36:39], a[80:83], a[4:7], v[36:39]
  ds_read_b128 v[242:245], v237 offset:0
  v_fmac_f32 v100, v246, v239
  v_mfma_f32_16x16x32_bf16 v[40:43], a[80:83], a[8:11], v[40:43]
  s_xor_b32 s93, s53, 1
  ds_read_b64_tr_b16 a[68:69], v226 offset:8192
  v_fmac_f32 v101, v247, v239
  v_mfma_f32_16x16x32_bf16 v[40:43], a[84:87], a[24:27], v[40:43]
  s_lshl_b32 s93, s93, 7
  ds_read_b64_tr_b16 a[70:71], v226 offset:12288
  v_fmac_f32 v102, v248, v239
  v_mfma_f32_16x16x32_bf16 v[44:47], a[84:87], a[28:31], v[44:47]
  s_add_u32 s80, s24, s93
  s_addc_u32 s81, s25, 0
  buffer_load_dwordx4 a[40:43], v231, s[4:7], s74 offen offset:2048 sc1
  v_mfma_f32_16x16x32_bf16 v[44:47], a[80:83], a[12:15], v[44:47]
  s_sub_u32 s82, 7340032, s93
  v_fmac_f32 v103, v249, v239
  v_fmac_f32 v104, v246, v240
  s_waitcnt lgkmcnt(5)
  v_mfma_f32_16x16x32_bf16 v[60:63], a[88:91], a[12:15], v[60:63]
  s_mov_b32 s83, 0x20000
  ds_read_b64_tr_b16 a[72:73], v226 offset:16384
  v_fmac_f32 v105, v247, v240
  v_mfma_f32_16x16x32_bf16 v[60:63], a[92:95], a[28:31], v[60:63]
  s_lshl_b32 s93, s53, 7
  ds_read_b64_tr_b16 a[74:75], v226 offset:20480
  v_fmac_f32 v106, v248, v240
  v_mfma_f32_16x16x32_bf16 v[56:59], a[92:95], a[24:27], v[56:59]
  s_add_u32 s84, s24, s93
  s_addc_u32 s85, s25, 0
  buffer_load_dwordx4 a[56:59], v231, s[4:7], s74 offen offset:3072 sc1
  v_mfma_f32_16x16x32_bf16 v[56:59], a[88:91], a[8:11], v[56:59]
  s_add_u32 s74, s74, 4096
  v_fmac_f32 v107, v249, v240
  v_fmac_f32 v108, v246, v241
  v_mfma_f32_16x16x32_bf16 v[52:55], a[88:91], a[4:7], v[52:55]
  s_sub_u32 s84, s84, 1024
  s_subb_u32 s85, s85, 0
  ds_read_b64_tr_b16 a[76:77], v226 offset:24576
  v_fmac_f32 v109, v247, v241
  v_mfma_f32_16x16x32_bf16 v[52:55], a[92:95], a[20:23], v[52:55]
  s_sub_u32 s86, 7341056, s93
  ds_read_b64_tr_b16 a[78:79], v226 offset:28672
  v_fmac_f32 v110, v248, v241
  v_mfma_f32_16x16x32_bf16 v[48:51], a[92:95], a[16:19], v[48:51]
  s_mov_b32 s87, 0x20000
  buffer_load_dwordx4 a[44:47], v231, s[4:7], s75 offen offset:2048 sc1
  v_mfma_f32_16x16x32_bf16 v[48:51], a[88:91], a[0:3], v[48:51]
  s_and_b32 s93, s53, 1
  v_fmac_f32 v111, v249, v241
  s_waitcnt lgkmcnt(4)
  v_mfma_f32_16x16x32_bf16 v[64:67], a[64:67], a[0:3], v[64:67]
  ds_read_b64_tr_b16 a[80:81], v227 offset:0
  v_fmac_f32 v0, v242, v238
  v_mfma_f32_16x16x32_bf16 v[64:67], a[68:71], a[16:19], v[64:67]
  s_mul_i32 s92, s93, 3670016
  ds_read_b64_tr_b16 a[82:83], v227 offset:4096
  v_fmac_f32 v1, v243, v238
  v_mfma_f32_16x16x32_bf16 v[68:71], a[68:71], a[20:23], v[68:71]
  s_lshl_b32 s93, s40, 14
  buffer_load_dwordx4 a[60:63], v231, s[4:7], s75 offen offset:3072 sc1
  v_mfma_f32_16x16x32_bf16 v[68:71], a[64:67], a[4:7], v[68:71]
  s_add_u32 s75, s75, 4096
  ds_read_b128 v[246:249], v237 offset:64
  v_fmac_f32 v2, v244, v238
  v_mfma_f32_16x16x32_bf16 v[72:75], a[64:67], a[8:11], v[72:75]
  s_add_u32 s92, s92, s93
  ds_read_b64_tr_b16 a[84:85], v227 offset:8192
  v_fmac_f32 v3, v245, v238
  v_mfma_f32_16x16x32_bf16 v[72:75], a[68:71], a[24:27], v[72:75]
  s_lshl_b32 s79, s40, 11
  ds_read_b64_tr_b16 a[86:87], v227 offset:12288
  v_fmac_f32 v4, v242, v239
  v_mfma_f32_16x16x32_bf16 v[76:79], a[68:71], a[28:31], v[76:79]
  s_lshr_b32 s93, s53, 1
  v_fmac_f32 v5, v243, v239
  v_fmac_f32 v6, v244, v239
  v_mfma_f32_16x16x32_bf16 v[76:79], a[64:67], a[12:15], v[76:79]
  s_add_u32 s93, s93, s52
  v_fmac_f32 v7, v245, v239
  v_fmac_f32 v8, v242, v240
  s_waitcnt lgkmcnt(5)
  v_mfma_f32_16x16x32_bf16 v[92:95], a[72:75], a[12:15], v[92:95]
  s_and_b32 s93, s93, 1
  ds_read_b64_tr_b16 a[88:89], v227 offset:16384
  v_fmac_f32 v9, v243, v240
  v_mfma_f32_16x16x32_bf16 v[92:95], a[76:79], a[28:31], v[92:95]
  s_add_u32 m0, s68, 0
  ds_read_b64_tr_b16 a[90:91], v227 offset:20480
  v_fmac_f32 v10, v244, v240
  v_mfma_f32_16x16x32_bf16 v[88:91], a[76:79], a[24:27], v[88:91]
  s_mul_i32 s88, s93, 1835008
  buffer_load_dwordx4 v232, s[16:19], s67 offen offset:0  lds
  v_mfma_f32_16x16x32_bf16 v[88:91], a[72:75], a[8:11], v[88:91]
  s_cmp_eq_u32 s40, 1
  s_cselect_b32 s78, 16384, 0
  v_fmac_f32 v11, v245, v240
  v_fmac_f32 v12, v242, v241
  v_mfma_f32_16x16x32_bf16 v[84:87], a[72:75], a[4:7], v[84:87]
  s_cmp_eq_u32 s40, 2
  s_cselect_b32 s78, -16384, s78
  ds_read_b64_tr_b16 a[92:93], v227 offset:24576
  v_fmac_f32 v13, v243, v241
  v_mfma_f32_16x16x32_bf16 v[84:87], a[76:79], a[20:23], v[84:87]
  s_mul_i32 s43, s69, 458752
  ds_read_b64_tr_b16 a[94:95], v227 offset:28672
  v_fmac_f32 v14, v244, v241
  v_mfma_f32_16x16x32_bf16 v[80:83], a[76:79], a[16:19], v[80:83]
  s_lshr_b32 s45, s55, 4
  buffer_load_dwordx4 v233, s[16:19], s67 offen offset:1024  lds
  v_mfma_f32_16x16x32_bf16 v[80:83], a[72:75], a[0:3], v[80:83]
  s_mul_i32 s45, s45, 57344
  v_fmac_f32 v15, v245, v241
  s_waitcnt lgkmcnt(4)
  v_mfma_f32_16x16x32_bf16 v[96:99], a[80:83], a[0:3], v[96:99]
  ds_read_b64_tr_b16 a[64:65], v228 offset:0
  v_fmac_f32 v16, v246, v238
  v_mfma_f32_16x16x32_bf16 v[96:99], a[84:87], a[16:19], v[96:99]
  s_add_u32 s43, s43, s45
  ds_read_b64_tr_b16 a[66:67], v228 offset:4096
  v_fmac_f32 v17, v247, v238
  v_mfma_f32_16x16x32_bf16 v[100:103], a[84:87], a[20:23], v[100:103]
  s_add_u32 s43, s43, s42
  buffer_load_dwordx4 v234, s[16:19], s67 offen offset:2048  lds
  v_mfma_f32_16x16x32_bf16 v[100:103], a[80:83], a[4:7], v[100:103]
  s_add_u32 s43, s43, 12582912
  ds_read_b128 v[242:245], v237 offset:128
  v_fmac_f32 v18, v248, v238
  v_mfma_f32_16x16x32_bf16 v[104:107], a[80:83], a[8:11], v[104:107]
  s_and_b32 s44, s55, 15
  ds_read_b64_tr_b16 a[68:69], v228 offset:8192
  v_fmac_f32 v19, v249, v238
  v_mfma_f32_16x16x32_bf16 v[104:107], a[84:87], a[24:27], v[104:107]
  s_lshl_b32 s45, s44, 10
  ds_read_b64_tr_b16 a[70:71], v228 offset:12288
  v_fmac_f32 v20, v246, v239
  v_mfma_f32_16x16x32_bf16 v[108:111], a[84:87], a[28:31], v[108:111]
  s_add_u32 s57, s43, s45
  buffer_load_dwordx4 v235, s[16:19], s67 offen offset:3072  lds
  v_mfma_f32_16x16x32_bf16 v[108:111], a[80:83], a[12:15], v[108:111]
  s_lshl_b32 s45, s44, 9
  v_fmac_f32 v21, v247, v239
  v_fmac_f32 v22, v248, v239
  s_waitcnt lgkmcnt(5)
  v_mfma_f32_16x16x32_bf16 v[124:127], a[88:91], a[12:15], v[124:127]
  s_add_u32 s61, s43, s45
  ds_read_b64_tr_b16 a[72:73], v228 offset:16384
  v_fmac_f32 v23, v249, v239
  v_mfma_f32_16x16x32_bf16 v[124:127], a[92:95], a[28:31], v[124:127]
  s_add_u32 s57, s57, 8192
  ds_read_b64_tr_b16 a[74:75], v228 offset:20480
  v_fmac_f32 v24, v246, v240
  v_mfma_f32_16x16x32_bf16 v[120:123], a[92:95], a[24:27], v[120:123]
  s_add_u32 s62, s61, 229376
  v_fmac_f32 v25, v247, v240
  v_fmac_f32 v26, v248, v240
  v_mfma_f32_16x16x32_bf16 v[120:123], a[88:91], a[8:11], v[120:123]
  s_add_u32 s58, s57, 114688
  v_fmac_f32 v27, v249, v240
  v_fmac_f32 v28, v246, v241
  v_mfma_f32_16x16x32_bf16 v[116:119], a[88:91], a[4:7], v[116:119]
  s_add_u32 s59, s58, 114688
  ds_read_b64_tr_b16 a[76:77], v228 offset:24576
  v_fmac_f32 v29, v247, v241
  v_mfma_f32_16x16x32_bf16 v[116:119], a[92:95], a[20:23], v[116:119]
  s_add_u32 m0, s68, 16384
  ds_read_b64_tr_b16 a[78:79], v228 offset:28672
  v_fmac_f32 v30, v248, v241
  v_mfma_f32_16x16x32_bf16 v[112:115], a[92:95], a[16:19], v[112:115]
  s_add_u32 s60, s59, 114688
  buffer_load_dwordx4 v232, s[20:23], s67 offen offset:0  lds
  v_mfma_f32_16x16x32_bf16 v[112:115], a[88:91], a[0:3], v[112:115]
  s_lshl_b32 s77, s54, 1
  v_fmac_f32 v31, v249, v241
  s_waitcnt lgkmcnt(4)
  v_mfma_f32_16x16x32_bf16 v[128:131], a[64:67], a[0:3], v[128:131]
  ds_read_b64_tr_b16 a[80:81], v229 offset:0
  v_fmac_f32 v32, v242, v238
  v_mfma_f32_16x16x32_bf16 v[128:131], a[68:71], a[16:19], v[128:131]
  s_lshr_b32 s43, s55, 4
  ds_read_b64_tr_b16 a[82:83], v229 offset:4096
  v_fmac_f32 v33, v243, v238
  v_mfma_f32_16x16x32_bf16 v[132:135], a[68:71], a[20:23], v[132:135]
  s_add_u32 s77, s77, s43
  buffer_load_dwordx4 v233, s[20:23], s67 offen offset:1024  lds
  v_mfma_f32_16x16x32_bf16 v[132:135], a[64:67], a[4:7], v[132:135]
  s_lshl_b32 s77, s77, 7
  ds_read_b128 v[246:249], v237 offset:192
  v_fmac_f32 v34, v244, v238
  v_mfma_f32_16x16x32_bf16 v[136:139], a[64:67], a[8:11], v[136:139]
  s_add_u32 s77, s77, s42
  ds_read_b64_tr_b16 a[84:85], v229 offset:8192
  v_fmac_f32 v35, v245, v238
  v_mfma_f32_16x16x32_bf16 v[136:139], a[68:71], a[24:27], v[136:139]
  s_add_u32 s77, s77, 27795456
  ds_read_b64_tr_b16 a[86:87], v229 offset:12288
  v_fmac_f32 v36, v242, v239
  v_mfma_f32_16x16x32_bf16 v[140:143], a[68:71], a[28:31], v[140:143]
  s_and_b32 s43, s53, 1
  buffer_load_dwordx4 v234, s[20:23], s67 offen offset:2048  lds
  v_mfma_f32_16x16x32_bf16 v[140:143], a[64:67], a[12:15], v[140:143]
  s_and_b32 s64, s52, 14
  v_fmac_f32 v37, v243, v239
  v_fmac_f32 v38, v244, v239
  s_waitcnt lgkmcnt(5)
  v_mfma_f32_16x16x32_bf16 v[156:159], a[72:75], a[12:15], v[156:159]
  s_add_u32 s64, s64, s43
  ds_read_b64_tr_b16 a[88:89], v229 offset:16384
  v_fmac_f32 v39, v245, v239
  v_mfma_f32_16x16x32_bf16 v[156:159], a[76:79], a[28:31], v[156:159]
  s_lshl_b32 s64, s64, 7
  ds_read_b64_tr_b16 a[90:91], v229 offset:20480
  v_fmac_f32 v40, v242, v240
  v_mfma_f32_16x16x32_bf16 v[152:155], a[76:79], a[24:27], v[152:155]
  s_add_u32 s64, s64, s42
  buffer_load_dwordx4 v235, s[20:23], s67 offen offset:3072  lds
  v_mfma_f32_16x16x32_bf16 v[152:155], a[72:75], a[8:11], v[152:155]
  s_add_u32 s67, s67, 458752
  v_fmac_f32 v41, v243, v240
  v_fmac_f32 v42, v244, v240
  v_mfma_f32_16x16x32_bf16 v[148:151], a[72:75], a[4:7], v[148:151]
  s_add_u32 s64, s64, 27795456
  ds_read_b64_tr_b16 a[92:93], v229 offset:24576
  v_fmac_f32 v43, v245, v240
  v_mfma_f32_16x16x32_bf16 v[148:151], a[76:79], a[20:23], v[148:151]
  s_lshl_b32 s49, s52, 3
  ds_read_b64_tr_b16 a[94:95], v229 offset:28672
  v_fmac_f32 v44, v242, v241
  v_mfma_f32_16x16x32_bf16 v[144:147], a[76:79], a[16:19], v[144:147]
  s_lshl_b32 s43, s40, 1
  v_fmac_f32 v45, v243, v241
  v_fmac_f32 v46, v244, v241
  v_mfma_f32_16x16x32_bf16 v[144:147], a[72:75], a[0:3], v[144:147]
  s_add_u32 s49, s49, s43
  v_fmac_f32 v47, v245, v241
  s_waitcnt lgkmcnt(4)
  v_mfma_f32_16x16x32_bf16 v[160:163], a[80:83], a[0:3], v[160:163]
  ds_read_b64_tr_b16 a[64:65], v230 offset:0
  v_fmac_f32 v48, v246, v238
  v_mfma_f32_16x16x32_bf16 v[160:163], a[84:87], a[16:19], v[160:163]
  s_lshl_b32 s76, s49, 15
  ds_read_b64_tr_b16 a[66:67], v230 offset:4096
  v_fmac_f32 v49, v247, v238
  v_mfma_f32_16x16x32_bf16 v[164:167], a[84:87], a[20:23], v[164:167]
  s_lshl_b32 s43, s53, 11
  buffer_load_dwordx4 a[96:99], v231, s[4:7], s72 offen offset:0 sc1
  v_mfma_f32_16x16x32_bf16 v[164:167], a[80:83], a[4:7], v[164:167]
  s_add_u32 s76, s76, s43
  ds_read_b128 v[242:245], v237 offset:256
  v_fmac_f32 v50, v248, v238
  v_mfma_f32_16x16x32_bf16 v[168:171], a[80:83], a[8:11], v[168:171]
  s_add_u32 s76, s76, s42
  ds_read_b64_tr_b16 a[68:69], v230 offset:8192
  v_fmac_f32 v51, v249, v238
  v_mfma_f32_16x16x32_bf16 v[168:171], a[84:87], a[24:27], v[168:171]
  s_add_u32 s46, s76, 4194304
  ds_read_b64_tr_b16 a[70:71], v230 offset:12288
  v_fmac_f32 v52, v246, v239
  v_mfma_f32_16x16x32_bf16 v[172:175], a[84:87], a[28:31], v[172:175]
  s_add_u32 s47, s46, 32768
  buffer_load_dwordx4 a[112:115], v231, s[4:7], s72 offen offset:1024 sc1
  v_mfma_f32_16x16x32_bf16 v[172:175], a[80:83], a[12:15], v[172:175]
  s_mul_i32 s48, s49, 114688
  v_fmac_f32 v53, v247, v239
  v_fmac_f32 v54, v248, v239
  s_waitcnt lgkmcnt(5)
  v_mfma_f32_16x16x32_bf16 v[188:191], a[88:91], a[12:15], v[188:191]
  s_and_b32 s43, s53, 1
  ds_read_b64_tr_b16 a[72:73], v230 offset:16384
  v_fmac_f32 v55, v249, v239
  v_mfma_f32_16x16x32_bf16 v[188:191], a[92:95], a[28:31], v[188:191]
  s_mul_i32 s44, s43, 57344
  ds_read_b64_tr_b16 a[74:75], v230 offset:20480
  v_fmac_f32 v56, v246, v240
  v_mfma_f32_16x16x32_bf16 v[184:187], a[92:95], a[24:27], v[184:187]
  s_add_u32 s48, s48, s44
  buffer_load_dwordx4 a[100:103], v231, s[4:7], s73 offen offset:0 sc1
  v_mfma_f32_16x16x32_bf16 v[184:187], a[88:91], a[8:11], v[184:187]
  s_add_u32 s48, s48, s42
  v_fmac_f32 v57, v247, v240
  v_fmac_f32 v58, v248, v240
  v_mfma_f32_16x16x32_bf16 v[180:183], a[88:91], a[4:7], v[180:183]
  s_add_u32 s48, s48, 12582912
  ds_read_b64_tr_b16 a[76:77], v230 offset:24576
  v_fmac_f32 v59, v249, v240
  v_mfma_f32_16x16x32_bf16 v[180:183], a[92:95], a[20:23], v[180:183]
  ds_read_b64_tr_b16 a[78:79], v230 offset:28672
  v_fmac_f32 v60, v246, v241
  v_mfma_f32_16x16x32_bf16 v[176:179], a[92:95], a[16:19], v[176:179]
  buffer_load_dwordx4 a[116:119], v231, s[4:7], s73 offen offset:1024 sc1
  v_mfma_f32_16x16x32_bf16 v[176:179], a[88:91], a[0:3], v[176:179]
  s_waitcnt lgkmcnt(4)
  v_fmac_f32 v61, v247, v241
  v_fmac_f32 v62, v248, v241
  v_fmac_f32 v63, v249, v241
  v_mfma_f32_16x16x32_bf16 v[192:195], a[64:67], a[0:3], v[192:195]
  s_waitcnt vmcnt(20)
  s_barrier
  ds_read_b64_tr_b16 a[80:81], v224 offset:32768
  v_mfma_f32_16x16x32_bf16 v[192:195], a[68:71], a[16:19], v[192:195]
  ds_read_b64_tr_b16 a[82:83], v224 offset:36864
  v_fmac_f32 v64, v242, v238
  v_mfma_f32_16x16x32_bf16 v[196:199], a[68:71], a[20:23], v[196:199]
  v_fmac_f32 v65, v243, v238
  v_fmac_f32 v66, v244, v238
  v_mfma_f32_16x16x32_bf16 v[196:199], a[64:67], a[4:7], v[196:199]
  ds_read_b128 v[246:249], v237 offset:320
  v_fmac_f32 v67, v245, v238
  v_mfma_f32_16x16x32_bf16 v[200:203], a[64:67], a[8:11], v[200:203]
  ds_read_b64_tr_b16 a[84:85], v224 offset:40960
  v_fmac_f32 v68, v242, v239
  v_mfma_f32_16x16x32_bf16 v[200:203], a[68:71], a[24:27], v[200:203]
  ds_read_b64_tr_b16 a[86:87], v224 offset:45056
  v_fmac_f32 v69, v243, v239
  v_mfma_f32_16x16x32_bf16 v[204:207], a[68:71], a[28:31], v[204:207]
  buffer_load_dwordx4 a[104:107], v231, s[4:7], s74 offen offset:0 sc1
  v_mfma_f32_16x16x32_bf16 v[204:207], a[64:67], a[12:15], v[204:207]
  s_waitcnt lgkmcnt(5)
  v_fmac_f32 v70, v244, v239
  v_fmac_f32 v71, v245, v239
  v_mfma_f32_16x16x32_bf16 v[220:223], a[72:75], a[12:15], v[220:223]
  ds_read_b64_tr_b16 a[88:89], v224 offset:49152
  v_fmac_f32 v72, v242, v240
  v_mfma_f32_16x16x32_bf16 v[220:223], a[76:79], a[28:31], v[220:223]
  ds_read_b64_tr_b16 a[90:91], v224 offset:53248
  v_fmac_f32 v73, v243, v240
  v_mfma_f32_16x16x32_bf16 v[216:219], a[76:79], a[24:27], v[216:219]
  buffer_load_dwordx4 a[120:123], v231, s[4:7], s74 offen offset:1024 sc1
  v_mfma_f32_16x16x32_bf16 v[216:219], a[72:75], a[8:11], v[216:219]
  v_fmac_f32 v74, v244, v240
  v_fmac_f32 v75, v245, v240
  v_mfma_f32_16x16x32_bf16 v[212:215], a[72:75], a[4:7], v[212:215]
  ds_read_b64_tr_b16 a[92:93], v224 offset:57344
  v_fmac_f32 v76, v242, v241
  v_mfma_f32_16x16x32_bf16 v[212:215], a[76:79], a[20:23], v[212:215]
  ds_read_b64_tr_b16 a[94:95], v224 offset:61440
  v_xor_b32 v224, 0x10000, v224
  v_fmac_f32 v77, v243, v241
  v_mfma_f32_16x16x32_bf16 v[208:211], a[76:79], a[16:19], v[208:211]
  buffer_load_dwordx4 a[108:111], v231, s[4:7], s75 offen offset:0 sc1
  v_mfma_f32_16x16x32_bf16 v[208:211], a[72:75], a[0:3], v[208:211]
  s_waitcnt vmcnt(21) lgkmcnt(4)
  v_fmac_f32 v78, v244, v241
  v_fmac_f32 v79, v245, v241
  v_mfma_f32_16x16x32_bf16 v[0:3], a[80:83], a[32:35], v[0:3]
  ds_read_b64_tr_b16 a[64:65], v225 offset:32768
  v_fmac_f32 v80, v246, v238
  v_mfma_f32_16x16x32_bf16 v[0:3], a[84:87], a[48:51], v[0:3]
  s_waitcnt vmcnt(19)
  ds_read_b64_tr_b16 a[66:67], v225 offset:36864
  v_fmac_f32 v81, v247, v238
  v_mfma_f32_16x16x32_bf16 v[4:7], a[84:87], a[52:55], v[4:7]
  buffer_load_dwordx4 a[124:127], v231, s[4:7], s75 offen offset:1024 sc1
  v_mfma_f32_16x16x32_bf16 v[4:7], a[80:83], a[36:39], v[4:7]
  s_waitcnt vmcnt(18)
  ds_read_b128 v[242:245], v237 offset:448
  v_fmac_f32 v82, v248, v238
  v_mfma_f32_16x16x32_bf16 v[8:11], a[80:83], a[40:43], v[8:11]
  ds_read_b64_tr_b16 a[68:69], v225 offset:40960
  v_fmac_f32 v83, v249, v238
  v_mfma_f32_16x16x32_bf16 v[8:11], a[84:87], a[56:59], v[8:11]
  s_waitcnt vmcnt(16)
  ds_read_b64_tr_b16 a[70:71], v225 offset:45056
  v_fmac_f32 v84, v246, v239
  v_mfma_f32_16x16x32_bf16 v[12:15], a[84:87], a[60:63], v[12:15]
  v_fmac_f32 v85, v247, v239
  v_fmac_f32 v86, v248, v239
  v_mfma_f32_16x16x32_bf16 v[12:15], a[80:83], a[44:47], v[12:15]
  s_waitcnt lgkmcnt(5)
  v_fmac_f32 v87, v249, v239
  v_fmac_f32 v88, v246, v240
  v_mfma_f32_16x16x32_bf16 v[28:31], a[88:91], a[44:47], v[28:31]
  ds_read_b64_tr_b16 a[72:73], v225 offset:49152
  v_fmac_f32 v89, v247, v240
  v_mfma_f32_16x16x32_bf16 v[28:31], a[92:95], a[60:63], v[28:31]
  s_add_u32 m0, s68, 32768
  ds_read_b64_tr_b16 a[74:75], v225 offset:53248
  v_fmac_f32 v90, v248, v240
  v_mfma_f32_16x16x32_bf16 v[24:27], a[92:95], a[56:59], v[24:27]
  buffer_load_dwordx4 v232, s[16:19], s67 offen offset:0  lds
  v_mfma_f32_16x16x32_bf16 v[24:27], a[88:91], a[40:43], v[24:27]
  v_fmac_f32 v91, v249, v240
  v_fmac_f32 v92, v246, v241
  v_mfma_f32_16x16x32_bf16 v[20:23], a[88:91], a[36:39], v[20:23]
  ds_read_b64_tr_b16 a[76:77], v225 offset:57344
  v_fmac_f32 v93, v247, v241
  v_mfma_f32_16x16x32_bf16 v[20:23], a[92:95], a[52:55], v[20:23]
  ds_read_b64_tr_b16 a[78:79], v225 offset:61440
  v_xor_b32 v225, 0x10000, v225
  v_fmac_f32 v94, v248, v241
  v_mfma_f32_16x16x32_bf16 v[16:19], a[92:95], a[48:51], v[16:19]
  buffer_load_dwordx4 v233, s[16:19], s67 offen offset:1024  lds
  v_mfma_f32_16x16x32_bf16 v[16:19], a[88:91], a[32:35], v[16:19]
  v_fmac_f32 v95, v249, v241
  s_waitcnt lgkmcnt(4)
  v_mfma_f32_16x16x32_bf16 v[32:35], a[64:67], a[32:35], v[32:35]
  ds_read_b64_tr_b16 a[80:81], v226 offset:32768
  v_fmac_f32 v112, v242, v238
  v_mfma_f32_16x16x32_bf16 v[32:35], a[68:71], a[48:51], v[32:35]
  ds_read_b64_tr_b16 a[82:83], v226 offset:36864
  v_fmac_f32 v113, v243, v238
  v_mfma_f32_16x16x32_bf16 v[36:39], a[68:71], a[52:55], v[36:39]
  buffer_load_dwordx4 v234, s[16:19], s67 offen offset:2048  lds
  v_mfma_f32_16x16x32_bf16 v[36:39], a[64:67], a[36:39], v[36:39]
  ds_read_b128 v[246:249], v237 offset:512
  v_fmac_f32 v114, v244, v238
  v_mfma_f32_16x16x32_bf16 v[40:43], a[64:67], a[40:43], v[40:43]
  ds_read_b64_tr_b16 a[84:85], v226 offset:40960
  v_fmac_f32 v115, v245, v238
  v_mfma_f32_16x16x32_bf16 v[40:43], a[68:71], a[56:59], v[40:43]
  ds_read_b64_tr_b16 a[86:87], v226 offset:45056
  v_fmac_f32 v116, v242, v239
  v_mfma_f32_16x16x32_bf16 v[44:47], a[68:71], a[60:63], v[44:47]
  buffer_load_dwordx4 v235, s[16:19], s67 offen offset:3072  lds
  v_mfma_f32_16x16x32_bf16 v[44:47], a[64:67], a[44:47], v[44:47]
  s_waitcnt lgkmcnt(5)
  v_fmac_f32 v117, v243, v239
  v_fmac_f32 v118, v244, v239
  v_mfma_f32_16x16x32_bf16 v[60:63], a[72:75], a[44:47], v[60:63]
  ds_read_b64_tr_b16 a[88:89], v226 offset:49152
  v_fmac_f32 v119, v245, v239
  v_mfma_f32_16x16x32_bf16 v[60:63], a[76:79], a[60:63], v[60:63]
  ds_read_b64_tr_b16 a[90:91], v226 offset:53248
  v_fmac_f32 v120, v242, v240
  v_mfma_f32_16x16x32_bf16 v[56:59], a[76:79], a[56:59], v[56:59]
  v_fmac_f32 v121, v243, v240
  v_fmac_f32 v122, v244, v240
  v_mfma_f32_16x16x32_bf16 v[56:59], a[72:75], a[40:43], v[56:59]
  v_fmac_f32 v123, v245, v240
  v_fmac_f32 v124, v242, v241
  v_mfma_f32_16x16x32_bf16 v[52:55], a[72:75], a[36:39], v[52:55]
  ds_read_b64_tr_b16 a[92:93], v226 offset:57344
  v_fmac_f32 v125, v243, v241
  v_mfma_f32_16x16x32_bf16 v[52:55], a[76:79], a[52:55], v[52:55]
  s_add_u32 m0, s68, 49152
  ds_read_b64_tr_b16 a[94:95], v226 offset:61440
  v_xor_b32 v226, 0x10000, v226
  v_fmac_f32 v126, v244, v241
  v_mfma_f32_16x16x32_bf16 v[48:51], a[76:79], a[48:51], v[48:51]
  buffer_load_dwordx4 v232, s[20:23], s67 offen offset:0  lds
  v_mfma_f32_16x16x32_bf16 v[48:51], a[72:75], a[32:35], v[48:51]
  v_fmac_f32 v127, v245, v241
  s_waitcnt lgkmcnt(4)
  v_mfma_f32_16x16x32_bf16 v[64:67], a[80:83], a[32:35], v[64:67]
  ds_read_b64_tr_b16 a[64:65], v227 offset:32768
  v_fmac_f32 v128, v246, v238
  v_mfma_f32_16x16x32_bf16 v[64:67], a[84:87], a[48:51], v[64:67]
  ds_read_b64_tr_b16 a[66:67], v227 offset:36864
  v_fmac_f32 v129, v247, v238
  v_mfma_f32_16x16x32_bf16 v[68:71], a[84:87], a[52:55], v[68:71]
  buffer_load_dwordx4 v233, s[20:23], s67 offen offset:1024  lds
  v_mfma_f32_16x16x32_bf16 v[68:71], a[80:83], a[36:39], v[68:71]
  ds_read_b128 v[242:245], v237 offset:576
  v_fmac_f32 v130, v248, v238
  v_mfma_f32_16x16x32_bf16 v[72:75], a[80:83], a[40:43], v[72:75]
  ds_read_b64_tr_b16 a[68:69], v227 offset:40960
  v_fmac_f32 v131, v249, v238
  v_mfma_f32_16x16x32_bf16 v[72:75], a[84:87], a[56:59], v[72:75]
  ds_read_b64_tr_b16 a[70:71], v227 offset:45056
  v_fmac_f32 v132, v246, v239
  v_mfma_f32_16x16x32_bf16 v[76:79], a[84:87], a[60:63], v[76:79]
  buffer_load_dwordx4 v234, s[20:23], s67 offen offset:2048  lds
  v_mfma_f32_16x16x32_bf16 v[76:79], a[80:83], a[44:47], v[76:79]
  s_waitcnt lgkmcnt(5)
  v_fmac_f32 v133, v247, v239
  v_fmac_f32 v134, v248, v239
  v_mfma_f32_16x16x32_bf16 v[92:95], a[88:91], a[44:47], v[92:95]
  ds_read_b64_tr_b16 a[72:73], v227 offset:49152
  v_fmac_f32 v135, v249, v239
  v_mfma_f32_16x16x32_bf16 v[92:95], a[92:95], a[60:63], v[92:95]
  ds_read_b64_tr_b16 a[74:75], v227 offset:53248
  v_fmac_f32 v136, v246, v240
  v_mfma_f32_16x16x32_bf16 v[88:91], a[92:95], a[56:59], v[88:91]
  buffer_load_dwordx4 v235, s[20:23], s67 offen offset:3072  lds
  v_mfma_f32_16x16x32_bf16 v[88:91], a[88:91], a[40:43], v[88:91]
  s_add_u32 s67, s67, 458752
  s_xor_b32 s68, s68, 0x10000
  v_fmac_f32 v137, v247, v240
  v_mfma_f32_16x16x32_bf16 v[84:87], a[88:91], a[36:39], v[84:87]
  ds_read_b64_tr_b16 a[76:77], v227 offset:57344
  v_fmac_f32 v138, v248, v240
  v_mfma_f32_16x16x32_bf16 v[84:87], a[92:95], a[52:55], v[84:87]
  ds_read_b64_tr_b16 a[78:79], v227 offset:61440
  v_xor_b32 v227, 0x10000, v227
  v_fmac_f32 v139, v249, v240
  v_mfma_f32_16x16x32_bf16 v[80:83], a[92:95], a[48:51], v[80:83]
  v_fmac_f32 v140, v246, v241
  v_fmac_f32 v141, v247, v241
  v_mfma_f32_16x16x32_bf16 v[80:83], a[88:91], a[32:35], v[80:83]
  s_waitcnt lgkmcnt(4)
  v_fmac_f32 v142, v248, v241
  v_fmac_f32 v143, v249, v241
  v_mfma_f32_16x16x32_bf16 v[96:99], a[64:67], a[32:35], v[96:99]
  s_waitcnt vmcnt(16)
  s_barrier
  ds_read_b64_tr_b16 a[80:81], v224 offset:0
  v_mfma_f32_16x16x32_bf16 v[96:99], a[68:71], a[48:51], v[96:99]
  ds_read_b64_tr_b16 a[82:83], v224 offset:4096
  v_fmac_f32 v144, v242, v238
  v_mfma_f32_16x16x32_bf16 v[100:103], a[68:71], a[52:55], v[100:103]
  buffer_load_dwordx4 a[0:3], v231, s[4:7], s72 offen offset:2048 sc1
  v_mfma_f32_16x16x32_bf16 v[100:103], a[64:67], a[36:39], v[100:103]
  ds_read_b128 v[246:249], v237 offset:640
  v_fmac_f32 v145, v243, v238
  v_mfma_f32_16x16x32_bf16 v[104:107], a[64:67], a[40:43], v[104:107]
  ds_read_b64_tr_b16 a[84:85], v224 offset:8192
  v_fmac_f32 v146, v244, v238
  v_mfma_f32_16x16x32_bf16 v[104:107], a[68:71], a[56:59], v[104:107]
  ds_read_b64_tr_b16 a[86:87], v224 offset:12288
  v_fmac_f32 v147, v245, v238
  v_mfma_f32_16x16x32_bf16 v[108:111], a[68:71], a[60:63], v[108:111]
  buffer_load_dwordx4 a[16:19], v231, s[4:7], s72 offen offset:3072 sc1
  v_mfma_f32_16x16x32_bf16 v[108:111], a[64:67], a[44:47], v[108:111]
  s_add_u32 s72, s72, 4096
  v_fmac_f32 v148, v242, v239
  v_fmac_f32 v149, v243, v239
  s_waitcnt lgkmcnt(5)
  v_mfma_f32_16x16x32_bf16 v[124:127], a[72:75], a[44:47], v[124:127]
  ds_read_b64_tr_b16 a[88:89], v224 offset:16384
  v_fmac_f32 v150, v244, v239
  v_mfma_f32_16x16x32_bf16 v[124:127], a[76:79], a[60:63], v[124:127]
  ds_read_b64_tr_b16 a[90:91], v224 offset:20480
  v_fmac_f32 v151, v245, v239
  v_mfma_f32_16x16x32_bf16 v[120:123], a[76:79], a[56:59], v[120:123]
  buffer_load_dwordx4 a[4:7], v231, s[4:7], s73 offen offset:2048 sc1
  v_mfma_f32_16x16x32_bf16 v[120:123], a[72:75], a[40:43], v[120:123]
  v_fmac_f32 v152, v242, v240
  v_fmac_f32 v153, v243, v240
  v_mfma_f32_16x16x32_bf16 v[116:119], a[72:75], a[36:39], v[116:119]
  ds_read_b64_tr_b16 a[92:93], v224 offset:24576
  v_fmac_f32 v154, v244, v240
  v_mfma_f32_16x16x32_bf16 v[116:119], a[76:79], a[52:55], v[116:119]
  ds_read_b64_tr_b16 a[94:95], v224 offset:28672
  v_fmac_f32 v155, v245, v240
  v_mfma_f32_16x16x32_bf16 v[112:115], a[76:79], a[48:51], v[112:115]
  buffer_load_dwordx4 a[20:23], v231, s[4:7], s73 offen offset:3072 sc1
  v_mfma_f32_16x16x32_bf16 v[112:115], a[72:75], a[32:35], v[112:115]
  s_add_u32 s73, s73, 4096
  v_fmac_f32 v156, v242, v241
  v_fmac_f32 v157, v243, v241
  v_fmac_f32 v158, v244, v241
  v_fmac_f32 v159, v245, v241
  s_waitcnt vmcnt(18) lgkmcnt(4)
  v_mfma_f32_16x16x32_bf16 v[0:3], a[80:83], a[96:99], v[0:3]
  ds_read_b64_tr_b16 a[64:65], v225 offset:0
  v_fmac_f32 v160, v246, v238
  v_mfma_f32_16x16x32_bf16 v[0:3], a[84:87], a[112:115], v[0:3]
  s_waitcnt vmcnt(16)
  ds_read_b64_tr_b16 a[66:67], v225 offset:4096
  v_fmac_f32 v161, v247, v238
  v_mfma_f32_16x16x32_bf16 v[4:7], a[84:87], a[116:119], v[4:7]
  v_fmac_f32 v162, v248, v238
  v_fmac_f32 v163, v249, v238
  v_mfma_f32_16x16x32_bf16 v[4:7], a[80:83], a[100:103], v[4:7]
  s_waitcnt vmcnt(14)
  ds_read_b128 v[242:245], v237 offset:704
  v_fmac_f32 v164, v246, v239
  v_mfma_f32_16x16x32_bf16 v[8:11], a[80:83], a[104:107], v[8:11]
  ds_read_b64_tr_b16 a[68:69], v225 offset:8192
  v_fmac_f32 v165, v247, v239
  v_mfma_f32_16x16x32_bf16 v[8:11], a[84:87], a[120:123], v[8:11]
  s_waitcnt vmcnt(12)
  ds_read_b64_tr_b16 a[70:71], v225 offset:12288
  v_fmac_f32 v166, v248, v239
  v_mfma_f32_16x16x32_bf16 v[12:15], a[84:87], a[124:127], v[12:15]
  buffer_load_dwordx4 a[8:11], v231, s[4:7], s74 offen offset:2048 sc1
  v_mfma_f32_16x16x32_bf16 v[12:15], a[80:83], a[108:111], v[12:15]
  s_waitcnt lgkmcnt(5)
  v_fmac_f32 v167, v249, v239
  v_fmac_f32 v168, v246, v240
  v_mfma_f32_16x16x32_bf16 v[28:31], a[88:91], a[108:111], v[28:31]
  ds_read_b64_tr_b16 a[72:73], v225 offset:16384
  v_fmac_f32 v169, v247, v240
  v_mfma_f32_16x16x32_bf16 v[28:31], a[92:95], a[124:127], v[28:31]
  ds_read_b64_tr_b16 a[74:75], v225 offset:20480
  v_fmac_f32 v170, v248, v240
  v_mfma_f32_16x16x32_bf16 v[24:27], a[92:95], a[120:123], v[24:27]
  buffer_load_dwordx4 a[24:27], v231, s[4:7], s74 offen offset:3072 sc1
  v_mfma_f32_16x16x32_bf16 v[24:27], a[88:91], a[104:107], v[24:27]
  s_add_u32 s74, s74, 4096
  v_fmac_f32 v171, v249, v240
  v_fmac_f32 v172, v246, v241
  v_mfma_f32_16x16x32_bf16 v[20:23], a[88:91], a[100:103], v[20:23]
  ds_read_b64_tr_b16 a[76:77], v225 offset:24576
  v_fmac_f32 v173, v247, v241
  v_mfma_f32_16x16x32_bf16 v[20:23], a[92:95], a[116:119], v[20:23]
  ds_read_b64_tr_b16 a[78:79], v225 offset:28672
  v_fmac_f32 v174, v248, v241
  v_mfma_f32_16x16x32_bf16 v[16:19], a[92:95], a[112:115], v[16:19]
  buffer_load_dwordx4 a[12:15], v231, s[4:7], s75 offen offset:2048 sc1
  v_mfma_f32_16x16x32_bf16 v[16:19], a[88:91], a[96:99], v[16:19]
  v_fmac_f32 v175, v249, v241
  s_waitcnt lgkmcnt(4)
  v_mfma_f32_16x16x32_bf16 v[32:35], a[64:67], a[96:99], v[32:35]
  ds_read_b64_tr_b16 a[80:81], v226 offset:0
  v_fmac_f32 v176, v242, v238
  v_mfma_f32_16x16x32_bf16 v[32:35], a[68:71], a[112:115], v[32:35]
  ds_read_b64_tr_b16 a[82:83], v226 offset:4096
  v_fmac_f32 v177, v243, v238
  v_mfma_f32_16x16x32_bf16 v[36:39], a[68:71], a[116:119], v[36:39]
  buffer_load_dwordx4 a[28:31], v231, s[4:7], s75 offen offset:3072 sc1
  v_mfma_f32_16x16x32_bf16 v[36:39], a[64:67], a[100:103], v[36:39]
  s_add_u32 s75, s75, 4096
  ds_read_b128 v[246:249], v237 offset:768
  v_fmac_f32 v178, v244, v238
  v_mfma_f32_16x16x32_bf16 v[40:43], a[64:67], a[104:107], v[40:43]
  ds_read_b64_tr_b16 a[84:85], v226 offset:8192
  v_fmac_f32 v179, v245, v238
  v_mfma_f32_16x16x32_bf16 v[40:43], a[68:71], a[120:123], v[40:43]
  ds_read_b64_tr_b16 a[86:87], v226 offset:12288
  v_fmac_f32 v180, v242, v239
  v_mfma_f32_16x16x32_bf16 v[44:47], a[68:71], a[124:127], v[44:47]
  v_fmac_f32 v181, v243, v239
  v_fmac_f32 v182, v244, v239
  v_mfma_f32_16x16x32_bf16 v[44:47], a[64:67], a[108:111], v[44:47]
  s_waitcnt lgkmcnt(5)
  v_fmac_f32 v183, v245, v239
  v_fmac_f32 v184, v242, v240
  v_mfma_f32_16x16x32_bf16 v[60:63], a[72:75], a[108:111], v[60:63]
  ds_read_b64_tr_b16 a[88:89], v226 offset:16384
  v_fmac_f32 v185, v243, v240
  v_mfma_f32_16x16x32_bf16 v[60:63], a[76:79], a[124:127], v[60:63]
  ds_read_b64_tr_b16 a[90:91], v226 offset:20480
  v_fmac_f32 v186, v244, v240
  v_mfma_f32_16x16x32_bf16 v[56:59], a[76:79], a[120:123], v[56:59]
  v_fmac_f32 v187, v245, v240
  v_fmac_f32 v188, v242, v241
  v_mfma_f32_16x16x32_bf16 v[56:59], a[72:75], a[104:107], v[56:59]
  v_fmac_f32 v189, v243, v241
  v_fmac_f32 v190, v244, v241
  v_mfma_f32_16x16x32_bf16 v[52:55], a[72:75], a[100:103], v[52:55]
  s_add_u32 m0, s79, 0
  ds_read_b64_tr_b16 a[92:93], v226 offset:24576
  v_fmac_f32 v191, v245, v241
  v_mfma_f32_16x16x32_bf16 v[52:55], a[76:79], a[116:119], v[52:55]
  s_add_u32 s92, s92, 196608
  s_add_u32 s92, s92, s78
  s_add_u32 s93, s92, s88
  v_mfma_f32_16x16x32_bf16 v[48:51], a[76:79], a[112:115], v[48:51]
  ds_read_b64_tr_b16 a[94:95], v226 offset:28672
  v_mfma_f32_16x16x32_bf16 v[48:51], a[72:75], a[96:99], v[48:51]
  s_waitcnt lgkmcnt(4)
  buffer_load_dwordx4 v252, s[80:83], s93 offen lds
  v_mfma_f32_16x16x32_bf16 v[64:67], a[80:83], a[96:99], v[64:67]
  ds_read_b64_tr_b16 a[64:65], v228 offset:32768
  v_fmac_f32 v192, v246, v238
  v_mfma_f32_16x16x32_bf16 v[64:67], a[84:87], a[112:115], v[64:67]
  ds_read_b64_tr_b16 a[66:67], v228 offset:36864
  v_fmac_f32 v193, v247, v238
  v_mfma_f32_16x16x32_bf16 v[68:71], a[84:87], a[116:119], v[68:71]
  buffer_load_dwordx4 v252, s[84:87], s93 offen offset:1024 lds
  v_mfma_f32_16x16x32_bf16 v[68:71], a[80:83], a[100:103], v[68:71]
  ds_read_b128 v[242:245], v237 offset:832
  v_fmac_f32 v194, v248, v238
  v_mfma_f32_16x16x32_bf16 v[72:75], a[80:83], a[104:107], v[72:75]
  ds_read_b64_tr_b16 a[68:69], v228 offset:40960
  v_fmac_f32 v195, v249, v238
  v_mfma_f32_16x16x32_bf16 v[72:75], a[84:87], a[120:123], v[72:75]
  ds_read_b64_tr_b16 a[70:71], v228 offset:45056
  v_fmac_f32 v196, v246, v239
  v_mfma_f32_16x16x32_bf16 v[76:79], a[84:87], a[124:127], v[76:79]
  v_fmac_f32 v197, v247, v239
  v_fmac_f32 v198, v248, v239
  v_mfma_f32_16x16x32_bf16 v[76:79], a[80:83], a[108:111], v[76:79]
  s_waitcnt lgkmcnt(5)
  v_fmac_f32 v199, v249, v239
  v_fmac_f32 v200, v246, v240
  v_mfma_f32_16x16x32_bf16 v[92:95], a[88:91], a[108:111], v[92:95]
  s_add_u32 m0, s79, 8192
  ds_read_b64_tr_b16 a[72:73], v228 offset:49152
  v_fmac_f32 v201, v247, v240
  v_mfma_f32_16x16x32_bf16 v[92:95], a[92:95], a[124:127], v[92:95]
  s_add_u32 s92, s92, 458752
  s_add_u32 s93, s92, s88
  ds_read_b64_tr_b16 a[74:75], v228 offset:53248
  v_fmac_f32 v202, v248, v240
  v_mfma_f32_16x16x32_bf16 v[88:91], a[92:95], a[120:123], v[88:91]
  buffer_load_dwordx4 v252, s[80:83], s93 offen lds
  v_mfma_f32_16x16x32_bf16 v[88:91], a[88:91], a[104:107], v[88:91]
  v_fmac_f32 v203, v249, v240
  v_fmac_f32 v204, v246, v241
  v_mfma_f32_16x16x32_bf16 v[84:87], a[88:91], a[100:103], v[84:87]
  ds_read_b64_tr_b16 a[76:77], v228 offset:57344
  v_fmac_f32 v205, v247, v241
  v_mfma_f32_16x16x32_bf16 v[84:87], a[92:95], a[116:119], v[84:87]
  ds_read_b64_tr_b16 a[78:79], v228 offset:61440
  v_xor_b32 v228, 0x10000, v228
  v_fmac_f32 v206, v248, v241
  v_mfma_f32_16x16x32_bf16 v[80:83], a[92:95], a[112:115], v[80:83]
  buffer_load_dwordx4 v252, s[84:87], s93 offen offset:1024 lds
  v_mfma_f32_16x16x32_bf16 v[80:83], a[88:91], a[96:99], v[80:83]
  v_fmac_f32 v207, v249, v241
  s_waitcnt lgkmcnt(4)
  v_mfma_f32_16x16x32_bf16 v[128:131], a[64:67], a[32:35], v[128:131]
  s_waitcnt vmcnt(12)
  s_barrier
  ds_read_b64_tr_b16 a[80:81], v224 offset:32768
  v_mfma_f32_16x16x32_bf16 v[128:131], a[68:71], a[48:51], v[128:131]
  ds_read_b64_tr_b16 a[82:83], v224 offset:36864
  v_fmac_f32 v208, v242, v238
  v_mfma_f32_16x16x32_bf16 v[132:135], a[68:71], a[52:55], v[132:135]
  v_fmac_f32 v209, v243, v238
  v_fmac_f32 v210, v244, v238
  v_mfma_f32_16x16x32_bf16 v[132:135], a[64:67], a[36:39], v[132:135]
  v_fmac_f32 v211, v245, v238
  v_fmac_f32 v212, v242, v239
  v_mfma_f32_16x16x32_bf16 v[136:139], a[64:67], a[40:43], v[136:139]
  s_add_u32 m0, s79, 16384
  ds_read_b64_tr_b16 a[84:85], v224 offset:40960
  v_fmac_f32 v213, v243, v239
  v_mfma_f32_16x16x32_bf16 v[136:139], a[68:71], a[56:59], v[136:139]
  s_add_u32 s92, s92, 458752
  s_add_u32 s93, s92, s88
  ds_read_b64_tr_b16 a[86:87], v224 offset:45056
  v_fmac_f32 v214, v244, v239
  v_mfma_f32_16x16x32_bf16 v[140:143], a[68:71], a[60:63], v[140:143]
  buffer_load_dwordx4 v252, s[80:83], s93 offen lds
  v_mfma_f32_16x16x32_bf16 v[140:143], a[64:67], a[44:47], v[140:143]
  s_waitcnt lgkmcnt(4)
  v_fmac_f32 v215, v245, v239
  v_fmac_f32 v216, v242, v240
  v_mfma_f32_16x16x32_bf16 v[156:159], a[72:75], a[44:47], v[156:159]
  ds_read_b64_tr_b16 a[88:89], v224 offset:49152
  v_fmac_f32 v217, v243, v240
  v_mfma_f32_16x16x32_bf16 v[156:159], a[76:79], a[60:63], v[156:159]
  ds_read_b64_tr_b16 a[90:91], v224 offset:53248
  v_fmac_f32 v218, v244, v240
  v_mfma_f32_16x16x32_bf16 v[152:155], a[76:79], a[56:59], v[152:155]
  buffer_load_dwordx4 v252, s[84:87], s93 offen offset:1024 lds
  v_mfma_f32_16x16x32_bf16 v[152:155], a[72:75], a[40:43], v[152:155]
  v_fmac_f32 v219, v245, v240
  v_fmac_f32 v220, v242, v241
  v_mfma_f32_16x16x32_bf16 v[148:151], a[72:75], a[36:39], v[148:151]
  ds_read_b64_tr_b16 a[92:93], v224 offset:57344
  v_fmac_f32 v221, v243, v241
  v_mfma_f32_16x16x32_bf16 v[148:151], a[76:79], a[52:55], v[148:151]
  ds_read_b64_tr_b16 a[94:95], v224 offset:61440
  v_fmac_f32 v222, v244, v241
  v_mfma_f32_16x16x32_bf16 v[144:147], a[76:79], a[48:51], v[144:147]
  v_fmac_f32 v223, v245, v241
  v_mfma_f32_16x16x32_bf16 v[144:147], a[72:75], a[32:35], v[144:147]
  s_waitcnt vmcnt(12) lgkmcnt(4)
  v_mfma_f32_16x16x32_bf16 v[0:3], a[80:83], a[0:3], v[0:3]
  s_add_u32 m0, s79, 24576
  ds_read_b64_tr_b16 a[64:65], v229 offset:32768
  v_and_b32 v236, 31, v253
  v_mfma_f32_16x16x32_bf16 v[0:3], a[84:87], a[16:19], v[0:3]
  s_add_u32 s92, s92, 458752
  s_add_u32 s93, s92, s88
  ds_read_b64_tr_b16 a[66:67], v229 offset:36864
  v_lshlrev_b32 v236, 4, v236
  s_waitcnt vmcnt(10)
  v_mfma_f32_16x16x32_bf16 v[4:7], a[84:87], a[20:23], v[4:7]
  buffer_load_dwordx4 v252, s[80:83], s93 offen lds
  v_mfma_f32_16x16x32_bf16 v[4:7], a[80:83], a[4:7], v[4:7]
  v_lshrrev_b32 v250, 5, v253
  s_waitcnt vmcnt(9)
  v_mfma_f32_16x16x32_bf16 v[8:11], a[80:83], a[8:11], v[8:11]
  s_mov_b32 s43, 114688
  ds_read_b64_tr_b16 a[68:69], v229 offset:40960
  v_mad_u32_u24 v236, v250, s43, v236
  v_mfma_f32_16x16x32_bf16 v[8:11], a[84:87], a[24:27], v[8:11]
  s_waitcnt vmcnt(7)
  ds_read_b64_tr_b16 a[70:71], v229 offset:45056
  v_and_b32 v250, 15, v253
  v_mfma_f32_16x16x32_bf16 v[12:15], a[84:87], a[28:31], v[12:15]
  s_add_u32 s43, s71, 1024
  buffer_load_dwordx4 v252, s[84:87], s93 offen offset:1024 lds
  v_mfma_f32_16x16x32_bf16 v[12:15], a[80:83], a[12:15], v[12:15]
  s_waitcnt lgkmcnt(4)
  v_lshl_add_u32 v250, v250, 2, s43
  v_mfma_f32_16x16x32_bf16 v[28:31], a[88:91], a[12:15], v[28:31]
  ds_read2_b32 v[238:239], v250 offset0:64 offset1:80
  ds_read_b64_tr_b16 a[72:73], v229 offset:49152
  v_mfma_f32_16x16x32_bf16 v[28:31], a[92:95], a[28:31], v[28:31]
  ds_read2_b32 v[240:241], v250 offset0:96 offset1:112
  ds_read_b64_tr_b16 a[74:75], v229 offset:53248
  v_mfma_f32_16x16x32_bf16 v[24:27], a[92:95], a[24:27], v[24:27]
  ds_read2_b32 v[232:233], v250 offset0:128 offset1:144
  v_mfma_f32_16x16x32_bf16 v[24:27], a[88:91], a[8:11], v[24:27]
  ds_read2_b32 v[234:235], v250 offset0:160 offset1:176
  v_mfma_f32_16x16x32_bf16 v[20:23], a[88:91], a[4:7], v[20:23]
  ds_read_b64_tr_b16 a[76:77], v229 offset:57344
  v_mfma_f32_16x16x32_bf16 v[20:23], a[92:95], a[20:23], v[20:23]
  ds_read_b64_tr_b16 a[78:79], v229 offset:61440
  v_xor_b32 v229, 0x10000, v229
  v_mfma_f32_16x16x32_bf16 v[16:19], a[92:95], a[16:19], v[16:19]
  v_mfma_f32_16x16x32_bf16 v[16:19], a[88:91], a[0:3], v[16:19]
  s_waitcnt lgkmcnt(8)
  v_mfma_f32_16x16x32_bf16 v[160:163], a[64:67], a[32:35], v[160:163]
  ds_read_b64_tr_b16 a[80:81], v225 offset:32768
  v_mfma_f32_16x16x32_bf16 v[160:163], a[68:71], a[48:51], v[160:163]
  ds_read_b64_tr_b16 a[82:83], v225 offset:36864
  v_mfma_f32_16x16x32_bf16 v[164:167], a[68:71], a[52:55], v[164:167]
  s_waitcnt lgkmcnt(4)
  v_mfma_f32_16x16x32_bf16 v[164:167], a[64:67], a[36:39], v[164:167]
  v_pk_mul_f32 v[242:243], v[0:1], v[238:239] op_sel:[0,0] op_sel_hi:[1,0]
  v_pk_mul_f32 v[244:245], v[2:3], v[238:239] op_sel:[0,0] op_sel_hi:[1,0]
  v_pk_mul_f32 v[0:1], v[0:1], v[16:17]
  v_pk_mul_f32 v[2:3], v[2:3], v[18:19]
  v_mfma_f32_16x16x32_bf16 v[168:171], a[64:67], a[40:43], v[168:171]
  ds_read_b64_tr_b16 a[84:85], v225 offset:40960
  v_mfma_f32_16x16x32_bf16 v[168:171], a[68:71], a[56:59], v[168:171]
  ds_read_b64_tr_b16 a[86:87], v225 offset:45056
  v_mfma_f32_16x16x32_bf16 v[172:175], a[68:71], a[60:63], v[172:175]
  v_mfma_f32_16x16x32_bf16 v[172:175], a[64:67], a[44:47], v[172:175]
  s_waitcnt lgkmcnt(4)
  v_mfma_f32_16x16x32_bf16 v[188:191], a[72:75], a[44:47], v[188:191]
  v_exp_f32 v242, v242
  v_mfma_f32_16x16x32_bf16 v[188:191], a[76:79], a[60:63], v[188:191]
  v_exp_f32 v243, v243
  v_mfma_f32_16x16x32_bf16 v[184:187], a[76:79], a[56:59], v[184:187]
  ds_read_b64_tr_b16 a[88:89], v225 offset:49152
  ds_read_b64_tr_b16 a[90:91], v225 offset:53248
  v_mfma_f32_16x16x32_bf16 v[184:187], a[72:75], a[40:43], v[184:187]
  v_exp_f32 v244, v244
  v_exp_f32 v245, v245
  s_nop 0
  v_pk_fma_f32 v[242:243], v[242:243], v[232:233], v[232:233] op_sel:[0,0,0] op_sel_hi:[1,0,0]
  v_pk_fma_f32 v[244:245], v[244:245], v[232:233], v[232:233] op_sel:[0,0,0] op_sel_hi:[1,0,0]
  v_pk_mul_f32 v[246:247], v[4:5], v[238:239] op_sel:[0,1] op_sel_hi:[1,1]
  v_pk_mul_f32 v[248:249], v[6:7], v[238:239] op_sel:[0,1] op_sel_hi:[1,1]
  v_pk_mul_f32 v[4:5], v[4:5], v[20:21]
  v_pk_mul_f32 v[6:7], v[6:7], v[22:23]
  v_rcp_f32 v242, v242
  v_mfma_f32_16x16x32_bf16 v[180:183], a[72:75], a[36:39], v[180:183]
  v_rcp_f32 v243, v243
  v_mfma_f32_16x16x32_bf16 v[180:183], a[76:79], a[52:55], v[180:183]
  v_rcp_f32 v244, v244
  v_mfma_f32_16x16x32_bf16 v[176:179], a[76:79], a[48:51], v[176:179]
  ds_read_b64_tr_b16 a[92:93], v225 offset:57344
  v_mfma_f32_16x16x32_bf16 v[176:179], a[72:75], a[32:35], v[176:179]
  ds_read_b64_tr_b16 a[94:95], v225 offset:61440
  s_waitcnt lgkmcnt(4)
  v_mfma_f32_16x16x32_bf16 v[32:35], a[80:83], a[0:3], v[32:35]
  v_exp_f32 v246, v246
  v_mfma_f32_16x16x32_bf16 v[32:35], a[84:87], a[16:19], v[32:35]
  v_exp_f32 v247, v247
  v_mfma_f32_16x16x32_bf16 v[36:39], a[84:87], a[20:23], v[36:39]
  ds_read_b64_tr_b16 a[64:65], v230 offset:32768
  ds_read_b64_tr_b16 a[66:67], v230 offset:36864
  v_mfma_f32_16x16x32_bf16 v[36:39], a[80:83], a[4:7], v[36:39]
  v_exp_f32 v248, v248
  v_exp_f32 v249, v249
  v_rcp_f32 v245, v245
  v_pk_fma_f32 v[246:247], v[246:247], v[232:233], v[232:233] op_sel:[0,1,1] op_sel_hi:[1,1,1]
  v_pk_fma_f32 v[248:249], v[248:249], v[232:233], v[232:233] op_sel:[0,1,1] op_sel_hi:[1,1,1]
  v_pk_mul_f32 v[0:1], v[0:1], v[242:243]
  v_pk_mul_f32 v[2:3], v[2:3], v[244:245]
  v_pk_mul_f32 v[242:243], v[8:9], v[240:241] op_sel:[0,0] op_sel_hi:[1,0]
  v_pk_mul_f32 v[244:245], v[10:11], v[240:241] op_sel:[0,0] op_sel_hi:[1,0]
  v_pk_mul_f32 v[8:9], v[8:9], v[24:25]
  v_pk_mul_f32 v[10:11], v[10:11], v[26:27]
  v_rcp_f32 v246, v246
  v_mfma_f32_16x16x32_bf16 v[40:43], a[80:83], a[8:11], v[40:43]
  v_rcp_f32 v247, v247
  v_mfma_f32_16x16x32_bf16 v[40:43], a[84:87], a[24:27], v[40:43]
  v_rcp_f32 v248, v248
  v_mfma_f32_16x16x32_bf16 v[44:47], a[84:87], a[28:31], v[44:47]
  ds_read_b64_tr_b16 a[68:69], v230 offset:40960
  v_cvt_pk_bf16_f32 v16, v0, v1
  v_mfma_f32_16x16x32_bf16 v[44:47], a[80:83], a[12:15], v[44:47]
  s_waitcnt lgkmcnt(3)
  ds_read_b64_tr_b16 a[70:71], v230 offset:45056
  v_cvt_pk_bf16_f32 v17, v2, v3
  v_mfma_f32_16x16x32_bf16 v[60:63], a[88:91], a[12:15], v[60:63]
  v_exp_f32 v242, v242
  v_mfma_f32_16x16x32_bf16 v[60:63], a[92:95], a[28:31], v[60:63]
  v_exp_f32 v243, v243
  v_mfma_f32_16x16x32_bf16 v[56:59], a[92:95], a[24:27], v[56:59]
  ds_read_b64_tr_b16 a[72:73], v230 offset:49152
  ds_read_b64_tr_b16 a[74:75], v230 offset:53248
  v_mfma_f32_16x16x32_bf16 v[56:59], a[88:91], a[8:11], v[56:59]
  v_exp_f32 v244, v244
  v_exp_f32 v245, v245
  v_rcp_f32 v249, v249
  v_pk_fma_f32 v[242:243], v[242:243], v[234:235], v[234:235] op_sel:[0,0,0] op_sel_hi:[1,0,0]
  v_pk_fma_f32 v[244:245], v[244:245], v[234:235], v[234:235] op_sel:[0,0,0] op_sel_hi:[1,0,0]
  v_pk_mul_f32 v[4:5], v[4:5], v[246:247]
  v_pk_mul_f32 v[6:7], v[6:7], v[248:249]
  v_pk_mul_f32 v[246:247], v[12:13], v[240:241] op_sel:[0,1] op_sel_hi:[1,1]
  v_pk_mul_f32 v[248:249], v[14:15], v[240:241] op_sel:[0,1] op_sel_hi:[1,1]
  v_pk_mul_f32 v[12:13], v[12:13], v[28:29]
  v_pk_mul_f32 v[14:15], v[14:15], v[30:31]
  v_rcp_f32 v242, v242
  v_mfma_f32_16x16x32_bf16 v[52:55], a[88:91], a[4:7], v[52:55]
  v_rcp_f32 v243, v243
  v_mfma_f32_16x16x32_bf16 v[52:55], a[92:95], a[20:23], v[52:55]
  v_rcp_f32 v244, v244
  v_mfma_f32_16x16x32_bf16 v[48:51], a[92:95], a[16:19], v[48:51]
  ds_read_b64_tr_b16 a[76:77], v230 offset:57344
  v_cvt_pk_bf16_f32 v18, v4, v5
  v_mfma_f32_16x16x32_bf16 v[48:51], a[88:91], a[0:3], v[48:51]
  s_waitcnt lgkmcnt(3)
  ds_read_b64_tr_b16 a[78:79], v230 offset:61440
  v_xor_b32 v230, 0x10000, v230
  v_cvt_pk_bf16_f32 v19, v6, v7
  v_mfma_f32_16x16x32_bf16 v[192:195], a[64:67], a[32:35], v[192:195]
  s_nop 1
  v_permlane32_swap_b32 v16, v18
  v_permlane32_swap_b32 v17, v19
  buffer_store_dwordx4 v[16:19], v236, s[4:7], s61 offen sc1
  v_exp_f32 v246, v246
  v_mfma_f32_16x16x32_bf16 v[192:195], a[68:71], a[48:51], v[192:195]
  v_exp_f32 v247, v247
  v_mfma_f32_16x16x32_bf16 v[196:199], a[68:71], a[52:55], v[196:199]
  ds_read_b64_tr_b16 a[80:81], v226 offset:32768
  ds_read_b64_tr_b16 a[82:83], v226 offset:36864
  v_mfma_f32_16x16x32_bf16 v[196:199], a[64:67], a[36:39], v[196:199]
  v_exp_f32 v248, v248
  v_exp_f32 v249, v249
  v_rcp_f32 v245, v245
  v_pk_fma_f32 v[246:247], v[246:247], v[234:235], v[234:235] op_sel:[0,1,1] op_sel_hi:[1,1,1]
  v_pk_fma_f32 v[248:249], v[248:249], v[234:235], v[234:235] op_sel:[0,1,1] op_sel_hi:[1,1,1]
  v_pk_mul_f32 v[8:9], v[8:9], v[242:243]
  v_pk_mul_f32 v[10:11], v[10:11], v[244:245]
  v_pk_mul_f32 v[242:243], v[32:33], v[238:239] op_sel:[0,0] op_sel_hi:[1,0]
  v_pk_mul_f32 v[244:245], v[34:35], v[238:239] op_sel:[0,0] op_sel_hi:[1,0]
  v_pk_mul_f32 v[32:33], v[32:33], v[48:49]
  v_pk_mul_f32 v[34:35], v[34:35], v[50:51]
  v_rcp_f32 v246, v246
  v_mfma_f32_16x16x32_bf16 v[200:203], a[64:67], a[40:43], v[200:203]
  v_rcp_f32 v247, v247
  v_mfma_f32_16x16x32_bf16 v[200:203], a[68:71], a[56:59], v[200:203]
  v_rcp_f32 v248, v248
  v_mfma_f32_16x16x32_bf16 v[204:207], a[68:71], a[60:63], v[204:207]
  ds_read_b64_tr_b16 a[84:85], v226 offset:40960
  v_cvt_pk_bf16_f32 v24, v8, v9
  v_mfma_f32_16x16x32_bf16 v[204:207], a[64:67], a[44:47], v[204:207]
  s_waitcnt lgkmcnt(3)
  ds_read_b64_tr_b16 a[86:87], v226 offset:45056
  v_cvt_pk_bf16_f32 v25, v10, v11
  v_mfma_f32_16x16x32_bf16 v[220:223], a[72:75], a[44:47], v[220:223]
  v_exp_f32 v242, v242
  v_mfma_f32_16x16x32_bf16 v[220:223], a[76:79], a[60:63], v[220:223]
  v_exp_f32 v243, v243
  v_mfma_f32_16x16x32_bf16 v[216:219], a[76:79], a[56:59], v[216:219]
  ds_read_b64_tr_b16 a[88:89], v226 offset:49152
  ds_read_b64_tr_b16 a[90:91], v226 offset:53248
  v_mfma_f32_16x16x32_bf16 v[216:219], a[72:75], a[40:43], v[216:219]
  v_exp_f32 v244, v244
  v_exp_f32 v245, v245
  v_rcp_f32 v249, v249
  v_pk_fma_f32 v[242:243], v[242:243], v[232:233], v[232:233] op_sel:[0,0,0] op_sel_hi:[1,0,0]
  v_pk_fma_f32 v[244:245], v[244:245], v[232:233], v[232:233] op_sel:[0,0,0] op_sel_hi:[1,0,0]
  v_pk_mul_f32 v[12:13], v[12:13], v[246:247]
  v_pk_mul_f32 v[14:15], v[14:15], v[248:249]
  v_pk_mul_f32 v[246:247], v[36:37], v[238:239] op_sel:[0,1] op_sel_hi:[1,1]
  v_pk_mul_f32 v[248:249], v[38:39], v[238:239] op_sel:[0,1] op_sel_hi:[1,1]
  v_pk_mul_f32 v[36:37], v[36:37], v[52:53]
  v_pk_mul_f32 v[38:39], v[38:39], v[54:55]
  v_rcp_f32 v242, v242
  v_mfma_f32_16x16x32_bf16 v[212:215], a[72:75], a[36:39], v[212:215]
  v_rcp_f32 v243, v243
  v_mfma_f32_16x16x32_bf16 v[212:215], a[76:79], a[52:55], v[212:215]
  v_rcp_f32 v244, v244
  v_mfma_f32_16x16x32_bf16 v[208:211], a[76:79], a[48:51], v[208:211]
  ds_read_b64_tr_b16 a[92:93], v226 offset:57344
  v_cvt_pk_bf16_f32 v26, v12, v13
  v_mfma_f32_16x16x32_bf16 v[208:211], a[72:75], a[32:35], v[208:211]
  s_waitcnt lgkmcnt(3)
  ds_read_b64_tr_b16 a[94:95], v226 offset:61440
  v_cvt_pk_bf16_f32 v27, v14, v15
  v_mfma_f32_16x16x32_bf16 v[64:67], a[80:83], a[0:3], v[64:67]
  s_nop 1
  v_permlane32_swap_b32 v24, v26
  v_permlane32_swap_b32 v25, v27
  buffer_store_dwordx4 v[24:27], v236, s[4:7], s62 offen sc1
  v_exp_f32 v246, v246
  v_mfma_f32_16x16x32_bf16 v[64:67], a[84:87], a[16:19], v[64:67]
  v_exp_f32 v247, v247
  v_mfma_f32_16x16x32_bf16 v[68:71], a[84:87], a[20:23], v[68:71]
  ds_read_b64_tr_b16 a[64:65], v227 offset:0
  ds_read_b64_tr_b16 a[66:67], v227 offset:4096
  v_mfma_f32_16x16x32_bf16 v[68:71], a[80:83], a[4:7], v[68:71]
  v_exp_f32 v248, v248
  v_exp_f32 v249, v249
  v_rcp_f32 v245, v245
  v_pk_fma_f32 v[246:247], v[246:247], v[232:233], v[232:233] op_sel:[0,1,1] op_sel_hi:[1,1,1]
  v_pk_fma_f32 v[248:249], v[248:249], v[232:233], v[232:233] op_sel:[0,1,1] op_sel_hi:[1,1,1]
  v_pk_mul_f32 v[32:33], v[32:33], v[242:243]
  v_pk_mul_f32 v[34:35], v[34:35], v[244:245]
  v_pk_mul_f32 v[242:243], v[40:41], v[240:241] op_sel:[0,0] op_sel_hi:[1,0]
  v_pk_mul_f32 v[244:245], v[42:43], v[240:241] op_sel:[0,0] op_sel_hi:[1,0]
  v_pk_mul_f32 v[40:41], v[40:41], v[56:57]
  v_pk_mul_f32 v[42:43], v[42:43], v[58:59]
  v_rcp_f32 v246, v246
  v_mfma_f32_16x16x32_bf16 v[72:75], a[80:83], a[8:11], v[72:75]
  v_rcp_f32 v247, v247
  v_lshlrev_b32 v8, 4, v253
  v_mfma_f32_16x16x32_bf16 v[72:75], a[84:87], a[24:27], v[72:75]
  v_rcp_f32 v248, v248
  v_add_u32 v9, 114688, v8
  v_mfma_f32_16x16x32_bf16 v[76:79], a[84:87], a[28:31], v[76:79]
  ds_read_b64_tr_b16 a[68:69], v227 offset:8192
  v_cvt_pk_bf16_f32 v48, v32, v33
  v_mfma_f32_16x16x32_bf16 v[76:79], a[80:83], a[12:15], v[76:79]
  s_waitcnt lgkmcnt(3)
  ds_read_b64_tr_b16 a[70:71], v227 offset:12288
  v_cvt_pk_bf16_f32 v49, v34, v35
  v_mfma_f32_16x16x32_bf16 v[92:95], a[88:91], a[12:15], v[92:95]
  buffer_load_dwordx4 v[16:19], v8, s[4:7], s46 offen offset:0 sc1
  v_exp_f32 v242, v242
  v_mfma_f32_16x16x32_bf16 v[92:95], a[92:95], a[28:31], v[92:95]
  buffer_load_dwordx4 v[20:23], v8, s[4:7], s46 offen offset:1024 sc1
  v_exp_f32 v243, v243
  v_mfma_f32_16x16x32_bf16 v[88:91], a[92:95], a[24:27], v[88:91]
  ds_read_b64_tr_b16 a[72:73], v227 offset:16384
  ds_read_b64_tr_b16 a[74:75], v227 offset:20480
  v_mfma_f32_16x16x32_bf16 v[88:91], a[88:91], a[8:11], v[88:91]
  v_exp_f32 v244, v244
  v_exp_f32 v245, v245
  v_rcp_f32 v249, v249
  v_pk_fma_f32 v[242:243], v[242:243], v[234:235], v[234:235] op_sel:[0,0,0] op_sel_hi:[1,0,0]
  v_pk_fma_f32 v[244:245], v[244:245], v[234:235], v[234:235] op_sel:[0,0,0] op_sel_hi:[1,0,0]
  v_pk_mul_f32 v[36:37], v[36:37], v[246:247]
  v_pk_mul_f32 v[38:39], v[38:39], v[248:249]
  v_pk_mul_f32 v[246:247], v[44:45], v[240:241] op_sel:[0,1] op_sel_hi:[1,1]
  v_pk_mul_f32 v[248:249], v[46:47], v[240:241] op_sel:[0,1] op_sel_hi:[1,1]
  v_pk_mul_f32 v[44:45], v[44:45], v[60:61]
  v_pk_mul_f32 v[46:47], v[46:47], v[62:63]
  v_rcp_f32 v242, v242
  v_mfma_f32_16x16x32_bf16 v[84:87], a[88:91], a[4:7], v[84:87]
  buffer_load_dwordx4 v[24:27], v8, s[4:7], s47 offen offset:0 sc1
  v_rcp_f32 v243, v243
  v_mfma_f32_16x16x32_bf16 v[84:87], a[92:95], a[20:23], v[84:87]
  buffer_load_dwordx4 v[28:31], v8, s[4:7], s47 offen offset:1024 sc1
  v_rcp_f32 v244, v244
  v_mfma_f32_16x16x32_bf16 v[80:83], a[92:95], a[16:19], v[80:83]
  ds_read_b64_tr_b16 a[76:77], v227 offset:24576
  v_cvt_pk_bf16_f32 v52, v36, v37
  v_mfma_f32_16x16x32_bf16 v[80:83], a[88:91], a[0:3], v[80:83]
  s_waitcnt lgkmcnt(3)
  ds_read_b64_tr_b16 a[78:79], v227 offset:28672
  v_cvt_pk_bf16_f32 v53, v38, v39
  v_mfma_f32_16x16x32_bf16 v[96:99], a[64:67], a[96:99], v[96:99]
  v_exp_f32 v246, v246
  v_bfe_u32 v11, v253, 2, 3
  v_mfma_f32_16x16x32_bf16 v[96:99], a[68:71], a[112:115], v[96:99]
  v_exp_f32 v247, v247
  v_bfe_u32 v12, v253, 3, 2
  v_mfma_f32_16x16x32_bf16 v[100:103], a[68:71], a[116:119], v[100:103]
  ds_read_b64_tr_b16 a[80:81], v227 offset:32768
  ds_read_b64_tr_b16 a[82:83], v227 offset:36864
  v_mfma_f32_16x16x32_bf16 v[100:103], a[64:67], a[100:103], v[100:103]
  v_exp_f32 v248, v248
  v_exp_f32 v249, v249
  v_rcp_f32 v245, v245
  v_pk_fma_f32 v[246:247], v[246:247], v[234:235], v[234:235] op_sel:[0,1,1] op_sel_hi:[1,1,1]
  v_pk_fma_f32 v[248:249], v[248:249], v[234:235], v[234:235] op_sel:[0,1,1] op_sel_hi:[1,1,1]
  v_pk_mul_f32 v[40:41], v[40:41], v[242:243]
  v_pk_mul_f32 v[42:43], v[42:43], v[244:245]
  v_pk_mul_f32 v[242:243], v[64:65], v[238:239] op_sel:[0,0] op_sel_hi:[1,0]
  v_pk_mul_f32 v[244:245], v[66:67], v[238:239] op_sel:[0,0] op_sel_hi:[1,0]
  v_pk_mul_f32 v[64:65], v[64:65], v[80:81]
  v_pk_mul_f32 v[66:67], v[66:67], v[82:83]
  v_rcp_f32 v246, v246
  v_mfma_f32_16x16x32_bf16 v[104:107], a[64:67], a[104:107], v[104:107]
  v_rcp_f32 v247, v247
  v_and_b32 v13, 3, v253
  v_mfma_f32_16x16x32_bf16 v[104:107], a[68:71], a[120:123], v[104:107]
  v_rcp_f32 v248, v248
  v_lshlrev_b32 v13, 3, v13
  v_mfma_f32_16x16x32_bf16 v[108:111], a[68:71], a[124:127], v[108:111]
  ds_read_b64_tr_b16 a[84:85], v227 offset:40960
  v_cvt_pk_bf16_f32 v56, v40, v41
  v_mfma_f32_16x16x32_bf16 v[108:111], a[64:67], a[108:111], v[108:111]
  s_waitcnt lgkmcnt(3)
  ds_read_b64_tr_b16 a[86:87], v227 offset:45056
  v_cvt_pk_bf16_f32 v57, v42, v43
  v_mfma_f32_16x16x32_bf16 v[124:127], a[72:75], a[108:111], v[124:127]
  v_exp_f32 v242, v242
  v_lshl_add_u32 v13, v11, 7, v13
  v_mfma_f32_16x16x32_bf16 v[124:127], a[76:79], a[124:127], v[124:127]
  v_exp_f32 v243, v243
  v_lshrrev_b32 v11, 5, v253
  v_mfma_f32_16x16x32_bf16 v[120:123], a[76:79], a[120:123], v[120:123]
  ds_read_b64_tr_b16 a[88:89], v227 offset:49152
  ds_read_b64_tr_b16 a[90:91], v227 offset:53248
  v_mfma_f32_16x16x32_bf16 v[120:123], a[72:75], a[104:107], v[120:123]
  v_exp_f32 v244, v244
  v_exp_f32 v245, v245
  v_rcp_f32 v249, v249
  v_pk_fma_f32 v[242:243], v[242:243], v[232:233], v[232:233] op_sel:[0,0,0] op_sel_hi:[1,0,0]
  v_pk_fma_f32 v[244:245], v[244:245], v[232:233], v[232:233] op_sel:[0,0,0] op_sel_hi:[1,0,0]
  v_pk_mul_f32 v[44:45], v[44:45], v[246:247]
  v_pk_mul_f32 v[46:47], v[46:47], v[248:249]
  v_pk_mul_f32 v[246:247], v[68:69], v[238:239] op_sel:[0,1] op_sel_hi:[1,1]
  v_pk_mul_f32 v[248:249], v[70:71], v[238:239] op_sel:[0,1] op_sel_hi:[1,1]
  v_pk_mul_f32 v[68:69], v[68:69], v[84:85]
  v_pk_mul_f32 v[70:71], v[70:71], v[86:87]
  v_rcp_f32 v242, v242
  v_mfma_f32_16x16x32_bf16 v[116:119], a[72:75], a[100:103], v[116:119]
  s_waitcnt vmcnt(4)
  s_barrier
  s_cmp_lg_u32 s40, 0
  s_cbranch_scc1 Lsgf20
  v_mov_b32 v250, 1
  s_mov_b64 exec, 1
  buffer_atomic_add v250, v251, s[4:7], s77 offen sc1
  s_mov_b64 exec, -1
Lsgf20:
  s_add_u32 s77, s77, 4096
  v_rcp_f32 v243, v243
  v_lshl_add_u32 v13, v11, 11, v13
  v_mfma_f32_16x16x32_bf16 v[116:119], a[76:79], a[116:119], v[116:119]
  s_add_u32 m0, s79, 32768
  v_rcp_f32 v244, v244
  v_xor_b32 v11, 0, v12
  v_mfma_f32_16x16x32_bf16 v[112:115], a[76:79], a[112:115], v[112:115]
  s_add_u32 s92, s92, 458752
  s_sub_u32 s93, s92, s88
  ds_read_b64_tr_b16 a[92:93], v227 offset:57344
  v_cvt_pk_bf16_f32 v60, v44, v45
  v_mfma_f32_16x16x32_bf16 v[112:115], a[72:75], a[96:99], v[112:115]
  s_waitcnt lgkmcnt(3)
  ds_read_b64_tr_b16 a[94:95], v227 offset:61440
  v_cvt_pk_bf16_f32 v61, v46, v47
  v_mfma_f32_16x16x32_bf16 v[96:99], a[80:83], a[0:3], v[96:99]
  buffer_load_dwordx4 v252, s[80:83], s93 offen lds
  v_exp_f32 v246, v246
  v_mfma_f32_16x16x32_bf16 v[96:99], a[84:87], a[16:19], v[96:99]
  buffer_load_dwordx4 v252, s[84:87], s93 offen offset:1024 lds
  v_exp_f32 v247, v247
  v_mfma_f32_16x16x32_bf16 v[100:103], a[84:87], a[20:23], v[100:103]
  ds_read_b64_tr_b16 a[64:65], v228 offset:0
  ds_read_b64_tr_b16 a[66:67], v228 offset:4096
  v_mfma_f32_16x16x32_bf16 v[100:103], a[80:83], a[4:7], v[100:103]
  v_exp_f32 v248, v248
  v_exp_f32 v249, v249
  v_rcp_f32 v245, v245
  v_pk_fma_f32 v[246:247], v[246:247], v[232:233], v[232:233] op_sel:[0,1,1] op_sel_hi:[1,1,1]
  v_pk_fma_f32 v[248:249], v[248:249], v[232:233], v[232:233] op_sel:[0,1,1] op_sel_hi:[1,1,1]
  v_pk_mul_f32 v[64:65], v[64:65], v[242:243]
  v_pk_mul_f32 v[66:67], v[66:67], v[244:245]
  v_pk_mul_f32 v[242:243], v[72:73], v[240:241] op_sel:[0,0] op_sel_hi:[1,0]
  v_pk_mul_f32 v[244:245], v[74:75], v[240:241] op_sel:[0,0] op_sel_hi:[1,0]
  v_pk_mul_f32 v[72:73], v[72:73], v[88:89]
  v_pk_mul_f32 v[74:75], v[74:75], v[90:91]
  v_rcp_f32 v246, v246
  v_mfma_f32_16x16x32_bf16 v[104:107], a[80:83], a[8:11], v[104:107]
  s_add_u32 m0, s79, 40960
  v_rcp_f32 v247, v247
  v_lshl_add_u32 v0, v11, 5, v13
  v_mfma_f32_16x16x32_bf16 v[104:107], a[84:87], a[24:27], v[104:107]
  s_add_u32 s92, s92, 458752
  s_sub_u32 s93, s92, s88
  buffer_load_dwordx4 v252, s[80:83], s93 offen lds
  v_rcp_f32 v248, v248
  v_mfma_f32_16x16x32_bf16 v[108:111], a[84:87], a[28:31], v[108:111]
  ds_read_b64_tr_b16 a[68:69], v228 offset:8192
  v_cvt_pk_bf16_f32 v50, v64, v65
  v_mfma_f32_16x16x32_bf16 v[108:111], a[80:83], a[12:15], v[108:111]
  s_waitcnt lgkmcnt(3)
  ds_read_b64_tr_b16 a[70:71], v228 offset:12288
  v_cvt_pk_bf16_f32 v51, v66, v67
  v_mfma_f32_16x16x32_bf16 v[124:127], a[88:91], a[12:15], v[124:127]
  buffer_load_dwordx4 v252, s[84:87], s93 offen offset:1024 lds
  buffer_store_dwordx4 v[48:51], v231, s[4:7], s57 offen sc1
  s_add_u32 s57, s57, 16384
  v_exp_f32 v242, v242
  v_mfma_f32_16x16x32_bf16 v[124:127], a[92:95], a[28:31], v[124:127]
  v_exp_f32 v243, v243
  v_add_u32 v4, 0x10000, v0
  v_mfma_f32_16x16x32_bf16 v[120:123], a[92:95], a[24:27], v[120:123]
  ds_read_b64_tr_b16 a[72:73], v228 offset:16384
  ds_read_b64_tr_b16 a[74:75], v228 offset:20480
  v_mfma_f32_16x16x32_bf16 v[120:123], a[88:91], a[8:11], v[120:123]
  v_exp_f32 v244, v244
  v_exp_f32 v245, v245
  v_rcp_f32 v249, v249
  v_pk_fma_f32 v[242:243], v[242:243], v[234:235], v[234:235] op_sel:[0,0,0] op_sel_hi:[1,0,0]
  v_pk_fma_f32 v[244:245], v[244:245], v[234:235], v[234:235] op_sel:[0,0,0] op_sel_hi:[1,0,0]
  v_pk_mul_f32 v[68:69], v[68:69], v[246:247]
  v_pk_mul_f32 v[70:71], v[70:71], v[248:249]
  v_pk_mul_f32 v[246:247], v[76:77], v[240:241] op_sel:[0,1] op_sel_hi:[1,1]
  v_pk_mul_f32 v[248:249], v[78:79], v[240:241] op_sel:[0,1] op_sel_hi:[1,1]
  v_pk_mul_f32 v[76:77], v[76:77], v[92:93]
  v_pk_mul_f32 v[78:79], v[78:79], v[94:95]
  v_rcp_f32 v242, v242
  v_mfma_f32_16x16x32_bf16 v[116:119], a[88:91], a[4:7], v[116:119]
  s_add_u32 m0, s79, 49152
  v_rcp_f32 v243, v243
  v_xor_b32 v11, 1, v12
  v_mfma_f32_16x16x32_bf16 v[116:119], a[92:95], a[20:23], v[116:119]
  s_add_u32 s92, s92, 458752
  s_sub_u32 s93, s92, s88
  buffer_load_dwordx4 v252, s[80:83], s93 offen lds
  v_rcp_f32 v244, v244
  v_mfma_f32_16x16x32_bf16 v[112:115], a[92:95], a[16:19], v[112:115]
  ds_read_b64_tr_b16 a[76:77], v228 offset:24576
  v_cvt_pk_bf16_f32 v54, v68, v69
  v_mfma_f32_16x16x32_bf16 v[112:115], a[88:91], a[0:3], v[112:115]
  s_waitcnt lgkmcnt(3)
  ds_read_b64_tr_b16 a[78:79], v228 offset:28672
  v_cvt_pk_bf16_f32 v55, v70, v71
  v_mfma_f32_16x16x32_bf16 v[128:131], a[64:67], a[96:99], v[128:131]
  buffer_load_dwordx4 v252, s[84:87], s93 offen offset:1024 lds
  buffer_store_dwordx4 v[52:55], v231, s[4:7], s58 offen sc1
  s_add_u32 s58, s58, 16384
  v_exp_f32 v246, v246
  v_mfma_f32_16x16x32_bf16 v[128:131], a[68:71], a[112:115], v[128:131]
  v_exp_f32 v247, v247
  v_lshl_add_u32 v1, v11, 5, v13
  v_mfma_f32_16x16x32_bf16 v[132:135], a[68:71], a[116:119], v[132:135]
  ds_read_b64_tr_b16 a[80:81], v228 offset:32768
  ds_read_b64_tr_b16 a[82:83], v228 offset:36864
  v_mfma_f32_16x16x32_bf16 v[132:135], a[64:67], a[100:103], v[132:135]
  v_exp_f32 v248, v248
  v_exp_f32 v249, v249
  v_rcp_f32 v245, v245
  v_pk_fma_f32 v[246:247], v[246:247], v[234:235], v[234:235] op_sel:[0,1,1] op_sel_hi:[1,1,1]
  v_pk_fma_f32 v[248:249], v[248:249], v[234:235], v[234:235] op_sel:[0,1,1] op_sel_hi:[1,1,1]
  v_pk_mul_f32 v[72:73], v[72:73], v[242:243]
  v_pk_mul_f32 v[74:75], v[74:75], v[244:245]
  v_pk_mul_f32 v[242:243], v[96:97], v[238:239] op_sel:[0,0] op_sel_hi:[1,0]
  v_pk_mul_f32 v[244:245], v[98:99], v[238:239] op_sel:[0,0] op_sel_hi:[1,0]
  v_pk_mul_f32 v[96:97], v[96:97], v[112:113]
  v_pk_mul_f32 v[98:99], v[98:99], v[114:115]
  v_rcp_f32 v246, v246
  v_mfma_f32_16x16x32_bf16 v[136:139], a[64:67], a[104:107], v[136:139]
  s_add_u32 m0, s79, 57344
  v_rcp_f32 v247, v247
  v_add_u32 v5, 0x10000, v1
  v_mfma_f32_16x16x32_bf16 v[136:139], a[68:71], a[120:123], v[136:139]
  s_add_u32 s92, s92, 458752
  s_sub_u32 s93, s92, s88
  buffer_load_dwordx4 v252, s[80:83], s93 offen lds
  v_rcp_f32 v248, v248
  v_mfma_f32_16x16x32_bf16 v[140:143], a[68:71], a[124:127], v[140:143]
  ds_read_b64_tr_b16 a[84:85], v228 offset:40960
  v_cvt_pk_bf16_f32 v58, v72, v73
  v_mfma_f32_16x16x32_bf16 v[140:143], a[64:67], a[108:111], v[140:143]
  s_waitcnt lgkmcnt(3)
  ds_read_b64_tr_b16 a[86:87], v228 offset:45056
  v_cvt_pk_bf16_f32 v59, v74, v75
  v_mfma_f32_16x16x32_bf16 v[156:159], a[72:75], a[108:111], v[156:159]
  buffer_load_dwordx4 v252, s[84:87], s93 offen offset:1024 lds
  buffer_store_dwordx4 v[56:59], v231, s[4:7], s59 offen sc1
  s_add_u32 s59, s59, 16384
  v_exp_f32 v242, v242
  v_mfma_f32_16x16x32_bf16 v[156:159], a[76:79], a[124:127], v[156:159]
  v_exp_f32 v243, v243
  v_xor_b32 v11, 2, v12
  v_mfma_f32_16x16x32_bf16 v[152:155], a[76:79], a[120:123], v[152:155]
  ds_read_b64_tr_b16 a[88:89], v228 offset:49152
  ds_read_b64_tr_b16 a[90:91], v228 offset:53248
  v_mfma_f32_16x16x32_bf16 v[152:155], a[72:75], a[104:107], v[152:155]
  v_exp_f32 v244, v244
  v_exp_f32 v245, v245
  v_rcp_f32 v249, v249
  v_pk_fma_f32 v[242:243], v[242:243], v[232:233], v[232:233] op_sel:[0,0,0] op_sel_hi:[1,0,0]
  v_pk_fma_f32 v[244:245], v[244:245], v[232:233], v[232:233] op_sel:[0,0,0] op_sel_hi:[1,0,0]
  v_pk_mul_f32 v[76:77], v[76:77], v[246:247]
  v_pk_mul_f32 v[78:79], v[78:79], v[248:249]
  v_pk_mul_f32 v[246:247], v[100:101], v[238:239] op_sel:[0,1] op_sel_hi:[1,1]
  v_pk_mul_f32 v[248:249], v[102:103], v[238:239] op_sel:[0,1] op_sel_hi:[1,1]
  v_pk_mul_f32 v[100:101], v[100:101], v[116:117]
  v_pk_mul_f32 v[102:103], v[102:103], v[118:119]
  v_rcp_f32 v242, v242
  v_mfma_f32_16x16x32_bf16 v[148:151], a[72:75], a[100:103], v[148:151]
  v_rcp_f32 v243, v243
  v_lshl_add_u32 v2, v11, 5, v13
  v_mfma_f32_16x16x32_bf16 v[148:151], a[76:79], a[116:119], v[148:151]
  v_rcp_f32 v244, v244
  v_add_u32 v6, 0x10000, v2
  v_mfma_f32_16x16x32_bf16 v[144:147], a[76:79], a[112:115], v[144:147]
  ds_read_b64_tr_b16 a[92:93], v228 offset:57344
  v_cvt_pk_bf16_f32 v62, v76, v77
  v_mfma_f32_16x16x32_bf16 v[144:147], a[72:75], a[96:99], v[144:147]
  s_waitcnt lgkmcnt(3)
  ds_read_b64_tr_b16 a[94:95], v228 offset:61440
  v_cvt_pk_bf16_f32 v63, v78, v79
  v_mfma_f32_16x16x32_bf16 v[128:131], a[80:83], a[0:3], v[128:131]
  buffer_store_dwordx4 v[60:63], v231, s[4:7], s60 offen sc1
  s_add_u32 s60, s60, 16384
  v_exp_f32 v246, v246
  v_mfma_f32_16x16x32_bf16 v[128:131], a[84:87], a[16:19], v[128:131]
  v_exp_f32 v247, v247
  v_xor_b32 v11, 3, v12
  v_mfma_f32_16x16x32_bf16 v[132:135], a[84:87], a[20:23], v[132:135]
  ds_read_b64_tr_b16 a[64:65], v229 offset:0
  ds_read_b64_tr_b16 a[66:67], v229 offset:4096
  v_mfma_f32_16x16x32_bf16 v[132:135], a[80:83], a[4:7], v[132:135]
  v_exp_f32 v248, v248
  v_exp_f32 v249, v249
  v_rcp_f32 v245, v245
  v_pk_fma_f32 v[246:247], v[246:247], v[232:233], v[232:233] op_sel:[0,1,1] op_sel_hi:[1,1,1]
  v_pk_fma_f32 v[248:249], v[248:249], v[232:233], v[232:233] op_sel:[0,1,1] op_sel_hi:[1,1,1]
  v_pk_mul_f32 v[96:97], v[96:97], v[242:243]
  v_pk_mul_f32 v[98:99], v[98:99], v[244:245]
  v_pk_mul_f32 v[242:243], v[104:105], v[240:241] op_sel:[0,0] op_sel_hi:[1,0]
  v_pk_mul_f32 v[244:245], v[106:107], v[240:241] op_sel:[0,0] op_sel_hi:[1,0]
  v_pk_mul_f32 v[104:105], v[104:105], v[120:121]
  v_pk_mul_f32 v[106:107], v[106:107], v[122:123]
  v_rcp_f32 v246, v246
  v_mfma_f32_16x16x32_bf16 v[136:139], a[80:83], a[8:11], v[136:139]
  buffer_load_dword v10, v251, s[4:7], s64 offen sc1
  v_rcp_f32 v247, v247
  v_mfma_f32_16x16x32_bf16 v[136:139], a[84:87], a[24:27], v[136:139]
  v_rcp_f32 v248, v248
  v_lshl_add_u32 v3, v11, 5, v13
  v_mfma_f32_16x16x32_bf16 v[140:143], a[84:87], a[28:31], v[140:143]
  ds_read_b64_tr_b16 a[68:69], v229 offset:8192
  v_cvt_pk_bf16_f32 v112, v96, v97
  v_mfma_f32_16x16x32_bf16 v[140:143], a[80:83], a[12:15], v[140:143]
  s_waitcnt lgkmcnt(3)
  ds_read_b64_tr_b16 a[70:71], v229 offset:12288
  v_cvt_pk_bf16_f32 v113, v98, v99
  v_mfma_f32_16x16x32_bf16 v[156:159], a[88:91], a[12:15], v[156:159]
  v_exp_f32 v242, v242
  v_add_u32 v7, 0x10000, v3
  v_mfma_f32_16x16x32_bf16 v[156:159], a[92:95], a[28:31], v[156:159]
  v_exp_f32 v243, v243
  v_mfma_f32_16x16x32_bf16 v[152:155], a[92:95], a[24:27], v[152:155]
  ds_read_b64_tr_b16 a[72:73], v229 offset:16384
  ds_read_b64_tr_b16 a[74:75], v229 offset:20480
  v_mfma_f32_16x16x32_bf16 v[152:155], a[88:91], a[8:11], v[152:155]
  v_exp_f32 v244, v244
  v_exp_f32 v245, v245
  v_rcp_f32 v249, v249
  v_pk_fma_f32 v[242:243], v[242:243], v[234:235], v[234:235] op_sel:[0,0,0] op_sel_hi:[1,0,0]
  v_pk_fma_f32 v[244:245], v[244:245], v[234:235], v[234:235] op_sel:[0,0,0] op_sel_hi:[1,0,0]
  v_pk_mul_f32 v[100:101], v[100:101], v[246:247]
  v_pk_mul_f32 v[102:103], v[102:103], v[248:249]
  v_pk_mul_f32 v[246:247], v[108:109], v[240:241] op_sel:[0,1] op_sel_hi:[1,1]
  v_pk_mul_f32 v[248:249], v[110:111], v[240:241] op_sel:[0,1] op_sel_hi:[1,1]
  v_pk_mul_f32 v[108:109], v[108:109], v[124:125]
  v_pk_mul_f32 v[110:111], v[110:111], v[126:127]
  v_rcp_f32 v242, v242
  v_mfma_f32_16x16x32_bf16 v[148:151], a[88:91], a[4:7], v[148:151]
  v_rcp_f32 v243, v243
  v_mfma_f32_16x16x32_bf16 v[148:151], a[92:95], a[20:23], v[148:151]
  v_rcp_f32 v244, v244
  v_mfma_f32_16x16x32_bf16 v[144:147], a[92:95], a[16:19], v[144:147]
  ds_read_b64_tr_b16 a[76:77], v229 offset:24576
  v_cvt_pk_bf16_f32 v116, v100, v101
  v_mfma_f32_16x16x32_bf16 v[144:147], a[88:91], a[0:3], v[144:147]
  s_waitcnt lgkmcnt(3)
  ds_read_b64_tr_b16 a[78:79], v229 offset:28672
  v_cvt_pk_bf16_f32 v117, v102, v103
  v_mfma_f32_16x16x32_bf16 v[160:163], a[64:67], a[96:99], v[160:163]
  v_exp_f32 v246, v246
  v_mfma_f32_16x16x32_bf16 v[160:163], a[68:71], a[112:115], v[160:163]
  v_exp_f32 v247, v247
  v_mfma_f32_16x16x32_bf16 v[164:167], a[68:71], a[116:119], v[164:167]
  ds_read_b64_tr_b16 a[80:81], v229 offset:32768
  ds_read_b64_tr_b16 a[82:83], v229 offset:36864
  v_mfma_f32_16x16x32_bf16 v[164:167], a[64:67], a[100:103], v[164:167]
  v_exp_f32 v248, v248
  v_exp_f32 v249, v249
  v_rcp_f32 v245, v245
  v_pk_fma_f32 v[246:247], v[246:247], v[234:235], v[234:235] op_sel:[0,1,1] op_sel_hi:[1,1,1]
  v_pk_fma_f32 v[248:249], v[248:249], v[234:235], v[234:235] op_sel:[0,1,1] op_sel_hi:[1,1,1]
  v_pk_mul_f32 v[104:105], v[104:105], v[242:243]
  v_pk_mul_f32 v[106:107], v[106:107], v[244:245]
  v_pk_mul_f32 v[242:243], v[128:129], v[238:239] op_sel:[0,0] op_sel_hi:[1,0]
  v_pk_mul_f32 v[244:245], v[130:131], v[238:239] op_sel:[0,0] op_sel_hi:[1,0]
  v_pk_mul_f32 v[128:129], v[128:129], v[144:145]
  v_pk_mul_f32 v[130:131], v[130:131], v[146:147]
  v_rcp_f32 v246, v246
  v_mfma_f32_16x16x32_bf16 v[168:171], a[64:67], a[104:107], v[168:171]
  v_rcp_f32 v247, v247
  v_mfma_f32_16x16x32_bf16 v[168:171], a[68:71], a[120:123], v[168:171]
  v_rcp_f32 v248, v248
  v_mfma_f32_16x16x32_bf16 v[172:175], a[68:71], a[124:127], v[172:175]
  ds_read_b64_tr_b16 a[84:85], v229 offset:40960
  v_cvt_pk_bf16_f32 v120, v104, v105
  v_mfma_f32_16x16x32_bf16 v[172:175], a[64:67], a[108:111], v[172:175]
  s_waitcnt lgkmcnt(3)
  ds_read_b64_tr_b16 a[86:87], v229 offset:45056
  v_cvt_pk_bf16_f32 v121, v106, v107
  v_mfma_f32_16x16x32_bf16 v[188:191], a[72:75], a[108:111], v[188:191]
  v_exp_f32 v242, v242
  v_mfma_f32_16x16x32_bf16 v[188:191], a[76:79], a[124:127], v[188:191]
  v_exp_f32 v243, v243
  v_mfma_f32_16x16x32_bf16 v[184:187], a[76:79], a[120:123], v[184:187]
  ds_read_b64_tr_b16 a[88:89], v229 offset:49152
  ds_read_b64_tr_b16 a[90:91], v229 offset:53248
  v_mfma_f32_16x16x32_bf16 v[184:187], a[72:75], a[104:107], v[184:187]
  v_exp_f32 v244, v244
  v_exp_f32 v245, v245
  v_rcp_f32 v249, v249
  v_pk_fma_f32 v[242:243], v[242:243], v[232:233], v[232:233] op_sel:[0,0,0] op_sel_hi:[1,0,0]
  v_pk_fma_f32 v[244:245], v[244:245], v[232:233], v[232:233] op_sel:[0,0,0] op_sel_hi:[1,0,0]
  v_pk_mul_f32 v[108:109], v[108:109], v[246:247]
  v_pk_mul_f32 v[110:111], v[110:111], v[248:249]
  v_pk_mul_f32 v[246:247], v[132:133], v[238:239] op_sel:[0,1] op_sel_hi:[1,1]
  v_pk_mul_f32 v[248:249], v[134:135], v[238:239] op_sel:[0,1] op_sel_hi:[1,1]
  v_pk_mul_f32 v[132:133], v[132:133], v[148:149]
  v_pk_mul_f32 v[134:135], v[134:135], v[150:151]
  v_rcp_f32 v242, v242
  v_mfma_f32_16x16x32_bf16 v[180:183], a[72:75], a[100:103], v[180:183]
  s_waitcnt vmcnt(1)
  s_barrier
  s_cmp_lg_u32 s40, 0
  s_cbranch_scc1 Lsgf21
  v_mov_b32 v250, 1
  s_mov_b64 exec, 1
  buffer_atomic_add v250, v251, s[4:7], s77 offen sc1
  s_mov_b64 exec, -1
Lsgf21:
  s_add_u32 s77, s77, 4096
  s_waitcnt vmcnt(0)
  v_cmp_gt_u32 vcc, 16, v10
  s_cbranch_vccnz Lp4a_c
Lp4a_r:
  s_add_u32 s64, s64, 4096
  v_rcp_f32 v243, v243
  v_mfma_f32_16x16x32_bf16 v[180:183], a[76:79], a[116:119], v[180:183]
  s_min_u32 s63, s88, 4096
  s_add_u32 s63, s48, s63
  buffer_load_dwordx4 a[128:131], v8, s[4:7], s63 offen offset:0 sc1
  v_rcp_f32 v244, v244
  v_mfma_f32_16x16x32_bf16 v[176:179], a[76:79], a[112:115], v[176:179]
  ds_read_b64_tr_b16 a[92:93], v229 offset:57344
  v_cvt_pk_bf16_f32 v124, v108, v109
  v_mfma_f32_16x16x32_bf16 v[176:179], a[72:75], a[96:99], v[176:179]
  s_waitcnt lgkmcnt(3)
  ds_read_b64_tr_b16 a[94:95], v229 offset:61440
  v_cvt_pk_bf16_f32 v125, v110, v111
  v_mfma_f32_16x16x32_bf16 v[160:163], a[80:83], a[0:3], v[160:163]
  buffer_load_dwordx4 a[132:135], v9, s[4:7], s63 offen offset:0 sc1
  v_exp_f32 v246, v246
  v_mfma_f32_16x16x32_bf16 v[160:163], a[84:87], a[16:19], v[160:163]
  buffer_load_dwordx4 a[136:139], v8, s[4:7], s63 offen offset:1024 sc1
  ds_read_b64_tr_b16 a[64:65], v230 offset:0
  v_exp_f32 v247, v247
  v_mfma_f32_16x16x32_bf16 v[164:167], a[84:87], a[20:23], v[164:167]
  ds_read_b64_tr_b16 a[66:67], v230 offset:4096
  buffer_load_dwordx4 a[140:143], v9, s[4:7], s63 offen offset:1024 sc1
  v_mfma_f32_16x16x32_bf16 v[164:167], a[80:83], a[4:7], v[164:167]
  v_exp_f32 v248, v248
  v_exp_f32 v249, v249
  v_rcp_f32 v245, v245
  v_pk_fma_f32 v[246:247], v[246:247], v[232:233], v[232:233] op_sel:[0,1,1] op_sel_hi:[1,1,1]
  v_pk_fma_f32 v[248:249], v[248:249], v[232:233], v[232:233] op_sel:[0,1,1] op_sel_hi:[1,1,1]
  v_pk_mul_f32 v[128:129], v[128:129], v[242:243]
  v_pk_mul_f32 v[130:131], v[130:131], v[244:245]
  v_pk_mul_f32 v[242:243], v[136:137], v[240:241] op_sel:[0,0] op_sel_hi:[1,0]
  v_pk_mul_f32 v[244:245], v[138:139], v[240:241] op_sel:[0,0] op_sel_hi:[1,0]
  v_pk_mul_f32 v[136:137], v[136:137], v[152:153]
  v_pk_mul_f32 v[138:139], v[138:139], v[154:155]
  v_rcp_f32 v246, v246
  v_mfma_f32_16x16x32_bf16 v[168:171], a[80:83], a[8:11], v[168:171]
  buffer_load_dwordx4 a[144:147], v8, s[4:7], s63 offen offset:2048 sc1
  v_rcp_f32 v247, v247
  v_mfma_f32_16x16x32_bf16 v[168:171], a[84:87], a[24:27], v[168:171]
  buffer_load_dwordx4 a[148:151], v9, s[4:7], s63 offen offset:2048 sc1
  v_rcp_f32 v248, v248
  v_mfma_f32_16x16x32_bf16 v[172:175], a[84:87], a[28:31], v[172:175]
  ds_read_b64_tr_b16 a[68:69], v230 offset:8192
  v_cvt_pk_bf16_f32 v114, v128, v129
  v_mfma_f32_16x16x32_bf16 v[172:175], a[80:83], a[12:15], v[172:175]
  s_waitcnt lgkmcnt(3)
  ds_read_b64_tr_b16 a[70:71], v230 offset:12288
  v_cvt_pk_bf16_f32 v115, v130, v131
  v_mfma_f32_16x16x32_bf16 v[188:191], a[88:91], a[12:15], v[188:191]
  buffer_load_dwordx4 a[152:155], v8, s[4:7], s63 offen offset:3072 sc1
  buffer_store_dwordx4 v[112:115], v231, s[4:7], s57 offen sc1
  s_add_u32 s57, s57, 16384
  v_exp_f32 v242, v242
  v_mfma_f32_16x16x32_bf16 v[188:191], a[92:95], a[28:31], v[188:191]
  buffer_load_dwordx4 a[156:159], v9, s[4:7], s63 offen offset:3072 sc1
  v_exp_f32 v243, v243
  v_mfma_f32_16x16x32_bf16 v[184:187], a[92:95], a[24:27], v[184:187]
  ds_read_b64_tr_b16 a[72:73], v230 offset:16384
  ds_read_b64_tr_b16 a[74:75], v230 offset:20480
  v_mfma_f32_16x16x32_bf16 v[184:187], a[88:91], a[8:11], v[184:187]
  v_exp_f32 v244, v244
  v_exp_f32 v245, v245
  v_rcp_f32 v249, v249
  v_pk_fma_f32 v[242:243], v[242:243], v[234:235], v[234:235] op_sel:[0,0,0] op_sel_hi:[1,0,0]
  v_pk_fma_f32 v[244:245], v[244:245], v[234:235], v[234:235] op_sel:[0,0,0] op_sel_hi:[1,0,0]
  v_pk_mul_f32 v[132:133], v[132:133], v[246:247]
  v_pk_mul_f32 v[134:135], v[134:135], v[248:249]
  v_pk_mul_f32 v[246:247], v[140:141], v[240:241] op_sel:[0,1] op_sel_hi:[1,1]
  v_pk_mul_f32 v[248:249], v[142:143], v[240:241] op_sel:[0,1] op_sel_hi:[1,1]
  v_pk_mul_f32 v[140:141], v[140:141], v[156:157]
  v_pk_mul_f32 v[142:143], v[142:143], v[158:159]
  v_rcp_f32 v242, v242
  v_mfma_f32_16x16x32_bf16 v[180:183], a[88:91], a[4:7], v[180:183]
  s_add_u32 s48, s48, 4096
  s_min_u32 s63, s88, 4096
  s_sub_u32 s63, s48, s63
  buffer_load_dwordx4 a[160:163], v8, s[4:7], s63 offen offset:0 sc1
  v_rcp_f32 v243, v243
  v_mfma_f32_16x16x32_bf16 v[180:183], a[92:95], a[20:23], v[180:183]
  buffer_load_dwordx4 a[164:167], v9, s[4:7], s63 offen offset:0 sc1
  v_rcp_f32 v244, v244
  v_mfma_f32_16x16x32_bf16 v[176:179], a[92:95], a[16:19], v[176:179]
  ds_read_b64_tr_b16 a[76:77], v230 offset:24576
  v_cvt_pk_bf16_f32 v118, v132, v133
  v_mfma_f32_16x16x32_bf16 v[176:179], a[88:91], a[0:3], v[176:179]
  s_waitcnt lgkmcnt(3)
  ds_read_b64_tr_b16 a[78:79], v230 offset:28672
  v_cvt_pk_bf16_f32 v119, v134, v135
  v_mfma_f32_16x16x32_bf16 v[192:195], a[64:67], a[96:99], v[192:195]
  buffer_load_dwordx4 a[168:171], v8, s[4:7], s63 offen offset:1024 sc1
  buffer_store_dwordx4 v[116:119], v231, s[4:7], s58 offen sc1
  s_add_u32 s58, s58, 16384
  v_exp_f32 v246, v246
  v_mfma_f32_16x16x32_bf16 v[192:195], a[68:71], a[112:115], v[192:195]
  buffer_load_dwordx4 a[172:175], v9, s[4:7], s63 offen offset:1024 sc1
  v_exp_f32 v247, v247
  v_mfma_f32_16x16x32_bf16 v[196:199], a[68:71], a[116:119], v[196:199]
  ds_read_b64_tr_b16 a[80:81], v230 offset:32768
  ds_read_b64_tr_b16 a[82:83], v230 offset:36864
  v_mfma_f32_16x16x32_bf16 v[196:199], a[64:67], a[100:103], v[196:199]
  v_exp_f32 v248, v248
  v_exp_f32 v249, v249
  v_rcp_f32 v245, v245
  v_pk_fma_f32 v[246:247], v[246:247], v[234:235], v[234:235] op_sel:[0,1,1] op_sel_hi:[1,1,1]
  v_pk_fma_f32 v[248:249], v[248:249], v[234:235], v[234:235] op_sel:[0,1,1] op_sel_hi:[1,1,1]
  v_pk_mul_f32 v[136:137], v[136:137], v[242:243]
  v_pk_mul_f32 v[138:139], v[138:139], v[244:245]
  v_pk_mul_f32 v[242:243], v[160:161], v[238:239] op_sel:[0,0] op_sel_hi:[1,0]
  v_pk_mul_f32 v[244:245], v[162:163], v[238:239] op_sel:[0,0] op_sel_hi:[1,0]
  v_pk_mul_f32 v[160:161], v[160:161], v[176:177]
  v_pk_mul_f32 v[162:163], v[162:163], v[178:179]
  v_rcp_f32 v246, v246
  v_mfma_f32_16x16x32_bf16 v[200:203], a[64:67], a[104:107], v[200:203]
  buffer_load_dwordx4 a[176:179], v8, s[4:7], s63 offen offset:2048 sc1
  v_rcp_f32 v247, v247
  v_mfma_f32_16x16x32_bf16 v[200:203], a[68:71], a[120:123], v[200:203]
  buffer_load_dwordx4 a[180:183], v9, s[4:7], s63 offen offset:2048 sc1
  v_rcp_f32 v248, v248
  v_mfma_f32_16x16x32_bf16 v[204:207], a[68:71], a[124:127], v[204:207]
  ds_read_b64_tr_b16 a[84:85], v230 offset:40960
  v_cvt_pk_bf16_f32 v122, v136, v137
  v_mfma_f32_16x16x32_bf16 v[204:207], a[64:67], a[108:111], v[204:207]
  s_waitcnt lgkmcnt(3)
  ds_read_b64_tr_b16 a[86:87], v230 offset:45056
  v_cvt_pk_bf16_f32 v123, v138, v139
  v_mfma_f32_16x16x32_bf16 v[220:223], a[72:75], a[108:111], v[220:223]
  buffer_load_dwordx4 a[184:187], v8, s[4:7], s63 offen offset:3072 sc1
  buffer_store_dwordx4 v[120:123], v231, s[4:7], s59 offen sc1
  s_add_u32 s59, s59, 16384
  v_exp_f32 v242, v242
  v_mfma_f32_16x16x32_bf16 v[220:223], a[76:79], a[124:127], v[220:223]
  buffer_load_dwordx4 a[188:191], v9, s[4:7], s63 offen offset:3072 sc1
  v_exp_f32 v243, v243
  v_mfma_f32_16x16x32_bf16 v[216:219], a[76:79], a[120:123], v[216:219]
  ds_read_b64_tr_b16 a[88:89], v230 offset:49152
  ds_read_b64_tr_b16 a[90:91], v230 offset:53248
  v_mfma_f32_16x16x32_bf16 v[216:219], a[72:75], a[104:107], v[216:219]
  v_exp_f32 v244, v244
  v_exp_f32 v245, v245
  v_rcp_f32 v249, v249
  v_pk_fma_f32 v[242:243], v[242:243], v[232:233], v[232:233] op_sel:[0,0,0] op_sel_hi:[1,0,0]
  v_pk_fma_f32 v[244:245], v[244:245], v[232:233], v[232:233] op_sel:[0,0,0] op_sel_hi:[1,0,0]
  v_pk_mul_f32 v[140:141], v[140:141], v[246:247]
  v_pk_mul_f32 v[142:143], v[142:143], v[248:249]
  v_pk_mul_f32 v[246:247], v[164:165], v[238:239] op_sel:[0,1] op_sel_hi:[1,1]
  v_pk_mul_f32 v[248:249], v[166:167], v[238:239] op_sel:[0,1] op_sel_hi:[1,1]
  v_pk_mul_f32 v[164:165], v[164:165], v[180:181]
  v_pk_mul_f32 v[166:167], v[166:167], v[182:183]
  v_rcp_f32 v242, v242
  v_mfma_f32_16x16x32_bf16 v[212:215], a[72:75], a[100:103], v[212:215]
  v_rcp_f32 v243, v243
  v_mfma_f32_16x16x32_bf16 v[212:215], a[76:79], a[116:119], v[212:215]
  v_rcp_f32 v244, v244
  v_mfma_f32_16x16x32_bf16 v[208:211], a[76:79], a[112:115], v[208:211]
  ds_read_b64_tr_b16 a[92:93], v230 offset:57344
  v_cvt_pk_bf16_f32 v126, v140, v141
  v_mfma_f32_16x16x32_bf16 v[208:211], a[72:75], a[96:99], v[208:211]
  s_waitcnt lgkmcnt(3)
  ds_read_b64_tr_b16 a[94:95], v230 offset:61440
  v_cvt_pk_bf16_f32 v127, v142, v143
  v_mfma_f32_16x16x32_bf16 v[192:195], a[80:83], a[0:3], v[192:195]
  buffer_store_dwordx4 v[124:127], v231, s[4:7], s60 offen sc1
  s_add_u32 s60, s60, 16384
  v_mfma_f32_16x16x32_bf16 v[192:195], a[84:87], a[16:19], v[192:195]
  v_exp_f32 v246, v246
  v_mfma_f32_16x16x32_bf16 v[196:199], a[84:87], a[20:23], v[196:199]
  v_exp_f32 v247, v247
  v_mfma_f32_16x16x32_bf16 v[196:199], a[80:83], a[4:7], v[196:199]
  v_exp_f32 v248, v248
  v_exp_f32 v249, v249
  v_rcp_f32 v245, v245
  v_pk_fma_f32 v[246:247], v[246:247], v[232:233], v[232:233] op_sel:[0,1,1] op_sel_hi:[1,1,1]
  v_pk_fma_f32 v[248:249], v[248:249], v[232:233], v[232:233] op_sel:[0,1,1] op_sel_hi:[1,1,1]
  v_pk_mul_f32 v[160:161], v[160:161], v[242:243]
  v_pk_mul_f32 v[162:163], v[162:163], v[244:245]
  v_pk_mul_f32 v[242:243], v[168:169], v[240:241] op_sel:[0,0] op_sel_hi:[1,0]
  v_pk_mul_f32 v[244:245], v[170:171], v[240:241] op_sel:[0,0] op_sel_hi:[1,0]
  v_pk_mul_f32 v[168:169], v[168:169], v[184:185]
  v_pk_mul_f32 v[170:171], v[170:171], v[186:187]
  v_rcp_f32 v246, v246
  v_mfma_f32_16x16x32_bf16 v[200:203], a[80:83], a[8:11], v[200:203]
  s_barrier
  v_rcp_f32 v247, v247
  v_mfma_f32_16x16x32_bf16 v[200:203], a[84:87], a[24:27], v[200:203]
  s_add_u32 m0, s79, 65536
  v_rcp_f32 v248, v248
  v_mfma_f32_16x16x32_bf16 v[204:207], a[84:87], a[28:31], v[204:207]
  s_add_u32 s92, s92, -3407872
  s_sub_u32 s92, s92, s78
  s_add_u32 s93, s92, s88
  v_cvt_pk_bf16_f32 v176, v160, v161
  v_mfma_f32_16x16x32_bf16 v[204:207], a[80:83], a[12:15], v[204:207]
  v_cvt_pk_bf16_f32 v177, v162, v163
  s_waitcnt lgkmcnt(0)
  v_mfma_f32_16x16x32_bf16 v[220:223], a[88:91], a[12:15], v[220:223]
  buffer_load_dwordx4 v252, s[80:83], s93 offen lds
  v_mfma_f32_16x16x32_bf16 v[220:223], a[92:95], a[28:31], v[220:223]
  buffer_load_dwordx4 v252, s[84:87], s93 offen offset:1024 lds
  v_exp_f32 v242, v242
  v_mfma_f32_16x16x32_bf16 v[216:219], a[92:95], a[24:27], v[216:219]
  v_exp_f32 v243, v243
  v_mfma_f32_16x16x32_bf16 v[216:219], a[88:91], a[8:11], v[216:219]
  v_exp_f32 v244, v244
  v_exp_f32 v245, v245
  v_rcp_f32 v249, v249
  v_pk_fma_f32 v[242:243], v[242:243], v[234:235], v[234:235] op_sel:[0,0,0] op_sel_hi:[1,0,0]
  v_pk_fma_f32 v[244:245], v[244:245], v[234:235], v[234:235] op_sel:[0,0,0] op_sel_hi:[1,0,0]
  v_pk_mul_f32 v[164:165], v[164:165], v[246:247]
  v_pk_mul_f32 v[166:167], v[166:167], v[248:249]
  v_pk_mul_f32 v[246:247], v[172:173], v[240:241] op_sel:[0,1] op_sel_hi:[1,1]
  v_pk_mul_f32 v[248:249], v[174:175], v[240:241] op_sel:[0,1] op_sel_hi:[1,1]
  v_pk_mul_f32 v[172:173], v[172:173], v[188:189]
  v_pk_mul_f32 v[174:175], v[174:175], v[190:191]
  v_mfma_f32_16x16x32_bf16 v[212:215], a[88:91], a[4:7], v[212:215]
  v_rcp_f32 v242, v242
  v_mfma_f32_16x16x32_bf16 v[212:215], a[92:95], a[20:23], v[212:215]
  v_mfma_f32_16x16x32_bf16 v[208:211], a[92:95], a[16:19], v[208:211]
  v_mfma_f32_16x16x32_bf16 v[208:211], a[88:91], a[0:3], v[208:211]
  ds_read_b64_tr_b16 a[0:1], v0 offset:0
  ds_read_b64_tr_b16 a[2:3], v0 offset:4096
  ds_read_b64_tr_b16 a[16:17], v0 offset:8192
  ds_read_b64_tr_b16 a[18:19], v0 offset:12288
  ds_read_b64_tr_b16 a[4:5], v1 offset:0
  ds_read_b64_tr_b16 a[6:7], v1 offset:4096
  ds_read_b64_tr_b16 a[20:21], v1 offset:8192
  ds_read_b64_tr_b16 a[22:23], v1 offset:12288
  ds_read_b64_tr_b16 a[8:9], v2 offset:0
  ds_read_b64_tr_b16 a[10:11], v2 offset:4096
  ds_read_b64_tr_b16 a[24:25], v2 offset:8192
  ds_read_b64_tr_b16 a[26:27], v2 offset:12288
  ds_read_b64_tr_b16 a[12:13], v3 offset:0
  ds_read_b64_tr_b16 a[14:15], v3 offset:4096
  ds_read_b64_tr_b16 a[28:29], v3 offset:8192
  ds_read_b64_tr_b16 a[30:31], v3 offset:12288
  buffer_load_dword v10, v251, s[4:7], s64 offen sc1
  s_add_u32 m0, s79, 73728
  s_add_u32 s92, s92, 262144
  s_add_u32 s93, s92, s88
  v_rcp_f32 v243, v243
  v_rcp_f32 v244, v244
  v_cvt_pk_bf16_f32 v180, v164, v165
  v_cvt_pk_bf16_f32 v181, v166, v167
  buffer_load_dwordx4 v252, s[80:83], s93 offen lds
  buffer_load_dwordx4 v252, s[84:87], s93 offen offset:1024 lds
  v_exp_f32 v246, v246
  v_exp_f32 v247, v247
  v_exp_f32 v248, v248
  v_exp_f32 v249, v249
  v_rcp_f32 v245, v245
  v_pk_fma_f32 v[246:247], v[246:247], v[234:235], v[234:235] op_sel:[0,1,1] op_sel_hi:[1,1,1]
  v_pk_fma_f32 v[248:249], v[248:249], v[234:235], v[234:235] op_sel:[0,1,1] op_sel_hi:[1,1,1]
  v_pk_mul_f32 v[168:169], v[168:169], v[242:243]
  v_pk_mul_f32 v[170:171], v[170:171], v[244:245]
  v_pk_mul_f32 v[242:243], v[192:193], v[238:239] op_sel:[0,0] op_sel_hi:[1,0]
  v_pk_mul_f32 v[244:245], v[194:195], v[238:239] op_sel:[0,0] op_sel_hi:[1,0]
  v_pk_mul_f32 v[192:193], v[192:193], v[208:209]
  v_pk_mul_f32 v[194:195], v[194:195], v[210:211]
  v_rcp_f32 v246, v246
  s_add_u32 m0, s79, 81920
  s_add_u32 s92, s92, 196608
  s_add_u32 s93, s92, s88
  v_rcp_f32 v247, v247
  v_rcp_f32 v248, v248
  v_cvt_pk_bf16_f32 v184, v168, v169
  v_cvt_pk_bf16_f32 v185, v170, v171
  buffer_load_dwordx4 v252, s[80:83], s93 offen lds
  buffer_load_dwordx4 v252, s[84:87], s93 offen offset:1024 lds
  v_exp_f32 v242, v242
  v_exp_f32 v243, v243
  v_exp_f32 v244, v244
  v_exp_f32 v245, v245
  v_rcp_f32 v249, v249
  v_pk_fma_f32 v[242:243], v[242:243], v[232:233], v[232:233] op_sel:[0,0,0] op_sel_hi:[1,0,0]
  v_pk_fma_f32 v[244:245], v[244:245], v[232:233], v[232:233] op_sel:[0,0,0] op_sel_hi:[1,0,0]
  v_pk_mul_f32 v[172:173], v[172:173], v[246:247]
  v_pk_mul_f32 v[174:175], v[174:175], v[248:249]
  v_pk_mul_f32 v[246:247], v[196:197], v[238:239] op_sel:[0,1] op_sel_hi:[1,1]
  v_pk_mul_f32 v[248:249], v[198:199], v[238:239] op_sel:[0,1] op_sel_hi:[1,1]
  v_pk_mul_f32 v[196:197], v[196:197], v[212:213]
  v_pk_mul_f32 v[198:199], v[198:199], v[214:215]
  v_rcp_f32 v242, v242
  s_add_u32 m0, s79, 90112
  s_add_u32 s92, s92, 262144
  s_add_u32 s93, s92, s88
  v_rcp_f32 v243, v243
  v_rcp_f32 v244, v244
  v_cvt_pk_bf16_f32 v188, v172, v173
  v_cvt_pk_bf16_f32 v189, v174, v175
  buffer_load_dwordx4 v252, s[80:83], s93 offen lds
  buffer_load_dwordx4 v252, s[84:87], s93 offen offset:1024 lds
  v_exp_f32 v246, v246
  v_exp_f32 v247, v247
  v_exp_f32 v248, v248
  v_exp_f32 v249, v249
  v_rcp_f32 v245, v245
  v_pk_fma_f32 v[246:247], v[246:247], v[232:233], v[232:233] op_sel:[0,1,1] op_sel_hi:[1,1,1]
  v_pk_fma_f32 v[248:249], v[248:249], v[232:233], v[232:233] op_sel:[0,1,1] op_sel_hi:[1,1,1]
  v_pk_mul_f32 v[192:193], v[192:193], v[242:243]
  v_pk_mul_f32 v[194:195], v[194:195], v[244:245]
  v_pk_mul_f32 v[242:243], v[200:201], v[240:241] op_sel:[0,0] op_sel_hi:[1,0]
  v_pk_mul_f32 v[244:245], v[202:203], v[240:241] op_sel:[0,0] op_sel_hi:[1,0]
  v_pk_mul_f32 v[200:201], v[200:201], v[216:217]
  v_pk_mul_f32 v[202:203], v[202:203], v[218:219]
  v_rcp_f32 v246, v246
  v_rcp_f32 v247, v247
  v_rcp_f32 v248, v248
  v_cvt_pk_bf16_f32 v178, v192, v193
  v_cvt_pk_bf16_f32 v179, v194, v195
  buffer_store_dwordx4 v[176:179], v231, s[4:7], s57 offen sc1
  s_add_u32 s57, s57, 16384
  v_exp_f32 v242, v242
  v_exp_f32 v243, v243
  v_exp_f32 v244, v244
  v_exp_f32 v245, v245
  v_rcp_f32 v249, v249
  v_pk_fma_f32 v[242:243], v[242:243], v[234:235], v[234:235] op_sel:[0,0,0] op_sel_hi:[1,0,0]
  v_pk_fma_f32 v[244:245], v[244:245], v[234:235], v[234:235] op_sel:[0,0,0] op_sel_hi:[1,0,0]
  v_pk_mul_f32 v[196:197], v[196:197], v[246:247]
  v_pk_mul_f32 v[198:199], v[198:199], v[248:249]
  v_pk_mul_f32 v[246:247], v[204:205], v[240:241] op_sel:[0,1] op_sel_hi:[1,1]
  v_pk_mul_f32 v[248:249], v[206:207], v[240:241] op_sel:[0,1] op_sel_hi:[1,1]
  v_pk_mul_f32 v[204:205], v[204:205], v[220:221]
  v_pk_mul_f32 v[206:207], v[206:207], v[222:223]
  v_rcp_f32 v242, v242
  v_rcp_f32 v243, v243
  v_rcp_f32 v244, v244
  v_cvt_pk_bf16_f32 v182, v196, v197
  v_cvt_pk_bf16_f32 v183, v198, v199
  buffer_store_dwordx4 v[180:183], v231, s[4:7], s58 offen sc1
  s_add_u32 s58, s58, 16384
  v_exp_f32 v246, v246
  v_exp_f32 v247, v247
  v_exp_f32 v248, v248
  v_exp_f32 v249, v249
  v_rcp_f32 v245, v245
  v_pk_fma_f32 v[246:247], v[246:247], v[234:235], v[234:235] op_sel:[0,1,1] op_sel_hi:[1,1,1]
  v_pk_fma_f32 v[248:249], v[248:249], v[234:235], v[234:235] op_sel:[0,1,1] op_sel_hi:[1,1,1]
  v_pk_mul_f32 v[200:201], v[200:201], v[242:243]
  v_pk_mul_f32 v[202:203], v[202:203], v[244:245]
  v_rcp_f32 v246, v246
  v_rcp_f32 v247, v247
  v_rcp_f32 v248, v248
  v_cvt_pk_bf16_f32 v186, v200, v201
  v_cvt_pk_bf16_f32 v187, v202, v203
  buffer_store_dwordx4 v[184:187], v231, s[4:7], s59 offen sc1
  s_add_u32 s59, s59, 16384
  v_rcp_f32 v249, v249
  s_nop 0
  v_pk_mul_f32 v[204:205], v[204:205], v[246:247]
  v_pk_mul_f32 v[206:207], v[206:207], v[248:249]
  v_cvt_pk_bf16_f32 v190, v204, v205
  v_cvt_pk_bf16_f32 v191, v206, v207
  buffer_store_dwordx4 v[188:191], v231, s[4:7], s60 offen sc1
  s_add_u32 s60, s60, 16384
  v_pk_mul_f32 v[32:33], v[250:251], 0 op_sel:[1,0] op_sel_hi:[1,0]
  v_pk_mul_f32 v[34:35], v[250:251], 0 op_sel:[1,0] op_sel_hi:[1,0]
  v_pk_mul_f32 v[36:37], v[250:251], 0 op_sel:[1,0] op_sel_hi:[1,0]
  v_pk_mul_f32 v[38:39], v[250:251], 0 op_sel:[1,0] op_sel_hi:[1,0]
  v_pk_mul_f32 v[40:41], v[250:251], 0 op_sel:[1,0] op_sel_hi:[1,0]
  v_pk_mul_f32 v[42:43], v[250:251], 0 op_sel:[1,0] op_sel_hi:[1,0]
  v_pk_mul_f32 v[44:45], v[250:251], 0 op_sel:[1,0] op_sel_hi:[1,0]
  v_pk_mul_f32 v[46:47], v[250:251], 0 op_sel:[1,0] op_sel_hi:[1,0]
  v_pk_mul_f32 v[48:49], v[250:251], 0 op_sel:[1,0] op_sel_hi:[1,0]
  v_pk_mul_f32 v[50:51], v[250:251], 0 op_sel:[1,0] op_sel_hi:[1,0]
  v_pk_mul_f32 v[52:53], v[250:251], 0 op_sel:[1,0] op_sel_hi:[1,0]
  v_pk_mul_f32 v[54:55], v[250:251], 0 op_sel:[1,0] op_sel_hi:[1,0]
  v_pk_mul_f32 v[56:57], v[250:251], 0 op_sel:[1,0] op_sel_hi:[1,0]
  v_pk_mul_f32 v[58:59], v[250:251], 0 op_sel:[1,0] op_sel_hi:[1,0]
  v_pk_mul_f32 v[60:61], v[250:251], 0 op_sel:[1,0] op_sel_hi:[1,0]
  v_pk_mul_f32 v[62:63], v[250:251], 0 op_sel:[1,0] op_sel_hi:[1,0]
  v_lshlrev_b32 v64, 16, v16
  v_and_b32 v65, 0xffff0000, v16
  v_lshlrev_b32 v66, 16, v17
  v_and_b32 v67, 0xffff0000, v17
  v_lshlrev_b32 v72, 16, v18
  v_and_b32 v73, 0xffff0000, v18
  v_lshlrev_b32 v74, 16, v19
  v_and_b32 v75, 0xffff0000, v19
  v_lshlrev_b32 v80, 16, v20
  v_and_b32 v81, 0xffff0000, v20
  v_lshlrev_b32 v82, 16, v21
  v_and_b32 v83, 0xffff0000, v21
  v_lshlrev_b32 v88, 16, v22
  v_and_b32 v89, 0xffff0000, v22
  v_lshlrev_b32 v90, 16, v23
  v_and_b32 v91, 0xffff0000, v23
  v_lshlrev_b32 v68, 16, v24
  v_and_b32 v69, 0xffff0000, v24
  v_lshlrev_b32 v70, 16, v25
  v_and_b32 v71, 0xffff0000, v25
  v_lshlrev_b32 v76, 16, v26
  v_and_b32 v77, 0xffff0000, v26
  v_lshlrev_b32 v78, 16, v27
  v_and_b32 v79, 0xffff0000, v27
  v_lshlrev_b32 v84, 16, v28
  v_and_b32 v85, 0xffff0000, v28
  v_lshlrev_b32 v86, 16, v29
  v_and_b32 v87, 0xffff0000, v29
  v_lshlrev_b32 v92, 16, v30
  v_and_b32 v93, 0xffff0000, v30
  v_lshlrev_b32 v94, 16, v31
  v_and_b32 v95, 0xffff0000, v31
  s_mov_b32 s56, 2
.p2align 3
Lp4_loop:
  s_waitcnt vmcnt(25) lgkmcnt(8)
  v_mfma_f32_16x16x32_bf16 v[32:35], a[0:3], a[128:131], v[32:35]
  s_waitcnt vmcnt(27)
  s_barrier
  ds_read_b64_tr_b16 a[32:33], v0 offset:1024
  s_waitcnt vmcnt(10)
  v_cmp_gt_u32 vcc, 16, v10
  s_cbranch_vccnz Lp4b_c
Lp4b_r:
  s_add_u32 s64, s64, 4096
  v_mfma_f32_16x16x32_bf16 v[32:35], a[16:19], a[136:139], v[32:35]
  s_add_u32 m0, s79, 98304
  ds_read_b64_tr_b16 a[34:35], v0 offset:5120
  s_add_u32 s92, s92, 196608
  v_mfma_f32_16x16x32_bf16 v[36:39], a[16:19], a[140:143], v[36:39]
  s_add_u32 s93, s92, s88
  buffer_load_dwordx4 v252, s[80:83], s93 offen lds
  v_mfma_f32_16x16x32_bf16 v[36:39], a[0:3], a[132:135], v[36:39]
  ds_read_b64_tr_b16 a[48:49], v0 offset:9216
  ds_read_b64_tr_b16 a[50:51], v0 offset:13312
  v_mfma_f32_16x16x32_bf16 v[44:47], a[4:7], a[132:135], v[44:47]
  ds_read_b64_tr_b16 a[36:37], v1 offset:1024
  v_mfma_f32_16x16x32_bf16 v[44:47], a[20:23], a[140:143], v[44:47]
  ds_read_b64_tr_b16 a[38:39], v1 offset:5120
  v_mfma_f32_16x16x32_bf16 v[40:43], a[20:23], a[136:139], v[40:43]
  buffer_load_dwordx4 v252, s[84:87], s93 offen offset:1024 lds
  v_mfma_f32_16x16x32_bf16 v[40:43], a[4:7], a[128:131], v[40:43]
  s_waitcnt lgkmcnt(6)
  ds_read_b64_tr_b16 a[52:53], v1 offset:9216
  ds_read_b64_tr_b16 a[54:55], v1 offset:13312
  v_mfma_f32_16x16x32_bf16 v[48:51], a[8:11], a[128:131], v[48:51]
  ds_read_b64_tr_b16 a[40:41], v2 offset:1024
  v_mfma_f32_16x16x32_bf16 v[48:51], a[24:27], a[136:139], v[48:51]
  s_add_u32 s48, s48, 4096
  ds_read_b64_tr_b16 a[42:43], v2 offset:5120
  s_min_u32 s63, s88, 8192
  v_mfma_f32_16x16x32_bf16 v[52:55], a[24:27], a[140:143], v[52:55]
  s_add_u32 s63, s48, s63
  buffer_load_dwordx4 a[192:195], v8, s[4:7], s63 offen offset:0 sc1
  v_mfma_f32_16x16x32_bf16 v[52:55], a[8:11], a[132:135], v[52:55]
  ds_read_b64_tr_b16 a[56:57], v2 offset:9216
  ds_read_b64_tr_b16 a[58:59], v2 offset:13312
  v_mfma_f32_16x16x32_bf16 v[60:63], a[12:15], a[132:135], v[60:63]
  ds_read_b64_tr_b16 a[44:45], v3 offset:1024
  v_mfma_f32_16x16x32_bf16 v[60:63], a[28:31], a[140:143], v[60:63]
  ds_read_b64_tr_b16 a[46:47], v3 offset:5120
  v_mfma_f32_16x16x32_bf16 v[56:59], a[28:31], a[136:139], v[56:59]
  buffer_load_dwordx4 a[196:199], v9, s[4:7], s63 offen offset:0 sc1
  v_mfma_f32_16x16x32_bf16 v[56:59], a[12:15], a[128:131], v[56:59]
  s_waitcnt lgkmcnt(6)
  ds_read_b64_tr_b16 a[60:61], v3 offset:9216
  ds_read_b64_tr_b16 a[62:63], v3 offset:13312
  v_mfma_f32_16x16x32_bf16 v[64:67], a[32:35], a[128:131], v[64:67]
  ds_read_b64_tr_b16 a[0:1], v0 offset:16384
  s_add_u32 m0, s79, 106496
  v_mfma_f32_16x16x32_bf16 v[64:67], a[48:51], a[136:139], v[64:67]
  s_add_u32 s92, s92, 262144
  ds_read_b64_tr_b16 a[2:3], v0 offset:20480
  s_add_u32 s93, s92, s88
  v_mfma_f32_16x16x32_bf16 v[68:71], a[48:51], a[140:143], v[68:71]
  buffer_load_dwordx4 v252, s[80:83], s93 offen lds
  v_mfma_f32_16x16x32_bf16 v[68:71], a[32:35], a[132:135], v[68:71]
  ds_read_b64_tr_b16 a[16:17], v0 offset:24576
  ds_read_b64_tr_b16 a[18:19], v0 offset:28672
  v_mfma_f32_16x16x32_bf16 v[76:79], a[36:39], a[132:135], v[76:79]
  ds_read_b64_tr_b16 a[4:5], v1 offset:16384
  v_mfma_f32_16x16x32_bf16 v[76:79], a[52:55], a[140:143], v[76:79]
  ds_read_b64_tr_b16 a[6:7], v1 offset:20480
  v_mfma_f32_16x16x32_bf16 v[72:75], a[52:55], a[136:139], v[72:75]
  buffer_load_dwordx4 v252, s[84:87], s93 offen offset:1024 lds
  v_mfma_f32_16x16x32_bf16 v[72:75], a[36:39], a[128:131], v[72:75]
  s_waitcnt lgkmcnt(6)
  ds_read_b64_tr_b16 a[20:21], v1 offset:24576
  ds_read_b64_tr_b16 a[22:23], v1 offset:28672
  v_mfma_f32_16x16x32_bf16 v[80:83], a[40:43], a[128:131], v[80:83]
  ds_read_b64_tr_b16 a[8:9], v2 offset:16384
  v_mfma_f32_16x16x32_bf16 v[80:83], a[56:59], a[136:139], v[80:83]
  ds_read_b64_tr_b16 a[10:11], v2 offset:20480
  v_mfma_f32_16x16x32_bf16 v[84:87], a[56:59], a[140:143], v[84:87]
  buffer_load_dwordx4 a[200:203], v8, s[4:7], s63 offen offset:1024 sc1
  v_mfma_f32_16x16x32_bf16 v[84:87], a[40:43], a[132:135], v[84:87]
  ds_read_b64_tr_b16 a[24:25], v2 offset:24576
  ds_read_b64_tr_b16 a[26:27], v2 offset:28672
  v_mfma_f32_16x16x32_bf16 v[92:95], a[44:47], a[132:135], v[92:95]
  ds_read_b64_tr_b16 a[12:13], v3 offset:16384
  v_mfma_f32_16x16x32_bf16 v[92:95], a[60:63], a[140:143], v[92:95]
  ds_read_b64_tr_b16 a[14:15], v3 offset:20480
  v_mfma_f32_16x16x32_bf16 v[88:91], a[60:63], a[136:139], v[88:91]
  buffer_load_dwordx4 a[204:207], v9, s[4:7], s63 offen offset:1024 sc1
  v_mfma_f32_16x16x32_bf16 v[88:91], a[44:47], a[128:131], v[88:91]
  s_waitcnt vmcnt(25) lgkmcnt(6)
  ds_read_b64_tr_b16 a[28:29], v3 offset:24576
  ds_read_b64_tr_b16 a[30:31], v3 offset:28672
  v_mfma_f32_16x16x32_bf16 v[32:35], a[0:3], a[144:147], v[32:35]
  ds_read_b64_tr_b16 a[32:33], v0 offset:17408
  s_add_u32 m0, s79, 114688
  v_mfma_f32_16x16x32_bf16 v[32:35], a[16:19], a[152:155], v[32:35]
  s_add_u32 s92, s92, 196608
  ds_read_b64_tr_b16 a[34:35], v0 offset:21504
  s_add_u32 s93, s92, s88
  v_mfma_f32_16x16x32_bf16 v[36:39], a[16:19], a[156:159], v[36:39]
  buffer_load_dwordx4 v252, s[80:83], s93 offen lds
  v_mfma_f32_16x16x32_bf16 v[36:39], a[0:3], a[148:151], v[36:39]
  ds_read_b64_tr_b16 a[48:49], v0 offset:25600
  ds_read_b64_tr_b16 a[50:51], v0 offset:29696
  v_mfma_f32_16x16x32_bf16 v[44:47], a[4:7], a[148:151], v[44:47]
  ds_read_b64_tr_b16 a[36:37], v1 offset:17408
  v_mfma_f32_16x16x32_bf16 v[44:47], a[20:23], a[156:159], v[44:47]
  ds_read_b64_tr_b16 a[38:39], v1 offset:21504
  v_mfma_f32_16x16x32_bf16 v[40:43], a[20:23], a[152:155], v[40:43]
  buffer_load_dwordx4 v252, s[84:87], s93 offen offset:1024 lds
  v_mfma_f32_16x16x32_bf16 v[40:43], a[4:7], a[144:147], v[40:43]
  s_waitcnt lgkmcnt(6)
  ds_read_b64_tr_b16 a[52:53], v1 offset:25600
  ds_read_b64_tr_b16 a[54:55], v1 offset:29696
  v_mfma_f32_16x16x32_bf16 v[48:51], a[8:11], a[144:147], v[48:51]
  ds_read_b64_tr_b16 a[40:41], v2 offset:17408
  v_mfma_f32_16x16x32_bf16 v[48:51], a[24:27], a[152:155], v[48:51]
  ds_read_b64_tr_b16 a[42:43], v2 offset:21504
  v_mfma_f32_16x16x32_bf16 v[52:55], a[24:27], a[156:159], v[52:55]
  buffer_load_dwordx4 a[208:211], v8, s[4:7], s63 offen offset:2048 sc1
  v_mfma_f32_16x16x32_bf16 v[52:55], a[8:11], a[148:151], v[52:55]
  ds_read_b64_tr_b16 a[56:57], v2 offset:25600
  ds_read_b64_tr_b16 a[58:59], v2 offset:29696
  v_mfma_f32_16x16x32_bf16 v[60:63], a[12:15], a[148:151], v[60:63]
  ds_read_b64_tr_b16 a[44:45], v3 offset:17408
  v_mfma_f32_16x16x32_bf16 v[60:63], a[28:31], a[156:159], v[60:63]
  ds_read_b64_tr_b16 a[46:47], v3 offset:21504
  v_mfma_f32_16x16x32_bf16 v[56:59], a[28:31], a[152:155], v[56:59]
  buffer_load_dwordx4 a[212:215], v9, s[4:7], s63 offen offset:2048 sc1
  v_mfma_f32_16x16x32_bf16 v[56:59], a[12:15], a[144:147], v[56:59]
  s_waitcnt lgkmcnt(6)
  ds_read_b64_tr_b16 a[60:61], v3 offset:25600
  ds_read_b64_tr_b16 a[62:63], v3 offset:29696
  v_mfma_f32_16x16x32_bf16 v[64:67], a[32:35], a[144:147], v[64:67]
  ds_read_b64_tr_b16 a[0:1], v0 offset:32768
  s_add_u32 m0, s79, 122880
  v_mfma_f32_16x16x32_bf16 v[64:67], a[48:51], a[152:155], v[64:67]
  s_add_u32 s92, s92, 262144
  ds_read_b64_tr_b16 a[2:3], v0 offset:36864
  s_add_u32 s93, s92, s88
  v_mfma_f32_16x16x32_bf16 v[68:71], a[48:51], a[156:159], v[68:71]
  buffer_load_dwordx4 v252, s[80:83], s93 offen lds
  v_mfma_f32_16x16x32_bf16 v[68:71], a[32:35], a[148:151], v[68:71]
  ds_read_b64_tr_b16 a[16:17], v0 offset:40960
  ds_read_b64_tr_b16 a[18:19], v0 offset:45056
  v_mfma_f32_16x16x32_bf16 v[76:79], a[36:39], a[148:151], v[76:79]
  ds_read_b64_tr_b16 a[4:5], v1 offset:32768
  v_mfma_f32_16x16x32_bf16 v[76:79], a[52:55], a[156:159], v[76:79]
  ds_read_b64_tr_b16 a[6:7], v1 offset:36864
  v_mfma_f32_16x16x32_bf16 v[72:75], a[52:55], a[152:155], v[72:75]
  buffer_load_dwordx4 v252, s[84:87], s93 offen offset:1024 lds
  v_mfma_f32_16x16x32_bf16 v[72:75], a[36:39], a[144:147], v[72:75]
  s_waitcnt lgkmcnt(6)
  ds_read_b64_tr_b16 a[20:21], v1 offset:40960
  ds_read_b64_tr_b16 a[22:23], v1 offset:45056
  v_mfma_f32_16x16x32_bf16 v[80:83], a[40:43], a[144:147], v[80:83]
  ds_read_b64_tr_b16 a[8:9], v2 offset:32768
  v_mfma_f32_16x16x32_bf16 v[80:83], a[56:59], a[152:155], v[80:83]
  ds_read_b64_tr_b16 a[10:11], v2 offset:36864
  v_mfma_f32_16x16x32_bf16 v[84:87], a[56:59], a[156:159], v[84:87]
  buffer_load_dwordx4 a[216:219], v8, s[4:7], s63 offen offset:3072 sc1
  v_mfma_f32_16x16x32_bf16 v[84:87], a[40:43], a[148:151], v[84:87]
  ds_read_b64_tr_b16 a[24:25], v2 offset:40960
  ds_read_b64_tr_b16 a[26:27], v2 offset:45056
  v_mfma_f32_16x16x32_bf16 v[92:95], a[44:47], a[148:151], v[92:95]
  ds_read_b64_tr_b16 a[12:13], v3 offset:32768
  v_mfma_f32_16x16x32_bf16 v[92:95], a[60:63], a[156:159], v[92:95]
  ds_read_b64_tr_b16 a[14:15], v3 offset:36864
  v_mfma_f32_16x16x32_bf16 v[88:91], a[60:63], a[152:155], v[88:91]
  buffer_load_dwordx4 a[220:223], v9, s[4:7], s63 offen offset:3072 sc1
  v_mfma_f32_16x16x32_bf16 v[88:91], a[44:47], a[144:147], v[88:91]
  s_waitcnt vmcnt(24) lgkmcnt(6)
  ds_read_b64_tr_b16 a[28:29], v3 offset:40960
  ds_read_b64_tr_b16 a[30:31], v3 offset:45056
  v_mfma_f32_16x16x32_bf16 v[32:35], a[0:3], a[160:163], v[32:35]
  s_waitcnt vmcnt(24)
  s_barrier
  ds_read_b64_tr_b16 a[32:33], v0 offset:33792
  v_mfma_f32_16x16x32_bf16 v[32:35], a[16:19], a[168:171], v[32:35]
  s_add_u32 m0, s79, 0
  ds_read_b64_tr_b16 a[34:35], v0 offset:37888
  s_add_u32 s92, s92, 196608
  v_mfma_f32_16x16x32_bf16 v[36:39], a[16:19], a[172:175], v[36:39]
  s_sub_u32 s93, s92, s88
  buffer_load_dwordx4 v252, s[80:83], s93 offen lds
  v_mfma_f32_16x16x32_bf16 v[36:39], a[0:3], a[164:167], v[36:39]
  ds_read_b64_tr_b16 a[48:49], v0 offset:41984
  ds_read_b64_tr_b16 a[50:51], v0 offset:46080
  v_mfma_f32_16x16x32_bf16 v[44:47], a[4:7], a[164:167], v[44:47]
  ds_read_b64_tr_b16 a[36:37], v1 offset:33792
  v_mfma_f32_16x16x32_bf16 v[44:47], a[20:23], a[172:175], v[44:47]
  ds_read_b64_tr_b16 a[38:39], v1 offset:37888
  v_mfma_f32_16x16x32_bf16 v[40:43], a[20:23], a[168:171], v[40:43]
  buffer_load_dwordx4 v252, s[84:87], s93 offen offset:1024 lds
  v_mfma_f32_16x16x32_bf16 v[40:43], a[4:7], a[160:163], v[40:43]
  s_waitcnt lgkmcnt(6)
  ds_read_b64_tr_b16 a[52:53], v1 offset:41984
  ds_read_b64_tr_b16 a[54:55], v1 offset:46080
  v_mfma_f32_16x16x32_bf16 v[48:51], a[8:11], a[160:163], v[48:51]
  ds_read_b64_tr_b16 a[40:41], v2 offset:33792
  v_mfma_f32_16x16x32_bf16 v[48:51], a[24:27], a[168:171], v[48:51]
  s_add_u32 s48, s48, 4096
  ds_read_b64_tr_b16 a[42:43], v2 offset:37888
  s_min_u32 s63, s88, 8192
  v_mfma_f32_16x16x32_bf16 v[52:55], a[24:27], a[172:175], v[52:55]
  s_add_u32 s63, s48, s63
  buffer_load_dwordx4 a[224:227], v8, s[4:7], s63 offen offset:0 sc1
  v_mfma_f32_16x16x32_bf16 v[52:55], a[8:11], a[164:167], v[52:55]
  ds_read_b64_tr_b16 a[56:57], v2 offset:41984
  ds_read_b64_tr_b16 a[58:59], v2 offset:46080
  v_mfma_f32_16x16x32_bf16 v[60:63], a[12:15], a[164:167], v[60:63]
  ds_read_b64_tr_b16 a[44:45], v3 offset:33792
  v_mfma_f32_16x16x32_bf16 v[60:63], a[28:31], a[172:175], v[60:63]
  ds_read_b64_tr_b16 a[46:47], v3 offset:37888
  v_mfma_f32_16x16x32_bf16 v[56:59], a[28:31], a[168:171], v[56:59]
  buffer_load_dwordx4 a[228:231], v9, s[4:7], s63 offen offset:0 sc1
  v_mfma_f32_16x16x32_bf16 v[56:59], a[12:15], a[160:163], v[56:59]
  s_waitcnt lgkmcnt(6)
  ds_read_b64_tr_b16 a[60:61], v3 offset:41984
  ds_read_b64_tr_b16 a[62:63], v3 offset:46080
  v_mfma_f32_16x16x32_bf16 v[64:67], a[32:35], a[160:163], v[64:67]
  ds_read_b64_tr_b16 a[0:1], v0 offset:49152
  s_add_u32 m0, s79, 8192
  v_mfma_f32_16x16x32_bf16 v[64:67], a[48:51], a[168:171], v[64:67]
  s_add_u32 s92, s92, 262144
  ds_read_b64_tr_b16 a[2:3], v0 offset:53248
  s_sub_u32 s93, s92, s88
  v_mfma_f32_16x16x32_bf16 v[68:71], a[48:51], a[172:175], v[68:71]
  buffer_load_dwordx4 v252, s[80:83], s93 offen lds
  v_mfma_f32_16x16x32_bf16 v[68:71], a[32:35], a[164:167], v[68:71]
  ds_read_b64_tr_b16 a[16:17], v0 offset:57344
  ds_read_b64_tr_b16 a[18:19], v0 offset:61440
  v_mfma_f32_16x16x32_bf16 v[76:79], a[36:39], a[164:167], v[76:79]
  ds_read_b64_tr_b16 a[4:5], v1 offset:49152
  v_mfma_f32_16x16x32_bf16 v[76:79], a[52:55], a[172:175], v[76:79]
  ds_read_b64_tr_b16 a[6:7], v1 offset:53248
  v_mfma_f32_16x16x32_bf16 v[72:75], a[52:55], a[168:171], v[72:75]
  buffer_load_dwordx4 v252, s[84:87], s93 offen offset:1024 lds
  v_mfma_f32_16x16x32_bf16 v[72:75], a[36:39], a[160:163], v[72:75]
  s_waitcnt lgkmcnt(6)
  ds_read_b64_tr_b16 a[20:21], v1 offset:57344
  ds_read_b64_tr_b16 a[22:23], v1 offset:61440
  v_mfma_f32_16x16x32_bf16 v[80:83], a[40:43], a[160:163], v[80:83]
  ds_read_b64_tr_b16 a[8:9], v2 offset:49152
  v_mfma_f32_16x16x32_bf16 v[80:83], a[56:59], a[168:171], v[80:83]
  ds_read_b64_tr_b16 a[10:11], v2 offset:53248
  v_mfma_f32_16x16x32_bf16 v[84:87], a[56:59], a[172:175], v[84:87]
  buffer_load_dwordx4 a[232:235], v8, s[4:7], s63 offen offset:1024 sc1
  v_mfma_f32_16x16x32_bf16 v[84:87], a[40:43], a[164:167], v[84:87]
  ds_read_b64_tr_b16 a[24:25], v2 offset:57344
  ds_read_b64_tr_b16 a[26:27], v2 offset:61440
  v_mfma_f32_16x16x32_bf16 v[92:95], a[44:47], a[164:167], v[92:95]
  ds_read_b64_tr_b16 a[12:13], v3 offset:49152
  v_mfma_f32_16x16x32_bf16 v[92:95], a[60:63], a[172:175], v[92:95]
  ds_read_b64_tr_b16 a[14:15], v3 offset:53248
  v_mfma_f32_16x16x32_bf16 v[88:91], a[60:63], a[168:171], v[88:91]
  buffer_load_dwordx4 a[236:239], v9, s[4:7], s63 offen offset:1024 sc1
  v_mfma_f32_16x16x32_bf16 v[88:91], a[44:47], a[160:163], v[88:91]
  s_waitcnt vmcnt(24) lgkmcnt(6)
  ds_read_b64_tr_b16 a[28:29], v3 offset:57344
  ds_read_b64_tr_b16 a[30:31], v3 offset:61440
  v_mfma_f32_16x16x32_bf16 v[32:35], a[0:3], a[176:179], v[32:35]
  ds_read_b64_tr_b16 a[32:33], v0 offset:50176
  s_add_u32 m0, s79, 16384
  v_mfma_f32_16x16x32_bf16 v[32:35], a[16:19], a[184:187], v[32:35]
  s_add_u32 s92, s92, 196608
  ds_read_b64_tr_b16 a[34:35], v0 offset:54272
  s_sub_u32 s93, s92, s88
  v_mfma_f32_16x16x32_bf16 v[36:39], a[16:19], a[188:191], v[36:39]
  buffer_load_dwordx4 v252, s[80:83], s93 offen lds
  v_mfma_f32_16x16x32_bf16 v[36:39], a[0:3], a[180:183], v[36:39]
  ds_read_b64_tr_b16 a[48:49], v0 offset:58368
  ds_read_b64_tr_b16 a[50:51], v0 offset:62464
  v_mfma_f32_16x16x32_bf16 v[44:47], a[4:7], a[180:183], v[44:47]
  ds_read_b64_tr_b16 a[36:37], v1 offset:50176
  v_mfma_f32_16x16x32_bf16 v[44:47], a[20:23], a[188:191], v[44:47]
  ds_read_b64_tr_b16 a[38:39], v1 offset:54272
  v_mfma_f32_16x16x32_bf16 v[40:43], a[20:23], a[184:187], v[40:43]
  buffer_load_dwordx4 v252, s[84:87], s93 offen offset:1024 lds
  v_mfma_f32_16x16x32_bf16 v[40:43], a[4:7], a[176:179], v[40:43]
  s_waitcnt lgkmcnt(6)
  ds_read_b64_tr_b16 a[52:53], v1 offset:58368
  ds_read_b64_tr_b16 a[54:55], v1 offset:62464
  v_mfma_f32_16x16x32_bf16 v[48:51], a[8:11], a[176:179], v[48:51]
  ds_read_b64_tr_b16 a[40:41], v2 offset:50176
  v_mfma_f32_16x16x32_bf16 v[48:51], a[24:27], a[184:187], v[48:51]
  ds_read_b64_tr_b16 a[42:43], v2 offset:54272
  v_mfma_f32_16x16x32_bf16 v[52:55], a[24:27], a[188:191], v[52:55]
  buffer_load_dwordx4 a[240:243], v8, s[4:7], s63 offen offset:2048 sc1
  v_mfma_f32_16x16x32_bf16 v[52:55], a[8:11], a[180:183], v[52:55]
  ds_read_b64_tr_b16 a[56:57], v2 offset:58368
  ds_read_b64_tr_b16 a[58:59], v2 offset:62464
  v_mfma_f32_16x16x32_bf16 v[60:63], a[12:15], a[180:183], v[60:63]
  ds_read_b64_tr_b16 a[44:45], v3 offset:50176
  v_mfma_f32_16x16x32_bf16 v[60:63], a[28:31], a[188:191], v[60:63]
  ds_read_b64_tr_b16 a[46:47], v3 offset:54272
  v_mfma_f32_16x16x32_bf16 v[56:59], a[28:31], a[184:187], v[56:59]
  buffer_load_dwordx4 a[244:247], v9, s[4:7], s63 offen offset:2048 sc1
  v_mfma_f32_16x16x32_bf16 v[56:59], a[12:15], a[176:179], v[56:59]
  s_waitcnt lgkmcnt(6)
  ds_read_b64_tr_b16 a[60:61], v3 offset:58368
  ds_read_b64_tr_b16 a[62:63], v3 offset:62464
  v_mfma_f32_16x16x32_bf16 v[64:67], a[32:35], a[176:179], v[64:67]
  ds_read_b64_tr_b16 a[0:1], v4 offset:0
  s_add_u32 m0, s79, 24576
  v_mfma_f32_16x16x32_bf16 v[64:67], a[48:51], a[184:187], v[64:67]
  s_add_u32 s92, s92, 262144
  ds_read_b64_tr_b16 a[2:3], v4 offset:4096
  s_sub_u32 s93, s92, s88
  v_mfma_f32_16x16x32_bf16 v[68:71], a[48:51], a[188:191], v[68:71]
  buffer_load_dwordx4 v252, s[80:83], s93 offen lds
  v_mfma_f32_16x16x32_bf16 v[68:71], a[32:35], a[180:183], v[68:71]
  ds_read_b64_tr_b16 a[16:17], v4 offset:8192
  ds_read_b64_tr_b16 a[18:19], v4 offset:12288
  v_mfma_f32_16x16x32_bf16 v[76:79], a[36:39], a[180:183], v[76:79]
  ds_read_b64_tr_b16 a[4:5], v5 offset:0
  v_mfma_f32_16x16x32_bf16 v[76:79], a[52:55], a[188:191], v[76:79]
  ds_read_b64_tr_b16 a[6:7], v5 offset:4096
  v_mfma_f32_16x16x32_bf16 v[72:75], a[52:55], a[184:187], v[72:75]
  buffer_load_dwordx4 v252, s[84:87], s93 offen offset:1024 lds
  v_mfma_f32_16x16x32_bf16 v[72:75], a[36:39], a[176:179], v[72:75]
  s_waitcnt lgkmcnt(6)
  ds_read_b64_tr_b16 a[20:21], v5 offset:8192
  ds_read_b64_tr_b16 a[22:23], v5 offset:12288
  v_mfma_f32_16x16x32_bf16 v[80:83], a[40:43], a[176:179], v[80:83]
  ds_read_b64_tr_b16 a[8:9], v6 offset:0
  v_mfma_f32_16x16x32_bf16 v[80:83], a[56:59], a[184:187], v[80:83]
  ds_read_b64_tr_b16 a[10:11], v6 offset:4096
  v_mfma_f32_16x16x32_bf16 v[84:87], a[56:59], a[188:191], v[84:87]
  buffer_load_dwordx4 a[248:251], v8, s[4:7], s63 offen offset:3072 sc1
  v_mfma_f32_16x16x32_bf16 v[84:87], a[40:43], a[180:183], v[84:87]
  ds_read_b64_tr_b16 a[24:25], v6 offset:8192
  ds_read_b64_tr_b16 a[26:27], v6 offset:12288
  v_mfma_f32_16x16x32_bf16 v[92:95], a[44:47], a[180:183], v[92:95]
  ds_read_b64_tr_b16 a[12:13], v7 offset:0
  v_mfma_f32_16x16x32_bf16 v[92:95], a[60:63], a[188:191], v[92:95]
  ds_read_b64_tr_b16 a[14:15], v7 offset:4096
  v_mfma_f32_16x16x32_bf16 v[88:91], a[60:63], a[184:187], v[88:91]
  buffer_load_dwordx4 a[252:255], v9, s[4:7], s63 offen offset:3072 sc1
  v_mfma_f32_16x16x32_bf16 v[88:91], a[44:47], a[176:179], v[88:91]
  s_waitcnt vmcnt(24) lgkmcnt(6)
  ds_read_b64_tr_b16 a[28:29], v7 offset:8192
  ds_read_b64_tr_b16 a[30:31], v7 offset:12288
  v_mfma_f32_16x16x32_bf16 v[32:35], a[0:3], a[192:195], v[32:35]
  s_waitcnt vmcnt(26)
  s_barrier
  s_xor_b32 s43, s56, 2
  s_or_b32 s43, s43, s40
  s_cbranch_scc0 Lp3_sgl_c
Lp3_sgl_r:
  ds_read_b64_tr_b16 a[32:33], v4 offset:1024
  v_mfma_f32_16x16x32_bf16 v[32:35], a[16:19], a[200:203], v[32:35]
  s_add_u32 m0, s79, 32768
  ds_read_b64_tr_b16 a[34:35], v4 offset:5120
  s_add_u32 s92, s92, 196608
  v_mfma_f32_16x16x32_bf16 v[36:39], a[16:19], a[204:207], v[36:39]
  s_sub_u32 s93, s92, s88
  buffer_load_dwordx4 v252, s[80:83], s93 offen lds
  v_mfma_f32_16x16x32_bf16 v[36:39], a[0:3], a[196:199], v[36:39]
  ds_read_b64_tr_b16 a[48:49], v4 offset:9216
  ds_read_b64_tr_b16 a[50:51], v4 offset:13312
  v_mfma_f32_16x16x32_bf16 v[44:47], a[4:7], a[196:199], v[44:47]
  ds_read_b64_tr_b16 a[36:37], v5 offset:1024
  v_mfma_f32_16x16x32_bf16 v[44:47], a[20:23], a[204:207], v[44:47]
  ds_read_b64_tr_b16 a[38:39], v5 offset:5120
  v_mfma_f32_16x16x32_bf16 v[40:43], a[20:23], a[200:203], v[40:43]
  buffer_load_dwordx4 v252, s[84:87], s93 offen offset:1024 lds
  v_mfma_f32_16x16x32_bf16 v[40:43], a[4:7], a[192:195], v[40:43]
  s_waitcnt lgkmcnt(6)
  ds_read_b64_tr_b16 a[52:53], v5 offset:9216
  ds_read_b64_tr_b16 a[54:55], v5 offset:13312
  v_mfma_f32_16x16x32_bf16 v[48:51], a[8:11], a[192:195], v[48:51]
  ds_read_b64_tr_b16 a[40:41], v6 offset:1024
  v_mfma_f32_16x16x32_bf16 v[48:51], a[24:27], a[200:203], v[48:51]
  s_add_u32 s48, s48, 4096
  ds_read_b64_tr_b16 a[42:43], v6 offset:5120
  s_min_u32 s63, s88, 8192
  v_mfma_f32_16x16x32_bf16 v[52:55], a[24:27], a[204:207], v[52:55]
  s_sub_u32 s63, s48, s63
  buffer_load_dwordx4 a[128:131], v8, s[4:7], s63 offen offset:0 sc1
  v_mfma_f32_16x16x32_bf16 v[52:55], a[8:11], a[196:199], v[52:55]
  ds_read_b64_tr_b16 a[56:57], v6 offset:9216
  ds_read_b64_tr_b16 a[58:59], v6 offset:13312
  v_mfma_f32_16x16x32_bf16 v[60:63], a[12:15], a[196:199], v[60:63]
  ds_read_b64_tr_b16 a[44:45], v7 offset:1024
  v_mfma_f32_16x16x32_bf16 v[60:63], a[28:31], a[204:207], v[60:63]
  ds_read_b64_tr_b16 a[46:47], v7 offset:5120
  v_mfma_f32_16x16x32_bf16 v[56:59], a[28:31], a[200:203], v[56:59]
  buffer_load_dwordx4 a[132:135], v9, s[4:7], s63 offen offset:0 sc1
  v_mfma_f32_16x16x32_bf16 v[56:59], a[12:15], a[192:195], v[56:59]
  s_waitcnt lgkmcnt(6)
  ds_read_b64_tr_b16 a[60:61], v7 offset:9216
  ds_read_b64_tr_b16 a[62:63], v7 offset:13312
  v_mfma_f32_16x16x32_bf16 v[64:67], a[32:35], a[192:195], v[64:67]
  ds_read_b64_tr_b16 a[0:1], v4 offset:16384
  s_add_u32 m0, s79, 40960
  v_mfma_f32_16x16x32_bf16 v[64:67], a[48:51], a[200:203], v[64:67]
  s_add_u32 s92, s92, 262144
  ds_read_b64_tr_b16 a[2:3], v4 offset:20480
  s_sub_u32 s93, s92, s88
  v_mfma_f32_16x16x32_bf16 v[68:71], a[48:51], a[204:207], v[68:71]
  buffer_load_dwordx4 v252, s[80:83], s93 offen lds
  v_mfma_f32_16x16x32_bf16 v[68:71], a[32:35], a[196:199], v[68:71]
  ds_read_b64_tr_b16 a[16:17], v4 offset:24576
  ds_read_b64_tr_b16 a[18:19], v4 offset:28672
  v_mfma_f32_16x16x32_bf16 v[76:79], a[36:39], a[196:199], v[76:79]
  ds_read_b64_tr_b16 a[4:5], v5 offset:16384
  v_mfma_f32_16x16x32_bf16 v[76:79], a[52:55], a[204:207], v[76:79]
  ds_read_b64_tr_b16 a[6:7], v5 offset:20480
  v_mfma_f32_16x16x32_bf16 v[72:75], a[52:55], a[200:203], v[72:75]
  buffer_load_dwordx4 v252, s[84:87], s93 offen offset:1024 lds
  v_mfma_f32_16x16x32_bf16 v[72:75], a[36:39], a[192:195], v[72:75]
  s_waitcnt lgkmcnt(6)
  ds_read_b64_tr_b16 a[20:21], v5 offset:24576
  ds_read_b64_tr_b16 a[22:23], v5 offset:28672
  v_mfma_f32_16x16x32_bf16 v[80:83], a[40:43], a[192:195], v[80:83]
  ds_read_b64_tr_b16 a[8:9], v6 offset:16384
  v_mfma_f32_16x16x32_bf16 v[80:83], a[56:59], a[200:203], v[80:83]
  ds_read_b64_tr_b16 a[10:11], v6 offset:20480
  v_mfma_f32_16x16x32_bf16 v[84:87], a[56:59], a[204:207], v[84:87]
  buffer_load_dwordx4 a[136:139], v8, s[4:7], s63 offen offset:1024 sc1
  v_mfma_f32_16x16x32_bf16 v[84:87], a[40:43], a[196:199], v[84:87]
  ds_read_b64_tr_b16 a[24:25], v6 offset:24576
  ds_read_b64_tr_b16 a[26:27], v6 offset:28672
  v_mfma_f32_16x16x32_bf16 v[92:95], a[44:47], a[196:199], v[92:95]
  ds_read_b64_tr_b16 a[12:13], v7 offset:16384
  v_mfma_f32_16x16x32_bf16 v[92:95], a[60:63], a[204:207], v[92:95]
  ds_read_b64_tr_b16 a[14:15], v7 offset:20480
  v_mfma_f32_16x16x32_bf16 v[88:91], a[60:63], a[200:203], v[88:91]
  buffer_load_dwordx4 a[140:143], v9, s[4:7], s63 offen offset:1024 sc1
  v_mfma_f32_16x16x32_bf16 v[88:91], a[44:47], a[192:195], v[88:91]
  s_waitcnt vmcnt(24) lgkmcnt(6)
  ds_read_b64_tr_b16 a[28:29], v7 offset:24576
  ds_read_b64_tr_b16 a[30:31], v7 offset:28672
  v_mfma_f32_16x16x32_bf16 v[32:35], a[0:3], a[208:211], v[32:35]
  ds_read_b64_tr_b16 a[32:33], v4 offset:17408
  s_add_u32 m0, s79, 49152
  v_mfma_f32_16x16x32_bf16 v[32:35], a[16:19], a[216:219], v[32:35]
  s_add_u32 s92, s92, 196608
  ds_read_b64_tr_b16 a[34:35], v4 offset:21504
  s_sub_u32 s93, s92, s88
  v_mfma_f32_16x16x32_bf16 v[36:39], a[16:19], a[220:223], v[36:39]
  buffer_load_dwordx4 v252, s[80:83], s93 offen lds
  v_mfma_f32_16x16x32_bf16 v[36:39], a[0:3], a[212:215], v[36:39]
  ds_read_b64_tr_b16 a[48:49], v4 offset:25600
  ds_read_b64_tr_b16 a[50:51], v4 offset:29696
  v_mfma_f32_16x16x32_bf16 v[44:47], a[4:7], a[212:215], v[44:47]
  ds_read_b64_tr_b16 a[36:37], v5 offset:17408
  v_mfma_f32_16x16x32_bf16 v[44:47], a[20:23], a[220:223], v[44:47]
  ds_read_b64_tr_b16 a[38:39], v5 offset:21504
  v_mfma_f32_16x16x32_bf16 v[40:43], a[20:23], a[216:219], v[40:43]
  buffer_load_dwordx4 v252, s[84:87], s93 offen offset:1024 lds
  v_mfma_f32_16x16x32_bf16 v[40:43], a[4:7], a[208:211], v[40:43]
  s_waitcnt lgkmcnt(6)
  ds_read_b64_tr_b16 a[52:53], v5 offset:25600
  ds_read_b64_tr_b16 a[54:55], v5 offset:29696
  v_mfma_f32_16x16x32_bf16 v[48:51], a[8:11], a[208:211], v[48:51]
  ds_read_b64_tr_b16 a[40:41], v6 offset:17408
  v_mfma_f32_16x16x32_bf16 v[48:51], a[24:27], a[216:219], v[48:51]
  ds_read_b64_tr_b16 a[42:43], v6 offset:21504
  v_mfma_f32_16x16x32_bf16 v[52:55], a[24:27], a[220:223], v[52:55]
  buffer_load_dwordx4 a[144:147], v8, s[4:7], s63 offen offset:2048 sc1
  v_mfma_f32_16x16x32_bf16 v[52:55], a[8:11], a[212:215], v[52:55]
  ds_read_b64_tr_b16 a[56:57], v6 offset:25600
  ds_read_b64_tr_b16 a[58:59], v6 offset:29696
  v_mfma_f32_16x16x32_bf16 v[60:63], a[12:15], a[212:215], v[60:63]
  ds_read_b64_tr_b16 a[44:45], v7 offset:17408
  v_mfma_f32_16x16x32_bf16 v[60:63], a[28:31], a[220:223], v[60:63]
  ds_read_b64_tr_b16 a[46:47], v7 offset:21504
  v_mfma_f32_16x16x32_bf16 v[56:59], a[28:31], a[216:219], v[56:59]
  buffer_load_dwordx4 a[148:151], v9, s[4:7], s63 offen offset:2048 sc1
  v_mfma_f32_16x16x32_bf16 v[56:59], a[12:15], a[208:211], v[56:59]
  s_waitcnt lgkmcnt(6)
  ds_read_b64_tr_b16 a[60:61], v7 offset:25600
  ds_read_b64_tr_b16 a[62:63], v7 offset:29696
  v_mfma_f32_16x16x32_bf16 v[64:67], a[32:35], a[208:211], v[64:67]
  ds_read_b64_tr_b16 a[0:1], v4 offset:32768
  s_add_u32 m0, s79, 57344
  v_mfma_f32_16x16x32_bf16 v[64:67], a[48:51], a[216:219], v[64:67]
  s_add_u32 s92, s92, 262144
  ds_read_b64_tr_b16 a[2:3], v4 offset:36864
  s_sub_u32 s93, s92, s88
  v_mfma_f32_16x16x32_bf16 v[68:71], a[48:51], a[220:223], v[68:71]
  buffer_load_dwordx4 v252, s[80:83], s93 offen lds
  v_mfma_f32_16x16x32_bf16 v[68:71], a[32:35], a[212:215], v[68:71]
  ds_read_b64_tr_b16 a[16:17], v4 offset:40960
  ds_read_b64_tr_b16 a[18:19], v4 offset:45056
  v_mfma_f32_16x16x32_bf16 v[76:79], a[36:39], a[212:215], v[76:79]
  ds_read_b64_tr_b16 a[4:5], v5 offset:32768
  v_mfma_f32_16x16x32_bf16 v[76:79], a[52:55], a[220:223], v[76:79]
  ds_read_b64_tr_b16 a[6:7], v5 offset:36864
  v_mfma_f32_16x16x32_bf16 v[72:75], a[52:55], a[216:219], v[72:75]
  buffer_load_dwordx4 v252, s[84:87], s93 offen offset:1024 lds
  v_mfma_f32_16x16x32_bf16 v[72:75], a[36:39], a[208:211], v[72:75]
  s_waitcnt lgkmcnt(6)
  ds_read_b64_tr_b16 a[20:21], v5 offset:40960
  ds_read_b64_tr_b16 a[22:23], v5 offset:45056
  v_mfma_f32_16x16x32_bf16 v[80:83], a[40:43], a[208:211], v[80:83]
  ds_read_b64_tr_b16 a[8:9], v6 offset:32768
  v_mfma_f32_16x16x32_bf16 v[80:83], a[56:59], a[216:219], v[80:83]
  ds_read_b64_tr_b16 a[10:11], v6 offset:36864
  v_mfma_f32_16x16x32_bf16 v[84:87], a[56:59], a[220:223], v[84:87]
  buffer_load_dwordx4 a[152:155], v8, s[4:7], s63 offen offset:3072 sc1
  v_mfma_f32_16x16x32_bf16 v[84:87], a[40:43], a[212:215], v[84:87]
  ds_read_b64_tr_b16 a[24:25], v6 offset:40960
  ds_read_b64_tr_b16 a[26:27], v6 offset:45056
  v_mfma_f32_16x16x32_bf16 v[92:95], a[44:47], a[212:215], v[92:95]
  ds_read_b64_tr_b16 a[12:13], v7 offset:32768
  v_mfma_f32_16x16x32_bf16 v[92:95], a[60:63], a[220:223], v[92:95]
  ds_read_b64_tr_b16 a[14:15], v7 offset:36864
  v_mfma_f32_16x16x32_bf16 v[88:91], a[60:63], a[216:219], v[88:91]
  buffer_load_dwordx4 a[156:159], v9, s[4:7], s63 offen offset:3072 sc1
  v_mfma_f32_16x16x32_bf16 v[88:91], a[44:47], a[208:211], v[88:91]
  s_waitcnt vmcnt(24) lgkmcnt(6)
  ds_read_b64_tr_b16 a[28:29], v7 offset:40960
  ds_read_b64_tr_b16 a[30:31], v7 offset:45056
  v_mfma_f32_16x16x32_bf16 v[32:35], a[0:3], a[224:227], v[32:35]
  s_waitcnt vmcnt(26)
  s_barrier
  ds_read_b64_tr_b16 a[32:33], v4 offset:33792
  v_mfma_f32_16x16x32_bf16 v[32:35], a[16:19], a[232:235], v[32:35]
  s_add_u32 m0, s79, 65536
  ds_read_b64_tr_b16 a[34:35], v4 offset:37888
  s_add_u32 s92, s92, -3407872
  v_mfma_f32_16x16x32_bf16 v[36:39], a[16:19], a[236:239], v[36:39]
  s_add_u32 s93, s92, s88
  buffer_load_dwordx4 v252, s[80:83], s93 offen lds
  v_mfma_f32_16x16x32_bf16 v[36:39], a[0:3], a[228:231], v[36:39]
  ds_read_b64_tr_b16 a[48:49], v4 offset:41984
  ds_read_b64_tr_b16 a[50:51], v4 offset:46080
  v_mfma_f32_16x16x32_bf16 v[44:47], a[4:7], a[228:231], v[44:47]
  ds_read_b64_tr_b16 a[36:37], v5 offset:33792
  v_mfma_f32_16x16x32_bf16 v[44:47], a[20:23], a[236:239], v[44:47]
  ds_read_b64_tr_b16 a[38:39], v5 offset:37888
  v_mfma_f32_16x16x32_bf16 v[40:43], a[20:23], a[232:235], v[40:43]
  buffer_load_dwordx4 v252, s[84:87], s93 offen offset:1024 lds
  v_mfma_f32_16x16x32_bf16 v[40:43], a[4:7], a[224:227], v[40:43]
  s_waitcnt lgkmcnt(6)
  ds_read_b64_tr_b16 a[52:53], v5 offset:41984
  ds_read_b64_tr_b16 a[54:55], v5 offset:46080
  v_mfma_f32_16x16x32_bf16 v[48:51], a[8:11], a[224:227], v[48:51]
  ds_read_b64_tr_b16 a[40:41], v6 offset:33792
  v_mfma_f32_16x16x32_bf16 v[48:51], a[24:27], a[232:235], v[48:51]
  s_add_u32 s48, s48, 4096
  ds_read_b64_tr_b16 a[42:43], v6 offset:37888
  s_min_u32 s63, s88, 8192
  v_mfma_f32_16x16x32_bf16 v[52:55], a[24:27], a[236:239], v[52:55]
  s_sub_u32 s63, s48, s63
  buffer_load_dwordx4 a[160:163], v8, s[4:7], s63 offen offset:0 sc1
  v_mfma_f32_16x16x32_bf16 v[52:55], a[8:11], a[228:231], v[52:55]
  ds_read_b64_tr_b16 a[56:57], v6 offset:41984
  ds_read_b64_tr_b16 a[58:59], v6 offset:46080
  v_mfma_f32_16x16x32_bf16 v[60:63], a[12:15], a[228:231], v[60:63]
  ds_read_b64_tr_b16 a[44:45], v7 offset:33792
  v_mfma_f32_16x16x32_bf16 v[60:63], a[28:31], a[236:239], v[60:63]
  ds_read_b64_tr_b16 a[46:47], v7 offset:37888
  v_mfma_f32_16x16x32_bf16 v[56:59], a[28:31], a[232:235], v[56:59]
  buffer_load_dwordx4 a[164:167], v9, s[4:7], s63 offen offset:0 sc1
  v_mfma_f32_16x16x32_bf16 v[56:59], a[12:15], a[224:227], v[56:59]
  s_waitcnt lgkmcnt(6)
  ds_read_b64_tr_b16 a[60:61], v7 offset:41984
  ds_read_b64_tr_b16 a[62:63], v7 offset:46080
  v_mfma_f32_16x16x32_bf16 v[64:67], a[32:35], a[224:227], v[64:67]
  s_add_u32 m0, s79, 73728
  ds_read_b64_tr_b16 a[0:1], v4 offset:49152
  buffer_load_dword v10, v251, s[4:7], s64 offen sc1
  v_mfma_f32_16x16x32_bf16 v[64:67], a[48:51], a[232:235], v[64:67]
  s_add_u32 s92, s92, 262144
  ds_read_b64_tr_b16 a[2:3], v4 offset:53248
  s_add_u32 s93, s92, s88
  v_mfma_f32_16x16x32_bf16 v[68:71], a[48:51], a[236:239], v[68:71]
  buffer_load_dwordx4 v252, s[80:83], s93 offen lds
  v_mfma_f32_16x16x32_bf16 v[68:71], a[32:35], a[228:231], v[68:71]
  ds_read_b64_tr_b16 a[16:17], v4 offset:57344
  ds_read_b64_tr_b16 a[18:19], v4 offset:61440
  v_mfma_f32_16x16x32_bf16 v[76:79], a[36:39], a[228:231], v[76:79]
  ds_read_b64_tr_b16 a[4:5], v5 offset:49152
  v_mfma_f32_16x16x32_bf16 v[76:79], a[52:55], a[236:239], v[76:79]
  ds_read_b64_tr_b16 a[6:7], v5 offset:53248
  v_mfma_f32_16x16x32_bf16 v[72:75], a[52:55], a[232:235], v[72:75]
  buffer_load_dwordx4 v252, s[84:87], s93 offen offset:1024 lds
  v_mfma_f32_16x16x32_bf16 v[72:75], a[36:39], a[224:227], v[72:75]
  s_waitcnt lgkmcnt(6)
  ds_read_b64_tr_b16 a[20:21], v5 offset:57344
  ds_read_b64_tr_b16 a[22:23], v5 offset:61440
  v_mfma_f32_16x16x32_bf16 v[80:83], a[40:43], a[224:227], v[80:83]
  ds_read_b64_tr_b16 a[8:9], v6 offset:49152
  v_mfma_f32_16x16x32_bf16 v[80:83], a[56:59], a[232:235], v[80:83]
  ds_read_b64_tr_b16 a[10:11], v6 offset:53248
  v_mfma_f32_16x16x32_bf16 v[84:87], a[56:59], a[236:239], v[84:87]
  buffer_load_dwordx4 a[168:171], v8, s[4:7], s63 offen offset:1024 sc1
  v_mfma_f32_16x16x32_bf16 v[84:87], a[40:43], a[228:231], v[84:87]
  ds_read_b64_tr_b16 a[24:25], v6 offset:57344
  ds_read_b64_tr_b16 a[26:27], v6 offset:61440
  v_mfma_f32_16x16x32_bf16 v[92:95], a[44:47], a[228:231], v[92:95]
  ds_read_b64_tr_b16 a[12:13], v7 offset:49152
  v_mfma_f32_16x16x32_bf16 v[92:95], a[60:63], a[236:239], v[92:95]
  ds_read_b64_tr_b16 a[14:15], v7 offset:53248
  v_mfma_f32_16x16x32_bf16 v[88:91], a[60:63], a[232:235], v[88:91]
  buffer_load_dwordx4 a[172:175], v9, s[4:7], s63 offen offset:1024 sc1
  v_mfma_f32_16x16x32_bf16 v[88:91], a[44:47], a[224:227], v[88:91]
  s_waitcnt vmcnt(25) lgkmcnt(6)
  ds_read_b64_tr_b16 a[28:29], v7 offset:57344
  ds_read_b64_tr_b16 a[30:31], v7 offset:61440
  v_mfma_f32_16x16x32_bf16 v[32:35], a[0:3], a[240:243], v[32:35]
  ds_read_b64_tr_b16 a[32:33], v4 offset:50176
  s_add_u32 m0, s79, 81920
  v_mfma_f32_16x16x32_bf16 v[32:35], a[16:19], a[248:251], v[32:35]
  s_add_u32 s92, s92, 196608
  ds_read_b64_tr_b16 a[34:35], v4 offset:54272
  s_add_u32 s93, s92, s88
  v_mfma_f32_16x16x32_bf16 v[36:39], a[16:19], a[252:255], v[36:39]
  buffer_load_dwordx4 v252, s[80:83], s93 offen lds
  v_mfma_f32_16x16x32_bf16 v[36:39], a[0:3], a[244:247], v[36:39]
  ds_read_b64_tr_b16 a[48:49], v4 offset:58368
  ds_read_b64_tr_b16 a[50:51], v4 offset:62464
  v_mfma_f32_16x16x32_bf16 v[44:47], a[4:7], a[244:247], v[44:47]
  ds_read_b64_tr_b16 a[36:37], v5 offset:50176
  v_mfma_f32_16x16x32_bf16 v[44:47], a[20:23], a[252:255], v[44:47]
  ds_read_b64_tr_b16 a[38:39], v5 offset:54272
  v_mfma_f32_16x16x32_bf16 v[40:43], a[20:23], a[248:251], v[40:43]
  buffer_load_dwordx4 v252, s[84:87], s93 offen offset:1024 lds
  v_mfma_f32_16x16x32_bf16 v[40:43], a[4:7], a[240:243], v[40:43]
  s_waitcnt lgkmcnt(6)
  ds_read_b64_tr_b16 a[52:53], v5 offset:58368
  ds_read_b64_tr_b16 a[54:55], v5 offset:62464
  v_mfma_f32_16x16x32_bf16 v[48:51], a[8:11], a[240:243], v[48:51]
  ds_read_b64_tr_b16 a[40:41], v6 offset:50176
  v_mfma_f32_16x16x32_bf16 v[48:51], a[24:27], a[248:251], v[48:51]
  ds_read_b64_tr_b16 a[42:43], v6 offset:54272
  v_mfma_f32_16x16x32_bf16 v[52:55], a[24:27], a[252:255], v[52:55]
  buffer_load_dwordx4 a[176:179], v8, s[4:7], s63 offen offset:2048 sc1
  v_mfma_f32_16x16x32_bf16 v[52:55], a[8:11], a[244:247], v[52:55]
  ds_read_b64_tr_b16 a[56:57], v6 offset:58368
  ds_read_b64_tr_b16 a[58:59], v6 offset:62464
  v_mfma_f32_16x16x32_bf16 v[60:63], a[12:15], a[244:247], v[60:63]
  ds_read_b64_tr_b16 a[44:45], v7 offset:50176
  v_mfma_f32_16x16x32_bf16 v[60:63], a[28:31], a[252:255], v[60:63]
  ds_read_b64_tr_b16 a[46:47], v7 offset:54272
  v_mfma_f32_16x16x32_bf16 v[56:59], a[28:31], a[248:251], v[56:59]
  buffer_load_dwordx4 a[180:183], v9, s[4:7], s63 offen offset:2048 sc1
  v_mfma_f32_16x16x32_bf16 v[56:59], a[12:15], a[240:243], v[56:59]
  s_waitcnt lgkmcnt(6)
  ds_read_b64_tr_b16 a[60:61], v7 offset:58368
  ds_read_b64_tr_b16 a[62:63], v7 offset:62464
  v_mfma_f32_16x16x32_bf16 v[64:67], a[32:35], a[240:243], v[64:67]
  ds_read_b64_tr_b16 a[0:1], v0 offset:0
  s_add_u32 m0, s79, 90112
  v_mfma_f32_16x16x32_bf16 v[64:67], a[48:51], a[248:251], v[64:67]
  s_add_u32 s92, s92, 262144
  ds_read_b64_tr_b16 a[2:3], v0 offset:4096
  s_add_u32 s93, s92, s88
  v_mfma_f32_16x16x32_bf16 v[68:71], a[48:51], a[252:255], v[68:71]
  buffer_load_dwordx4 v252, s[80:83], s93 offen lds
  v_mfma_f32_16x16x32_bf16 v[68:71], a[32:35], a[244:247], v[68:71]
  ds_read_b64_tr_b16 a[16:17], v0 offset:8192
  ds_read_b64_tr_b16 a[18:19], v0 offset:12288
  v_mfma_f32_16x16x32_bf16 v[76:79], a[36:39], a[244:247], v[76:79]
  ds_read_b64_tr_b16 a[4:5], v1 offset:0
  v_mfma_f32_16x16x32_bf16 v[76:79], a[52:55], a[252:255], v[76:79]
  ds_read_b64_tr_b16 a[6:7], v1 offset:4096
  v_mfma_f32_16x16x32_bf16 v[72:75], a[52:55], a[248:251], v[72:75]
  buffer_load_dwordx4 v252, s[84:87], s93 offen offset:1024 lds
  v_mfma_f32_16x16x32_bf16 v[72:75], a[36:39], a[240:243], v[72:75]
  s_waitcnt lgkmcnt(6)
  ds_read_b64_tr_b16 a[20:21], v1 offset:8192
  ds_read_b64_tr_b16 a[22:23], v1 offset:12288
  v_mfma_f32_16x16x32_bf16 v[80:83], a[40:43], a[240:243], v[80:83]
  ds_read_b64_tr_b16 a[8:9], v2 offset:0
  v_mfma_f32_16x16x32_bf16 v[80:83], a[56:59], a[248:251], v[80:83]
  ds_read_b64_tr_b16 a[10:11], v2 offset:4096
  v_mfma_f32_16x16x32_bf16 v[84:87], a[56:59], a[252:255], v[84:87]
  buffer_load_dwordx4 a[184:187], v8, s[4:7], s63 offen offset:3072 sc1
  v_mfma_f32_16x16x32_bf16 v[84:87], a[40:43], a[244:247], v[84:87]
  ds_read_b64_tr_b16 a[24:25], v2 offset:8192
  ds_read_b64_tr_b16 a[26:27], v2 offset:12288
  v_mfma_f32_16x16x32_bf16 v[92:95], a[44:47], a[244:247], v[92:95]
  ds_read_b64_tr_b16 a[12:13], v3 offset:0
  v_mfma_f32_16x16x32_bf16 v[92:95], a[60:63], a[252:255], v[92:95]
  s_sub_u32 s56, s56, 1
  ds_read_b64_tr_b16 a[14:15], v3 offset:4096
  v_mfma_f32_16x16x32_bf16 v[88:91], a[60:63], a[248:251], v[88:91]
  s_cmp_lg_u32 s56, 0
  buffer_load_dwordx4 a[188:191], v9, s[4:7], s63 offen offset:3072 sc1
  ds_read_b64_tr_b16 a[28:29], v3 offset:8192
  v_mfma_f32_16x16x32_bf16 v[88:91], a[44:47], a[240:243], v[88:91]
  ds_read_b64_tr_b16 a[30:31], v3 offset:12288
  s_cbranch_scc1 Lp4_loop
Lmk_Lp4_loop_tail:
  s_waitcnt vmcnt(25) lgkmcnt(8)
  v_mfma_f32_16x16x32_bf16 v[32:35], a[0:3], a[128:131], v[32:35]
  s_waitcnt vmcnt(27)
  s_barrier
  ds_read_b64_tr_b16 a[32:33], v0 offset:1024
  v_mfma_f32_16x16x32_bf16 v[32:35], a[16:19], a[136:139], v[32:35]
  s_add_u32 m0, s79, 98304
  ds_read_b64_tr_b16 a[34:35], v0 offset:5120
  s_add_u32 s92, s92, 196608
  v_mfma_f32_16x16x32_bf16 v[36:39], a[16:19], a[140:143], v[36:39]
  s_add_u32 s93, s92, s88
  buffer_load_dwordx4 v252, s[80:83], s93 offen lds
  v_mfma_f32_16x16x32_bf16 v[36:39], a[0:3], a[132:135], v[36:39]
  ds_read_b64_tr_b16 a[48:49], v0 offset:9216
  ds_read_b64_tr_b16 a[50:51], v0 offset:13312
  v_mfma_f32_16x16x32_bf16 v[44:47], a[4:7], a[132:135], v[44:47]
  ds_read_b64_tr_b16 a[36:37], v1 offset:1024
  v_mfma_f32_16x16x32_bf16 v[44:47], a[20:23], a[140:143], v[44:47]
  ds_read_b64_tr_b16 a[38:39], v1 offset:5120
  v_mfma_f32_16x16x32_bf16 v[40:43], a[20:23], a[136:139], v[40:43]
  buffer_load_dwordx4 v252, s[84:87], s93 offen offset:1024 lds
  v_mfma_f32_16x16x32_bf16 v[40:43], a[4:7], a[128:131], v[40:43]
  s_waitcnt lgkmcnt(6)
  ds_read_b64_tr_b16 a[52:53], v1 offset:9216
  ds_read_b64_tr_b16 a[54:55], v1 offset:13312
  v_mfma_f32_16x16x32_bf16 v[48:51], a[8:11], a[128:131], v[48:51]
  ds_read_b64_tr_b16 a[40:41], v2 offset:1024
  v_mfma_f32_16x16x32_bf16 v[48:51], a[24:27], a[136:139], v[48:51]
  s_add_u32 s48, s48, 4096
  ds_read_b64_tr_b16 a[42:43], v2 offset:5120
  s_min_u32 s63, s88, 8192
  v_mfma_f32_16x16x32_bf16 v[52:55], a[24:27], a[140:143], v[52:55]
  s_add_u32 s63, s48, s63
  buffer_load_dwordx4 a[192:195], v8, s[4:7], s63 offen offset:0 sc1
  v_mfma_f32_16x16x32_bf16 v[52:55], a[8:11], a[132:135], v[52:55]
  ds_read_b64_tr_b16 a[56:57], v2 offset:9216
  ds_read_b64_tr_b16 a[58:59], v2 offset:13312
  v_mfma_f32_16x16x32_bf16 v[60:63], a[12:15], a[132:135], v[60:63]
  ds_read_b64_tr_b16 a[44:45], v3 offset:1024
  v_mfma_f32_16x16x32_bf16 v[60:63], a[28:31], a[140:143], v[60:63]
  ds_read_b64_tr_b16 a[46:47], v3 offset:5120
  v_mfma_f32_16x16x32_bf16 v[56:59], a[28:31], a[136:139], v[56:59]
  buffer_load_dwordx4 a[196:199], v9, s[4:7], s63 offen offset:0 sc1
  v_mfma_f32_16x16x32_bf16 v[56:59], a[12:15], a[128:131], v[56:59]
  s_waitcnt lgkmcnt(6)
  ds_read_b64_tr_b16 a[60:61], v3 offset:9216
  ds_read_b64_tr_b16 a[62:63], v3 offset:13312
  v_mfma_f32_16x16x32_bf16 v[64:67], a[32:35], a[128:131], v[64:67]
  ds_read_b64_tr_b16 a[0:1], v0 offset:16384
  s_add_u32 m0, s79, 106496
  v_mfma_f32_16x16x32_bf16 v[64:67], a[48:51], a[136:139], v[64:67]
  s_add_u32 s92, s92, 262144
  ds_read_b64_tr_b16 a[2:3], v0 offset:20480
  s_add_u32 s93, s92, s88
  v_mfma_f32_16x16x32_bf16 v[68:71], a[48:51], a[140:143], v[68:71]
  buffer_load_dwordx4 v252, s[80:83], s93 offen lds
  v_mfma_f32_16x16x32_bf16 v[68:71], a[32:35], a[132:135], v[68:71]
  ds_read_b64_tr_b16 a[16:17], v0 offset:24576
  ds_read_b64_tr_b16 a[18:19], v0 offset:28672
  v_mfma_f32_16x16x32_bf16 v[76:79], a[36:39], a[132:135], v[76:79]
  ds_read_b64_tr_b16 a[4:5], v1 offset:16384
  v_mfma_f32_16x16x32_bf16 v[76:79], a[52:55], a[140:143], v[76:79]
  ds_read_b64_tr_b16 a[6:7], v1 offset:20480
  v_mfma_f32_16x16x32_bf16 v[72:75], a[52:55], a[136:139], v[72:75]
  buffer_load_dwordx4 v252, s[84:87], s93 offen offset:1024 lds
  v_mfma_f32_16x16x32_bf16 v[72:75], a[36:39], a[128:131], v[72:75]
  s_waitcnt lgkmcnt(6)
  ds_read_b64_tr_b16 a[20:21], v1 offset:24576
  ds_read_b64_tr_b16 a[22:23], v1 offset:28672
  v_mfma_f32_16x16x32_bf16 v[80:83], a[40:43], a[128:131], v[80:83]
  ds_read_b64_tr_b16 a[8:9], v2 offset:16384
  v_mfma_f32_16x16x32_bf16 v[80:83], a[56:59], a[136:139], v[80:83]
  ds_read_b64_tr_b16 a[10:11], v2 offset:20480
  v_mfma_f32_16x16x32_bf16 v[84:87], a[56:59], a[140:143], v[84:87]
  buffer_load_dwordx4 a[200:203], v8, s[4:7], s63 offen offset:1024 sc1
  v_mfma_f32_16x16x32_bf16 v[84:87], a[40:43], a[132:135], v[84:87]
  ds_read_b64_tr_b16 a[24:25], v2 offset:24576
  ds_read_b64_tr_b16 a[26:27], v2 offset:28672
  v_mfma_f32_16x16x32_bf16 v[92:95], a[44:47], a[132:135], v[92:95]
  ds_read_b64_tr_b16 a[12:13], v3 offset:16384
  v_mfma_f32_16x16x32_bf16 v[92:95], a[60:63], a[140:143], v[92:95]
  ds_read_b64_tr_b16 a[14:15], v3 offset:20480
  v_mfma_f32_16x16x32_bf16 v[88:91], a[60:63], a[136:139], v[88:91]
  buffer_load_dwordx4 a[204:207], v9, s[4:7], s63 offen offset:1024 sc1
  v_mfma_f32_16x16x32_bf16 v[88:91], a[44:47], a[128:131], v[88:91]
  s_waitcnt vmcnt(25) lgkmcnt(6)
  ds_read_b64_tr_b16 a[28:29], v3 offset:24576
  ds_read_b64_tr_b16 a[30:31], v3 offset:28672
  v_mfma_f32_16x16x32_bf16 v[32:35], a[0:3], a[144:147], v[32:35]
  ds_read_b64_tr_b16 a[32:33], v0 offset:17408
  s_add_u32 m0, s79, 114688
  v_mfma_f32_16x16x32_bf16 v[32:35], a[16:19], a[152:155], v[32:35]
  s_add_u32 s92, s92, 196608
  ds_read_b64_tr_b16 a[34:35], v0 offset:21504
  s_add_u32 s93, s92, s88
  v_mfma_f32_16x16x32_bf16 v[36:39], a[16:19], a[156:159], v[36:39]
  buffer_load_dwordx4 v252, s[80:83], s93 offen lds
  v_mfma_f32_16x16x32_bf16 v[36:39], a[0:3], a[148:151], v[36:39]
  ds_read_b64_tr_b16 a[48:49], v0 offset:25600
  ds_read_b64_tr_b16 a[50:51], v0 offset:29696
  v_mfma_f32_16x16x32_bf16 v[44:47], a[4:7], a[148:151], v[44:47]
  ds_read_b64_tr_b16 a[36:37], v1 offset:17408
  v_mfma_f32_16x16x32_bf16 v[44:47], a[20:23], a[156:159], v[44:47]
  ds_read_b64_tr_b16 a[38:39], v1 offset:21504
  v_mfma_f32_16x16x32_bf16 v[40:43], a[20:23], a[152:155], v[40:43]
  buffer_load_dwordx4 v252, s[84:87], s93 offen offset:1024 lds
  v_mfma_f32_16x16x32_bf16 v[40:43], a[4:7], a[144:147], v[40:43]
  s_waitcnt lgkmcnt(6)
  ds_read_b64_tr_b16 a[52:53], v1 offset:25600
  ds_read_b64_tr_b16 a[54:55], v1 offset:29696
  v_mfma_f32_16x16x32_bf16 v[48:51], a[8:11], a[144:147], v[48:51]
  ds_read_b64_tr_b16 a[40:41], v2 offset:17408
  v_mfma_f32_16x16x32_bf16 v[48:51], a[24:27], a[152:155], v[48:51]
  ds_read_b64_tr_b16 a[42:43], v2 offset:21504
  v_mfma_f32_16x16x32_bf16 v[52:55], a[24:27], a[156:159], v[52:55]
  buffer_load_dwordx4 a[208:211], v8, s[4:7], s63 offen offset:2048 sc1
  v_mfma_f32_16x16x32_bf16 v[52:55], a[8:11], a[148:151], v[52:55]
  ds_read_b64_tr_b16 a[56:57], v2 offset:25600
  ds_read_b64_tr_b16 a[58:59], v2 offset:29696
  v_mfma_f32_16x16x32_bf16 v[60:63], a[12:15], a[148:151], v[60:63]
  ds_read_b64_tr_b16 a[44:45], v3 offset:17408
  v_mfma_f32_16x16x32_bf16 v[60:63], a[28:31], a[156:159], v[60:63]
  ds_read_b64_tr_b16 a[46:47], v3 offset:21504
  v_mfma_f32_16x16x32_bf16 v[56:59], a[28:31], a[152:155], v[56:59]
  buffer_load_dwordx4 a[212:215], v9, s[4:7], s63 offen offset:2048 sc1
  v_mfma_f32_16x16x32_bf16 v[56:59], a[12:15], a[144:147], v[56:59]
  s_waitcnt lgkmcnt(6)
  ds_read_b64_tr_b16 a[60:61], v3 offset:25600
  ds_read_b64_tr_b16 a[62:63], v3 offset:29696
  v_mfma_f32_16x16x32_bf16 v[64:67], a[32:35], a[144:147], v[64:67]
  ds_read_b64_tr_b16 a[0:1], v0 offset:32768
  s_add_u32 m0, s79, 122880
  v_mfma_f32_16x16x32_bf16 v[64:67], a[48:51], a[152:155], v[64:67]
  s_add_u32 s92, s92, 262144
  ds_read_b64_tr_b16 a[2:3], v0 offset:36864
  s_add_u32 s93, s92, s88
  v_mfma_f32_16x16x32_bf16 v[68:71], a[48:51], a[156:159], v[68:71]
  buffer_load_dwordx4 v252, s[80:83], s93 offen lds
  v_mfma_f32_16x16x32_bf16 v[68:71], a[32:35], a[148:151], v[68:71]
  ds_read_b64_tr_b16 a[16:17], v0 offset:40960
  ds_read_b64_tr_b16 a[18:19], v0 offset:45056
  v_mfma_f32_16x16x32_bf16 v[76:79], a[36:39], a[148:151], v[76:79]
  ds_read_b64_tr_b16 a[4:5], v1 offset:32768
  v_mfma_f32_16x16x32_bf16 v[76:79], a[52:55], a[156:159], v[76:79]
  ds_read_b64_tr_b16 a[6:7], v1 offset:36864
  v_mfma_f32_16x16x32_bf16 v[72:75], a[52:55], a[152:155], v[72:75]
  buffer_load_dwordx4 v252, s[84:87], s93 offen offset:1024 lds
  v_mfma_f32_16x16x32_bf16 v[72:75], a[36:39], a[144:147], v[72:75]
  s_waitcnt lgkmcnt(6)
  ds_read_b64_tr_b16 a[20:21], v1 offset:40960
  ds_read_b64_tr_b16 a[22:23], v1 offset:45056
  v_mfma_f32_16x16x32_bf16 v[80:83], a[40:43], a[144:147], v[80:83]
  ds_read_b64_tr_b16 a[8:9], v2 offset:32768
  v_mfma_f32_16x16x32_bf16 v[80:83], a[56:59], a[152:155], v[80:83]
  ds_read_b64_tr_b16 a[10:11], v2 offset:36864
  v_mfma_f32_16x16x32_bf16 v[84:87], a[56:59], a[156:159], v[84:87]
  buffer_load_dwordx4 a[216:219], v8, s[4:7], s63 offen offset:3072 sc1
  v_mfma_f32_16x16x32_bf16 v[84:87], a[40:43], a[148:151], v[84:87]
  ds_read_b64_tr_b16 a[24:25], v2 offset:40960
  ds_read_b64_tr_b16 a[26:27], v2 offset:45056
  v_mfma_f32_16x16x32_bf16 v[92:95], a[44:47], a[148:151], v[92:95]
  ds_read_b64_tr_b16 a[12:13], v3 offset:32768
  v_mfma_f32_16x16x32_bf16 v[92:95], a[60:63], a[156:159], v[92:95]
  ds_read_b64_tr_b16 a[14:15], v3 offset:36864
  v_mfma_f32_16x16x32_bf16 v[88:91], a[60:63], a[152:155], v[88:91]
  buffer_load_dwordx4 a[220:223], v9, s[4:7], s63 offen offset:3072 sc1
  v_mfma_f32_16x16x32_bf16 v[88:91], a[44:47], a[144:147], v[88:91]
  s_waitcnt vmcnt(24) lgkmcnt(6)
  ds_read_b64_tr_b16 a[28:29], v3 offset:40960
  ds_read_b64_tr_b16 a[30:31], v3 offset:45056
  v_mfma_f32_16x16x32_bf16 v[32:35], a[0:3], a[160:163], v[32:35]
  s_waitcnt vmcnt(26)
  s_barrier
  ds_read_b64_tr_b16 a[32:33], v0 offset:33792
  v_mfma_f32_16x16x32_bf16 v[32:35], a[16:19], a[168:171], v[32:35]
  s_add_u32 m0, s79, 0
  ds_read_b64_tr_b16 a[34:35], v0 offset:37888
  s_add_u32 s92, s92, 196608
  v_mfma_f32_16x16x32_bf16 v[36:39], a[16:19], a[172:175], v[36:39]
  s_sub_u32 s93, s92, s88
  buffer_load_dwordx4 v252, s[80:83], s93 offen lds
  v_mfma_f32_16x16x32_bf16 v[36:39], a[0:3], a[164:167], v[36:39]
  ds_read_b64_tr_b16 a[48:49], v0 offset:41984
  ds_read_b64_tr_b16 a[50:51], v0 offset:46080
  v_mfma_f32_16x16x32_bf16 v[44:47], a[4:7], a[164:167], v[44:47]
  ds_read_b64_tr_b16 a[36:37], v1 offset:33792
  v_mfma_f32_16x16x32_bf16 v[44:47], a[20:23], a[172:175], v[44:47]
  ds_read_b64_tr_b16 a[38:39], v1 offset:37888
  v_mfma_f32_16x16x32_bf16 v[40:43], a[20:23], a[168:171], v[40:43]
  buffer_load_dwordx4 v252, s[84:87], s93 offen offset:1024 lds
  v_mfma_f32_16x16x32_bf16 v[40:43], a[4:7], a[160:163], v[40:43]
  s_waitcnt lgkmcnt(6)
  ds_read_b64_tr_b16 a[52:53], v1 offset:41984
  ds_read_b64_tr_b16 a[54:55], v1 offset:46080
  v_mfma_f32_16x16x32_bf16 v[48:51], a[8:11], a[160:163], v[48:51]
  ds_read_b64_tr_b16 a[40:41], v2 offset:33792
  v_mfma_f32_16x16x32_bf16 v[48:51], a[24:27], a[168:171], v[48:51]
  s_add_u32 s48, s48, 4096
  ds_read_b64_tr_b16 a[42:43], v2 offset:37888
  s_min_u32 s63, s88, 8192
  v_mfma_f32_16x16x32_bf16 v[52:55], a[24:27], a[172:175], v[52:55]
  s_add_u32 s63, s48, s63
  buffer_load_dwordx4 a[224:227], v8, s[4:7], s63 offen offset:0 sc1
  v_mfma_f32_16x16x32_bf16 v[52:55], a[8:11], a[164:167], v[52:55]
  ds_read_b64_tr_b16 a[56:57], v2 offset:41984
  ds_read_b64_tr_b16 a[58:59], v2 offset:46080
  v_mfma_f32_16x16x32_bf16 v[60:63], a[12:15], a[164:167], v[60:63]
  ds_read_b64_tr_b16 a[44:45], v3 offset:33792
  v_mfma_f32_16x16x32_bf16 v[60:63], a[28:31], a[172:175], v[60:63]
  ds_read_b64_tr_b16 a[46:47], v3 offset:37888
  v_mfma_f32_16x16x32_bf16 v[56:59], a[28:31], a[168:171], v[56:59]
  buffer_load_dwordx4 a[228:231], v9, s[4:7], s63 offen offset:0 sc1
  v_mfma_f32_16x16x32_bf16 v[56:59], a[12:15], a[160:163], v[56:59]
  s_waitcnt lgkmcnt(6)
  ds_read_b64_tr_b16 a[60:61], v3 offset:41984
  ds_read_b64_tr_b16 a[62:63], v3 offset:46080
  v_mfma_f32_16x16x32_bf16 v[64:67], a[32:35], a[160:163], v[64:67]
  ds_read_b64_tr_b16 a[0:1], v0 offset:49152
  s_add_u32 m0, s79, 8192
  v_mfma_f32_16x16x32_bf16 v[64:67], a[48:51], a[168:171], v[64:67]
  s_add_u32 s92, s92, 262144
  ds_read_b64_tr_b16 a[2:3], v0 offset:53248
  s_sub_u32 s93, s92, s88
  v_mfma_f32_16x16x32_bf16 v[68:71], a[48:51], a[172:175], v[68:71]
  buffer_load_dwordx4 v252, s[80:83], s93 offen lds
  v_mfma_f32_16x16x32_bf16 v[68:71], a[32:35], a[164:167], v[68:71]
  ds_read_b64_tr_b16 a[16:17], v0 offset:57344
  ds_read_b64_tr_b16 a[18:19], v0 offset:61440
  v_mfma_f32_16x16x32_bf16 v[76:79], a[36:39], a[164:167], v[76:79]
  ds_read_b64_tr_b16 a[4:5], v1 offset:49152
  v_mfma_f32_16x16x32_bf16 v[76:79], a[52:55], a[172:175], v[76:79]
  ds_read_b64_tr_b16 a[6:7], v1 offset:53248
  v_mfma_f32_16x16x32_bf16 v[72:75], a[52:55], a[168:171], v[72:75]
  buffer_load_dwordx4 v252, s[84:87], s93 offen offset:1024 lds
  v_mfma_f32_16x16x32_bf16 v[72:75], a[36:39], a[160:163], v[72:75]
  s_waitcnt lgkmcnt(6)
  ds_read_b64_tr_b16 a[20:21], v1 offset:57344
  ds_read_b64_tr_b16 a[22:23], v1 offset:61440
  v_mfma_f32_16x16x32_bf16 v[80:83], a[40:43], a[160:163], v[80:83]
  ds_read_b64_tr_b16 a[8:9], v2 offset:49152
  v_mfma_f32_16x16x32_bf16 v[80:83], a[56:59], a[168:171], v[80:83]
  ds_read_b64_tr_b16 a[10:11], v2 offset:53248
  v_mfma_f32_16x16x32_bf16 v[84:87], a[56:59], a[172:175], v[84:87]
  buffer_load_dwordx4 a[232:235], v8, s[4:7], s63 offen offset:1024 sc1
  v_mfma_f32_16x16x32_bf16 v[84:87], a[40:43], a[164:167], v[84:87]
  ds_read_b64_tr_b16 a[24:25], v2 offset:57344
  ds_read_b64_tr_b16 a[26:27], v2 offset:61440
  v_mfma_f32_16x16x32_bf16 v[92:95], a[44:47], a[164:167], v[92:95]
  ds_read_b64_tr_b16 a[12:13], v3 offset:49152
  v_mfma_f32_16x16x32_bf16 v[92:95], a[60:63], a[172:175], v[92:95]
  ds_read_b64_tr_b16 a[14:15], v3 offset:53248
  v_mfma_f32_16x16x32_bf16 v[88:91], a[60:63], a[168:171], v[88:91]
  buffer_load_dwordx4 a[236:239], v9, s[4:7], s63 offen offset:1024 sc1
  v_mfma_f32_16x16x32_bf16 v[88:91], a[44:47], a[160:163], v[88:91]
  s_waitcnt vmcnt(24) lgkmcnt(6)
  ds_read_b64_tr_b16 a[28:29], v3 offset:57344
  ds_read_b64_tr_b16 a[30:31], v3 offset:61440
  v_mfma_f32_16x16x32_bf16 v[32:35], a[0:3], a[176:179], v[32:35]
  ds_read_b64_tr_b16 a[32:33], v0 offset:50176
  s_add_u32 m0, s79, 16384
  v_mfma_f32_16x16x32_bf16 v[32:35], a[16:19], a[184:187], v[32:35]
  s_add_u32 s92, s92, 196608
  ds_read_b64_tr_b16 a[34:35], v0 offset:54272
  s_sub_u32 s93, s92, s88
  v_mfma_f32_16x16x32_bf16 v[36:39], a[16:19], a[188:191], v[36:39]
  buffer_load_dwordx4 v252, s[80:83], s93 offen lds
  v_mfma_f32_16x16x32_bf16 v[36:39], a[0:3], a[180:183], v[36:39]
  ds_read_b64_tr_b16 a[48:49], v0 offset:58368
  ds_read_b64_tr_b16 a[50:51], v0 offset:62464
  v_mfma_f32_16x16x32_bf16 v[44:47], a[4:7], a[180:183], v[44:47]
  ds_read_b64_tr_b16 a[36:37], v1 offset:50176
  v_mfma_f32_16x16x32_bf16 v[44:47], a[20:23], a[188:191], v[44:47]
  ds_read_b64_tr_b16 a[38:39], v1 offset:54272
  v_mfma_f32_16x16x32_bf16 v[40:43], a[20:23], a[184:187], v[40:43]
  buffer_load_dwordx4 v252, s[84:87], s93 offen offset:1024 lds
  v_mfma_f32_16x16x32_bf16 v[40:43], a[4:7], a[176:179], v[40:43]
  s_waitcnt lgkmcnt(6)
  ds_read_b64_tr_b16 a[52:53], v1 offset:58368
  ds_read_b64_tr_b16 a[54:55], v1 offset:62464
  v_mfma_f32_16x16x32_bf16 v[48:51], a[8:11], a[176:179], v[48:51]
  ds_read_b64_tr_b16 a[40:41], v2 offset:50176
  v_mfma_f32_16x16x32_bf16 v[48:51], a[24:27], a[184:187], v[48:51]
  ds_read_b64_tr_b16 a[42:43], v2 offset:54272
  v_mfma_f32_16x16x32_bf16 v[52:55], a[24:27], a[188:191], v[52:55]
  buffer_load_dwordx4 a[240:243], v8, s[4:7], s63 offen offset:2048 sc1
  v_mfma_f32_16x16x32_bf16 v[52:55], a[8:11], a[180:183], v[52:55]
  ds_read_b64_tr_b16 a[56:57], v2 offset:58368
  ds_read_b64_tr_b16 a[58:59], v2 offset:62464
  v_mfma_f32_16x16x32_bf16 v[60:63], a[12:15], a[180:183], v[60:63]
  ds_read_b64_tr_b16 a[44:45], v3 offset:50176
  v_mfma_f32_16x16x32_bf16 v[60:63], a[28:31], a[188:191], v[60:63]
  ds_read_b64_tr_b16 a[46:47], v3 offset:54272
  v_mfma_f32_16x16x32_bf16 v[56:59], a[28:31], a[184:187], v[56:59]
  buffer_load_dwordx4 a[244:247], v9, s[4:7], s63 offen offset:2048 sc1
  v_mfma_f32_16x16x32_bf16 v[56:59], a[12:15], a[176:179], v[56:59]
  s_waitcnt lgkmcnt(6)
  ds_read_b64_tr_b16 a[60:61], v3 offset:58368
  ds_read_b64_tr_b16 a[62:63], v3 offset:62464
  v_mfma_f32_16x16x32_bf16 v[64:67], a[32:35], a[176:179], v[64:67]
  ds_read_b64_tr_b16 a[0:1], v4 offset:0
  s_add_u32 m0, s79, 24576
  v_mfma_f32_16x16x32_bf16 v[64:67], a[48:51], a[184:187], v[64:67]
  s_add_u32 s92, s92, 262144
  ds_read_b64_tr_b16 a[2:3], v4 offset:4096
  s_sub_u32 s93, s92, s88
  v_mfma_f32_16x16x32_bf16 v[68:71], a[48:51], a[188:191], v[68:71]
  buffer_load_dwordx4 v252, s[80:83], s93 offen lds
  v_mfma_f32_16x16x32_bf16 v[68:71], a[32:35], a[180:183], v[68:71]
  ds_read_b64_tr_b16 a[16:17], v4 offset:8192
  ds_read_b64_tr_b16 a[18:19], v4 offset:12288
  v_mfma_f32_16x16x32_bf16 v[76:79], a[36:39], a[180:183], v[76:79]
  ds_read_b64_tr_b16 a[4:5], v5 offset:0
  v_mfma_f32_16x16x32_bf16 v[76:79], a[52:55], a[188:191], v[76:79]
  ds_read_b64_tr_b16 a[6:7], v5 offset:4096
  v_mfma_f32_16x16x32_bf16 v[72:75], a[52:55], a[184:187], v[72:75]
  buffer_load_dwordx4 v252, s[84:87], s93 offen offset:1024 lds
  v_mfma_f32_16x16x32_bf16 v[72:75], a[36:39], a[176:179], v[72:75]
  s_waitcnt lgkmcnt(6)
  ds_read_b64_tr_b16 a[20:21], v5 offset:8192
  ds_read_b64_tr_b16 a[22:23], v5 offset:12288
  v_mfma_f32_16x16x32_bf16 v[80:83], a[40:43], a[176:179], v[80:83]
  ds_read_b64_tr_b16 a[8:9], v6 offset:0
  v_mfma_f32_16x16x32_bf16 v[80:83], a[56:59], a[184:187], v[80:83]
  ds_read_b64_tr_b16 a[10:11], v6 offset:4096
  v_mfma_f32_16x16x32_bf16 v[84:87], a[56:59], a[188:191], v[84:87]
  buffer_load_dwordx4 a[248:251], v8, s[4:7], s63 offen offset:3072 sc1
  v_mfma_f32_16x16x32_bf16 v[84:87], a[40:43], a[180:183], v[84:87]
  ds_read_b64_tr_b16 a[24:25], v6 offset:8192
  ds_read_b64_tr_b16 a[26:27], v6 offset:12288
  v_mfma_f32_16x16x32_bf16 v[92:95], a[44:47], a[180:183], v[92:95]
  ds_read_b64_tr_b16 a[12:13], v7 offset:0
  v_mfma_f32_16x16x32_bf16 v[92:95], a[60:63], a[188:191], v[92:95]
  ds_read_b64_tr_b16 a[14:15], v7 offset:4096
  v_mfma_f32_16x16x32_bf16 v[88:91], a[60:63], a[184:187], v[88:91]
  buffer_load_dwordx4 a[252:255], v9, s[4:7], s63 offen offset:3072 sc1
  v_mfma_f32_16x16x32_bf16 v[88:91], a[44:47], a[176:179], v[88:91]
  s_waitcnt vmcnt(24) lgkmcnt(6)
  ds_read_b64_tr_b16 a[28:29], v7 offset:8192
  ds_read_b64_tr_b16 a[30:31], v7 offset:12288
  v_mfma_f32_16x16x32_bf16 v[32:35], a[0:3], a[192:195], v[32:35]
  s_waitcnt vmcnt(26)
  s_barrier
  ds_read_b64_tr_b16 a[32:33], v4 offset:1024
  v_mfma_f32_16x16x32_bf16 v[32:35], a[16:19], a[200:203], v[32:35]
  s_add_u32 m0, s79, 32768
  ds_read_b64_tr_b16 a[34:35], v4 offset:5120
  s_add_u32 s92, s92, 196608
  v_mfma_f32_16x16x32_bf16 v[36:39], a[16:19], a[204:207], v[36:39]
  s_sub_u32 s93, s92, s88
  buffer_load_dwordx4 v252, s[80:83], s93 offen lds
  v_mfma_f32_16x16x32_bf16 v[36:39], a[0:3], a[196:199], v[36:39]
  ds_read_b64_tr_b16 a[48:49], v4 offset:9216
  ds_read_b64_tr_b16 a[50:51], v4 offset:13312
  v_mfma_f32_16x16x32_bf16 v[44:47], a[4:7], a[196:199], v[44:47]
  ds_read_b64_tr_b16 a[36:37], v5 offset:1024
  v_mfma_f32_16x16x32_bf16 v[44:47], a[20:23], a[204:207], v[44:47]
  ds_read_b64_tr_b16 a[38:39], v5 offset:5120
  v_mfma_f32_16x16x32_bf16 v[40:43], a[20:23], a[200:203], v[40:43]
  buffer_load_dwordx4 v252, s[84:87], s93 offen offset:1024 lds
  v_mfma_f32_16x16x32_bf16 v[40:43], a[4:7], a[192:195], v[40:43]
  s_waitcnt lgkmcnt(6)
  ds_read_b64_tr_b16 a[52:53], v5 offset:9216
  ds_read_b64_tr_b16 a[54:55], v5 offset:13312
  v_mfma_f32_16x16x32_bf16 v[48:51], a[8:11], a[192:195], v[48:51]
  ds_read_b64_tr_b16 a[40:41], v6 offset:1024
  v_mfma_f32_16x16x32_bf16 v[48:51], a[24:27], a[200:203], v[48:51]
  s_add_u32 s48, s48, 4096
  ds_read_b64_tr_b16 a[42:43], v6 offset:5120
  s_min_u32 s63, s88, 8192
  v_mfma_f32_16x16x32_bf16 v[52:55], a[24:27], a[204:207], v[52:55]
  s_sub_u32 s63, s48, s63
  buffer_load_dwordx4 a[128:131], v8, s[4:7], s63 offen offset:0 sc1
  v_mfma_f32_16x16x32_bf16 v[52:55], a[8:11], a[196:199], v[52:55]
  ds_read_b64_tr_b16 a[56:57], v6 offset:9216
  ds_read_b64_tr_b16 a[58:59], v6 offset:13312
  v_mfma_f32_16x16x32_bf16 v[60:63], a[12:15], a[196:199], v[60:63]
  ds_read_b64_tr_b16 a[44:45], v7 offset:1024
  v_mfma_f32_16x16x32_bf16 v[60:63], a[28:31], a[204:207], v[60:63]
  ds_read_b64_tr_b16 a[46:47], v7 offset:5120
  v_mfma_f32_16x16x32_bf16 v[56:59], a[28:31], a[200:203], v[56:59]
  buffer_load_dwordx4 a[132:135], v9, s[4:7], s63 offen offset:0 sc1
  v_mfma_f32_16x16x32_bf16 v[56:59], a[12:15], a[192:195], v[56:59]
  s_waitcnt lgkmcnt(6)
  ds_read_b64_tr_b16 a[60:61], v7 offset:9216
  ds_read_b64_tr_b16 a[62:63], v7 offset:13312
  v_mfma_f32_16x16x32_bf16 v[64:67], a[32:35], a[192:195], v[64:67]
  ds_read_b64_tr_b16 a[0:1], v4 offset:16384
  s_add_u32 m0, s79, 40960
  v_mfma_f32_16x16x32_bf16 v[64:67], a[48:51], a[200:203], v[64:67]
  s_add_u32 s92, s92, 262144
  ds_read_b64_tr_b16 a[2:3], v4 offset:20480
  s_sub_u32 s93, s92, s88
  v_mfma_f32_16x16x32_bf16 v[68:71], a[48:51], a[204:207], v[68:71]
  buffer_load_dwordx4 v252, s[80:83], s93 offen lds
  v_mfma_f32_16x16x32_bf16 v[68:71], a[32:35], a[196:199], v[68:71]
  ds_read_b64_tr_b16 a[16:17], v4 offset:24576
  ds_read_b64_tr_b16 a[18:19], v4 offset:28672
  v_mfma_f32_16x16x32_bf16 v[76:79], a[36:39], a[196:199], v[76:79]
  ds_read_b64_tr_b16 a[4:5], v5 offset:16384
  v_mfma_f32_16x16x32_bf16 v[76:79], a[52:55], a[204:207], v[76:79]
  ds_read_b64_tr_b16 a[6:7], v5 offset:20480
  v_mfma_f32_16x16x32_bf16 v[72:75], a[52:55], a[200:203], v[72:75]
  buffer_load_dwordx4 v252, s[84:87], s93 offen offset:1024 lds
  v_mfma_f32_16x16x32_bf16 v[72:75], a[36:39], a[192:195], v[72:75]
  s_waitcnt lgkmcnt(6)
  ds_read_b64_tr_b16 a[20:21], v5 offset:24576
  ds_read_b64_tr_b16 a[22:23], v5 offset:28672
  v_mfma_f32_16x16x32_bf16 v[80:83], a[40:43], a[192:195], v[80:83]
  ds_read_b64_tr_b16 a[8:9], v6 offset:16384
  v_mfma_f32_16x16x32_bf16 v[80:83], a[56:59], a[200:203], v[80:83]
  ds_read_b64_tr_b16 a[10:11], v6 offset:20480
  v_mfma_f32_16x16x32_bf16 v[84:87], a[56:59], a[204:207], v[84:87]
  buffer_load_dwordx4 a[136:139], v8, s[4:7], s63 offen offset:1024 sc1
  v_mfma_f32_16x16x32_bf16 v[84:87], a[40:43], a[196:199], v[84:87]
  ds_read_b64_tr_b16 a[24:25], v6 offset:24576
  ds_read_b64_tr_b16 a[26:27], v6 offset:28672
  v_mfma_f32_16x16x32_bf16 v[92:95], a[44:47], a[196:199], v[92:95]
  ds_read_b64_tr_b16 a[12:13], v7 offset:16384
  v_mfma_f32_16x16x32_bf16 v[92:95], a[60:63], a[204:207], v[92:95]
  ds_read_b64_tr_b16 a[14:15], v7 offset:20480
  v_mfma_f32_16x16x32_bf16 v[88:91], a[60:63], a[200:203], v[88:91]
  buffer_load_dwordx4 a[140:143], v9, s[4:7], s63 offen offset:1024 sc1
  v_mfma_f32_16x16x32_bf16 v[88:91], a[44:47], a[192:195], v[88:91]
  s_waitcnt vmcnt(24) lgkmcnt(6)
  ds_read_b64_tr_b16 a[28:29], v7 offset:24576
  ds_read_b64_tr_b16 a[30:31], v7 offset:28672
  v_mfma_f32_16x16x32_bf16 v[32:35], a[0:3], a[208:211], v[32:35]
  ds_read_b64_tr_b16 a[32:33], v4 offset:32768
  s_add_u32 m0, s79, 49152
  v_mfma_f32_16x16x32_bf16 v[32:35], a[16:19], a[216:219], v[32:35]
  s_add_u32 s92, s92, 196608
  ds_read_b64_tr_b16 a[34:35], v4 offset:36864
  s_sub_u32 s93, s92, s88
  v_mfma_f32_16x16x32_bf16 v[36:39], a[16:19], a[220:223], v[36:39]
  ds_read_b64_tr_b16 a[48:49], v4 offset:40960
  buffer_load_dwordx4 v252, s[80:83], s93 offen lds
  v_mfma_f32_16x16x32_bf16 v[36:39], a[0:3], a[212:215], v[36:39]
  ds_read_b64_tr_b16 a[50:51], v4 offset:45056
  v_mfma_f32_16x16x32_bf16 v[44:47], a[4:7], a[212:215], v[44:47]
  ds_read_b64_tr_b16 a[36:37], v5 offset:32768
  buffer_load_dwordx4 v252, s[84:87], s93 offen offset:1024 lds
  v_mfma_f32_16x16x32_bf16 v[44:47], a[20:23], a[220:223], v[44:47]
  ds_read_b64_tr_b16 a[38:39], v5 offset:36864
  v_mfma_f32_16x16x32_bf16 v[40:43], a[20:23], a[216:219], v[40:43]
  ds_read_b64_tr_b16 a[52:53], v5 offset:40960
  buffer_load_dwordx4 a[144:147], v8, s[4:7], s63 offen offset:2048 sc1
  v_mfma_f32_16x16x32_bf16 v[40:43], a[4:7], a[208:211], v[40:43]
  ds_read_b64_tr_b16 a[54:55], v5 offset:45056
  s_waitcnt lgkmcnt(8)
  v_mfma_f32_16x16x32_bf16 v[48:51], a[8:11], a[208:211], v[48:51]
  s_add_u32 m0, s79, 57344
  ds_read_b64_tr_b16 a[40:41], v6 offset:32768
  buffer_load_dwordx4 a[148:151], v9, s[4:7], s63 offen offset:2048 sc1
  v_mfma_f32_16x16x32_bf16 v[48:51], a[24:27], a[216:219], v[48:51]
  s_add_u32 s92, s92, 262144
  ds_read_b64_tr_b16 a[42:43], v6 offset:36864
  s_sub_u32 s93, s92, s88
  v_mfma_f32_16x16x32_bf16 v[52:55], a[24:27], a[220:223], v[52:55]
  ds_read_b64_tr_b16 a[56:57], v6 offset:40960
  buffer_load_dwordx4 v252, s[80:83], s93 offen lds
  v_mfma_f32_16x16x32_bf16 v[52:55], a[8:11], a[212:215], v[52:55]
  ds_read_b64_tr_b16 a[58:59], v6 offset:45056
  v_mfma_f32_16x16x32_bf16 v[60:63], a[12:15], a[212:215], v[60:63]
  ds_read_b64_tr_b16 a[44:45], v7 offset:32768
  buffer_load_dwordx4 v252, s[84:87], s93 offen offset:1024 lds
  v_mfma_f32_16x16x32_bf16 v[60:63], a[28:31], a[220:223], v[60:63]
  ds_read_b64_tr_b16 a[46:47], v7 offset:36864
  v_mfma_f32_16x16x32_bf16 v[56:59], a[28:31], a[216:219], v[56:59]
  ds_read_b64_tr_b16 a[60:61], v7 offset:40960
  buffer_load_dwordx4 a[152:155], v8, s[4:7], s63 offen offset:3072 sc1
  v_mfma_f32_16x16x32_bf16 v[56:59], a[12:15], a[208:211], v[56:59]
  s_waitcnt vmcnt(23) lgkmcnt(7)
  ds_read_b64_tr_b16 a[62:63], v7 offset:45056
  buffer_load_dwordx4 a[156:159], v9, s[4:7], s63 offen offset:3072 sc1
  v_mfma_f32_16x16x32_bf16 v[32:35], a[32:35], a[224:227], v[32:35]
  s_waitcnt vmcnt(26)
  s_barrier
  ds_read_b64_tr_b16 a[0:1], v4 offset:49152
  v_mfma_f32_16x16x32_bf16 v[32:35], a[48:51], a[232:235], v[32:35]
  s_add_u32 s48, s48, 4096
  ds_read_b64_tr_b16 a[2:3], v4 offset:53248
  s_min_u32 s63, s88, 8192
  v_mfma_f32_16x16x32_bf16 v[36:39], a[48:51], a[236:239], v[36:39]
  s_sub_u32 s63, s48, s63
  ds_read_b64_tr_b16 a[16:17], v4 offset:57344
  buffer_load_dwordx4 a[160:163], v8, s[4:7], s63 offen offset:0 sc1
  v_mfma_f32_16x16x32_bf16 v[36:39], a[32:35], a[228:231], v[36:39]
  ds_read_b64_tr_b16 a[18:19], v4 offset:61440
  v_mfma_f32_16x16x32_bf16 v[44:47], a[36:39], a[228:231], v[44:47]
  ds_read_b64_tr_b16 a[4:5], v5 offset:49152
  v_mfma_f32_16x16x32_bf16 v[44:47], a[52:55], a[236:239], v[44:47]
  ds_read_b64_tr_b16 a[6:7], v5 offset:53248
  v_mfma_f32_16x16x32_bf16 v[40:43], a[52:55], a[232:235], v[40:43]
  ds_read_b64_tr_b16 a[20:21], v5 offset:57344
  buffer_load_dwordx4 a[164:167], v9, s[4:7], s63 offen offset:0 sc1
  v_mfma_f32_16x16x32_bf16 v[40:43], a[36:39], a[224:227], v[40:43]
  ds_read_b64_tr_b16 a[22:23], v5 offset:61440
  s_waitcnt lgkmcnt(8)
  v_mfma_f32_16x16x32_bf16 v[48:51], a[40:43], a[224:227], v[48:51]
  ds_read_b64_tr_b16 a[8:9], v6 offset:49152
  v_mfma_f32_16x16x32_bf16 v[48:51], a[56:59], a[232:235], v[48:51]
  ds_read_b64_tr_b16 a[10:11], v6 offset:53248
  v_mfma_f32_16x16x32_bf16 v[52:55], a[56:59], a[236:239], v[52:55]
  ds_read_b64_tr_b16 a[24:25], v6 offset:57344
  buffer_load_dwordx4 a[168:171], v8, s[4:7], s63 offen offset:1024 sc1
  v_mfma_f32_16x16x32_bf16 v[52:55], a[40:43], a[228:231], v[52:55]
  ds_read_b64_tr_b16 a[26:27], v6 offset:61440
  v_mfma_f32_16x16x32_bf16 v[60:63], a[44:47], a[228:231], v[60:63]
  ds_read_b64_tr_b16 a[12:13], v7 offset:49152
  v_mfma_f32_16x16x32_bf16 v[60:63], a[60:63], a[236:239], v[60:63]
  ds_read_b64_tr_b16 a[14:15], v7 offset:53248
  v_mfma_f32_16x16x32_bf16 v[56:59], a[60:63], a[232:235], v[56:59]
  ds_read_b64_tr_b16 a[28:29], v7 offset:57344
  buffer_load_dwordx4 a[172:175], v9, s[4:7], s63 offen offset:1024 sc1
  v_mfma_f32_16x16x32_bf16 v[56:59], a[44:47], a[224:227], v[56:59]
  ds_read_b64_tr_b16 a[30:31], v7 offset:61440
  s_waitcnt vmcnt(20) lgkmcnt(8)
  v_mfma_f32_16x16x32_bf16 v[32:35], a[0:3], a[240:243], v[32:35]
  ds_read_b64_tr_b16 a[32:33], v0 offset:0
  v_mfma_f32_16x16x32_bf16 v[32:35], a[16:19], a[248:251], v[32:35]
  ds_read_b64_tr_b16 a[34:35], v0 offset:4096
  v_mfma_f32_16x16x32_bf16 v[36:39], a[16:19], a[252:255], v[36:39]
  ds_read_b64_tr_b16 a[48:49], v0 offset:8192
  buffer_load_dwordx4 a[176:179], v8, s[4:7], s63 offen offset:2048 sc1
  v_mfma_f32_16x16x32_bf16 v[36:39], a[0:3], a[244:247], v[36:39]
  ds_read_b64_tr_b16 a[50:51], v0 offset:12288
  v_mfma_f32_16x16x32_bf16 v[44:47], a[4:7], a[244:247], v[44:47]
  ds_read_b64_tr_b16 a[36:37], v1 offset:0
  v_mfma_f32_16x16x32_bf16 v[44:47], a[20:23], a[252:255], v[44:47]
  ds_read_b64_tr_b16 a[38:39], v1 offset:4096
  v_mfma_f32_16x16x32_bf16 v[40:43], a[20:23], a[248:251], v[40:43]
  ds_read_b64_tr_b16 a[52:53], v1 offset:8192
  buffer_load_dwordx4 a[180:183], v9, s[4:7], s63 offen offset:2048 sc1
  v_mfma_f32_16x16x32_bf16 v[40:43], a[4:7], a[240:243], v[40:43]
  ds_read_b64_tr_b16 a[54:55], v1 offset:12288
  s_waitcnt lgkmcnt(8)
  v_mfma_f32_16x16x32_bf16 v[48:51], a[8:11], a[240:243], v[48:51]
  ds_read_b64_tr_b16 a[40:41], v2 offset:0
  v_mfma_f32_16x16x32_bf16 v[48:51], a[24:27], a[248:251], v[48:51]
  ds_read_b64_tr_b16 a[42:43], v2 offset:4096
  v_mfma_f32_16x16x32_bf16 v[52:55], a[24:27], a[252:255], v[52:55]
  ds_read_b64_tr_b16 a[56:57], v2 offset:8192
  buffer_load_dwordx4 a[184:187], v8, s[4:7], s63 offen offset:3072 sc1
  v_mfma_f32_16x16x32_bf16 v[52:55], a[8:11], a[244:247], v[52:55]
  ds_read_b64_tr_b16 a[58:59], v2 offset:12288
  v_mfma_f32_16x16x32_bf16 v[60:63], a[12:15], a[244:247], v[60:63]
  ds_read_b64_tr_b16 a[44:45], v3 offset:0
  v_mfma_f32_16x16x32_bf16 v[60:63], a[28:31], a[252:255], v[60:63]
  ds_read_b64_tr_b16 a[46:47], v3 offset:4096
  v_mfma_f32_16x16x32_bf16 v[56:59], a[28:31], a[248:251], v[56:59]
  ds_read_b64_tr_b16 a[60:61], v3 offset:8192
  buffer_load_dwordx4 a[188:191], v9, s[4:7], s63 offen offset:3072 sc1
  v_mfma_f32_16x16x32_bf16 v[56:59], a[12:15], a[240:243], v[56:59]
  ds_read_b64_tr_b16 a[62:63], v3 offset:12288
  s_waitcnt vmcnt(16) lgkmcnt(8)
  v_mfma_f32_16x16x32_bf16 v[32:35], a[32:35], a[128:131], v[32:35]
  s_waitcnt vmcnt(18)
  s_barrier
  ds_read_b64_tr_b16 a[0:1], v0 offset:16384
  v_mfma_f32_16x16x32_bf16 v[32:35], a[48:51], a[136:139], v[32:35]
  ds_read_b64_tr_b16 a[2:3], v0 offset:20480
  v_mfma_f32_16x16x32_bf16 v[36:39], a[48:51], a[140:143], v[36:39]
  ds_read_b64_tr_b16 a[16:17], v0 offset:24576
  v_mfma_f32_16x16x32_bf16 v[36:39], a[32:35], a[132:135], v[36:39]
  ds_read_b64_tr_b16 a[18:19], v0 offset:28672
  v_mfma_f32_16x16x32_bf16 v[44:47], a[36:39], a[132:135], v[44:47]
  ds_read_b64_tr_b16 a[4:5], v1 offset:16384
  v_mfma_f32_16x16x32_bf16 v[44:47], a[52:55], a[140:143], v[44:47]
  ds_read_b64_tr_b16 a[6:7], v1 offset:20480
  v_mfma_f32_16x16x32_bf16 v[40:43], a[52:55], a[136:139], v[40:43]
  ds_read_b64_tr_b16 a[20:21], v1 offset:24576
  v_mfma_f32_16x16x32_bf16 v[40:43], a[36:39], a[128:131], v[40:43]
  ds_read_b64_tr_b16 a[22:23], v1 offset:28672
  s_waitcnt lgkmcnt(8)
  v_mfma_f32_16x16x32_bf16 v[48:51], a[40:43], a[128:131], v[48:51]
  ds_read_b64_tr_b16 a[8:9], v2 offset:16384
  v_mfma_f32_16x16x32_bf16 v[48:51], a[56:59], a[136:139], v[48:51]
  ds_read_b64_tr_b16 a[10:11], v2 offset:20480
  v_mfma_f32_16x16x32_bf16 v[52:55], a[56:59], a[140:143], v[52:55]
  ds_read_b64_tr_b16 a[24:25], v2 offset:24576
  v_mfma_f32_16x16x32_bf16 v[52:55], a[40:43], a[132:135], v[52:55]
  ds_read_b64_tr_b16 a[26:27], v2 offset:28672
  v_mfma_f32_16x16x32_bf16 v[60:63], a[44:47], a[132:135], v[60:63]
  ds_read_b64_tr_b16 a[12:13], v3 offset:16384
  v_mfma_f32_16x16x32_bf16 v[60:63], a[60:63], a[140:143], v[60:63]
  ds_read_b64_tr_b16 a[14:15], v3 offset:20480
  v_mfma_f32_16x16x32_bf16 v[56:59], a[60:63], a[136:139], v[56:59]
  ds_read_b64_tr_b16 a[28:29], v3 offset:24576
  v_mfma_f32_16x16x32_bf16 v[56:59], a[44:47], a[128:131], v[56:59]
  ds_read_b64_tr_b16 a[30:31], v3 offset:28672
  s_waitcnt vmcnt(8) lgkmcnt(8)
  v_mfma_f32_16x16x32_bf16 v[32:35], a[0:3], a[144:147], v[32:35]
  ds_read_b64_tr_b16 a[32:33], v0 offset:32768
  v_mfma_f32_16x16x32_bf16 v[32:35], a[16:19], a[152:155], v[32:35]
  ds_read_b64_tr_b16 a[34:35], v0 offset:36864
  v_mfma_f32_16x16x32_bf16 v[36:39], a[16:19], a[156:159], v[36:39]
  ds_read_b64_tr_b16 a[48:49], v0 offset:40960
  v_mfma_f32_16x16x32_bf16 v[36:39], a[0:3], a[148:151], v[36:39]
  ds_read_b64_tr_b16 a[50:51], v0 offset:45056
  v_mfma_f32_16x16x32_bf16 v[44:47], a[4:7], a[148:151], v[44:47]
  ds_read_b64_tr_b16 a[36:37], v1 offset:32768
  v_mfma_f32_16x16x32_bf16 v[44:47], a[20:23], a[156:159], v[44:47]
  ds_read_b64_tr_b16 a[38:39], v1 offset:36864
  v_mfma_f32_16x16x32_bf16 v[40:43], a[20:23], a[152:155], v[40:43]
  ds_read_b64_tr_b16 a[52:53], v1 offset:40960
  v_mfma_f32_16x16x32_bf16 v[40:43], a[4:7], a[144:147], v[40:43]
  ds_read_b64_tr_b16 a[54:55], v1 offset:45056
  s_waitcnt lgkmcnt(8)
  v_mfma_f32_16x16x32_bf16 v[48:51], a[8:11], a[144:147], v[48:51]
  ds_read_b64_tr_b16 a[40:41], v2 offset:32768
  v_mfma_f32_16x16x32_bf16 v[48:51], a[24:27], a[152:155], v[48:51]
  ds_read_b64_tr_b16 a[42:43], v2 offset:36864
  v_mfma_f32_16x16x32_bf16 v[52:55], a[24:27], a[156:159], v[52:55]
  ds_read_b64_tr_b16 a[56:57], v2 offset:40960
  v_mfma_f32_16x16x32_bf16 v[52:55], a[8:11], a[148:151], v[52:55]
  ds_read_b64_tr_b16 a[58:59], v2 offset:45056
  v_mfma_f32_16x16x32_bf16 v[60:63], a[12:15], a[148:151], v[60:63]
  ds_read_b64_tr_b16 a[44:45], v3 offset:32768
  v_mfma_f32_16x16x32_bf16 v[60:63], a[28:31], a[156:159], v[60:63]
  ds_read_b64_tr_b16 a[46:47], v3 offset:36864
  v_mfma_f32_16x16x32_bf16 v[56:59], a[28:31], a[152:155], v[56:59]
  ds_read_b64_tr_b16 a[60:61], v3 offset:40960
  v_mfma_f32_16x16x32_bf16 v[56:59], a[12:15], a[144:147], v[56:59]
  ds_read_b64_tr_b16 a[62:63], v3 offset:45056
  s_waitcnt vmcnt(4) lgkmcnt(8)
  v_mfma_f32_16x16x32_bf16 v[32:35], a[32:35], a[160:163], v[32:35]
  s_waitcnt vmcnt(10)
  s_barrier
  ds_read_b64_tr_b16 a[0:1], v0 offset:49152
  v_mfma_f32_16x16x32_bf16 v[32:35], a[48:51], a[168:171], v[32:35]
  ds_read_b64_tr_b16 a[2:3], v0 offset:53248
  v_mfma_f32_16x16x32_bf16 v[36:39], a[48:51], a[172:175], v[36:39]
  ds_read_b64_tr_b16 a[16:17], v0 offset:57344
  v_mfma_f32_16x16x32_bf16 v[36:39], a[32:35], a[164:167], v[36:39]
  ds_read_b64_tr_b16 a[18:19], v0 offset:61440
  v_mfma_f32_16x16x32_bf16 v[44:47], a[36:39], a[164:167], v[44:47]
  ds_read_b64_tr_b16 a[4:5], v1 offset:49152
  v_mfma_f32_16x16x32_bf16 v[44:47], a[52:55], a[172:175], v[44:47]
  ds_read_b64_tr_b16 a[6:7], v1 offset:53248
  v_mfma_f32_16x16x32_bf16 v[40:43], a[52:55], a[168:171], v[40:43]
  ds_read_b64_tr_b16 a[20:21], v1 offset:57344
  v_mfma_f32_16x16x32_bf16 v[40:43], a[36:39], a[160:163], v[40:43]
  ds_read_b64_tr_b16 a[22:23], v1 offset:61440
  s_waitcnt lgkmcnt(8)
  v_mfma_f32_16x16x32_bf16 v[48:51], a[40:43], a[160:163], v[48:51]
  ds_read_b64_tr_b16 a[8:9], v2 offset:49152
  v_mfma_f32_16x16x32_bf16 v[48:51], a[56:59], a[168:171], v[48:51]
  ds_read_b64_tr_b16 a[10:11], v2 offset:53248
  v_mfma_f32_16x16x32_bf16 v[52:55], a[56:59], a[172:175], v[52:55]
  ds_read_b64_tr_b16 a[24:25], v2 offset:57344
  v_mfma_f32_16x16x32_bf16 v[52:55], a[40:43], a[164:167], v[52:55]
  ds_read_b64_tr_b16 a[26:27], v2 offset:61440
  v_mfma_f32_16x16x32_bf16 v[60:63], a[44:47], a[164:167], v[60:63]
  ds_read_b64_tr_b16 a[12:13], v3 offset:49152
  v_mfma_f32_16x16x32_bf16 v[60:63], a[60:63], a[172:175], v[60:63]
  ds_read_b64_tr_b16 a[14:15], v3 offset:53248
  v_mfma_f32_16x16x32_bf16 v[56:59], a[60:63], a[168:171], v[56:59]
  ds_read_b64_tr_b16 a[28:29], v3 offset:57344
  v_mfma_f32_16x16x32_bf16 v[56:59], a[44:47], a[160:163], v[56:59]
  ds_read_b64_tr_b16 a[30:31], v3 offset:61440
  s_waitcnt vmcnt(0) lgkmcnt(8)
  v_mfma_f32_16x16x32_bf16 v[32:35], a[0:3], a[176:179], v[32:35]
  ds_read_b64_tr_b16 a[32:33], v4 offset:17408
  v_mfma_f32_16x16x32_bf16 v[32:35], a[16:19], a[184:187], v[32:35]
  ds_read_b64_tr_b16 a[34:35], v4 offset:21504
  v_mfma_f32_16x16x32_bf16 v[36:39], a[16:19], a[188:191], v[36:39]
  ds_read_b64_tr_b16 a[48:49], v4 offset:25600
  v_mfma_f32_16x16x32_bf16 v[36:39], a[0:3], a[180:183], v[36:39]
  ds_read_b64_tr_b16 a[50:51], v4 offset:29696
  v_mfma_f32_16x16x32_bf16 v[44:47], a[4:7], a[180:183], v[44:47]
  ds_read_b64_tr_b16 a[36:37], v5 offset:17408
  v_mfma_f32_16x16x32_bf16 v[44:47], a[20:23], a[188:191], v[44:47]
  ds_read_b64_tr_b16 a[38:39], v5 offset:21504
  v_mfma_f32_16x16x32_bf16 v[40:43], a[20:23], a[184:187], v[40:43]
  ds_read_b64_tr_b16 a[52:53], v5 offset:25600
  v_mfma_f32_16x16x32_bf16 v[40:43], a[4:7], a[176:179], v[40:43]
  ds_read_b64_tr_b16 a[54:55], v5 offset:29696
  s_waitcnt lgkmcnt(8)
  v_mfma_f32_16x16x32_bf16 v[48:51], a[8:11], a[176:179], v[48:51]
  ds_read_b64_tr_b16 a[40:41], v6 offset:17408
  v_mfma_f32_16x16x32_bf16 v[48:51], a[24:27], a[184:187], v[48:51]
  ds_read_b64_tr_b16 a[42:43], v6 offset:21504
  v_mfma_f32_16x16x32_bf16 v[52:55], a[24:27], a[188:191], v[52:55]
  ds_read_b64_tr_b16 a[56:57], v6 offset:25600
  v_mfma_f32_16x16x32_bf16 v[52:55], a[8:11], a[180:183], v[52:55]
  ds_read_b64_tr_b16 a[58:59], v6 offset:29696
  v_mfma_f32_16x16x32_bf16 v[60:63], a[12:15], a[180:183], v[60:63]
  ds_read_b64_tr_b16 a[44:45], v7 offset:17408
  v_mfma_f32_16x16x32_bf16 v[60:63], a[28:31], a[188:191], v[60:63]
  ds_read_b64_tr_b16 a[46:47], v7 offset:21504
  v_mfma_f32_16x16x32_bf16 v[56:59], a[28:31], a[184:187], v[56:59]
  ds_read_b64_tr_b16 a[60:61], v7 offset:25600
  v_mfma_f32_16x16x32_bf16 v[56:59], a[12:15], a[176:179], v[56:59]
  ds_read_b64_tr_b16 a[62:63], v7 offset:29696
  s_waitcnt lgkmcnt(8)
  v_mfma_f32_16x16x32_bf16 v[64:67], a[32:35], a[208:211], v[64:67]
  s_lshl_b32 s45, s2, 2
  ds_read_b64_tr_b16 a[0:1], v4 offset:33792
  s_add_u32 s45, s45, s40
  v_mfma_f32_16x16x32_bf16 v[64:67], a[48:51], a[216:219], v[64:67]
  s_lshl_b32 s45, s45, 12
  ds_read_b64_tr_b16 a[2:3], v4 offset:37888
  s_xor_b32 s44, s45, 32768
  v_mfma_f32_16x16x32_bf16 v[68:71], a[48:51], a[220:223], v[68:71]
  s_add_u32 s43, s42, 28311552
  ds_read_b64_tr_b16 a[16:17], v4 offset:41984
  s_add_u32 s44, s44, s43
  v_mfma_f32_16x16x32_bf16 v[68:71], a[32:35], a[212:215], v[68:71]
  s_add_u32 s45, s45, s43
  ds_read_b64_tr_b16 a[18:19], v4 offset:46080
  v_cvt_pk_bf16_f32 v16, v32, v33
  v_mfma_f32_16x16x32_bf16 v[76:79], a[36:39], a[212:215], v[76:79]
  ds_read_b64_tr_b16 a[4:5], v5 offset:33792
  v_cvt_pk_bf16_f32 v17, v34, v35
  v_mfma_f32_16x16x32_bf16 v[76:79], a[52:55], a[220:223], v[76:79]
  ds_read_b64_tr_b16 a[6:7], v5 offset:37888
  v_cvt_pk_bf16_f32 v18, v40, v41
  v_cvt_pk_bf16_f32 v19, v42, v43
  v_mfma_f32_16x16x32_bf16 v[72:75], a[52:55], a[216:219], v[72:75]
  buffer_store_dwordx4 v[16:19], v8, s[4:7], s44 offen offset:0 sc1
  ds_read_b64_tr_b16 a[20:21], v5 offset:41984
  v_cvt_pk_bf16_f32 v24, v36, v37
  v_cvt_pk_bf16_f32 v25, v38, v39
  v_mfma_f32_16x16x32_bf16 v[72:75], a[36:39], a[208:211], v[72:75]
  s_waitcnt lgkmcnt(7)
  ds_read_b64_tr_b16 a[22:23], v5 offset:46080
  v_cvt_pk_bf16_f32 v26, v44, v45
  v_cvt_pk_bf16_f32 v27, v46, v47
  v_mfma_f32_16x16x32_bf16 v[80:83], a[40:43], a[208:211], v[80:83]
  ds_read_b64_tr_b16 a[8:9], v6 offset:33792
  buffer_store_dwordx4 v[24:27], v8, s[4:7], s44 offen offset:2048 sc1
  v_cvt_pk_bf16_f32 v20, v48, v49
  v_mfma_f32_16x16x32_bf16 v[80:83], a[56:59], a[216:219], v[80:83]
  ds_read_b64_tr_b16 a[10:11], v6 offset:37888
  v_cvt_pk_bf16_f32 v21, v50, v51
  v_mfma_f32_16x16x32_bf16 v[84:87], a[56:59], a[220:223], v[84:87]
  ds_read_b64_tr_b16 a[24:25], v6 offset:41984
  v_cvt_pk_bf16_f32 v22, v56, v57
  v_cvt_pk_bf16_f32 v23, v58, v59
  v_mfma_f32_16x16x32_bf16 v[84:87], a[40:43], a[212:215], v[84:87]
  buffer_store_dwordx4 v[20:23], v8, s[4:7], s44 offen offset:1024 sc1
  ds_read_b64_tr_b16 a[26:27], v6 offset:46080
  v_cvt_pk_bf16_f32 v28, v52, v53
  v_cvt_pk_bf16_f32 v29, v54, v55
  v_mfma_f32_16x16x32_bf16 v[92:95], a[44:47], a[212:215], v[92:95]
  ds_read_b64_tr_b16 a[12:13], v7 offset:33792
  v_cvt_pk_bf16_f32 v30, v60, v61
  v_cvt_pk_bf16_f32 v31, v62, v63
  v_mfma_f32_16x16x32_bf16 v[92:95], a[60:63], a[220:223], v[92:95]
  ds_read_b64_tr_b16 a[14:15], v7 offset:37888
  buffer_store_dwordx4 v[28:31], v8, s[4:7], s44 offen offset:3072 sc1
  v_mfma_f32_16x16x32_bf16 v[88:91], a[60:63], a[216:219], v[88:91]
  ds_read_b64_tr_b16 a[28:29], v7 offset:41984
  v_mfma_f32_16x16x32_bf16 v[88:91], a[44:47], a[208:211], v[88:91]
  ds_read_b64_tr_b16 a[30:31], v7 offset:46080
  s_waitcnt lgkmcnt(8)
  v_mfma_f32_16x16x32_bf16 v[64:67], a[0:3], a[224:227], v[64:67]
  ds_read_b64_tr_b16 a[32:33], v4 offset:50176
  v_and_b32 v148, 15, v253
  v_mfma_f32_16x16x32_bf16 v[64:67], a[16:19], a[232:235], v[64:67]
  ds_read_b64_tr_b16 a[34:35], v4 offset:54272
  v_lshrrev_b32 v149, 4, v253
  v_mfma_f32_16x16x32_bf16 v[68:71], a[16:19], a[236:239], v[68:71]
  ds_read_b64_tr_b16 a[48:49], v4 offset:58368
  v_lshrrev_b32 v128, 2, v148
  v_mfma_f32_16x16x32_bf16 v[68:71], a[0:3], a[228:231], v[68:71]
  ds_read_b64_tr_b16 a[50:51], v4 offset:62464
  v_cmp_eq_u32 vcc, v128, v149
  v_mfma_f32_16x16x32_bf16 v[76:79], a[4:7], a[228:231], v[76:79]
  ds_read_b64_tr_b16 a[36:37], v5 offset:50176
  v_and_b32 v128, 3, v148
  v_mfma_f32_16x16x32_bf16 v[76:79], a[20:23], a[236:239], v[76:79]
  ds_read_b64_tr_b16 a[38:39], v5 offset:54272
  v_lshlrev_b32 v148, 3, v148
  v_mfma_f32_16x16x32_bf16 v[72:75], a[20:23], a[232:235], v[72:75]
  ds_read_b64_tr_b16 a[52:53], v5 offset:58368
  v_mov_b32 v149, 0x7ffffff0
  v_mfma_f32_16x16x32_bf16 v[72:75], a[4:7], a[224:227], v[72:75]
  s_waitcnt lgkmcnt(7)
  ds_read_b64_tr_b16 a[54:55], v5 offset:62464
  v_cndmask_b32 v148, v149, v148, vcc
  v_mfma_f32_16x16x32_bf16 v[80:83], a[8:11], a[224:227], v[80:83]
  ds_read_b64_tr_b16 a[40:41], v6 offset:50176
  v_cmp_eq_u32 s[66:67], 1, v128
  v_mfma_f32_16x16x32_bf16 v[80:83], a[24:27], a[232:235], v[80:83]
  ds_read_b64_tr_b16 a[42:43], v6 offset:54272
  v_cmp_eq_u32 s[68:69], 2, v128
  v_mfma_f32_16x16x32_bf16 v[84:87], a[24:27], a[236:239], v[84:87]
  ds_read_b64_tr_b16 a[56:57], v6 offset:58368
  v_cmp_eq_u32 s[70:71], 3, v128
  v_mfma_f32_16x16x32_bf16 v[84:87], a[8:11], a[228:231], v[84:87]
  ds_read_b64_tr_b16 a[58:59], v6 offset:62464
  v_mov_b32 v128, 0x3f803f80
  v_mfma_f32_16x16x32_bf16 v[92:95], a[12:15], a[228:231], v[92:95]
  ds_read_b64_tr_b16 a[44:45], v7 offset:50176
  v_mov_b32 v129, 0x3f803f80
  v_mfma_f32_16x16x32_bf16 v[92:95], a[28:31], a[236:239], v[92:95]
  ds_read_b64_tr_b16 a[46:47], v7 offset:54272
  v_mov_b32 v130, 0x3f803f80
  v_mfma_f32_16x16x32_bf16 v[88:91], a[28:31], a[232:235], v[88:91]
  ds_read_b64_tr_b16 a[60:61], v7 offset:58368
  v_mov_b32 v131, 0x3f803f80
  v_mfma_f32_16x16x32_bf16 v[88:91], a[12:15], a[224:227], v[88:91]
  ds_read_b64_tr_b16 a[62:63], v7 offset:62464
  s_waitcnt lgkmcnt(8)
  v_mfma_f32_16x16x32_bf16 v[64:67], a[32:35], a[240:243], v[64:67]
  ds_read_b64_tr_b16 a[0:1], v0 offset:1024
  v_and_b32 v152, 15, v253
  v_lshrrev_b32 v153, 4, v253
  v_mfma_f32_16x16x32_bf16 v[64:67], a[48:51], a[248:251], v[64:67]
  ds_read_b64_tr_b16 a[2:3], v0 offset:5120
  v_lshrrev_b32 v155, 1, v153
  v_and_b32 v153, 1, v153
  v_mfma_f32_16x16x32_bf16 v[68:71], a[48:51], a[252:255], v[68:71]
  ds_read_b64_tr_b16 a[16:17], v0 offset:9216
  v_lshl_add_u32 v153, v153, 1, v155
  v_and_b32 v155, 7, v253
  v_mfma_f32_16x16x32_bf16 v[68:71], a[32:35], a[244:247], v[68:71]
  ds_read_b64_tr_b16 a[18:19], v0 offset:13312
  v_xor_b32 v153, v153, v155
  v_lshlrev_b32 v153, 4, v153
  v_mfma_f32_16x16x32_bf16 v[76:79], a[36:39], a[244:247], v[76:79]
  s_lshl_b32 s43, s40, 12
  ds_read_b64_tr_b16 a[4:5], v1 offset:1024
  v_lshl_add_u32 v152, v152, 7, v153
  v_mfma_f32_16x16x32_bf16 v[76:79], a[52:55], a[252:255], v[76:79]
  ds_read_b64_tr_b16 a[6:7], v1 offset:5120
  v_add_u32 v152, s43, v152
  v_xor_b32 v153, 64, v152
  v_mfma_f32_16x16x32_bf16 v[72:75], a[52:55], a[248:251], v[72:75]
  ds_read_b64_tr_b16 a[20:21], v1 offset:9216
  v_lshrrev_b32 v156, 3, v253
  v_xor_b32 v154, v156, v155
  v_mfma_f32_16x16x32_bf16 v[72:75], a[36:39], a[240:243], v[72:75]
  s_waitcnt lgkmcnt(7)
  ds_read_b64_tr_b16 a[22:23], v1 offset:13312
  v_lshlrev_b32 v154, 4, v154
  v_lshl_add_u32 v154, v156, 7, v154
  v_mfma_f32_16x16x32_bf16 v[80:83], a[40:43], a[240:243], v[80:83]
  ds_read_b64_tr_b16 a[8:9], v2 offset:1024
  v_add_u32 v154, s43, v154
  v_mfma_f32_16x16x32_bf16 v[80:83], a[56:59], a[248:251], v[80:83]
  ds_read_b64_tr_b16 a[10:11], v2 offset:5120
  v_lshlrev_b32 v155, 4, v155
  v_mfma_f32_16x16x32_bf16 v[84:87], a[56:59], a[252:255], v[84:87]
  ds_read_b64_tr_b16 a[24:25], v2 offset:9216
  v_lshl_add_u32 v155, v156, 12, v155
  v_mfma_f32_16x16x32_bf16 v[84:87], a[40:43], a[244:247], v[84:87]
  ds_read_b64_tr_b16 a[26:27], v2 offset:13312
  v_mfma_f32_16x16x32_bf16 v[92:95], a[44:47], a[244:247], v[92:95]
  ds_read_b64_tr_b16 a[12:13], v3 offset:1024
  v_mfma_f32_16x16x32_bf16 v[92:95], a[60:63], a[252:255], v[92:95]
  ds_read_b64_tr_b16 a[14:15], v3 offset:5120
  v_mfma_f32_16x16x32_bf16 v[88:91], a[60:63], a[248:251], v[88:91]
  ds_read_b64_tr_b16 a[28:29], v3 offset:9216
  v_mfma_f32_16x16x32_bf16 v[88:91], a[44:47], a[240:243], v[88:91]
  ds_read_b64_tr_b16 a[30:31], v3 offset:13312
  s_waitcnt lgkmcnt(8)
  v_mfma_f32_16x16x32_bf16 v[64:67], a[0:3], a[128:131], v[64:67]
  s_add_u32 s46, s76, 41943040
  ds_read_b64_tr_b16 a[32:33], v0 offset:17408
  s_add_u32 s47, s46, 32768
  v_mfma_f32_16x16x32_bf16 v[64:67], a[16:19], a[136:139], v[64:67]
  s_lshl_b32 s48, s49, 11
  ds_read_b64_tr_b16 a[34:35], v0 offset:21504
  s_lshl_b32 s43, s53, 7
  v_mfma_f32_16x16x32_bf16 v[68:71], a[16:19], a[140:143], v[68:71]
  s_add_u32 s48, s48, s43
  ds_read_b64_tr_b16 a[48:49], v0 offset:25600
  s_add_u32 s48, s48, 69206016
  v_mfma_f32_16x16x32_bf16 v[68:71], a[0:3], a[132:135], v[68:71]
  s_and_b32 s57, s49, 63
  ds_read_b64_tr_b16 a[50:51], v0 offset:29696
  s_lshl_b32 s57, s57, 16
  v_mfma_f32_16x16x32_bf16 v[76:79], a[4:7], a[132:135], v[76:79]
  s_add_u32 s57, s57, s43
  ds_read_b64_tr_b16 a[36:37], v1 offset:17408
  s_lshr_b32 s43, s49, 6
  v_mfma_f32_16x16x32_bf16 v[76:79], a[20:23], a[140:143], v[76:79]
  s_lshl_b32 s43, s43, 11
  ds_read_b64_tr_b16 a[38:39], v1 offset:21504
  s_add_u32 s57, s57, s43
  v_mfma_f32_16x16x32_bf16 v[72:75], a[20:23], a[136:139], v[72:75]
  s_and_b32 s43, s53, 0
  ds_read_b64_tr_b16 a[52:53], v1 offset:25600
  s_mul_i32 s77, s52, 1
  v_mfma_f32_16x16x32_bf16 v[72:75], a[4:7], a[128:131], v[72:75]
  s_add_u32 s77, s77, s43
  ds_read_b64_tr_b16 a[54:55], v1 offset:29696
  s_lshl_b32 s77, s77, 7
  s_waitcnt lgkmcnt(8)
  v_mfma_f32_16x16x32_bf16 v[80:83], a[8:11], a[128:131], v[80:83]
  ds_read_b64_tr_b16 a[40:41], v2 offset:17408
  s_add_u32 s77, s77, 27815936
  v_mfma_f32_16x16x32_bf16 v[80:83], a[24:27], a[136:139], v[80:83]
  ds_read_b64_tr_b16 a[42:43], v2 offset:21504
  v_mfma_f32_16x16x32_bf16 v[84:87], a[24:27], a[140:143], v[84:87]
  ds_read_b64_tr_b16 a[56:57], v2 offset:25600
  v_mfma_f32_16x16x32_bf16 v[84:87], a[8:11], a[132:135], v[84:87]
  ds_read_b64_tr_b16 a[58:59], v2 offset:29696
  v_mfma_f32_16x16x32_bf16 v[92:95], a[12:15], a[132:135], v[92:95]
  ds_read_b64_tr_b16 a[44:45], v3 offset:17408
  v_mfma_f32_16x16x32_bf16 v[92:95], a[28:31], a[140:143], v[92:95]
  ds_read_b64_tr_b16 a[46:47], v3 offset:21504
  v_mfma_f32_16x16x32_bf16 v[88:91], a[28:31], a[136:139], v[88:91]
  ds_read_b64_tr_b16 a[60:61], v3 offset:25600
  v_mfma_f32_16x16x32_bf16 v[88:91], a[12:15], a[128:131], v[88:91]
  ds_read_b64_tr_b16 a[62:63], v3 offset:29696
  s_waitcnt lgkmcnt(8)
  v_mfma_f32_16x16x32_bf16 v[64:67], a[32:35], a[144:147], v[64:67]
  ds_read_b64_tr_b16 a[0:1], v0 offset:33792
  v_mfma_f32_16x16x32_bf16 v[64:67], a[48:51], a[152:155], v[64:67]
  ds_read_b64_tr_b16 a[2:3], v0 offset:37888
  v_mfma_f32_16x16x32_bf16 v[68:71], a[48:51], a[156:159], v[68:71]
  ds_read_b64_tr_b16 a[16:17], v0 offset:41984
  v_mfma_f32_16x16x32_bf16 v[68:71], a[32:35], a[148:151], v[68:71]
  ds_read_b64_tr_b16 a[18:19], v0 offset:46080
  v_mfma_f32_16x16x32_bf16 v[76:79], a[36:39], a[148:151], v[76:79]
  ds_read_b64_tr_b16 a[4:5], v1 offset:33792
  buffer_load_dwordx4 v[96:99], v8, s[4:7], s45 offen offset:0 sc1
  v_mfma_f32_16x16x32_bf16 v[76:79], a[52:55], a[156:159], v[76:79]
  buffer_load_dwordx4 v[100:103], v8, s[4:7], s45 offen offset:1024 sc1
  ds_read_b64_tr_b16 a[6:7], v1 offset:37888
  v_mfma_f32_16x16x32_bf16 v[72:75], a[52:55], a[152:155], v[72:75]
  ds_read_b64_tr_b16 a[20:21], v1 offset:41984
  buffer_load_dwordx4 v[104:107], v8, s[4:7], s45 offen offset:2048 sc1
  buffer_load_dwordx4 v[108:111], v8, s[4:7], s45 offen offset:3072 sc1
  v_mfma_f32_16x16x32_bf16 v[72:75], a[36:39], a[144:147], v[72:75]
  ds_read_b64_tr_b16 a[22:23], v1 offset:46080
  s_waitcnt lgkmcnt(8)
  v_mfma_f32_16x16x32_bf16 v[80:83], a[40:43], a[144:147], v[80:83]
  ds_read_b64_tr_b16 a[8:9], v2 offset:33792
  v_mfma_f32_16x16x32_bf16 v[80:83], a[56:59], a[152:155], v[80:83]
  ds_read_b64_tr_b16 a[10:11], v2 offset:37888
  v_mfma_f32_16x16x32_bf16 v[84:87], a[56:59], a[156:159], v[84:87]
  ds_read_b64_tr_b16 a[24:25], v2 offset:41984
  v_mfma_f32_16x16x32_bf16 v[84:87], a[40:43], a[148:151], v[84:87]
  ds_read_b64_tr_b16 a[26:27], v2 offset:46080
  v_mfma_f32_16x16x32_bf16 v[92:95], a[44:47], a[148:151], v[92:95]
  ds_read_b64_tr_b16 a[12:13], v3 offset:33792
  v_mfma_f32_16x16x32_bf16 v[92:95], a[60:63], a[156:159], v[92:95]
  ds_read_b64_tr_b16 a[14:15], v3 offset:37888
  v_mfma_f32_16x16x32_bf16 v[88:91], a[60:63], a[152:155], v[88:91]
  ds_read_b64_tr_b16 a[28:29], v3 offset:41984
  v_mfma_f32_16x16x32_bf16 v[88:91], a[44:47], a[144:147], v[88:91]
  ds_read_b64_tr_b16 a[30:31], v3 offset:46080
  s_waitcnt lgkmcnt(8)
  v_mfma_f32_16x16x32_bf16 v[64:67], a[0:3], a[160:163], v[64:67]
  ds_read_b64_tr_b16 a[32:33], v0 offset:50176
  v_mfma_f32_16x16x32_bf16 v[64:67], a[16:19], a[168:171], v[64:67]
  ds_read_b64_tr_b16 a[34:35], v0 offset:54272
  v_mfma_f32_16x16x32_bf16 v[68:71], a[16:19], a[172:175], v[68:71]
  ds_read_b64_tr_b16 a[48:49], v0 offset:58368
  v_mfma_f32_16x16x32_bf16 v[68:71], a[0:3], a[164:167], v[68:71]
  ds_read_b64_tr_b16 a[50:51], v0 offset:62464
  v_mfma_f32_16x16x32_bf16 v[76:79], a[4:7], a[164:167], v[76:79]
  ds_read_b64_tr_b16 a[36:37], v1 offset:50176
  v_mfma_f32_16x16x32_bf16 v[76:79], a[20:23], a[172:175], v[76:79]
  ds_read_b64_tr_b16 a[38:39], v1 offset:54272
  v_mfma_f32_16x16x32_bf16 v[72:75], a[20:23], a[168:171], v[72:75]
  ds_read_b64_tr_b16 a[52:53], v1 offset:58368
  v_mfma_f32_16x16x32_bf16 v[72:75], a[4:7], a[160:163], v[72:75]
  ds_read_b64_tr_b16 a[54:55], v1 offset:62464
  s_waitcnt lgkmcnt(8)
  v_mfma_f32_16x16x32_bf16 v[80:83], a[8:11], a[160:163], v[80:83]
  ds_read_b64_tr_b16 a[40:41], v2 offset:50176
  v_mfma_f32_16x16x32_bf16 v[80:83], a[24:27], a[168:171], v[80:83]
  ds_read_b64_tr_b16 a[42:43], v2 offset:54272
  v_mfma_f32_16x16x32_bf16 v[84:87], a[24:27], a[172:175], v[84:87]
  ds_read_b64_tr_b16 a[56:57], v2 offset:58368
  v_mfma_f32_16x16x32_bf16 v[84:87], a[8:11], a[164:167], v[84:87]
  ds_read_b64_tr_b16 a[58:59], v2 offset:62464
  v_mfma_f32_16x16x32_bf16 v[92:95], a[12:15], a[164:167], v[92:95]
  ds_read_b64_tr_b16 a[44:45], v3 offset:50176
  v_mfma_f32_16x16x32_bf16 v[92:95], a[28:31], a[172:175], v[92:95]
  ds_read_b64_tr_b16 a[46:47], v3 offset:54272
  v_mfma_f32_16x16x32_bf16 v[88:91], a[28:31], a[168:171], v[88:91]
  ds_read_b64_tr_b16 a[60:61], v3 offset:58368
  v_mfma_f32_16x16x32_bf16 v[88:91], a[12:15], a[160:163], v[88:91]
  s_waitcnt vmcnt(0)
  ds_read_b64_tr_b16 a[62:63], v3 offset:62464
  v_max3_u32 v112, v96, v97, v98
  v_max3_u32 v113, v99, v100, v101
  v_max3_u32 v112, v112, v102, v103
  v_max3_u32 v113, v113, v104, v105
  v_max3_u32 v112, v112, v106, v107
  v_max3_u32 v113, v113, v108, v109
  v_max3_u32 v112, v112, v110, v111
  v_max_u32 v112, v112, v113
  v_cmp_eq_u32 vcc, -1, v112
  s_cbranch_vccnz Lp4_mb_c
Lp4_mb_r:
  s_waitcnt lgkmcnt(8)
  v_mfma_f32_16x16x32_bf16 v[64:67], a[32:35], a[176:179], v[64:67]
  v_lshlrev_b32 v32, 16, v96
  v_and_b32 v33, 0xffff0000, v96
  v_mfma_f32_16x16x32_bf16 v[64:67], a[48:51], a[184:187], v[64:67]
  v_lshlrev_b32 v34, 16, v97
  v_and_b32 v35, 0xffff0000, v97
  v_mfma_f32_16x16x32_bf16 v[68:71], a[48:51], a[188:191], v[68:71]
  v_lshlrev_b32 v40, 16, v98
  v_and_b32 v41, 0xffff0000, v98
  v_mfma_f32_16x16x32_bf16 v[68:71], a[32:35], a[180:183], v[68:71]
  v_lshlrev_b32 v42, 16, v99
  v_and_b32 v43, 0xffff0000, v99
  v_mfma_f32_16x16x32_bf16 v[76:79], a[36:39], a[180:183], v[76:79]
  v_lshlrev_b32 v36, 16, v104
  v_and_b32 v37, 0xffff0000, v104
  v_mfma_f32_16x16x32_bf16 v[76:79], a[52:55], a[188:191], v[76:79]
  v_lshlrev_b32 v38, 16, v105
  v_and_b32 v39, 0xffff0000, v105
  v_mfma_f32_16x16x32_bf16 v[72:75], a[52:55], a[184:187], v[72:75]
  v_lshlrev_b32 v44, 16, v106
  v_and_b32 v45, 0xffff0000, v106
  v_mfma_f32_16x16x32_bf16 v[72:75], a[36:39], a[176:179], v[72:75]
  s_waitcnt lgkmcnt(0)
  v_lshlrev_b32 v46, 16, v107
  v_and_b32 v47, 0xffff0000, v107
  v_mfma_f32_16x16x32_bf16 v[80:83], a[40:43], a[176:179], v[80:83]
  v_lshlrev_b32 v48, 16, v100
  v_and_b32 v49, 0xffff0000, v100
  v_mfma_f32_16x16x32_bf16 v[80:83], a[56:59], a[184:187], v[80:83]
  s_barrier
  v_lshlrev_b32 v50, 16, v101
  v_mfma_f32_16x16x32_bf16 v[84:87], a[56:59], a[188:191], v[84:87]
  v_and_b32 v51, 0xffff0000, v101
  v_lshlrev_b32 v56, 16, v102
  v_mfma_f32_16x16x32_bf16 v[84:87], a[40:43], a[180:183], v[84:87]
  v_and_b32 v57, 0xffff0000, v102
  v_lshlrev_b32 v58, 16, v103
  v_mfma_f32_16x16x32_bf16 v[92:95], a[44:47], a[180:183], v[92:95]
  v_and_b32 v59, 0xffff0000, v103
  v_lshlrev_b32 v52, 16, v108
  v_mfma_f32_16x16x32_bf16 v[92:95], a[60:63], a[188:191], v[92:95]
  v_and_b32 v53, 0xffff0000, v108
  v_lshlrev_b32 v54, 16, v109
  v_mfma_f32_16x16x32_bf16 v[88:91], a[60:63], a[184:187], v[88:91]
  v_and_b32 v55, 0xffff0000, v109
  v_lshlrev_b32 v60, 16, v110
  v_mfma_f32_16x16x32_bf16 v[88:91], a[44:47], a[176:179], v[88:91]
  v_and_b32 v61, 0xffff0000, v110
  v_lshlrev_b32 v62, 16, v111
  v_and_b32 v63, 0xffff0000, v111
  v_pk_add_f32 v[68:69], v[68:69], v[36:37]
  v_pk_add_f32 v[70:71], v[70:71], v[38:39]
  v_pk_add_f32 v[76:77], v[76:77], v[44:45]
  v_pk_add_f32 v[78:79], v[78:79], v[46:47]
  v_cvt_pk_bf16_f32 v24, v68, v69
  v_cvt_pk_bf16_f32 v25, v70, v71
  v_cvt_pk_bf16_f32 v26, v76, v77
  v_cvt_pk_bf16_f32 v27, v78, v79
  v_pk_add_f32 v[64:65], v[64:65], v[32:33]
  v_pk_add_f32 v[66:67], v[66:67], v[34:35]
  v_pk_add_f32 v[72:73], v[72:73], v[40:41]
  v_pk_add_f32 v[74:75], v[74:75], v[42:43]
  v_cvt_pk_bf16_f32 v16, v64, v65
  v_cvt_pk_bf16_f32 v17, v66, v67
  v_cvt_pk_bf16_f32 v18, v72, v73
  v_cvt_pk_bf16_f32 v19, v74, v75
  v_pk_add_f32 v[84:85], v[84:85], v[52:53]
  v_pk_add_f32 v[86:87], v[86:87], v[54:55]
  v_pk_add_f32 v[92:93], v[92:93], v[60:61]
  v_pk_add_f32 v[94:95], v[94:95], v[62:63]
  v_cvt_pk_bf16_f32 v28, v84, v85
  v_cvt_pk_bf16_f32 v29, v86, v87
  v_cvt_pk_bf16_f32 v30, v92, v93
  v_cvt_pk_bf16_f32 v31, v94, v95
  v_pk_add_f32 v[80:81], v[80:81], v[48:49]
  v_pk_add_f32 v[82:83], v[82:83], v[50:51]
  v_pk_add_f32 v[88:89], v[88:89], v[56:57]
  v_pk_add_f32 v[90:91], v[90:91], v[58:59]
  v_cvt_pk_bf16_f32 v20, v80, v81
  v_cvt_pk_bf16_f32 v21, v82, v83
  v_cvt_pk_bf16_f32 v22, v88, v89
  v_cvt_pk_bf16_f32 v23, v90, v91
  s_cmp_eq_u32 s41, 0
  s_cbranch_scc1 Lp4_mid
  v_permlane16_swap_b32 v16, v18
  v_permlane16_swap_b32 v17, v19
  v_permlane16_swap_b32 v20, v22
  v_permlane16_swap_b32 v21, v23
  ds_write_b128 v152, v[16:19] offset:0
  ds_write_b128 v153, v[20:23] offset:0
  ds_read_b128 v[96:99], v154 offset:0
  ds_read_b128 v[100:103], v154 offset:1024
  v_permlane16_swap_b32 v24, v26
  v_permlane16_swap_b32 v25, v27
  v_permlane16_swap_b32 v28, v30
  v_permlane16_swap_b32 v29, v31
  ds_write_b128 v152, v[24:27] offset:2048
  ds_write_b128 v153, v[28:31] offset:2048
  ds_read_b128 v[104:107], v154 offset:2048
  ds_read_b128 v[108:111], v154 offset:3072
  s_waitcnt lgkmcnt(5)
  buffer_store_dwordx4 v[96:99], v155, s[32:35], s57 offen nt
  s_add_u32 s57, s57, 32768
  s_waitcnt lgkmcnt(4)
  buffer_store_dwordx4 v[100:103], v155, s[32:35], s57 offen nt
  s_add_u32 s57, s57, 32768
  s_waitcnt lgkmcnt(1)
  buffer_store_dwordx4 v[104:107], v155, s[32:35], s57 offen nt
  s_add_u32 s57, s57, 32768
  s_waitcnt lgkmcnt(0)
  buffer_store_dwordx4 v[108:111], v155, s[32:35], s57 offen nt
  s_add_u32 s57, s57, 32768
  s_endpgm
Lp4_mid:
  buffer_store_dwordx4 v[16:19], v8, s[4:7], s46 offen offset:0 sc1
  buffer_store_dwordx4 v[24:27], v8, s[4:7], s47 offen offset:0 sc1
  v_mfma_f32_16x16x32_bf16 v[144:147], v[24:27], v[24:27], 0
  v_mfma_f32_16x16x32_bf16 v[140:143], v[128:131], v[24:27], 0
  v_mfma_f32_16x16x32_bf16 v[136:139], v[16:19], v[16:19], 0
  v_mfma_f32_16x16x32_bf16 v[132:135], v[128:131], v[16:19], 0
  buffer_store_dwordx4 v[20:23], v8, s[4:7], s46 offen offset:1024 sc1
  v_mfma_f32_16x16x32_bf16 v[144:147], v[28:31], v[28:31], v[144:147]
  buffer_store_dwordx4 v[28:31], v8, s[4:7], s47 offen offset:1024 sc1
  v_mfma_f32_16x16x32_bf16 v[140:143], v[128:131], v[28:31], v[140:143]
  v_mfma_f32_16x16x32_bf16 v[136:139], v[20:23], v[20:23], v[136:139]
  v_mfma_f32_16x16x32_bf16 v[132:135], v[128:131], v[20:23], v[132:135]
  s_nop 5
  v_cndmask_b32 v141, v144, v145, s[66:67]
  v_cndmask_b32 v141, v141, v146, s[68:69]
  v_cndmask_b32 v141, v141, v147, s[70:71]
  buffer_store_dwordx2 v[140:141], v148, s[4:7], s48 offen offset:2048 sc1
  v_cndmask_b32 v133, v136, v137, s[66:67]
  v_cndmask_b32 v133, v133, v138, s[68:69]
  v_cndmask_b32 v133, v133, v139, s[70:71]
  buffer_store_dwordx2 v[132:133], v148, s[4:7], s48 offen offset:0 sc1
  s_mov_b32 s41, 1
  s_mov_b32 s42, 0x2800000
  s_mov_b32 s28, s4
  s_mov_b32 s29, s5
  s_mov_b32 s30, 0x10000000
  s_lshr_b32 s57, s40, 1
  s_and_b32 s58, s40, 1
  s_lshl_b32 s71, s50, 3
  s_add_u32 s67, s50, s51
  s_and_b32 s67, s67, 0
  s_lshl_b32 s67, s67, 3
  s_lshl_b32 s62, s40, 12
  s_mul_i32 s63, s40, 6144
  s_add_u32 s76, s63, 139264
  s_and_b32 s43, s50, 7
  s_cmp_lg_u32 s43, 0
  s_cselect_b32 s43, 1, 0
  s_sub_u32 s72, s71, s43
  v_lshrrev_b32 v2, 3, v253
  v_bfe_u32 v3, v253, 1, 2
  v_lshrrev_b32 v4, 4, v253
  v_xor_b32 v3, v3, v4
  v_and_b32 v5, 1, v253
  v_mov_b32 v6, v2
  s_lshl_b32 s43, s40, 4
  v_mul_u32_u24 v6, 6144, v6
  v_lshl_add_u32 v6, v3, 5, v6
  v_lshl_add_u32 v124, v5, 4, v6
  v_add_u32 v125, 48128, v124
  s_mul_i32 s43, s43, 6144
  s_lshl_b32 s60, s51, 7
  s_add_u32 s60, s60, s43
  v_and_b32 v3, 7, v253
  s_lshl_b32 s43, s40, 1
  s_add_u32 s43, s43, s71
  v_lshlrev_b32 v120, 4, v253
  v_mov_b32 v121, v120
  v_add_u32 v122, 30720, v120
  v_add_u32 v123, 30720, v120
  v_lshlrev_b32 v5, 8, v2
  v_lshl_add_u32 v5, v3, 4, v5
  v_add_u32 v126, 128, v5
  s_lshl_b32 s43, s43, 15
  s_mov_b32 s44, 41943040
  s_add_u32 s59, s43, s44
  s_lshl_b32 s43, s72, 15
  s_add_u32 s73, s43, s44
  s_movk_i32 s61, 2048
  v_and_b32 v2, 15, v253
  v_lshrrev_b32 v3, 4, v253
  v_and_b32 v4, 7, v253
  v_lshlrev_b32 v6, 4, v253
  v_add_u32 v7, 1024, v6
  v_lshlrev_b32 v5, 7, v3
  v_lshl_add_u32 v8, v4, 4, v5
  v_add_u32 v9, 512, v8
  s_lshl_b32 s43, s57, 13
  s_add_u32 s43, s43, 73728
  v_add_u32 v112, s43, v6
  v_add_u32 v113, s43, v7
  v_add_u32 v114, 122880, v8
  v_add_u32 v115, 122880, v9
  s_lshl_b32 s43, s52, 3
  s_lshl_b32 s44, s40, 1
  s_add_u32 s43, s43, s44
  v_mov_b32 v187, v6
  s_lshl_b32 s43, s43, 15
  s_lshl_b32 s44, s53, 11
  s_add_u32 s43, s43, s44
  s_add_u32 s64, s43, 41943040
  v_lshrrev_b32 v2, 2, v253
  v_bfe_u32 v3, v253, 3, 2
  v_and_b32 v4, 3, v253
  v_lshlrev_b32 v4, 3, v4
  v_lshl_add_u32 v4, v2, 7, v4
  s_lshl_b32 s43, s58, 1
  s_or_b32 s43, s43, s57
  v_xor_b32 v5, s43, v3
  v_lshl_add_u32 v116, v5, 5, v4
  v_xor_b32 v5, 1, v5
  v_lshl_add_u32 v117, v5, 5, v4
  v_add_u32 v118, 49152, v116
  v_add_u32 v119, 49152, v117
  s_mov_b32 s84, s16
  s_mov_b32 s85, s17
  s_mov_b32 s86, 7340032
  s_mov_b32 s87, 0x20000
  s_mov_b32 s3, 0
  s_mov_b32 s88, 63
  s_mov_b32 s100, 0
  v_mov_b32 v238, 0x40000000
  s_waitcnt vmcnt(0)
  s_barrier
  s_cmp_lg_u32 s40, 0
  s_cbranch_scc1 Lsig22
  v_mov_b32 v250, 1
  s_mov_b64 exec, 1
  buffer_atomic_add v250, v251, s[4:7], s77 offen sc1
  s_mov_b64 exec, -1
Lsig22:
  s_add_u32 s44, s67, 0
  s_and_b32 s44, s44, 15
  s_mul_i32 s45, s44, 393216
  s_add_u32 s69, s45, s60
  s_add_u32 s70, s69, 4096
  s_add_u32 m0, s63, 0
  s_nop 0
  buffer_load_dwordx4 v124, s[8:11], s69 offen offset:0  lds
  buffer_load_dwordx4 v125, s[8:11], s69 offen offset:1024  lds
  buffer_load_dwordx4 v124, s[8:11], s69 offen offset:2048  lds
  buffer_load_dwordx4 v125, s[8:11], s69 offen offset:3072  lds
  s_add_u32 m0, s63, 4096
  s_nop 0
  buffer_load_dwordx4 v124, s[8:11], s70 offen offset:0  lds
  buffer_load_dwordx4 v125, s[8:11], s70 offen offset:1024  lds
  s_add_u32 s44, s67, 1
  s_and_b32 s44, s44, 15
  s_mul_i32 s45, s44, 393216
  s_add_u32 s69, s45, s60
  s_add_u32 s70, s69, 4096
  s_add_u32 m0, s63, 24576
  s_nop 0
  buffer_load_dwordx4 v124, s[8:11], s69 offen offset:0  lds
  buffer_load_dwordx4 v125, s[8:11], s69 offen offset:1024  lds
  buffer_load_dwordx4 v124, s[8:11], s69 offen offset:2048  lds
  buffer_load_dwordx4 v125, s[8:11], s69 offen offset:3072  lds
  s_add_u32 m0, s63, 28672
  s_nop 0
  buffer_load_dwordx4 v124, s[8:11], s70 offen offset:0  lds
  buffer_load_dwordx4 v125, s[8:11], s70 offen offset:1024  lds
  s_add_u32 s44, s67, 2
  s_and_b32 s44, s44, 15
  s_mul_i32 s45, s44, 393216
  s_add_u32 s69, s45, s60
  s_add_u32 s70, s69, 4096
  s_add_u32 m0, s63, 49152
  s_nop 0
  buffer_load_dwordx4 v124, s[8:11], s69 offen offset:0  lds
  buffer_load_dwordx4 v125, s[8:11], s69 offen offset:1024  lds
  buffer_load_dwordx4 v124, s[8:11], s69 offen offset:2048  lds
  buffer_load_dwordx4 v125, s[8:11], s69 offen offset:3072  lds
  s_add_u32 m0, s63, 53248
  s_nop 0
  buffer_load_dwordx4 v124, s[8:11], s70 offen offset:0  lds
  buffer_load_dwordx4 v125, s[8:11], s70 offen offset:1024  lds
  v_pk_mul_f32 v[0:1], v[250:251], 0 op_sel:[1,0] op_sel_hi:[1,0]
  v_pk_mul_f32 v[2:3], v[250:251], 0 op_sel:[1,0] op_sel_hi:[1,0]
  v_pk_mul_f32 v[4:5], v[250:251], 0 op_sel:[1,0] op_sel_hi:[1,0]
  v_pk_mul_f32 v[6:7], v[250:251], 0 op_sel:[1,0] op_sel_hi:[1,0]
  v_pk_mul_f32 v[8:9], v[250:251], 0 op_sel:[1,0] op_sel_hi:[1,0]
  v_pk_mul_f32 v[10:11], v[250:251], 0 op_sel:[1,0] op_sel_hi:[1,0]
  v_pk_mul_f32 v[12:13], v[250:251], 0 op_sel:[1,0] op_sel_hi:[1,0]
  v_pk_mul_f32 v[14:15], v[250:251], 0 op_sel:[1,0] op_sel_hi:[1,0]
  v_pk_mul_f32 v[16:17], v[250:251], 0 op_sel:[1,0] op_sel_hi:[1,0]
  v_pk_mul_f32 v[18:19], v[250:251], 0 op_sel:[1,0] op_sel_hi:[1,0]
  v_pk_mul_f32 v[20:21], v[250:251], 0 op_sel:[1,0] op_sel_hi:[1,0]
  v_pk_mul_f32 v[22:23], v[250:251], 0 op_sel:[1,0] op_sel_hi:[1,0]
  v_pk_mul_f32 v[24:25], v[250:251], 0 op_sel:[1,0] op_sel_hi:[1,0]
  v_pk_mul_f32 v[26:27], v[250:251], 0 op_sel:[1,0] op_sel_hi:[1,0]
  v_pk_mul_f32 v[28:29], v[250:251], 0 op_sel:[1,0] op_sel_hi:[1,0]
  v_pk_mul_f32 v[30:31], v[250:251], 0 op_sel:[1,0] op_sel_hi:[1,0]
  v_pk_mul_f32 v[32:33], v[250:251], 0 op_sel:[1,0] op_sel_hi:[1,0]
  v_pk_mul_f32 v[34:35], v[250:251], 0 op_sel:[1,0] op_sel_hi:[1,0]
  v_pk_mul_f32 v[36:37], v[250:251], 0 op_sel:[1,0] op_sel_hi:[1,0]
  v_pk_mul_f32 v[38:39], v[250:251], 0 op_sel:[1,0] op_sel_hi:[1,0]
  v_pk_mul_f32 v[40:41], v[250:251], 0 op_sel:[1,0] op_sel_hi:[1,0]
  v_pk_mul_f32 v[42:43], v[250:251], 0 op_sel:[1,0] op_sel_hi:[1,0]
  v_pk_mul_f32 v[44:45], v[250:251], 0 op_sel:[1,0] op_sel_hi:[1,0]
  v_pk_mul_f32 v[46:47], v[250:251], 0 op_sel:[1,0] op_sel_hi:[1,0]
  v_pk_mul_f32 v[48:49], v[250:251], 0 op_sel:[1,0] op_sel_hi:[1,0]
  v_pk_mul_f32 v[50:51], v[250:251], 0 op_sel:[1,0] op_sel_hi:[1,0]
  v_pk_mul_f32 v[52:53], v[250:251], 0 op_sel:[1,0] op_sel_hi:[1,0]
  v_pk_mul_f32 v[54:55], v[250:251], 0 op_sel:[1,0] op_sel_hi:[1,0]
  v_pk_mul_f32 v[56:57], v[250:251], 0 op_sel:[1,0] op_sel_hi:[1,0]
  v_pk_mul_f32 v[58:59], v[250:251], 0 op_sel:[1,0] op_sel_hi:[1,0]
  v_pk_mul_f32 v[60:61], v[250:251], 0 op_sel:[1,0] op_sel_hi:[1,0]
  v_pk_mul_f32 v[62:63], v[250:251], 0 op_sel:[1,0] op_sel_hi:[1,0]
  v_pk_mul_f32 v[64:65], v[250:251], 0 op_sel:[1,0] op_sel_hi:[1,0]
  v_pk_mul_f32 v[66:67], v[250:251], 0 op_sel:[1,0] op_sel_hi:[1,0]
  v_pk_mul_f32 v[68:69], v[250:251], 0 op_sel:[1,0] op_sel_hi:[1,0]
  v_pk_mul_f32 v[70:71], v[250:251], 0 op_sel:[1,0] op_sel_hi:[1,0]
  v_pk_mul_f32 v[72:73], v[250:251], 0 op_sel:[1,0] op_sel_hi:[1,0]
  v_pk_mul_f32 v[74:75], v[250:251], 0 op_sel:[1,0] op_sel_hi:[1,0]
  v_pk_mul_f32 v[76:77], v[250:251], 0 op_sel:[1,0] op_sel_hi:[1,0]
  v_pk_mul_f32 v[78:79], v[250:251], 0 op_sel:[1,0] op_sel_hi:[1,0]
  v_pk_mul_f32 v[80:81], v[250:251], 0 op_sel:[1,0] op_sel_hi:[1,0]
  v_pk_mul_f32 v[82:83], v[250:251], 0 op_sel:[1,0] op_sel_hi:[1,0]
  v_pk_mul_f32 v[84:85], v[250:251], 0 op_sel:[1,0] op_sel_hi:[1,0]
  v_pk_mul_f32 v[86:87], v[250:251], 0 op_sel:[1,0] op_sel_hi:[1,0]
  v_pk_mul_f32 v[88:89], v[250:251], 0 op_sel:[1,0] op_sel_hi:[1,0]
  v_pk_mul_f32 v[90:91], v[250:251], 0 op_sel:[1,0] op_sel_hi:[1,0]
  v_pk_mul_f32 v[92:93], v[250:251], 0 op_sel:[1,0] op_sel_hi:[1,0]
  v_pk_mul_f32 v[94:95], v[250:251], 0 op_sel:[1,0] op_sel_hi:[1,0]
  v_pk_mul_f32 v[96:97], v[250:251], 0 op_sel:[1,0] op_sel_hi:[1,0]
  v_pk_mul_f32 v[98:99], v[250:251], 0 op_sel:[1,0] op_sel_hi:[1,0]
  v_pk_mul_f32 v[100:101], v[250:251], 0 op_sel:[1,0] op_sel_hi:[1,0]
  v_pk_mul_f32 v[102:103], v[250:251], 0 op_sel:[1,0] op_sel_hi:[1,0]
  s_mul_i32 s77, s50, 128
  s_add_u32 s77, s77, 27815808
  s_and_b32 s43, s50, 7
  s_cmp_eq_u32 s43, 0
  s_cselect_b32 s43, 128, 0
  v_lshlrev_b32 v249, 7, v253
  v_or_b32 v249, s43, v249
  s_branch Llayer
Lend:
  s_endpgm
Lside_sub:
  s_cmp_eq_u32 s90, 1
  s_cbranch_scc0 Lside_l
  s_cmp_lg_u32 s40, 0
  s_cbranch_scc1 Lside_a
  s_and_b32 s43, s2, 1
  s_lshl_b32 s43, s43, 7
  v_mov_b32 v250, 1
  s_mov_b64 exec, 1
  buffer_atomic_add v250, v251, s[36:39], s43 offen sc1
  s_mov_b64 exec, -1
Lside_a:
  s_add_u32 s88, s88, 3
  s_add_u32 s90, s90, 1
  s_setpc_b64 s[78:79]
Lside_l:
  buffer_load_dwordx4 a[240:243], v239, s[12:15], s89 offen
  s_add_u32 s89, s89, 1024
  s_cmp_eq_u32 s90, 0
  s_cbranch_scc0 Lside_b
  buffer_load_dwordx4 a[176:179], v238, s[84:87], s100 offen
  s_add_u32 s100, s100, 57344
  buffer_load_dwordx4 a[180:183], v238, s[84:87], s100 offen
  s_add_u32 s100, s100, 57344
  buffer_load_dwordx4 a[184:187], v238, s[84:87], s100 offen
  s_add_u32 s100, s100, 57344
  buffer_load_dwordx4 a[188:191], v238, s[84:87], s100 offen
  s_add_u32 s100, s100, 57344
  buffer_load_dwordx4 a[192:195], v238, s[84:87], s100 offen
  s_add_u32 s100, s100, 57344
  buffer_load_dwordx4 a[196:199], v238, s[84:87], s100 offen
  s_add_u32 s100, s100, 57344
  buffer_load_dwordx4 a[200:203], v238, s[84:87], s100 offen
  s_add_u32 s100, s100, 57344
  buffer_load_dwordx4 a[204:207], v238, s[84:87], s100 offen
  s_add_u32 s100, s100, 57344
  s_add_u32 s100, s100, 3211264
  s_add_u32 s88, s88, 3
  s_add_u32 s90, s90, 1
  s_setpc_b64 s[78:79]
Lside_b:
  buffer_load_dwordx4 a[208:211], v238, s[84:87], s100 offen
  s_add_u32 s100, s100, 57344
  buffer_load_dwordx4 a[212:215], v238, s[84:87], s100 offen
  s_add_u32 s100, s100, 57344
  buffer_load_dwordx4 a[216:219], v238, s[84:87], s100 offen
  s_add_u32 s100, s100, 57344
  buffer_load_dwordx4 a[220:223], v238, s[84:87], s100 offen
  s_add_u32 s100, s100, 57344
  buffer_load_dwordx4 a[224:227], v238, s[84:87], s100 offen
  s_add_u32 s100, s100, 57344
  buffer_load_dwordx4 a[228:231], v238, s[84:87], s100 offen
  s_add_u32 s100, s100, 57344
  buffer_load_dwordx4 a[232:235], v238, s[84:87], s100 offen
  s_add_u32 s100, s100, 57344
  buffer_load_dwordx4 a[236:239], v238, s[84:87], s100 offen
  s_add_u32 s100, s100, 57344
  s_mov_b32 s88, 63
  s_setpc_b64 s[78:79]
Lside_k9_c:
  s_call_b64 s[78:79], Lside_sub
  s_branch Lside_k9_r
Lside_k0_c:
  s_call_b64 s[78:79], Lside_sub
  s_branch Lside_k0_r
Lside_k1_c:
  s_call_b64 s[78:79], Lside_sub
  s_branch Lside_k1_r
Lside_k2_c:
  s_call_b64 s[78:79], Lside_sub
  s_branch Lside_k2_r
Lside_k3_c:
  s_call_b64 s[78:79], Lside_sub
  s_branch Lside_k3_r
Lside_k4_c:
  s_call_b64 s[78:79], Lside_sub
  s_branch Lside_k4_r
Lside_k5_c:
  s_call_b64 s[78:79], Lside_sub
  s_branch Lside_k5_r
Lchk3_c:
  s_mov_b32 s43, 0x40000
Lchk3_s:
  buffer_load_dword v127, v240, s[36:39], 0 offen sc1
  s_waitcnt vmcnt(0)
  v_cmp_gt_u32 vcc, 128, v127
  s_cbranch_vccz Lchk3_r
  s_sub_u32 s43, s43, 1
  s_cmp_lg_u32 s43, 0
  s_cbranch_scc1 Lchk3_s
  s_branch Lchk3_r
Lc4_c:
  buffer_load_dwordx4 v[200:203], v106, s[4:7], s46 offen sc1
  s_add_u32 s46, s46, 24576
  buffer_load_dwordx4 v[204:207], v106, s[4:7], s46 offen sc1
  s_add_u32 s46, s46, 24576
  s_branch Lc4_r
Lc5_c:
  buffer_load_dwordx4 v[208:211], v106, s[4:7], s46 offen sc1
  s_add_u32 s46, s46, 24576
  buffer_load_dwordx4 v[212:215], v106, s[4:7], s46 offen sc1
  s_add_u32 s46, s46, 24576
  s_branch Lc5_r
Lc6_c:
  buffer_load_dwordx4 v[216:219], v106, s[4:7], s46 offen sc1
  s_add_u32 s46, s46, 24576
  buffer_load_dwordx4 v[220:223], v106, s[4:7], s46 offen sc1
  s_add_u32 s46, s46, 24576
  s_branch Lc6_r
Lc7_c:
  buffer_load_dwordx4 v[224:227], v106, s[4:7], s46 offen sc1
  s_add_u32 s46, s46, 24576
  buffer_load_dwordx4 v[228:231], v106, s[4:7], s46 offen sc1
  s_add_u32 s46, s46, 24576
  s_branch Lc7_r
Lc8_c:
  v_pk_add_f32 v[200:201], v[200:201], v[216:217]
  v_pk_add_f32 v[202:203], v[202:203], v[218:219]
  v_pk_add_f32 v[204:205], v[204:205], v[220:221]
  v_pk_add_f32 v[206:207], v[206:207], v[222:223]
  v_pk_add_f32 v[208:209], v[208:209], v[224:225]
  v_pk_add_f32 v[210:211], v[210:211], v[226:227]
  v_pk_add_f32 v[212:213], v[212:213], v[228:229]
  v_pk_add_f32 v[214:215], v[214:215], v[230:231]
  v_pk_add_f32 v[200:201], v[200:201], v[208:209]
  v_pk_add_f32 v[202:203], v[202:203], v[210:211]
  v_pk_add_f32 v[204:205], v[204:205], v[212:213]
  v_pk_add_f32 v[206:207], v[206:207], v[214:215]
  v_pk_add_f32 v[200:201], v[200:201], v[204:205]
  v_pk_add_f32 v[202:203], v[202:203], v[206:207]
  v_mov_b32 v204, v200
  v_mov_b32 v205, v201
  v_mov_b32 v206, v202
  v_mov_b32 v207, v203
  v_permlane32_swap_b32 v200, v204
  v_permlane32_swap_b32 v201, v205
  v_permlane32_swap_b32 v202, v206
  v_permlane32_swap_b32 v203, v207
  v_add_f32 v200, v200, v204
  v_add_f32 v201, v201, v205
  v_add_f32 v202, v202, v206
  v_add_f32 v203, v203, v207
  ds_write_b128 v126, v[200:203] offset:1024
  s_branch Lc8_r
Lc10_c:
  v_accvgpr_read_b32 v236, a176
  v_accvgpr_read_b32 v237, a177
  v_accvgpr_read_b32 v238, a178
  v_accvgpr_read_b32 v239, a179
  v_lshlrev_b32 v224, 16, v236
  v_and_b32 v225, 0xffff0000, v236
  v_lshlrev_b32 v226, 16, v237
  v_and_b32 v227, 0xffff0000, v237
  v_lshlrev_b32 v228, 16, v238
  v_and_b32 v229, 0xffff0000, v238
  v_lshlrev_b32 v230, 16, v239
  v_and_b32 v231, 0xffff0000, v239
  v_accvgpr_read_b32 v236, a180
  v_accvgpr_read_b32 v237, a181
  v_accvgpr_read_b32 v238, a182
  v_accvgpr_read_b32 v239, a183
  v_lshlrev_b32 v232, 16, v236
  v_and_b32 v233, 0xffff0000, v236
  v_pk_add_f32 v[224:225], v[224:225], v[232:233]
  v_lshlrev_b32 v232, 16, v237
  v_and_b32 v233, 0xffff0000, v237
  v_pk_add_f32 v[226:227], v[226:227], v[232:233]
  v_lshlrev_b32 v232, 16, v238
  v_and_b32 v233, 0xffff0000, v238
  v_pk_add_f32 v[228:229], v[228:229], v[232:233]
  v_lshlrev_b32 v232, 16, v239
  v_and_b32 v233, 0xffff0000, v239
  v_pk_add_f32 v[230:231], v[230:231], v[232:233]
  v_accvgpr_read_b32 v236, a184
  v_accvgpr_read_b32 v237, a185
  v_accvgpr_read_b32 v238, a186
  v_accvgpr_read_b32 v239, a187
  v_lshlrev_b32 v232, 16, v236
  v_and_b32 v233, 0xffff0000, v236
  v_pk_add_f32 v[224:225], v[224:225], v[232:233]
  v_lshlrev_b32 v232, 16, v237
  v_and_b32 v233, 0xffff0000, v237
  v_pk_add_f32 v[226:227], v[226:227], v[232:233]
  v_lshlrev_b32 v232, 16, v238
  v_and_b32 v233, 0xffff0000, v238
  v_pk_add_f32 v[228:229], v[228:229], v[232:233]
  v_lshlrev_b32 v232, 16, v239
  v_and_b32 v233, 0xffff0000, v239
  v_pk_add_f32 v[230:231], v[230:231], v[232:233]
  v_accvgpr_read_b32 v236, a188
  v_accvgpr_read_b32 v237, a189
  v_accvgpr_read_b32 v238, a190
  v_accvgpr_read_b32 v239, a191
  v_lshlrev_b32 v232, 16, v236
  v_and_b32 v233, 0xffff0000, v236
  v_pk_add_f32 v[224:225], v[224:225], v[232:233]
  v_lshlrev_b32 v232, 16, v237
  v_and_b32 v233, 0xffff0000, v237
  v_pk_add_f32 v[226:227], v[226:227], v[232:233]
  v_lshlrev_b32 v232, 16, v238
  v_and_b32 v233, 0xffff0000, v238
  v_pk_add_f32 v[228:229], v[228:229], v[232:233]
  v_lshlrev_b32 v232, 16, v239
  v_and_b32 v233, 0xffff0000, v239
  v_pk_add_f32 v[230:231], v[230:231], v[232:233]
  v_accvgpr_read_b32 v236, a192
  v_accvgpr_read_b32 v237, a193
  v_accvgpr_read_b32 v238, a194
  v_accvgpr_read_b32 v239, a195
  v_lshlrev_b32 v232, 16, v236
  v_and_b32 v233, 0xffff0000, v236
  v_pk_add_f32 v[224:225], v[224:225], v[232:233]
  v_lshlrev_b32 v232, 16, v237
  v_and_b32 v233, 0xffff0000, v237
  v_pk_add_f32 v[226:227], v[226:227], v[232:233]
  v_lshlrev_b32 v232, 16, v238
  v_and_b32 v233, 0xffff0000, v238
  v_pk_add_f32 v[228:229], v[228:229], v[232:233]
  v_lshlrev_b32 v232, 16, v239
  v_and_b32 v233, 0xffff0000, v239
  v_pk_add_f32 v[230:231], v[230:231], v[232:233]
  v_accvgpr_read_b32 v236, a196
  v_accvgpr_read_b32 v237, a197
  v_accvgpr_read_b32 v238, a198
  v_accvgpr_read_b32 v239, a199
  v_lshlrev_b32 v232, 16, v236
  v_and_b32 v233, 0xffff0000, v236
  v_pk_add_f32 v[224:225], v[224:225], v[232:233]
  v_lshlrev_b32 v232, 16, v237
  v_and_b32 v233, 0xffff0000, v237
  v_pk_add_f32 v[226:227], v[226:227], v[232:233]
  v_lshlrev_b32 v232, 16, v238
  v_and_b32 v233, 0xffff0000, v238
  v_pk_add_f32 v[228:229], v[228:229], v[232:233]
  v_lshlrev_b32 v232, 16, v239
  v_and_b32 v233, 0xffff0000, v239
  v_pk_add_f32 v[230:231], v[230:231], v[232:233]
  v_accvgpr_read_b32 v236, a200
  v_accvgpr_read_b32 v237, a201
  v_accvgpr_read_b32 v238, a202
  v_accvgpr_read_b32 v239, a203
  v_lshlrev_b32 v232, 16, v236
  v_and_b32 v233, 0xffff0000, v236
  v_pk_add_f32 v[224:225], v[224:225], v[232:233]
  v_lshlrev_b32 v232, 16, v237
  v_and_b32 v233, 0xffff0000, v237
  v_pk_add_f32 v[226:227], v[226:227], v[232:233]
  v_lshlrev_b32 v232, 16, v238
  v_and_b32 v233, 0xffff0000, v238
  v_pk_add_f32 v[228:229], v[228:229], v[232:233]
  v_lshlrev_b32 v232, 16, v239
  v_and_b32 v233, 0xffff0000, v239
  v_pk_add_f32 v[230:231], v[230:231], v[232:233]
  v_accvgpr_read_b32 v236, a204
  v_accvgpr_read_b32 v237, a205
  v_accvgpr_read_b32 v238, a206
  v_accvgpr_read_b32 v239, a207
  v_lshlrev_b32 v232, 16, v236
  v_and_b32 v233, 0xffff0000, v236
  v_pk_add_f32 v[224:225], v[224:225], v[232:233]
  v_lshlrev_b32 v232, 16, v237
  v_and_b32 v233, 0xffff0000, v237
  v_pk_add_f32 v[226:227], v[226:227], v[232:233]
  v_lshlrev_b32 v232, 16, v238
  v_and_b32 v233, 0xffff0000, v238
  v_pk_add_f32 v[228:229], v[228:229], v[232:233]
  v_lshlrev_b32 v232, 16, v239
  v_and_b32 v233, 0xffff0000, v239
  v_pk_add_f32 v[230:231], v[230:231], v[232:233]
  s_branch Lc10_r
Lc11_c:
  v_accvgpr_read_b32 v236, a208
  v_accvgpr_read_b32 v237, a209
  v_accvgpr_read_b32 v238, a210
  v_accvgpr_read_b32 v239, a211
  v_lshlrev_b32 v232, 16, v236
  v_and_b32 v233, 0xffff0000, v236
  v_pk_add_f32 v[224:225], v[224:225], v[232:233]
  v_lshlrev_b32 v232, 16, v237
  v_and_b32 v233, 0xffff0000, v237
  v_pk_add_f32 v[226:227], v[226:227], v[232:233]
  v_lshlrev_b32 v232, 16, v238
  v_and_b32 v233, 0xffff0000, v238
  v_pk_add_f32 v[228:229], v[228:229], v[232:233]
  v_lshlrev_b32 v232, 16, v239
  v_and_b32 v233, 0xffff0000, v239
  v_pk_add_f32 v[230:231], v[230:231], v[232:233]
  v_accvgpr_read_b32 v236, a212
  v_accvgpr_read_b32 v237, a213
  v_accvgpr_read_b32 v238, a214
  v_accvgpr_read_b32 v239, a215
  v_lshlrev_b32 v232, 16, v236
  v_and_b32 v233, 0xffff0000, v236
  v_pk_add_f32 v[224:225], v[224:225], v[232:233]
  v_lshlrev_b32 v232, 16, v237
  v_and_b32 v233, 0xffff0000, v237
  v_pk_add_f32 v[226:227], v[226:227], v[232:233]
  v_lshlrev_b32 v232, 16, v238
  v_and_b32 v233, 0xffff0000, v238
  v_pk_add_f32 v[228:229], v[228:229], v[232:233]
  v_lshlrev_b32 v232, 16, v239
  v_and_b32 v233, 0xffff0000, v239
  v_pk_add_f32 v[230:231], v[230:231], v[232:233]
  v_accvgpr_read_b32 v236, a216
  v_accvgpr_read_b32 v237, a217
  v_accvgpr_read_b32 v238, a218
  v_accvgpr_read_b32 v239, a219
  v_lshlrev_b32 v232, 16, v236
  v_and_b32 v233, 0xffff0000, v236
  v_pk_add_f32 v[224:225], v[224:225], v[232:233]
  v_lshlrev_b32 v232, 16, v237
  v_and_b32 v233, 0xffff0000, v237
  v_pk_add_f32 v[226:227], v[226:227], v[232:233]
  v_lshlrev_b32 v232, 16, v238
  v_and_b32 v233, 0xffff0000, v238
  v_pk_add_f32 v[228:229], v[228:229], v[232:233]
  v_lshlrev_b32 v232, 16, v239
  v_and_b32 v233, 0xffff0000, v239
  v_pk_add_f32 v[230:231], v[230:231], v[232:233]
  v_accvgpr_read_b32 v236, a220
  v_accvgpr_read_b32 v237, a221
  v_accvgpr_read_b32 v238, a222
  v_accvgpr_read_b32 v239, a223
  v_lshlrev_b32 v232, 16, v236
  v_and_b32 v233, 0xffff0000, v236
  v_pk_add_f32 v[224:225], v[224:225], v[232:233]
  v_lshlrev_b32 v232, 16, v237
  v_and_b32 v233, 0xffff0000, v237
  v_pk_add_f32 v[226:227], v[226:227], v[232:233]
  v_lshlrev_b32 v232, 16, v238
  v_and_b32 v233, 0xffff0000, v238
  v_pk_add_f32 v[228:229], v[228:229], v[232:233]
  v_lshlrev_b32 v232, 16, v239
  v_and_b32 v233, 0xffff0000, v239
  v_pk_add_f32 v[230:231], v[230:231], v[232:233]
  v_accvgpr_read_b32 v236, a224
  v_accvgpr_read_b32 v237, a225
  v_accvgpr_read_b32 v238, a226
  v_accvgpr_read_b32 v239, a227
  v_lshlrev_b32 v232, 16, v236
  v_and_b32 v233, 0xffff0000, v236
  v_pk_add_f32 v[224:225], v[224:225], v[232:233]
  v_lshlrev_b32 v232, 16, v237
  v_and_b32 v233, 0xffff0000, v237
  v_pk_add_f32 v[226:227], v[226:227], v[232:233]
  v_lshlrev_b32 v232, 16, v238
  v_and_b32 v233, 0xffff0000, v238
  v_pk_add_f32 v[228:229], v[228:229], v[232:233]
  v_lshlrev_b32 v232, 16, v239
  v_and_b32 v233, 0xffff0000, v239
  v_pk_add_f32 v[230:231], v[230:231], v[232:233]
  v_accvgpr_read_b32 v236, a228
  v_accvgpr_read_b32 v237, a229
  v_accvgpr_read_b32 v238, a230
  v_accvgpr_read_b32 v239, a231
  v_lshlrev_b32 v232, 16, v236
  v_and_b32 v233, 0xffff0000, v236
  v_pk_add_f32 v[224:225], v[224:225], v[232:233]
  v_lshlrev_b32 v232, 16, v237
  v_and_b32 v233, 0xffff0000, v237
  v_pk_add_f32 v[226:227], v[226:227], v[232:233]
  v_lshlrev_b32 v232, 16, v238
  v_and_b32 v233, 0xffff0000, v238
  v_pk_add_f32 v[228:229], v[228:229], v[232:233]
  v_lshlrev_b32 v232, 16, v239
  v_and_b32 v233, 0xffff0000, v239
  v_pk_add_f32 v[230:231], v[230:231], v[232:233]
  v_accvgpr_read_b32 v236, a232
  v_accvgpr_read_b32 v237, a233
  v_accvgpr_read_b32 v238, a234
  v_accvgpr_read_b32 v239, a235
  v_lshlrev_b32 v232, 16, v236
  v_and_b32 v233, 0xffff0000, v236
  v_pk_add_f32 v[224:225], v[224:225], v[232:233]
  v_lshlrev_b32 v232, 16, v237
  v_and_b32 v233, 0xffff0000, v237
  v_pk_add_f32 v[226:227], v[226:227], v[232:233]
  v_lshlrev_b32 v232, 16, v238
  v_and_b32 v233, 0xffff0000, v238
  v_pk_add_f32 v[228:229], v[228:229], v[232:233]
  v_lshlrev_b32 v232, 16, v239
  v_and_b32 v233, 0xffff0000, v239
  v_pk_add_f32 v[230:231], v[230:231], v[232:233]
  v_accvgpr_read_b32 v236, a236
  v_accvgpr_read_b32 v237, a237
  v_accvgpr_read_b32 v238, a238
  v_accvgpr_read_b32 v239, a239
  v_lshlrev_b32 v232, 16, v236
  v_and_b32 v233, 0xffff0000, v236
  v_pk_add_f32 v[224:225], v[224:225], v[232:233]
  v_lshlrev_b32 v232, 16, v237
  v_and_b32 v233, 0xffff0000, v237
  v_pk_add_f32 v[226:227], v[226:227], v[232:233]
  v_lshlrev_b32 v232, 16, v238
  v_and_b32 v233, 0xffff0000, v238
  v_pk_add_f32 v[228:229], v[228:229], v[232:233]
  v_lshlrev_b32 v232, 16, v239
  v_and_b32 v233, 0xffff0000, v239
  v_pk_add_f32 v[230:231], v[230:231], v[232:233]
  v_mov_b32 v232, v224
  v_mov_b32 v233, v225
  v_mov_b32 v234, v226
  v_mov_b32 v235, v227
  v_mov_b32 v236, v228
  v_mov_b32 v237, v229
  v_mov_b32 v238, v230
  v_mov_b32 v239, v231
  v_permlane32_swap_b32 v224, v232
  v_permlane32_swap_b32 v225, v233
  v_permlane32_swap_b32 v226, v234
  v_permlane32_swap_b32 v227, v235
  v_permlane32_swap_b32 v228, v236
  v_permlane32_swap_b32 v229, v237
  v_permlane32_swap_b32 v230, v238
  v_permlane32_swap_b32 v231, v239
  v_add_f32 v224, v224, v232
  v_add_f32 v225, v225, v233
  v_add_f32 v226, v226, v234
  v_add_f32 v227, v227, v235
  v_add_f32 v228, v228, v236
  v_add_f32 v229, v229, v237
  v_add_f32 v230, v230, v238
  v_add_f32 v231, v231, v239
  v_mov_b32 v232, v224
  v_mov_b32 v233, v225
  v_mov_b32 v234, v226
  v_mov_b32 v235, v227
  v_mov_b32 v236, v228
  v_mov_b32 v237, v229
  v_mov_b32 v238, v230
  v_mov_b32 v239, v231
  v_permlane16_swap_b32 v224, v232
  v_permlane16_swap_b32 v225, v233
  v_permlane16_swap_b32 v226, v234
  v_permlane16_swap_b32 v227, v235
  v_permlane16_swap_b32 v228, v236
  v_permlane16_swap_b32 v229, v237
  v_permlane16_swap_b32 v230, v238
  v_permlane16_swap_b32 v231, v239
  v_add_f32 v224, v224, v232
  v_add_f32 v225, v225, v233
  v_add_f32 v226, v226, v234
  v_add_f32 v227, v227, v235
  v_add_f32 v228, v228, v236
  v_add_f32 v229, v229, v237
  v_add_f32 v230, v230, v238
  v_add_f32 v231, v231, v239
  v_and_b32 v232, 7, v253
  s_lshl_b32 s43, s40, 8
  s_add_u32 s43, s43, 143360
  v_add_f32_dpp v224, v224, v224 row_ror:8 row_mask:0xf bank_mask:0xf
  v_add_f32_dpp v225, v225, v225 row_ror:8 row_mask:0xf bank_mask:0xf
  v_add_f32_dpp v226, v226, v226 row_ror:8 row_mask:0xf bank_mask:0xf
  v_add_f32_dpp v227, v227, v227 row_ror:8 row_mask:0xf bank_mask:0xf
  v_add_f32_dpp v228, v228, v228 row_ror:8 row_mask:0xf bank_mask:0xf
  v_add_f32_dpp v229, v229, v229 row_ror:8 row_mask:0xf bank_mask:0xf
  v_add_f32_dpp v230, v230, v230 row_ror:8 row_mask:0xf bank_mask:0xf
  v_add_f32_dpp v231, v231, v231 row_ror:8 row_mask:0xf bank_mask:0xf
  v_lshl_add_u32 v232, v232, 5, s43
  ds_write_b128 v232, v[224:227]
  ds_write_b128 v232, v[228:231] offset:16
  s_branch Lc11_r
Lc14_c:
  v_lshlrev_b32 v232, 2, v253
  v_add_u32 v233, 143360, v232
  ds_read_b32 v234, v233 offset:0
  ds_read_b32 v235, v233 offset:256
  ds_read_b32 v236, v233 offset:512
  ds_read_b32 v237, v233 offset:768
  s_waitcnt lgkmcnt(0)
  v_add_f32 v234, v234, v235
  v_add_f32 v236, v236, v237
  v_add_f32 v234, v234, v236
  buffer_store_dword v234, v232, s[4:7], s101 offen sc1
  s_branch Lc14_r
Lc16_c:
  s_bfe_u32 s43, s2, 0x20001
  s_lshl_b32 s43, s43, 7
  s_add_u32 s43, s43, 27794432
  v_mov_b32 v250, 1
  s_mov_b64 exec, 1
  buffer_atomic_add v250, v251, s[4:7], s43 offen sc1
  s_mov_b64 exec, -1
  s_branch Lc16_r
Lchk19_c:
  s_mov_b32 s43, 0x40000
Lchk19_s:
  buffer_load_dword v237, v251, s[4:7], s48 offen sc1
  s_waitcnt vmcnt(0)
  v_cmp_gt_u32 vcc, 56, v237
  s_cbranch_vccz Lchk19_r
  s_sub_u32 s43, s43, 1
  s_cmp_lg_u32 s43, 0
  s_cbranch_scc1 Lchk19_s
  s_branch Lchk19_r
Lp4a_c:
  s_mov_b32 s43, 0x40000
Lp4a_s:
  buffer_load_dword v10, v251, s[4:7], s64 offen sc1
  s_waitcnt vmcnt(0)
  v_cmp_gt_u32 vcc, 16, v10
  s_cbranch_vccz Lp4a_r
  s_sub_u32 s43, s43, 1
  s_cmp_lg_u32 s43, 0
  s_cbranch_scc1 Lp4a_s
  s_branch Lp4a_r
Lp4b_c:
  s_mov_b32 s43, 0x40000
Lp4b_s:
  buffer_load_dword v10, v251, s[4:7], s64 offen sc1
  s_waitcnt vmcnt(0)
  v_cmp_gt_u32 vcc, 16, v10
  s_cbranch_vccz Lp4b_r
  s_sub_u32 s43, s43, 1
  s_cmp_lg_u32 s43, 0
  s_cbranch_scc1 Lp4b_s
  s_branch Lp4b_r
Lp3_sgl_c:
  v_mov_b32 v250, 1
  s_mov_b64 exec, 1
  buffer_atomic_add v250, v251, s[4:7], s77 offen sc1
  s_mov_b64 exec, -1
  s_branch Lp3_sgl_r
Lp4_mb_c:
  s_mov_b32 s43, 0x40000
Lp4_mb_s:
  buffer_load_dwordx4 v[96:99], v8, s[4:7], s45 offen offset:0 sc1
  buffer_load_dwordx4 v[100:103], v8, s[4:7], s45 offen offset:1024 sc1
  buffer_load_dwordx4 v[104:107], v8, s[4:7], s45 offen offset:2048 sc1
  buffer_load_dwordx4 v[108:111], v8, s[4:7], s45 offen offset:3072 sc1
  s_waitcnt vmcnt(0)
  v_max3_u32 v112, v96, v97, v98
  v_max3_u32 v113, v99, v100, v101
  v_max3_u32 v112, v112, v102, v103
  v_max3_u32 v113, v113, v104, v105
  v_max3_u32 v112, v112, v106, v107
  v_max3_u32 v113, v113, v108, v109
  v_max3_u32 v112, v112, v110, v111
  v_max_u32 v112, v112, v113
  v_cmp_eq_u32 vcc, -1, v112
  s_cbranch_vccz Lp4_mb_r
  s_sub_u32 s43, s43, 1
  s_cmp_lg_u32 s43, 0
  s_cbranch_scc1 Lp4_mb_s
  s_branch Lp4_mb_r
Lcode_end:
.fill (Lpc0 + 65536 - Lcode_end)/4, 4, 0xbf810000
.section .rodata,"a"
.p2align 6
.amdhsa_kernel interleave_layers__sliding_local_dilated__swiglu_ffn__prompt_kernel
  .amdhsa_next_free_vgpr 512
  .amdhsa_next_free_sgpr 102
  .amdhsa_accum_offset 256
  .amdhsa_group_segment_fixed_size 0
  .amdhsa_kernarg_size 80
  .amdhsa_user_sgpr_count 2
  .amdhsa_user_sgpr_kernarg_segment_ptr 1
  .amdhsa_system_sgpr_workgroup_id_x 1
  .amdhsa_float_denorm_mode_32 3
.end_amdhsa_kernel
```

```asm
; @launch grid=(256,1,1) block=(256,1,1) lds=163840
.amdgcn_target "amdgcn-amd-amdhsa--gfx950"
.text
.globl interleave_layers__sliding_local_dilated__swiglu_ffn__prompt_kernel
.p2align 8
.type interleave_layers__sliding_local_dilated__swiglu_ffn__prompt_kernel,@function
interleave_layers__sliding_local_dilated__swiglu_ffn__prompt_kernel:
  s_cmp_lt_u32 s2, 256
  s_cbranch_scc1 Lgo
  s_endpgm
Lgo:
  s_load_dwordx2 s[28:29], s[0:1], 0
  s_load_dwordx2 s[8:9], s[0:1], 8
  s_getpc_b64 s[44:45]
Lpc0:
  s_bfe_u32 s43, s2, 0x40003
  s_lshl_b32 s43, s43, 12
  v_lshl_add_u32 v2, v0, 4, s43
  s_and_b32 s44, s44, 0xffffff80
  global_load_dwordx4 a[240:243], v2, s[44:45]
  v_lshrrev_b32 v1, 6, v0
  v_and_b32 v253, 63, v0
  v_readfirstlane_b32 s40, v1
  v_mov_b32 v251, 0
  s_mov_b32 s30, 0x400000
  s_mov_b32 s31, 0x20000
  s_mov_b32 s10, 0x600000
  s_mov_b32 s11, 0x20000
  s_and_b32 s44, s2, 1
  s_bfe_u32 s45, s2, 0x20001
  s_lshr_b32 s46, s2, 3
  s_lshl_b32 s47, s44, 3
  s_and_b32 s43, s46, 7
  s_add_u32 s50, s47, s43
  s_lshl_b32 s43, s45, 2
  s_lshr_b32 s51, s46, 3
  s_add_u32 s51, s51, s43
  s_lshr_b32 s57, s40, 1
  s_and_b32 s58, s40, 1
  s_lshl_b32 s71, s50, 3
  s_add_u32 s67, s50, s51
  s_and_b32 s67, s67, 15
  s_lshl_b32 s62, s40, 12
  s_mul_i32 s63, s40, 6144
  s_add_u32 s76, s63, 139264
  s_and_b32 s43, s50, 7
  s_cmp_lg_u32 s43, 0
  s_cselect_b32 s43, 1, 0
  s_sub_u32 s72, s71, s43
  v_lshrrev_b32 v2, 3, v253
  v_bfe_u32 v3, v253, 1, 2
  v_lshrrev_b32 v4, 4, v253
  v_xor_b32 v3, v3, v4
  v_and_b32 v5, 1, v253
  v_lshrrev_b32 v6, 5, v253
  v_lshl_add_u32 v6, v6, 2, v2
  s_lshl_b32 s43, s57, 5
  s_lshl_b32 s44, s58, 2
  s_add_u32 s43, s43, s44
  v_mul_u32_u24 v6, 6144, v6
  v_lshl_add_u32 v6, v3, 5, v6
  v_lshl_add_u32 v124, v5, 4, v6
  v_add_u32 v125, 97280, v124
  s_mul_i32 s43, s43, 6144
  s_lshl_b32 s60, s51, 7
  s_add_u32 s60, s60, s43
  v_and_b32 v3, 7, v253
  s_lshl_b32 s43, s40, 1
  s_add_u32 s43, s43, s71
  v_add_u32 v5, 0, v4
  v_xor_b32 v5, v5, v3
  v_lshlrev_b32 v5, 4, v5
  v_lshl_add_u32 v5, v2, 12, v5
  v_add_u32 v120, 0, v5
  v_add_u32 v5, 4, v4
  v_xor_b32 v5, v5, v3
  v_lshlrev_b32 v5, 4, v5
  v_lshl_add_u32 v5, v2, 12, v5
  v_add_u32 v121, 31744, v5
  v_add_u32 v5, 0, v4
  v_xor_b32 v5, v5, v3
  v_lshlrev_b32 v5, 4, v5
  v_lshl_add_u32 v5, v2, 12, v5
  v_add_u32 v122, 63488, v5
  v_add_u32 v5, 4, v4
  v_xor_b32 v5, v5, v3
  v_lshlrev_b32 v5, 4, v5
  v_lshl_add_u32 v5, v2, 12, v5
  v_add_u32 v123, 95232, v5
  v_and_b32 v5, 6, v2
  v_xor_b32 v5, v5, v3
  v_lshlrev_b32 v5, 4, v5
  v_lshl_add_u32 v5, v2, 12, v5
  v_add_u32 v126, 32768, v5
  s_lshr_b32 s44, s50, 3
  s_lshl_b32 s44, s44, 11
  s_and_b32 s43, s43, 63
  s_lshl_b32 s43, s43, 16
  s_add_u32 s59, s43, s44
  s_and_b32 s43, s72, 63
  s_lshl_b32 s43, s43, 16
  s_add_u32 s73, s43, s44
  s_movk_i32 s61, 128
  s_waitcnt lgkmcnt(0)
  s_add_u32 s44, s67, 0
  s_and_b32 s44, s44, 15
  s_mul_i32 s45, s44, s61
  s_add_u32 s68, s45, s59
  s_add_u32 m0, s62, 73728
  s_nop 0
  buffer_load_dwordx4 v120, s[28:31], s68 offen offset:0 sc1  lds
  buffer_load_dwordx4 v121, s[28:31], s68 offen offset:1024 sc1  lds
  buffer_load_dwordx4 v122, s[28:31], s68 offen offset:2048 sc1  lds
  buffer_load_dwordx4 v123, s[28:31], s68 offen offset:3072 sc1  lds
  s_add_u32 s44, s67, 0
  s_and_b32 s44, s44, 15
  s_mul_i32 s45, s44, 393216
  s_add_u32 s69, s45, s60
  s_add_u32 s70, s69, 4096
  s_add_u32 m0, s63, 0
  s_nop 0
  buffer_load_dwordx4 v124, s[8:11], s69 offen offset:0  lds
  buffer_load_dwordx4 v125, s[8:11], s69 offen offset:1024  lds
  buffer_load_dwordx4 v124, s[8:11], s69 offen offset:2048  lds
  buffer_load_dwordx4 v125, s[8:11], s69 offen offset:3072  lds
  s_add_u32 m0, s63, 4096
  s_nop 0
  buffer_load_dwordx4 v124, s[8:11], s70 offen offset:0  lds
  buffer_load_dwordx4 v125, s[8:11], s70 offen offset:1024  lds
  s_add_u32 s44, s67, s40
  s_add_u32 s44, s44, 0
  s_and_b32 s44, s44, 15
  s_mul_i32 s44, s44, s61
  s_lshl_b32 s45, s40, 10
  s_add_u32 m0, s45, 122880
  s_add_u32 s44, s44, s73
  buffer_load_dwordx4 v126, s[28:31], s44 offen sc1 lds
  s_load_dwordx2 s[4:5], s[0:1], 72
  s_load_dwordx2 s[12:13], s[0:1], 16
  s_load_dwordx2 s[16:17], s[0:1], 32
  s_load_dwordx2 s[20:21], s[0:1], 40
  s_load_dwordx2 s[24:25], s[0:1], 48
  s_load_dwordx2 s[32:33], s[0:1], 56
  s_load_dwordx2 s[36:37], s[0:1], 64
  s_mov_b32 s6, 0x10000000
  s_mov_b32 s7, 0x20000
  s_mov_b32 s14, 0x200000
  s_mov_b32 s15, 0x20000
  s_mov_b32 s18, 0x700000
  s_mov_b32 s19, 0x20000
  s_mov_b32 s22, 0x700000
  s_mov_b32 s23, 0x20000
  s_mov_b32 s26, 0x700000
  s_mov_b32 s27, 0x20000
  s_mov_b32 s34, 0x400000
  s_mov_b32 s35, 0x20000
  s_mov_b32 s38, 0x100
  s_mov_b32 s39, 0x20000
  s_mov_b32 s41, 0
  s_mov_b32 s42, 0
  s_and_b32 s44, s2, 1
  s_bfe_u32 s45, s2, 0x20001
  s_lshr_b32 s46, s2, 3
  s_lshl_b32 s47, s44, 3
  s_lshr_b32 s43, s45, 1
  s_lshl_b32 s43, s43, 2
  s_add_u32 s52, s47, s43
  s_and_b32 s48, s46, 3
  s_add_u32 s52, s52, s48
  s_and_b32 s43, s45, 1
  s_lshr_b32 s49, s46, 2
  s_lshl_b32 s53, s49, 1
  s_add_u32 s53, s53, s43
  s_lshl_b32 s43, s44, 2
  s_add_u32 s54, s43, s48
  s_lshl_b32 s43, s45, 3
  s_add_u32 s55, s43, s49
  v_lshrrev_b32 v2, 3, v253
  v_bfe_u32 v3, v253, 1, 2
  v_lshrrev_b32 v4, 4, v253
  v_xor_b32 v3, v3, v4
  v_and_b32 v4, 1, v253
  v_lshlrev_b32 v2, 11, v2
  v_lshl_add_u32 v2, v3, 5, v2
  v_lshl_add_u32 v252, v4, 4, v2
  s_waitcnt lgkmcnt(0)
  s_and_b32 s43, s40, 1
  s_mul_i32 s43, s43, 41943040
  s_lshl_b32 s44, s2, 7
  s_add_u32 s43, s43, s44
  s_add_u32 s43, s43, 27787264
  buffer_store_dword v251, v251, s[4:7], s43 offen sc1
  v_and_b32 v2, 15, v253
  v_lshrrev_b32 v3, 4, v253
  v_and_b32 v4, 7, v253
  v_lshrrev_b32 v5, 1, v2
  v_xor_b32 v5, v5, v3
  v_lshlrev_b32 v5, 4, v5
  v_lshl_add_u32 v6, v2, 7, v5
  v_xor_b32 v7, 64, v6
  v_and_b32 v5, 6, v4
  v_xor_b32 v5, v5, v3
  v_lshlrev_b32 v5, 4, v5
  v_lshl_add_u32 v8, v4, 7, v5
  v_xor_b32 v9, 64, v8
  s_lshl_b32 s43, s57, 13
  s_add_u32 s43, s43, 73728
  v_add_u32 v112, s43, v6
  v_add_u32 v113, s43, v7
  v_add_u32 v114, 122880, v8
  v_add_u32 v115, 122880, v9
  s_lshl_b32 s43, s52, 3
  s_lshl_b32 s44, s40, 1
  s_add_u32 s43, s43, s44
  v_lshrrev_b32 v5, 1, v3
  v_lshrrev_b32 v187, 1, v2
  v_xor_b32 v5, v5, v187
  v_lshlrev_b32 v5, 4, v5
  v_lshl_add_u32 v187, v2, 7, v5
  v_and_b32 v5, 1, v3
  v_lshl_add_u32 v187, v5, 3, v187
  s_lshr_b32 s44, s43, 6
  s_lshl_b32 s44, s44, 11
  s_and_b32 s43, s43, 63
  s_lshl_b32 s43, s43, 16
  s_add_u32 s43, s43, s44
  s_lshl_b32 s44, s53, 7
  s_add_u32 s64, s43, s44
  v_lshrrev_b32 v2, 2, v253
  v_bfe_u32 v3, v253, 3, 2
  v_and_b32 v4, 3, v253
  v_lshlrev_b32 v4, 3, v4
  v_lshl_add_u32 v4, v2, 7, v4
  s_lshl_b32 s43, s58, 1
  s_or_b32 s43, s43, s57
  v_xor_b32 v5, s43, v3
  v_lshl_add_u32 v116, v5, 5, v4
  v_xor_b32 v5, 1, v5
  v_lshl_add_u32 v117, v5, 5, v4
  v_add_u32 v118, 49152, v116
  v_add_u32 v119, 49152, v117
  v_and_b32 v235, 15, v253
  v_lshrrev_b32 v236, 4, v253
  v_lshlrev_b32 v236, 2, v236
  v_sub_u32 v235, v235, v236
  v_mov_b32 v237, 0xf149f2ca
  v_subrev_u32 v238, 0, v235
  v_cmp_gt_u32 vcc, 8, v238
  v_add_u32 v238, 16, v238
  v_cmp_gt_u32 s[78:79], 8, v238
  v_cndmask_b32 v132, v237, 0, vcc
  s_nop 0
  v_cndmask_b32 v136, v237, 0, s[78:79]
  v_subrev_u32 v238, 1, v235
  v_cmp_gt_u32 vcc, 8, v238
  v_add_u32 v238, 16, v238
  v_cmp_gt_u32 s[78:79], 8, v238
  v_cndmask_b32 v133, v237, 0, vcc
  s_nop 0
  v_cndmask_b32 v137, v237, 0, s[78:79]
  v_subrev_u32 v238, 2, v235
  v_cmp_gt_u32 vcc, 8, v238
  v_add_u32 v238, 16, v238
  v_cmp_gt_u32 s[78:79], 8, v238
  v_cndmask_b32 v134, v237, 0, vcc
  s_nop 0
  v_cndmask_b32 v138, v237, 0, s[78:79]
  v_subrev_u32 v238, 3, v235
  v_cmp_gt_u32 vcc, 8, v238
  v_add_u32 v238, 16, v238
  v_cmp_gt_u32 s[78:79], 8, v238
  v_cndmask_b32 v135, v237, 0, vcc
  s_nop 0
  v_cndmask_b32 v139, v237, 0, s[78:79]
  v_lshlrev_b32 v232, 4, v253
  v_add_u32 v232, 149504, v232
  ds_write_b128 v232, v[132:135]
  ds_write_b128 v232, v[136:139] offset:1024
  s_lshr_b32 s46, s2, 3
  s_cmp_ge_u32 s46, 14
  s_cselect_b32 s44, 14, 0
  s_cselect_b32 s45, 1, 0
  s_cselect_b32 s84, s20, s16
  s_cselect_b32 s85, s21, s17
  s_mov_b32 s86, 7340032
  s_mov_b32 s87, 0x20000
  s_sub_u32 s44, s46, s44
  s_bfe_u32 s47, s2, 0x20001
  s_mul_i32 s47, s47, 14
  s_add_u32 s44, s44, s47
  s_and_b32 s47, s2, 1
  s_lshl_b32 s48, s47, 1
  s_add_u32 s48, s48, s45
  s_mul_i32 s48, s48, 14336
  s_lshl_b32 s49, s44, 8
  s_add_u32 s48, s48, s49
  s_add_u32 s101, s48, 27918336
  s_lshl_b32 s47, s47, 2
  s_add_u32 s47, s47, s40
  s_mul_i32 s47, s47, 458752
  s_lshl_b32 s44, s44, 7
  s_add_u32 s100, s47, s44
  s_cmp_lt_u32 s46, 28
  s_cselect_b32 s3, 1, 0
  s_cmp_eq_u32 s41, 0
  s_cselect_b32 s3, s3, 0
  v_lshrrev_b32 v238, 3, v253
  v_mul_u32_u24 v238, 7168, v238
  v_and_b32 v239, 7, v253
  v_lshl_add_u32 v238, v239, 4, v238
  s_cmp_eq_u32 s3, 0
  s_cselect_b32 s43, 0x40000000, 0
  v_or_b32 v238, s43, v238
  v_lshlrev_b32 v239, 4, v253
  s_lshl_b32 s43, s2, 2
  s_add_u32 s43, s43, s40
  s_lshl_b32 s89, s43, 11
  s_mul_i32 s43, s46, 43
  s_lshr_b32 s43, s43, 8
  s_mul_i32 s43, s43, 6
  s_sub_u32 s43, s46, s43
  s_add_u32 s43, s43, 5
  s_cmp_eq_u32 s41, 0
  s_cselect_b32 s88, s43, 63
  s_mov_b32 s90, 0
  s_lshl_b32 s43, s58, 12
  v_add_u32 v132, s43, v112
  v_add_u32 v133, s43, v113
  v_and_b32 v128, 15, v253
  v_lshrrev_b32 v129, 4, v253
  v_cmp_eq_u32 vcc, 0, v128
  v_lshlrev_b32 v129, 4, v129
  v_mov_b32 v130, 0x40000000
  v_cndmask_b32 v136, v130, v129, vcc
  v_mov_b32 v156, 0x3f803f80
  v_mov_b32 v157, 0x3f803f80
  v_mov_b32 v158, 0x3f803f80
  v_mov_b32 v159, 0x3f803f80
  s_lshl_b32 s43, s40, 1
  s_add_u32 s43, s43, s71
  s_lshl_b32 s48, s43, 11
  s_lshl_b32 s43, s67, 7
  s_add_u32 s48, s48, s43
  s_add_u32 s48, s48, 27262976
  s_lshl_b32 s43, s51, 2
  s_lshl_b32 s44, s58, 1
  s_add_u32 s43, s43, s44
  s_add_u32 s43, s43, s57
  s_lshl_b32 s43, s43, 6
  s_mul_i32 s49, s67, 12288
  s_add_u32 s49, s49, s43
  s_add_u32 s49, s49, 27983872
  v_and_b32 v212, 15, v253
  v_lshrrev_b32 v213, 4, v253
  v_lshrrev_b32 v192, 2, v212
  v_cmp_eq_u32 vcc, v192, v213
  v_and_b32 v192, 3, v212
  v_lshlrev_b32 v212, 3, v212
  v_mov_b32 v213, 0x7ffffff0
  v_cndmask_b32 v212, v213, v212, vcc
  v_cmp_eq_u32 s[78:79], 1, v192
  v_cmp_eq_u32 s[80:81], 2, v192
  v_cmp_eq_u32 s[82:83], 3, v192
  v_mov_b32 v192, 0x3f803f80
  v_mov_b32 v193, 0x3f803f80
  v_mov_b32 v194, 0x3f803f80
  v_mov_b32 v195, 0x3f803f80
  s_add_u32 s44, s67, 1
  s_and_b32 s44, s44, 15
  s_mul_i32 s45, s44, s61
  s_add_u32 s68, s45, s59
  s_add_u32 m0, s62, 90112
  s_nop 0
  buffer_load_dwordx4 v120, s[28:31], s68 offen offset:0 sc1  lds
  buffer_load_dwordx4 v121, s[28:31], s68 offen offset:1024 sc1  lds
  buffer_load_dwordx4 v122, s[28:31], s68 offen offset:2048 sc1  lds
  buffer_load_dwordx4 v123, s[28:31], s68 offen offset:3072 sc1  lds
  s_waitcnt vmcnt(5)
  s_barrier
  ds_read_b64_tr_b16 a[40:41], v116 offset:0
  ds_read_b64_tr_b16 a[42:43], v116 offset:6144
  ds_read_b64_tr_b16 a[64:65], v116 offset:12288
  ds_read_b64_tr_b16 a[66:67], v116 offset:18432
  ds_read_b128 a[4:7], v112 offset:0
  ds_read_b128 a[24:27], v113 offset:0
  ds_read_b128 a[8:11], v112 offset:2048
  ds_read_b128 a[28:31], v113 offset:2048
  ds_read_b128 a[12:15], v112 offset:4096
  ds_read_b128 a[32:35], v113 offset:4096
  ds_read_b128 a[16:19], v112 offset:6144
  ds_read_b128 a[36:39], v113 offset:6144
  ds_read_b64_tr_b16 a[44:45], v117 offset:0
  ds_read_b64_tr_b16 a[46:47], v117 offset:6144
  ds_read_b64_tr_b16 a[68:69], v117 offset:12288
  ds_read_b64_tr_b16 a[70:71], v117 offset:18432
  ds_read_b128 a[0:3], v114 offset:0
  ds_read_b128 a[20:23], v115 offset:0
  ds_read_b64_tr_b16 a[48:49], v116 offset:2048
  ds_read_b64_tr_b16 a[50:51], v116 offset:8192
  ds_read_b64_tr_b16 a[72:73], v116 offset:14336
  ds_read_b64_tr_b16 a[74:75], v116 offset:20480
  ds_read_b64_tr_b16 a[52:53], v117 offset:2048
  ds_read_b64_tr_b16 a[54:55], v117 offset:8192
  ds_read_b64_tr_b16 a[76:77], v117 offset:14336
  ds_read_b64_tr_b16 a[78:79], v117 offset:20480
  ds_read_b64_tr_b16 a[56:57], v116 offset:4096
  ds_read_b64_tr_b16 a[58:59], v116 offset:10240
  ds_read_b64_tr_b16 a[80:81], v116 offset:16384
  ds_read_b64_tr_b16 a[82:83], v116 offset:22528
  ds_read_b64_tr_b16 a[60:61], v117 offset:4096
  ds_read_b64_tr_b16 a[62:63], v117 offset:10240
  ds_read_b64_tr_b16 a[84:85], v117 offset:16384
  ds_read_b64_tr_b16 a[86:87], v117 offset:22528
  ds_read_b128 v[140:143], v132 offset:0
  ds_read_b128 v[144:147], v133 offset:0
  ds_read_b128 v[148:151], v132 offset:2048
  ds_read_b128 v[152:155], v133 offset:2048
  s_add_u32 s44, s67, 1
  s_and_b32 s44, s44, 15
  s_mul_i32 s45, s44, 393216
  s_add_u32 s69, s45, s60
  s_add_u32 s70, s69, 4096
  s_add_u32 m0, s63, 24576
  s_nop 0
  buffer_load_dwordx4 v124, s[8:11], s69 offen offset:0  lds
  buffer_load_dwordx4 v125, s[8:11], s69 offen offset:1024  lds
  buffer_load_dwordx4 v124, s[8:11], s69 offen offset:2048  lds
  buffer_load_dwordx4 v125, s[8:11], s69 offen offset:3072  lds
  s_add_u32 m0, s63, 28672
  s_nop 0
  buffer_load_dwordx4 v124, s[8:11], s70 offen offset:0  lds
  buffer_load_dwordx4 v125, s[8:11], s70 offen offset:1024  lds
  s_waitcnt lgkmcnt(15)
  v_mfma_f32_16x16x32_bf16 v[0:3], a[40:43], a[4:7], 0
  s_add_u32 s44, s67, 2
  s_and_b32 s44, s44, 15
  s_mul_i32 s45, s44, 393216
  s_add_u32 s69, s45, s60
  s_add_u32 s70, s69, 4096
  s_add_u32 m0, s63, 49152
  s_nop 0
  v_mfma_f32_16x16x32_bf16 v[0:3], a[64:67], a[24:27], v[0:3]
  buffer_load_dwordx4 v124, s[8:11], s69 offen offset:0  lds
  v_mfma_f32_16x16x32_bf16 v[4:7], a[64:67], a[28:31], 0
  v_mfma_f32_16x16x32_bf16 v[4:7], a[40:43], a[8:11], v[4:7]
  buffer_load_dwordx4 v125, s[8:11], s69 offen offset:1024  lds
  v_mfma_f32_16x16x32_bf16 v[8:11], a[40:43], a[12:15], 0
  v_mfma_f32_16x16x32_bf16 v[8:11], a[64:67], a[32:35], v[8:11]
  v_mfma_f32_16x16x32_bf16 v[12:15], a[64:67], a[36:39], 0
  buffer_load_dwordx4 v124, s[8:11], s69 offen offset:2048  lds
  v_mfma_f32_16x16x32_bf16 v[12:15], a[40:43], a[16:19], v[12:15]
  v_mfma_f32_16x16x32_bf16 v[28:31], a[44:47], a[16:19], 0
  buffer_load_dwordx4 v125, s[8:11], s69 offen offset:3072  lds
  v_mfma_f32_16x16x32_bf16 v[28:31], a[68:71], a[36:39], v[28:31]
  s_add_u32 m0, s63, 53248
  s_nop 0
  v_mfma_f32_16x16x32_bf16 v[24:27], a[68:71], a[32:35], 0
  v_mfma_f32_16x16x32_bf16 v[24:27], a[44:47], a[12:15], v[24:27]
  buffer_load_dwordx4 v124, s[8:11], s70 offen offset:0  lds
  v_mfma_f32_16x16x32_bf16 v[20:23], a[44:47], a[8:11], 0
  v_mfma_f32_16x16x32_bf16 v[20:23], a[68:71], a[28:31], v[20:23]
  buffer_load_dwordx4 v125, s[8:11], s70 offen offset:1024  lds
  v_mfma_f32_16x16x32_bf16 v[16:19], a[68:71], a[24:27], 0
  s_add_u32 s44, s67, 2
  s_and_b32 s44, s44, 15
  s_mul_i32 s45, s44, s61
  s_add_u32 s68, s45, s59
  s_add_u32 m0, s62, 106496
  s_nop 0
  v_mfma_f32_16x16x32_bf16 v[16:19], a[44:47], a[4:7], v[16:19]
  v_mfma_f32_16x16x32_bf16 v[96:99], a[48:51], a[0:3], 0
  s_waitcnt vmcnt(6) lgkmcnt(0)
  s_barrier
  ds_read_b64_tr_b16 a[128:129], v116 offset:24576
  v_mfma_f32_16x16x32_bf16 v[96:99], a[72:75], a[20:23], v[96:99]
  ds_read_b64_tr_b16 a[130:131], v116 offset:30720
  buffer_load_dwordx4 v120, s[28:31], s68 offen offset:0 sc1  lds
  v_mfma_f32_16x16x32_bf16 v[32:35], a[72:75], a[24:27], 0
  ds_read_b64_tr_b16 a[152:153], v116 offset:36864
  v_mfma_f32_16x16x32_bf16 v[32:35], a[48:51], a[4:7], v[32:35]
  ds_read_b64_tr_b16 a[154:155], v116 offset:43008
  v_mfma_f32_16x16x32_bf16 v[36:39], a[48:51], a[8:11], 0
  ds_read_b128 a[92:95], v112 offset:16384
  buffer_load_dwordx4 v121, s[28:31], s68 offen offset:1024 sc1  lds
  v_mfma_f32_16x16x32_bf16 v[36:39], a[72:75], a[28:31], v[36:39]
  ds_read_b128 a[112:115], v113 offset:16384
  v_mfma_f32_16x16x32_bf16 v[40:43], a[72:75], a[32:35], 0
  ds_read_b128 a[96:99], v112 offset:18432
  buffer_load_dwordx4 v122, s[28:31], s68 offen offset:2048 sc1  lds
  v_mfma_f32_16x16x32_bf16 v[40:43], a[48:51], a[12:15], v[40:43]
  ds_read_b128 a[116:119], v113 offset:18432
  v_mfma_f32_16x16x32_bf16 v[44:47], a[48:51], a[16:19], 0
  ds_read_b128 a[100:103], v112 offset:20480
  v_mfma_f32_16x16x32_bf16 v[44:47], a[72:75], a[36:39], v[44:47]
  s_add_u32 s44, s67, s40
  ds_read_b128 a[120:123], v113 offset:20480
  buffer_load_dwordx4 v123, s[28:31], s68 offen offset:3072 sc1  lds
  s_add_u32 s44, s44, 4
  s_and_b32 s44, s44, 15
  s_mul_i32 s44, s44, s61
  s_lshl_b32 s45, s40, 10
  v_mfma_f32_16x16x32_bf16 v[60:63], a[76:79], a[36:39], 0
  s_add_u32 m0, s45, 126976
  s_add_u32 s44, s44, s73
  ds_read_b128 a[104:107], v112 offset:22528
  v_mfma_f32_16x16x32_bf16 v[60:63], a[52:55], a[16:19], v[60:63]
  ds_read_b128 a[124:127], v113 offset:22528
  v_mfma_f32_16x16x32_bf16 v[56:59], a[52:55], a[12:15], 0
  ds_read_b64_tr_b16 a[132:133], v117 offset:24576
  buffer_load_dwordx4 v126, s[28:31], s44 offen sc1 lds
  s_add_u32 s44, s67, s40
  s_add_u32 s44, s44, 8
  s_and_b32 s44, s44, 15
  s_mul_i32 s44, s44, s61
  s_lshl_b32 s45, s40, 10
  v_mfma_f32_16x16x32_bf16 v[56:59], a[76:79], a[32:35], v[56:59]
  s_add_u32 m0, s45, 131072
  s_add_u32 s44, s44, s73
  ds_read_b64_tr_b16 a[134:135], v117 offset:30720
  v_mfma_f32_16x16x32_bf16 v[160:163], a[40:43], v[156:159], 0
  ds_read_b64_tr_b16 a[156:157], v117 offset:36864
  v_mfma_f32_16x16x32_bf16 v[164:167], a[48:51], v[156:159], 0
  ds_read_b64_tr_b16 a[158:159], v117 offset:43008
  buffer_load_dwordx4 v126, s[28:31], s44 offen sc1 lds
  s_add_u32 s44, s67, s40
  s_add_u32 s44, s44, 12
  s_and_b32 s44, s44, 15
  s_mul_i32 s44, s44, s61
  s_lshl_b32 s45, s40, 10
  v_mfma_f32_16x16x32_bf16 v[168:171], a[56:59], v[156:159], 0
  s_add_u32 m0, s45, 135168
  s_add_u32 s44, s44, s73
  ds_read_b128 a[88:91], v114 offset:1024
  v_mfma_f32_16x16x32_bf16 v[160:163], a[64:67], v[156:159], v[160:163]
  ds_read_b128 a[108:111], v115 offset:1024
  buffer_load_dwordx4 v126, s[28:31], s44 offen sc1 lds
  s_add_u32 s44, s67, 3
  s_and_b32 s44, s44, 15
  s_mul_i32 s45, s44, s61
  s_add_u32 s68, s45, s59
  s_add_u32 m0, s62, 73728
  s_nop 0
  v_mfma_f32_16x16x32_bf16 v[164:167], a[72:75], v[156:159], v[164:167]
  ds_read_b64_tr_b16 a[136:137], v116 offset:26624
  v_mfma_f32_16x16x32_bf16 v[168:171], a[80:83], v[156:159], v[168:171]
  ds_read_b64_tr_b16 a[138:139], v116 offset:32768
  v_mfma_f32_16x16x32_bf16 v[208:211], v[148:151], v[148:151], 0
  ds_read_b64_tr_b16 a[160:161], v116 offset:38912
  buffer_load_dwordx4 v120, s[28:31], s68 offen offset:0 sc1  lds
  v_mfma_f32_16x16x32_bf16 v[204:207], v[192:195], v[148:151], 0
  ds_read_b64_tr_b16 a[162:163], v116 offset:45056
  v_mfma_f32_16x16x32_bf16 v[200:203], v[140:143], v[140:143], 0
  ds_read_b64_tr_b16 a[140:141], v117 offset:26624
  v_mfma_f32_16x16x32_bf16 v[196:199], v[192:195], v[140:143], 0
  ds_read_b64_tr_b16 a[142:143], v117 offset:32768
  buffer_load_dwordx4 v121, s[28:31], s68 offen offset:1024 sc1  lds
  v_mfma_f32_16x16x32_bf16 v[208:211], v[152:155], v[152:155], v[208:211]
  ds_read_b64_tr_b16 a[164:165], v117 offset:38912
  v_mfma_f32_16x16x32_bf16 v[204:207], v[192:195], v[152:155], v[204:207]
  ds_read_b64_tr_b16 a[166:167], v117 offset:45056
  v_mfma_f32_16x16x32_bf16 v[200:203], v[144:147], v[144:147], v[200:203]
  ds_read_b64_tr_b16 a[144:145], v116 offset:28672
  buffer_load_dwordx4 v122, s[28:31], s68 offen offset:2048 sc1  lds
  v_mfma_f32_16x16x32_bf16 v[196:199], v[192:195], v[144:147], v[196:199]
  ds_read_b64_tr_b16 a[146:147], v116 offset:34816
  v_mfma_f32_16x16x32_bf16 v[52:55], a[76:79], a[28:31], 0
  s_add_u32 s44, s67, 3
  ds_read_b64_tr_b16 a[168:169], v116 offset:40960
  buffer_load_dwordx4 v123, s[28:31], s68 offen offset:3072 sc1  lds
  s_and_b32 s44, s44, 15
  s_mul_i32 s45, s44, 393216
  s_add_u32 s69, s45, s60
  s_add_u32 s70, s69, 4096
  s_add_u32 m0, s63, 0
  s_nop 0
  v_mfma_f32_16x16x32_bf16 v[52:55], a[52:55], a[8:11], v[52:55]
  ds_read_b64_tr_b16 a[170:171], v116 offset:47104
  v_mfma_f32_16x16x32_bf16 v[48:51], a[52:55], a[4:7], 0
  ds_read_b64_tr_b16 a[148:149], v117 offset:28672
  v_mfma_f32_16x16x32_bf16 v[48:51], a[76:79], a[24:27], v[48:51]
  ds_read_b64_tr_b16 a[150:151], v117 offset:34816
  buffer_load_dwordx4 v124, s[8:11], s69 offen offset:0  lds
  v_mfma_f32_16x16x32_bf16 v[100:103], a[20:23], a[80:83], 0
  ds_read_b64_tr_b16 a[172:173], v117 offset:40960
  v_mfma_f32_16x16x32_bf16 v[100:103], a[0:3], a[56:59], v[100:103]
  ds_read_b64_tr_b16 a[174:175], v117 offset:47104
  v_mfma_f32_16x16x32_bf16 v[64:67], a[4:7], a[56:59], 0
  buffer_load_dwordx4 v125, s[8:11], s69 offen offset:1024  lds
  v_mfma_f32_16x16x32_bf16 v[64:67], a[24:27], a[80:83], v[64:67]
  v_cndmask_b32 v205, v208, v209, s[78:79]
  v_cndmask_b32 v205, v205, v210, s[80:81]
  v_cndmask_b32 v205, v205, v211, s[82:83]
  v_mfma_f32_16x16x32_bf16 v[68:71], a[28:31], a[80:83], 0
  buffer_store_dwordx2 v[204:205], v212, s[4:7], s48 offen offset:2048 sc1
  v_cndmask_b32 v197, v200, v201, s[78:79]
  v_mfma_f32_16x16x32_bf16 v[68:71], a[8:11], a[56:59], v[68:71]
  buffer_load_dwordx4 v124, s[8:11], s69 offen offset:2048  lds
  v_mfma_f32_16x16x32_bf16 v[72:75], a[12:15], a[56:59], 0
  v_cndmask_b32 v197, v197, v202, s[80:81]
  v_cndmask_b32 v197, v197, v203, s[82:83]
  v_mfma_f32_16x16x32_bf16 v[72:75], a[32:35], a[80:83], v[72:75]
  buffer_store_dwordx2 v[196:197], v212, s[4:7], s48 offen offset:0 sc1
  buffer_load_dwordx4 v125, s[8:11], s69 offen offset:3072  lds
  s_add_u32 m0, s63, 4096
  s_nop 0
  v_mfma_f32_16x16x32_bf16 v[76:79], a[36:39], a[80:83], 0
  buffer_store_dwordx4 v[160:163], v136, s[4:7], s49 offen sc1
  v_mfma_f32_16x16x32_bf16 v[76:79], a[16:19], a[56:59], v[76:79]
  s_add_u32 s49, s49, 4096
  buffer_store_dwordx4 v[164:167], v136, s[4:7], s49 offen sc1
  v_mfma_f32_16x16x32_bf16 v[92:95], a[16:19], a[60:63], 0
  s_add_u32 s49, s49, 4096
  buffer_load_dwordx4 v124, s[8:11], s70 offen offset:0  lds
  v_mfma_f32_16x16x32_bf16 v[92:95], a[36:39], a[84:87], v[92:95]
  buffer_store_dwordx4 v[168:171], v136, s[4:7], s49 offen sc1
  v_mfma_f32_16x16x32_bf16 v[88:91], a[32:35], a[84:87], 0
  s_add_u32 s49, s49, 4096
  v_mfma_f32_16x16x32_bf16 v[88:91], a[12:15], a[60:63], v[88:91]
  buffer_load_dwordx4 v125, s[8:11], s70 offen offset:1024  lds
  v_mfma_f32_16x16x32_bf16 v[84:87], a[8:11], a[60:63], 0
  v_mfma_f32_16x16x32_bf16 v[84:87], a[28:31], a[84:87], v[84:87]
  v_mfma_f32_16x16x32_bf16 v[80:83], a[24:27], a[84:87], 0
  v_mfma_f32_16x16x32_bf16 v[80:83], a[4:7], a[60:63], v[80:83]
  s_add_u32 s44, s67, 4
  s_and_b32 s44, s44, 15
  s_mul_i32 s45, s44, s61
  s_add_u32 s68, s45, s59
  s_mov_b32 s66, 5
  s_mov_b32 s56, 2
  s_cmp_eq_u32 s66, s88
  s_cbranch_scc1 Lside_k9_c
Lside_k9_r:
  s_branch Lp1_u1
  s_branch Lp1_common
Llayer:
  s_cmp_lg_u32 s40, 0
  s_cbranch_scc1 Lpdn2
  s_mov_b32 s43, 0x40000
  s_mov_b64 exec, 3
Lpol1:
  v_mov_b32 v250, 0
  buffer_atomic_add v250, v249, s[4:7], s77 offen sc0 sc1
  s_waitcnt vmcnt(0)
  v_cmp_gt_u32 vcc, 16, v250
  s_cbranch_vccz Lpdn2x
  s_sub_u32 s43, s43, 1
  s_cmp_lg_u32 s43, 0
  s_cbranch_scc1 Lpol1
Lpdn2x:
  s_mov_b64 exec, -1
  s_add_u32 s44, s67, 2
  s_and_b32 s44, s44, 15
  s_mul_i32 s45, s44, 393216
  s_add_u32 s69, s45, s60
  s_add_u32 s70, s69, 4096
  s_add_u32 m0, s63, 49152
  s_nop 0
  buffer_load_dwordx4 v124, s[8:11], s69 offen offset:0  lds
  buffer_load_dwordx4 v125, s[8:11], s69 offen offset:1024  lds
  buffer_load_dwordx4 v124, s[8:11], s69 offen offset:2048  lds
  buffer_load_dwordx4 v125, s[8:11], s69 offen offset:3072  lds
  s_add_u32 m0, s63, 53248
  s_nop 0
  buffer_load_dwordx4 v124, s[8:11], s70 offen offset:0  lds
  buffer_load_dwordx4 v125, s[8:11], s70 offen offset:1024  lds
Lpdn2:
  s_waitcnt vmcnt(6) lgkmcnt(0)
  s_barrier
  s_add_u32 s44, s67, 0
  s_and_b32 s44, s44, 15
  s_mul_i32 s45, s44, s61
  s_add_u32 s68, s45, s59
  s_add_u32 m0, s62, 73728
  s_nop 0
  buffer_load_dwordx4 v120, s[28:31], s68 offen offset:0 sc1  lds
  buffer_load_dwordx4 v121, s[28:31], s68 offen offset:1024 sc1  lds
  buffer_load_dwordx4 v122, s[28:31], s68 offen offset:2048 sc1  lds
  buffer_load_dwordx4 v123, s[28:31], s68 offen offset:3072 sc1  lds
  s_add_u32 s44, s67, s40
  s_add_u32 s44, s44, 0
  s_and_b32 s44, s44, 15
  s_mul_i32 s44, s44, s61
  s_lshl_b32 s45, s40, 10
  s_add_u32 m0, s45, 122880
  s_add_u32 s44, s44, s73
  buffer_load_dwordx4 v126, s[28:31], s44 offen sc1 lds
  s_add_u32 s44, s67, 1
  s_and_b32 s44, s44, 15
  s_mul_i32 s45, s44, s61
  s_add_u32 s68, s45, s59
  s_add_u32 m0, s62, 90112
  s_nop 0
  buffer_load_dwordx4 v120, s[28:31], s68 offen offset:0 sc1  lds
  buffer_load_dwordx4 v121, s[28:31], s68 offen offset:1024 sc1  lds
  buffer_load_dwordx4 v122, s[28:31], s68 offen offset:2048 sc1  lds
  buffer_load_dwordx4 v123, s[28:31], s68 offen offset:3072 sc1  lds
  ds_read_b64_tr_b16 a[40:41], v116 offset:0
  ds_read_b64_tr_b16 a[42:43], v116 offset:6144
  ds_read_b64_tr_b16 a[64:65], v116 offset:12288
  ds_read_b64_tr_b16 a[66:67], v116 offset:18432
  ds_read_b64_tr_b16 a[44:45], v117 offset:0
  ds_read_b64_tr_b16 a[46:47], v117 offset:6144
  ds_read_b64_tr_b16 a[68:69], v117 offset:12288
  ds_read_b64_tr_b16 a[70:71], v117 offset:18432
  ds_read_b64_tr_b16 a[48:49], v116 offset:2048
  ds_read_b64_tr_b16 a[50:51], v116 offset:8192
  ds_read_b64_tr_b16 a[72:73], v116 offset:14336
  ds_read_b64_tr_b16 a[74:75], v116 offset:20480
  ds_read_b64_tr_b16 a[52:53], v117 offset:2048
  ds_read_b64_tr_b16 a[54:55], v117 offset:8192
  ds_read_b64_tr_b16 a[76:77], v117 offset:14336
  ds_read_b64_tr_b16 a[78:79], v117 offset:20480
  ds_read_b64_tr_b16 a[56:57], v116 offset:4096
  ds_read_b64_tr_b16 a[58:59], v116 offset:10240
  ds_read_b64_tr_b16 a[80:81], v116 offset:16384
  ds_read_b64_tr_b16 a[82:83], v116 offset:22528
  ds_read_b64_tr_b16 a[60:61], v117 offset:4096
  ds_read_b64_tr_b16 a[62:63], v117 offset:10240
  ds_read_b64_tr_b16 a[84:85], v117 offset:16384
  ds_read_b64_tr_b16 a[86:87], v117 offset:22528
  s_waitcnt vmcnt(4)
  s_barrier
  ds_read_b128 a[4:7], v112 offset:0
  ds_read_b128 a[24:27], v113 offset:0
  ds_read_b128 a[8:11], v112 offset:2048
  ds_read_b128 a[28:31], v113 offset:2048
  ds_read_b128 a[12:15], v112 offset:4096
  ds_read_b128 a[32:35], v113 offset:4096
  ds_read_b128 a[16:19], v112 offset:6144
  ds_read_b128 a[36:39], v113 offset:6144
  ds_read_b128 a[0:3], v114 offset:0
  ds_read_b128 a[20:23], v115 offset:0
  s_add_u32 s44, s67, s40
  s_add_u32 s44, s44, 4
  s_and_b32 s44, s44, 15
  s_mul_i32 s44, s44, s61
  s_lshl_b32 s45, s40, 10
  s_add_u32 m0, s45, 126976
  s_add_u32 s44, s44, s73
  buffer_load_dwordx4 v126, s[28:31], s44 offen sc1 lds
  s_add_u32 s44, s67, s40
  s_add_u32 s44, s44, 8
  s_and_b32 s44, s44, 15
  s_mul_i32 s44, s44, s61
  s_lshl_b32 s45, s40, 10
  s_add_u32 m0, s45, 131072
  s_add_u32 s44, s44, s73
  buffer_load_dwordx4 v126, s[28:31], s44 offen sc1 lds
  s_add_u32 s44, s67, s40
  s_add_u32 s44, s44, 12
  s_and_b32 s44, s44, 15
  s_mul_i32 s44, s44, s61
  s_lshl_b32 s45, s40, 10
  s_add_u32 m0, s45, 135168
  s_add_u32 s44, s44, s73
  buffer_load_dwordx4 v126, s[28:31], s44 offen sc1 lds
  s_add_u32 s44, s67, 2
  s_and_b32 s44, s44, 15
  s_mul_i32 s45, s44, s61
  s_add_u32 s68, s45, s59
  s_add_u32 m0, s62, 106496
  s_nop 0
  buffer_load_dwordx4 v120, s[28:31], s68 offen offset:0 sc1  lds
  buffer_load_dwordx4 v121, s[28:31], s68 offen offset:1024 sc1  lds
  buffer_load_dwordx4 v122, s[28:31], s68 offen offset:2048 sc1  lds
  buffer_load_dwordx4 v123, s[28:31], s68 offen offset:3072 sc1  lds
  s_waitcnt lgkmcnt(0)
Lp1_common:
  s_mov_b32 s66, 4
  s_add_u32 s44, s67, 3
  s_and_b32 s44, s44, 15
  s_mul_i32 s45, s44, s61
  s_add_u32 s68, s45, s59
  s_mov_b32 s56, 2
.p2align 3
Lp1_loop:
  s_waitcnt lgkmcnt(15)
  v_mfma_f32_16x16x32_bf16 v[0:3], a[40:43], a[4:7], v[0:3]
  s_mul_i32 s45, s44, 393216
  v_mfma_f32_16x16x32_bf16 v[0:3], a[64:67], a[24:27], v[0:3]
  s_add_u32 s69, s45, s60
  v_mfma_f32_16x16x32_bf16 v[4:7], a[64:67], a[28:31], v[4:7]
  s_add_u32 s70, s69, 4096
  v_mfma_f32_16x16x32_bf16 v[4:7], a[40:43], a[8:11], v[4:7]
  v_mfma_f32_16x16x32_bf16 v[8:11], a[40:43], a[12:15], v[8:11]
  s_waitcnt vmcnt(7) lgkmcnt(0)
  s_barrier
  ds_read_b64_tr_b16 a[128:129], v116 offset:24576
  v_mfma_f32_16x16x32_bf16 v[8:11], a[64:67], a[32:35], v[8:11]
  ds_read_b64_tr_b16 a[130:131], v116 offset:30720
  v_mfma_f32_16x16x32_bf16 v[12:15], a[64:67], a[36:39], v[12:15]
  s_add_u32 m0, s62, 73728
  ds_read_b64_tr_b16 a[152:153], v116 offset:36864
  v_mfma_f32_16x16x32_bf16 v[12:15], a[40:43], a[16:19], v[12:15]
  buffer_load_dwordx4 v120, s[28:31], s68 offen offset:0 sc1  lds
  v_mfma_f32_16x16x32_bf16 v[28:31], a[44:47], a[16:19], v[28:31]
  ds_read_b64_tr_b16 a[154:155], v116 offset:43008
  v_mfma_f32_16x16x32_bf16 v[28:31], a[68:71], a[36:39], v[28:31]
  ds_read_b128 a[92:95], v112 offset:16384
  v_mfma_f32_16x16x32_bf16 v[24:27], a[68:71], a[32:35], v[24:27]
  ds_read_b128 a[112:115], v113 offset:16384
  v_mfma_f32_16x16x32_bf16 v[24:27], a[44:47], a[12:15], v[24:27]
  buffer_load_dwordx4 v121, s[28:31], s68 offen offset:1024 sc1  lds
  v_mfma_f32_16x16x32_bf16 v[20:23], a[44:47], a[8:11], v[20:23]
  ds_read_b128 a[96:99], v112 offset:18432
  v_mfma_f32_16x16x32_bf16 v[20:23], a[68:71], a[28:31], v[20:23]
  ds_read_b128 a[116:119], v113 offset:18432
  v_mfma_f32_16x16x32_bf16 v[16:19], a[68:71], a[24:27], v[16:19]
  ds_read_b128 a[100:103], v112 offset:20480
  v_mfma_f32_16x16x32_bf16 v[16:19], a[44:47], a[4:7], v[16:19]
  buffer_load_dwordx4 v122, s[28:31], s68 offen offset:2048 sc1  lds
  v_mfma_f32_16x16x32_bf16 v[96:99], a[48:51], a[0:3], v[96:99]
  ds_read_b128 a[120:123], v113 offset:20480
  v_mfma_f32_16x16x32_bf16 v[96:99], a[72:75], a[20:23], v[96:99]
  ds_read_b128 a[104:107], v112 offset:22528
  v_mfma_f32_16x16x32_bf16 v[32:35], a[72:75], a[24:27], v[32:35]
  ds_read_b128 a[124:127], v113 offset:22528
  v_mfma_f32_16x16x32_bf16 v[32:35], a[48:51], a[4:7], v[32:35]
  buffer_load_dwordx4 v123, s[28:31], s68 offen offset:3072 sc1  lds
  v_mfma_f32_16x16x32_bf16 v[36:39], a[48:51], a[8:11], v[36:39]
  ds_read_b64_tr_b16 a[132:133], v117 offset:24576
  v_mfma_f32_16x16x32_bf16 v[36:39], a[72:75], a[28:31], v[36:39]
  ds_read_b64_tr_b16 a[134:135], v117 offset:30720
  v_mfma_f32_16x16x32_bf16 v[40:43], a[72:75], a[32:35], v[40:43]
  s_add_u32 m0, s63, 0
  ds_read_b64_tr_b16 a[156:157], v117 offset:36864
  v_mfma_f32_16x16x32_bf16 v[40:43], a[48:51], a[12:15], v[40:43]
  buffer_load_dwordx4 v124, s[8:11], s69 offen offset:0  lds
  v_mfma_f32_16x16x32_bf16 v[44:47], a[48:51], a[16:19], v[44:47]
  s_add_u32 s44, s44, 1
  ds_read_b64_tr_b16 a[158:159], v117 offset:43008
  v_mfma_f32_16x16x32_bf16 v[44:47], a[72:75], a[36:39], v[44:47]
  s_and_b32 s44, s44, 15
  ds_read_b128 a[88:91], v114 offset:1024
  v_mfma_f32_16x16x32_bf16 v[60:63], a[76:79], a[36:39], v[60:63]
  s_add_u32 s66, s66, 1
  ds_read_b128 a[108:111], v115 offset:1024
  v_mfma_f32_16x16x32_bf16 v[60:63], a[52:55], a[16:19], v[60:63]
  s_mul_i32 s45, s44, s61
  buffer_load_dwordx4 v125, s[8:11], s69 offen offset:1024  lds
  v_mfma_f32_16x16x32_bf16 v[56:59], a[52:55], a[12:15], v[56:59]
  s_add_u32 s68, s45, s59
  ds_read_b64_tr_b16 a[136:137], v116 offset:26624
  v_mfma_f32_16x16x32_bf16 v[56:59], a[76:79], a[32:35], v[56:59]
  ds_read_b64_tr_b16 a[138:139], v116 offset:32768
  v_mfma_f32_16x16x32_bf16 v[52:55], a[76:79], a[28:31], v[52:55]
  ds_read_b64_tr_b16 a[160:161], v116 offset:38912
  v_mfma_f32_16x16x32_bf16 v[52:55], a[52:55], a[8:11], v[52:55]
  buffer_load_dwordx4 v124, s[8:11], s69 offen offset:2048  lds
  v_mfma_f32_16x16x32_bf16 v[48:51], a[52:55], a[4:7], v[48:51]
  ds_read_b64_tr_b16 a[162:163], v116 offset:45056
  v_mfma_f32_16x16x32_bf16 v[48:51], a[76:79], a[24:27], v[48:51]
  ds_read_b64_tr_b16 a[140:141], v117 offset:26624
  v_mfma_f32_16x16x32_bf16 v[100:103], a[20:23], a[80:83], v[100:103]
  ds_read_b64_tr_b16 a[142:143], v117 offset:32768
  v_mfma_f32_16x16x32_bf16 v[100:103], a[0:3], a[56:59], v[100:103]
  buffer_load_dwordx4 v125, s[8:11], s69 offen offset:3072  lds
  v_mfma_f32_16x16x32_bf16 v[64:67], a[4:7], a[56:59], v[64:67]
  ds_read_b64_tr_b16 a[164:165], v117 offset:38912
  v_mfma_f32_16x16x32_bf16 v[64:67], a[24:27], a[80:83], v[64:67]
  ds_read_b64_tr_b16 a[166:167], v117 offset:45056
  v_mfma_f32_16x16x32_bf16 v[68:71], a[28:31], a[80:83], v[68:71]
  s_add_u32 m0, s63, 4096
  ds_read_b64_tr_b16 a[144:145], v116 offset:28672
  v_mfma_f32_16x16x32_bf16 v[68:71], a[8:11], a[56:59], v[68:71]
  buffer_load_dwordx4 v124, s[8:11], s70 offen offset:0  lds
  v_mfma_f32_16x16x32_bf16 v[72:75], a[12:15], a[56:59], v[72:75]
  ds_read_b64_tr_b16 a[146:147], v116 offset:34816
  v_mfma_f32_16x16x32_bf16 v[72:75], a[32:35], a[80:83], v[72:75]
  ds_read_b64_tr_b16 a[168:169], v116 offset:40960
  v_mfma_f32_16x16x32_bf16 v[76:79], a[36:39], a[80:83], v[76:79]
  ds_read_b64_tr_b16 a[170:171], v116 offset:47104
  v_mfma_f32_16x16x32_bf16 v[76:79], a[16:19], a[56:59], v[76:79]
  buffer_load_dwordx4 v125, s[8:11], s70 offen offset:1024  lds
  v_mfma_f32_16x16x32_bf16 v[92:95], a[16:19], a[60:63], v[92:95]
  ds_read_b64_tr_b16 a[148:149], v117 offset:28672
  v_mfma_f32_16x16x32_bf16 v[92:95], a[36:39], a[84:87], v[92:95]
  ds_read_b64_tr_b16 a[150:151], v117 offset:34816
  v_mfma_f32_16x16x32_bf16 v[88:91], a[32:35], a[84:87], v[88:91]
  ds_read_b64_tr_b16 a[172:173], v117 offset:40960
  v_mfma_f32_16x16x32_bf16 v[88:91], a[12:15], a[60:63], v[88:91]
  ds_read_b64_tr_b16 a[174:175], v117 offset:47104
  v_mfma_f32_16x16x32_bf16 v[84:87], a[8:11], a[60:63], v[84:87]
  s_cmp_eq_u32 s66, s88
  s_cbranch_scc1 Lside_k0_c
Lside_k0_r:
  v_mfma_f32_16x16x32_bf16 v[84:87], a[28:31], a[84:87], v[84:87]
  v_mfma_f32_16x16x32_bf16 v[80:83], a[24:27], a[84:87], v[80:83]
  v_mfma_f32_16x16x32_bf16 v[80:83], a[4:7], a[60:63], v[80:83]
Lp1_u1:
  s_waitcnt lgkmcnt(15)
  v_mfma_f32_16x16x32_bf16 v[0:3], a[128:131], a[92:95], v[0:3]
  s_mul_i32 s45, s44, 393216
  v_mfma_f32_16x16x32_bf16 v[0:3], a[152:155], a[112:115], v[0:3]
  s_add_u32 s69, s45, s60
  v_mfma_f32_16x16x32_bf16 v[4:7], a[152:155], a[116:119], v[4:7]
  s_add_u32 s70, s69, 4096
  v_mfma_f32_16x16x32_bf16 v[4:7], a[128:131], a[96:99], v[4:7]
  v_mfma_f32_16x16x32_bf16 v[8:11], a[128:131], a[100:103], v[8:11]
  s_waitcnt vmcnt(10) lgkmcnt(0)
  s_barrier
  ds_read_b64_tr_b16 a[40:41], v118 offset:0
  v_mfma_f32_16x16x32_bf16 v[8:11], a[152:155], a[120:123], v[8:11]
  ds_read_b64_tr_b16 a[42:43], v118 offset:6144
  v_mfma_f32_16x16x32_bf16 v[12:15], a[152:155], a[124:127], v[12:15]
  s_add_u32 m0, s62, 90112
  ds_read_b64_tr_b16 a[64:65], v118 offset:12288
  v_mfma_f32_16x16x32_bf16 v[12:15], a[128:131], a[104:107], v[12:15]
  buffer_load_dwordx4 v120, s[28:31], s68 offen offset:0 sc1  lds
  v_mfma_f32_16x16x32_bf16 v[28:31], a[132:135], a[104:107], v[28:31]
  ds_read_b64_tr_b16 a[66:67], v118 offset:18432
  v_mfma_f32_16x16x32_bf16 v[28:31], a[156:159], a[124:127], v[28:31]
  ds_read_b128 a[4:7], v112 offset:32768
  v_mfma_f32_16x16x32_bf16 v[24:27], a[156:159], a[120:123], v[24:27]
  ds_read_b128 a[24:27], v113 offset:32768
  v_mfma_f32_16x16x32_bf16 v[24:27], a[132:135], a[100:103], v[24:27]
  buffer_load_dwordx4 v121, s[28:31], s68 offen offset:1024 sc1  lds
  v_mfma_f32_16x16x32_bf16 v[20:23], a[132:135], a[96:99], v[20:23]
  ds_read_b128 a[8:11], v112 offset:34816
  v_mfma_f32_16x16x32_bf16 v[20:23], a[156:159], a[116:119], v[20:23]
  ds_read_b128 a[28:31], v113 offset:34816
  v_mfma_f32_16x16x32_bf16 v[16:19], a[156:159], a[112:115], v[16:19]
  ds_read_b128 a[12:15], v112 offset:36864
  v_mfma_f32_16x16x32_bf16 v[16:19], a[132:135], a[92:95], v[16:19]
  buffer_load_dwordx4 v122, s[28:31], s68 offen offset:2048 sc1  lds
  v_mfma_f32_16x16x32_bf16 v[96:99], a[136:139], a[88:91], v[96:99]
  ds_read_b128 a[32:35], v113 offset:36864
  v_mfma_f32_16x16x32_bf16 v[96:99], a[160:163], a[108:111], v[96:99]
  ds_read_b128 a[16:19], v112 offset:38912
  v_mfma_f32_16x16x32_bf16 v[32:35], a[160:163], a[112:115], v[32:35]
  ds_read_b128 a[36:39], v113 offset:38912
  v_mfma_f32_16x16x32_bf16 v[32:35], a[136:139], a[92:95], v[32:35]
  buffer_load_dwordx4 v123, s[28:31], s68 offen offset:3072 sc1  lds
  v_mfma_f32_16x16x32_bf16 v[36:39], a[136:139], a[96:99], v[36:39]
  ds_read_b64_tr_b16 a[44:45], v119 offset:0
  v_mfma_f32_16x16x32_bf16 v[36:39], a[160:163], a[116:119], v[36:39]
  ds_read_b64_tr_b16 a[46:47], v119 offset:6144
  v_mfma_f32_16x16x32_bf16 v[40:43], a[160:163], a[120:123], v[40:43]
  s_add_u32 m0, s63, 24576
  ds_read_b64_tr_b16 a[68:69], v119 offset:12288
  v_mfma_f32_16x16x32_bf16 v[40:43], a[136:139], a[100:103], v[40:43]
  buffer_load_dwordx4 v124, s[8:11], s69 offen offset:0  lds
  v_mfma_f32_16x16x32_bf16 v[44:47], a[136:139], a[104:107], v[44:47]
  s_add_u32 s44, s44, 1
  ds_read_b64_tr_b16 a[70:71], v119 offset:18432
  v_mfma_f32_16x16x32_bf16 v[44:47], a[160:163], a[124:127], v[44:47]
  s_and_b32 s44, s44, 15
  ds_read_b128 a[0:3], v114 offset:2048
  v_mfma_f32_16x16x32_bf16 v[60:63], a[164:167], a[124:127], v[60:63]
  s_add_u32 s66, s66, 1
  ds_read_b128 a[20:23], v115 offset:2048
  v_mfma_f32_16x16x32_bf16 v[60:63], a[140:143], a[104:107], v[60:63]
  s_mul_i32 s45, s44, s61
  buffer_load_dwordx4 v125, s[8:11], s69 offen offset:1024  lds
  v_mfma_f32_16x16x32_bf16 v[56:59], a[140:143], a[100:103], v[56:59]
  s_add_u32 s68, s45, s59
  ds_read_b64_tr_b16 a[48:49], v118 offset:2048
  v_mfma_f32_16x16x32_bf16 v[56:59], a[164:167], a[120:123], v[56:59]
  ds_read_b64_tr_b16 a[50:51], v118 offset:8192
  v_mfma_f32_16x16x32_bf16 v[52:55], a[164:167], a[116:119], v[52:55]
  ds_read_b64_tr_b16 a[72:73], v118 offset:14336
  v_mfma_f32_16x16x32_bf16 v[52:55], a[140:143], a[96:99], v[52:55]
  buffer_load_dwordx4 v124, s[8:11], s69 offen offset:2048  lds
  v_mfma_f32_16x16x32_bf16 v[48:51], a[140:143], a[92:95], v[48:51]
  ds_read_b64_tr_b16 a[74:75], v118 offset:20480
  v_mfma_f32_16x16x32_bf16 v[48:51], a[164:167], a[112:115], v[48:51]
  ds_read_b64_tr_b16 a[52:53], v119 offset:2048
  v_mfma_f32_16x16x32_bf16 v[100:103], a[108:111], a[168:171], v[100:103]
  ds_read_b64_tr_b16 a[54:55], v119 offset:8192
  v_mfma_f32_16x16x32_bf16 v[100:103], a[88:91], a[144:147], v[100:103]
  buffer_load_dwordx4 v125, s[8:11], s69 offen offset:3072  lds
  v_mfma_f32_16x16x32_bf16 v[64:67], a[92:95], a[144:147], v[64:67]
  ds_read_b64_tr_b16 a[76:77], v119 offset:14336
  v_mfma_f32_16x16x32_bf16 v[64:67], a[112:115], a[168:171], v[64:67]
  ds_read_b64_tr_b16 a[78:79], v119 offset:20480
  v_mfma_f32_16x16x32_bf16 v[68:71], a[116:119], a[168:171], v[68:71]
  s_add_u32 m0, s63, 28672
  ds_read_b64_tr_b16 a[56:57], v118 offset:4096
  v_mfma_f32_16x16x32_bf16 v[68:71], a[96:99], a[144:147], v[68:71]
  buffer_load_dwordx4 v124, s[8:11], s70 offen offset:0  lds
  v_mfma_f32_16x16x32_bf16 v[72:75], a[100:103], a[144:147], v[72:75]
  ds_read_b64_tr_b16 a[58:59], v118 offset:10240
  v_mfma_f32_16x16x32_bf16 v[72:75], a[120:123], a[168:171], v[72:75]
  ds_read_b64_tr_b16 a[80:81], v118 offset:16384
  v_mfma_f32_16x16x32_bf16 v[76:79], a[124:127], a[168:171], v[76:79]
  ds_read_b64_tr_b16 a[82:83], v118 offset:22528
  v_mfma_f32_16x16x32_bf16 v[76:79], a[104:107], a[144:147], v[76:79]
  buffer_load_dwordx4 v125, s[8:11], s70 offen offset:1024  lds
  v_mfma_f32_16x16x32_bf16 v[92:95], a[104:107], a[148:151], v[92:95]
  ds_read_b64_tr_b16 a[60:61], v119 offset:4096
  v_mfma_f32_16x16x32_bf16 v[92:95], a[124:127], a[172:175], v[92:95]
  ds_read_b64_tr_b16 a[62:63], v119 offset:10240
  v_mfma_f32_16x16x32_bf16 v[88:91], a[120:123], a[172:175], v[88:91]
  ds_read_b64_tr_b16 a[84:85], v119 offset:16384
  v_mfma_f32_16x16x32_bf16 v[88:91], a[100:103], a[148:151], v[88:91]
  ds_read_b64_tr_b16 a[86:87], v119 offset:22528
  v_mfma_f32_16x16x32_bf16 v[84:87], a[96:99], a[148:151], v[84:87]
  s_cmp_eq_u32 s66, s88
  s_cbranch_scc1 Lside_k1_c
Lside_k1_r:
  v_mfma_f32_16x16x32_bf16 v[84:87], a[116:119], a[172:175], v[84:87]
  v_mfma_f32_16x16x32_bf16 v[80:83], a[112:115], a[172:175], v[80:83]
  v_mfma_f32_16x16x32_bf16 v[80:83], a[92:95], a[148:151], v[80:83]
  s_waitcnt lgkmcnt(15)
  v_mfma_f32_16x16x32_bf16 v[0:3], a[40:43], a[4:7], v[0:3]
  s_mul_i32 s45, s44, 393216
  v_mfma_f32_16x16x32_bf16 v[0:3], a[64:67], a[24:27], v[0:3]
  s_add_u32 s69, s45, s60
  v_mfma_f32_16x16x32_bf16 v[4:7], a[64:67], a[28:31], v[4:7]
  s_add_u32 s70, s69, 4096
  v_mfma_f32_16x16x32_bf16 v[4:7], a[40:43], a[8:11], v[4:7]
  v_mfma_f32_16x16x32_bf16 v[8:11], a[40:43], a[12:15], v[8:11]
  s_waitcnt vmcnt(10) lgkmcnt(0)
  s_barrier
  ds_read_b64_tr_b16 a[128:129], v116 offset:0
  v_mfma_f32_16x16x32_bf16 v[8:11], a[64:67], a[32:35], v[8:11]
  ds_read_b64_tr_b16 a[130:131], v116 offset:6144
  v_mfma_f32_16x16x32_bf16 v[12:15], a[64:67], a[36:39], v[12:15]
  s_add_u32 m0, s62, 106496
  ds_read_b64_tr_b16 a[152:153], v116 offset:12288
  v_mfma_f32_16x16x32_bf16 v[12:15], a[40:43], a[16:19], v[12:15]
  buffer_load_dwordx4 v120, s[28:31], s68 offen offset:0 sc1  lds
  v_mfma_f32_16x16x32_bf16 v[28:31], a[44:47], a[16:19], v[28:31]
  ds_read_b64_tr_b16 a[154:155], v116 offset:18432
  v_mfma_f32_16x16x32_bf16 v[28:31], a[68:71], a[36:39], v[28:31]
  ds_read_b128 a[92:95], v112 offset:0
  v_mfma_f32_16x16x32_bf16 v[24:27], a[68:71], a[32:35], v[24:27]
  ds_read_b128 a[112:115], v113 offset:0
  v_mfma_f32_16x16x32_bf16 v[24:27], a[44:47], a[12:15], v[24:27]
  buffer_load_dwordx4 v121, s[28:31], s68 offen offset:1024 sc1  lds
  v_mfma_f32_16x16x32_bf16 v[20:23], a[44:47], a[8:11], v[20:23]
  ds_read_b128 a[96:99], v112 offset:2048
  v_mfma_f32_16x16x32_bf16 v[20:23], a[68:71], a[28:31], v[20:23]
  ds_read_b128 a[116:119], v113 offset:2048
  v_mfma_f32_16x16x32_bf16 v[16:19], a[68:71], a[24:27], v[16:19]
  ds_read_b128 a[100:103], v112 offset:4096
  v_mfma_f32_16x16x32_bf16 v[16:19], a[44:47], a[4:7], v[16:19]
  buffer_load_dwordx4 v122, s[28:31], s68 offen offset:2048 sc1  lds
  v_mfma_f32_16x16x32_bf16 v[96:99], a[48:51], a[0:3], v[96:99]
  ds_read_b128 a[120:123], v113 offset:4096
  v_mfma_f32_16x16x32_bf16 v[96:99], a[72:75], a[20:23], v[96:99]
  ds_read_b128 a[104:107], v112 offset:6144
  v_mfma_f32_16x16x32_bf16 v[32:35], a[72:75], a[24:27], v[32:35]
  ds_read_b128 a[124:127], v113 offset:6144
  v_mfma_f32_16x16x32_bf16 v[32:35], a[48:51], a[4:7], v[32:35]
  buffer_load_dwordx4 v123, s[28:31], s68 offen offset:3072 sc1  lds
  v_mfma_f32_16x16x32_bf16 v[36:39], a[48:51], a[8:11], v[36:39]
  ds_read_b64_tr_b16 a[132:133], v117 offset:0
  v_mfma_f32_16x16x32_bf16 v[36:39], a[72:75], a[28:31], v[36:39]
  ds_read_b64_tr_b16 a[134:135], v117 offset:6144
  v_mfma_f32_16x16x32_bf16 v[40:43], a[72:75], a[32:35], v[40:43]
  s_add_u32 m0, s63, 49152
  ds_read_b64_tr_b16 a[156:157], v117 offset:12288
  v_mfma_f32_16x16x32_bf16 v[40:43], a[48:51], a[12:15], v[40:43]
  buffer_load_dwordx4 v124, s[8:11], s69 offen offset:0  lds
  v_mfma_f32_16x16x32_bf16 v[44:47], a[48:51], a[16:19], v[44:47]
  s_add_u32 s44, s44, 1
  ds_read_b64_tr_b16 a[158:159], v117 offset:18432
  v_mfma_f32_16x16x32_bf16 v[44:47], a[72:75], a[36:39], v[44:47]
  s_and_b32 s44, s44, 15
  ds_read_b128 a[88:91], v114 offset:3072
  v_mfma_f32_16x16x32_bf16 v[60:63], a[76:79], a[36:39], v[60:63]
  s_add_u32 s66, s66, 1
  ds_read_b128 a[108:111], v115 offset:3072
  v_mfma_f32_16x16x32_bf16 v[60:63], a[52:55], a[16:19], v[60:63]
  s_mul_i32 s45, s44, s61
  buffer_load_dwordx4 v125, s[8:11], s69 offen offset:1024  lds
  v_mfma_f32_16x16x32_bf16 v[56:59], a[52:55], a[12:15], v[56:59]
  s_add_u32 s68, s45, s59
  ds_read_b64_tr_b16 a[136:137], v116 offset:2048
  v_mfma_f32_16x16x32_bf16 v[56:59], a[76:79], a[32:35], v[56:59]
  ds_read_b64_tr_b16 a[138:139], v116 offset:8192
  v_mfma_f32_16x16x32_bf16 v[52:55], a[76:79], a[28:31], v[52:55]
  ds_read_b64_tr_b16 a[160:161], v116 offset:14336
  v_mfma_f32_16x16x32_bf16 v[52:55], a[52:55], a[8:11], v[52:55]
  buffer_load_dwordx4 v124, s[8:11], s69 offen offset:2048  lds
  v_mfma_f32_16x16x32_bf16 v[48:51], a[52:55], a[4:7], v[48:51]
  ds_read_b64_tr_b16 a[162:163], v116 offset:20480
  v_mfma_f32_16x16x32_bf16 v[48:51], a[76:79], a[24:27], v[48:51]
  ds_read_b64_tr_b16 a[140:141], v117 offset:2048
  v_mfma_f32_16x16x32_bf16 v[100:103], a[20:23], a[80:83], v[100:103]
  ds_read_b64_tr_b16 a[142:143], v117 offset:8192
  v_mfma_f32_16x16x32_bf16 v[100:103], a[0:3], a[56:59], v[100:103]
  buffer_load_dwordx4 v125, s[8:11], s69 offen offset:3072  lds
  v_mfma_f32_16x16x32_bf16 v[64:67], a[4:7], a[56:59], v[64:67]
  ds_read_b64_tr_b16 a[164:165], v117 offset:14336
  v_mfma_f32_16x16x32_bf16 v[64:67], a[24:27], a[80:83], v[64:67]
  ds_read_b64_tr_b16 a[166:167], v117 offset:20480
  v_mfma_f32_16x16x32_bf16 v[68:71], a[28:31], a[80:83], v[68:71]
  s_add_u32 m0, s63, 53248
  ds_read_b64_tr_b16 a[144:145], v116 offset:4096
  v_mfma_f32_16x16x32_bf16 v[68:71], a[8:11], a[56:59], v[68:71]
  buffer_load_dwordx4 v124, s[8:11], s70 offen offset:0  lds
  v_mfma_f32_16x16x32_bf16 v[72:75], a[12:15], a[56:59], v[72:75]
  ds_read_b64_tr_b16 a[146:147], v116 offset:10240
  v_mfma_f32_16x16x32_bf16 v[72:75], a[32:35], a[80:83], v[72:75]
  ds_read_b64_tr_b16 a[168:169], v116 offset:16384
  v_mfma_f32_16x16x32_bf16 v[76:79], a[36:39], a[80:83], v[76:79]
  ds_read_b64_tr_b16 a[170:171], v116 offset:22528
  v_mfma_f32_16x16x32_bf16 v[76:79], a[16:19], a[56:59], v[76:79]
  buffer_load_dwordx4 v125, s[8:11], s70 offen offset:1024  lds
  v_mfma_f32_16x16x32_bf16 v[92:95], a[16:19], a[60:63], v[92:95]
  ds_read_b64_tr_b16 a[148:149], v117 offset:4096
  v_mfma_f32_16x16x32_bf16 v[92:95], a[36:39], a[84:87], v[92:95]
  ds_read_b64_tr_b16 a[150:151], v117 offset:10240
  v_mfma_f32_16x16x32_bf16 v[88:91], a[32:35], a[84:87], v[88:91]
  ds_read_b64_tr_b16 a[172:173], v117 offset:16384
  v_mfma_f32_16x16x32_bf16 v[88:91], a[12:15], a[60:63], v[88:91]
  ds_read_b64_tr_b16 a[174:175], v117 offset:22528
  v_mfma_f32_16x16x32_bf16 v[84:87], a[8:11], a[60:63], v[84:87]
  s_cmp_eq_u32 s66, s88
  s_cbranch_scc1 Lside_k2_c
Lside_k2_r:
  v_mfma_f32_16x16x32_bf16 v[84:87], a[28:31], a[84:87], v[84:87]
  v_mfma_f32_16x16x32_bf16 v[80:83], a[24:27], a[84:87], v[80:83]
  v_mfma_f32_16x16x32_bf16 v[80:83], a[4:7], a[60:63], v[80:83]
  s_waitcnt lgkmcnt(15)
  v_mfma_f32_16x16x32_bf16 v[0:3], a[128:131], a[92:95], v[0:3]
  s_mul_i32 s45, s44, 393216
  v_mfma_f32_16x16x32_bf16 v[0:3], a[152:155], a[112:115], v[0:3]
  s_add_u32 s69, s45, s60
  v_mfma_f32_16x16x32_bf16 v[4:7], a[152:155], a[116:119], v[4:7]
  s_add_u32 s70, s69, 4096
  v_mfma_f32_16x16x32_bf16 v[4:7], a[128:131], a[96:99], v[4:7]
  v_mfma_f32_16x16x32_bf16 v[8:11], a[128:131], a[100:103], v[8:11]
  s_waitcnt vmcnt(10) lgkmcnt(0)
  s_barrier
  ds_read_b64_tr_b16 a[40:41], v116 offset:24576
  v_mfma_f32_16x16x32_bf16 v[8:11], a[152:155], a[120:123], v[8:11]
  ds_read_b64_tr_b16 a[42:43], v116 offset:30720
  v_mfma_f32_16x16x32_bf16 v[12:15], a[152:155], a[124:127], v[12:15]
  s_add_u32 m0, s62, 73728
  ds_read_b64_tr_b16 a[64:65], v116 offset:36864
  v_mfma_f32_16x16x32_bf16 v[12:15], a[128:131], a[104:107], v[12:15]
  buffer_load_dwordx4 v120, s[28:31], s68 offen offset:0 sc1  lds
  v_mfma_f32_16x16x32_bf16 v[28:31], a[132:135], a[104:107], v[28:31]
  ds_read_b64_tr_b16 a[66:67], v116 offset:43008
  v_mfma_f32_16x16x32_bf16 v[28:31], a[156:159], a[124:127], v[28:31]
  ds_read_b128 a[4:7], v112 offset:16384
  v_mfma_f32_16x16x32_bf16 v[24:27], a[156:159], a[120:123], v[24:27]
  ds_read_b128 a[24:27], v113 offset:16384
  v_mfma_f32_16x16x32_bf16 v[24:27], a[132:135], a[100:103], v[24:27]
  buffer_load_dwordx4 v121, s[28:31], s68 offen offset:1024 sc1  lds
  v_mfma_f32_16x16x32_bf16 v[20:23], a[132:135], a[96:99], v[20:23]
  ds_read_b128 a[8:11], v112 offset:18432
  v_mfma_f32_16x16x32_bf16 v[20:23], a[156:159], a[116:119], v[20:23]
  ds_read_b128 a[28:31], v113 offset:18432
  v_mfma_f32_16x16x32_bf16 v[16:19], a[156:159], a[112:115], v[16:19]
  ds_read_b128 a[12:15], v112 offset:20480
  v_mfma_f32_16x16x32_bf16 v[16:19], a[132:135], a[92:95], v[16:19]
  buffer_load_dwordx4 v122, s[28:31], s68 offen offset:2048 sc1  lds
  v_mfma_f32_16x16x32_bf16 v[96:99], a[136:139], a[88:91], v[96:99]
  ds_read_b128 a[32:35], v113 offset:20480
  v_mfma_f32_16x16x32_bf16 v[96:99], a[160:163], a[108:111], v[96:99]
  ds_read_b128 a[16:19], v112 offset:22528
  v_mfma_f32_16x16x32_bf16 v[32:35], a[160:163], a[112:115], v[32:35]
  ds_read_b128 a[36:39], v113 offset:22528
  v_mfma_f32_16x16x32_bf16 v[32:35], a[136:139], a[92:95], v[32:35]
  buffer_load_dwordx4 v123, s[28:31], s68 offen offset:3072 sc1  lds
  v_mfma_f32_16x16x32_bf16 v[36:39], a[136:139], a[96:99], v[36:39]
  ds_read_b64_tr_b16 a[44:45], v117 offset:24576
  v_mfma_f32_16x16x32_bf16 v[36:39], a[160:163], a[116:119], v[36:39]
  ds_read_b64_tr_b16 a[46:47], v117 offset:30720
  v_mfma_f32_16x16x32_bf16 v[40:43], a[160:163], a[120:123], v[40:43]
  s_add_u32 m0, s63, 0
  ds_read_b64_tr_b16 a[68:69], v117 offset:36864
  v_mfma_f32_16x16x32_bf16 v[40:43], a[136:139], a[100:103], v[40:43]
  buffer_load_dwordx4 v124, s[8:11], s69 offen offset:0  lds
  v_mfma_f32_16x16x32_bf16 v[44:47], a[136:139], a[104:107], v[44:47]
  s_add_u32 s44, s44, 1
  ds_read_b64_tr_b16 a[70:71], v117 offset:43008
  v_mfma_f32_16x16x32_bf16 v[44:47], a[160:163], a[124:127], v[44:47]
  s_and_b32 s44, s44, 15
  ds_read_b128 a[0:3], v114 offset:4096
  v_mfma_f32_16x16x32_bf16 v[60:63], a[164:167], a[124:127], v[60:63]
  s_add_u32 s66, s66, 1
  ds_read_b128 a[20:23], v115 offset:4096
  v_mfma_f32_16x16x32_bf16 v[60:63], a[140:143], a[104:107], v[60:63]
  s_mul_i32 s45, s44, s61
  buffer_load_dwordx4 v125, s[8:11], s69 offen offset:1024  lds
  v_mfma_f32_16x16x32_bf16 v[56:59], a[140:143], a[100:103], v[56:59]
  s_add_u32 s68, s45, s59
  ds_read_b64_tr_b16 a[48:49], v116 offset:26624
  v_mfma_f32_16x16x32_bf16 v[56:59], a[164:167], a[120:123], v[56:59]
  ds_read_b64_tr_b16 a[50:51], v116 offset:32768
  v_mfma_f32_16x16x32_bf16 v[52:55], a[164:167], a[116:119], v[52:55]
  ds_read_b64_tr_b16 a[72:73], v116 offset:38912
  v_mfma_f32_16x16x32_bf16 v[52:55], a[140:143], a[96:99], v[52:55]
  buffer_load_dwordx4 v124, s[8:11], s69 offen offset:2048  lds
  v_mfma_f32_16x16x32_bf16 v[48:51], a[140:143], a[92:95], v[48:51]
  ds_read_b64_tr_b16 a[74:75], v116 offset:45056
  v_mfma_f32_16x16x32_bf16 v[48:51], a[164:167], a[112:115], v[48:51]
  ds_read_b64_tr_b16 a[52:53], v117 offset:26624
  v_mfma_f32_16x16x32_bf16 v[100:103], a[108:111], a[168:171], v[100:103]
  ds_read_b64_tr_b16 a[54:55], v117 offset:32768
  v_mfma_f32_16x16x32_bf16 v[100:103], a[88:91], a[144:147], v[100:103]
  buffer_load_dwordx4 v125, s[8:11], s69 offen offset:3072  lds
  v_mfma_f32_16x16x32_bf16 v[64:67], a[92:95], a[144:147], v[64:67]
  ds_read_b64_tr_b16 a[76:77], v117 offset:38912
  v_mfma_f32_16x16x32_bf16 v[64:67], a[112:115], a[168:171], v[64:67]
  ds_read_b64_tr_b16 a[78:79], v117 offset:45056
  v_mfma_f32_16x16x32_bf16 v[68:71], a[116:119], a[168:171], v[68:71]
  s_add_u32 m0, s63, 4096
  ds_read_b64_tr_b16 a[56:57], v116 offset:28672
  v_mfma_f32_16x16x32_bf16 v[68:71], a[96:99], a[144:147], v[68:71]
  buffer_load_dwordx4 v124, s[8:11], s70 offen offset:0  lds
  v_mfma_f32_16x16x32_bf16 v[72:75], a[100:103], a[144:147], v[72:75]
  ds_read_b64_tr_b16 a[58:59], v116 offset:34816
  v_mfma_f32_16x16x32_bf16 v[72:75], a[120:123], a[168:171], v[72:75]
  ds_read_b64_tr_b16 a[80:81], v116 offset:40960
  v_mfma_f32_16x16x32_bf16 v[76:79], a[124:127], a[168:171], v[76:79]
  ds_read_b64_tr_b16 a[82:83], v116 offset:47104
  v_mfma_f32_16x16x32_bf16 v[76:79], a[104:107], a[144:147], v[76:79]
  buffer_load_dwordx4 v125, s[8:11], s70 offen offset:1024  lds
  v_mfma_f32_16x16x32_bf16 v[92:95], a[104:107], a[148:151], v[92:95]
  ds_read_b64_tr_b16 a[60:61], v117 offset:28672
  v_mfma_f32_16x16x32_bf16 v[92:95], a[124:127], a[172:175], v[92:95]
  ds_read_b64_tr_b16 a[62:63], v117 offset:34816
  v_mfma_f32_16x16x32_bf16 v[88:91], a[120:123], a[172:175], v[88:91]
  ds_read_b64_tr_b16 a[84:85], v117 offset:40960
  v_mfma_f32_16x16x32_bf16 v[88:91], a[100:103], a[148:151], v[88:91]
  ds_read_b64_tr_b16 a[86:87], v117 offset:47104
  v_mfma_f32_16x16x32_bf16 v[84:87], a[96:99], a[148:151], v[84:87]
  s_cmp_eq_u32 s66, s88
  s_cbranch_scc1 Lside_k3_c
Lside_k3_r:
  v_mfma_f32_16x16x32_bf16 v[84:87], a[116:119], a[172:175], v[84:87]
  v_mfma_f32_16x16x32_bf16 v[80:83], a[112:115], a[172:175], v[80:83]
  v_mfma_f32_16x16x32_bf16 v[80:83], a[92:95], a[148:151], v[80:83]
  s_waitcnt lgkmcnt(15)
  v_mfma_f32_16x16x32_bf16 v[0:3], a[40:43], a[4:7], v[0:3]
  s_mul_i32 s45, s44, 393216
  v_mfma_f32_16x16x32_bf16 v[0:3], a[64:67], a[24:27], v[0:3]
  s_add_u32 s69, s45, s60
  v_mfma_f32_16x16x32_bf16 v[4:7], a[64:67], a[28:31], v[4:7]
  s_add_u32 s70, s69, 4096
  v_mfma_f32_16x16x32_bf16 v[4:7], a[40:43], a[8:11], v[4:7]
  v_mfma_f32_16x16x32_bf16 v[8:11], a[40:43], a[12:15], v[8:11]
  s_waitcnt vmcnt(10) lgkmcnt(0)
  s_barrier
  ds_read_b64_tr_b16 a[128:129], v118 offset:0
  v_mfma_f32_16x16x32_bf16 v[8:11], a[64:67], a[32:35], v[8:11]
  ds_read_b64_tr_b16 a[130:131], v118 offset:6144
  v_mfma_f32_16x16x32_bf16 v[12:15], a[64:67], a[36:39], v[12:15]
  s_add_u32 m0, s62, 90112
  ds_read_b64_tr_b16 a[152:153], v118 offset:12288
  v_mfma_f32_16x16x32_bf16 v[12:15], a[40:43], a[16:19], v[12:15]
  buffer_load_dwordx4 v120, s[28:31], s68 offen offset:0 sc1  lds
  v_mfma_f32_16x16x32_bf16 v[28:31], a[44:47], a[16:19], v[28:31]
  ds_read_b64_tr_b16 a[154:155], v118 offset:18432
  v_mfma_f32_16x16x32_bf16 v[28:31], a[68:71], a[36:39], v[28:31]
  ds_read_b128 a[92:95], v112 offset:32768
  v_mfma_f32_16x16x32_bf16 v[24:27], a[68:71], a[32:35], v[24:27]
  ds_read_b128 a[112:115], v113 offset:32768
  v_mfma_f32_16x16x32_bf16 v[24:27], a[44:47], a[12:15], v[24:27]
  buffer_load_dwordx4 v121, s[28:31], s68 offen offset:1024 sc1  lds
  v_mfma_f32_16x16x32_bf16 v[20:23], a[44:47], a[8:11], v[20:23]
  ds_read_b128 a[96:99], v112 offset:34816
  v_mfma_f32_16x16x32_bf16 v[20:23], a[68:71], a[28:31], v[20:23]
  ds_read_b128 a[116:119], v113 offset:34816
  v_mfma_f32_16x16x32_bf16 v[16:19], a[68:71], a[24:27], v[16:19]
  ds_read_b128 a[100:103], v112 offset:36864
  v_mfma_f32_16x16x32_bf16 v[16:19], a[44:47], a[4:7], v[16:19]
  buffer_load_dwordx4 v122, s[28:31], s68 offen offset:2048 sc1  lds
  v_mfma_f32_16x16x32_bf16 v[96:99], a[48:51], a[0:3], v[96:99]
  ds_read_b128 a[120:123], v113 offset:36864
  v_mfma_f32_16x16x32_bf16 v[96:99], a[72:75], a[20:23], v[96:99]
  ds_read_b128 a[104:107], v112 offset:38912
  v_mfma_f32_16x16x32_bf16 v[32:35], a[72:75], a[24:27], v[32:35]
  ds_read_b128 a[124:127], v113 offset:38912
  v_mfma_f32_16x16x32_bf16 v[32:35], a[48:51], a[4:7], v[32:35]
  buffer_load_dwordx4 v123, s[28:31], s68 offen offset:3072 sc1  lds
  v_mfma_f32_16x16x32_bf16 v[36:39], a[48:51], a[8:11], v[36:39]
  ds_read_b64_tr_b16 a[132:133], v119 offset:0
  v_mfma_f32_16x16x32_bf16 v[36:39], a[72:75], a[28:31], v[36:39]
  ds_read_b64_tr_b16 a[134:135], v119 offset:6144
  v_mfma_f32_16x16x32_bf16 v[40:43], a[72:75], a[32:35], v[40:43]
  s_add_u32 m0, s63, 24576
  ds_read_b64_tr_b16 a[156:157], v119 offset:12288
  v_mfma_f32_16x16x32_bf16 v[40:43], a[48:51], a[12:15], v[40:43]
  buffer_load_dwordx4 v124, s[8:11], s69 offen offset:0  lds
  v_mfma_f32_16x16x32_bf16 v[44:47], a[48:51], a[16:19], v[44:47]
  s_add_u32 s44, s44, 1
  ds_read_b64_tr_b16 a[158:159], v119 offset:18432
  v_mfma_f32_16x16x32_bf16 v[44:47], a[72:75], a[36:39], v[44:47]
  s_and_b32 s44, s44, 15
  ds_read_b128 a[88:91], v114 offset:5120
  v_mfma_f32_16x16x32_bf16 v[60:63], a[76:79], a[36:39], v[60:63]
  s_add_u32 s66, s66, 1
  ds_read_b128 a[108:111], v115 offset:5120
  v_mfma_f32_16x16x32_bf16 v[60:63], a[52:55], a[16:19], v[60:63]
  s_mul_i32 s45, s44, s61
  buffer_load_dwordx4 v125, s[8:11], s69 offen offset:1024  lds
  v_mfma_f32_16x16x32_bf16 v[56:59], a[52:55], a[12:15], v[56:59]
  s_add_u32 s68, s45, s59
  ds_read_b64_tr_b16 a[136:137], v118 offset:2048
  v_mfma_f32_16x16x32_bf16 v[56:59], a[76:79], a[32:35], v[56:59]
  ds_read_b64_tr_b16 a[138:139], v118 offset:8192
  v_mfma_f32_16x16x32_bf16 v[52:55], a[76:79], a[28:31], v[52:55]
  ds_read_b64_tr_b16 a[160:161], v118 offset:14336
  v_mfma_f32_16x16x32_bf16 v[52:55], a[52:55], a[8:11], v[52:55]
  buffer_load_dwordx4 v124, s[8:11], s69 offen offset:2048  lds
  v_mfma_f32_16x16x32_bf16 v[48:51], a[52:55], a[4:7], v[48:51]
  ds_read_b64_tr_b16 a[162:163], v118 offset:20480
  v_mfma_f32_16x16x32_bf16 v[48:51], a[76:79], a[24:27], v[48:51]
  ds_read_b64_tr_b16 a[140:141], v119 offset:2048
  v_mfma_f32_16x16x32_bf16 v[100:103], a[20:23], a[80:83], v[100:103]
  ds_read_b64_tr_b16 a[142:143], v119 offset:8192
  v_mfma_f32_16x16x32_bf16 v[100:103], a[0:3], a[56:59], v[100:103]
  buffer_load_dwordx4 v125, s[8:11], s69 offen offset:3072  lds
  v_mfma_f32_16x16x32_bf16 v[64:67], a[4:7], a[56:59], v[64:67]
  ds_read_b64_tr_b16 a[164:165], v119 offset:14336
  v_mfma_f32_16x16x32_bf16 v[64:67], a[24:27], a[80:83], v[64:67]
  ds_read_b64_tr_b16 a[166:167], v119 offset:20480
  v_mfma_f32_16x16x32_bf16 v[68:71], a[28:31], a[80:83], v[68:71]
  s_add_u32 m0, s63, 28672
  ds_read_b64_tr_b16 a[144:145], v118 offset:4096
  v_mfma_f32_16x16x32_bf16 v[68:71], a[8:11], a[56:59], v[68:71]
  buffer_load_dwordx4 v124, s[8:11], s70 offen offset:0  lds
  v_mfma_f32_16x16x32_bf16 v[72:75], a[12:15], a[56:59], v[72:75]
  ds_read_b64_tr_b16 a[146:147], v118 offset:10240
  v_mfma_f32_16x16x32_bf16 v[72:75], a[32:35], a[80:83], v[72:75]
  ds_read_b64_tr_b16 a[168:169], v118 offset:16384
  v_mfma_f32_16x16x32_bf16 v[76:79], a[36:39], a[80:83], v[76:79]
  ds_read_b64_tr_b16 a[170:171], v118 offset:22528
  v_mfma_f32_16x16x32_bf16 v[76:79], a[16:19], a[56:59], v[76:79]
  buffer_load_dwordx4 v125, s[8:11], s70 offen offset:1024  lds
  v_mfma_f32_16x16x32_bf16 v[92:95], a[16:19], a[60:63], v[92:95]
  ds_read_b64_tr_b16 a[148:149], v119 offset:4096
  v_mfma_f32_16x16x32_bf16 v[92:95], a[36:39], a[84:87], v[92:95]
  ds_read_b64_tr_b16 a[150:151], v119 offset:10240
  v_mfma_f32_16x16x32_bf16 v[88:91], a[32:35], a[84:87], v[88:91]
  ds_read_b64_tr_b16 a[172:173], v119 offset:16384
  v_mfma_f32_16x16x32_bf16 v[88:91], a[12:15], a[60:63], v[88:91]
  ds_read_b64_tr_b16 a[174:175], v119 offset:22528
  v_mfma_f32_16x16x32_bf16 v[84:87], a[8:11], a[60:63], v[84:87]
  s_cmp_eq_u32 s66, s88
  s_cbranch_scc1 Lside_k4_c
Lside_k4_r:
  v_mfma_f32_16x16x32_bf16 v[84:87], a[28:31], a[84:87], v[84:87]
  v_mfma_f32_16x16x32_bf16 v[80:83], a[24:27], a[84:87], v[80:83]
  v_mfma_f32_16x16x32_bf16 v[80:83], a[4:7], a[60:63], v[80:83]
  s_waitcnt lgkmcnt(15)
  v_mfma_f32_16x16x32_bf16 v[0:3], a[128:131], a[92:95], v[0:3]
  s_mul_i32 s45, s44, 393216
  v_mfma_f32_16x16x32_bf16 v[0:3], a[152:155], a[112:115], v[0:3]
  s_add_u32 s69, s45, s60
  v_mfma_f32_16x16x32_bf16 v[4:7], a[152:155], a[116:119], v[4:7]
  s_add_u32 s70, s69, 4096
  v_mfma_f32_16x16x32_bf16 v[4:7], a[128:131], a[96:99], v[4:7]
  v_mfma_f32_16x16x32_bf16 v[8:11], a[128:131], a[100:103], v[8:11]
  s_waitcnt vmcnt(10) lgkmcnt(0)
  s_barrier
  ds_read_b64_tr_b16 a[40:41], v116 offset:0
  v_mfma_f32_16x16x32_bf16 v[8:11], a[152:155], a[120:123], v[8:11]
  ds_read_b64_tr_b16 a[42:43], v116 offset:6144
  v_mfma_f32_16x16x32_bf16 v[12:15], a[152:155], a[124:127], v[12:15]
  s_add_u32 m0, s62, 106496
  ds_read_b64_tr_b16 a[64:65], v116 offset:12288
  v_mfma_f32_16x16x32_bf16 v[12:15], a[128:131], a[104:107], v[12:15]
  buffer_load_dwordx4 v120, s[28:31], s68 offen offset:0 sc1  lds
  v_mfma_f32_16x16x32_bf16 v[28:31], a[132:135], a[104:107], v[28:31]
  ds_read_b64_tr_b16 a[66:67], v116 offset:18432
  v_mfma_f32_16x16x32_bf16 v[28:31], a[156:159], a[124:127], v[28:31]
  ds_read_b128 a[4:7], v112 offset:0
  v_mfma_f32_16x16x32_bf16 v[24:27], a[156:159], a[120:123], v[24:27]
  ds_read_b128 a[24:27], v113 offset:0
  v_mfma_f32_16x16x32_bf16 v[24:27], a[132:135], a[100:103], v[24:27]
  buffer_load_dwordx4 v121, s[28:31], s68 offen offset:1024 sc1  lds
  v_mfma_f32_16x16x32_bf16 v[20:23], a[132:135], a[96:99], v[20:23]
  ds_read_b128 a[8:11], v112 offset:2048
  v_mfma_f32_16x16x32_bf16 v[20:23], a[156:159], a[116:119], v[20:23]
  ds_read_b128 a[28:31], v113 offset:2048
  v_mfma_f32_16x16x32_bf16 v[16:19], a[156:159], a[112:115], v[16:19]
  ds_read_b128 a[12:15], v112 offset:4096
  v_mfma_f32_16x16x32_bf16 v[16:19], a[132:135], a[92:95], v[16:19]
  buffer_load_dwordx4 v122, s[28:31], s68 offen offset:2048 sc1  lds
  v_mfma_f32_16x16x32_bf16 v[96:99], a[136:139], a[88:91], v[96:99]
  ds_read_b128 a[32:35], v113 offset:4096
  v_mfma_f32_16x16x32_bf16 v[96:99], a[160:163], a[108:111], v[96:99]
  ds_read_b128 a[16:19], v112 offset:6144
  v_mfma_f32_16x16x32_bf16 v[32:35], a[160:163], a[112:115], v[32:35]
  ds_read_b128 a[36:39], v113 offset:6144
  v_mfma_f32_16x16x32_bf16 v[32:35], a[136:139], a[92:95], v[32:35]
  buffer_load_dwordx4 v123, s[28:31], s68 offen offset:3072 sc1  lds
  v_mfma_f32_16x16x32_bf16 v[36:39], a[136:139], a[96:99], v[36:39]
  ds_read_b64_tr_b16 a[44:45], v117 offset:0
  v_mfma_f32_16x16x32_bf16 v[36:39], a[160:163], a[116:119], v[36:39]
  ds_read_b64_tr_b16 a[46:47], v117 offset:6144
  v_mfma_f32_16x16x32_bf16 v[40:43], a[160:163], a[120:123], v[40:43]
  s_add_u32 m0, s63, 49152
  ds_read_b64_tr_b16 a[68:69], v117 offset:12288
  v_mfma_f32_16x16x32_bf16 v[40:43], a[136:139], a[100:103], v[40:43]
  buffer_load_dwordx4 v124, s[8:11], s69 offen offset:0  lds
  v_mfma_f32_16x16x32_bf16 v[44:47], a[136:139], a[104:107], v[44:47]
  s_add_u32 s44, s44, 1
  ds_read_b64_tr_b16 a[70:71], v117 offset:18432
  v_mfma_f32_16x16x32_bf16 v[44:47], a[160:163], a[124:127], v[44:47]
  s_and_b32 s44, s44, 15
  ds_read_b128 a[0:3], v114 offset:6144
  v_add_u32 v114, 6144, v114
  v_mfma_f32_16x16x32_bf16 v[60:63], a[164:167], a[124:127], v[60:63]
  s_add_u32 s66, s66, 1
  ds_read_b128 a[20:23], v115 offset:6144
  v_add_u32 v115, 6144, v115
  v_mfma_f32_16x16x32_bf16 v[60:63], a[140:143], a[104:107], v[60:63]
  s_mul_i32 s45, s44, s61
  buffer_load_dwordx4 v125, s[8:11], s69 offen offset:1024  lds
  v_mfma_f32_16x16x32_bf16 v[56:59], a[140:143], a[100:103], v[56:59]
  s_add_u32 s68, s45, s59
  ds_read_b64_tr_b16 a[48:49], v116 offset:2048
  v_mfma_f32_16x16x32_bf16 v[56:59], a[164:167], a[120:123], v[56:59]
  ds_read_b64_tr_b16 a[50:51], v116 offset:8192
  v_mfma_f32_16x16x32_bf16 v[52:55], a[164:167], a[116:119], v[52:55]
  ds_read_b64_tr_b16 a[72:73], v116 offset:14336
  v_mfma_f32_16x16x32_bf16 v[52:55], a[140:143], a[96:99], v[52:55]
  buffer_load_dwordx4 v124, s[8:11], s69 offen offset:2048  lds
  v_mfma_f32_16x16x32_bf16 v[48:51], a[140:143], a[92:95], v[48:51]
  ds_read_b64_tr_b16 a[74:75], v116 offset:20480
  v_mfma_f32_16x16x32_bf16 v[48:51], a[164:167], a[112:115], v[48:51]
  ds_read_b64_tr_b16 a[52:53], v117 offset:2048
  v_mfma_f32_16x16x32_bf16 v[100:103], a[108:111], a[168:171], v[100:103]
  ds_read_b64_tr_b16 a[54:55], v117 offset:8192
  v_mfma_f32_16x16x32_bf16 v[100:103], a[88:91], a[144:147], v[100:103]
  buffer_load_dwordx4 v125, s[8:11], s69 offen offset:3072  lds
  v_mfma_f32_16x16x32_bf16 v[64:67], a[92:95], a[144:147], v[64:67]
  ds_read_b64_tr_b16 a[76:77], v117 offset:14336
  v_mfma_f32_16x16x32_bf16 v[64:67], a[112:115], a[168:171], v[64:67]
  ds_read_b64_tr_b16 a[78:79], v117 offset:20480
  v_mfma_f32_16x16x32_bf16 v[68:71], a[116:119], a[168:171], v[68:71]
  s_add_u32 m0, s63, 53248
  ds_read_b64_tr_b16 a[56:57], v116 offset:4096
  v_mfma_f32_16x16x32_bf16 v[68:71], a[96:99], a[144:147], v[68:71]
  buffer_load_dwordx4 v124, s[8:11], s70 offen offset:0  lds
  v_mfma_f32_16x16x32_bf16 v[72:75], a[100:103], a[144:147], v[72:75]
  ds_read_b64_tr_b16 a[58:59], v116 offset:10240
  v_mfma_f32_16x16x32_bf16 v[72:75], a[120:123], a[168:171], v[72:75]
  ds_read_b64_tr_b16 a[80:81], v116 offset:16384
  v_mfma_f32_16x16x32_bf16 v[76:79], a[124:127], a[168:171], v[76:79]
  ds_read_b64_tr_b16 a[82:83], v116 offset:22528
  v_mfma_f32_16x16x32_bf16 v[76:79], a[104:107], a[144:147], v[76:79]
  buffer_load_dwordx4 v125, s[8:11], s70 offen offset:1024  lds
  v_mfma_f32_16x16x32_bf16 v[92:95], a[104:107], a[148:151], v[92:95]
  ds_read_b64_tr_b16 a[60:61], v117 offset:4096
  v_mfma_f32_16x16x32_bf16 v[92:95], a[124:127], a[172:175], v[92:95]
  ds_read_b64_tr_b16 a[62:63], v117 offset:10240
  v_mfma_f32_16x16x32_bf16 v[88:91], a[120:123], a[172:175], v[88:91]
  ds_read_b64_tr_b16 a[84:85], v117 offset:16384
  v_mfma_f32_16x16x32_bf16 v[88:91], a[100:103], a[148:151], v[88:91]
  ds_read_b64_tr_b16 a[86:87], v117 offset:22528
  v_mfma_f32_16x16x32_bf16 v[84:87], a[96:99], a[148:151], v[84:87]
  s_cmp_eq_u32 s66, s88
  s_cbranch_scc1 Lside_k5_c
Lside_k5_r:
  v_mfma_f32_16x16x32_bf16 v[84:87], a[116:119], a[172:175], v[84:87]
  s_sub_u32 s56, s56, 1
  v_mfma_f32_16x16x32_bf16 v[80:83], a[112:115], a[172:175], v[80:83]
  s_cmp_lg_u32 s56, 0
  v_mfma_f32_16x16x32_bf16 v[80:83], a[92:95], a[148:151], v[80:83]
  s_cbranch_scc1 Lp1_loop
Lmk_Lp1_loop_tail:
  s_waitcnt lgkmcnt(15)
  v_mfma_f32_16x16x32_bf16 v[0:3], a[40:43], a[4:7], v[0:3]
  s_mul_i32 s45, s44, 393216
  v_and_b32 v240, 1, v253
  v_lshlrev_b32 v240, 7, v240
  v_mfma_f32_16x16x32_bf16 v[0:3], a[64:67], a[24:27], v[0:3]
  s_add_u32 s69, s45, s60
  v_mfma_f32_16x16x32_bf16 v[4:7], a[64:67], a[28:31], v[4:7]
  s_add_u32 s70, s69, 4096
  buffer_load_dword v127, v240, s[36:39], 0 offen sc1
  v_mfma_f32_16x16x32_bf16 v[4:7], a[40:43], a[8:11], v[4:7]
  s_lshl_b32 s43, s57, 2
  v_mfma_f32_16x16x32_bf16 v[8:11], a[40:43], a[12:15], v[8:11]
  s_waitcnt vmcnt(11) lgkmcnt(0)
  s_barrier
  ds_read_b64_tr_b16 a[128:129], v116 offset:24576
  v_mfma_f32_16x16x32_bf16 v[8:11], a[64:67], a[32:35], v[8:11]
  s_add_u32 s74, s71, s43
  ds_read_b64_tr_b16 a[130:131], v116 offset:30720
  v_mfma_f32_16x16x32_bf16 v[12:15], a[64:67], a[36:39], v[12:15]
  s_add_u32 m0, s62, 73728
  ds_read_b64_tr_b16 a[152:153], v116 offset:36864
  v_mfma_f32_16x16x32_bf16 v[12:15], a[40:43], a[16:19], v[12:15]
  s_add_u32 s45, s42, 27262976
  buffer_load_dwordx4 v120, s[28:31], s68 offen offset:0 sc1  lds
  v_mfma_f32_16x16x32_bf16 v[28:31], a[44:47], a[16:19], v[28:31]
  s_lshl_b32 s44, s72, 11
  ds_read_b64_tr_b16 a[154:155], v116 offset:43008
  v_mfma_f32_16x16x32_bf16 v[28:31], a[68:71], a[36:39], v[28:31]
  s_add_u32 s77, s44, s45
  ds_read_b128 a[92:95], v112 offset:16384
  v_mfma_f32_16x16x32_bf16 v[24:27], a[68:71], a[32:35], v[24:27]
  s_lshl_b32 s44, s40, 1
  ds_read_b128 a[112:115], v113 offset:16384
  v_mfma_f32_16x16x32_bf16 v[24:27], a[44:47], a[12:15], v[24:27]
  s_add_u32 s44, s44, s71
  buffer_load_dwordx4 v121, s[28:31], s68 offen offset:1024 sc1  lds
  v_mfma_f32_16x16x32_bf16 v[20:23], a[44:47], a[8:11], v[20:23]
  s_lshl_b32 s44, s44, 11
  ds_read_b128 a[96:99], v112 offset:18432
  v_mfma_f32_16x16x32_bf16 v[20:23], a[68:71], a[28:31], v[20:23]
  s_add_u32 s78, s44, s45
  ds_read_b128 a[116:119], v113 offset:18432
  v_mfma_f32_16x16x32_bf16 v[16:19], a[68:71], a[24:27], v[16:19]
  s_lshl_b32 s43, s51, 1
  ds_read_b128 a[100:103], v112 offset:20480
  v_mfma_f32_16x16x32_bf16 v[16:19], a[44:47], a[4:7], v[16:19]
  s_add_u32 s75, s43, s58
  buffer_load_dwordx4 v122, s[28:31], s68 offen offset:2048 sc1  lds
  v_mfma_f32_16x16x32_bf16 v[96:99], a[48:51], a[0:3], v[96:99]
  s_lshl_b32 s43, s75, 7
  ds_read_b128 a[120:123], v113 offset:20480
  v_mfma_f32_16x16x32_bf16 v[96:99], a[72:75], a[20:23], v[96:99]
  s_add_u32 s46, s43, 27983872
  ds_read_b128 a[104:107], v112 offset:22528
  v_mfma_f32_16x16x32_bf16 v[32:35], a[72:75], a[24:27], v[32:35]
  s_lshl_b32 s43, s57, 6
  ds_read_b128 a[124:127], v113 offset:22528
  v_mfma_f32_16x16x32_bf16 v[32:35], a[48:51], a[4:7], v[32:35]
  buffer_load_dwordx4 v123, s[28:31], s68 offen offset:3072 sc1  lds
  v_mfma_f32_16x16x32_bf16 v[36:39], a[48:51], a[8:11], v[36:39]
  ds_read_b64_tr_b16 a[132:133], v117 offset:24576
  v_mfma_f32_16x16x32_bf16 v[36:39], a[72:75], a[28:31], v[36:39]
  ds_read_b64_tr_b16 a[134:135], v117 offset:30720
  v_mfma_f32_16x16x32_bf16 v[40:43], a[72:75], a[32:35], v[40:43]
  s_add_u32 m0, s63, 0
  ds_read_b64_tr_b16 a[156:157], v117 offset:36864
  v_mfma_f32_16x16x32_bf16 v[40:43], a[48:51], a[12:15], v[40:43]
  buffer_load_dwordx4 v124, s[8:11], s69 offen offset:0  lds
  v_mfma_f32_16x16x32_bf16 v[44:47], a[48:51], a[16:19], v[44:47]
  ds_read_b64_tr_b16 a[158:159], v117 offset:43008
  v_mfma_f32_16x16x32_bf16 v[44:47], a[72:75], a[36:39], v[44:47]
  ds_read_b128 a[88:91], v114 offset:1024
  v_mfma_f32_16x16x32_bf16 v[60:63], a[76:79], a[36:39], v[60:63]
  ds_read_b128 a[108:111], v115 offset:1024
  v_mfma_f32_16x16x32_bf16 v[60:63], a[52:55], a[16:19], v[60:63]
  buffer_load_dwordx4 v125, s[8:11], s69 offen offset:1024  lds
  v_mfma_f32_16x16x32_bf16 v[56:59], a[52:55], a[12:15], v[56:59]
  ds_read_b64_tr_b16 a[136:137], v116 offset:26624
  v_mfma_f32_16x16x32_bf16 v[56:59], a[76:79], a[32:35], v[56:59]
  ds_read_b64_tr_b16 a[138:139], v116 offset:32768
  v_mfma_f32_16x16x32_bf16 v[52:55], a[76:79], a[28:31], v[52:55]
  ds_read_b64_tr_b16 a[160:161], v116 offset:38912
  v_lshlrev_b32 v105, 3, v253
  v_mfma_f32_16x16x32_bf16 v[52:55], a[52:55], a[8:11], v[52:55]
  buffer_load_dwordx4 v124, s[8:11], s69 offen offset:2048  lds
  v_mfma_f32_16x16x32_bf16 v[48:51], a[52:55], a[4:7], v[48:51]
  ds_read_b64_tr_b16 a[162:163], v116 offset:45056
  v_lshlrev_b32 v104, 4, v253
  v_mfma_f32_16x16x32_bf16 v[48:51], a[76:79], a[24:27], v[48:51]
  ds_read_b64_tr_b16 a[140:141], v117 offset:26624
  v_xor_b32 v126, s43, v104
  v_mfma_f32_16x16x32_bf16 v[100:103], a[20:23], a[80:83], v[100:103]
  ds_read_b64_tr_b16 a[142:143], v117 offset:32768
  v_add_u32 v126, s76, v126
  v_mfma_f32_16x16x32_bf16 v[100:103], a[0:3], a[56:59], v[100:103]
  buffer_load_dwordx4 v125, s[8:11], s69 offen offset:3072  lds
  v_mfma_f32_16x16x32_bf16 v[64:67], a[4:7], a[56:59], v[64:67]
  ds_read_b64_tr_b16 a[164:165], v117 offset:38912
  v_bfe_u32 v106, v253, 3, 2
  v_mfma_f32_16x16x32_bf16 v[64:67], a[24:27], a[80:83], v[64:67]
  ds_read_b64_tr_b16 a[166:167], v117 offset:45056
  v_lshrrev_b32 v107, 5, v253
  v_mfma_f32_16x16x32_bf16 v[68:71], a[28:31], a[80:83], v[68:71]
  s_add_u32 m0, s63, 4096
  ds_read_b64_tr_b16 a[144:145], v116 offset:28672
  v_mad_u32_u24 v106, v107, 3, v106
  v_mfma_f32_16x16x32_bf16 v[68:71], a[8:11], a[56:59], v[68:71]
  buffer_load_dwordx4 v124, s[8:11], s70 offen offset:0  lds
  v_mfma_f32_16x16x32_bf16 v[72:75], a[12:15], a[56:59], v[72:75]
  ds_read_b64_tr_b16 a[146:147], v116 offset:34816
  v_and_b32 v107, 7, v253
  v_mfma_f32_16x16x32_bf16 v[72:75], a[32:35], a[80:83], v[72:75]
  ds_read_b64_tr_b16 a[168:169], v116 offset:40960
  v_lshlrev_b32 v107, 4, v107
  v_mfma_f32_16x16x32_bf16 v[76:79], a[36:39], a[80:83], v[76:79]
  ds_read_b64_tr_b16 a[170:171], v116 offset:47104
  v_lshl_add_u32 v106, v106, 12, v107
  v_mfma_f32_16x16x32_bf16 v[76:79], a[16:19], a[56:59], v[76:79]
  buffer_load_dwordx4 v125, s[8:11], s70 offen offset:1024  lds
  v_mfma_f32_16x16x32_bf16 v[92:95], a[16:19], a[60:63], v[92:95]
  ds_read_b64_tr_b16 a[148:149], v117 offset:28672
  v_mfma_f32_16x16x32_bf16 v[92:95], a[36:39], a[84:87], v[92:95]
  ds_read_b64_tr_b16 a[150:151], v117 offset:34816
  v_mfma_f32_16x16x32_bf16 v[88:91], a[32:35], a[84:87], v[88:91]
  ds_read_b64_tr_b16 a[172:173], v117 offset:40960
  v_mfma_f32_16x16x32_bf16 v[88:91], a[12:15], a[60:63], v[88:91]
  s_waitcnt vmcnt(10)
  v_cmp_gt_u32 vcc, 128, v127
  s_cbranch_vccnz Lchk3_c
Lchk3_r:
  v_mfma_f32_16x16x32_bf16 v[84:87], a[8:11], a[60:63], v[84:87]
  ds_read_b64_tr_b16 a[174:175], v117 offset:47104
  v_mfma_f32_16x16x32_bf16 v[84:87], a[28:31], a[84:87], v[84:87]
  v_mfma_f32_16x16x32_bf16 v[80:83], a[24:27], a[84:87], v[80:83]
  v_mfma_f32_16x16x32_bf16 v[80:83], a[4:7], a[60:63], v[80:83]
  s_waitcnt lgkmcnt(15)
  v_mfma_f32_16x16x32_bf16 v[0:3], a[128:131], a[92:95], v[0:3]
  s_cmp_eq_u32 s41, 0
  s_cbranch_scc1 Lc4_c
Lc4_r:
  v_mfma_f32_16x16x32_bf16 v[0:3], a[152:155], a[112:115], v[0:3]
  s_lshl_b32 s92, s53, 7
  s_lshl_b32 s93, s40, 14
  s_add_u32 s92, s92, s93
  v_mfma_f32_16x16x32_bf16 v[4:7], a[152:155], a[116:119], v[4:7]
  s_lshl_b32 s89, s40, 10
  v_add_u32 v186, s92, v252
  s_bfe_u32 s88, s2, 0x5
  v_mfma_f32_16x16x32_bf16 v[4:7], a[128:131], a[96:99], v[4:7]
  s_lshl_b32 s88, s88, 21
  buffer_load_dwordx2 v[128:129], v105, s[4:7], s78 offen offset:0 sc1
  v_mfma_f32_16x16x32_bf16 v[8:11], a[128:131], a[100:103], v[8:11]
  s_waitcnt lgkmcnt(0)
  s_barrier
  ds_read_b64_tr_b16 a[40:41], v118 offset:0
  v_mfma_f32_16x16x32_bf16 v[8:11], a[152:155], a[120:123], v[8:11]
  ds_read_b64_tr_b16 a[42:43], v118 offset:6144
  v_mfma_f32_16x16x32_bf16 v[12:15], a[152:155], a[124:127], v[12:15]
  s_cmp_eq_u32 s41, 0
  s_cbranch_scc1 Lc5_c
Lc5_r:
  ds_read_b64_tr_b16 a[64:65], v118 offset:12288
  v_mfma_f32_16x16x32_bf16 v[12:15], a[128:131], a[104:107], v[12:15]
  buffer_load_dwordx2 v[130:131], v105, s[4:7], s78 offen offset:512 sc1
  v_mfma_f32_16x16x32_bf16 v[28:31], a[132:135], a[104:107], v[28:31]
  ds_read_b64_tr_b16 a[66:67], v118 offset:18432
  v_mfma_f32_16x16x32_bf16 v[28:31], a[156:159], a[124:127], v[28:31]
  ds_read_b128 a[4:7], v112 offset:32768
  v_mfma_f32_16x16x32_bf16 v[24:27], a[156:159], a[120:123], v[24:27]
  ds_read_b128 a[24:27], v113 offset:32768
  v_mfma_f32_16x16x32_bf16 v[24:27], a[132:135], a[100:103], v[24:27]
  buffer_load_dwordx2 v[132:133], v105, s[4:7], s78 offen offset:1024 sc1
  v_mfma_f32_16x16x32_bf16 v[20:23], a[132:135], a[96:99], v[20:23]
  s_cmp_eq_u32 s41, 0
  s_cbranch_scc1 Lc6_c
Lc6_r:
  ds_read_b128 a[8:11], v112 offset:34816
  v_mfma_f32_16x16x32_bf16 v[20:23], a[156:159], a[116:119], v[20:23]
  ds_read_b128 a[28:31], v113 offset:34816
  v_mfma_f32_16x16x32_bf16 v[16:19], a[156:159], a[112:115], v[16:19]
  ds_read_b128 a[12:15], v112 offset:36864
  v_mfma_f32_16x16x32_bf16 v[16:19], a[132:135], a[92:95], v[16:19]
  buffer_load_dwordx2 v[134:135], v105, s[4:7], s78 offen offset:1536 sc1
  v_mfma_f32_16x16x32_bf16 v[96:99], a[136:139], a[88:91], v[96:99]
  ds_read_b128 a[32:35], v113 offset:36864
  v_mfma_f32_16x16x32_bf16 v[96:99], a[160:163], a[108:111], v[96:99]
  ds_read_b128 a[16:19], v112 offset:38912
  v_mfma_f32_16x16x32_bf16 v[32:35], a[160:163], a[112:115], v[32:35]
  s_cmp_eq_u32 s41, 0
  s_cbranch_scc1 Lc7_c
Lc7_r:
  ds_read_b128 a[36:39], v113 offset:38912
  v_mfma_f32_16x16x32_bf16 v[32:35], a[136:139], a[92:95], v[32:35]
  buffer_load_dwordx2 v[136:137], v105, s[4:7], s78 offen offset:2048 sc1
  v_mfma_f32_16x16x32_bf16 v[36:39], a[136:139], a[96:99], v[36:39]
  ds_read_b64_tr_b16 a[44:45], v119 offset:0
  v_mfma_f32_16x16x32_bf16 v[36:39], a[160:163], a[116:119], v[36:39]
  ds_read_b64_tr_b16 a[46:47], v119 offset:6144
  v_mfma_f32_16x16x32_bf16 v[40:43], a[160:163], a[120:123], v[40:43]
  ds_read_b64_tr_b16 a[68:69], v119 offset:12288
  v_mfma_f32_16x16x32_bf16 v[40:43], a[136:139], a[100:103], v[40:43]
  buffer_load_dwordx2 v[138:139], v105, s[4:7], s78 offen offset:2560 sc1
  v_mfma_f32_16x16x32_bf16 v[44:47], a[136:139], a[104:107], v[44:47]
  ds_read_b64_tr_b16 a[70:71], v119 offset:18432
  v_lshrrev_b32 v240, 4, v253
  v_mfma_f32_16x16x32_bf16 v[44:47], a[160:163], a[124:127], v[44:47]
  ds_read_b128 a[0:3], v114 offset:2048
  v_lshlrev_b32 v124, 4, v240
  v_mfma_f32_16x16x32_bf16 v[60:63], a[164:167], a[124:127], v[60:63]
  ds_read_b128 a[20:23], v115 offset:2048
  v_and_b32 v125, 15, v253
  v_mfma_f32_16x16x32_bf16 v[60:63], a[140:143], a[104:107], v[60:63]
  buffer_load_dwordx2 v[140:141], v105, s[4:7], s78 offen offset:3072 sc1
  v_mfma_f32_16x16x32_bf16 v[56:59], a[140:143], a[100:103], v[56:59]
  ds_read_b64_tr_b16 a[48:49], v118 offset:2048
  v_lshlrev_b32 v125, 2, v125
  v_mfma_f32_16x16x32_bf16 v[56:59], a[164:167], a[120:123], v[56:59]
  s_lshl_b32 s43, s57, 9
  ds_read_b64_tr_b16 a[50:51], v118 offset:8192
  v_add_u32 v164, 155648, v124
  v_mfma_f32_16x16x32_bf16 v[52:55], a[164:167], a[116:119], v[52:55]
  ds_read_b64_tr_b16 a[72:73], v118 offset:14336
  v_add_u32 v166, 155648, v125
  v_mfma_f32_16x16x32_bf16 v[52:55], a[140:143], a[96:99], v[52:55]
  buffer_load_dwordx2 v[142:143], v105, s[4:7], s78 offen offset:3584 sc1
  v_mfma_f32_16x16x32_bf16 v[48:51], a[140:143], a[92:95], v[48:51]
  ds_read_b64_tr_b16 a[74:75], v118 offset:20480
  v_add_u32 v165, s43, v164
  v_mfma_f32_16x16x32_bf16 v[48:51], a[164:167], a[112:115], v[48:51]
  ds_read_b64_tr_b16 a[52:53], v119 offset:2048
  v_add_u32 v167, s43, v166
  v_mfma_f32_16x16x32_bf16 v[100:103], a[108:111], a[168:171], v[100:103]
  s_lshl_b32 s43, s40, 1
  ds_read_b64_tr_b16 a[54:55], v119 offset:8192
  v_mfma_f32_16x16x32_bf16 v[100:103], a[88:91], a[144:147], v[100:103]
  s_add_u32 s43, s43, 1
  buffer_load_dwordx2 v[144:145], v105, s[4:7], s77 offen offset:0 sc1
  v_mfma_f32_16x16x32_bf16 v[64:67], a[92:95], a[144:147], v[64:67]
  ds_read_b64_tr_b16 a[76:77], v119 offset:14336
  v_add_u32 v241, s43, v240
  v_mfma_f32_16x16x32_bf16 v[64:67], a[112:115], a[168:171], v[64:67]
  ds_read_b64_tr_b16 a[78:79], v119 offset:20480
  v_cmp_gt_u32 vcc, 2, v240
  v_mfma_f32_16x16x32_bf16 v[68:71], a[116:119], a[168:171], v[68:71]
  ds_read_b64_tr_b16 a[56:57], v118 offset:4096
  v_and_b32 v240, 1, v240
  v_mfma_f32_16x16x32_bf16 v[68:71], a[96:99], a[144:147], v[68:71]
  buffer_load_dwordx2 v[146:147], v105, s[4:7], s77 offen offset:512 sc1
  v_mfma_f32_16x16x32_bf16 v[72:75], a[100:103], a[144:147], v[72:75]
  ds_read_b64_tr_b16 a[58:59], v118 offset:10240
  v_mul_u32_u24 v240, 9, v240
  v_mfma_f32_16x16x32_bf16 v[72:75], a[120:123], a[168:171], v[72:75]
  ds_read_b64_tr_b16 a[80:81], v118 offset:16384
  v_cndmask_b32 v240, v240, v241, vcc
  v_mfma_f32_16x16x32_bf16 v[76:79], a[124:127], a[168:171], v[76:79]
  ds_read_b64_tr_b16 a[82:83], v118 offset:22528
  v_lshl_add_u32 v106, v240, 7, v166
  v_mfma_f32_16x16x32_bf16 v[76:79], a[104:107], a[144:147], v[76:79]
  buffer_load_dwordx2 v[148:149], v105, s[4:7], s77 offen offset:1024 sc1
  v_mfma_f32_16x16x32_bf16 v[92:95], a[104:107], a[148:151], v[92:95]
  ds_read_b64_tr_b16 a[60:61], v119 offset:4096
  v_add_u32 v124, s76, v124
  v_mfma_f32_16x16x32_bf16 v[92:95], a[124:127], a[172:175], v[92:95]
  ds_read_b64_tr_b16 a[62:63], v119 offset:10240
  v_add_u32 v125, s76, v125
  v_mfma_f32_16x16x32_bf16 v[88:91], a[120:123], a[172:175], v[88:91]
  ds_read_b64_tr_b16 a[84:85], v119 offset:16384
  v_add_u32 v107, 149504, v104
  v_mfma_f32_16x16x32_bf16 v[88:91], a[100:103], a[148:151], v[88:91]
  buffer_load_dwordx2 v[150:151], v105, s[4:7], s77 offen offset:1536 sc1
  v_mfma_f32_16x16x32_bf16 v[84:87], a[96:99], a[148:151], v[84:87]
  ds_read_b64_tr_b16 a[86:87], v119 offset:22528
  v_mfma_f32_16x16x32_bf16 v[84:87], a[116:119], a[172:175], v[84:87]
  v_mfma_f32_16x16x32_bf16 v[80:83], a[112:115], a[172:175], v[80:83]
  v_mfma_f32_16x16x32_bf16 v[80:83], a[92:95], a[148:151], v[80:83]
  s_waitcnt lgkmcnt(15)
  v_mfma_f32_16x16x32_bf16 v[0:3], a[40:43], a[4:7], v[0:3]
  s_lshl_b32 s44, s2, 2
  s_add_u32 s44, s44, s40
  s_lshl_b32 s44, s44, 12
  v_mfma_f32_16x16x32_bf16 v[0:3], a[64:67], a[24:27], v[0:3]
  s_add_u32 s44, s44, s42
  v_mfma_f32_16x16x32_bf16 v[4:7], a[64:67], a[28:31], v[4:7]
  s_add_u32 s44, s44, 28311552
  v_mov_b32 v246, -1
  v_mov_b32 v247, -1
  v_mfma_f32_16x16x32_bf16 v[4:7], a[40:43], a[8:11], v[4:7]
  v_mov_b32 v248, -1
  v_mov_b32 v249, -1
  v_mfma_f32_16x16x32_bf16 v[8:11], a[40:43], a[12:15], v[8:11]
  s_waitcnt vmcnt(12) lgkmcnt(0)
  s_barrier
  ds_read_b64_tr_b16 a[128:129], v116 offset:0
  v_mfma_f32_16x16x32_bf16 v[8:11], a[64:67], a[32:35], v[8:11]
  ds_read_b64_tr_b16 a[130:131], v116 offset:6144
  v_mfma_f32_16x16x32_bf16 v[12:15], a[64:67], a[36:39], v[12:15]
  s_waitcnt vmcnt(8)
  ds_read_b64_tr_b16 a[152:153], v116 offset:12288
  v_add_u32 v198, 1024, v125
  v_mfma_f32_16x16x32_bf16 v[12:15], a[40:43], a[16:19], v[12:15]
  ds_read_b64_tr_b16 a[154:155], v116 offset:18432
  v_add_f32 v128, v128, v130
  v_mfma_f32_16x16x32_bf16 v[28:31], a[44:47], a[16:19], v[28:31]
  buffer_store_dwordx4 v[246:249], v104, s[4:7], s44 offen offset:0 sc1
  v_mfma_f32_16x16x32_bf16 v[28:31], a[68:71], a[36:39], v[28:31]
  ds_read_b128 a[92:95], v112 offset:0
  v_add_f32 v129, v129, v131
  v_mfma_f32_16x16x32_bf16 v[24:27], a[68:71], a[32:35], v[24:27]
  ds_read_b128 a[112:115], v113 offset:0
  v_add_f32 v132, v132, v134
  v_mfma_f32_16x16x32_bf16 v[24:27], a[44:47], a[12:15], v[24:27]
  ds_read_b128 a[96:99], v112 offset:2048
  v_add_f32 v133, v133, v135
  v_mfma_f32_16x16x32_bf16 v[20:23], a[44:47], a[8:11], v[20:23]
  buffer_store_dwordx4 v[246:249], v104, s[4:7], s44 offen offset:1024 sc1
  v_mfma_f32_16x16x32_bf16 v[20:23], a[68:71], a[28:31], v[20:23]
  ds_read_b128 a[116:119], v113 offset:2048
  v_add_f32 v128, v128, v132
  v_mfma_f32_16x16x32_bf16 v[16:19], a[68:71], a[24:27], v[16:19]
  ds_read_b128 a[100:103], v112 offset:4096
  v_add_f32 v129, v129, v133
  v_mfma_f32_16x16x32_bf16 v[16:19], a[44:47], a[4:7], v[16:19]
  s_waitcnt vmcnt(6)
  ds_read_b128 a[120:123], v113 offset:4096
  s_cmp_eq_u32 s41, 0
  s_cbranch_scc1 Lc8_c
Lc8_r:
  v_mfma_f32_16x16x32_bf16 v[96:99], a[48:51], a[0:3], v[96:99]
  buffer_store_dwordx4 v[246:249], v104, s[4:7], s44 offen offset:2048 sc1
  v_mfma_f32_16x16x32_bf16 v[96:99], a[72:75], a[20:23], v[96:99]
  ds_read_b128 a[104:107], v112 offset:6144
  ds_read_b128 v[168:171], v124 offset:1024
  v_mfma_f32_16x16x32_bf16 v[32:35], a[72:75], a[24:27], v[32:35]
  ds_read_b128 a[124:127], v113 offset:6144
  ds_read_b128 v[172:175], v124 offset:1088
  v_mfma_f32_16x16x32_bf16 v[32:35], a[48:51], a[4:7], v[32:35]
  ds_read_b64_tr_b16 a[132:133], v117 offset:0
  ds_read_b128 v[176:179], v124 offset:1152
  v_mfma_f32_16x16x32_bf16 v[36:39], a[48:51], a[8:11], v[36:39]
  buffer_store_dwordx4 v[246:249], v104, s[4:7], s44 offen offset:3072 sc1
  v_mfma_f32_16x16x32_bf16 v[36:39], a[72:75], a[28:31], v[36:39]
  ds_read_b64_tr_b16 a[134:135], v117 offset:6144
  ds_read_b128 v[180:183], v124 offset:1216
  v_mfma_f32_16x16x32_bf16 v[40:43], a[72:75], a[32:35], v[40:43]
  ds_read_b64_tr_b16 a[156:157], v117 offset:12288
  ds_read2_b32 v[184:185], v198 offset0:64 offset1:80
  v_mfma_f32_16x16x32_bf16 v[40:43], a[48:51], a[12:15], v[40:43]
  s_add_u32 m0, s62, 90112
  ds_read_b64_tr_b16 a[158:159], v117 offset:18432
  s_xor_b32 s47, s40, 2
  v_mfma_f32_16x16x32_bf16 v[44:47], a[48:51], a[16:19], v[44:47]
  s_mul_i32 s47, s47, 6144
  buffer_load_dwordx4 v120, s[28:31], s64 offen offset:0 sc1 lds
  v_mfma_f32_16x16x32_bf16 v[44:47], a[72:75], a[36:39], v[44:47]
  s_add_u32 s47, s47, 139264
  ds_read_b128 a[88:91], v114 offset:3072
  s_add_u32 s49, s47, 3072
  v_mfma_f32_16x16x32_bf16 v[60:63], a[76:79], a[36:39], v[60:63]
  s_add_u32 s79, s47, 2048
  ds_read_b128 a[108:111], v115 offset:3072
  v_mfma_f32_16x16x32_bf16 v[60:63], a[52:55], a[16:19], v[60:63]
  s_cmp_eq_u32 s57, 0
  s_cselect_b32 s49, s76, s49
  s_cselect_b32 s79, s47, s79
  ds_read_b64_tr_b16 a[136:137], v116 offset:2048
  v_add_u32 v198, s49, v105
  v_mfma_f32_16x16x32_bf16 v[56:59], a[52:55], a[12:15], v[56:59]
  ds_read_b64_tr_b16 a[138:139], v116 offset:8192
  v_add_u32 v199, s79, v105
  v_mfma_f32_16x16x32_bf16 v[56:59], a[76:79], a[32:35], v[56:59]
  ds_read_b64_tr_b16 a[160:161], v116 offset:14336
  v_add_u32 v105, s76, v105
  v_mfma_f32_16x16x32_bf16 v[52:55], a[76:79], a[28:31], v[52:55]
  ds_read_b64_tr_b16 a[162:163], v116 offset:20480
  v_add_f32 v136, v136, v138
  v_mfma_f32_16x16x32_bf16 v[52:55], a[52:55], a[8:11], v[52:55]
  ds_read_b64_tr_b16 a[140:141], v117 offset:2048
  v_add_f32 v137, v137, v139
  v_mfma_f32_16x16x32_bf16 v[48:51], a[52:55], a[4:7], v[48:51]
  buffer_load_dwordx4 v121, s[28:31], s64 offen offset:1024 sc1 lds
  v_mfma_f32_16x16x32_bf16 v[48:51], a[76:79], a[24:27], v[48:51]
  ds_read_b64_tr_b16 a[142:143], v117 offset:8192
  v_add_f32 v140, v140, v142
  v_mfma_f32_16x16x32_bf16 v[100:103], a[20:23], a[80:83], v[100:103]
  ds_read_b64_tr_b16 a[164:165], v117 offset:14336
  v_add_f32 v141, v141, v143
  v_mfma_f32_16x16x32_bf16 v[100:103], a[0:3], a[56:59], v[100:103]
  ds_read_b64_tr_b16 a[166:167], v117 offset:20480
  v_add_f32 v136, v136, v140
  v_mfma_f32_16x16x32_bf16 v[64:67], a[4:7], a[56:59], v[64:67]
  ds_read_b64_tr_b16 a[144:145], v116 offset:4096
  v_add_f32 v137, v137, v141
  v_mfma_f32_16x16x32_bf16 v[64:67], a[24:27], a[80:83], v[64:67]
  s_waitcnt vmcnt(6)
  ds_read_b64_tr_b16 a[146:147], v116 offset:10240
  v_add_f32 v144, v144, v146
  v_mfma_f32_16x16x32_bf16 v[68:71], a[28:31], a[80:83], v[68:71]
  ds_read_b64_tr_b16 a[168:169], v116 offset:16384
  v_add_f32 v145, v145, v147
  v_mfma_f32_16x16x32_bf16 v[68:71], a[8:11], a[56:59], v[68:71]
  ds_read_b64_tr_b16 a[170:171], v116 offset:22528
  v_add_f32 v148, v148, v150
  v_mfma_f32_16x16x32_bf16 v[72:75], a[12:15], a[56:59], v[72:75]
  buffer_load_dwordx4 v122, s[28:31], s64 offen offset:2048 sc1 lds
  v_mfma_f32_16x16x32_bf16 v[72:75], a[32:35], a[80:83], v[72:75]
  ds_read_b64_tr_b16 a[148:149], v117 offset:4096
  v_add_f32 v149, v149, v151
  v_mfma_f32_16x16x32_bf16 v[76:79], a[36:39], a[80:83], v[76:79]
  ds_read_b64_tr_b16 a[150:151], v117 offset:10240
  v_add_f32 v144, v144, v148
  v_mfma_f32_16x16x32_bf16 v[76:79], a[16:19], a[56:59], v[76:79]
  ds_read_b64_tr_b16 a[172:173], v117 offset:16384
  v_add_f32 v145, v145, v149
  v_mfma_f32_16x16x32_bf16 v[92:95], a[16:19], a[60:63], v[92:95]
  s_mov_b32 s48, 0x3a800000
  ds_read_b64_tr_b16 a[174:175], v117 offset:22528
  v_mov_b32 v240, 0x3727c5ac
  v_mfma_f32_16x16x32_bf16 v[92:95], a[36:39], a[84:87], v[92:95]
  v_permlane32_swap_b32 v136, v130
  v_permlane32_swap_b32 v137, v131
  v_mfma_f32_16x16x32_bf16 v[88:91], a[32:35], a[84:87], v[88:91]
  v_permlane32_swap_b32 v128, v144
  v_permlane32_swap_b32 v129, v145
  v_mfma_f32_16x16x32_bf16 v[88:91], a[12:15], a[60:63], v[88:91]
  v_add_f32 v136, v136, v130
  v_add_f32 v128, v128, v144
  v_mfma_f32_16x16x32_bf16 v[84:87], a[8:11], a[60:63], v[84:87]
  buffer_load_dwordx4 v123, s[28:31], s64 offen offset:3072 sc1 lds
  v_mfma_f32_16x16x32_bf16 v[84:87], a[28:31], a[84:87], v[84:87]
  v_add_f32 v137, v137, v131
  v_add_f32 v129, v129, v145
  v_mfma_f32_16x16x32_bf16 v[80:83], a[24:27], a[84:87], v[80:83]
  v_permlane16_swap_b32 v128, v136
  v_mfma_f32_16x16x32_bf16 v[80:83], a[4:7], a[60:63], v[80:83]
  s_nop 0
  v_permlane16_swap_b32 v129, v137
  v_add_f32 v128, v128, v136
  s_waitcnt lgkmcnt(15)
  v_mfma_f32_16x16x32_bf16 v[0:3], a[128:131], a[92:95], v[0:3]
  v_add_f32 v129, v129, v137
  v_mul_f32 v128, 0xba800000, v128
  v_mfma_f32_16x16x32_bf16 v[0:3], a[152:155], a[112:115], v[0:3]
  s_add_u32 m0, s89, 40960
  v_fma_f32 v129, v129, s48, v240
  v_fma_f32 v129, -v128, v128, v129
  v_mfma_f32_16x16x32_bf16 v[4:7], a[152:155], a[116:119], v[4:7]
  s_xor_b32 s92, s88, 655360
  v_max_f32 v129, v129, v240
  v_rsq_f32 v129, v129
  v_mfma_f32_16x16x32_bf16 v[4:7], a[128:131], a[96:99], v[4:7]
  s_nop 0
  buffer_load_dwordx4 v186, s[12:15], s92 offen lds
  v_mfma_f32_16x16x32_bf16 v[8:11], a[128:131], a[100:103], v[8:11]
  ds_write2_b32 v106, v128, v129 offset0:0 offset1:16
  v_mfma_f32_16x16x32_bf16 v[8:11], a[152:155], a[120:123], v[8:11]
  v_mfma_f32_16x16x32_bf16 v[12:15], a[152:155], a[124:127], v[12:15]
  v_mfma_f32_16x16x32_bf16 v[12:15], a[128:131], a[104:107], v[12:15]
  s_add_u32 m0, s89, 45056
  v_mfma_f32_16x16x32_bf16 v[28:31], a[132:135], a[104:107], v[28:31]
  s_xor_b32 s92, s88, 720896
  v_mfma_f32_16x16x32_bf16 v[28:31], a[156:159], a[124:127], v[28:31]
  buffer_load_dwordx4 v186, s[12:15], s92 offen lds
  v_mfma_f32_16x16x32_bf16 v[24:27], a[156:159], a[120:123], v[24:27]
  s_waitcnt lgkmcnt(0)
  s_barrier
  ds_read2_b32 v[190:191], v167 offset0:32 offset1:48
  ds_read2_b32 v[192:193], v167 offset0:64 offset1:80
  v_mfma_f32_16x16x32_bf16 v[24:27], a[132:135], a[100:103], v[24:27]
  ds_read2_b32 v[194:195], v167 offset0:96 offset1:112
  ds_read2_b32 v[196:197], v167 offset0:128 offset1:144
  v_mfma_f32_16x16x32_bf16 v[20:23], a[132:135], a[96:99], v[20:23]
  ds_read2_b32 v[188:189], v166 offset0:0 offset1:16
  ds_read_b128 v[128:131], v107
  v_mfma_f32_16x16x32_bf16 v[20:23], a[156:159], a[116:119], v[20:23]
  s_add_u32 m0, s89, 49152
  ds_read_b128 v[132:135], v107 offset:1024
  ds_read_b128 v[200:203], v164 offset:0
  v_mfma_f32_16x16x32_bf16 v[16:19], a[156:159], a[112:115], v[16:19]
  s_xor_b32 s92, s88, 786432
  ds_read_b128 v[220:223], v164 offset:64
  ds_read_b128 v[216:219], v165 offset:512
  v_mfma_f32_16x16x32_bf16 v[16:19], a[132:135], a[92:95], v[16:19]
  buffer_load_dwordx4 v186, s[12:15], s92 offen lds
  v_mfma_f32_16x16x32_bf16 v[96:99], a[136:139], a[88:91], v[96:99]
  ds_read_b128 v[236:239], v165 offset:576
  ds_read_b128 v[204:207], v165 offset:128
  v_mfma_f32_16x16x32_bf16 v[96:99], a[160:163], a[108:111], v[96:99]
  ds_read_b128 v[224:227], v165 offset:192
  ds_read_b128 v[208:211], v165 offset:256
  v_mfma_f32_16x16x32_bf16 v[32:35], a[160:163], a[112:115], v[32:35]
  ds_read_b128 v[228:231], v165 offset:320
  ds_read_b128 v[212:215], v165 offset:384
  v_mfma_f32_16x16x32_bf16 v[32:35], a[136:139], a[92:95], v[32:35]
  s_add_u32 m0, s89, 53248
  ds_read_b128 v[232:235], v165 offset:448
  s_and_b32 s43, s50, 7
  v_mfma_f32_16x16x32_bf16 v[36:39], a[136:139], a[96:99], v[36:39]
  s_xor_b32 s92, s88, 851968
  buffer_load_dwordx4 v186, s[12:15], s92 offen lds
  v_mfma_f32_16x16x32_bf16 v[36:39], a[160:163], a[116:119], v[36:39]
  s_or_b32 s43, s43, s57
  s_cselect_b64 s[46:47], -1, 0
  v_mfma_f32_16x16x32_bf16 v[40:43], a[160:163], a[120:123], v[40:43]
  v_mov_b32 v245, 0xf149f2ca
  v_mfma_f32_16x16x32_bf16 v[40:43], a[136:139], a[100:103], v[40:43]
  s_waitcnt lgkmcnt(10)
  v_fmac_f32 v12, v168, v196
  v_fmac_f32 v13, v169, v196
  v_mfma_f32_16x16x32_bf16 v[44:47], a[136:139], a[104:107], v[44:47]
  v_fmac_f32 v14, v170, v196
  v_fmac_f32 v15, v171, v196
  v_mfma_f32_16x16x32_bf16 v[44:47], a[160:163], a[124:127], v[44:47]
  s_add_u32 m0, s89, 57344
  v_fmac_f32 v28, v172, v196
  v_fmac_f32 v29, v173, v196
  v_mfma_f32_16x16x32_bf16 v[60:63], a[164:167], a[124:127], v[60:63]
  s_xor_b32 s92, s88, 917504
  v_fmac_f32 v30, v174, v196
  v_fmac_f32 v31, v175, v196
  v_mfma_f32_16x16x32_bf16 v[60:63], a[140:143], a[104:107], v[60:63]
  buffer_load_dwordx4 v186, s[12:15], s92 offen lds
  v_mfma_f32_16x16x32_bf16 v[56:59], a[140:143], a[100:103], v[56:59]
  v_cvt_pk_bf16_f32 v12, v12, v13
  v_cvt_pk_bf16_f32 v13, v14, v15
  v_mfma_f32_16x16x32_bf16 v[56:59], a[164:167], a[120:123], v[56:59]
  v_cvt_pk_bf16_f32 v14, v28, v29
  v_cvt_pk_bf16_f32 v15, v30, v31
  v_mfma_f32_16x16x32_bf16 v[52:55], a[164:167], a[116:119], v[52:55]
  v_fmac_f32 v8, v168, v194
  v_fmac_f32 v9, v169, v194
  v_mfma_f32_16x16x32_bf16 v[52:55], a[140:143], a[96:99], v[52:55]
  s_add_u32 m0, s89, 61440
  v_fmac_f32 v10, v170, v194
  v_fmac_f32 v11, v171, v194
  v_mfma_f32_16x16x32_bf16 v[48:51], a[140:143], a[92:95], v[48:51]
  s_xor_b32 s92, s88, 983040
  v_fmac_f32 v24, v172, v194
  v_fmac_f32 v25, v173, v194
  v_mfma_f32_16x16x32_bf16 v[48:51], a[164:167], a[112:115], v[48:51]
  buffer_load_dwordx4 v186, s[12:15], s92 offen lds
  v_mfma_f32_16x16x32_bf16 v[100:103], a[108:111], a[168:171], v[100:103]
  v_fmac_f32 v26, v174, v194
  v_fmac_f32 v27, v175, v194
  v_mfma_f32_16x16x32_bf16 v[100:103], a[88:91], a[144:147], v[100:103]
  v_cvt_pk_bf16_f32 v8, v8, v9
  v_cvt_pk_bf16_f32 v9, v10, v11
  v_mfma_f32_16x16x32_bf16 v[64:67], a[92:95], a[144:147], v[64:67]
  v_cvt_pk_bf16_f32 v10, v24, v25
  v_cvt_pk_bf16_f32 v11, v26, v27
  v_mfma_f32_16x16x32_bf16 v[64:67], a[112:115], a[168:171], v[64:67]
  s_add_u32 m0, s89, 65536
  v_fmac_f32 v4, v168, v192
  v_fmac_f32 v5, v169, v192
  v_mfma_f32_16x16x32_bf16 v[68:71], a[116:119], a[168:171], v[68:71]
  s_xor_b32 s92, s88, 1048576
  v_fmac_f32 v6, v170, v192
  v_fmac_f32 v7, v171, v192
  v_mfma_f32_16x16x32_bf16 v[68:71], a[96:99], a[144:147], v[68:71]
  buffer_load_dwordx4 v186, s[12:15], s92 offen lds
  v_mfma_f32_16x16x32_bf16 v[72:75], a[100:103], a[144:147], v[72:75]
  v_fmac_f32 v20, v172, v192
  v_fmac_f32 v21, v173, v192
  v_mfma_f32_16x16x32_bf16 v[72:75], a[120:123], a[168:171], v[72:75]
  v_fmac_f32 v22, v174, v192
  v_fmac_f32 v23, v175, v192
  v_mfma_f32_16x16x32_bf16 v[76:79], a[124:127], a[168:171], v[76:79]
  v_cvt_pk_bf16_f32 v4, v4, v5
  v_cvt_pk_bf16_f32 v5, v6, v7
  v_mfma_f32_16x16x32_bf16 v[76:79], a[104:107], a[144:147], v[76:79]
  s_add_u32 m0, s89, 69632
  v_cvt_pk_bf16_f32 v6, v20, v21
  v_cvt_pk_bf16_f32 v7, v22, v23
  v_mfma_f32_16x16x32_bf16 v[92:95], a[104:107], a[148:151], v[92:95]
  s_xor_b32 s92, s88, 1114112
  v_fmac_f32 v0, v168, v190
  v_fmac_f32 v1, v169, v190
  v_mfma_f32_16x16x32_bf16 v[92:95], a[124:127], a[172:175], v[92:95]
  buffer_load_dwordx4 v186, s[12:15], s92 offen lds
  v_mfma_f32_16x16x32_bf16 v[88:91], a[120:123], a[172:175], v[88:91]
  v_fmac_f32 v2, v170, v190
  v_fmac_f32 v3, v171, v190
  v_mfma_f32_16x16x32_bf16 v[88:91], a[100:103], a[148:151], v[88:91]
  v_fmac_f32 v16, v172, v190
  v_fmac_f32 v17, v173, v190
  v_mfma_f32_16x16x32_bf16 v[84:87], a[96:99], a[148:151], v[84:87]
  v_fmac_f32 v18, v174, v190
  v_fmac_f32 v19, v175, v190
  v_mfma_f32_16x16x32_bf16 v[84:87], a[116:119], a[172:175], v[84:87]
  v_cvt_pk_bf16_f32 v0, v0, v1
  v_cvt_pk_bf16_f32 v1, v2, v3
  v_mfma_f32_16x16x32_bf16 v[80:83], a[112:115], a[172:175], v[80:83]
  v_cvt_pk_bf16_f32 v2, v16, v17
  v_cvt_pk_bf16_f32 v3, v18, v19
  v_mfma_f32_16x16x32_bf16 v[80:83], a[92:95], a[148:151], v[80:83]
  v_cndmask_b32 v136, v245, v132, s[46:47]
  v_mov_b32 v160, 0x3f803f80
Lmk_p1epi:
  v_mul_f32 v108, 0x3e8293ee, v191
  v_cndmask_b32 v137, v245, v133, s[46:47]
  v_mov_b32 v161, 0x3f803f80
  v_mul_f32 v109, 0x3e8293ee, v193
  v_cndmask_b32 v138, v245, v134, s[46:47]
  v_mov_b32 v162, 0x3f803f80
  v_mul_f32 v110, 0x3e8293ee, v195
  v_cndmask_b32 v139, v245, v135, s[46:47]
  v_mov_b32 v163, 0x3f803f80
  v_mul_f32 v111, 0x3e8293ee, v197
  s_waitcnt lgkmcnt(0)
  v_pk_fma_f32 v[96:97], v[176:177], v[188:189], v[96:97] op_sel:[0,0,0] op_sel_hi:[1,0,1]
  v_pk_fma_f32 v[98:99], v[178:179], v[188:189], v[98:99] op_sel:[0,0,0] op_sel_hi:[1,0,1]
  v_pk_mul_f32 v[96:97], v[96:97], v[188:189] op_sel:[0,1] op_sel_hi:[1,1]
  v_pk_mul_f32 v[98:99], v[98:99], v[188:189] op_sel:[0,1] op_sel_hi:[1,1]
  v_cvt_pk_bf16_f32 v96, v96, v97
  v_cvt_pk_bf16_f32 v97, v98, v99
  v_pk_fma_f32 v[44:45], v[176:177], v[196:197], v[44:45] op_sel:[0,0,0] op_sel_hi:[1,0,1]
  v_pk_fma_f32 v[46:47], v[178:179], v[196:197], v[46:47] op_sel:[0,0,0] op_sel_hi:[1,0,1]
  v_pk_fma_f32 v[60:61], v[180:181], v[196:197], v[60:61] op_sel:[0,0,0] op_sel_hi:[1,0,1]
  v_pk_fma_f32 v[62:63], v[182:183], v[196:197], v[62:63] op_sel:[0,0,0] op_sel_hi:[1,0,1]
  v_pk_mul_f32 v[44:45], v[44:45], v[196:197] op_sel:[0,1] op_sel_hi:[1,1]
  v_pk_mul_f32 v[46:47], v[46:47], v[196:197] op_sel:[0,1] op_sel_hi:[1,1]
  v_pk_mul_f32 v[60:61], v[60:61], v[196:197] op_sel:[0,1] op_sel_hi:[1,1]
  v_pk_mul_f32 v[62:63], v[62:63], v[196:197] op_sel:[0,1] op_sel_hi:[1,1]
  v_cvt_pk_bf16_f32 v44, v44, v45
  v_cvt_pk_bf16_f32 v45, v46, v47
  v_cvt_pk_bf16_f32 v46, v60, v61
  v_cvt_pk_bf16_f32 v47, v62, v63
  v_pk_fma_f32 v[100:101], v[200:201], v[184:185], v[100:101] op_sel:[0,0,0] op_sel_hi:[1,0,1]
  v_pk_fma_f32 v[102:103], v[202:203], v[184:185], v[102:103] op_sel:[0,0,0] op_sel_hi:[1,0,1]
  v_pk_mul_f32 v[100:101], v[100:101], v[220:221]
  v_pk_mul_f32 v[102:103], v[102:103], v[222:223]
  v_cvt_pk_bf16_f32 v100, v100, v101
  v_cvt_pk_bf16_f32 v101, v102, v103
  v_pk_fma_f32 v[76:77], v[216:217], v[184:185], v[76:77] op_sel:[0,0,0] op_sel_hi:[1,0,1]
  v_pk_fma_f32 v[78:79], v[218:219], v[184:185], v[78:79] op_sel:[0,0,0] op_sel_hi:[1,0,1]
  v_pk_fma_f32 v[92:93], v[216:217], v[184:185], v[92:93] op_sel:[0,1,0] op_sel_hi:[1,1,1]
  v_pk_fma_f32 v[94:95], v[218:219], v[184:185], v[94:95] op_sel:[0,1,0] op_sel_hi:[1,1,1]
  v_pk_mul_f32 v[76:77], v[76:77], v[236:237]
  v_pk_mul_f32 v[78:79], v[78:79], v[238:239]
  v_pk_mul_f32 v[92:93], v[92:93], v[236:237]
  v_pk_mul_f32 v[94:95], v[94:95], v[238:239]
  v_cvt_pk_bf16_f32 v148, v76, v77
  v_cvt_pk_bf16_f32 v149, v78, v79
  v_cvt_pk_bf16_f32 v158, v92, v93
  v_cvt_pk_bf16_f32 v159, v94, v95
  ds_write2st64_b64 v105, v[96:97], v[100:101] offset0:0 offset1:1
  ds_write2st64_b64 v105, v[44:45], v[148:149] offset0:4 offset1:5
  ds_write2st64_b64 v105, v[46:47], v[158:159] offset0:6 offset1:7
  s_add_u32 m0, s89, 0
  s_xor_b32 s92, s88, 0
  buffer_load_dwordx4 v186, s[12:15], s92 offen lds
  v_pk_fma_f32 v[40:41], v[176:177], v[194:195], v[40:41] op_sel:[0,0,0] op_sel_hi:[1,0,1]
  v_pk_fma_f32 v[42:43], v[178:179], v[194:195], v[42:43] op_sel:[0,0,0] op_sel_hi:[1,0,1]
  v_pk_fma_f32 v[56:57], v[180:181], v[194:195], v[56:57] op_sel:[0,0,0] op_sel_hi:[1,0,1]
  v_pk_fma_f32 v[58:59], v[182:183], v[194:195], v[58:59] op_sel:[0,0,0] op_sel_hi:[1,0,1]
  v_pk_mul_f32 v[40:41], v[40:41], v[194:195] op_sel:[0,1] op_sel_hi:[1,1]
  v_pk_mul_f32 v[42:43], v[42:43], v[194:195] op_sel:[0,1] op_sel_hi:[1,1]
  v_pk_mul_f32 v[56:57], v[56:57], v[194:195] op_sel:[0,1] op_sel_hi:[1,1]
  v_pk_mul_f32 v[58:59], v[58:59], v[194:195] op_sel:[0,1] op_sel_hi:[1,1]
  v_cvt_pk_bf16_f32 v40, v40, v41
  v_cvt_pk_bf16_f32 v41, v42, v43
  v_cvt_pk_bf16_f32 v42, v56, v57
  v_cvt_pk_bf16_f32 v43, v58, v59
  s_add_u32 m0, s89, 4096
  s_xor_b32 s92, s88, 65536
  buffer_load_dwordx4 v186, s[12:15], s92 offen lds
  v_pk_fma_f32 v[36:37], v[176:177], v[192:193], v[36:37] op_sel:[0,0,0] op_sel_hi:[1,0,1]
  v_pk_fma_f32 v[38:39], v[178:179], v[192:193], v[38:39] op_sel:[0,0,0] op_sel_hi:[1,0,1]
  v_pk_fma_f32 v[52:53], v[180:181], v[192:193], v[52:53] op_sel:[0,0,0] op_sel_hi:[1,0,1]
  v_pk_fma_f32 v[54:55], v[182:183], v[192:193], v[54:55] op_sel:[0,0,0] op_sel_hi:[1,0,1]
  v_pk_mul_f32 v[36:37], v[36:37], v[192:193] op_sel:[0,1] op_sel_hi:[1,1]
  v_pk_mul_f32 v[38:39], v[38:39], v[192:193] op_sel:[0,1] op_sel_hi:[1,1]
  v_pk_mul_f32 v[52:53], v[52:53], v[192:193] op_sel:[0,1] op_sel_hi:[1,1]
  v_pk_mul_f32 v[54:55], v[54:55], v[192:193] op_sel:[0,1] op_sel_hi:[1,1]
  v_cvt_pk_bf16_f32 v36, v36, v37
  v_cvt_pk_bf16_f32 v37, v38, v39
  v_cvt_pk_bf16_f32 v38, v52, v53
  v_cvt_pk_bf16_f32 v39, v54, v55
  s_add_u32 m0, s89, 8192
  s_xor_b32 s92, s88, 131072
  buffer_load_dwordx4 v186, s[12:15], s92 offen lds
  v_pk_fma_f32 v[32:33], v[176:177], v[190:191], v[32:33] op_sel:[0,0,0] op_sel_hi:[1,0,1]
  v_pk_fma_f32 v[34:35], v[178:179], v[190:191], v[34:35] op_sel:[0,0,0] op_sel_hi:[1,0,1]
  v_pk_fma_f32 v[48:49], v[180:181], v[190:191], v[48:49] op_sel:[0,0,0] op_sel_hi:[1,0,1]
  v_pk_fma_f32 v[50:51], v[182:183], v[190:191], v[50:51] op_sel:[0,0,0] op_sel_hi:[1,0,1]
  v_pk_mul_f32 v[32:33], v[32:33], v[190:191] op_sel:[0,1] op_sel_hi:[1,1]
  v_pk_mul_f32 v[34:35], v[34:35], v[190:191] op_sel:[0,1] op_sel_hi:[1,1]
  v_pk_mul_f32 v[48:49], v[48:49], v[190:191] op_sel:[0,1] op_sel_hi:[1,1]
  v_pk_mul_f32 v[50:51], v[50:51], v[190:191] op_sel:[0,1] op_sel_hi:[1,1]
  v_cvt_pk_bf16_f32 v32, v32, v33
  v_cvt_pk_bf16_f32 v33, v34, v35
  v_cvt_pk_bf16_f32 v34, v48, v49
  v_cvt_pk_bf16_f32 v35, v50, v51
  s_waitcnt lgkmcnt(0)
  s_barrier
  ds_read_b64 v[120:121], v198
  ds_read_b64 v[122:123], v199
  ds_read_b64 v[140:141], v198 offset:512
  ds_read_b64 v[150:151], v199 offset:512
  v_mfma_f32_16x16x32_bf16 v[60:63], v[44:47], v[12:15], v[128:131]
  v_mfma_f32_16x16x32_bf16 v[28:31], v[40:43], v[12:15], v[132:135]
  v_mfma_f32_16x16x32_bf16 v[56:59], v[40:43], v[8:11], v[128:131]
  v_mfma_f32_16x16x32_bf16 v[24:27], v[36:39], v[8:11], v[132:135]
  v_mfma_f32_16x16x32_bf16 v[52:55], v[36:39], v[4:7], v[128:131]
  v_mfma_f32_16x16x32_bf16 v[20:23], v[32:35], v[4:7], v[132:135]
  v_mfma_f32_16x16x32_bf16 v[48:51], v[32:35], v[0:3], v[128:131]
  s_waitcnt lgkmcnt(0)
  v_mfma_f32_16x16x32_bf16 v[16:19], v[120:123], v[0:3], v[136:139]
  s_add_u32 m0, s89, 12288
  s_xor_b32 s92, s88, 196608
  buffer_load_dwordx4 v186, s[12:15], s92 offen lds
  v_pk_fma_f32 v[64:65], v[204:205], v[184:185], v[64:65] op_sel:[0,0,0] op_sel_hi:[1,0,1]
  v_pk_fma_f32 v[66:67], v[206:207], v[184:185], v[66:67] op_sel:[0,0,0] op_sel_hi:[1,0,1]
  v_pk_fma_f32 v[80:81], v[204:205], v[184:185], v[80:81] op_sel:[0,1,0] op_sel_hi:[1,1,1]
  v_pk_fma_f32 v[82:83], v[206:207], v[184:185], v[82:83] op_sel:[0,1,0] op_sel_hi:[1,1,1]
  v_pk_mul_f32 v[64:65], v[64:65], v[224:225]
  v_pk_mul_f32 v[66:67], v[66:67], v[226:227]
  v_pk_mul_f32 v[80:81], v[80:81], v[224:225]
  v_pk_mul_f32 v[82:83], v[82:83], v[226:227]
  v_cvt_pk_bf16_f32 v142, v64, v65
  v_cvt_pk_bf16_f32 v143, v66, v67
  v_cvt_pk_bf16_f32 v152, v80, v81
  v_cvt_pk_bf16_f32 v153, v82, v83
  s_add_u32 m0, s89, 16384
  s_xor_b32 s92, s88, 262144
  buffer_load_dwordx4 v186, s[12:15], s92 offen lds
  v_pk_fma_f32 v[68:69], v[208:209], v[184:185], v[68:69] op_sel:[0,0,0] op_sel_hi:[1,0,1]
  v_pk_fma_f32 v[70:71], v[210:211], v[184:185], v[70:71] op_sel:[0,0,0] op_sel_hi:[1,0,1]
  v_pk_fma_f32 v[84:85], v[208:209], v[184:185], v[84:85] op_sel:[0,1,0] op_sel_hi:[1,1,1]
  v_pk_fma_f32 v[86:87], v[210:211], v[184:185], v[86:87] op_sel:[0,1,0] op_sel_hi:[1,1,1]
  v_pk_mul_f32 v[68:69], v[68:69], v[228:229]
  v_pk_mul_f32 v[70:71], v[70:71], v[230:231]
  v_pk_mul_f32 v[84:85], v[84:85], v[228:229]
  v_pk_mul_f32 v[86:87], v[86:87], v[230:231]
  v_cvt_pk_bf16_f32 v144, v68, v69
  v_cvt_pk_bf16_f32 v145, v70, v71
  v_cvt_pk_bf16_f32 v154, v84, v85
  v_cvt_pk_bf16_f32 v155, v86, v87
  s_add_u32 m0, s89, 20480
  s_xor_b32 s92, s88, 327680
  buffer_load_dwordx4 v186, s[12:15], s92 offen lds
  v_pk_fma_f32 v[72:73], v[212:213], v[184:185], v[72:73] op_sel:[0,0,0] op_sel_hi:[1,0,1]
  v_pk_fma_f32 v[74:75], v[214:215], v[184:185], v[74:75] op_sel:[0,0,0] op_sel_hi:[1,0,1]
  v_pk_fma_f32 v[88:89], v[212:213], v[184:185], v[88:89] op_sel:[0,1,0] op_sel_hi:[1,1,1]
  v_pk_fma_f32 v[90:91], v[214:215], v[184:185], v[90:91] op_sel:[0,1,0] op_sel_hi:[1,1,1]
  v_pk_mul_f32 v[72:73], v[72:73], v[232:233]
  v_pk_mul_f32 v[74:75], v[74:75], v[234:235]
  v_pk_mul_f32 v[88:89], v[88:89], v[232:233]
  v_pk_mul_f32 v[90:91], v[90:91], v[234:235]
  v_cvt_pk_bf16_f32 v146, v72, v73
  v_cvt_pk_bf16_f32 v147, v74, v75
  v_cvt_pk_bf16_f32 v156, v88, v89
  v_cvt_pk_bf16_f32 v157, v90, v91
  s_add_u32 m0, s89, 24576
  s_xor_b32 s92, s88, 393216
  buffer_load_dwordx4 v186, s[12:15], s92 offen lds
  s_cmp_eq_u32 s57, 0
  s_cbranch_scc1 Lp1_nsw
  v_swap_b32 v140, v150
  v_swap_b32 v141, v151
  v_swap_b32 v142, v152
  v_swap_b32 v143, v153
  v_swap_b32 v144, v154
  v_swap_b32 v145, v155
  v_swap_b32 v146, v156
  v_swap_b32 v147, v157
  v_swap_b32 v148, v158
  v_swap_b32 v149, v159
Lp1_nsw:
  v_max3_f32 v240, v16, v17, v18
  v_max3_f32 v241, v20, v21, v22
  v_max3_f32 v242, v24, v25, v26
  v_max3_f32 v243, v28, v29, v30
  v_max3_f32 v240, v240, v19, v48
  v_max3_f32 v241, v241, v23, v52
  v_max3_f32 v242, v242, v27, v56
  v_max3_f32 v243, v243, v31, v60
  v_max3_f32 v240, v240, v49, v50
  v_max3_f32 v241, v241, v53, v54
  v_max3_f32 v242, v242, v57, v58
  v_max3_f32 v243, v243, v61, v62
  v_max_f32 v240, v240, v51
  v_max_f32 v241, v241, v55
  v_max_f32 v242, v242, v59
  v_max_f32 v243, v243, v63
  v_mov_b32 v244, v240
  v_mov_b32 v245, v241
  v_mov_b32 v246, v242
  v_mov_b32 v247, v243
  v_permlane32_swap_b32 v240, v244
  v_permlane32_swap_b32 v241, v245
  v_permlane32_swap_b32 v242, v246
  v_permlane32_swap_b32 v243, v247
  v_max_f32 v240, v240, v244
  v_max_f32 v241, v241, v245
  v_max_f32 v242, v242, v246
  v_max_f32 v243, v243, v247
  v_mov_b32 v244, v240
  v_mov_b32 v245, v241
  v_mov_b32 v246, v242
  v_mov_b32 v247, v243
  v_permlane16_swap_b32 v240, v244
  v_permlane16_swap_b32 v241, v245
  v_permlane16_swap_b32 v242, v246
  v_permlane16_swap_b32 v243, v247
  v_max_f32 v240, v240, v244
  v_max_f32 v241, v241, v245
  v_max_f32 v242, v242, v246
  v_max_f32 v243, v243, v247
  v_pk_mul_f32 v[240:241], v[240:241], v[108:109] neg_lo:[0,1] neg_hi:[0,1]
  v_pk_mul_f32 v[242:243], v[242:243], v[110:111] neg_lo:[0,1] neg_hi:[0,1]
  v_pk_fma_f32 v[16:17], v[16:17], v[108:109], v[240:241] op_sel:[0,0,0] op_sel_hi:[1,0,0]
  v_pk_fma_f32 v[18:19], v[18:19], v[108:109], v[240:241] op_sel:[0,0,0] op_sel_hi:[1,0,0]
  v_pk_fma_f32 v[48:49], v[48:49], v[108:109], v[240:241] op_sel:[0,0,0] op_sel_hi:[1,0,0]
  v_pk_fma_f32 v[50:51], v[50:51], v[108:109], v[240:241] op_sel:[0,0,0] op_sel_hi:[1,0,0]
  v_exp_f32 v16, v16
  v_exp_f32 v17, v17
  v_exp_f32 v18, v18
  v_exp_f32 v19, v19
  v_exp_f32 v48, v48
  v_exp_f32 v49, v49
  v_exp_f32 v50, v50
  v_exp_f32 v51, v51
  v_cvt_pk_bf16_f32 v0, v16, v17
  v_cvt_pk_bf16_f32 v1, v18, v19
  v_cvt_pk_bf16_f32 v2, v48, v49
  v_cvt_pk_bf16_f32 v3, v50, v51
  s_add_u32 m0, s89, 28672
  s_xor_b32 s92, s88, 458752
  buffer_load_dwordx4 v186, s[12:15], s92 offen lds
  v_pk_fma_f32 v[20:21], v[20:21], v[108:109], v[240:241] op_sel:[0,1,1] op_sel_hi:[1,1,1]
  v_pk_fma_f32 v[22:23], v[22:23], v[108:109], v[240:241] op_sel:[0,1,1] op_sel_hi:[1,1,1]
  v_pk_fma_f32 v[52:53], v[52:53], v[108:109], v[240:241] op_sel:[0,1,1] op_sel_hi:[1,1,1]
  v_pk_fma_f32 v[54:55], v[54:55], v[108:109], v[240:241] op_sel:[0,1,1] op_sel_hi:[1,1,1]
  v_exp_f32 v20, v20
  v_exp_f32 v21, v21
  v_exp_f32 v22, v22
  v_exp_f32 v23, v23
  v_exp_f32 v52, v52
  v_exp_f32 v53, v53
  v_exp_f32 v54, v54
  v_exp_f32 v55, v55
  v_cvt_pk_bf16_f32 v4, v20, v21
  v_cvt_pk_bf16_f32 v5, v22, v23
  v_cvt_pk_bf16_f32 v6, v52, v53
  v_cvt_pk_bf16_f32 v7, v54, v55
  s_add_u32 m0, s89, 32768
  s_xor_b32 s92, s88, 524288
  buffer_load_dwordx4 v186, s[12:15], s92 offen lds
  v_pk_fma_f32 v[24:25], v[24:25], v[110:111], v[242:243] op_sel:[0,0,0] op_sel_hi:[1,0,0]
  v_pk_fma_f32 v[26:27], v[26:27], v[110:111], v[242:243] op_sel:[0,0,0] op_sel_hi:[1,0,0]
  v_pk_fma_f32 v[56:57], v[56:57], v[110:111], v[242:243] op_sel:[0,0,0] op_sel_hi:[1,0,0]
  v_pk_fma_f32 v[58:59], v[58:59], v[110:111], v[242:243] op_sel:[0,0,0] op_sel_hi:[1,0,0]
  v_exp_f32 v24, v24
  v_exp_f32 v25, v25
  v_exp_f32 v26, v26
  v_exp_f32 v27, v27
  v_exp_f32 v56, v56
  v_exp_f32 v57, v57
  v_exp_f32 v58, v58
  v_exp_f32 v59, v59
  v_cvt_pk_bf16_f32 v8, v24, v25
  v_cvt_pk_bf16_f32 v9, v26, v27
  v_cvt_pk_bf16_f32 v10, v56, v57
  v_cvt_pk_bf16_f32 v11, v58, v59
  v_pk_fma_f32 v[28:29], v[28:29], v[110:111], v[242:243] op_sel:[0,1,1] op_sel_hi:[1,1,1]
  v_pk_fma_f32 v[30:31], v[30:31], v[110:111], v[242:243] op_sel:[0,1,1] op_sel_hi:[1,1,1]
  v_pk_fma_f32 v[60:61], v[60:61], v[110:111], v[242:243] op_sel:[0,1,1] op_sel_hi:[1,1,1]
  v_pk_fma_f32 v[62:63], v[62:63], v[110:111], v[242:243] op_sel:[0,1,1] op_sel_hi:[1,1,1]
  v_exp_f32 v28, v28
  v_exp_f32 v29, v29
  v_exp_f32 v30, v30
  v_exp_f32 v31, v31
  v_exp_f32 v60, v60
  v_exp_f32 v61, v61
  v_exp_f32 v62, v62
  v_exp_f32 v63, v63
  v_cvt_pk_bf16_f32 v12, v28, v29
  v_cvt_pk_bf16_f32 v13, v30, v31
  v_cvt_pk_bf16_f32 v14, v60, v61
  v_cvt_pk_bf16_f32 v15, v62, v63
  s_add_u32 m0, s89, 36864
  s_xor_b32 s92, s88, 589824
  buffer_load_dwordx4 v186, s[12:15], s92 offen lds
  v_mfma_f32_16x16x32_bf16 v[32:35], v[160:163], v[0:3], 0
  s_lshl_b32 s43, s74, 15
  s_lshl_b32 s44, s75, 10
  v_mfma_f32_16x16x32_bf16 v[36:39], v[160:163], v[4:7], 0
  s_add_u32 s43, s43, s44
  s_add_u32 s43, s43, s42
  v_mfma_f32_16x16x32_bf16 v[40:43], v[160:163], v[8:11], 0
  s_add_u32 s46, s43, 8388608
  s_add_u32 s47, s46, 32768
  v_mfma_f32_16x16x32_bf16 v[44:47], v[160:163], v[12:15], 0
  s_add_u32 s48, s47, 32768
  s_add_u32 s49, s48, 32768
  v_mfma_f32_16x16x32_bf16 v[64:67], v[140:143], v[0:3], 0
  s_lshl_b32 s77, s50, 1
  v_mfma_f32_16x16x32_bf16 v[80:83], v[150:153], v[0:3], 0
  s_lshr_b32 s43, s51, 3
  v_mfma_f32_16x16x32_bf16 v[68:71], v[142:145], v[4:7], 0
  s_add_u32 s77, s77, s43
  v_mfma_f32_16x16x32_bf16 v[84:87], v[152:155], v[4:7], 0
  s_lshl_b32 s77, s77, 7
  v_mfma_f32_16x16x32_bf16 v[72:75], v[144:147], v[8:11], 0
  s_add_u32 s77, s77, s42
  v_rcp_f32 v32, v32
  v_mfma_f32_16x16x32_bf16 v[88:91], v[154:157], v[8:11], 0
  s_add_u32 s77, s77, 27787264
  v_rcp_f32 v36, v36
  v_mfma_f32_16x16x32_bf16 v[76:79], v[146:149], v[12:15], 0
  v_rcp_f32 v40, v40
  v_mfma_f32_16x16x32_bf16 v[92:95], v[156:159], v[12:15], 0
  v_rcp_f32 v44, v44
  v_pk_mul_f32 v[64:65], v[64:65], v[32:33] op_sel:[0,0] op_sel_hi:[1,0]
  v_pk_mul_f32 v[66:67], v[66:67], v[32:33] op_sel:[0,0] op_sel_hi:[1,0]
  v_pk_mul_f32 v[80:81], v[80:81], v[32:33] op_sel:[0,0] op_sel_hi:[1,0]
  v_pk_mul_f32 v[82:83], v[82:83], v[32:33] op_sel:[0,0] op_sel_hi:[1,0]
  v_cvt_pk_bf16_f32 v16, v64, v65
  v_cvt_pk_bf16_f32 v17, v66, v67
  v_cvt_pk_bf16_f32 v18, v80, v81
  v_cvt_pk_bf16_f32 v19, v82, v83
  buffer_store_dwordx4 v[16:19], v104, s[4:7], s46 offen sc1
  v_pk_mul_f32 v[68:69], v[68:69], v[36:37] op_sel:[0,0] op_sel_hi:[1,0]
  v_pk_mul_f32 v[70:71], v[70:71], v[36:37] op_sel:[0,0] op_sel_hi:[1,0]
  v_pk_mul_f32 v[84:85], v[84:85], v[36:37] op_sel:[0,0] op_sel_hi:[1,0]
  v_pk_mul_f32 v[86:87], v[86:87], v[36:37] op_sel:[0,0] op_sel_hi:[1,0]
  v_cvt_pk_bf16_f32 v20, v68, v69
  v_cvt_pk_bf16_f32 v21, v70, v71
  v_cvt_pk_bf16_f32 v22, v84, v85
  v_cvt_pk_bf16_f32 v23, v86, v87
  buffer_store_dwordx4 v[20:23], v104, s[4:7], s47 offen sc1
  v_pk_mul_f32 v[72:73], v[72:73], v[40:41] op_sel:[0,0] op_sel_hi:[1,0]
  v_pk_mul_f32 v[74:75], v[74:75], v[40:41] op_sel:[0,0] op_sel_hi:[1,0]
  v_pk_mul_f32 v[88:89], v[88:89], v[40:41] op_sel:[0,0] op_sel_hi:[1,0]
  v_pk_mul_f32 v[90:91], v[90:91], v[40:41] op_sel:[0,0] op_sel_hi:[1,0]
  v_cvt_pk_bf16_f32 v24, v72, v73
  v_cvt_pk_bf16_f32 v25, v74, v75
  v_cvt_pk_bf16_f32 v26, v88, v89
  v_cvt_pk_bf16_f32 v27, v90, v91
  buffer_store_dwordx4 v[24:27], v104, s[4:7], s48 offen sc1
  v_pk_mul_f32 v[76:77], v[76:77], v[44:45] op_sel:[0,0] op_sel_hi:[1,0]
  v_pk_mul_f32 v[78:79], v[78:79], v[44:45] op_sel:[0,0] op_sel_hi:[1,0]
  v_pk_mul_f32 v[92:93], v[92:93], v[44:45] op_sel:[0,0] op_sel_hi:[1,0]
  v_pk_mul_f32 v[94:95], v[94:95], v[44:45] op_sel:[0,0] op_sel_hi:[1,0]
  v_cvt_pk_bf16_f32 v28, v76, v77
  v_cvt_pk_bf16_f32 v29, v78, v79
  v_cvt_pk_bf16_f32 v30, v92, v93
  v_cvt_pk_bf16_f32 v31, v94, v95
  buffer_store_dwordx4 v[28:31], v104, s[4:7], s49 offen sc1
Lmk_p1end:
  s_lshl_b32 s44, s52, 3
  s_lshl_b32 s43, s40, 1
  s_add_u32 s44, s44, s43
  s_lshl_b32 s45, s44, 15
  s_add_u32 s57, s45, s42
  s_add_u32 s57, s57, 8388608
  s_lshl_b32 s43, s53, 11
  s_add_u32 s45, s45, s43
  s_add_u32 s45, s45, s42
  s_add_u32 s58, s45, 4194304
  s_add_u32 s59, s58, 32768
  s_lshl_b32 s44, s44, 11
  s_lshl_b32 s43, s53, 7
  s_add_u32 s44, s44, s43
  s_add_u32 s44, s44, s42
  s_add_u32 s60, s44, 27525120
  v_lshlrev_b32 v48, 4, v253
  v_add_u32 v49, 32768, v48
  s_cmp_eq_u32 s41, 0
  s_cselect_b32 s44, 32, 8
  s_cselect_b32 s45, 64, 0x400
  s_lshl_b32 s43, s40, 12
  s_add_u32 s43, s43, 90112
  v_xor_b32 v3, s44, v187
  v_xor_b32 v4, s45, v187
  v_xor_b32 v5, s45, v3
  v_add_u32 v2, s43, v187
  v_add_u32 v3, s43, v3
  v_add_u32 v4, s43, v4
  v_add_u32 v5, s43, v5
  s_waitcnt vmcnt(22)
  ds_read_b64 v[52:53], v2 offset:0
  ds_read_b64 v[54:55], v3 offset:0
  ds_read_b64 v[56:57], v4 offset:0
  ds_read_b64 v[58:59], v5 offset:0
  ds_read_b64 v[60:61], v2 offset:2048
  ds_read_b64 v[62:63], v3 offset:2048
  ds_read_b64 v[64:65], v4 offset:2048
  ds_read_b64 v[66:67], v5 offset:2048
  v_lshrrev_b32 v2, 2, v253
  v_bfe_u32 v3, v253, 3, 2
  v_and_b32 v4, 3, v253
  v_lshlrev_b32 v4, 3, v4
  v_lshl_add_u32 v4, v2, 7, v4
  v_xor_b32 v5, 0, v3
  v_lshl_add_u32 v40, v5, 5, v4
  v_xor_b32 v5, 1, v3
  v_lshl_add_u32 v41, v5, 5, v4
  v_xor_b32 v5, 2, v3
  v_lshl_add_u32 v42, v5, 5, v4
  v_xor_b32 v5, 3, v3
  v_lshl_add_u32 v43, v5, 5, v4
  s_cmp_lg_u32 s3, 0
  s_cbranch_scc1 Lc10_c
Lc10_r:
  s_waitcnt lgkmcnt(0)
  s_waitcnt vmcnt(0)
  s_barrier
  s_cmp_lg_u32 s40, 0
  s_cbranch_scc1 Lsig9
  v_mov_b32 v250, 1
  s_mov_b64 exec, 1
  buffer_atomic_add v250, v251, s[4:7], s77 offen sc1
  s_mov_b64 exec, -1
Lsig9:
  s_add_u32 m0, s89, 73728
  s_xor_b32 s92, s88, 1179648
  buffer_load_dwordx4 v186, s[12:15], s92 offen lds
  s_add_u32 m0, s89, 77824
  s_xor_b32 s92, s88, 1245184
  buffer_load_dwordx4 v186, s[12:15], s92 offen lds
  s_add_u32 m0, s89, 81920
  s_xor_b32 s92, s88, 1310720
  buffer_load_dwordx4 v186, s[12:15], s92 offen lds
  s_add_u32 m0, s89, 86016
  s_xor_b32 s92, s88, 1376256
  buffer_load_dwordx4 v186, s[12:15], s92 offen lds
  s_add_u32 m0, s89, 90112
  s_xor_b32 s92, s88, 1441792
  buffer_load_dwordx4 v186, s[12:15], s92 offen lds
  s_add_u32 m0, s89, 94208
  s_xor_b32 s92, s88, 1507328
  buffer_load_dwordx4 v186, s[12:15], s92 offen lds
  s_add_u32 m0, s89, 98304
  s_xor_b32 s92, s88, 1572864
  buffer_load_dwordx4 v186, s[12:15], s92 offen lds
  s_add_u32 m0, s89, 102400
  s_xor_b32 s92, s88, 1638400
  buffer_load_dwordx4 v186, s[12:15], s92 offen lds
  s_add_u32 m0, s89, 106496
  s_xor_b32 s92, s88, 1703936
  buffer_load_dwordx4 v186, s[12:15], s92 offen lds
  s_add_u32 m0, s89, 110592
  s_xor_b32 s92, s88, 1769472
  buffer_load_dwordx4 v186, s[12:15], s92 offen lds
  s_add_u32 m0, s89, 114688
  s_xor_b32 s92, s88, 1835008
  buffer_load_dwordx4 v186, s[12:15], s92 offen lds
  s_add_u32 m0, s89, 118784
  s_xor_b32 s92, s88, 1900544
  buffer_load_dwordx4 v186, s[12:15], s92 offen lds
  s_add_u32 m0, s89, 122880
  s_xor_b32 s92, s88, 1966080
  buffer_load_dwordx4 v186, s[12:15], s92 offen lds
  s_add_u32 m0, s89, 126976
  s_xor_b32 s92, s88, 2031616
  buffer_load_dwordx4 v186, s[12:15], s92 offen lds
  v_lshlrev_b32 v0, 16, v52
  v_and_b32 v1, 0xffff0000, v52
  v_lshlrev_b32 v2, 16, v53
  v_and_b32 v3, 0xffff0000, v53
  v_lshlrev_b32 v8, 16, v54
  v_and_b32 v9, 0xffff0000, v54
  v_lshlrev_b32 v10, 16, v55
  v_and_b32 v11, 0xffff0000, v55
  v_lshlrev_b32 v16, 16, v56
  v_and_b32 v17, 0xffff0000, v56
  v_lshlrev_b32 v18, 16, v57
  v_and_b32 v19, 0xffff0000, v57
  v_lshlrev_b32 v24, 16, v58
  v_and_b32 v25, 0xffff0000, v58
  v_lshlrev_b32 v26, 16, v59
  v_and_b32 v27, 0xffff0000, v59
  v_lshlrev_b32 v4, 16, v60
  v_and_b32 v5, 0xffff0000, v60
  v_lshlrev_b32 v6, 16, v61
  v_and_b32 v7, 0xffff0000, v61
  v_lshlrev_b32 v12, 16, v62
  v_and_b32 v13, 0xffff0000, v62
  v_lshlrev_b32 v14, 16, v63
  v_and_b32 v15, 0xffff0000, v63
  v_lshlrev_b32 v20, 16, v64
  v_and_b32 v21, 0xffff0000, v64
  v_lshlrev_b32 v22, 16, v65
  v_and_b32 v23, 0xffff0000, v65
  v_lshlrev_b32 v28, 16, v66
  v_and_b32 v29, 0xffff0000, v66
  v_lshlrev_b32 v30, 16, v67
  v_and_b32 v31, 0xffff0000, v67
  v_and_b32 v92, 15, v253
  v_lshrrev_b32 v93, 4, v253
  v_lshrrev_b32 v72, 2, v92
  v_cmp_eq_u32 vcc, v72, v93
  v_and_b32 v72, 3, v92
  v_lshlrev_b32 v92, 3, v92
  v_mov_b32 v93, 0x7ffffff0
  v_cndmask_b32 v92, v93, v92, vcc
  v_cmp_eq_u32 s[64:65], 1, v72
  v_cmp_eq_u32 s[66:67], 2, v72
  v_cmp_eq_u32 s[68:69], 3, v72
  v_mov_b32 v72, 0x3f803f80
  v_mov_b32 v73, 0x3f803f80
  v_mov_b32 v74, 0x3f803f80
  v_mov_b32 v75, 0x3f803f80
  s_cmp_lg_u32 s3, 0
  s_cbranch_scc1 Lc11_c
Lc11_r:
  s_lshl_b32 s77, s52, 8
  s_add_u32 s77, s77, 27787264
  v_lshlrev_b32 v249, 7, v253
  s_add_u32 s77, s77, s42
  s_cmp_lg_u32 s40, 0
  s_cbranch_scc1 Lpdn13
  s_mov_b32 s43, 0x40000
  s_mov_b64 exec, 3
Lpol12:
  v_mov_b32 v250, 0
  buffer_atomic_add v250, v249, s[4:7], s77 offen sc0 sc1
  s_waitcnt vmcnt(0)
  v_cmp_gt_u32 vcc, 8, v250
  s_cbranch_vccz Lpdn13x
  s_sub_u32 s43, s43, 1
  s_cmp_lg_u32 s43, 0
  s_cbranch_scc1 Lpol12
Lpdn13x:
  s_mov_b64 exec, -1
Lpdn13:
  s_waitcnt vmcnt(0) lgkmcnt(0)
  s_barrier
  s_lshr_b32 s88, s88, 6
  s_xor_b32 s93, s57, s88
  buffer_load_dwordx4 a[0:3], v48, s[4:7], s93 offen offset:0 sc1
  buffer_load_dwordx4 a[4:7], v49, s[4:7], s93 offen offset:0 sc1
  buffer_load_dwordx4 a[8:11], v48, s[4:7], s93 offen offset:1024 sc1
  buffer_load_dwordx4 a[12:15], v49, s[4:7], s93 offen offset:1024 sc1
  buffer_load_dwordx4 a[16:19], v48, s[4:7], s93 offen offset:2048 sc1
  buffer_load_dwordx4 a[20:23], v49, s[4:7], s93 offen offset:2048 sc1
  buffer_load_dwordx4 a[24:27], v48, s[4:7], s93 offen offset:3072 sc1
  buffer_load_dwordx4 a[28:31], v49, s[4:7], s93 offen offset:3072 sc1
  s_add_u32 s57, s57, 4096
  s_xor_b32 s93, s57, s88
  buffer_load_dwordx4 a[32:35], v48, s[4:7], s93 offen offset:0 sc1
  buffer_load_dwordx4 a[36:39], v49, s[4:7], s93 offen offset:0 sc1
  buffer_load_dwordx4 a[40:43], v48, s[4:7], s93 offen offset:1024 sc1
  buffer_load_dwordx4 a[44:47], v49, s[4:7], s93 offen offset:1024 sc1
  s_cmp_eq_u32 s40, 1
  s_cselect_b32 s3, s3, 0
  s_cmp_lg_u32 s3, 0
  s_cbranch_scc1 Lc14_c
Lc14_r:
  ds_read_b64_tr_b16 a[128:129], v40 offset:0
  ds_read_b64_tr_b16 a[130:131], v40 offset:2048
  ds_read_b64_tr_b16 a[144:145], v40 offset:4096
  ds_read_b64_tr_b16 a[146:147], v40 offset:6144
  ds_read_b64_tr_b16 a[132:133], v41 offset:0
  ds_read_b64_tr_b16 a[134:135], v41 offset:2048
  ds_read_b64_tr_b16 a[148:149], v41 offset:4096
  ds_read_b64_tr_b16 a[150:151], v41 offset:6144
  ds_read_b64_tr_b16 a[136:137], v42 offset:0
  ds_read_b64_tr_b16 a[138:139], v42 offset:2048
  ds_read_b64_tr_b16 a[152:153], v42 offset:4096
  ds_read_b64_tr_b16 a[154:155], v42 offset:6144
  ds_read_b64_tr_b16 a[140:141], v43 offset:0
  ds_read_b64_tr_b16 a[142:143], v43 offset:2048
  ds_read_b64_tr_b16 a[156:157], v43 offset:4096
  ds_read_b64_tr_b16 a[158:159], v43 offset:6144
  s_and_b32 s43, s53, 0
  s_mul_i32 s77, s52, 1
  s_add_u32 s77, s77, s43
  s_lshl_b32 s77, s77, 7
  s_add_u32 s77, s77, s42
  s_add_u32 s77, s77, 27791360
  s_mov_b32 s56, 3
.p2align 3
Lp2_loop:
  s_waitcnt vmcnt(8) lgkmcnt(8)
  v_mfma_f32_16x16x32_bf16 v[0:3], a[128:131], a[0:3], v[0:3]
  ds_read_b64_tr_b16 a[160:161], v40 offset:8192
  v_mfma_f32_16x16x32_bf16 v[0:3], a[144:147], a[8:11], v[0:3]
  ds_read_b64_tr_b16 a[162:163], v40 offset:10240
  buffer_load_dwordx4 a[48:51], v48, s[4:7], s93 offen offset:2048 sc1
  v_mfma_f32_16x16x32_bf16 v[4:7], a[144:147], a[12:15], v[4:7]
  ds_read_b64_tr_b16 a[176:177], v40 offset:12288
  v_mfma_f32_16x16x32_bf16 v[4:7], a[128:131], a[4:7], v[4:7]
  ds_read_b64_tr_b16 a[178:179], v40 offset:14336
  v_mfma_f32_16x16x32_bf16 v[12:15], a[132:135], a[4:7], v[12:15]
  ds_read_b64_tr_b16 a[164:165], v41 offset:8192
  v_mfma_f32_16x16x32_bf16 v[12:15], a[148:151], a[12:15], v[12:15]
  ds_read_b64_tr_b16 a[166:167], v41 offset:10240
  buffer_load_dwordx4 a[52:55], v49, s[4:7], s93 offen offset:2048 sc1
  v_mfma_f32_16x16x32_bf16 v[8:11], a[148:151], a[8:11], v[8:11]
  ds_read_b64_tr_b16 a[180:181], v41 offset:12288
  v_mfma_f32_16x16x32_bf16 v[8:11], a[132:135], a[0:3], v[8:11]
  ds_read_b64_tr_b16 a[182:183], v41 offset:14336
  s_waitcnt lgkmcnt(8)
  v_mfma_f32_16x16x32_bf16 v[16:19], a[136:139], a[0:3], v[16:19]
  ds_read_b64_tr_b16 a[168:169], v42 offset:8192
  v_mfma_f32_16x16x32_bf16 v[16:19], a[152:155], a[8:11], v[16:19]
  ds_read_b64_tr_b16 a[170:171], v42 offset:10240
  buffer_load_dwordx4 a[56:59], v48, s[4:7], s93 offen offset:3072 sc1
  v_mfma_f32_16x16x32_bf16 v[20:23], a[152:155], a[12:15], v[20:23]
  ds_read_b64_tr_b16 a[184:185], v42 offset:12288
  v_mfma_f32_16x16x32_bf16 v[20:23], a[136:139], a[4:7], v[20:23]
  ds_read_b64_tr_b16 a[186:187], v42 offset:14336
  v_mfma_f32_16x16x32_bf16 v[28:31], a[140:143], a[4:7], v[28:31]
  ds_read_b64_tr_b16 a[172:173], v43 offset:8192
  v_mfma_f32_16x16x32_bf16 v[28:31], a[156:159], a[12:15], v[28:31]
  ds_read_b64_tr_b16 a[174:175], v43 offset:10240
  buffer_load_dwordx4 a[60:63], v49, s[4:7], s93 offen offset:3072 sc1
  v_mfma_f32_16x16x32_bf16 v[24:27], a[156:159], a[8:11], v[24:27]
  ds_read_b64_tr_b16 a[188:189], v43 offset:12288
  v_mfma_f32_16x16x32_bf16 v[24:27], a[140:143], a[0:3], v[24:27]
  ds_read_b64_tr_b16 a[190:191], v43 offset:14336
  s_waitcnt vmcnt(8) lgkmcnt(8)
  v_mfma_f32_16x16x32_bf16 v[0:3], a[160:163], a[16:19], v[0:3]
  ds_read_b64_tr_b16 a[128:129], v40 offset:16384
  v_mfma_f32_16x16x32_bf16 v[0:3], a[176:179], a[24:27], v[0:3]
  s_add_u32 s57, s57, 4096
  s_xor_b32 s93, s57, s88
  ds_read_b64_tr_b16 a[130:131], v40 offset:18432
  v_mfma_f32_16x16x32_bf16 v[4:7], a[176:179], a[28:31], v[4:7]
  buffer_load_dwordx4 a[0:3], v48, s[4:7], s93 offen offset:0 sc1
  ds_read_b64_tr_b16 a[144:145], v40 offset:20480
  v_mfma_f32_16x16x32_bf16 v[4:7], a[160:163], a[20:23], v[4:7]
  ds_read_b64_tr_b16 a[146:147], v40 offset:22528
  v_mfma_f32_16x16x32_bf16 v[12:15], a[164:167], a[20:23], v[12:15]
  ds_read_b64_tr_b16 a[132:133], v41 offset:16384
  v_mfma_f32_16x16x32_bf16 v[12:15], a[180:183], a[28:31], v[12:15]
  ds_read_b64_tr_b16 a[134:135], v41 offset:18432
  buffer_load_dwordx4 a[4:7], v49, s[4:7], s93 offen offset:0 sc1
  v_mfma_f32_16x16x32_bf16 v[8:11], a[180:183], a[24:27], v[8:11]
  ds_read_b64_tr_b16 a[148:149], v41 offset:20480
  v_mfma_f32_16x16x32_bf16 v[8:11], a[164:167], a[16:19], v[8:11]
  ds_read_b64_tr_b16 a[150:151], v41 offset:22528
  s_waitcnt lgkmcnt(8)
  v_mfma_f32_16x16x32_bf16 v[16:19], a[168:171], a[16:19], v[16:19]
  ds_read_b64_tr_b16 a[136:137], v42 offset:16384
  v_mfma_f32_16x16x32_bf16 v[16:19], a[184:187], a[24:27], v[16:19]
  ds_read_b64_tr_b16 a[138:139], v42 offset:18432
  buffer_load_dwordx4 a[8:11], v48, s[4:7], s93 offen offset:1024 sc1
  v_mfma_f32_16x16x32_bf16 v[20:23], a[184:187], a[28:31], v[20:23]
  ds_read_b64_tr_b16 a[152:153], v42 offset:20480
  v_mfma_f32_16x16x32_bf16 v[20:23], a[168:171], a[20:23], v[20:23]
  ds_read_b64_tr_b16 a[154:155], v42 offset:22528
  v_mfma_f32_16x16x32_bf16 v[28:31], a[172:175], a[20:23], v[28:31]
  ds_read_b64_tr_b16 a[140:141], v43 offset:16384
  v_mfma_f32_16x16x32_bf16 v[28:31], a[188:191], a[28:31], v[28:31]
  ds_read_b64_tr_b16 a[142:143], v43 offset:18432
  buffer_load_dwordx4 a[12:15], v49, s[4:7], s93 offen offset:1024 sc1
  v_mfma_f32_16x16x32_bf16 v[24:27], a[188:191], a[24:27], v[24:27]
  ds_read_b64_tr_b16 a[156:157], v43 offset:20480
  v_mfma_f32_16x16x32_bf16 v[24:27], a[172:175], a[16:19], v[24:27]
  ds_read_b64_tr_b16 a[158:159], v43 offset:22528
  s_waitcnt vmcnt(8) lgkmcnt(8)
  v_mfma_f32_16x16x32_bf16 v[0:3], a[128:131], a[32:35], v[0:3]
  ds_read_b64_tr_b16 a[160:161], v40 offset:24576
  v_mfma_f32_16x16x32_bf16 v[0:3], a[144:147], a[40:43], v[0:3]
  ds_read_b64_tr_b16 a[162:163], v40 offset:26624
  buffer_load_dwordx4 a[16:19], v48, s[4:7], s93 offen offset:2048 sc1
  v_mfma_f32_16x16x32_bf16 v[4:7], a[144:147], a[44:47], v[4:7]
  ds_read_b64_tr_b16 a[176:177], v40 offset:28672
  v_mfma_f32_16x16x32_bf16 v[4:7], a[128:131], a[36:39], v[4:7]
  ds_read_b64_tr_b16 a[178:179], v40 offset:30720
  v_add_u32 v40, 32768, v40
  v_mfma_f32_16x16x32_bf16 v[12:15], a[132:135], a[36:39], v[12:15]
  ds_read_b64_tr_b16 a[164:165], v41 offset:24576
  v_mfma_f32_16x16x32_bf16 v[12:15], a[148:151], a[44:47], v[12:15]
  ds_read_b64_tr_b16 a[166:167], v41 offset:26624
  buffer_load_dwordx4 a[20:23], v49, s[4:7], s93 offen offset:2048 sc1
  v_mfma_f32_16x16x32_bf16 v[8:11], a[148:151], a[40:43], v[8:11]
  ds_read_b64_tr_b16 a[180:181], v41 offset:28672
  v_mfma_f32_16x16x32_bf16 v[8:11], a[132:135], a[32:35], v[8:11]
  s_waitcnt lgkmcnt(7)
  ds_read_b64_tr_b16 a[182:183], v41 offset:30720
  v_add_u32 v41, 32768, v41
  v_mfma_f32_16x16x32_bf16 v[16:19], a[136:139], a[32:35], v[16:19]
  ds_read_b64_tr_b16 a[168:169], v42 offset:24576
  v_mfma_f32_16x16x32_bf16 v[16:19], a[152:155], a[40:43], v[16:19]
  ds_read_b64_tr_b16 a[170:171], v42 offset:26624
  buffer_load_dwordx4 a[24:27], v48, s[4:7], s93 offen offset:3072 sc1
  v_mfma_f32_16x16x32_bf16 v[20:23], a[152:155], a[44:47], v[20:23]
  ds_read_b64_tr_b16 a[184:185], v42 offset:28672
  v_mfma_f32_16x16x32_bf16 v[20:23], a[136:139], a[36:39], v[20:23]
  ds_read_b64_tr_b16 a[186:187], v42 offset:30720
  v_add_u32 v42, 32768, v42
  v_mfma_f32_16x16x32_bf16 v[28:31], a[140:143], a[36:39], v[28:31]
  ds_read_b64_tr_b16 a[172:173], v43 offset:24576
  v_mfma_f32_16x16x32_bf16 v[28:31], a[156:159], a[44:47], v[28:31]
  ds_read_b64_tr_b16 a[174:175], v43 offset:26624
  buffer_load_dwordx4 a[28:31], v49, s[4:7], s93 offen offset:3072 sc1
  v_mfma_f32_16x16x32_bf16 v[24:27], a[156:159], a[40:43], v[24:27]
  ds_read_b64_tr_b16 a[188:189], v43 offset:28672
  v_mfma_f32_16x16x32_bf16 v[24:27], a[140:143], a[32:35], v[24:27]
  s_waitcnt vmcnt(8) lgkmcnt(7)
  ds_read_b64_tr_b16 a[190:191], v43 offset:30720
  v_add_u32 v43, 32768, v43
  v_mfma_f32_16x16x32_bf16 v[0:3], a[160:163], a[48:51], v[0:3]
  ds_read_b64_tr_b16 a[128:129], v40 offset:0
  v_mfma_f32_16x16x32_bf16 v[0:3], a[176:179], a[56:59], v[0:3]
  s_add_u32 s57, s57, 4096
  s_xor_b32 s93, s57, s88
  ds_read_b64_tr_b16 a[130:131], v40 offset:2048
  v_mfma_f32_16x16x32_bf16 v[4:7], a[176:179], a[60:63], v[4:7]
  buffer_load_dwordx4 a[32:35], v48, s[4:7], s93 offen offset:0 sc1
  ds_read_b64_tr_b16 a[144:145], v40 offset:4096
  v_mfma_f32_16x16x32_bf16 v[4:7], a[160:163], a[52:55], v[4:7]
  ds_read_b64_tr_b16 a[146:147], v40 offset:6144
  v_mfma_f32_16x16x32_bf16 v[12:15], a[164:167], a[52:55], v[12:15]
  ds_read_b64_tr_b16 a[132:133], v41 offset:0
  v_mfma_f32_16x16x32_bf16 v[12:15], a[180:183], a[60:63], v[12:15]
  ds_read_b64_tr_b16 a[134:135], v41 offset:2048
  buffer_load_dwordx4 a[36:39], v49, s[4:7], s93 offen offset:0 sc1
  v_mfma_f32_16x16x32_bf16 v[8:11], a[180:183], a[56:59], v[8:11]
  ds_read_b64_tr_b16 a[148:149], v41 offset:4096
  v_mfma_f32_16x16x32_bf16 v[8:11], a[164:167], a[48:51], v[8:11]
  ds_read_b64_tr_b16 a[150:151], v41 offset:6144
  s_waitcnt lgkmcnt(8)
  v_mfma_f32_16x16x32_bf16 v[16:19], a[168:171], a[48:51], v[16:19]
  ds_read_b64_tr_b16 a[136:137], v42 offset:0
  v_mfma_f32_16x16x32_bf16 v[16:19], a[184:187], a[56:59], v[16:19]
  ds_read_b64_tr_b16 a[138:139], v42 offset:2048
  buffer_load_dwordx4 a[40:43], v48, s[4:7], s93 offen offset:1024 sc1
  v_mfma_f32_16x16x32_bf16 v[20:23], a[184:187], a[60:63], v[20:23]
  ds_read_b64_tr_b16 a[152:153], v42 offset:4096
  v_mfma_f32_16x16x32_bf16 v[20:23], a[168:171], a[52:55], v[20:23]
  ds_read_b64_tr_b16 a[154:155], v42 offset:6144
  v_mfma_f32_16x16x32_bf16 v[28:31], a[172:175], a[52:55], v[28:31]
  ds_read_b64_tr_b16 a[140:141], v43 offset:0
  v_mfma_f32_16x16x32_bf16 v[28:31], a[188:191], a[60:63], v[28:31]
  s_sub_u32 s56, s56, 1
  ds_read_b64_tr_b16 a[142:143], v43 offset:2048
  buffer_load_dwordx4 a[44:47], v49, s[4:7], s93 offen offset:1024 sc1
  v_mfma_f32_16x16x32_bf16 v[24:27], a[188:191], a[56:59], v[24:27]
  s_cmp_lg_u32 s56, 0
  ds_read_b64_tr_b16 a[156:157], v43 offset:4096
  v_mfma_f32_16x16x32_bf16 v[24:27], a[172:175], a[48:51], v[24:27]
  ds_read_b64_tr_b16 a[158:159], v43 offset:6144
  s_cbranch_scc1 Lp2_loop
Lmk_Lp2_loop_tail:
  s_waitcnt vmcnt(8) lgkmcnt(8)
  v_mfma_f32_16x16x32_bf16 v[0:3], a[128:131], a[0:3], v[0:3]
  ds_read_b64_tr_b16 a[160:161], v40 offset:8192
  v_mfma_f32_16x16x32_bf16 v[0:3], a[144:147], a[8:11], v[0:3]
  ds_read_b64_tr_b16 a[162:163], v40 offset:10240
  buffer_load_dwordx4 a[48:51], v48, s[4:7], s93 offen offset:2048 sc1
  v_mfma_f32_16x16x32_bf16 v[4:7], a[144:147], a[12:15], v[4:7]
  ds_read_b64_tr_b16 a[176:177], v40 offset:12288
  v_mfma_f32_16x16x32_bf16 v[4:7], a[128:131], a[4:7], v[4:7]
  ds_read_b64_tr_b16 a[178:179], v40 offset:14336
  v_mfma_f32_16x16x32_bf16 v[12:15], a[132:135], a[4:7], v[12:15]
  ds_read_b64_tr_b16 a[164:165], v41 offset:8192
  v_mfma_f32_16x16x32_bf16 v[12:15], a[148:151], a[12:15], v[12:15]
  ds_read_b64_tr_b16 a[166:167], v41 offset:10240
  buffer_load_dwordx4 a[52:55], v49, s[4:7], s93 offen offset:2048 sc1
  v_mfma_f32_16x16x32_bf16 v[8:11], a[148:151], a[8:11], v[8:11]
  ds_read_b64_tr_b16 a[180:181], v41 offset:12288
  v_mfma_f32_16x16x32_bf16 v[8:11], a[132:135], a[0:3], v[8:11]
  ds_read_b64_tr_b16 a[182:183], v41 offset:14336
  s_waitcnt lgkmcnt(8)
  v_mfma_f32_16x16x32_bf16 v[16:19], a[136:139], a[0:3], v[16:19]
  ds_read_b64_tr_b16 a[168:169], v42 offset:8192
  v_mfma_f32_16x16x32_bf16 v[16:19], a[152:155], a[8:11], v[16:19]
  ds_read_b64_tr_b16 a[170:171], v42 offset:10240
  buffer_load_dwordx4 a[56:59], v48, s[4:7], s93 offen offset:3072 sc1
  v_mfma_f32_16x16x32_bf16 v[20:23], a[152:155], a[12:15], v[20:23]
  ds_read_b64_tr_b16 a[184:185], v42 offset:12288
  v_mfma_f32_16x16x32_bf16 v[20:23], a[136:139], a[4:7], v[20:23]
  ds_read_b64_tr_b16 a[186:187], v42 offset:14336
  v_mfma_f32_16x16x32_bf16 v[28:31], a[140:143], a[4:7], v[28:31]
  ds_read_b64_tr_b16 a[172:173], v43 offset:8192
  v_mfma_f32_16x16x32_bf16 v[28:31], a[156:159], a[12:15], v[28:31]
  ds_read_b64_tr_b16 a[174:175], v43 offset:10240
  buffer_load_dwordx4 a[60:63], v49, s[4:7], s93 offen offset:3072 sc1
  v_mfma_f32_16x16x32_bf16 v[24:27], a[156:159], a[8:11], v[24:27]
  ds_read_b64_tr_b16 a[188:189], v43 offset:12288
  v_mfma_f32_16x16x32_bf16 v[24:27], a[140:143], a[0:3], v[24:27]
  ds_read_b64_tr_b16 a[190:191], v43 offset:14336
  s_waitcnt vmcnt(8) lgkmcnt(8)
  v_mfma_f32_16x16x32_bf16 v[0:3], a[160:163], a[16:19], v[0:3]
  ds_read_b64_tr_b16 a[128:129], v40 offset:16384
  v_mfma_f32_16x16x32_bf16 v[0:3], a[176:179], a[24:27], v[0:3]
  ds_read_b64_tr_b16 a[130:131], v40 offset:18432
  v_mfma_f32_16x16x32_bf16 v[4:7], a[176:179], a[28:31], v[4:7]
  ds_read_b64_tr_b16 a[144:145], v40 offset:20480
  v_mfma_f32_16x16x32_bf16 v[4:7], a[160:163], a[20:23], v[4:7]
  ds_read_b64_tr_b16 a[146:147], v40 offset:22528
  v_mfma_f32_16x16x32_bf16 v[12:15], a[164:167], a[20:23], v[12:15]
  ds_read_b64_tr_b16 a[132:133], v41 offset:16384
  v_mfma_f32_16x16x32_bf16 v[12:15], a[180:183], a[28:31], v[12:15]
  ds_read_b64_tr_b16 a[134:135], v41 offset:18432
  v_mfma_f32_16x16x32_bf16 v[8:11], a[180:183], a[24:27], v[8:11]
  ds_read_b64_tr_b16 a[148:149], v41 offset:20480
  v_mfma_f32_16x16x32_bf16 v[8:11], a[164:167], a[16:19], v[8:11]
  ds_read_b64_tr_b16 a[150:151], v41 offset:22528
  s_waitcnt lgkmcnt(8)
  v_mfma_f32_16x16x32_bf16 v[16:19], a[168:171], a[16:19], v[16:19]
  ds_read_b64_tr_b16 a[136:137], v42 offset:16384
  v_mfma_f32_16x16x32_bf16 v[16:19], a[184:187], a[24:27], v[16:19]
  ds_read_b64_tr_b16 a[138:139], v42 offset:18432
  v_mfma_f32_16x16x32_bf16 v[20:23], a[184:187], a[28:31], v[20:23]
  ds_read_b64_tr_b16 a[152:153], v42 offset:20480
  v_mfma_f32_16x16x32_bf16 v[20:23], a[168:171], a[20:23], v[20:23]
  ds_read_b64_tr_b16 a[154:155], v42 offset:22528
  v_mfma_f32_16x16x32_bf16 v[28:31], a[172:175], a[20:23], v[28:31]
  ds_read_b64_tr_b16 a[140:141], v43 offset:16384
  v_mfma_f32_16x16x32_bf16 v[28:31], a[188:191], a[28:31], v[28:31]
  ds_read_b64_tr_b16 a[142:143], v43 offset:18432
  v_mfma_f32_16x16x32_bf16 v[24:27], a[188:191], a[24:27], v[24:27]
  ds_read_b64_tr_b16 a[156:157], v43 offset:20480
  v_mfma_f32_16x16x32_bf16 v[24:27], a[172:175], a[16:19], v[24:27]
  ds_read_b64_tr_b16 a[158:159], v43 offset:22528
  s_waitcnt vmcnt(4) lgkmcnt(8)
  v_mfma_f32_16x16x32_bf16 v[0:3], a[128:131], a[32:35], v[0:3]
  ds_read_b64_tr_b16 a[160:161], v40 offset:24576
  v_mfma_f32_16x16x32_bf16 v[0:3], a[144:147], a[40:43], v[0:3]
  ds_read_b64_tr_b16 a[162:163], v40 offset:26624
  v_mfma_f32_16x16x32_bf16 v[4:7], a[144:147], a[44:47], v[4:7]
  ds_read_b64_tr_b16 a[176:177], v40 offset:28672
  v_mfma_f32_16x16x32_bf16 v[4:7], a[128:131], a[36:39], v[4:7]
  ds_read_b64_tr_b16 a[178:179], v40 offset:30720
  v_add_u32 v40, 32768, v40
  v_mfma_f32_16x16x32_bf16 v[12:15], a[132:135], a[36:39], v[12:15]
  ds_read_b64_tr_b16 a[164:165], v41 offset:24576
  v_mfma_f32_16x16x32_bf16 v[12:15], a[148:151], a[44:47], v[12:15]
  ds_read_b64_tr_b16 a[166:167], v41 offset:26624
  v_mfma_f32_16x16x32_bf16 v[8:11], a[148:151], a[40:43], v[8:11]
  ds_read_b64_tr_b16 a[180:181], v41 offset:28672
  v_mfma_f32_16x16x32_bf16 v[8:11], a[132:135], a[32:35], v[8:11]
  s_waitcnt lgkmcnt(7)
  ds_read_b64_tr_b16 a[182:183], v41 offset:30720
  v_add_u32 v41, 32768, v41
  v_mfma_f32_16x16x32_bf16 v[16:19], a[136:139], a[32:35], v[16:19]
  ds_read_b64_tr_b16 a[168:169], v42 offset:24576
  v_mfma_f32_16x16x32_bf16 v[16:19], a[152:155], a[40:43], v[16:19]
  ds_read_b64_tr_b16 a[170:171], v42 offset:26624
  v_mfma_f32_16x16x32_bf16 v[20:23], a[152:155], a[44:47], v[20:23]
  ds_read_b64_tr_b16 a[184:185], v42 offset:28672
  v_mfma_f32_16x16x32_bf16 v[20:23], a[136:139], a[36:39], v[20:23]
  ds_read_b64_tr_b16 a[186:187], v42 offset:30720
  v_add_u32 v42, 32768, v42
  v_mfma_f32_16x16x32_bf16 v[28:31], a[140:143], a[36:39], v[28:31]
  ds_read_b64_tr_b16 a[172:173], v43 offset:24576
  v_mfma_f32_16x16x32_bf16 v[28:31], a[156:159], a[44:47], v[28:31]
  ds_read_b64_tr_b16 a[174:175], v43 offset:26624
  v_mfma_f32_16x16x32_bf16 v[24:27], a[156:159], a[40:43], v[24:27]
  ds_read_b64_tr_b16 a[188:189], v43 offset:28672
  v_mfma_f32_16x16x32_bf16 v[24:27], a[140:143], a[32:35], v[24:27]
  s_waitcnt vmcnt(0) lgkmcnt(7)
  ds_read_b64_tr_b16 a[190:191], v43 offset:30720
  v_add_u32 v43, 32768, v43
  v_mfma_f32_16x16x32_bf16 v[0:3], a[160:163], a[48:51], v[0:3]
  v_mfma_f32_16x16x32_bf16 v[0:3], a[176:179], a[56:59], v[0:3]
  v_mfma_f32_16x16x32_bf16 v[4:7], a[176:179], a[60:63], v[4:7]
  v_mfma_f32_16x16x32_bf16 v[4:7], a[160:163], a[52:55], v[4:7]
  v_mfma_f32_16x16x32_bf16 v[12:15], a[164:167], a[52:55], v[12:15]
  v_mfma_f32_16x16x32_bf16 v[12:15], a[180:183], a[60:63], v[12:15]
  v_mfma_f32_16x16x32_bf16 v[8:11], a[180:183], a[56:59], v[8:11]
  v_mfma_f32_16x16x32_bf16 v[8:11], a[164:167], a[48:51], v[8:11]
  s_waitcnt lgkmcnt(0)
  v_mfma_f32_16x16x32_bf16 v[16:19], a[168:171], a[48:51], v[16:19]
  s_nop 0
  v_mfma_f32_16x16x32_bf16 v[16:19], a[184:187], a[56:59], v[16:19]
  s_nop 0
  v_mfma_f32_16x16x32_bf16 v[20:23], a[184:187], a[60:63], v[20:23]
  s_nop 0
  v_mfma_f32_16x16x32_bf16 v[20:23], a[168:171], a[52:55], v[20:23]
  v_cvt_pk_bf16_f32 v60, v4, v5
  v_cvt_pk_bf16_f32 v61, v6, v7
  v_mfma_f32_16x16x32_bf16 v[28:31], a[172:175], a[52:55], v[28:31]
  v_cvt_pk_bf16_f32 v62, v12, v13
  v_cvt_pk_bf16_f32 v63, v14, v15
  v_mfma_f32_16x16x32_bf16 v[28:31], a[188:191], a[60:63], v[28:31]
  buffer_store_dwordx4 v[60:63], v48, s[4:7], s59 offen offset:0 sc1
  v_mfma_f32_16x16x32_bf16 v[24:27], a[188:191], a[56:59], v[24:27]
  v_cvt_pk_bf16_f32 v52, v0, v1
  v_cvt_pk_bf16_f32 v53, v2, v3
  v_mfma_f32_16x16x32_bf16 v[24:27], a[172:175], a[48:51], v[24:27]
  v_cvt_pk_bf16_f32 v54, v8, v9
  v_cvt_pk_bf16_f32 v55, v10, v11
  v_mfma_f32_16x16x32_bf16 v[88:91], v[60:63], v[60:63], 0
  buffer_store_dwordx4 v[52:55], v48, s[4:7], s58 offen offset:0 sc1
  v_mfma_f32_16x16x32_bf16 v[84:87], v[72:75], v[60:63], 0
  v_cvt_pk_bf16_f32 v64, v20, v21
  v_mfma_f32_16x16x32_bf16 v[80:83], v[52:55], v[52:55], 0
  v_cvt_pk_bf16_f32 v65, v22, v23
  v_cvt_pk_bf16_f32 v66, v28, v29
  v_cvt_pk_bf16_f32 v67, v30, v31
  v_mfma_f32_16x16x32_bf16 v[76:79], v[72:75], v[52:55], 0
  buffer_store_dwordx4 v[64:67], v48, s[4:7], s59 offen offset:1024 sc1
  v_cvt_pk_bf16_f32 v56, v16, v17
  v_cvt_pk_bf16_f32 v57, v18, v19
  v_cvt_pk_bf16_f32 v58, v24, v25
  v_cvt_pk_bf16_f32 v59, v26, v27
  buffer_store_dwordx4 v[56:59], v48, s[4:7], s58 offen offset:1024 sc1
  s_nop 0
  v_mfma_f32_16x16x32_bf16 v[88:91], v[64:67], v[64:67], v[88:91]
  v_mfma_f32_16x16x32_bf16 v[84:87], v[72:75], v[64:67], v[84:87]
  v_mfma_f32_16x16x32_bf16 v[80:83], v[56:59], v[56:59], v[80:83]
  v_mfma_f32_16x16x32_bf16 v[76:79], v[72:75], v[56:59], v[76:79]
  s_nop 5
  v_cndmask_b32 v85, v88, v89, s[64:65]
  v_cndmask_b32 v85, v85, v90, s[66:67]
  v_cndmask_b32 v85, v85, v91, s[68:69]
  buffer_store_dwordx2 v[84:85], v92, s[4:7], s60 offen offset:2048 sc1
  v_cndmask_b32 v77, v80, v81, s[64:65]
  v_cndmask_b32 v77, v77, v82, s[66:67]
  v_cndmask_b32 v77, v77, v83, s[68:69]
  buffer_store_dwordx2 v[76:77], v92, s[4:7], s60 offen offset:0 sc1
  s_and_b32 s66, s55, 1
  v_lshrrev_b32 v2, 4, v253
  v_bfe_u32 v3, v253, 1, 3
  v_and_b32 v4, 1, v253
  v_lshlrev_b32 v4, 4, v4
  v_mul_u32_u24 v5, 7168, v2
  v_add_u32 v5, v5, v4
  s_cmp_eq_u32 s66, 0
  s_cselect_b32 s44, 7, 0
  v_mov_b32 v7, 0x40000000
  v_add_u32 v6, 0, v2
  v_xor_b32 v6, v6, v3
  v_cmp_eq_u32 vcc, s44, v6
  v_lshl_add_u32 v6, v6, 5, v5
  v_add_u32 v6, 0, v6
  v_cndmask_b32 v232, v6, v7, vcc
  v_add_u32 v6, 4, v2
  v_xor_b32 v6, v6, v3
  v_cmp_eq_u32 vcc, s44, v6
  v_lshl_add_u32 v6, v6, 5, v5
  v_add_u32 v6, 27648, v6
  v_cndmask_b32 v233, v6, v7, vcc
  v_add_u32 v6, 0, v2
  v_xor_b32 v6, v6, v3
  v_cmp_eq_u32 vcc, s44, v6
  v_lshl_add_u32 v6, v6, 5, v5
  v_add_u32 v6, 55296, v6
  v_cndmask_b32 v234, v6, v7, vcc
  v_add_u32 v6, 4, v2
  v_xor_b32 v6, v6, v3
  v_cmp_eq_u32 vcc, s44, v6
  v_lshl_add_u32 v6, v6, 5, v5
  v_add_u32 v6, 82944, v6
  v_cndmask_b32 v235, v6, v7, vcc
  s_mul_i32 s67, s55, 224
  s_and_b32 s67, s67, 0xffffffc0
  s_mul_i32 s43, s40, 114688
  s_add_u32 s67, s67, s43
  s_lshl_b32 s68, s40, 12
  v_lshlrev_b32 v231, 4, v253
  s_lshl_b32 s43, s41, 30
  v_or_b32 v236, s43, v231
  s_lshl_b32 s43, s2, 2
  s_add_u32 s43, s43, s40
  s_mul_i32 s70, s43, 7168
  s_lshl_b32 s69, s54, 2
  s_add_u32 s69, s69, s40
  s_lshl_b32 s72, s69, 17
  s_add_u32 s72, s72, s42
  s_add_u32 s72, s72, 4194304
  s_add_u32 s73, s72, 32768
  s_add_u32 s74, s73, 32768
  s_add_u32 s75, s74, 32768
  s_lshl_b32 s71, s40, 11
  s_add_u32 s71, s71, 131072
  v_lshrrev_b32 v2, 2, v253
  v_and_b32 v3, 7, v2
  v_and_b32 v4, 3, v253
  v_lshlrev_b32 v5, 3, v4
  v_lshl_add_u32 v5, v2, 8, v5
  s_lshl_b32 s43, s66, 1
  s_cmp_eq_u32 s66, 0
  s_cselect_b32 s45, 6, 1
  v_xor_b32 v6, s45, v3
  v_lshl_add_u32 v224, v6, 5, v5
  s_add_u32 s46, s43, 0
  v_xor_b32 v6, s46, v3
  v_lshl_add_u32 v225, v6, 5, v5
  s_add_u32 s46, s43, 1
  v_xor_b32 v6, s46, v3
  v_lshl_add_u32 v226, v6, 5, v5
  s_add_u32 s46, s43, 2
  v_xor_b32 v6, s46, v3
  v_lshl_add_u32 v227, v6, 5, v5
  s_add_u32 s46, s43, 3
  v_xor_b32 v6, s46, v3
  v_lshl_add_u32 v228, v6, 5, v5
  s_add_u32 s46, s43, 4
  v_xor_b32 v6, s46, v3
  v_lshl_add_u32 v229, v6, 5, v5
  s_add_u32 s46, s43, 5
  v_xor_b32 v6, s46, v3
  v_lshl_add_u32 v230, v6, 5, v5
  s_mul_i32 s46, s55, 448
  s_add_u32 s46, s46, 27918336
  s_add_u32 s47, s46, 28672
  s_lshr_b32 s48, s55, 3
  s_lshl_b32 s48, s48, 7
  s_add_u32 s48, s48, 27794432
  s_lshl_b32 s44, s69, 13
  s_add_u32 s44, s44, s42
  s_add_u32 s44, s44, 27525120
  s_add_u32 s45, s44, 4096
  s_waitcnt vmcnt(0)
  s_barrier
  s_cmp_lg_u32 s40, 0
  s_cbranch_scc1 Lsig15
  v_mov_b32 v250, 1
  s_mov_b64 exec, 1
  buffer_atomic_add v250, v251, s[4:7], s77 offen sc1
  s_mov_b64 exec, -1
Lsig15:
  s_cmp_lg_u32 s3, 0
  s_cbranch_scc1 Lc16_c
Lc16_r:
  s_add_u32 m0, s68, 0
  s_nop 0
  buffer_load_dwordx4 v232, s[16:19], s67 offen offset:0  lds
  buffer_load_dwordx4 v233, s[16:19], s67 offen offset:1024  lds
  buffer_load_dwordx4 v234, s[16:19], s67 offen offset:2048  lds
  buffer_load_dwordx4 v235, s[16:19], s67 offen offset:3072  lds
  s_add_u32 m0, s68, 16384
  s_nop 0
  buffer_load_dwordx4 v232, s[20:23], s67 offen offset:0  lds
  buffer_load_dwordx4 v233, s[20:23], s67 offen offset:1024  lds
  buffer_load_dwordx4 v234, s[20:23], s67 offen offset:2048  lds
  buffer_load_dwordx4 v235, s[20:23], s67 offen offset:3072  lds
  s_add_u32 s67, s67, 458752
  s_cmp_eq_u32 s40, 0
  s_cbranch_scc1 Ln017
  s_add_u32 m0, s68, 32768
  s_nop 0
  buffer_load_dwordx4 v232, s[16:19], s67 offen offset:0  lds
  buffer_load_dwordx4 v233, s[16:19], s67 offen offset:1024  lds
  buffer_load_dwordx4 v234, s[16:19], s67 offen offset:2048  lds
  buffer_load_dwordx4 v235, s[16:19], s67 offen offset:3072  lds
  s_add_u32 m0, s68, 49152
  s_nop 0
  buffer_load_dwordx4 v232, s[20:23], s67 offen offset:0  lds
  buffer_load_dwordx4 v233, s[20:23], s67 offen offset:1024  lds
  buffer_load_dwordx4 v234, s[20:23], s67 offen offset:2048  lds
  buffer_load_dwordx4 v235, s[20:23], s67 offen offset:3072  lds
  s_add_u32 s67, s67, 458752
  s_xor_b32 s68, s68, 0x10000
Ln017:
  s_mul_i32 s77, s54, 256
  s_add_u32 s77, s77, s42
  s_add_u32 s77, s77, 27791360
  v_lshlrev_b32 v249, 7, v253
  s_cmp_lg_u32 s40, 0
  s_cbranch_scc1 Lpdn19
  s_mov_b32 s43, 0x40000
  s_mov_b64 exec, 3
Lpol18:
  v_mov_b32 v250, 0
  buffer_atomic_add v250, v249, s[4:7], s77 offen sc0 sc1
  s_waitcnt vmcnt(0)
  v_cmp_gt_u32 vcc, 16, v250
  s_cbranch_vccz Lpdn19x
  s_sub_u32 s43, s43, 1
  s_cmp_lg_u32 s43, 0
  s_cbranch_scc1 Lpol18
Lpdn19x:
  s_mov_b64 exec, -1
  s_add_u32 m0, s68, 32768
  s_nop 0
  buffer_load_dwordx4 v232, s[16:19], s67 offen offset:0  lds
  buffer_load_dwordx4 v233, s[16:19], s67 offen offset:1024  lds
  buffer_load_dwordx4 v234, s[16:19], s67 offen offset:2048  lds
  buffer_load_dwordx4 v235, s[16:19], s67 offen offset:3072  lds
  s_add_u32 m0, s68, 49152
  s_nop 0
  buffer_load_dwordx4 v232, s[20:23], s67 offen offset:0  lds
  buffer_load_dwordx4 v233, s[20:23], s67 offen offset:1024  lds
  buffer_load_dwordx4 v234, s[20:23], s67 offen offset:2048  lds
  buffer_load_dwordx4 v235, s[20:23], s67 offen offset:3072  lds
  s_add_u32 s67, s67, 458752
  s_xor_b32 s68, s68, 0x10000
Lpdn19:
  s_waitcnt vmcnt(8) lgkmcnt(0)
  s_barrier
  buffer_load_dwordx4 a[0:3], v231, s[4:7], s72 offen offset:0 sc1
  buffer_load_dwordx4 a[16:19], v231, s[4:7], s72 offen offset:1024 sc1
  buffer_load_dwordx4 a[4:7], v231, s[4:7], s73 offen offset:0 sc1
  buffer_load_dwordx4 a[20:23], v231, s[4:7], s73 offen offset:1024 sc1
  buffer_load_dwordx4 a[8:11], v231, s[4:7], s74 offen offset:0 sc1
  buffer_load_dwordx4 a[24:27], v231, s[4:7], s74 offen offset:1024 sc1
  buffer_load_dwordx4 a[12:15], v231, s[4:7], s75 offen offset:0 sc1
  buffer_load_dwordx4 a[28:31], v231, s[4:7], s75 offen offset:1024 sc1
  ds_read_b64_tr_b16 a[64:65], v224 offset:0
  ds_read_b64_tr_b16 a[66:67], v224 offset:4096
  ds_read_b64_tr_b16 a[68:69], v224 offset:8192
  ds_read_b64_tr_b16 a[70:71], v224 offset:12288
  ds_read_b64_tr_b16 a[72:73], v224 offset:16384
  ds_read_b64_tr_b16 a[74:75], v224 offset:20480
  ds_read_b64_tr_b16 a[76:77], v224 offset:24576
  ds_read_b64_tr_b16 a[78:79], v224 offset:28672
Lmk_p3s0:
  s_waitcnt vmcnt(6) lgkmcnt(4)
  v_mfma_f32_16x16x32_bf16 v[0:3], a[64:67], a[0:3], 0
  ds_read_b64_tr_b16 a[80:81], v225 offset:0
  v_mfma_f32_16x16x32_bf16 v[0:3], a[68:71], a[16:19], v[0:3]
  ds_read_b64_tr_b16 a[82:83], v225 offset:4096
  s_waitcnt vmcnt(4)
  v_mfma_f32_16x16x32_bf16 v[4:7], a[68:71], a[20:23], 0
  v_mfma_f32_16x16x32_bf16 v[4:7], a[64:67], a[4:7], v[4:7]
  s_waitcnt vmcnt(2)
  v_mfma_f32_16x16x32_bf16 v[8:11], a[64:67], a[8:11], 0
  ds_read_b64_tr_b16 a[84:85], v225 offset:8192
  v_mfma_f32_16x16x32_bf16 v[8:11], a[68:71], a[24:27], v[8:11]
  ds_read_b64_tr_b16 a[86:87], v225 offset:12288
  s_waitcnt vmcnt(0)
  v_mfma_f32_16x16x32_bf16 v[12:15], a[68:71], a[28:31], 0
  v_mfma_f32_16x16x32_bf16 v[12:15], a[64:67], a[12:15], v[12:15]
  s_waitcnt lgkmcnt(4)
  v_mfma_f32_16x16x32_bf16 v[28:31], a[72:75], a[12:15], 0
  ds_read_b64_tr_b16 a[88:89], v225 offset:16384
  v_mfma_f32_16x16x32_bf16 v[28:31], a[76:79], a[28:31], v[28:31]
  ds_read_b64_tr_b16 a[90:91], v225 offset:20480
  v_mfma_f32_16x16x32_bf16 v[24:27], a[76:79], a[24:27], 0
  buffer_load_dwordx4 a[32:35], v231, s[4:7], s72 offen offset:2048 sc1
  v_mfma_f32_16x16x32_bf16 v[24:27], a[72:75], a[8:11], v[24:27]
  v_mfma_f32_16x16x32_bf16 v[20:23], a[72:75], a[4:7], 0
  ds_read_b64_tr_b16 a[92:93], v225 offset:24576
  v_mfma_f32_16x16x32_bf16 v[20:23], a[76:79], a[20:23], v[20:23]
  ds_read_b64_tr_b16 a[94:95], v225 offset:28672
  v_mfma_f32_16x16x32_bf16 v[16:19], a[76:79], a[16:19], 0
  buffer_load_dwordx4 a[48:51], v231, s[4:7], s72 offen offset:3072 sc1
  v_mfma_f32_16x16x32_bf16 v[16:19], a[72:75], a[0:3], v[16:19]
  s_add_u32 s72, s72, 4096
  s_waitcnt lgkmcnt(4)
  v_mfma_f32_16x16x32_bf16 v[32:35], a[80:83], a[0:3], 0
  ds_read_b64_tr_b16 a[64:65], v226 offset:0
  v_mfma_f32_16x16x32_bf16 v[32:35], a[84:87], a[16:19], v[32:35]
  ds_read_b64_tr_b16 a[66:67], v226 offset:4096
  v_mfma_f32_16x16x32_bf16 v[36:39], a[84:87], a[20:23], 0
  buffer_load_dwordx4 a[36:39], v231, s[4:7], s73 offen offset:2048 sc1
  v_mfma_f32_16x16x32_bf16 v[36:39], a[80:83], a[4:7], v[36:39]
  v_mfma_f32_16x16x32_bf16 v[40:43], a[80:83], a[8:11], 0
  ds_read_b64_tr_b16 a[68:69], v226 offset:8192
  v_mfma_f32_16x16x32_bf16 v[40:43], a[84:87], a[24:27], v[40:43]
  ds_read_b64_tr_b16 a[70:71], v226 offset:12288
  v_mfma_f32_16x16x32_bf16 v[44:47], a[84:87], a[28:31], 0
  buffer_load_dwordx4 a[52:55], v231, s[4:7], s73 offen offset:3072 sc1
  v_mfma_f32_16x16x32_bf16 v[44:47], a[80:83], a[12:15], v[44:47]
  s_add_u32 s73, s73, 4096
  s_waitcnt lgkmcnt(4)
  v_mfma_f32_16x16x32_bf16 v[60:63], a[88:91], a[12:15], 0
  ds_read_b64_tr_b16 a[72:73], v226 offset:16384
  v_mfma_f32_16x16x32_bf16 v[60:63], a[92:95], a[28:31], v[60:63]
  ds_read_b64_tr_b16 a[74:75], v226 offset:20480
  v_mfma_f32_16x16x32_bf16 v[56:59], a[92:95], a[24:27], 0
  buffer_load_dwordx4 a[40:43], v231, s[4:7], s74 offen offset:2048 sc1
  v_mfma_f32_16x16x32_bf16 v[56:59], a[88:91], a[8:11], v[56:59]
  v_mfma_f32_16x16x32_bf16 v[52:55], a[88:91], a[4:7], 0
  ds_read_b64_tr_b16 a[76:77], v226 offset:24576
  v_mfma_f32_16x16x32_bf16 v[52:55], a[92:95], a[20:23], v[52:55]
  ds_read_b64_tr_b16 a[78:79], v226 offset:28672
  v_mfma_f32_16x16x32_bf16 v[48:51], a[92:95], a[16:19], 0
  buffer_load_dwordx4 a[56:59], v231, s[4:7], s74 offen offset:3072 sc1
  v_mfma_f32_16x16x32_bf16 v[48:51], a[88:91], a[0:3], v[48:51]
  s_add_u32 s74, s74, 4096
  s_waitcnt lgkmcnt(4)
  v_mfma_f32_16x16x32_bf16 v[64:67], a[64:67], a[0:3], 0
  ds_read_b64_tr_b16 a[80:81], v227 offset:0
  v_mfma_f32_16x16x32_bf16 v[64:67], a[68:71], a[16:19], v[64:67]
  ds_read_b64_tr_b16 a[82:83], v227 offset:4096
  v_mfma_f32_16x16x32_bf16 v[68:71], a[68:71], a[20:23], 0
  buffer_load_dwordx4 a[44:47], v231, s[4:7], s75 offen offset:2048 sc1
  v_mfma_f32_16x16x32_bf16 v[68:71], a[64:67], a[4:7], v[68:71]
  v_mfma_f32_16x16x32_bf16 v[72:75], a[64:67], a[8:11], 0
  ds_read_b64_tr_b16 a[84:85], v227 offset:8192
  v_mfma_f32_16x16x32_bf16 v[72:75], a[68:71], a[24:27], v[72:75]
  ds_read_b64_tr_b16 a[86:87], v227 offset:12288
  v_mfma_f32_16x16x32_bf16 v[76:79], a[68:71], a[28:31], 0
  buffer_load_dwordx4 a[60:63], v231, s[4:7], s75 offen offset:3072 sc1
  v_mfma_f32_16x16x32_bf16 v[76:79], a[64:67], a[12:15], v[76:79]
  s_add_u32 s75, s75, 4096
  s_waitcnt lgkmcnt(4)
  v_mfma_f32_16x16x32_bf16 v[92:95], a[72:75], a[12:15], 0
  ds_read_b64_tr_b16 a[88:89], v227 offset:16384
  v_mfma_f32_16x16x32_bf16 v[92:95], a[76:79], a[28:31], v[92:95]
  ds_read_b64_tr_b16 a[90:91], v227 offset:20480
  s_add_u32 m0, s68, 32768
  v_mfma_f32_16x16x32_bf16 v[88:91], a[76:79], a[24:27], 0
  buffer_load_dwordx4 v231, s[4:7], s44 offen offset:0 sc1 lds
  v_mfma_f32_16x16x32_bf16 v[88:91], a[72:75], a[8:11], v[88:91]
  v_mfma_f32_16x16x32_bf16 v[84:87], a[72:75], a[4:7], 0
  ds_read_b64_tr_b16 a[92:93], v227 offset:24576
  v_mfma_f32_16x16x32_bf16 v[84:87], a[76:79], a[20:23], v[84:87]
  ds_read_b64_tr_b16 a[94:95], v227 offset:28672
  v_mfma_f32_16x16x32_bf16 v[80:83], a[76:79], a[16:19], 0
  buffer_load_dwordx4 v231, s[4:7], s44 offen offset:1024 sc1 lds
  v_mfma_f32_16x16x32_bf16 v[80:83], a[72:75], a[0:3], v[80:83]
  s_waitcnt lgkmcnt(4)
  v_mfma_f32_16x16x32_bf16 v[96:99], a[80:83], a[0:3], 0
  ds_read_b64_tr_b16 a[64:65], v228 offset:0
  v_mfma_f32_16x16x32_bf16 v[96:99], a[84:87], a[16:19], v[96:99]
  ds_read_b64_tr_b16 a[66:67], v228 offset:4096
  v_mfma_f32_16x16x32_bf16 v[100:103], a[84:87], a[20:23], 0
  buffer_load_dwordx4 v231, s[4:7], s44 offen offset:2048 sc1 lds
  v_mfma_f32_16x16x32_bf16 v[100:103], a[80:83], a[4:7], v[100:103]
  v_mfma_f32_16x16x32_bf16 v[104:107], a[80:83], a[8:11], 0
  ds_read_b64_tr_b16 a[68:69], v228 offset:8192
  v_mfma_f32_16x16x32_bf16 v[104:107], a[84:87], a[24:27], v[104:107]
  ds_read_b64_tr_b16 a[70:71], v228 offset:12288
  v_mfma_f32_16x16x32_bf16 v[108:111], a[84:87], a[28:31], 0
  buffer_load_dwordx4 v231, s[4:7], s44 offen offset:3072 sc1 lds
  v_mfma_f32_16x16x32_bf16 v[108:111], a[80:83], a[12:15], v[108:111]
  s_waitcnt lgkmcnt(4)
  v_mfma_f32_16x16x32_bf16 v[124:127], a[88:91], a[12:15], 0
  ds_read_b64_tr_b16 a[72:73], v228 offset:16384
  v_mfma_f32_16x16x32_bf16 v[124:127], a[92:95], a[28:31], v[124:127]
  ds_read_b64_tr_b16 a[74:75], v228 offset:20480
  s_add_u32 m0, s68, 49152
  v_mfma_f32_16x16x32_bf16 v[120:123], a[92:95], a[24:27], 0
  buffer_load_dwordx4 v231, s[4:7], s45 offen offset:0 sc1 lds
  v_mfma_f32_16x16x32_bf16 v[120:123], a[88:91], a[8:11], v[120:123]
  v_mfma_f32_16x16x32_bf16 v[116:119], a[88:91], a[4:7], 0
  ds_read_b64_tr_b16 a[76:77], v228 offset:24576
  v_mfma_f32_16x16x32_bf16 v[116:119], a[92:95], a[20:23], v[116:119]
  ds_read_b64_tr_b16 a[78:79], v228 offset:28672
  v_mfma_f32_16x16x32_bf16 v[112:115], a[92:95], a[16:19], 0
  buffer_load_dwordx4 v231, s[4:7], s45 offen offset:1024 sc1 lds
  v_mfma_f32_16x16x32_bf16 v[112:115], a[88:91], a[0:3], v[112:115]
  s_waitcnt lgkmcnt(4)
  v_mfma_f32_16x16x32_bf16 v[128:131], a[64:67], a[0:3], 0
  ds_read_b64_tr_b16 a[80:81], v229 offset:0
  v_mfma_f32_16x16x32_bf16 v[128:131], a[68:71], a[16:19], v[128:131]
  ds_read_b64_tr_b16 a[82:83], v229 offset:4096
  v_mfma_f32_16x16x32_bf16 v[132:135], a[68:71], a[20:23], 0
  buffer_load_dwordx4 v231, s[4:7], s45 offen offset:2048 sc1 lds
  v_mfma_f32_16x16x32_bf16 v[132:135], a[64:67], a[4:7], v[132:135]
  v_mfma_f32_16x16x32_bf16 v[136:139], a[64:67], a[8:11], 0
  ds_read_b64_tr_b16 a[84:85], v229 offset:8192
  v_mfma_f32_16x16x32_bf16 v[136:139], a[68:71], a[24:27], v[136:139]
  ds_read_b64_tr_b16 a[86:87], v229 offset:12288
  v_mfma_f32_16x16x32_bf16 v[140:143], a[68:71], a[28:31], 0
  buffer_load_dwordx4 v231, s[4:7], s45 offen offset:3072 sc1 lds
  v_mfma_f32_16x16x32_bf16 v[140:143], a[64:67], a[12:15], v[140:143]
  s_waitcnt lgkmcnt(4)
  v_mfma_f32_16x16x32_bf16 v[156:159], a[72:75], a[12:15], 0
  ds_read_b64_tr_b16 a[88:89], v229 offset:16384
  v_mfma_f32_16x16x32_bf16 v[156:159], a[76:79], a[28:31], v[156:159]
  ds_read_b64_tr_b16 a[90:91], v229 offset:20480
  s_add_u32 m0, s68, 0
  v_mfma_f32_16x16x32_bf16 v[152:155], a[76:79], a[24:27], 0
  buffer_load_dwordx4 v232, s[16:19], s67 offen offset:0  lds
  v_mfma_f32_16x16x32_bf16 v[152:155], a[72:75], a[8:11], v[152:155]
  v_mfma_f32_16x16x32_bf16 v[148:151], a[72:75], a[4:7], 0
  ds_read_b64_tr_b16 a[92:93], v229 offset:24576
  v_mfma_f32_16x16x32_bf16 v[148:151], a[76:79], a[20:23], v[148:151]
  ds_read_b64_tr_b16 a[94:95], v229 offset:28672
  v_mfma_f32_16x16x32_bf16 v[144:147], a[76:79], a[16:19], 0
  buffer_load_dwordx4 v233, s[16:19], s67 offen offset:1024  lds
  v_mfma_f32_16x16x32_bf16 v[144:147], a[72:75], a[0:3], v[144:147]
  s_waitcnt lgkmcnt(4)
  v_mfma_f32_16x16x32_bf16 v[160:163], a[80:83], a[0:3], 0
  ds_read_b64_tr_b16 a[64:65], v230 offset:0
  v_mfma_f32_16x16x32_bf16 v[160:163], a[84:87], a[16:19], v[160:163]
  ds_read_b64_tr_b16 a[66:67], v230 offset:4096
  v_mfma_f32_16x16x32_bf16 v[164:167], a[84:87], a[20:23], 0
  buffer_load_dwordx4 v234, s[16:19], s67 offen offset:2048  lds
  v_mfma_f32_16x16x32_bf16 v[164:167], a[80:83], a[4:7], v[164:167]
  v_mfma_f32_16x16x32_bf16 v[168:171], a[80:83], a[8:11], 0
  ds_read_b64_tr_b16 a[68:69], v230 offset:8192
  v_mfma_f32_16x16x32_bf16 v[168:171], a[84:87], a[24:27], v[168:171]
  ds_read_b64_tr_b16 a[70:71], v230 offset:12288
  v_mfma_f32_16x16x32_bf16 v[172:175], a[84:87], a[28:31], 0
  buffer_load_dwordx4 v235, s[16:19], s67 offen offset:3072  lds
  v_mfma_f32_16x16x32_bf16 v[172:175], a[80:83], a[12:15], v[172:175]
  s_waitcnt lgkmcnt(4)
  v_mfma_f32_16x16x32_bf16 v[188:191], a[88:91], a[12:15], 0
  ds_read_b64_tr_b16 a[72:73], v230 offset:16384
  v_mfma_f32_16x16x32_bf16 v[188:191], a[92:95], a[28:31], v[188:191]
  ds_read_b64_tr_b16 a[74:75], v230 offset:20480
  s_add_u32 m0, s68, 16384
  v_mfma_f32_16x16x32_bf16 v[184:187], a[92:95], a[24:27], 0
  buffer_load_dwordx4 v232, s[20:23], s67 offen offset:0  lds
  v_mfma_f32_16x16x32_bf16 v[184:187], a[88:91], a[8:11], v[184:187]
  v_mfma_f32_16x16x32_bf16 v[180:183], a[88:91], a[4:7], 0
  ds_read_b64_tr_b16 a[76:77], v230 offset:24576
  v_mfma_f32_16x16x32_bf16 v[180:183], a[92:95], a[20:23], v[180:183]
  ds_read_b64_tr_b16 a[78:79], v230 offset:28672
  v_mfma_f32_16x16x32_bf16 v[176:179], a[92:95], a[16:19], 0
  buffer_load_dwordx4 v233, s[20:23], s67 offen offset:1024  lds
  v_mfma_f32_16x16x32_bf16 v[176:179], a[88:91], a[0:3], v[176:179]
  s_waitcnt lgkmcnt(4)
  v_mfma_f32_16x16x32_bf16 v[192:195], a[64:67], a[0:3], 0
  s_barrier
  ds_read_b64_tr_b16 a[80:81], v224 offset:32768
  v_mfma_f32_16x16x32_bf16 v[192:195], a[68:71], a[16:19], v[192:195]
  ds_read_b64_tr_b16 a[82:83], v224 offset:36864
  v_mfma_f32_16x16x32_bf16 v[196:199], a[68:71], a[20:23], 0
  buffer_load_dwordx4 v234, s[20:23], s67 offen offset:2048  lds
  v_mfma_f32_16x16x32_bf16 v[196:199], a[64:67], a[4:7], v[196:199]
  v_mfma_f32_16x16x32_bf16 v[200:203], a[64:67], a[8:11], 0
  ds_read_b64_tr_b16 a[84:85], v224 offset:40960
  v_mfma_f32_16x16x32_bf16 v[200:203], a[68:71], a[24:27], v[200:203]
  ds_read_b64_tr_b16 a[86:87], v224 offset:45056
  v_mfma_f32_16x16x32_bf16 v[204:207], a[68:71], a[28:31], 0
  buffer_load_dwordx4 v235, s[20:23], s67 offen offset:3072  lds
  v_mfma_f32_16x16x32_bf16 v[204:207], a[64:67], a[12:15], v[204:207]
  s_add_u32 s67, s67, 458752
  s_waitcnt lgkmcnt(4)
  v_mfma_f32_16x16x32_bf16 v[220:223], a[72:75], a[12:15], 0
  ds_read_b64_tr_b16 a[88:89], v224 offset:49152
  v_mfma_f32_16x16x32_bf16 v[220:223], a[76:79], a[28:31], v[220:223]
  ds_read_b64_tr_b16 a[90:91], v224 offset:53248
  v_mfma_f32_16x16x32_bf16 v[216:219], a[76:79], a[24:27], 0
  buffer_load_dwordx4 a[96:99], v236, s[24:27], s70 offen
  v_mfma_f32_16x16x32_bf16 v[216:219], a[72:75], a[8:11], v[216:219]
  s_add_u32 s70, s70, 1024
  v_mfma_f32_16x16x32_bf16 v[212:215], a[72:75], a[4:7], 0
  ds_read_b64_tr_b16 a[92:93], v224 offset:57344
  v_mfma_f32_16x16x32_bf16 v[212:215], a[76:79], a[20:23], v[212:215]
  ds_read_b64_tr_b16 a[94:95], v224 offset:61440
  v_xor_b32 v224, 0x10000, v224
  v_mfma_f32_16x16x32_bf16 v[208:211], a[76:79], a[16:19], 0
  v_mfma_f32_16x16x32_bf16 v[208:211], a[72:75], a[0:3], v[208:211]
Lmk_p3s1:
  s_waitcnt vmcnt(17) lgkmcnt(4)
  v_mfma_f32_16x16x32_bf16 v[0:3], a[80:83], a[32:35], v[0:3]
  ds_read_b64_tr_b16 a[64:65], v225 offset:32768
  s_add_u32 s43, s68, 32768
  v_mfma_f32_16x16x32_bf16 v[0:3], a[84:87], a[48:51], v[0:3]
  ds_read_b64_tr_b16 a[66:67], v225 offset:36864
  v_lshlrev_b32 v250, 3, v253
  v_mfma_f32_16x16x32_bf16 v[4:7], a[84:87], a[52:55], v[4:7]
  buffer_load_dwordx4 a[0:3], v231, s[4:7], s72 offen offset:0 sc1
  v_mfma_f32_16x16x32_bf16 v[4:7], a[80:83], a[36:39], v[4:7]
  v_add_u32 v250, s43, v250
  v_mfma_f32_16x16x32_bf16 v[8:11], a[80:83], a[40:43], v[8:11]
  ds_read_b64_tr_b16 a[68:69], v225 offset:40960
  v_mfma_f32_16x16x32_bf16 v[8:11], a[84:87], a[56:59], v[8:11]
  ds_read_b64_tr_b16 a[70:71], v225 offset:45056
  v_mfma_f32_16x16x32_bf16 v[12:15], a[84:87], a[60:63], v[12:15]
  s_waitcnt vmcnt(10)
  ds_read_b64 v[238:239], v250 offset:0
  ds_read_b64 v[240:241], v250 offset:2048
  v_mfma_f32_16x16x32_bf16 v[12:15], a[80:83], a[44:47], v[12:15]
  s_waitcnt lgkmcnt(6)
  ds_read_b64 v[242:243], v250 offset:16384
  ds_read_b64 v[244:245], v250 offset:18432
  v_mfma_f32_16x16x32_bf16 v[28:31], a[88:91], a[44:47], v[28:31]
  ds_read_b64_tr_b16 a[72:73], v225 offset:49152
  v_mfma_f32_16x16x32_bf16 v[28:31], a[92:95], a[60:63], v[28:31]
  ds_read_b64_tr_b16 a[74:75], v225 offset:53248
  v_mfma_f32_16x16x32_bf16 v[24:27], a[92:95], a[56:59], v[24:27]
  buffer_load_dwordx4 a[16:19], v231, s[4:7], s72 offen offset:1024 sc1
  v_mfma_f32_16x16x32_bf16 v[24:27], a[88:91], a[40:43], v[24:27]
  ds_read_b64 v[246:247], v250 offset:512
  v_mfma_f32_16x16x32_bf16 v[20:23], a[88:91], a[36:39], v[20:23]
  ds_read_b64_tr_b16 a[76:77], v225 offset:57344
  v_mfma_f32_16x16x32_bf16 v[20:23], a[92:95], a[52:55], v[20:23]
  ds_read_b64_tr_b16 a[78:79], v225 offset:61440
  v_xor_b32 v225, 0x10000, v225
  v_mfma_f32_16x16x32_bf16 v[16:19], a[92:95], a[48:51], v[16:19]
  v_mfma_f32_16x16x32_bf16 v[16:19], a[88:91], a[32:35], v[16:19]
  ds_read_b64 v[248:249], v250 offset:2560
  s_waitcnt lgkmcnt(10)
  v_mfma_f32_16x16x32_bf16 v[32:35], a[64:67], a[32:35], v[32:35]
  s_waitcnt lgkmcnt(3)
  ds_read_b64_tr_b16 a[80:81], v226 offset:32768
  v_add_f32 v238, v238, v246
  v_mfma_f32_16x16x32_bf16 v[32:35], a[68:71], a[48:51], v[32:35]
  ds_read_b64_tr_b16 a[82:83], v226 offset:36864
  v_add_f32 v239, v239, v247
  v_mfma_f32_16x16x32_bf16 v[36:39], a[68:71], a[52:55], v[36:39]
  buffer_load_dwordx4 a[4:7], v231, s[4:7], s73 offen offset:0 sc1
  v_mfma_f32_16x16x32_bf16 v[36:39], a[64:67], a[36:39], v[36:39]
  ds_read_b64 v[246:247], v250 offset:16896
  v_mfma_f32_16x16x32_bf16 v[40:43], a[64:67], a[40:43], v[40:43]
  s_waitcnt lgkmcnt(3)
  ds_read_b64_tr_b16 a[84:85], v226 offset:40960
  v_add_f32 v240, v240, v248
  v_mfma_f32_16x16x32_bf16 v[40:43], a[68:71], a[56:59], v[40:43]
  ds_read_b64_tr_b16 a[86:87], v226 offset:45056
  v_add_f32 v241, v241, v249
  v_mfma_f32_16x16x32_bf16 v[44:47], a[68:71], a[60:63], v[44:47]
  buffer_load_dwordx4 a[20:23], v231, s[4:7], s73 offen offset:1024 sc1
  v_mfma_f32_16x16x32_bf16 v[44:47], a[64:67], a[44:47], v[44:47]
  ds_read_b64 v[248:249], v250 offset:18944
  v_mfma_f32_16x16x32_bf16 v[60:63], a[72:75], a[44:47], v[60:63]
  s_waitcnt lgkmcnt(3)
  ds_read_b64_tr_b16 a[88:89], v226 offset:49152
  v_add_f32 v242, v242, v246
  v_mfma_f32_16x16x32_bf16 v[60:63], a[76:79], a[60:63], v[60:63]
  ds_read_b64_tr_b16 a[90:91], v226 offset:53248
  v_add_f32 v243, v243, v247
  v_mfma_f32_16x16x32_bf16 v[56:59], a[76:79], a[56:59], v[56:59]
  v_mfma_f32_16x16x32_bf16 v[56:59], a[72:75], a[40:43], v[56:59]
  ds_read_b64 v[246:247], v250 offset:1024
  v_mfma_f32_16x16x32_bf16 v[52:55], a[72:75], a[36:39], v[52:55]
  s_waitcnt lgkmcnt(3)
  ds_read_b64_tr_b16 a[92:93], v226 offset:57344
  v_add_f32 v244, v244, v248
  v_mfma_f32_16x16x32_bf16 v[52:55], a[76:79], a[52:55], v[52:55]
  ds_read_b64_tr_b16 a[94:95], v226 offset:61440
  v_xor_b32 v226, 0x10000, v226
  v_add_f32 v245, v245, v249
  v_mfma_f32_16x16x32_bf16 v[48:51], a[76:79], a[48:51], v[48:51]
  buffer_load_dwordx4 a[8:11], v231, s[4:7], s74 offen offset:0 sc1
  v_mfma_f32_16x16x32_bf16 v[48:51], a[72:75], a[32:35], v[48:51]
  ds_read_b64 v[248:249], v250 offset:3072
  v_mfma_f32_16x16x32_bf16 v[64:67], a[80:83], a[32:35], v[64:67]
  s_waitcnt lgkmcnt(3)
  ds_read_b64_tr_b16 a[64:65], v227 offset:32768
  v_add_f32 v238, v238, v246
  v_mfma_f32_16x16x32_bf16 v[64:67], a[84:87], a[48:51], v[64:67]
  ds_read_b64_tr_b16 a[66:67], v227 offset:36864
  v_add_f32 v239, v239, v247
  v_mfma_f32_16x16x32_bf16 v[68:71], a[84:87], a[52:55], v[68:71]
  v_mfma_f32_16x16x32_bf16 v[68:71], a[80:83], a[36:39], v[68:71]
  ds_read_b64 v[246:247], v250 offset:17408
  v_mfma_f32_16x16x32_bf16 v[72:75], a[80:83], a[40:43], v[72:75]
  s_waitcnt lgkmcnt(3)
  ds_read_b64_tr_b16 a[68:69], v227 offset:40960
  v_add_f32 v240, v240, v248
  v_mfma_f32_16x16x32_bf16 v[72:75], a[84:87], a[56:59], v[72:75]
  ds_read_b64_tr_b16 a[70:71], v227 offset:45056
  v_add_f32 v241, v241, v249
  v_mfma_f32_16x16x32_bf16 v[76:79], a[84:87], a[60:63], v[76:79]
  buffer_load_dwordx4 a[24:27], v231, s[4:7], s74 offen offset:1024 sc1
  v_mfma_f32_16x16x32_bf16 v[76:79], a[80:83], a[44:47], v[76:79]
  ds_read_b64 v[248:249], v250 offset:19456
  v_mfma_f32_16x16x32_bf16 v[92:95], a[88:91], a[44:47], v[92:95]
  s_waitcnt lgkmcnt(3)
  ds_read_b64_tr_b16 a[72:73], v227 offset:49152
  v_add_f32 v242, v242, v246
  v_mfma_f32_16x16x32_bf16 v[92:95], a[92:95], a[60:63], v[92:95]
  ds_read_b64_tr_b16 a[74:75], v227 offset:53248
  v_add_f32 v243, v243, v247
  v_mfma_f32_16x16x32_bf16 v[88:91], a[92:95], a[56:59], v[88:91]
  buffer_load_dword v237, v251, s[4:7], s48 offen sc1
  v_mfma_f32_16x16x32_bf16 v[88:91], a[88:91], a[40:43], v[88:91]
  ds_read_b64 v[246:247], v250 offset:1536
  v_mfma_f32_16x16x32_bf16 v[84:87], a[88:91], a[36:39], v[84:87]
  s_waitcnt lgkmcnt(3)
  ds_read_b64_tr_b16 a[76:77], v227 offset:57344
  v_add_f32 v244, v244, v248
  v_mfma_f32_16x16x32_bf16 v[84:87], a[92:95], a[52:55], v[84:87]
  ds_read_b64_tr_b16 a[78:79], v227 offset:61440
  v_xor_b32 v227, 0x10000, v227
  v_add_f32 v245, v245, v249
  v_mfma_f32_16x16x32_bf16 v[80:83], a[92:95], a[48:51], v[80:83]
  buffer_load_dwordx4 a[12:15], v231, s[4:7], s75 offen offset:0 sc1
  v_mfma_f32_16x16x32_bf16 v[80:83], a[88:91], a[32:35], v[80:83]
  ds_read_b64 v[248:249], v250 offset:3584
  v_mfma_f32_16x16x32_bf16 v[96:99], a[64:67], a[32:35], v[96:99]
  s_waitcnt lgkmcnt(3)
  ds_read_b64_tr_b16 a[80:81], v228 offset:32768
  v_add_f32 v238, v238, v246
  v_mfma_f32_16x16x32_bf16 v[96:99], a[68:71], a[48:51], v[96:99]
  ds_read_b64_tr_b16 a[82:83], v228 offset:36864
  v_add_f32 v239, v239, v247
  v_mfma_f32_16x16x32_bf16 v[100:103], a[68:71], a[52:55], v[100:103]
  buffer_load_dwordx4 a[96:99], v236, s[24:27], s70 offen
  v_mfma_f32_16x16x32_bf16 v[100:103], a[64:67], a[36:39], v[100:103]
  s_add_u32 s70, s70, 1024
  ds_read_b64 v[246:247], v250 offset:17920
  v_mfma_f32_16x16x32_bf16 v[104:107], a[64:67], a[40:43], v[104:107]
  s_waitcnt lgkmcnt(3)
  ds_read_b64_tr_b16 a[84:85], v228 offset:40960
  v_add_f32 v240, v240, v248
  v_mfma_f32_16x16x32_bf16 v[104:107], a[68:71], a[56:59], v[104:107]
  ds_read_b64_tr_b16 a[86:87], v228 offset:45056
  v_add_f32 v241, v241, v249
  v_mfma_f32_16x16x32_bf16 v[108:111], a[68:71], a[60:63], v[108:111]
  buffer_load_dwordx4 a[28:31], v231, s[4:7], s75 offen offset:1024 sc1
  v_mfma_f32_16x16x32_bf16 v[108:111], a[64:67], a[44:47], v[108:111]
  ds_read_b64 v[248:249], v250 offset:19968
  v_mfma_f32_16x16x32_bf16 v[124:127], a[72:75], a[44:47], v[124:127]
  s_waitcnt lgkmcnt(3)
  ds_read_b64_tr_b16 a[88:89], v228 offset:49152
  v_add_f32 v242, v242, v246
  v_mfma_f32_16x16x32_bf16 v[124:127], a[76:79], a[60:63], v[124:127]
  ds_read_b64_tr_b16 a[90:91], v228 offset:53248
  v_add_f32 v243, v243, v247
  v_mfma_f32_16x16x32_bf16 v[120:123], a[76:79], a[56:59], v[120:123]
  v_mfma_f32_16x16x32_bf16 v[120:123], a[72:75], a[40:43], v[120:123]
  v_mfma_f32_16x16x32_bf16 v[116:119], a[72:75], a[36:39], v[116:119]
  s_waitcnt lgkmcnt(2)
  ds_read_b64_tr_b16 a[92:93], v228 offset:57344
  v_add_f32 v244, v244, v248
  v_mfma_f32_16x16x32_bf16 v[116:119], a[76:79], a[52:55], v[116:119]
  ds_read_b64_tr_b16 a[94:95], v228 offset:61440
  v_xor_b32 v228, 0x10000, v228
  v_mfma_f32_16x16x32_bf16 v[112:115], a[76:79], a[48:51], v[112:115]
  s_mov_b32 s43, 0x3a800000
  v_add_f32 v245, v245, v249
  v_mov_b32 v250, 0x3727c5ac
  v_mfma_f32_16x16x32_bf16 v[112:115], a[72:75], a[32:35], v[112:115]
  v_lshlrev_b32 v246, 2, v253
  v_add_u32 v246, s71, v246
  v_mfma_f32_16x16x32_bf16 v[128:131], a[80:83], a[32:35], v[128:131]
  ds_read_b64_tr_b16 a[64:65], v229 offset:32768
  v_permlane32_swap_b32 v238, v242
  v_mfma_f32_16x16x32_bf16 v[128:131], a[84:87], a[48:51], v[128:131]
  ds_read_b64_tr_b16 a[66:67], v229 offset:36864
  s_add_u32 m0, s68, 32768
  v_mfma_f32_16x16x32_bf16 v[132:135], a[84:87], a[52:55], v[132:135]
  buffer_load_dwordx4 v232, s[16:19], s67 offen offset:0  lds
  v_mfma_f32_16x16x32_bf16 v[132:135], a[80:83], a[36:39], v[132:135]
  v_permlane32_swap_b32 v239, v243
  v_permlane32_swap_b32 v240, v244
  v_mfma_f32_16x16x32_bf16 v[136:139], a[80:83], a[40:43], v[136:139]
  ds_read_b64_tr_b16 a[68:69], v229 offset:40960
  v_permlane32_swap_b32 v241, v245
  v_mfma_f32_16x16x32_bf16 v[136:139], a[84:87], a[56:59], v[136:139]
  ds_read_b64_tr_b16 a[70:71], v229 offset:45056
  v_add_f32 v238, v238, v242
  v_mfma_f32_16x16x32_bf16 v[140:143], a[84:87], a[60:63], v[140:143]
  buffer_load_dwordx4 v233, s[16:19], s67 offen offset:1024  lds
  v_mfma_f32_16x16x32_bf16 v[140:143], a[80:83], a[44:47], v[140:143]
  s_waitcnt lgkmcnt(4)
  v_add_f32 v240, v240, v244
  v_add_f32 v239, v239, v243
  v_mfma_f32_16x16x32_bf16 v[156:159], a[88:91], a[44:47], v[156:159]
  ds_read_b64_tr_b16 a[72:73], v229 offset:49152
  v_add_f32 v241, v241, v245
  v_mfma_f32_16x16x32_bf16 v[156:159], a[92:95], a[60:63], v[156:159]
  ds_read_b64_tr_b16 a[74:75], v229 offset:53248
  v_and_b32 v247, 0xffffff3f, v246
  v_mfma_f32_16x16x32_bf16 v[152:155], a[92:95], a[56:59], v[152:155]
  buffer_load_dwordx4 v234, s[16:19], s67 offen offset:2048  lds
  v_mfma_f32_16x16x32_bf16 v[152:155], a[88:91], a[40:43], v[152:155]
  v_permlane16_swap_b32 v238, v240
  v_permlane16_swap_b32 v239, v241
  v_mfma_f32_16x16x32_bf16 v[148:151], a[88:91], a[36:39], v[148:151]
  ds_read_b64_tr_b16 a[76:77], v229 offset:57344
  v_add_f32 v238, v238, v240
  v_mfma_f32_16x16x32_bf16 v[148:151], a[92:95], a[52:55], v[148:151]
  ds_read_b64_tr_b16 a[78:79], v229 offset:61440
  v_xor_b32 v229, 0x10000, v229
  v_add_f32 v239, v239, v241
  v_mfma_f32_16x16x32_bf16 v[144:147], a[92:95], a[48:51], v[144:147]
  v_add_u32 v247, 1024, v247
  v_mul_f32 v238, 0xba800000, v238
  v_mfma_f32_16x16x32_bf16 v[144:147], a[88:91], a[32:35], v[144:147]
  s_waitcnt lgkmcnt(4)
  v_fma_f32 v239, v239, s43, v250
  v_fma_f32 v239, -v238, v238, v239
  v_mfma_f32_16x16x32_bf16 v[160:163], a[64:67], a[32:35], v[160:163]
  ds_read_b64_tr_b16 a[80:81], v230 offset:32768
  v_max_f32 v239, v239, v250
  v_mfma_f32_16x16x32_bf16 v[160:163], a[68:71], a[48:51], v[160:163]
  ds_read_b64_tr_b16 a[82:83], v230 offset:36864
  v_rsq_f32 v240, v239
  v_mfma_f32_16x16x32_bf16 v[164:167], a[68:71], a[52:55], v[164:167]
  buffer_load_dwordx4 v235, s[16:19], s67 offen offset:3072  lds
  v_mfma_f32_16x16x32_bf16 v[164:167], a[64:67], a[36:39], v[164:167]
  ds_write_b32 v246, v238 offset:1024
  ds_write_b32 v246, v239 offset:1536
  v_mfma_f32_16x16x32_bf16 v[168:171], a[64:67], a[40:43], v[168:171]
  ds_read_b64_tr_b16 a[84:85], v230 offset:40960
  v_mul_f32 v240, 0xbfb8aa3b, v240
  v_mfma_f32_16x16x32_bf16 v[168:171], a[68:71], a[56:59], v[168:171]
  ds_read_b64_tr_b16 a[86:87], v230 offset:45056
  s_add_u32 m0, s68, 49152
  v_mfma_f32_16x16x32_bf16 v[172:175], a[68:71], a[60:63], v[172:175]
  buffer_load_dwordx4 v232, s[20:23], s67 offen offset:0  lds
  v_mfma_f32_16x16x32_bf16 v[172:175], a[64:67], a[44:47], v[172:175]
  s_waitcnt lgkmcnt(6)
  ds_write_b32 v246, v240 offset:1280
  ds_read2_b32 v[238:239], v247 offset0:0 offset1:16
  v_mfma_f32_16x16x32_bf16 v[188:191], a[72:75], a[44:47], v[188:191]
  ds_read_b64_tr_b16 a[88:89], v230 offset:49152
  ds_read2_b32 v[240:241], v247 offset0:32 offset1:48
  v_mfma_f32_16x16x32_bf16 v[188:191], a[76:79], a[60:63], v[188:191]
  ds_read_b64_tr_b16 a[90:91], v230 offset:53248
  v_lshrrev_b32 v250, 3, v253
  v_mfma_f32_16x16x32_bf16 v[184:187], a[76:79], a[56:59], v[184:187]
  v_add_u32 v250, s66, v250
  v_add_u32 v250, -1, v250
  v_mfma_f32_16x16x32_bf16 v[184:187], a[72:75], a[40:43], v[184:187]
  v_bfe_u32 v242, v253, 2, 1
  v_mul_u32_u24 v242, 14336, v242
  v_mfma_f32_16x16x32_bf16 v[180:183], a[72:75], a[36:39], v[180:183]
  ds_read_b64_tr_b16 a[92:93], v230 offset:57344
  v_min_u32 v250, 6, v250
  v_mfma_f32_16x16x32_bf16 v[180:183], a[76:79], a[52:55], v[180:183]
  ds_read_b64_tr_b16 a[94:95], v230 offset:61440
  v_xor_b32 v230, 0x10000, v230
  v_lshl_add_u32 v250, v250, 6, v242
  v_mfma_f32_16x16x32_bf16 v[176:179], a[76:79], a[48:51], v[176:179]
  buffer_load_dwordx4 v233, s[20:23], s67 offen offset:1024  lds
  v_mfma_f32_16x16x32_bf16 v[176:179], a[72:75], a[32:35], v[176:179]
  s_waitcnt lgkmcnt(7)
  v_and_b32 v242, 3, v253
  v_lshl_add_u32 v250, v242, 4, v250
  v_mfma_f32_16x16x32_bf16 v[192:195], a[80:83], a[32:35], v[192:195]
  s_waitcnt vmcnt(17)
  s_barrier
  ds_read_b64_tr_b16 a[64:65], v224 offset:0
  s_waitcnt vmcnt(9)
  v_cmp_gt_u32 vcc, 56, v237
  s_cbranch_vccnz Lchk20_c
Lchk20_r:
  v_mfma_f32_16x16x32_bf16 v[192:195], a[84:87], a[48:51], v[192:195]
  ds_read_b64_tr_b16 a[66:67], v224 offset:4096
  buffer_load_dwordx4 v[242:245], v250, s[4:7], s46 offen sc1
  v_mfma_f32_16x16x32_bf16 v[196:199], a[84:87], a[52:55], v[196:199]
  buffer_load_dwordx4 v[246:249], v250, s[4:7], s47 offen sc1
  v_lshrrev_b32 v237, 4, v253
  v_mfma_f32_16x16x32_bf16 v[196:199], a[80:83], a[36:39], v[196:199]
  v_lshlrev_b32 v237, 4, v237
  v_add_u32 v237, s71, v237
  v_mfma_f32_16x16x32_bf16 v[200:203], a[80:83], a[40:43], v[200:203]
  ds_read_b64_tr_b16 a[68:69], v224 offset:8192
  v_add_u32 v250, s71, v231
  v_mfma_f32_16x16x32_bf16 v[200:203], a[84:87], a[56:59], v[200:203]
  ds_read_b64_tr_b16 a[70:71], v224 offset:12288
  v_mfma_f32_16x16x32_bf16 v[204:207], a[84:87], a[60:63], v[204:207]
  buffer_load_dwordx4 v234, s[20:23], s67 offen offset:2048  lds
  v_mfma_f32_16x16x32_bf16 v[204:207], a[80:83], a[44:47], v[204:207]
  s_waitcnt lgkmcnt(4)
  v_mfma_f32_16x16x32_bf16 v[220:223], a[88:91], a[44:47], v[220:223]
  ds_read_b64_tr_b16 a[72:73], v224 offset:16384
  v_mfma_f32_16x16x32_bf16 v[220:223], a[92:95], a[60:63], v[220:223]
  ds_read_b64_tr_b16 a[74:75], v224 offset:20480
  v_mfma_f32_16x16x32_bf16 v[216:219], a[92:95], a[56:59], v[216:219]
  buffer_load_dwordx4 v235, s[20:23], s67 offen offset:3072  lds
  v_mfma_f32_16x16x32_bf16 v[216:219], a[88:91], a[40:43], v[216:219]
  s_add_u32 s67, s67, 458752
  s_xor_b32 s68, s68, 0x10000
  v_mfma_f32_16x16x32_bf16 v[212:215], a[88:91], a[36:39], v[212:215]
  ds_read_b64_tr_b16 a[76:77], v224 offset:24576
  v_mfma_f32_16x16x32_bf16 v[212:215], a[92:95], a[52:55], v[212:215]
  ds_read_b64_tr_b16 a[78:79], v224 offset:28672
  v_mfma_f32_16x16x32_bf16 v[208:211], a[92:95], a[48:51], v[208:211]
  v_mfma_f32_16x16x32_bf16 v[208:211], a[88:91], a[32:35], v[208:211]
  s_mov_b32 s56, 5
.p2align 3
Lp3_loop:
  s_waitcnt vmcnt(8) lgkmcnt(4)
  v_mfma_f32_16x16x32_bf16 v[0:3], a[64:67], a[0:3], v[0:3]
  ds_read_b64_tr_b16 a[80:81], v225 offset:0
  v_mfma_f32_16x16x32_bf16 v[0:3], a[68:71], a[16:19], v[0:3]
  ds_read_b64_tr_b16 a[82:83], v225 offset:4096
  v_mfma_f32_16x16x32_bf16 v[4:7], a[68:71], a[20:23], v[4:7]
  buffer_load_dwordx4 a[32:35], v231, s[4:7], s72 offen offset:2048 sc1
  v_mfma_f32_16x16x32_bf16 v[4:7], a[64:67], a[4:7], v[4:7]
  v_mfma_f32_16x16x32_bf16 v[8:11], a[64:67], a[8:11], v[8:11]
  ds_read_b64_tr_b16 a[84:85], v225 offset:8192
  v_mfma_f32_16x16x32_bf16 v[8:11], a[68:71], a[24:27], v[8:11]
  ds_read_b64_tr_b16 a[86:87], v225 offset:12288
  v_mfma_f32_16x16x32_bf16 v[12:15], a[68:71], a[28:31], v[12:15]
  v_mfma_f32_16x16x32_bf16 v[12:15], a[64:67], a[12:15], v[12:15]
  s_waitcnt lgkmcnt(4)
  v_mfma_f32_16x16x32_bf16 v[28:31], a[72:75], a[12:15], v[28:31]
  ds_read_b64_tr_b16 a[88:89], v225 offset:16384
  v_mfma_f32_16x16x32_bf16 v[28:31], a[76:79], a[28:31], v[28:31]
  ds_read_b64_tr_b16 a[90:91], v225 offset:20480
  v_mfma_f32_16x16x32_bf16 v[24:27], a[76:79], a[24:27], v[24:27]
  buffer_load_dwordx4 a[48:51], v231, s[4:7], s72 offen offset:3072 sc1
  v_mfma_f32_16x16x32_bf16 v[24:27], a[72:75], a[8:11], v[24:27]
  s_add_u32 s72, s72, 4096
  v_mfma_f32_16x16x32_bf16 v[20:23], a[72:75], a[4:7], v[20:23]
  ds_read_b64_tr_b16 a[92:93], v225 offset:24576
  v_mfma_f32_16x16x32_bf16 v[20:23], a[76:79], a[20:23], v[20:23]
  ds_read_b64_tr_b16 a[94:95], v225 offset:28672
  v_mfma_f32_16x16x32_bf16 v[16:19], a[76:79], a[16:19], v[16:19]
  v_mfma_f32_16x16x32_bf16 v[16:19], a[72:75], a[0:3], v[16:19]
  s_waitcnt lgkmcnt(4)
  v_mfma_f32_16x16x32_bf16 v[32:35], a[80:83], a[0:3], v[32:35]
  ds_read_b64_tr_b16 a[64:65], v226 offset:0
  v_mfma_f32_16x16x32_bf16 v[32:35], a[84:87], a[16:19], v[32:35]
  ds_read_b64_tr_b16 a[66:67], v226 offset:4096
  v_mfma_f32_16x16x32_bf16 v[36:39], a[84:87], a[20:23], v[36:39]
  buffer_load_dwordx4 a[36:39], v231, s[4:7], s73 offen offset:2048 sc1
  v_mfma_f32_16x16x32_bf16 v[36:39], a[80:83], a[4:7], v[36:39]
  v_mfma_f32_16x16x32_bf16 v[40:43], a[80:83], a[8:11], v[40:43]
  ds_read_b64_tr_b16 a[68:69], v226 offset:8192
  v_mfma_f32_16x16x32_bf16 v[40:43], a[84:87], a[24:27], v[40:43]
  ds_read_b64_tr_b16 a[70:71], v226 offset:12288
  v_mfma_f32_16x16x32_bf16 v[44:47], a[84:87], a[28:31], v[44:47]
  buffer_load_dwordx4 a[52:55], v231, s[4:7], s73 offen offset:3072 sc1
  v_mfma_f32_16x16x32_bf16 v[44:47], a[80:83], a[12:15], v[44:47]
  s_add_u32 s73, s73, 4096
  s_waitcnt lgkmcnt(4)
  v_mfma_f32_16x16x32_bf16 v[60:63], a[88:91], a[12:15], v[60:63]
  ds_read_b64_tr_b16 a[72:73], v226 offset:16384
  v_mfma_f32_16x16x32_bf16 v[60:63], a[92:95], a[28:31], v[60:63]
  ds_read_b64_tr_b16 a[74:75], v226 offset:20480
  v_mfma_f32_16x16x32_bf16 v[56:59], a[92:95], a[24:27], v[56:59]
  v_mfma_f32_16x16x32_bf16 v[56:59], a[88:91], a[8:11], v[56:59]
  v_mfma_f32_16x16x32_bf16 v[52:55], a[88:91], a[4:7], v[52:55]
  ds_read_b64_tr_b16 a[76:77], v226 offset:24576
  v_mfma_f32_16x16x32_bf16 v[52:55], a[92:95], a[20:23], v[52:55]
  ds_read_b64_tr_b16 a[78:79], v226 offset:28672
  v_mfma_f32_16x16x32_bf16 v[48:51], a[92:95], a[16:19], v[48:51]
  buffer_load_dwordx4 a[40:43], v231, s[4:7], s74 offen offset:2048 sc1
  v_mfma_f32_16x16x32_bf16 v[48:51], a[88:91], a[0:3], v[48:51]
  s_waitcnt lgkmcnt(4)
  v_mfma_f32_16x16x32_bf16 v[64:67], a[64:67], a[0:3], v[64:67]
  ds_read_b64_tr_b16 a[80:81], v227 offset:0
  v_mfma_f32_16x16x32_bf16 v[64:67], a[68:71], a[16:19], v[64:67]
  ds_read_b64_tr_b16 a[82:83], v227 offset:4096
  v_mfma_f32_16x16x32_bf16 v[68:71], a[68:71], a[20:23], v[68:71]
  v_mfma_f32_16x16x32_bf16 v[68:71], a[64:67], a[4:7], v[68:71]
  v_mfma_f32_16x16x32_bf16 v[72:75], a[64:67], a[8:11], v[72:75]
  ds_read_b64_tr_b16 a[84:85], v227 offset:8192
  v_mfma_f32_16x16x32_bf16 v[72:75], a[68:71], a[24:27], v[72:75]
  ds_read_b64_tr_b16 a[86:87], v227 offset:12288
  v_mfma_f32_16x16x32_bf16 v[76:79], a[68:71], a[28:31], v[76:79]
  buffer_load_dwordx4 a[56:59], v231, s[4:7], s74 offen offset:3072 sc1
  v_mfma_f32_16x16x32_bf16 v[76:79], a[64:67], a[12:15], v[76:79]
  s_add_u32 s74, s74, 4096
  s_waitcnt lgkmcnt(4)
  v_mfma_f32_16x16x32_bf16 v[92:95], a[72:75], a[12:15], v[92:95]
  ds_read_b64_tr_b16 a[88:89], v227 offset:16384
  v_mfma_f32_16x16x32_bf16 v[92:95], a[76:79], a[28:31], v[92:95]
  ds_read_b64_tr_b16 a[90:91], v227 offset:20480
  v_mfma_f32_16x16x32_bf16 v[88:91], a[76:79], a[24:27], v[88:91]
  v_mfma_f32_16x16x32_bf16 v[88:91], a[72:75], a[8:11], v[88:91]
  v_mfma_f32_16x16x32_bf16 v[84:87], a[72:75], a[4:7], v[84:87]
  ds_read_b64_tr_b16 a[92:93], v227 offset:24576
  v_mfma_f32_16x16x32_bf16 v[84:87], a[76:79], a[20:23], v[84:87]
  ds_read_b64_tr_b16 a[94:95], v227 offset:28672
  v_mfma_f32_16x16x32_bf16 v[80:83], a[76:79], a[16:19], v[80:83]
  buffer_load_dwordx4 a[44:47], v231, s[4:7], s75 offen offset:2048 sc1
  v_mfma_f32_16x16x32_bf16 v[80:83], a[72:75], a[0:3], v[80:83]
  s_waitcnt lgkmcnt(4)
  v_mfma_f32_16x16x32_bf16 v[96:99], a[80:83], a[0:3], v[96:99]
  ds_read_b64_tr_b16 a[64:65], v228 offset:0
  v_mfma_f32_16x16x32_bf16 v[96:99], a[84:87], a[16:19], v[96:99]
  ds_read_b64_tr_b16 a[66:67], v228 offset:4096
  v_mfma_f32_16x16x32_bf16 v[100:103], a[84:87], a[20:23], v[100:103]
  buffer_load_dwordx4 a[96:99], v236, s[24:27], s70 offen
  v_mfma_f32_16x16x32_bf16 v[100:103], a[80:83], a[4:7], v[100:103]
  s_add_u32 s70, s70, 1024
  v_mfma_f32_16x16x32_bf16 v[104:107], a[80:83], a[8:11], v[104:107]
  ds_read_b64_tr_b16 a[68:69], v228 offset:8192
  v_mfma_f32_16x16x32_bf16 v[104:107], a[84:87], a[24:27], v[104:107]
  ds_read_b64_tr_b16 a[70:71], v228 offset:12288
  v_mfma_f32_16x16x32_bf16 v[108:111], a[84:87], a[28:31], v[108:111]
  buffer_load_dwordx4 a[60:63], v231, s[4:7], s75 offen offset:3072 sc1
  v_mfma_f32_16x16x32_bf16 v[108:111], a[80:83], a[12:15], v[108:111]
  s_add_u32 s75, s75, 4096
  s_waitcnt lgkmcnt(4)
  v_mfma_f32_16x16x32_bf16 v[124:127], a[88:91], a[12:15], v[124:127]
  ds_read_b64_tr_b16 a[72:73], v228 offset:16384
  v_mfma_f32_16x16x32_bf16 v[124:127], a[92:95], a[28:31], v[124:127]
  ds_read_b64_tr_b16 a[74:75], v228 offset:20480
  s_add_u32 m0, s68, 0
  v_mfma_f32_16x16x32_bf16 v[120:123], a[92:95], a[24:27], v[120:123]
  buffer_load_dwordx4 v232, s[16:19], s67 offen offset:0  lds
  v_mfma_f32_16x16x32_bf16 v[120:123], a[88:91], a[8:11], v[120:123]
  v_mfma_f32_16x16x32_bf16 v[116:119], a[88:91], a[4:7], v[116:119]
  ds_read_b64_tr_b16 a[76:77], v228 offset:24576
  v_mfma_f32_16x16x32_bf16 v[116:119], a[92:95], a[20:23], v[116:119]
  ds_read_b64_tr_b16 a[78:79], v228 offset:28672
  v_mfma_f32_16x16x32_bf16 v[112:115], a[92:95], a[16:19], v[112:115]
  v_mfma_f32_16x16x32_bf16 v[112:115], a[88:91], a[0:3], v[112:115]
  s_waitcnt lgkmcnt(4)
  v_mfma_f32_16x16x32_bf16 v[128:131], a[64:67], a[0:3], v[128:131]
  ds_read_b64_tr_b16 a[80:81], v229 offset:0
  v_mfma_f32_16x16x32_bf16 v[128:131], a[68:71], a[16:19], v[128:131]
  ds_read_b64_tr_b16 a[82:83], v229 offset:4096
  v_mfma_f32_16x16x32_bf16 v[132:135], a[68:71], a[20:23], v[132:135]
  buffer_load_dwordx4 v233, s[16:19], s67 offen offset:1024  lds
  v_mfma_f32_16x16x32_bf16 v[132:135], a[64:67], a[4:7], v[132:135]
  v_mfma_f32_16x16x32_bf16 v[136:139], a[64:67], a[8:11], v[136:139]
  ds_read_b64_tr_b16 a[84:85], v229 offset:8192
  v_mfma_f32_16x16x32_bf16 v[136:139], a[68:71], a[24:27], v[136:139]
  ds_read_b64_tr_b16 a[86:87], v229 offset:12288
  v_mfma_f32_16x16x32_bf16 v[140:143], a[68:71], a[28:31], v[140:143]
  v_mfma_f32_16x16x32_bf16 v[140:143], a[64:67], a[12:15], v[140:143]
  s_waitcnt lgkmcnt(4)
  v_mfma_f32_16x16x32_bf16 v[156:159], a[72:75], a[12:15], v[156:159]
  ds_read_b64_tr_b16 a[88:89], v229 offset:16384
  v_mfma_f32_16x16x32_bf16 v[156:159], a[76:79], a[28:31], v[156:159]
  ds_read_b64_tr_b16 a[90:91], v229 offset:20480
  v_mfma_f32_16x16x32_bf16 v[152:155], a[76:79], a[24:27], v[152:155]
  buffer_load_dwordx4 v234, s[16:19], s67 offen offset:2048  lds
  v_mfma_f32_16x16x32_bf16 v[152:155], a[72:75], a[8:11], v[152:155]
  v_mfma_f32_16x16x32_bf16 v[148:151], a[72:75], a[4:7], v[148:151]
  ds_read_b64_tr_b16 a[92:93], v229 offset:24576
  v_mfma_f32_16x16x32_bf16 v[148:151], a[76:79], a[20:23], v[148:151]
  ds_read_b64_tr_b16 a[94:95], v229 offset:28672
  v_mfma_f32_16x16x32_bf16 v[144:147], a[76:79], a[16:19], v[144:147]
  buffer_load_dwordx4 v235, s[16:19], s67 offen offset:3072  lds
  v_mfma_f32_16x16x32_bf16 v[144:147], a[72:75], a[0:3], v[144:147]
  s_waitcnt lgkmcnt(4)
  v_mfma_f32_16x16x32_bf16 v[160:163], a[80:83], a[0:3], v[160:163]
  ds_read_b64_tr_b16 a[64:65], v230 offset:0
  v_mfma_f32_16x16x32_bf16 v[160:163], a[84:87], a[16:19], v[160:163]
  ds_read_b64_tr_b16 a[66:67], v230 offset:4096
  v_mfma_f32_16x16x32_bf16 v[164:167], a[84:87], a[20:23], v[164:167]
  v_mfma_f32_16x16x32_bf16 v[164:167], a[80:83], a[4:7], v[164:167]
  v_mfma_f32_16x16x32_bf16 v[168:171], a[80:83], a[8:11], v[168:171]
  ds_read_b64_tr_b16 a[68:69], v230 offset:8192
  v_mfma_f32_16x16x32_bf16 v[168:171], a[84:87], a[24:27], v[168:171]
  ds_read_b64_tr_b16 a[70:71], v230 offset:12288
  s_add_u32 m0, s68, 16384
  v_mfma_f32_16x16x32_bf16 v[172:175], a[84:87], a[28:31], v[172:175]
  buffer_load_dwordx4 v232, s[20:23], s67 offen offset:0  lds
  v_mfma_f32_16x16x32_bf16 v[172:175], a[80:83], a[12:15], v[172:175]
  s_waitcnt lgkmcnt(4)
  v_mfma_f32_16x16x32_bf16 v[188:191], a[88:91], a[12:15], v[188:191]
  ds_read_b64_tr_b16 a[72:73], v230 offset:16384
  v_mfma_f32_16x16x32_bf16 v[188:191], a[92:95], a[28:31], v[188:191]
  ds_read_b64_tr_b16 a[74:75], v230 offset:20480
  v_mfma_f32_16x16x32_bf16 v[184:187], a[92:95], a[24:27], v[184:187]
  v_mfma_f32_16x16x32_bf16 v[184:187], a[88:91], a[8:11], v[184:187]
  v_mfma_f32_16x16x32_bf16 v[180:183], a[88:91], a[4:7], v[180:183]
  ds_read_b64_tr_b16 a[76:77], v230 offset:24576
  v_mfma_f32_16x16x32_bf16 v[180:183], a[92:95], a[20:23], v[180:183]
  ds_read_b64_tr_b16 a[78:79], v230 offset:28672
  v_mfma_f32_16x16x32_bf16 v[176:179], a[92:95], a[16:19], v[176:179]
  buffer_load_dwordx4 v233, s[20:23], s67 offen offset:1024  lds
  v_mfma_f32_16x16x32_bf16 v[176:179], a[88:91], a[0:3], v[176:179]
  s_waitcnt lgkmcnt(4)
  v_mfma_f32_16x16x32_bf16 v[192:195], a[64:67], a[0:3], v[192:195]
  s_waitcnt vmcnt(15)
  s_barrier
  ds_read_b64_tr_b16 a[80:81], v224 offset:32768
  v_mfma_f32_16x16x32_bf16 v[192:195], a[68:71], a[16:19], v[192:195]
  ds_read_b64_tr_b16 a[82:83], v224 offset:36864
  v_mfma_f32_16x16x32_bf16 v[196:199], a[68:71], a[20:23], v[196:199]
  v_mfma_f32_16x16x32_bf16 v[196:199], a[64:67], a[4:7], v[196:199]
  v_mfma_f32_16x16x32_bf16 v[200:203], a[64:67], a[8:11], v[200:203]
  ds_read_b64_tr_b16 a[84:85], v224 offset:40960
  v_mfma_f32_16x16x32_bf16 v[200:203], a[68:71], a[24:27], v[200:203]
  ds_read_b64_tr_b16 a[86:87], v224 offset:45056
  v_mfma_f32_16x16x32_bf16 v[204:207], a[68:71], a[28:31], v[204:207]
  buffer_load_dwordx4 v234, s[20:23], s67 offen offset:2048  lds
  v_mfma_f32_16x16x32_bf16 v[204:207], a[64:67], a[12:15], v[204:207]
  s_waitcnt lgkmcnt(4)
  v_mfma_f32_16x16x32_bf16 v[220:223], a[72:75], a[12:15], v[220:223]
  ds_read_b64_tr_b16 a[88:89], v224 offset:49152
  v_mfma_f32_16x16x32_bf16 v[220:223], a[76:79], a[28:31], v[220:223]
  ds_read_b64_tr_b16 a[90:91], v224 offset:53248
  v_mfma_f32_16x16x32_bf16 v[216:219], a[76:79], a[24:27], v[216:219]
  buffer_load_dwordx4 v235, s[20:23], s67 offen offset:3072  lds
  v_mfma_f32_16x16x32_bf16 v[216:219], a[72:75], a[8:11], v[216:219]
  s_add_u32 s67, s67, 458752
  v_mfma_f32_16x16x32_bf16 v[212:215], a[72:75], a[4:7], v[212:215]
  ds_read_b64_tr_b16 a[92:93], v224 offset:57344
  v_mfma_f32_16x16x32_bf16 v[212:215], a[76:79], a[20:23], v[212:215]
  ds_read_b64_tr_b16 a[94:95], v224 offset:61440
  v_xor_b32 v224, 0x10000, v224
  v_mfma_f32_16x16x32_bf16 v[208:211], a[76:79], a[16:19], v[208:211]
  v_mfma_f32_16x16x32_bf16 v[208:211], a[72:75], a[0:3], v[208:211]
  s_waitcnt vmcnt(8) lgkmcnt(4)
  v_mfma_f32_16x16x32_bf16 v[0:3], a[80:83], a[32:35], v[0:3]
  ds_read_b64_tr_b16 a[64:65], v225 offset:32768
  v_mfma_f32_16x16x32_bf16 v[0:3], a[84:87], a[48:51], v[0:3]
  ds_read_b64_tr_b16 a[66:67], v225 offset:36864
  v_mfma_f32_16x16x32_bf16 v[4:7], a[84:87], a[52:55], v[4:7]
  buffer_load_dwordx4 a[0:3], v231, s[4:7], s72 offen offset:0 sc1
  v_mfma_f32_16x16x32_bf16 v[4:7], a[80:83], a[36:39], v[4:7]
  v_mfma_f32_16x16x32_bf16 v[8:11], a[80:83], a[40:43], v[8:11]
  ds_read_b64_tr_b16 a[68:69], v225 offset:40960
  v_mfma_f32_16x16x32_bf16 v[8:11], a[84:87], a[56:59], v[8:11]
  ds_read_b64_tr_b16 a[70:71], v225 offset:45056
  v_mfma_f32_16x16x32_bf16 v[12:15], a[84:87], a[60:63], v[12:15]
  v_mfma_f32_16x16x32_bf16 v[12:15], a[80:83], a[44:47], v[12:15]
  s_waitcnt lgkmcnt(4)
  v_mfma_f32_16x16x32_bf16 v[28:31], a[88:91], a[44:47], v[28:31]
  ds_read_b64_tr_b16 a[72:73], v225 offset:49152
  v_mfma_f32_16x16x32_bf16 v[28:31], a[92:95], a[60:63], v[28:31]
  ds_read_b64_tr_b16 a[74:75], v225 offset:53248
  v_mfma_f32_16x16x32_bf16 v[24:27], a[92:95], a[56:59], v[24:27]
  buffer_load_dwordx4 a[16:19], v231, s[4:7], s72 offen offset:1024 sc1
  v_mfma_f32_16x16x32_bf16 v[24:27], a[88:91], a[40:43], v[24:27]
  v_mfma_f32_16x16x32_bf16 v[20:23], a[88:91], a[36:39], v[20:23]
  ds_read_b64_tr_b16 a[76:77], v225 offset:57344
  v_mfma_f32_16x16x32_bf16 v[20:23], a[92:95], a[52:55], v[20:23]
  ds_read_b64_tr_b16 a[78:79], v225 offset:61440
  v_xor_b32 v225, 0x10000, v225
  v_mfma_f32_16x16x32_bf16 v[16:19], a[92:95], a[48:51], v[16:19]
  v_mfma_f32_16x16x32_bf16 v[16:19], a[88:91], a[32:35], v[16:19]
  s_waitcnt lgkmcnt(4)
  v_mfma_f32_16x16x32_bf16 v[32:35], a[64:67], a[32:35], v[32:35]
  ds_read_b64_tr_b16 a[80:81], v226 offset:32768
  v_mfma_f32_16x16x32_bf16 v[32:35], a[68:71], a[48:51], v[32:35]
  ds_read_b64_tr_b16 a[82:83], v226 offset:36864
  v_mfma_f32_16x16x32_bf16 v[36:39], a[68:71], a[52:55], v[36:39]
  buffer_load_dwordx4 a[4:7], v231, s[4:7], s73 offen offset:0 sc1
  v_mfma_f32_16x16x32_bf16 v[36:39], a[64:67], a[36:39], v[36:39]
  v_mfma_f32_16x16x32_bf16 v[40:43], a[64:67], a[40:43], v[40:43]
  ds_read_b64_tr_b16 a[84:85], v226 offset:40960
  v_mfma_f32_16x16x32_bf16 v[40:43], a[68:71], a[56:59], v[40:43]
  ds_read_b64_tr_b16 a[86:87], v226 offset:45056
  v_mfma_f32_16x16x32_bf16 v[44:47], a[68:71], a[60:63], v[44:47]
  buffer_load_dwordx4 a[20:23], v231, s[4:7], s73 offen offset:1024 sc1
  v_mfma_f32_16x16x32_bf16 v[44:47], a[64:67], a[44:47], v[44:47]
  s_waitcnt lgkmcnt(4)
  v_mfma_f32_16x16x32_bf16 v[60:63], a[72:75], a[44:47], v[60:63]
  ds_read_b64_tr_b16 a[88:89], v226 offset:49152
  v_mfma_f32_16x16x32_bf16 v[60:63], a[76:79], a[60:63], v[60:63]
  ds_read_b64_tr_b16 a[90:91], v226 offset:53248
  v_mfma_f32_16x16x32_bf16 v[56:59], a[76:79], a[56:59], v[56:59]
  v_mfma_f32_16x16x32_bf16 v[56:59], a[72:75], a[40:43], v[56:59]
  v_mfma_f32_16x16x32_bf16 v[52:55], a[72:75], a[36:39], v[52:55]
  ds_read_b64_tr_b16 a[92:93], v226 offset:57344
  v_mfma_f32_16x16x32_bf16 v[52:55], a[76:79], a[52:55], v[52:55]
  ds_read_b64_tr_b16 a[94:95], v226 offset:61440
  v_xor_b32 v226, 0x10000, v226
  v_mfma_f32_16x16x32_bf16 v[48:51], a[76:79], a[48:51], v[48:51]
  buffer_load_dwordx4 a[8:11], v231, s[4:7], s74 offen offset:0 sc1
  v_mfma_f32_16x16x32_bf16 v[48:51], a[72:75], a[32:35], v[48:51]
  s_waitcnt lgkmcnt(4)
  v_mfma_f32_16x16x32_bf16 v[64:67], a[80:83], a[32:35], v[64:67]
  ds_read_b64_tr_b16 a[64:65], v227 offset:32768
  v_mfma_f32_16x16x32_bf16 v[64:67], a[84:87], a[48:51], v[64:67]
  ds_read_b64_tr_b16 a[66:67], v227 offset:36864
  v_mfma_f32_16x16x32_bf16 v[68:71], a[84:87], a[52:55], v[68:71]
  v_mfma_f32_16x16x32_bf16 v[68:71], a[80:83], a[36:39], v[68:71]
  v_mfma_f32_16x16x32_bf16 v[72:75], a[80:83], a[40:43], v[72:75]
  ds_read_b64_tr_b16 a[68:69], v227 offset:40960
  v_mfma_f32_16x16x32_bf16 v[72:75], a[84:87], a[56:59], v[72:75]
  ds_read_b64_tr_b16 a[70:71], v227 offset:45056
  v_mfma_f32_16x16x32_bf16 v[76:79], a[84:87], a[60:63], v[76:79]
  buffer_load_dwordx4 a[24:27], v231, s[4:7], s74 offen offset:1024 sc1
  v_mfma_f32_16x16x32_bf16 v[76:79], a[80:83], a[44:47], v[76:79]
  s_waitcnt lgkmcnt(4)
  v_mfma_f32_16x16x32_bf16 v[92:95], a[88:91], a[44:47], v[92:95]
  ds_read_b64_tr_b16 a[72:73], v227 offset:49152
  v_mfma_f32_16x16x32_bf16 v[92:95], a[92:95], a[60:63], v[92:95]
  ds_read_b64_tr_b16 a[74:75], v227 offset:53248
  v_mfma_f32_16x16x32_bf16 v[88:91], a[92:95], a[56:59], v[88:91]
  v_mfma_f32_16x16x32_bf16 v[88:91], a[88:91], a[40:43], v[88:91]
  v_mfma_f32_16x16x32_bf16 v[84:87], a[88:91], a[36:39], v[84:87]
  ds_read_b64_tr_b16 a[76:77], v227 offset:57344
  v_mfma_f32_16x16x32_bf16 v[84:87], a[92:95], a[52:55], v[84:87]
  ds_read_b64_tr_b16 a[78:79], v227 offset:61440
  v_xor_b32 v227, 0x10000, v227
  v_mfma_f32_16x16x32_bf16 v[80:83], a[92:95], a[48:51], v[80:83]
  buffer_load_dwordx4 a[12:15], v231, s[4:7], s75 offen offset:0 sc1
  v_mfma_f32_16x16x32_bf16 v[80:83], a[88:91], a[32:35], v[80:83]
  s_waitcnt lgkmcnt(4)
  v_mfma_f32_16x16x32_bf16 v[96:99], a[64:67], a[32:35], v[96:99]
  ds_read_b64_tr_b16 a[80:81], v228 offset:32768
  v_mfma_f32_16x16x32_bf16 v[96:99], a[68:71], a[48:51], v[96:99]
  ds_read_b64_tr_b16 a[82:83], v228 offset:36864
  v_mfma_f32_16x16x32_bf16 v[100:103], a[68:71], a[52:55], v[100:103]
  v_mfma_f32_16x16x32_bf16 v[100:103], a[64:67], a[36:39], v[100:103]
  v_mfma_f32_16x16x32_bf16 v[104:107], a[64:67], a[40:43], v[104:107]
  ds_read_b64_tr_b16 a[84:85], v228 offset:40960
  v_mfma_f32_16x16x32_bf16 v[104:107], a[68:71], a[56:59], v[104:107]
  ds_read_b64_tr_b16 a[86:87], v228 offset:45056
  v_mfma_f32_16x16x32_bf16 v[108:111], a[68:71], a[60:63], v[108:111]
  buffer_load_dwordx4 a[28:31], v231, s[4:7], s75 offen offset:1024 sc1
  v_mfma_f32_16x16x32_bf16 v[108:111], a[64:67], a[44:47], v[108:111]
  s_waitcnt lgkmcnt(4)
  v_mfma_f32_16x16x32_bf16 v[124:127], a[72:75], a[44:47], v[124:127]
  ds_read_b64_tr_b16 a[88:89], v228 offset:49152
  v_mfma_f32_16x16x32_bf16 v[124:127], a[76:79], a[60:63], v[124:127]
  ds_read_b64_tr_b16 a[90:91], v228 offset:53248
  s_add_u32 m0, s68, 32768
  v_mfma_f32_16x16x32_bf16 v[120:123], a[76:79], a[56:59], v[120:123]
  buffer_load_dwordx4 v232, s[16:19], s67 offen offset:0  lds
  v_mfma_f32_16x16x32_bf16 v[120:123], a[72:75], a[40:43], v[120:123]
  v_mfma_f32_16x16x32_bf16 v[116:119], a[72:75], a[36:39], v[116:119]
  ds_read_b64_tr_b16 a[92:93], v228 offset:57344
  v_mfma_f32_16x16x32_bf16 v[116:119], a[76:79], a[52:55], v[116:119]
  ds_read_b64_tr_b16 a[94:95], v228 offset:61440
  v_xor_b32 v228, 0x10000, v228
  v_mfma_f32_16x16x32_bf16 v[112:115], a[76:79], a[48:51], v[112:115]
  v_mfma_f32_16x16x32_bf16 v[112:115], a[72:75], a[32:35], v[112:115]
  s_waitcnt lgkmcnt(4)
  v_mfma_f32_16x16x32_bf16 v[128:131], a[80:83], a[32:35], v[128:131]
  ds_read_b64_tr_b16 a[64:65], v229 offset:32768
  v_mfma_f32_16x16x32_bf16 v[128:131], a[84:87], a[48:51], v[128:131]
  ds_read_b64_tr_b16 a[66:67], v229 offset:36864
  v_mfma_f32_16x16x32_bf16 v[132:135], a[84:87], a[52:55], v[132:135]
  buffer_load_dwordx4 v233, s[16:19], s67 offen offset:1024  lds
  v_mfma_f32_16x16x32_bf16 v[132:135], a[80:83], a[36:39], v[132:135]
  v_mfma_f32_16x16x32_bf16 v[136:139], a[80:83], a[40:43], v[136:139]
  ds_read_b64_tr_b16 a[68:69], v229 offset:40960
  v_mfma_f32_16x16x32_bf16 v[136:139], a[84:87], a[56:59], v[136:139]
  ds_read_b64_tr_b16 a[70:71], v229 offset:45056
  v_mfma_f32_16x16x32_bf16 v[140:143], a[84:87], a[60:63], v[140:143]
  v_mfma_f32_16x16x32_bf16 v[140:143], a[80:83], a[44:47], v[140:143]
  s_waitcnt lgkmcnt(4)
  v_mfma_f32_16x16x32_bf16 v[156:159], a[88:91], a[44:47], v[156:159]
  ds_read_b64_tr_b16 a[72:73], v229 offset:49152
  v_mfma_f32_16x16x32_bf16 v[156:159], a[92:95], a[60:63], v[156:159]
  ds_read_b64_tr_b16 a[74:75], v229 offset:53248
  v_mfma_f32_16x16x32_bf16 v[152:155], a[92:95], a[56:59], v[152:155]
  buffer_load_dwordx4 v234, s[16:19], s67 offen offset:2048  lds
  v_mfma_f32_16x16x32_bf16 v[152:155], a[88:91], a[40:43], v[152:155]
  v_mfma_f32_16x16x32_bf16 v[148:151], a[88:91], a[36:39], v[148:151]
  ds_read_b64_tr_b16 a[76:77], v229 offset:57344
  v_mfma_f32_16x16x32_bf16 v[148:151], a[92:95], a[52:55], v[148:151]
  ds_read_b64_tr_b16 a[78:79], v229 offset:61440
  v_xor_b32 v229, 0x10000, v229
  v_mfma_f32_16x16x32_bf16 v[144:147], a[92:95], a[48:51], v[144:147]
  buffer_load_dwordx4 v235, s[16:19], s67 offen offset:3072  lds
  v_mfma_f32_16x16x32_bf16 v[144:147], a[88:91], a[32:35], v[144:147]
  s_waitcnt lgkmcnt(4)
  v_mfma_f32_16x16x32_bf16 v[160:163], a[64:67], a[32:35], v[160:163]
  ds_read_b64_tr_b16 a[80:81], v230 offset:32768
  v_mfma_f32_16x16x32_bf16 v[160:163], a[68:71], a[48:51], v[160:163]
  ds_read_b64_tr_b16 a[82:83], v230 offset:36864
  v_mfma_f32_16x16x32_bf16 v[164:167], a[68:71], a[52:55], v[164:167]
  v_mfma_f32_16x16x32_bf16 v[164:167], a[64:67], a[36:39], v[164:167]
  v_mfma_f32_16x16x32_bf16 v[168:171], a[64:67], a[40:43], v[168:171]
  ds_read_b64_tr_b16 a[84:85], v230 offset:40960
  v_mfma_f32_16x16x32_bf16 v[168:171], a[68:71], a[56:59], v[168:171]
  ds_read_b64_tr_b16 a[86:87], v230 offset:45056
  s_add_u32 m0, s68, 49152
  v_mfma_f32_16x16x32_bf16 v[172:175], a[68:71], a[60:63], v[172:175]
  buffer_load_dwordx4 v232, s[20:23], s67 offen offset:0  lds
  v_mfma_f32_16x16x32_bf16 v[172:175], a[64:67], a[44:47], v[172:175]
  s_waitcnt lgkmcnt(4)
  v_mfma_f32_16x16x32_bf16 v[188:191], a[72:75], a[44:47], v[188:191]
  ds_read_b64_tr_b16 a[88:89], v230 offset:49152
  v_mfma_f32_16x16x32_bf16 v[188:191], a[76:79], a[60:63], v[188:191]
  ds_read_b64_tr_b16 a[90:91], v230 offset:53248
  v_mfma_f32_16x16x32_bf16 v[184:187], a[76:79], a[56:59], v[184:187]
  v_mfma_f32_16x16x32_bf16 v[184:187], a[72:75], a[40:43], v[184:187]
  v_mfma_f32_16x16x32_bf16 v[180:183], a[72:75], a[36:39], v[180:183]
  ds_read_b64_tr_b16 a[92:93], v230 offset:57344
  v_mfma_f32_16x16x32_bf16 v[180:183], a[76:79], a[52:55], v[180:183]
  ds_read_b64_tr_b16 a[94:95], v230 offset:61440
  v_xor_b32 v230, 0x10000, v230
  v_mfma_f32_16x16x32_bf16 v[176:179], a[76:79], a[48:51], v[176:179]
  buffer_load_dwordx4 v233, s[20:23], s67 offen offset:1024  lds
  v_mfma_f32_16x16x32_bf16 v[176:179], a[72:75], a[32:35], v[176:179]
  s_waitcnt lgkmcnt(4)
  v_mfma_f32_16x16x32_bf16 v[192:195], a[80:83], a[32:35], v[192:195]
  s_waitcnt vmcnt(14)
  s_barrier
  ds_read_b64_tr_b16 a[64:65], v224 offset:0
  v_mfma_f32_16x16x32_bf16 v[192:195], a[84:87], a[48:51], v[192:195]
  ds_read_b64_tr_b16 a[66:67], v224 offset:4096
  v_mfma_f32_16x16x32_bf16 v[196:199], a[84:87], a[52:55], v[196:199]
  v_mfma_f32_16x16x32_bf16 v[196:199], a[80:83], a[36:39], v[196:199]
  v_mfma_f32_16x16x32_bf16 v[200:203], a[80:83], a[40:43], v[200:203]
  ds_read_b64_tr_b16 a[68:69], v224 offset:8192
  v_mfma_f32_16x16x32_bf16 v[200:203], a[84:87], a[56:59], v[200:203]
  ds_read_b64_tr_b16 a[70:71], v224 offset:12288
  v_mfma_f32_16x16x32_bf16 v[204:207], a[84:87], a[60:63], v[204:207]
  buffer_load_dwordx4 v234, s[20:23], s67 offen offset:2048  lds
  v_mfma_f32_16x16x32_bf16 v[204:207], a[80:83], a[44:47], v[204:207]
  s_waitcnt lgkmcnt(4)
  v_mfma_f32_16x16x32_bf16 v[220:223], a[88:91], a[44:47], v[220:223]
  ds_read_b64_tr_b16 a[72:73], v224 offset:16384
  v_mfma_f32_16x16x32_bf16 v[220:223], a[92:95], a[60:63], v[220:223]
  ds_read_b64_tr_b16 a[74:75], v224 offset:20480
  v_mfma_f32_16x16x32_bf16 v[216:219], a[92:95], a[56:59], v[216:219]
  buffer_load_dwordx4 v235, s[20:23], s67 offen offset:3072  lds
  v_mfma_f32_16x16x32_bf16 v[216:219], a[88:91], a[40:43], v[216:219]
  s_add_u32 s67, s67, 458752
  s_xor_b32 s68, s68, 0x10000
  v_mfma_f32_16x16x32_bf16 v[212:215], a[88:91], a[36:39], v[212:215]
  ds_read_b64_tr_b16 a[76:77], v224 offset:24576
  v_mfma_f32_16x16x32_bf16 v[212:215], a[92:95], a[52:55], v[212:215]
  s_sub_u32 s56, s56, 1
  ds_read_b64_tr_b16 a[78:79], v224 offset:28672
  v_mfma_f32_16x16x32_bf16 v[208:211], a[92:95], a[48:51], v[208:211]
  s_cmp_lg_u32 s56, 0
  v_mfma_f32_16x16x32_bf16 v[208:211], a[88:91], a[32:35], v[208:211]
  s_cbranch_scc1 Lp3_loop
Lmk_Lp3_loop_tail:
  s_waitcnt vmcnt(8) lgkmcnt(4)
  v_mfma_f32_16x16x32_bf16 v[0:3], a[64:67], a[0:3], v[0:3]
  ds_read_b64_tr_b16 a[80:81], v225 offset:0
  v_add_f32 v242, v242, v246
  v_mfma_f32_16x16x32_bf16 v[0:3], a[68:71], a[16:19], v[0:3]
  ds_read_b64_tr_b16 a[82:83], v225 offset:4096
  v_add_f32 v243, v243, v247
  v_mfma_f32_16x16x32_bf16 v[4:7], a[68:71], a[20:23], v[4:7]
  buffer_load_dwordx4 a[32:35], v231, s[4:7], s72 offen offset:2048 sc1
  v_mfma_f32_16x16x32_bf16 v[4:7], a[64:67], a[4:7], v[4:7]
  v_add_f32 v244, v244, v248
  v_add_f32 v245, v245, v249
  v_mfma_f32_16x16x32_bf16 v[8:11], a[64:67], a[8:11], v[8:11]
  ds_read_b64_tr_b16 a[84:85], v225 offset:8192
  ds_write_b128 v250, v[242:245]
  v_mfma_f32_16x16x32_bf16 v[8:11], a[68:71], a[24:27], v[8:11]
  ds_read_b64_tr_b16 a[86:87], v225 offset:12288
  v_mfma_f32_16x16x32_bf16 v[12:15], a[68:71], a[28:31], v[12:15]
  buffer_load_dwordx4 a[48:51], v231, s[4:7], s72 offen offset:3072 sc1
  v_mfma_f32_16x16x32_bf16 v[12:15], a[64:67], a[12:15], v[12:15]
  s_add_u32 s72, s72, 4096
  s_waitcnt lgkmcnt(5)
  v_mfma_f32_16x16x32_bf16 v[28:31], a[72:75], a[12:15], v[28:31]
  ds_read_b64_tr_b16 a[88:89], v225 offset:16384
  v_mfma_f32_16x16x32_bf16 v[28:31], a[76:79], a[28:31], v[28:31]
  ds_read_b64_tr_b16 a[90:91], v225 offset:20480
  v_mfma_f32_16x16x32_bf16 v[24:27], a[76:79], a[24:27], v[24:27]
  buffer_load_dwordx4 a[36:39], v231, s[4:7], s73 offen offset:2048 sc1
  v_mfma_f32_16x16x32_bf16 v[24:27], a[72:75], a[8:11], v[24:27]
  ds_read_b128 v[246:249], v237 offset:384
  v_mfma_f32_16x16x32_bf16 v[20:23], a[72:75], a[4:7], v[20:23]
  ds_read_b64_tr_b16 a[92:93], v225 offset:24576
  v_mfma_f32_16x16x32_bf16 v[20:23], a[76:79], a[20:23], v[20:23]
  ds_read_b64_tr_b16 a[94:95], v225 offset:28672
  v_mfma_f32_16x16x32_bf16 v[16:19], a[76:79], a[16:19], v[16:19]
  buffer_load_dwordx4 a[52:55], v231, s[4:7], s73 offen offset:3072 sc1
  v_mfma_f32_16x16x32_bf16 v[16:19], a[72:75], a[0:3], v[16:19]
  s_add_u32 s73, s73, 4096
  s_waitcnt lgkmcnt(5)
  v_mfma_f32_16x16x32_bf16 v[32:35], a[80:83], a[0:3], v[32:35]
  s_waitcnt lgkmcnt(2)
  ds_read_b64_tr_b16 a[64:65], v226 offset:0
  v_fmac_f32 v96, v246, v238
  v_mfma_f32_16x16x32_bf16 v[32:35], a[84:87], a[16:19], v[32:35]
  ds_read_b64_tr_b16 a[66:67], v226 offset:4096
  v_fmac_f32 v97, v247, v238
  v_mfma_f32_16x16x32_bf16 v[36:39], a[84:87], a[20:23], v[36:39]
  v_fmac_f32 v98, v248, v238
  v_fmac_f32 v99, v249, v238
  v_mfma_f32_16x16x32_bf16 v[36:39], a[80:83], a[4:7], v[36:39]
  ds_read_b128 v[242:245], v237 offset:0
  v_fmac_f32 v100, v246, v239
  v_mfma_f32_16x16x32_bf16 v[40:43], a[80:83], a[8:11], v[40:43]
  s_xor_b32 s93, s53, 1
  ds_read_b64_tr_b16 a[68:69], v226 offset:8192
  v_fmac_f32 v101, v247, v239
  v_mfma_f32_16x16x32_bf16 v[40:43], a[84:87], a[24:27], v[40:43]
  s_lshl_b32 s93, s93, 7
  ds_read_b64_tr_b16 a[70:71], v226 offset:12288
  v_fmac_f32 v102, v248, v239
  v_mfma_f32_16x16x32_bf16 v[44:47], a[84:87], a[28:31], v[44:47]
  s_add_u32 s80, s24, s93
  s_addc_u32 s81, s25, 0
  buffer_load_dwordx4 a[40:43], v231, s[4:7], s74 offen offset:2048 sc1
  v_mfma_f32_16x16x32_bf16 v[44:47], a[80:83], a[12:15], v[44:47]
  s_sub_u32 s82, 7340032, s93
  v_fmac_f32 v103, v249, v239
  v_fmac_f32 v104, v246, v240
  s_waitcnt lgkmcnt(5)
  v_mfma_f32_16x16x32_bf16 v[60:63], a[88:91], a[12:15], v[60:63]
  s_mov_b32 s83, 0x20000
  ds_read_b64_tr_b16 a[72:73], v226 offset:16384
  v_fmac_f32 v105, v247, v240
  v_mfma_f32_16x16x32_bf16 v[60:63], a[92:95], a[28:31], v[60:63]
  s_lshl_b32 s93, s53, 7
  ds_read_b64_tr_b16 a[74:75], v226 offset:20480
  v_fmac_f32 v106, v248, v240
  v_mfma_f32_16x16x32_bf16 v[56:59], a[92:95], a[24:27], v[56:59]
  s_add_u32 s84, s24, s93
  s_addc_u32 s85, s25, 0
  buffer_load_dwordx4 a[56:59], v231, s[4:7], s74 offen offset:3072 sc1
  v_mfma_f32_16x16x32_bf16 v[56:59], a[88:91], a[8:11], v[56:59]
  s_add_u32 s74, s74, 4096
  v_fmac_f32 v107, v249, v240
  v_fmac_f32 v108, v246, v241
  v_mfma_f32_16x16x32_bf16 v[52:55], a[88:91], a[4:7], v[52:55]
  s_sub_u32 s84, s84, 1024
  s_subb_u32 s85, s85, 0
  ds_read_b64_tr_b16 a[76:77], v226 offset:24576
  v_fmac_f32 v109, v247, v241
  v_mfma_f32_16x16x32_bf16 v[52:55], a[92:95], a[20:23], v[52:55]
  s_sub_u32 s86, 7341056, s93
  ds_read_b64_tr_b16 a[78:79], v226 offset:28672
  v_fmac_f32 v110, v248, v241
  v_mfma_f32_16x16x32_bf16 v[48:51], a[92:95], a[16:19], v[48:51]
  s_mov_b32 s87, 0x20000
  buffer_load_dwordx4 a[44:47], v231, s[4:7], s75 offen offset:2048 sc1
  v_mfma_f32_16x16x32_bf16 v[48:51], a[88:91], a[0:3], v[48:51]
  s_and_b32 s93, s53, 1
  v_fmac_f32 v111, v249, v241
  s_waitcnt lgkmcnt(4)
  v_mfma_f32_16x16x32_bf16 v[64:67], a[64:67], a[0:3], v[64:67]
  ds_read_b64_tr_b16 a[80:81], v227 offset:0
  v_fmac_f32 v0, v242, v238
  v_mfma_f32_16x16x32_bf16 v[64:67], a[68:71], a[16:19], v[64:67]
  s_mul_i32 s92, s93, 3670016
  ds_read_b64_tr_b16 a[82:83], v227 offset:4096
  v_fmac_f32 v1, v243, v238
  v_mfma_f32_16x16x32_bf16 v[68:71], a[68:71], a[20:23], v[68:71]
  s_lshl_b32 s93, s40, 14
  buffer_load_dwordx4 a[60:63], v231, s[4:7], s75 offen offset:3072 sc1
  v_mfma_f32_16x16x32_bf16 v[68:71], a[64:67], a[4:7], v[68:71]
  s_add_u32 s75, s75, 4096
  ds_read_b128 v[246:249], v237 offset:64
  v_fmac_f32 v2, v244, v238
  v_mfma_f32_16x16x32_bf16 v[72:75], a[64:67], a[8:11], v[72:75]
  s_add_u32 s92, s92, s93
  ds_read_b64_tr_b16 a[84:85], v227 offset:8192
  v_fmac_f32 v3, v245, v238
  v_mfma_f32_16x16x32_bf16 v[72:75], a[68:71], a[24:27], v[72:75]
  s_lshl_b32 s79, s40, 11
  ds_read_b64_tr_b16 a[86:87], v227 offset:12288
  v_fmac_f32 v4, v242, v239
  v_mfma_f32_16x16x32_bf16 v[76:79], a[68:71], a[28:31], v[76:79]
  s_lshr_b32 s93, s53, 1
  v_fmac_f32 v5, v243, v239
  v_fmac_f32 v6, v244, v239
  v_mfma_f32_16x16x32_bf16 v[76:79], a[64:67], a[12:15], v[76:79]
  s_add_u32 s93, s93, s52
  v_fmac_f32 v7, v245, v239
  v_fmac_f32 v8, v242, v240
  s_waitcnt lgkmcnt(5)
  v_mfma_f32_16x16x32_bf16 v[92:95], a[72:75], a[12:15], v[92:95]
  s_and_b32 s93, s93, 1
  ds_read_b64_tr_b16 a[88:89], v227 offset:16384
  v_fmac_f32 v9, v243, v240
  v_mfma_f32_16x16x32_bf16 v[92:95], a[76:79], a[28:31], v[92:95]
  s_add_u32 m0, s68, 0
  ds_read_b64_tr_b16 a[90:91], v227 offset:20480
  v_fmac_f32 v10, v244, v240
  v_mfma_f32_16x16x32_bf16 v[88:91], a[76:79], a[24:27], v[88:91]
  s_mul_i32 s88, s93, 1835008
  buffer_load_dwordx4 v232, s[16:19], s67 offen offset:0  lds
  v_mfma_f32_16x16x32_bf16 v[88:91], a[72:75], a[8:11], v[88:91]
  s_cmp_eq_u32 s40, 1
  s_cselect_b32 s78, 16384, 0
  v_fmac_f32 v11, v245, v240
  v_fmac_f32 v12, v242, v241
  v_mfma_f32_16x16x32_bf16 v[84:87], a[72:75], a[4:7], v[84:87]
  s_cmp_eq_u32 s40, 2
  s_cselect_b32 s78, -16384, s78
  ds_read_b64_tr_b16 a[92:93], v227 offset:24576
  v_fmac_f32 v13, v243, v241
  v_mfma_f32_16x16x32_bf16 v[84:87], a[76:79], a[20:23], v[84:87]
  s_mul_i32 s43, s69, 458752
  ds_read_b64_tr_b16 a[94:95], v227 offset:28672
  v_fmac_f32 v14, v244, v241
  v_mfma_f32_16x16x32_bf16 v[80:83], a[76:79], a[16:19], v[80:83]
  s_lshr_b32 s45, s55, 4
  buffer_load_dwordx4 v233, s[16:19], s67 offen offset:1024  lds
  v_mfma_f32_16x16x32_bf16 v[80:83], a[72:75], a[0:3], v[80:83]
  s_mul_i32 s45, s45, 57344
  v_fmac_f32 v15, v245, v241
  s_waitcnt lgkmcnt(4)
  v_mfma_f32_16x16x32_bf16 v[96:99], a[80:83], a[0:3], v[96:99]
  ds_read_b64_tr_b16 a[64:65], v228 offset:0
  v_fmac_f32 v16, v246, v238
  v_mfma_f32_16x16x32_bf16 v[96:99], a[84:87], a[16:19], v[96:99]
  s_add_u32 s43, s43, s45
  ds_read_b64_tr_b16 a[66:67], v228 offset:4096
  v_fmac_f32 v17, v247, v238
  v_mfma_f32_16x16x32_bf16 v[100:103], a[84:87], a[20:23], v[100:103]
  s_add_u32 s43, s43, s42
  buffer_load_dwordx4 v234, s[16:19], s67 offen offset:2048  lds
  v_mfma_f32_16x16x32_bf16 v[100:103], a[80:83], a[4:7], v[100:103]
  s_add_u32 s43, s43, 12582912
  ds_read_b128 v[242:245], v237 offset:128
  v_fmac_f32 v18, v248, v238
  v_mfma_f32_16x16x32_bf16 v[104:107], a[80:83], a[8:11], v[104:107]
  s_and_b32 s44, s55, 15
  ds_read_b64_tr_b16 a[68:69], v228 offset:8192
  v_fmac_f32 v19, v249, v238
  v_mfma_f32_16x16x32_bf16 v[104:107], a[84:87], a[24:27], v[104:107]
  s_lshl_b32 s45, s44, 10
  ds_read_b64_tr_b16 a[70:71], v228 offset:12288
  v_fmac_f32 v20, v246, v239
  v_mfma_f32_16x16x32_bf16 v[108:111], a[84:87], a[28:31], v[108:111]
  s_add_u32 s57, s43, s45
  buffer_load_dwordx4 v235, s[16:19], s67 offen offset:3072  lds
  v_mfma_f32_16x16x32_bf16 v[108:111], a[80:83], a[12:15], v[108:111]
  s_lshl_b32 s45, s44, 9
  v_fmac_f32 v21, v247, v239
  v_fmac_f32 v22, v248, v239
  s_waitcnt lgkmcnt(5)
  v_mfma_f32_16x16x32_bf16 v[124:127], a[88:91], a[12:15], v[124:127]
  s_add_u32 s61, s43, s45
  ds_read_b64_tr_b16 a[72:73], v228 offset:16384
  v_fmac_f32 v23, v249, v239
  v_mfma_f32_16x16x32_bf16 v[124:127], a[92:95], a[28:31], v[124:127]
  s_add_u32 s57, s57, 8192
  ds_read_b64_tr_b16 a[74:75], v228 offset:20480
  v_fmac_f32 v24, v246, v240
  v_mfma_f32_16x16x32_bf16 v[120:123], a[92:95], a[24:27], v[120:123]
  s_add_u32 s62, s61, 229376
  v_fmac_f32 v25, v247, v240
  v_fmac_f32 v26, v248, v240
  v_mfma_f32_16x16x32_bf16 v[120:123], a[88:91], a[8:11], v[120:123]
  s_add_u32 s58, s57, 114688
  v_fmac_f32 v27, v249, v240
  v_fmac_f32 v28, v246, v241
  v_mfma_f32_16x16x32_bf16 v[116:119], a[88:91], a[4:7], v[116:119]
  s_add_u32 s59, s58, 114688
  ds_read_b64_tr_b16 a[76:77], v228 offset:24576
  v_fmac_f32 v29, v247, v241
  v_mfma_f32_16x16x32_bf16 v[116:119], a[92:95], a[20:23], v[116:119]
  s_add_u32 m0, s68, 16384
  ds_read_b64_tr_b16 a[78:79], v228 offset:28672
  v_fmac_f32 v30, v248, v241
  v_mfma_f32_16x16x32_bf16 v[112:115], a[92:95], a[16:19], v[112:115]
  s_add_u32 s60, s59, 114688
  buffer_load_dwordx4 v232, s[20:23], s67 offen offset:0  lds
  v_mfma_f32_16x16x32_bf16 v[112:115], a[88:91], a[0:3], v[112:115]
  s_lshl_b32 s77, s54, 1
  v_fmac_f32 v31, v249, v241
  s_waitcnt lgkmcnt(4)
  v_mfma_f32_16x16x32_bf16 v[128:131], a[64:67], a[0:3], v[128:131]
  ds_read_b64_tr_b16 a[80:81], v229 offset:0
  v_fmac_f32 v32, v242, v238
  v_mfma_f32_16x16x32_bf16 v[128:131], a[68:71], a[16:19], v[128:131]
  s_lshr_b32 s43, s55, 4
  ds_read_b64_tr_b16 a[82:83], v229 offset:4096
  v_fmac_f32 v33, v243, v238
  v_mfma_f32_16x16x32_bf16 v[132:135], a[68:71], a[20:23], v[132:135]
  s_add_u32 s77, s77, s43
  buffer_load_dwordx4 v233, s[20:23], s67 offen offset:1024  lds
  v_mfma_f32_16x16x32_bf16 v[132:135], a[64:67], a[4:7], v[132:135]
  s_lshl_b32 s77, s77, 7
  ds_read_b128 v[246:249], v237 offset:192
  v_fmac_f32 v34, v244, v238
  v_mfma_f32_16x16x32_bf16 v[136:139], a[64:67], a[8:11], v[136:139]
  s_add_u32 s77, s77, s42
  ds_read_b64_tr_b16 a[84:85], v229 offset:8192
  v_fmac_f32 v35, v245, v238
  v_mfma_f32_16x16x32_bf16 v[136:139], a[68:71], a[24:27], v[136:139]
  s_add_u32 s77, s77, 27795456
  ds_read_b64_tr_b16 a[86:87], v229 offset:12288
  v_fmac_f32 v36, v242, v239
  v_mfma_f32_16x16x32_bf16 v[140:143], a[68:71], a[28:31], v[140:143]
  s_and_b32 s43, s53, 1
  buffer_load_dwordx4 v234, s[20:23], s67 offen offset:2048  lds
  v_mfma_f32_16x16x32_bf16 v[140:143], a[64:67], a[12:15], v[140:143]
  s_and_b32 s64, s52, 14
  v_fmac_f32 v37, v243, v239
  v_fmac_f32 v38, v244, v239
  s_waitcnt lgkmcnt(5)
  v_mfma_f32_16x16x32_bf16 v[156:159], a[72:75], a[12:15], v[156:159]
  s_add_u32 s64, s64, s43
  ds_read_b64_tr_b16 a[88:89], v229 offset:16384
  v_fmac_f32 v39, v245, v239
  v_mfma_f32_16x16x32_bf16 v[156:159], a[76:79], a[28:31], v[156:159]
  s_lshl_b32 s64, s64, 7
  ds_read_b64_tr_b16 a[90:91], v229 offset:20480
  v_fmac_f32 v40, v242, v240
  v_mfma_f32_16x16x32_bf16 v[152:155], a[76:79], a[24:27], v[152:155]
  s_add_u32 s64, s64, s42
  buffer_load_dwordx4 v235, s[20:23], s67 offen offset:3072  lds
  v_mfma_f32_16x16x32_bf16 v[152:155], a[72:75], a[8:11], v[152:155]
  s_add_u32 s67, s67, 458752
  v_fmac_f32 v41, v243, v240
  v_fmac_f32 v42, v244, v240
  v_mfma_f32_16x16x32_bf16 v[148:151], a[72:75], a[4:7], v[148:151]
  s_add_u32 s64, s64, 27795456
  ds_read_b64_tr_b16 a[92:93], v229 offset:24576
  v_fmac_f32 v43, v245, v240
  v_mfma_f32_16x16x32_bf16 v[148:151], a[76:79], a[20:23], v[148:151]
  s_lshl_b32 s49, s52, 3
  ds_read_b64_tr_b16 a[94:95], v229 offset:28672
  v_fmac_f32 v44, v242, v241
  v_mfma_f32_16x16x32_bf16 v[144:147], a[76:79], a[16:19], v[144:147]
  s_lshl_b32 s43, s40, 1
  v_fmac_f32 v45, v243, v241
  v_fmac_f32 v46, v244, v241
  v_mfma_f32_16x16x32_bf16 v[144:147], a[72:75], a[0:3], v[144:147]
  s_add_u32 s49, s49, s43
  v_fmac_f32 v47, v245, v241
  s_waitcnt lgkmcnt(4)
  v_mfma_f32_16x16x32_bf16 v[160:163], a[80:83], a[0:3], v[160:163]
  ds_read_b64_tr_b16 a[64:65], v230 offset:0
  v_fmac_f32 v48, v246, v238
  v_mfma_f32_16x16x32_bf16 v[160:163], a[84:87], a[16:19], v[160:163]
  s_lshl_b32 s76, s49, 15
  ds_read_b64_tr_b16 a[66:67], v230 offset:4096
  v_fmac_f32 v49, v247, v238
  v_mfma_f32_16x16x32_bf16 v[164:167], a[84:87], a[20:23], v[164:167]
  s_lshl_b32 s43, s53, 11
  buffer_load_dwordx4 a[96:99], v231, s[4:7], s72 offen offset:0 sc1
  v_mfma_f32_16x16x32_bf16 v[164:167], a[80:83], a[4:7], v[164:167]
  s_add_u32 s76, s76, s43
  ds_read_b128 v[242:245], v237 offset:256
  v_fmac_f32 v50, v248, v238
  v_mfma_f32_16x16x32_bf16 v[168:171], a[80:83], a[8:11], v[168:171]
  s_add_u32 s76, s76, s42
  ds_read_b64_tr_b16 a[68:69], v230 offset:8192
  v_fmac_f32 v51, v249, v238
  v_mfma_f32_16x16x32_bf16 v[168:171], a[84:87], a[24:27], v[168:171]
  s_add_u32 s46, s76, 4194304
  ds_read_b64_tr_b16 a[70:71], v230 offset:12288
  v_fmac_f32 v52, v246, v239
  v_mfma_f32_16x16x32_bf16 v[172:175], a[84:87], a[28:31], v[172:175]
  s_add_u32 s47, s46, 32768
  buffer_load_dwordx4 a[112:115], v231, s[4:7], s72 offen offset:1024 sc1
  v_mfma_f32_16x16x32_bf16 v[172:175], a[80:83], a[12:15], v[172:175]
  s_mul_i32 s48, s49, 114688
  v_fmac_f32 v53, v247, v239
  v_fmac_f32 v54, v248, v239
  s_waitcnt lgkmcnt(5)
  v_mfma_f32_16x16x32_bf16 v[188:191], a[88:91], a[12:15], v[188:191]
  s_and_b32 s43, s53, 1
  ds_read_b64_tr_b16 a[72:73], v230 offset:16384
  v_fmac_f32 v55, v249, v239
  v_mfma_f32_16x16x32_bf16 v[188:191], a[92:95], a[28:31], v[188:191]
  s_mul_i32 s44, s43, 57344
  ds_read_b64_tr_b16 a[74:75], v230 offset:20480
  v_fmac_f32 v56, v246, v240
  v_mfma_f32_16x16x32_bf16 v[184:187], a[92:95], a[24:27], v[184:187]
  s_add_u32 s48, s48, s44
  buffer_load_dwordx4 a[100:103], v231, s[4:7], s73 offen offset:0 sc1
  v_mfma_f32_16x16x32_bf16 v[184:187], a[88:91], a[8:11], v[184:187]
  s_add_u32 s48, s48, s42
  v_fmac_f32 v57, v247, v240
  v_fmac_f32 v58, v248, v240
  v_mfma_f32_16x16x32_bf16 v[180:183], a[88:91], a[4:7], v[180:183]
  s_add_u32 s48, s48, 12582912
  ds_read_b64_tr_b16 a[76:77], v230 offset:24576
  v_fmac_f32 v59, v249, v240
  v_mfma_f32_16x16x32_bf16 v[180:183], a[92:95], a[20:23], v[180:183]
  ds_read_b64_tr_b16 a[78:79], v230 offset:28672
  v_fmac_f32 v60, v246, v241
  v_mfma_f32_16x16x32_bf16 v[176:179], a[92:95], a[16:19], v[176:179]
  buffer_load_dwordx4 a[116:119], v231, s[4:7], s73 offen offset:1024 sc1
  v_mfma_f32_16x16x32_bf16 v[176:179], a[88:91], a[0:3], v[176:179]
  s_waitcnt lgkmcnt(4)
  v_fmac_f32 v61, v247, v241
  v_fmac_f32 v62, v248, v241
  v_fmac_f32 v63, v249, v241
  v_mfma_f32_16x16x32_bf16 v[192:195], a[64:67], a[0:3], v[192:195]
  s_waitcnt vmcnt(20)
  s_barrier
  ds_read_b64_tr_b16 a[80:81], v224 offset:32768
  v_mfma_f32_16x16x32_bf16 v[192:195], a[68:71], a[16:19], v[192:195]
  ds_read_b64_tr_b16 a[82:83], v224 offset:36864
  v_fmac_f32 v64, v242, v238
  v_mfma_f32_16x16x32_bf16 v[196:199], a[68:71], a[20:23], v[196:199]
  v_fmac_f32 v65, v243, v238
  v_fmac_f32 v66, v244, v238
  v_mfma_f32_16x16x32_bf16 v[196:199], a[64:67], a[4:7], v[196:199]
  ds_read_b128 v[246:249], v237 offset:320
  v_fmac_f32 v67, v245, v238
  v_mfma_f32_16x16x32_bf16 v[200:203], a[64:67], a[8:11], v[200:203]
  ds_read_b64_tr_b16 a[84:85], v224 offset:40960
  v_fmac_f32 v68, v242, v239
  v_mfma_f32_16x16x32_bf16 v[200:203], a[68:71], a[24:27], v[200:203]
  ds_read_b64_tr_b16 a[86:87], v224 offset:45056
  v_fmac_f32 v69, v243, v239
  v_mfma_f32_16x16x32_bf16 v[204:207], a[68:71], a[28:31], v[204:207]
  buffer_load_dwordx4 a[104:107], v231, s[4:7], s74 offen offset:0 sc1
  v_mfma_f32_16x16x32_bf16 v[204:207], a[64:67], a[12:15], v[204:207]
  s_waitcnt lgkmcnt(5)
  v_fmac_f32 v70, v244, v239
  v_fmac_f32 v71, v245, v239
  v_mfma_f32_16x16x32_bf16 v[220:223], a[72:75], a[12:15], v[220:223]
  ds_read_b64_tr_b16 a[88:89], v224 offset:49152
  v_fmac_f32 v72, v242, v240
  v_mfma_f32_16x16x32_bf16 v[220:223], a[76:79], a[28:31], v[220:223]
  ds_read_b64_tr_b16 a[90:91], v224 offset:53248
  v_fmac_f32 v73, v243, v240
  v_mfma_f32_16x16x32_bf16 v[216:219], a[76:79], a[24:27], v[216:219]
  buffer_load_dwordx4 a[120:123], v231, s[4:7], s74 offen offset:1024 sc1
  v_mfma_f32_16x16x32_bf16 v[216:219], a[72:75], a[8:11], v[216:219]
  v_fmac_f32 v74, v244, v240
  v_fmac_f32 v75, v245, v240
  v_mfma_f32_16x16x32_bf16 v[212:215], a[72:75], a[4:7], v[212:215]
  ds_read_b64_tr_b16 a[92:93], v224 offset:57344
  v_fmac_f32 v76, v242, v241
  v_mfma_f32_16x16x32_bf16 v[212:215], a[76:79], a[20:23], v[212:215]
  ds_read_b64_tr_b16 a[94:95], v224 offset:61440
  v_xor_b32 v224, 0x10000, v224
  v_fmac_f32 v77, v243, v241
  v_mfma_f32_16x16x32_bf16 v[208:211], a[76:79], a[16:19], v[208:211]
  buffer_load_dwordx4 a[108:111], v231, s[4:7], s75 offen offset:0 sc1
  v_mfma_f32_16x16x32_bf16 v[208:211], a[72:75], a[0:3], v[208:211]
  s_waitcnt vmcnt(21) lgkmcnt(4)
  v_fmac_f32 v78, v244, v241
  v_fmac_f32 v79, v245, v241
  v_mfma_f32_16x16x32_bf16 v[0:3], a[80:83], a[32:35], v[0:3]
  ds_read_b64_tr_b16 a[64:65], v225 offset:32768
  v_fmac_f32 v80, v246, v238
  v_mfma_f32_16x16x32_bf16 v[0:3], a[84:87], a[48:51], v[0:3]
  s_waitcnt vmcnt(19)
  ds_read_b64_tr_b16 a[66:67], v225 offset:36864
  v_fmac_f32 v81, v247, v238
  v_mfma_f32_16x16x32_bf16 v[4:7], a[84:87], a[52:55], v[4:7]
  buffer_load_dwordx4 a[124:127], v231, s[4:7], s75 offen offset:1024 sc1
  v_mfma_f32_16x16x32_bf16 v[4:7], a[80:83], a[36:39], v[4:7]
  s_waitcnt vmcnt(18)
  ds_read_b128 v[242:245], v237 offset:448
  v_fmac_f32 v82, v248, v238
  v_mfma_f32_16x16x32_bf16 v[8:11], a[80:83], a[40:43], v[8:11]
  ds_read_b64_tr_b16 a[68:69], v225 offset:40960
  v_fmac_f32 v83, v249, v238
  v_mfma_f32_16x16x32_bf16 v[8:11], a[84:87], a[56:59], v[8:11]
  s_waitcnt vmcnt(16)
  ds_read_b64_tr_b16 a[70:71], v225 offset:45056
  v_fmac_f32 v84, v246, v239
  v_mfma_f32_16x16x32_bf16 v[12:15], a[84:87], a[60:63], v[12:15]
  v_fmac_f32 v85, v247, v239
  v_fmac_f32 v86, v248, v239
  v_mfma_f32_16x16x32_bf16 v[12:15], a[80:83], a[44:47], v[12:15]
  s_waitcnt lgkmcnt(5)
  v_fmac_f32 v87, v249, v239
  v_fmac_f32 v88, v246, v240
  v_mfma_f32_16x16x32_bf16 v[28:31], a[88:91], a[44:47], v[28:31]
  ds_read_b64_tr_b16 a[72:73], v225 offset:49152
  v_fmac_f32 v89, v247, v240
  v_mfma_f32_16x16x32_bf16 v[28:31], a[92:95], a[60:63], v[28:31]
  s_add_u32 m0, s68, 32768
  ds_read_b64_tr_b16 a[74:75], v225 offset:53248
  v_fmac_f32 v90, v248, v240
  v_mfma_f32_16x16x32_bf16 v[24:27], a[92:95], a[56:59], v[24:27]
  buffer_load_dwordx4 v232, s[16:19], s67 offen offset:0  lds
  v_mfma_f32_16x16x32_bf16 v[24:27], a[88:91], a[40:43], v[24:27]
  v_fmac_f32 v91, v249, v240
  v_fmac_f32 v92, v246, v241
  v_mfma_f32_16x16x32_bf16 v[20:23], a[88:91], a[36:39], v[20:23]
  ds_read_b64_tr_b16 a[76:77], v225 offset:57344
  v_fmac_f32 v93, v247, v241
  v_mfma_f32_16x16x32_bf16 v[20:23], a[92:95], a[52:55], v[20:23]
  ds_read_b64_tr_b16 a[78:79], v225 offset:61440
  v_xor_b32 v225, 0x10000, v225
  v_fmac_f32 v94, v248, v241
  v_mfma_f32_16x16x32_bf16 v[16:19], a[92:95], a[48:51], v[16:19]
  buffer_load_dwordx4 v233, s[16:19], s67 offen offset:1024  lds
  v_mfma_f32_16x16x32_bf16 v[16:19], a[88:91], a[32:35], v[16:19]
  v_fmac_f32 v95, v249, v241
  s_waitcnt lgkmcnt(4)
  v_mfma_f32_16x16x32_bf16 v[32:35], a[64:67], a[32:35], v[32:35]
  ds_read_b64_tr_b16 a[80:81], v226 offset:32768
  v_fmac_f32 v112, v242, v238
  v_mfma_f32_16x16x32_bf16 v[32:35], a[68:71], a[48:51], v[32:35]
  ds_read_b64_tr_b16 a[82:83], v226 offset:36864
  v_fmac_f32 v113, v243, v238
  v_mfma_f32_16x16x32_bf16 v[36:39], a[68:71], a[52:55], v[36:39]
  buffer_load_dwordx4 v234, s[16:19], s67 offen offset:2048  lds
  v_mfma_f32_16x16x32_bf16 v[36:39], a[64:67], a[36:39], v[36:39]
  ds_read_b128 v[246:249], v237 offset:512
  v_fmac_f32 v114, v244, v238
  v_mfma_f32_16x16x32_bf16 v[40:43], a[64:67], a[40:43], v[40:43]
  ds_read_b64_tr_b16 a[84:85], v226 offset:40960
  v_fmac_f32 v115, v245, v238
  v_mfma_f32_16x16x32_bf16 v[40:43], a[68:71], a[56:59], v[40:43]
  ds_read_b64_tr_b16 a[86:87], v226 offset:45056
  v_fmac_f32 v116, v242, v239
  v_mfma_f32_16x16x32_bf16 v[44:47], a[68:71], a[60:63], v[44:47]
  buffer_load_dwordx4 v235, s[16:19], s67 offen offset:3072  lds
  v_mfma_f32_16x16x32_bf16 v[44:47], a[64:67], a[44:47], v[44:47]
  s_waitcnt lgkmcnt(5)
  v_fmac_f32 v117, v243, v239
  v_fmac_f32 v118, v244, v239
  v_mfma_f32_16x16x32_bf16 v[60:63], a[72:75], a[44:47], v[60:63]
  ds_read_b64_tr_b16 a[88:89], v226 offset:49152
  v_fmac_f32 v119, v245, v239
  v_mfma_f32_16x16x32_bf16 v[60:63], a[76:79], a[60:63], v[60:63]
  ds_read_b64_tr_b16 a[90:91], v226 offset:53248
  v_fmac_f32 v120, v242, v240
  v_mfma_f32_16x16x32_bf16 v[56:59], a[76:79], a[56:59], v[56:59]
  v_fmac_f32 v121, v243, v240
  v_fmac_f32 v122, v244, v240
  v_mfma_f32_16x16x32_bf16 v[56:59], a[72:75], a[40:43], v[56:59]
  v_fmac_f32 v123, v245, v240
  v_fmac_f32 v124, v242, v241
  v_mfma_f32_16x16x32_bf16 v[52:55], a[72:75], a[36:39], v[52:55]
  ds_read_b64_tr_b16 a[92:93], v226 offset:57344
  v_fmac_f32 v125, v243, v241
  v_mfma_f32_16x16x32_bf16 v[52:55], a[76:79], a[52:55], v[52:55]
  s_add_u32 m0, s68, 49152
  ds_read_b64_tr_b16 a[94:95], v226 offset:61440
  v_xor_b32 v226, 0x10000, v226
  v_fmac_f32 v126, v244, v241
  v_mfma_f32_16x16x32_bf16 v[48:51], a[76:79], a[48:51], v[48:51]
  buffer_load_dwordx4 v232, s[20:23], s67 offen offset:0  lds
  v_mfma_f32_16x16x32_bf16 v[48:51], a[72:75], a[32:35], v[48:51]
  v_fmac_f32 v127, v245, v241
  s_waitcnt lgkmcnt(4)
  v_mfma_f32_16x16x32_bf16 v[64:67], a[80:83], a[32:35], v[64:67]
  ds_read_b64_tr_b16 a[64:65], v227 offset:32768
  v_fmac_f32 v128, v246, v238
  v_mfma_f32_16x16x32_bf16 v[64:67], a[84:87], a[48:51], v[64:67]
  ds_read_b64_tr_b16 a[66:67], v227 offset:36864
  v_fmac_f32 v129, v247, v238
  v_mfma_f32_16x16x32_bf16 v[68:71], a[84:87], a[52:55], v[68:71]
  buffer_load_dwordx4 v233, s[20:23], s67 offen offset:1024  lds
  v_mfma_f32_16x16x32_bf16 v[68:71], a[80:83], a[36:39], v[68:71]
  ds_read_b128 v[242:245], v237 offset:576
  v_fmac_f32 v130, v248, v238
  v_mfma_f32_16x16x32_bf16 v[72:75], a[80:83], a[40:43], v[72:75]
  ds_read_b64_tr_b16 a[68:69], v227 offset:40960
  v_fmac_f32 v131, v249, v238
  v_mfma_f32_16x16x32_bf16 v[72:75], a[84:87], a[56:59], v[72:75]
  ds_read_b64_tr_b16 a[70:71], v227 offset:45056
  v_fmac_f32 v132, v246, v239
  v_mfma_f32_16x16x32_bf16 v[76:79], a[84:87], a[60:63], v[76:79]
  buffer_load_dwordx4 v234, s[20:23], s67 offen offset:2048  lds
  v_mfma_f32_16x16x32_bf16 v[76:79], a[80:83], a[44:47], v[76:79]
  s_waitcnt lgkmcnt(5)
  v_fmac_f32 v133, v247, v239
  v_fmac_f32 v134, v248, v239
  v_mfma_f32_16x16x32_bf16 v[92:95], a[88:91], a[44:47], v[92:95]
  ds_read_b64_tr_b16 a[72:73], v227 offset:49152
  v_fmac_f32 v135, v249, v239
  v_mfma_f32_16x16x32_bf16 v[92:95], a[92:95], a[60:63], v[92:95]
  ds_read_b64_tr_b16 a[74:75], v227 offset:53248
  v_fmac_f32 v136, v246, v240
  v_mfma_f32_16x16x32_bf16 v[88:91], a[92:95], a[56:59], v[88:91]
  buffer_load_dwordx4 v235, s[20:23], s67 offen offset:3072  lds
  v_mfma_f32_16x16x32_bf16 v[88:91], a[88:91], a[40:43], v[88:91]
  s_add_u32 s67, s67, 458752
  s_xor_b32 s68, s68, 0x10000
  v_fmac_f32 v137, v247, v240
  v_mfma_f32_16x16x32_bf16 v[84:87], a[88:91], a[36:39], v[84:87]
  ds_read_b64_tr_b16 a[76:77], v227 offset:57344
  v_fmac_f32 v138, v248, v240
  v_mfma_f32_16x16x32_bf16 v[84:87], a[92:95], a[52:55], v[84:87]
  ds_read_b64_tr_b16 a[78:79], v227 offset:61440
  v_xor_b32 v227, 0x10000, v227
  v_fmac_f32 v139, v249, v240
  v_mfma_f32_16x16x32_bf16 v[80:83], a[92:95], a[48:51], v[80:83]
  v_fmac_f32 v140, v246, v241
  v_fmac_f32 v141, v247, v241
  v_mfma_f32_16x16x32_bf16 v[80:83], a[88:91], a[32:35], v[80:83]
  s_waitcnt lgkmcnt(4)
  v_fmac_f32 v142, v248, v241
  v_fmac_f32 v143, v249, v241
  v_mfma_f32_16x16x32_bf16 v[96:99], a[64:67], a[32:35], v[96:99]
  s_waitcnt vmcnt(16)
  s_barrier
  ds_read_b64_tr_b16 a[80:81], v224 offset:0
  v_mfma_f32_16x16x32_bf16 v[96:99], a[68:71], a[48:51], v[96:99]
  ds_read_b64_tr_b16 a[82:83], v224 offset:4096
  v_fmac_f32 v144, v242, v238
  v_mfma_f32_16x16x32_bf16 v[100:103], a[68:71], a[52:55], v[100:103]
  buffer_load_dwordx4 a[0:3], v231, s[4:7], s72 offen offset:2048 sc1
  v_mfma_f32_16x16x32_bf16 v[100:103], a[64:67], a[36:39], v[100:103]
  ds_read_b128 v[246:249], v237 offset:640
  v_fmac_f32 v145, v243, v238
  v_mfma_f32_16x16x32_bf16 v[104:107], a[64:67], a[40:43], v[104:107]
  ds_read_b64_tr_b16 a[84:85], v224 offset:8192
  v_fmac_f32 v146, v244, v238
  v_mfma_f32_16x16x32_bf16 v[104:107], a[68:71], a[56:59], v[104:107]
  ds_read_b64_tr_b16 a[86:87], v224 offset:12288
  v_fmac_f32 v147, v245, v238
  v_mfma_f32_16x16x32_bf16 v[108:111], a[68:71], a[60:63], v[108:111]
  buffer_load_dwordx4 a[16:19], v231, s[4:7], s72 offen offset:3072 sc1
  v_mfma_f32_16x16x32_bf16 v[108:111], a[64:67], a[44:47], v[108:111]
  s_add_u32 s72, s72, 4096
  v_fmac_f32 v148, v242, v239
  v_fmac_f32 v149, v243, v239
  s_waitcnt lgkmcnt(5)
  v_mfma_f32_16x16x32_bf16 v[124:127], a[72:75], a[44:47], v[124:127]
  ds_read_b64_tr_b16 a[88:89], v224 offset:16384
  v_fmac_f32 v150, v244, v239
  v_mfma_f32_16x16x32_bf16 v[124:127], a[76:79], a[60:63], v[124:127]
  ds_read_b64_tr_b16 a[90:91], v224 offset:20480
  v_fmac_f32 v151, v245, v239
  v_mfma_f32_16x16x32_bf16 v[120:123], a[76:79], a[56:59], v[120:123]
  buffer_load_dwordx4 a[4:7], v231, s[4:7], s73 offen offset:2048 sc1
  v_mfma_f32_16x16x32_bf16 v[120:123], a[72:75], a[40:43], v[120:123]
  v_fmac_f32 v152, v242, v240
  v_fmac_f32 v153, v243, v240
  v_mfma_f32_16x16x32_bf16 v[116:119], a[72:75], a[36:39], v[116:119]
  ds_read_b64_tr_b16 a[92:93], v224 offset:24576
  v_fmac_f32 v154, v244, v240
  v_mfma_f32_16x16x32_bf16 v[116:119], a[76:79], a[52:55], v[116:119]
  ds_read_b64_tr_b16 a[94:95], v224 offset:28672
  v_fmac_f32 v155, v245, v240
  v_mfma_f32_16x16x32_bf16 v[112:115], a[76:79], a[48:51], v[112:115]
  buffer_load_dwordx4 a[20:23], v231, s[4:7], s73 offen offset:3072 sc1
  v_mfma_f32_16x16x32_bf16 v[112:115], a[72:75], a[32:35], v[112:115]
  s_add_u32 s73, s73, 4096
  v_fmac_f32 v156, v242, v241
  v_fmac_f32 v157, v243, v241
  v_fmac_f32 v158, v244, v241
  v_fmac_f32 v159, v245, v241
  s_waitcnt vmcnt(18) lgkmcnt(4)
  v_mfma_f32_16x16x32_bf16 v[0:3], a[80:83], a[96:99], v[0:3]
  ds_read_b64_tr_b16 a[64:65], v225 offset:0
  v_fmac_f32 v160, v246, v238
  v_mfma_f32_16x16x32_bf16 v[0:3], a[84:87], a[112:115], v[0:3]
  s_waitcnt vmcnt(16)
  ds_read_b64_tr_b16 a[66:67], v225 offset:4096
  v_fmac_f32 v161, v247, v238
  v_mfma_f32_16x16x32_bf16 v[4:7], a[84:87], a[116:119], v[4:7]
  v_fmac_f32 v162, v248, v238
  v_fmac_f32 v163, v249, v238
  v_mfma_f32_16x16x32_bf16 v[4:7], a[80:83], a[100:103], v[4:7]
  s_waitcnt vmcnt(14)
  ds_read_b128 v[242:245], v237 offset:704
  v_fmac_f32 v164, v246, v239
  v_mfma_f32_16x16x32_bf16 v[8:11], a[80:83], a[104:107], v[8:11]
  ds_read_b64_tr_b16 a[68:69], v225 offset:8192
  v_fmac_f32 v165, v247, v239
  v_mfma_f32_16x16x32_bf16 v[8:11], a[84:87], a[120:123], v[8:11]
  s_waitcnt vmcnt(12)
  ds_read_b64_tr_b16 a[70:71], v225 offset:12288
  v_fmac_f32 v166, v248, v239
  v_mfma_f32_16x16x32_bf16 v[12:15], a[84:87], a[124:127], v[12:15]
  buffer_load_dwordx4 a[8:11], v231, s[4:7], s74 offen offset:2048 sc1
  v_mfma_f32_16x16x32_bf16 v[12:15], a[80:83], a[108:111], v[12:15]
  s_waitcnt lgkmcnt(5)
  v_fmac_f32 v167, v249, v239
  v_fmac_f32 v168, v246, v240
  v_mfma_f32_16x16x32_bf16 v[28:31], a[88:91], a[108:111], v[28:31]
  ds_read_b64_tr_b16 a[72:73], v225 offset:16384
  v_fmac_f32 v169, v247, v240
  v_mfma_f32_16x16x32_bf16 v[28:31], a[92:95], a[124:127], v[28:31]
  ds_read_b64_tr_b16 a[74:75], v225 offset:20480
  v_fmac_f32 v170, v248, v240
  v_mfma_f32_16x16x32_bf16 v[24:27], a[92:95], a[120:123], v[24:27]
  buffer_load_dwordx4 a[24:27], v231, s[4:7], s74 offen offset:3072 sc1
  v_mfma_f32_16x16x32_bf16 v[24:27], a[88:91], a[104:107], v[24:27]
  s_add_u32 s74, s74, 4096
  v_fmac_f32 v171, v249, v240
  v_fmac_f32 v172, v246, v241
  v_mfma_f32_16x16x32_bf16 v[20:23], a[88:91], a[100:103], v[20:23]
  ds_read_b64_tr_b16 a[76:77], v225 offset:24576
  v_fmac_f32 v173, v247, v241
  v_mfma_f32_16x16x32_bf16 v[20:23], a[92:95], a[116:119], v[20:23]
  ds_read_b64_tr_b16 a[78:79], v225 offset:28672
  v_fmac_f32 v174, v248, v241
  v_mfma_f32_16x16x32_bf16 v[16:19], a[92:95], a[112:115], v[16:19]
  buffer_load_dwordx4 a[12:15], v231, s[4:7], s75 offen offset:2048 sc1
  v_mfma_f32_16x16x32_bf16 v[16:19], a[88:91], a[96:99], v[16:19]
  v_fmac_f32 v175, v249, v241
  s_waitcnt lgkmcnt(4)
  v_mfma_f32_16x16x32_bf16 v[32:35], a[64:67], a[96:99], v[32:35]
  ds_read_b64_tr_b16 a[80:81], v226 offset:0
  v_fmac_f32 v176, v242, v238
  v_mfma_f32_16x16x32_bf16 v[32:35], a[68:71], a[112:115], v[32:35]
  ds_read_b64_tr_b16 a[82:83], v226 offset:4096
  v_fmac_f32 v177, v243, v238
  v_mfma_f32_16x16x32_bf16 v[36:39], a[68:71], a[116:119], v[36:39]
  buffer_load_dwordx4 a[28:31], v231, s[4:7], s75 offen offset:3072 sc1
  v_mfma_f32_16x16x32_bf16 v[36:39], a[64:67], a[100:103], v[36:39]
  s_add_u32 s75, s75, 4096
  ds_read_b128 v[246:249], v237 offset:768
  v_fmac_f32 v178, v244, v238
  v_mfma_f32_16x16x32_bf16 v[40:43], a[64:67], a[104:107], v[40:43]
  ds_read_b64_tr_b16 a[84:85], v226 offset:8192
  v_fmac_f32 v179, v245, v238
  v_mfma_f32_16x16x32_bf16 v[40:43], a[68:71], a[120:123], v[40:43]
  ds_read_b64_tr_b16 a[86:87], v226 offset:12288
  v_fmac_f32 v180, v242, v239
  v_mfma_f32_16x16x32_bf16 v[44:47], a[68:71], a[124:127], v[44:47]
  v_fmac_f32 v181, v243, v239
  v_fmac_f32 v182, v244, v239
  v_mfma_f32_16x16x32_bf16 v[44:47], a[64:67], a[108:111], v[44:47]
  s_waitcnt lgkmcnt(5)
  v_fmac_f32 v183, v245, v239
  v_fmac_f32 v184, v242, v240
  v_mfma_f32_16x16x32_bf16 v[60:63], a[72:75], a[108:111], v[60:63]
  ds_read_b64_tr_b16 a[88:89], v226 offset:16384
  v_fmac_f32 v185, v243, v240
  v_mfma_f32_16x16x32_bf16 v[60:63], a[76:79], a[124:127], v[60:63]
  ds_read_b64_tr_b16 a[90:91], v226 offset:20480
  v_fmac_f32 v186, v244, v240
  v_mfma_f32_16x16x32_bf16 v[56:59], a[76:79], a[120:123], v[56:59]
  v_fmac_f32 v187, v245, v240
  v_fmac_f32 v188, v242, v241
  v_mfma_f32_16x16x32_bf16 v[56:59], a[72:75], a[104:107], v[56:59]
  v_fmac_f32 v189, v243, v241
  v_fmac_f32 v190, v244, v241
  v_mfma_f32_16x16x32_bf16 v[52:55], a[72:75], a[100:103], v[52:55]
  s_add_u32 m0, s79, 0
  ds_read_b64_tr_b16 a[92:93], v226 offset:24576
  v_fmac_f32 v191, v245, v241
  v_mfma_f32_16x16x32_bf16 v[52:55], a[76:79], a[116:119], v[52:55]
  s_add_u32 s92, s92, 196608
  s_add_u32 s92, s92, s78
  s_add_u32 s93, s92, s88
  v_mfma_f32_16x16x32_bf16 v[48:51], a[76:79], a[112:115], v[48:51]
  ds_read_b64_tr_b16 a[94:95], v226 offset:28672
  v_mfma_f32_16x16x32_bf16 v[48:51], a[72:75], a[96:99], v[48:51]
  s_waitcnt lgkmcnt(4)
  buffer_load_dwordx4 v252, s[80:83], s93 offen lds
  v_mfma_f32_16x16x32_bf16 v[64:67], a[80:83], a[96:99], v[64:67]
  ds_read_b64_tr_b16 a[64:65], v228 offset:32768
  v_fmac_f32 v192, v246, v238
  v_mfma_f32_16x16x32_bf16 v[64:67], a[84:87], a[112:115], v[64:67]
  ds_read_b64_tr_b16 a[66:67], v228 offset:36864
  v_fmac_f32 v193, v247, v238
  v_mfma_f32_16x16x32_bf16 v[68:71], a[84:87], a[116:119], v[68:71]
  buffer_load_dwordx4 v252, s[84:87], s93 offen offset:1024 lds
  v_mfma_f32_16x16x32_bf16 v[68:71], a[80:83], a[100:103], v[68:71]
  ds_read_b128 v[242:245], v237 offset:832
  v_fmac_f32 v194, v248, v238
  v_mfma_f32_16x16x32_bf16 v[72:75], a[80:83], a[104:107], v[72:75]
  ds_read_b64_tr_b16 a[68:69], v228 offset:40960
  v_fmac_f32 v195, v249, v238
  v_mfma_f32_16x16x32_bf16 v[72:75], a[84:87], a[120:123], v[72:75]
  ds_read_b64_tr_b16 a[70:71], v228 offset:45056
  v_fmac_f32 v196, v246, v239
  v_mfma_f32_16x16x32_bf16 v[76:79], a[84:87], a[124:127], v[76:79]
  v_fmac_f32 v197, v247, v239
  v_fmac_f32 v198, v248, v239
  v_mfma_f32_16x16x32_bf16 v[76:79], a[80:83], a[108:111], v[76:79]
  s_waitcnt lgkmcnt(5)
  v_fmac_f32 v199, v249, v239
  v_fmac_f32 v200, v246, v240
  v_mfma_f32_16x16x32_bf16 v[92:95], a[88:91], a[108:111], v[92:95]
  s_add_u32 m0, s79, 8192
  ds_read_b64_tr_b16 a[72:73], v228 offset:49152
  v_fmac_f32 v201, v247, v240
  v_mfma_f32_16x16x32_bf16 v[92:95], a[92:95], a[124:127], v[92:95]
  s_add_u32 s92, s92, 458752
  s_add_u32 s93, s92, s88
  ds_read_b64_tr_b16 a[74:75], v228 offset:53248
  v_fmac_f32 v202, v248, v240
  v_mfma_f32_16x16x32_bf16 v[88:91], a[92:95], a[120:123], v[88:91]
  buffer_load_dwordx4 v252, s[80:83], s93 offen lds
  v_mfma_f32_16x16x32_bf16 v[88:91], a[88:91], a[104:107], v[88:91]
  v_fmac_f32 v203, v249, v240
  v_fmac_f32 v204, v246, v241
  v_mfma_f32_16x16x32_bf16 v[84:87], a[88:91], a[100:103], v[84:87]
  ds_read_b64_tr_b16 a[76:77], v228 offset:57344
  v_fmac_f32 v205, v247, v241
  v_mfma_f32_16x16x32_bf16 v[84:87], a[92:95], a[116:119], v[84:87]
  ds_read_b64_tr_b16 a[78:79], v228 offset:61440
  v_xor_b32 v228, 0x10000, v228
  v_fmac_f32 v206, v248, v241
  v_mfma_f32_16x16x32_bf16 v[80:83], a[92:95], a[112:115], v[80:83]
  buffer_load_dwordx4 v252, s[84:87], s93 offen offset:1024 lds
  v_mfma_f32_16x16x32_bf16 v[80:83], a[88:91], a[96:99], v[80:83]
  v_fmac_f32 v207, v249, v241
  s_waitcnt lgkmcnt(4)
  v_mfma_f32_16x16x32_bf16 v[128:131], a[64:67], a[32:35], v[128:131]
  s_waitcnt vmcnt(12)
  s_barrier
  ds_read_b64_tr_b16 a[80:81], v224 offset:32768
  v_mfma_f32_16x16x32_bf16 v[128:131], a[68:71], a[48:51], v[128:131]
  ds_read_b64_tr_b16 a[82:83], v224 offset:36864
  v_fmac_f32 v208, v242, v238
  v_mfma_f32_16x16x32_bf16 v[132:135], a[68:71], a[52:55], v[132:135]
  v_fmac_f32 v209, v243, v238
  v_fmac_f32 v210, v244, v238
  v_mfma_f32_16x16x32_bf16 v[132:135], a[64:67], a[36:39], v[132:135]
  v_fmac_f32 v211, v245, v238
  v_fmac_f32 v212, v242, v239
  v_mfma_f32_16x16x32_bf16 v[136:139], a[64:67], a[40:43], v[136:139]
  s_add_u32 m0, s79, 16384
  ds_read_b64_tr_b16 a[84:85], v224 offset:40960
  v_fmac_f32 v213, v243, v239
  v_mfma_f32_16x16x32_bf16 v[136:139], a[68:71], a[56:59], v[136:139]
  s_add_u32 s92, s92, 458752
  s_add_u32 s93, s92, s88
  ds_read_b64_tr_b16 a[86:87], v224 offset:45056
  v_fmac_f32 v214, v244, v239
  v_mfma_f32_16x16x32_bf16 v[140:143], a[68:71], a[60:63], v[140:143]
  buffer_load_dwordx4 v252, s[80:83], s93 offen lds
  v_mfma_f32_16x16x32_bf16 v[140:143], a[64:67], a[44:47], v[140:143]
  s_waitcnt lgkmcnt(4)
  v_fmac_f32 v215, v245, v239
  v_fmac_f32 v216, v242, v240
  v_mfma_f32_16x16x32_bf16 v[156:159], a[72:75], a[44:47], v[156:159]
  ds_read_b64_tr_b16 a[88:89], v224 offset:49152
  v_fmac_f32 v217, v243, v240
  v_mfma_f32_16x16x32_bf16 v[156:159], a[76:79], a[60:63], v[156:159]
  ds_read_b64_tr_b16 a[90:91], v224 offset:53248
  v_fmac_f32 v218, v244, v240
  v_mfma_f32_16x16x32_bf16 v[152:155], a[76:79], a[56:59], v[152:155]
  buffer_load_dwordx4 v252, s[84:87], s93 offen offset:1024 lds
  v_mfma_f32_16x16x32_bf16 v[152:155], a[72:75], a[40:43], v[152:155]
  v_fmac_f32 v219, v245, v240
  v_fmac_f32 v220, v242, v241
  v_mfma_f32_16x16x32_bf16 v[148:151], a[72:75], a[36:39], v[148:151]
  ds_read_b64_tr_b16 a[92:93], v224 offset:57344
  v_fmac_f32 v221, v243, v241
  v_mfma_f32_16x16x32_bf16 v[148:151], a[76:79], a[52:55], v[148:151]
  ds_read_b64_tr_b16 a[94:95], v224 offset:61440
  v_fmac_f32 v222, v244, v241
  v_mfma_f32_16x16x32_bf16 v[144:147], a[76:79], a[48:51], v[144:147]
  v_fmac_f32 v223, v245, v241
  v_mfma_f32_16x16x32_bf16 v[144:147], a[72:75], a[32:35], v[144:147]
  s_waitcnt vmcnt(12) lgkmcnt(4)
  v_mfma_f32_16x16x32_bf16 v[0:3], a[80:83], a[0:3], v[0:3]
  s_add_u32 m0, s79, 24576
  ds_read_b64_tr_b16 a[64:65], v229 offset:32768
  v_and_b32 v236, 31, v253
  v_mfma_f32_16x16x32_bf16 v[0:3], a[84:87], a[16:19], v[0:3]
  s_add_u32 s92, s92, 458752
  s_add_u32 s93, s92, s88
  ds_read_b64_tr_b16 a[66:67], v229 offset:36864
  v_lshlrev_b32 v236, 4, v236
  s_waitcnt vmcnt(10)
  v_mfma_f32_16x16x32_bf16 v[4:7], a[84:87], a[20:23], v[4:7]
  buffer_load_dwordx4 v252, s[80:83], s93 offen lds
  v_mfma_f32_16x16x32_bf16 v[4:7], a[80:83], a[4:7], v[4:7]
  v_lshrrev_b32 v250, 5, v253
  s_waitcnt vmcnt(9)
  v_mfma_f32_16x16x32_bf16 v[8:11], a[80:83], a[8:11], v[8:11]
  s_mov_b32 s43, 114688
  ds_read_b64_tr_b16 a[68:69], v229 offset:40960
  v_mad_u32_u24 v236, v250, s43, v236
  v_mfma_f32_16x16x32_bf16 v[8:11], a[84:87], a[24:27], v[8:11]
  s_waitcnt vmcnt(7)
  ds_read_b64_tr_b16 a[70:71], v229 offset:45056
  v_and_b32 v250, 15, v253
  v_mfma_f32_16x16x32_bf16 v[12:15], a[84:87], a[28:31], v[12:15]
  s_add_u32 s43, s71, 1024
  buffer_load_dwordx4 v252, s[84:87], s93 offen offset:1024 lds
  v_mfma_f32_16x16x32_bf16 v[12:15], a[80:83], a[12:15], v[12:15]
  s_waitcnt lgkmcnt(4)
  v_lshl_add_u32 v250, v250, 2, s43
  v_mfma_f32_16x16x32_bf16 v[28:31], a[88:91], a[12:15], v[28:31]
  ds_read2_b32 v[238:239], v250 offset0:64 offset1:80
  ds_read_b64_tr_b16 a[72:73], v229 offset:49152
  v_mfma_f32_16x16x32_bf16 v[28:31], a[92:95], a[28:31], v[28:31]
  ds_read2_b32 v[240:241], v250 offset0:96 offset1:112
  ds_read_b64_tr_b16 a[74:75], v229 offset:53248
  v_mfma_f32_16x16x32_bf16 v[24:27], a[92:95], a[24:27], v[24:27]
  ds_read2_b32 v[232:233], v250 offset0:128 offset1:144
  v_mfma_f32_16x16x32_bf16 v[24:27], a[88:91], a[8:11], v[24:27]
  ds_read2_b32 v[234:235], v250 offset0:160 offset1:176
  v_mfma_f32_16x16x32_bf16 v[20:23], a[88:91], a[4:7], v[20:23]
  ds_read_b64_tr_b16 a[76:77], v229 offset:57344
  v_mfma_f32_16x16x32_bf16 v[20:23], a[92:95], a[20:23], v[20:23]
  ds_read_b64_tr_b16 a[78:79], v229 offset:61440
  v_xor_b32 v229, 0x10000, v229
  v_mfma_f32_16x16x32_bf16 v[16:19], a[92:95], a[16:19], v[16:19]
  v_mfma_f32_16x16x32_bf16 v[16:19], a[88:91], a[0:3], v[16:19]
  s_waitcnt lgkmcnt(8)
  v_mfma_f32_16x16x32_bf16 v[160:163], a[64:67], a[32:35], v[160:163]
  ds_read_b64_tr_b16 a[80:81], v225 offset:32768
  v_mfma_f32_16x16x32_bf16 v[160:163], a[68:71], a[48:51], v[160:163]
  ds_read_b64_tr_b16 a[82:83], v225 offset:36864
  v_mfma_f32_16x16x32_bf16 v[164:167], a[68:71], a[52:55], v[164:167]
  s_waitcnt lgkmcnt(4)
  v_mfma_f32_16x16x32_bf16 v[164:167], a[64:67], a[36:39], v[164:167]
  v_pk_mul_f32 v[242:243], v[0:1], v[238:239] op_sel:[0,0] op_sel_hi:[1,0]
  v_pk_mul_f32 v[244:245], v[2:3], v[238:239] op_sel:[0,0] op_sel_hi:[1,0]
  v_pk_mul_f32 v[0:1], v[0:1], v[16:17]
  v_pk_mul_f32 v[2:3], v[2:3], v[18:19]
  v_mfma_f32_16x16x32_bf16 v[168:171], a[64:67], a[40:43], v[168:171]
  ds_read_b64_tr_b16 a[84:85], v225 offset:40960
  v_mfma_f32_16x16x32_bf16 v[168:171], a[68:71], a[56:59], v[168:171]
  ds_read_b64_tr_b16 a[86:87], v225 offset:45056
  v_mfma_f32_16x16x32_bf16 v[172:175], a[68:71], a[60:63], v[172:175]
  v_mfma_f32_16x16x32_bf16 v[172:175], a[64:67], a[44:47], v[172:175]
  s_waitcnt lgkmcnt(4)
  v_mfma_f32_16x16x32_bf16 v[188:191], a[72:75], a[44:47], v[188:191]
  v_exp_f32 v242, v242
  v_mfma_f32_16x16x32_bf16 v[188:191], a[76:79], a[60:63], v[188:191]
  v_exp_f32 v243, v243
  v_mfma_f32_16x16x32_bf16 v[184:187], a[76:79], a[56:59], v[184:187]
  ds_read_b64_tr_b16 a[88:89], v225 offset:49152
  ds_read_b64_tr_b16 a[90:91], v225 offset:53248
  v_mfma_f32_16x16x32_bf16 v[184:187], a[72:75], a[40:43], v[184:187]
  v_exp_f32 v244, v244
  v_exp_f32 v245, v245
  s_nop 0
  v_pk_fma_f32 v[242:243], v[242:243], v[232:233], v[232:233] op_sel:[0,0,0] op_sel_hi:[1,0,0]
  v_pk_fma_f32 v[244:245], v[244:245], v[232:233], v[232:233] op_sel:[0,0,0] op_sel_hi:[1,0,0]
  v_pk_mul_f32 v[246:247], v[4:5], v[238:239] op_sel:[0,1] op_sel_hi:[1,1]
  v_pk_mul_f32 v[248:249], v[6:7], v[238:239] op_sel:[0,1] op_sel_hi:[1,1]
  v_pk_mul_f32 v[4:5], v[4:5], v[20:21]
  v_pk_mul_f32 v[6:7], v[6:7], v[22:23]
  v_rcp_f32 v242, v242
  v_mfma_f32_16x16x32_bf16 v[180:183], a[72:75], a[36:39], v[180:183]
  v_rcp_f32 v243, v243
  v_mfma_f32_16x16x32_bf16 v[180:183], a[76:79], a[52:55], v[180:183]
  v_rcp_f32 v244, v244
  v_mfma_f32_16x16x32_bf16 v[176:179], a[76:79], a[48:51], v[176:179]
  ds_read_b64_tr_b16 a[92:93], v225 offset:57344
  v_mfma_f32_16x16x32_bf16 v[176:179], a[72:75], a[32:35], v[176:179]
  ds_read_b64_tr_b16 a[94:95], v225 offset:61440
  s_waitcnt lgkmcnt(4)
  v_mfma_f32_16x16x32_bf16 v[32:35], a[80:83], a[0:3], v[32:35]
  v_exp_f32 v246, v246
  v_mfma_f32_16x16x32_bf16 v[32:35], a[84:87], a[16:19], v[32:35]
  v_exp_f32 v247, v247
  v_mfma_f32_16x16x32_bf16 v[36:39], a[84:87], a[20:23], v[36:39]
  ds_read_b64_tr_b16 a[64:65], v230 offset:32768
  ds_read_b64_tr_b16 a[66:67], v230 offset:36864
  v_mfma_f32_16x16x32_bf16 v[36:39], a[80:83], a[4:7], v[36:39]
  v_exp_f32 v248, v248
  v_exp_f32 v249, v249
  v_rcp_f32 v245, v245
  v_pk_fma_f32 v[246:247], v[246:247], v[232:233], v[232:233] op_sel:[0,1,1] op_sel_hi:[1,1,1]
  v_pk_fma_f32 v[248:249], v[248:249], v[232:233], v[232:233] op_sel:[0,1,1] op_sel_hi:[1,1,1]
  v_pk_mul_f32 v[0:1], v[0:1], v[242:243]
  v_pk_mul_f32 v[2:3], v[2:3], v[244:245]
  v_pk_mul_f32 v[242:243], v[8:9], v[240:241] op_sel:[0,0] op_sel_hi:[1,0]
  v_pk_mul_f32 v[244:245], v[10:11], v[240:241] op_sel:[0,0] op_sel_hi:[1,0]
  v_pk_mul_f32 v[8:9], v[8:9], v[24:25]
  v_pk_mul_f32 v[10:11], v[10:11], v[26:27]
  v_rcp_f32 v246, v246
  v_mfma_f32_16x16x32_bf16 v[40:43], a[80:83], a[8:11], v[40:43]
  v_rcp_f32 v247, v247
  v_mfma_f32_16x16x32_bf16 v[40:43], a[84:87], a[24:27], v[40:43]
  v_rcp_f32 v248, v248
  v_mfma_f32_16x16x32_bf16 v[44:47], a[84:87], a[28:31], v[44:47]
  ds_read_b64_tr_b16 a[68:69], v230 offset:40960
  v_cvt_pk_bf16_f32 v16, v0, v1
  v_mfma_f32_16x16x32_bf16 v[44:47], a[80:83], a[12:15], v[44:47]
  s_waitcnt lgkmcnt(3)
  ds_read_b64_tr_b16 a[70:71], v230 offset:45056
  v_cvt_pk_bf16_f32 v17, v2, v3
  v_mfma_f32_16x16x32_bf16 v[60:63], a[88:91], a[12:15], v[60:63]
  v_exp_f32 v242, v242
  v_mfma_f32_16x16x32_bf16 v[60:63], a[92:95], a[28:31], v[60:63]
  v_exp_f32 v243, v243
  v_mfma_f32_16x16x32_bf16 v[56:59], a[92:95], a[24:27], v[56:59]
  ds_read_b64_tr_b16 a[72:73], v230 offset:49152
  ds_read_b64_tr_b16 a[74:75], v230 offset:53248
  v_mfma_f32_16x16x32_bf16 v[56:59], a[88:91], a[8:11], v[56:59]
  v_exp_f32 v244, v244
  v_exp_f32 v245, v245
  v_rcp_f32 v249, v249
  v_pk_fma_f32 v[242:243], v[242:243], v[234:235], v[234:235] op_sel:[0,0,0] op_sel_hi:[1,0,0]
  v_pk_fma_f32 v[244:245], v[244:245], v[234:235], v[234:235] op_sel:[0,0,0] op_sel_hi:[1,0,0]
  v_pk_mul_f32 v[4:5], v[4:5], v[246:247]
  v_pk_mul_f32 v[6:7], v[6:7], v[248:249]
  v_pk_mul_f32 v[246:247], v[12:13], v[240:241] op_sel:[0,1] op_sel_hi:[1,1]
  v_pk_mul_f32 v[248:249], v[14:15], v[240:241] op_sel:[0,1] op_sel_hi:[1,1]
  v_pk_mul_f32 v[12:13], v[12:13], v[28:29]
  v_pk_mul_f32 v[14:15], v[14:15], v[30:31]
  v_rcp_f32 v242, v242
  v_mfma_f32_16x16x32_bf16 v[52:55], a[88:91], a[4:7], v[52:55]
  v_rcp_f32 v243, v243
  v_mfma_f32_16x16x32_bf16 v[52:55], a[92:95], a[20:23], v[52:55]
  v_rcp_f32 v244, v244
  v_mfma_f32_16x16x32_bf16 v[48:51], a[92:95], a[16:19], v[48:51]
  ds_read_b64_tr_b16 a[76:77], v230 offset:57344
  v_cvt_pk_bf16_f32 v18, v4, v5
  v_mfma_f32_16x16x32_bf16 v[48:51], a[88:91], a[0:3], v[48:51]
  s_waitcnt lgkmcnt(3)
  ds_read_b64_tr_b16 a[78:79], v230 offset:61440
  v_xor_b32 v230, 0x10000, v230
  v_cvt_pk_bf16_f32 v19, v6, v7
  v_mfma_f32_16x16x32_bf16 v[192:195], a[64:67], a[32:35], v[192:195]
  s_nop 1
  v_permlane32_swap_b32 v16, v18
  v_permlane32_swap_b32 v17, v19
  buffer_store_dwordx4 v[16:19], v236, s[4:7], s61 offen sc1
  v_exp_f32 v246, v246
  v_mfma_f32_16x16x32_bf16 v[192:195], a[68:71], a[48:51], v[192:195]
  v_exp_f32 v247, v247
  v_mfma_f32_16x16x32_bf16 v[196:199], a[68:71], a[52:55], v[196:199]
  ds_read_b64_tr_b16 a[80:81], v226 offset:32768
  ds_read_b64_tr_b16 a[82:83], v226 offset:36864
  v_mfma_f32_16x16x32_bf16 v[196:199], a[64:67], a[36:39], v[196:199]
  v_exp_f32 v248, v248
  v_exp_f32 v249, v249
  v_rcp_f32 v245, v245
  v_pk_fma_f32 v[246:247], v[246:247], v[234:235], v[234:235] op_sel:[0,1,1] op_sel_hi:[1,1,1]
  v_pk_fma_f32 v[248:249], v[248:249], v[234:235], v[234:235] op_sel:[0,1,1] op_sel_hi:[1,1,1]
  v_pk_mul_f32 v[8:9], v[8:9], v[242:243]
  v_pk_mul_f32 v[10:11], v[10:11], v[244:245]
  v_pk_mul_f32 v[242:243], v[32:33], v[238:239] op_sel:[0,0] op_sel_hi:[1,0]
  v_pk_mul_f32 v[244:245], v[34:35], v[238:239] op_sel:[0,0] op_sel_hi:[1,0]
  v_pk_mul_f32 v[32:33], v[32:33], v[48:49]
  v_pk_mul_f32 v[34:35], v[34:35], v[50:51]
  v_rcp_f32 v246, v246
  v_mfma_f32_16x16x32_bf16 v[200:203], a[64:67], a[40:43], v[200:203]
  v_rcp_f32 v247, v247
  v_mfma_f32_16x16x32_bf16 v[200:203], a[68:71], a[56:59], v[200:203]
  v_rcp_f32 v248, v248
  v_mfma_f32_16x16x32_bf16 v[204:207], a[68:71], a[60:63], v[204:207]
  ds_read_b64_tr_b16 a[84:85], v226 offset:40960
  v_cvt_pk_bf16_f32 v24, v8, v9
  v_mfma_f32_16x16x32_bf16 v[204:207], a[64:67], a[44:47], v[204:207]
  s_waitcnt lgkmcnt(3)
  ds_read_b64_tr_b16 a[86:87], v226 offset:45056
  v_cvt_pk_bf16_f32 v25, v10, v11
  v_mfma_f32_16x16x32_bf16 v[220:223], a[72:75], a[44:47], v[220:223]
  v_exp_f32 v242, v242
  v_mfma_f32_16x16x32_bf16 v[220:223], a[76:79], a[60:63], v[220:223]
  v_exp_f32 v243, v243
  v_mfma_f32_16x16x32_bf16 v[216:219], a[76:79], a[56:59], v[216:219]
  ds_read_b64_tr_b16 a[88:89], v226 offset:49152
  ds_read_b64_tr_b16 a[90:91], v226 offset:53248
  v_mfma_f32_16x16x32_bf16 v[216:219], a[72:75], a[40:43], v[216:219]
  v_exp_f32 v244, v244
  v_exp_f32 v245, v245
  v_rcp_f32 v249, v249
  v_pk_fma_f32 v[242:243], v[242:243], v[232:233], v[232:233] op_sel:[0,0,0] op_sel_hi:[1,0,0]
  v_pk_fma_f32 v[244:245], v[244:245], v[232:233], v[232:233] op_sel:[0,0,0] op_sel_hi:[1,0,0]
  v_pk_mul_f32 v[12:13], v[12:13], v[246:247]
  v_pk_mul_f32 v[14:15], v[14:15], v[248:249]
  v_pk_mul_f32 v[246:247], v[36:37], v[238:239] op_sel:[0,1] op_sel_hi:[1,1]
  v_pk_mul_f32 v[248:249], v[38:39], v[238:239] op_sel:[0,1] op_sel_hi:[1,1]
  v_pk_mul_f32 v[36:37], v[36:37], v[52:53]
  v_pk_mul_f32 v[38:39], v[38:39], v[54:55]
  v_rcp_f32 v242, v242
  v_mfma_f32_16x16x32_bf16 v[212:215], a[72:75], a[36:39], v[212:215]
  v_rcp_f32 v243, v243
  v_mfma_f32_16x16x32_bf16 v[212:215], a[76:79], a[52:55], v[212:215]
  v_rcp_f32 v244, v244
  v_mfma_f32_16x16x32_bf16 v[208:211], a[76:79], a[48:51], v[208:211]
  ds_read_b64_tr_b16 a[92:93], v226 offset:57344
  v_cvt_pk_bf16_f32 v26, v12, v13
  v_mfma_f32_16x16x32_bf16 v[208:211], a[72:75], a[32:35], v[208:211]
  s_waitcnt lgkmcnt(3)
  ds_read_b64_tr_b16 a[94:95], v226 offset:61440
  v_cvt_pk_bf16_f32 v27, v14, v15
  v_mfma_f32_16x16x32_bf16 v[64:67], a[80:83], a[0:3], v[64:67]
  s_nop 1
  v_permlane32_swap_b32 v24, v26
  v_permlane32_swap_b32 v25, v27
  buffer_store_dwordx4 v[24:27], v236, s[4:7], s62 offen sc1
  v_exp_f32 v246, v246
  v_mfma_f32_16x16x32_bf16 v[64:67], a[84:87], a[16:19], v[64:67]
  v_exp_f32 v247, v247
  v_mfma_f32_16x16x32_bf16 v[68:71], a[84:87], a[20:23], v[68:71]
  ds_read_b64_tr_b16 a[64:65], v227 offset:0
  ds_read_b64_tr_b16 a[66:67], v227 offset:4096
  v_mfma_f32_16x16x32_bf16 v[68:71], a[80:83], a[4:7], v[68:71]
  v_exp_f32 v248, v248
  v_exp_f32 v249, v249
  v_rcp_f32 v245, v245
  v_pk_fma_f32 v[246:247], v[246:247], v[232:233], v[232:233] op_sel:[0,1,1] op_sel_hi:[1,1,1]
  v_pk_fma_f32 v[248:249], v[248:249], v[232:233], v[232:233] op_sel:[0,1,1] op_sel_hi:[1,1,1]
  v_pk_mul_f32 v[32:33], v[32:33], v[242:243]
  v_pk_mul_f32 v[34:35], v[34:35], v[244:245]
  v_pk_mul_f32 v[242:243], v[40:41], v[240:241] op_sel:[0,0] op_sel_hi:[1,0]
  v_pk_mul_f32 v[244:245], v[42:43], v[240:241] op_sel:[0,0] op_sel_hi:[1,0]
  v_pk_mul_f32 v[40:41], v[40:41], v[56:57]
  v_pk_mul_f32 v[42:43], v[42:43], v[58:59]
  v_rcp_f32 v246, v246
  v_mfma_f32_16x16x32_bf16 v[72:75], a[80:83], a[8:11], v[72:75]
  v_rcp_f32 v247, v247
  v_lshlrev_b32 v8, 4, v253
  v_mfma_f32_16x16x32_bf16 v[72:75], a[84:87], a[24:27], v[72:75]
  v_rcp_f32 v248, v248
  v_add_u32 v9, 114688, v8
  v_mfma_f32_16x16x32_bf16 v[76:79], a[84:87], a[28:31], v[76:79]
  ds_read_b64_tr_b16 a[68:69], v227 offset:8192
  v_cvt_pk_bf16_f32 v48, v32, v33
  v_mfma_f32_16x16x32_bf16 v[76:79], a[80:83], a[12:15], v[76:79]
  s_waitcnt lgkmcnt(3)
  ds_read_b64_tr_b16 a[70:71], v227 offset:12288
  v_cvt_pk_bf16_f32 v49, v34, v35
  v_mfma_f32_16x16x32_bf16 v[92:95], a[88:91], a[12:15], v[92:95]
  buffer_load_dwordx4 v[16:19], v8, s[4:7], s46 offen offset:0 sc1
  v_exp_f32 v242, v242
  v_mfma_f32_16x16x32_bf16 v[92:95], a[92:95], a[28:31], v[92:95]
  buffer_load_dwordx4 v[20:23], v8, s[4:7], s46 offen offset:1024 sc1
  v_exp_f32 v243, v243
  v_mfma_f32_16x16x32_bf16 v[88:91], a[92:95], a[24:27], v[88:91]
  ds_read_b64_tr_b16 a[72:73], v227 offset:16384
  ds_read_b64_tr_b16 a[74:75], v227 offset:20480
  v_mfma_f32_16x16x32_bf16 v[88:91], a[88:91], a[8:11], v[88:91]
  v_exp_f32 v244, v244
  v_exp_f32 v245, v245
  v_rcp_f32 v249, v249
  v_pk_fma_f32 v[242:243], v[242:243], v[234:235], v[234:235] op_sel:[0,0,0] op_sel_hi:[1,0,0]
  v_pk_fma_f32 v[244:245], v[244:245], v[234:235], v[234:235] op_sel:[0,0,0] op_sel_hi:[1,0,0]
  v_pk_mul_f32 v[36:37], v[36:37], v[246:247]
  v_pk_mul_f32 v[38:39], v[38:39], v[248:249]
  v_pk_mul_f32 v[246:247], v[44:45], v[240:241] op_sel:[0,1] op_sel_hi:[1,1]
  v_pk_mul_f32 v[248:249], v[46:47], v[240:241] op_sel:[0,1] op_sel_hi:[1,1]
  v_pk_mul_f32 v[44:45], v[44:45], v[60:61]
  v_pk_mul_f32 v[46:47], v[46:47], v[62:63]
  v_rcp_f32 v242, v242
  v_mfma_f32_16x16x32_bf16 v[84:87], a[88:91], a[4:7], v[84:87]
  buffer_load_dwordx4 v[24:27], v8, s[4:7], s47 offen offset:0 sc1
  v_rcp_f32 v243, v243
  v_mfma_f32_16x16x32_bf16 v[84:87], a[92:95], a[20:23], v[84:87]
  buffer_load_dwordx4 v[28:31], v8, s[4:7], s47 offen offset:1024 sc1
  v_rcp_f32 v244, v244
  v_mfma_f32_16x16x32_bf16 v[80:83], a[92:95], a[16:19], v[80:83]
  ds_read_b64_tr_b16 a[76:77], v227 offset:24576
  v_cvt_pk_bf16_f32 v52, v36, v37
  v_mfma_f32_16x16x32_bf16 v[80:83], a[88:91], a[0:3], v[80:83]
  s_waitcnt lgkmcnt(3)
  ds_read_b64_tr_b16 a[78:79], v227 offset:28672
  v_cvt_pk_bf16_f32 v53, v38, v39
  v_mfma_f32_16x16x32_bf16 v[96:99], a[64:67], a[96:99], v[96:99]
  v_exp_f32 v246, v246
  v_bfe_u32 v11, v253, 2, 3
  v_mfma_f32_16x16x32_bf16 v[96:99], a[68:71], a[112:115], v[96:99]
  v_exp_f32 v247, v247
  v_bfe_u32 v12, v253, 3, 2
  v_mfma_f32_16x16x32_bf16 v[100:103], a[68:71], a[116:119], v[100:103]
  ds_read_b64_tr_b16 a[80:81], v227 offset:32768
  ds_read_b64_tr_b16 a[82:83], v227 offset:36864
  v_mfma_f32_16x16x32_bf16 v[100:103], a[64:67], a[100:103], v[100:103]
  v_exp_f32 v248, v248
  v_exp_f32 v249, v249
  v_rcp_f32 v245, v245
  v_pk_fma_f32 v[246:247], v[246:247], v[234:235], v[234:235] op_sel:[0,1,1] op_sel_hi:[1,1,1]
  v_pk_fma_f32 v[248:249], v[248:249], v[234:235], v[234:235] op_sel:[0,1,1] op_sel_hi:[1,1,1]
  v_pk_mul_f32 v[40:41], v[40:41], v[242:243]
  v_pk_mul_f32 v[42:43], v[42:43], v[244:245]
  v_pk_mul_f32 v[242:243], v[64:65], v[238:239] op_sel:[0,0] op_sel_hi:[1,0]
  v_pk_mul_f32 v[244:245], v[66:67], v[238:239] op_sel:[0,0] op_sel_hi:[1,0]
  v_pk_mul_f32 v[64:65], v[64:65], v[80:81]
  v_pk_mul_f32 v[66:67], v[66:67], v[82:83]
  v_rcp_f32 v246, v246
  v_mfma_f32_16x16x32_bf16 v[104:107], a[64:67], a[104:107], v[104:107]
  v_rcp_f32 v247, v247
  v_and_b32 v13, 3, v253
  v_mfma_f32_16x16x32_bf16 v[104:107], a[68:71], a[120:123], v[104:107]
  v_rcp_f32 v248, v248
  v_lshlrev_b32 v13, 3, v13
  v_mfma_f32_16x16x32_bf16 v[108:111], a[68:71], a[124:127], v[108:111]
  ds_read_b64_tr_b16 a[84:85], v227 offset:40960
  v_cvt_pk_bf16_f32 v56, v40, v41
  v_mfma_f32_16x16x32_bf16 v[108:111], a[64:67], a[108:111], v[108:111]
  s_waitcnt lgkmcnt(3)
  ds_read_b64_tr_b16 a[86:87], v227 offset:45056
  v_cvt_pk_bf16_f32 v57, v42, v43
  v_mfma_f32_16x16x32_bf16 v[124:127], a[72:75], a[108:111], v[124:127]
  v_exp_f32 v242, v242
  v_lshl_add_u32 v13, v11, 7, v13
  v_mfma_f32_16x16x32_bf16 v[124:127], a[76:79], a[124:127], v[124:127]
  v_exp_f32 v243, v243
  v_lshrrev_b32 v11, 5, v253
  v_mfma_f32_16x16x32_bf16 v[120:123], a[76:79], a[120:123], v[120:123]
  ds_read_b64_tr_b16 a[88:89], v227 offset:49152
  ds_read_b64_tr_b16 a[90:91], v227 offset:53248
  v_mfma_f32_16x16x32_bf16 v[120:123], a[72:75], a[104:107], v[120:123]
  v_exp_f32 v244, v244
  v_exp_f32 v245, v245
  v_rcp_f32 v249, v249
  v_pk_fma_f32 v[242:243], v[242:243], v[232:233], v[232:233] op_sel:[0,0,0] op_sel_hi:[1,0,0]
  v_pk_fma_f32 v[244:245], v[244:245], v[232:233], v[232:233] op_sel:[0,0,0] op_sel_hi:[1,0,0]
  v_pk_mul_f32 v[44:45], v[44:45], v[246:247]
  v_pk_mul_f32 v[46:47], v[46:47], v[248:249]
  v_pk_mul_f32 v[246:247], v[68:69], v[238:239] op_sel:[0,1] op_sel_hi:[1,1]
  v_pk_mul_f32 v[248:249], v[70:71], v[238:239] op_sel:[0,1] op_sel_hi:[1,1]
  v_pk_mul_f32 v[68:69], v[68:69], v[84:85]
  v_pk_mul_f32 v[70:71], v[70:71], v[86:87]
  v_rcp_f32 v242, v242
  v_mfma_f32_16x16x32_bf16 v[116:119], a[72:75], a[100:103], v[116:119]
  s_waitcnt vmcnt(4)
  s_barrier
  s_cmp_lg_u32 s40, 0
  s_cbranch_scc1 Lsgf21
  v_mov_b32 v250, 1
  s_mov_b64 exec, 1
  buffer_atomic_add v250, v251, s[4:7], s77 offen sc1
  s_mov_b64 exec, -1
Lsgf21:
  s_add_u32 s77, s77, 4096
  v_rcp_f32 v243, v243
  v_lshl_add_u32 v13, v11, 11, v13
  v_mfma_f32_16x16x32_bf16 v[116:119], a[76:79], a[116:119], v[116:119]
  s_add_u32 m0, s79, 32768
  v_rcp_f32 v244, v244
  v_xor_b32 v11, 0, v12
  v_mfma_f32_16x16x32_bf16 v[112:115], a[76:79], a[112:115], v[112:115]
  s_add_u32 s92, s92, 458752
  s_sub_u32 s93, s92, s88
  ds_read_b64_tr_b16 a[92:93], v227 offset:57344
  v_cvt_pk_bf16_f32 v60, v44, v45
  v_mfma_f32_16x16x32_bf16 v[112:115], a[72:75], a[96:99], v[112:115]
  s_waitcnt lgkmcnt(3)
  ds_read_b64_tr_b16 a[94:95], v227 offset:61440
  v_cvt_pk_bf16_f32 v61, v46, v47
  v_mfma_f32_16x16x32_bf16 v[96:99], a[80:83], a[0:3], v[96:99]
  buffer_load_dwordx4 v252, s[80:83], s93 offen lds
  v_exp_f32 v246, v246
  v_mfma_f32_16x16x32_bf16 v[96:99], a[84:87], a[16:19], v[96:99]
  buffer_load_dwordx4 v252, s[84:87], s93 offen offset:1024 lds
  v_exp_f32 v247, v247
  v_mfma_f32_16x16x32_bf16 v[100:103], a[84:87], a[20:23], v[100:103]
  ds_read_b64_tr_b16 a[64:65], v228 offset:0
  ds_read_b64_tr_b16 a[66:67], v228 offset:4096
  v_mfma_f32_16x16x32_bf16 v[100:103], a[80:83], a[4:7], v[100:103]
  v_exp_f32 v248, v248
  v_exp_f32 v249, v249
  v_rcp_f32 v245, v245
  v_pk_fma_f32 v[246:247], v[246:247], v[232:233], v[232:233] op_sel:[0,1,1] op_sel_hi:[1,1,1]
  v_pk_fma_f32 v[248:249], v[248:249], v[232:233], v[232:233] op_sel:[0,1,1] op_sel_hi:[1,1,1]
  v_pk_mul_f32 v[64:65], v[64:65], v[242:243]
  v_pk_mul_f32 v[66:67], v[66:67], v[244:245]
  v_pk_mul_f32 v[242:243], v[72:73], v[240:241] op_sel:[0,0] op_sel_hi:[1,0]
  v_pk_mul_f32 v[244:245], v[74:75], v[240:241] op_sel:[0,0] op_sel_hi:[1,0]
  v_pk_mul_f32 v[72:73], v[72:73], v[88:89]
  v_pk_mul_f32 v[74:75], v[74:75], v[90:91]
  v_rcp_f32 v246, v246
  v_mfma_f32_16x16x32_bf16 v[104:107], a[80:83], a[8:11], v[104:107]
  s_add_u32 m0, s79, 40960
  v_rcp_f32 v247, v247
  v_lshl_add_u32 v0, v11, 5, v13
  v_mfma_f32_16x16x32_bf16 v[104:107], a[84:87], a[24:27], v[104:107]
  s_add_u32 s92, s92, 458752
  s_sub_u32 s93, s92, s88
  buffer_load_dwordx4 v252, s[80:83], s93 offen lds
  v_rcp_f32 v248, v248
  v_mfma_f32_16x16x32_bf16 v[108:111], a[84:87], a[28:31], v[108:111]
  ds_read_b64_tr_b16 a[68:69], v228 offset:8192
  v_cvt_pk_bf16_f32 v50, v64, v65
  v_mfma_f32_16x16x32_bf16 v[108:111], a[80:83], a[12:15], v[108:111]
  s_waitcnt lgkmcnt(3)
  ds_read_b64_tr_b16 a[70:71], v228 offset:12288
  v_cvt_pk_bf16_f32 v51, v66, v67
  v_mfma_f32_16x16x32_bf16 v[124:127], a[88:91], a[12:15], v[124:127]
  buffer_load_dwordx4 v252, s[84:87], s93 offen offset:1024 lds
  buffer_store_dwordx4 v[48:51], v231, s[4:7], s57 offen sc1
  s_add_u32 s57, s57, 16384
  v_exp_f32 v242, v242
  v_mfma_f32_16x16x32_bf16 v[124:127], a[92:95], a[28:31], v[124:127]
  v_exp_f32 v243, v243
  v_add_u32 v4, 0x10000, v0
  v_mfma_f32_16x16x32_bf16 v[120:123], a[92:95], a[24:27], v[120:123]
  ds_read_b64_tr_b16 a[72:73], v228 offset:16384
  ds_read_b64_tr_b16 a[74:75], v228 offset:20480
  v_mfma_f32_16x16x32_bf16 v[120:123], a[88:91], a[8:11], v[120:123]
  v_exp_f32 v244, v244
  v_exp_f32 v245, v245
  v_rcp_f32 v249, v249
  v_pk_fma_f32 v[242:243], v[242:243], v[234:235], v[234:235] op_sel:[0,0,0] op_sel_hi:[1,0,0]
  v_pk_fma_f32 v[244:245], v[244:245], v[234:235], v[234:235] op_sel:[0,0,0] op_sel_hi:[1,0,0]
  v_pk_mul_f32 v[68:69], v[68:69], v[246:247]
  v_pk_mul_f32 v[70:71], v[70:71], v[248:249]
  v_pk_mul_f32 v[246:247], v[76:77], v[240:241] op_sel:[0,1] op_sel_hi:[1,1]
  v_pk_mul_f32 v[248:249], v[78:79], v[240:241] op_sel:[0,1] op_sel_hi:[1,1]
  v_pk_mul_f32 v[76:77], v[76:77], v[92:93]
  v_pk_mul_f32 v[78:79], v[78:79], v[94:95]
  v_rcp_f32 v242, v242
  v_mfma_f32_16x16x32_bf16 v[116:119], a[88:91], a[4:7], v[116:119]
  s_add_u32 m0, s79, 49152
  v_rcp_f32 v243, v243
  v_xor_b32 v11, 1, v12
  v_mfma_f32_16x16x32_bf16 v[116:119], a[92:95], a[20:23], v[116:119]
  s_add_u32 s92, s92, 458752
  s_sub_u32 s93, s92, s88
  buffer_load_dwordx4 v252, s[80:83], s93 offen lds
  v_rcp_f32 v244, v244
  v_mfma_f32_16x16x32_bf16 v[112:115], a[92:95], a[16:19], v[112:115]
  ds_read_b64_tr_b16 a[76:77], v228 offset:24576
  v_cvt_pk_bf16_f32 v54, v68, v69
  v_mfma_f32_16x16x32_bf16 v[112:115], a[88:91], a[0:3], v[112:115]
  s_waitcnt lgkmcnt(3)
  ds_read_b64_tr_b16 a[78:79], v228 offset:28672
  v_cvt_pk_bf16_f32 v55, v70, v71
  v_mfma_f32_16x16x32_bf16 v[128:131], a[64:67], a[96:99], v[128:131]
  buffer_load_dwordx4 v252, s[84:87], s93 offen offset:1024 lds
  buffer_store_dwordx4 v[52:55], v231, s[4:7], s58 offen sc1
  s_add_u32 s58, s58, 16384
  v_exp_f32 v246, v246
  v_mfma_f32_16x16x32_bf16 v[128:131], a[68:71], a[112:115], v[128:131]
  v_exp_f32 v247, v247
  v_lshl_add_u32 v1, v11, 5, v13
  v_mfma_f32_16x16x32_bf16 v[132:135], a[68:71], a[116:119], v[132:135]
  ds_read_b64_tr_b16 a[80:81], v228 offset:32768
  ds_read_b64_tr_b16 a[82:83], v228 offset:36864
  v_mfma_f32_16x16x32_bf16 v[132:135], a[64:67], a[100:103], v[132:135]
  v_exp_f32 v248, v248
  v_exp_f32 v249, v249
  v_rcp_f32 v245, v245
  v_pk_fma_f32 v[246:247], v[246:247], v[234:235], v[234:235] op_sel:[0,1,1] op_sel_hi:[1,1,1]
  v_pk_fma_f32 v[248:249], v[248:249], v[234:235], v[234:235] op_sel:[0,1,1] op_sel_hi:[1,1,1]
  v_pk_mul_f32 v[72:73], v[72:73], v[242:243]
  v_pk_mul_f32 v[74:75], v[74:75], v[244:245]
  v_pk_mul_f32 v[242:243], v[96:97], v[238:239] op_sel:[0,0] op_sel_hi:[1,0]
  v_pk_mul_f32 v[244:245], v[98:99], v[238:239] op_sel:[0,0] op_sel_hi:[1,0]
  v_pk_mul_f32 v[96:97], v[96:97], v[112:113]
  v_pk_mul_f32 v[98:99], v[98:99], v[114:115]
  v_rcp_f32 v246, v246
  v_mfma_f32_16x16x32_bf16 v[136:139], a[64:67], a[104:107], v[136:139]
  s_add_u32 m0, s79, 57344
  v_rcp_f32 v247, v247
  v_add_u32 v5, 0x10000, v1
  v_mfma_f32_16x16x32_bf16 v[136:139], a[68:71], a[120:123], v[136:139]
  s_add_u32 s92, s92, 458752
  s_sub_u32 s93, s92, s88
  buffer_load_dwordx4 v252, s[80:83], s93 offen lds
  v_rcp_f32 v248, v248
  v_mfma_f32_16x16x32_bf16 v[140:143], a[68:71], a[124:127], v[140:143]
  ds_read_b64_tr_b16 a[84:85], v228 offset:40960
  v_cvt_pk_bf16_f32 v58, v72, v73
  v_mfma_f32_16x16x32_bf16 v[140:143], a[64:67], a[108:111], v[140:143]
  s_waitcnt lgkmcnt(3)
  ds_read_b64_tr_b16 a[86:87], v228 offset:45056
  v_cvt_pk_bf16_f32 v59, v74, v75
  v_mfma_f32_16x16x32_bf16 v[156:159], a[72:75], a[108:111], v[156:159]
  buffer_load_dwordx4 v252, s[84:87], s93 offen offset:1024 lds
  buffer_store_dwordx4 v[56:59], v231, s[4:7], s59 offen sc1
  s_add_u32 s59, s59, 16384
  v_exp_f32 v242, v242
  v_mfma_f32_16x16x32_bf16 v[156:159], a[76:79], a[124:127], v[156:159]
  v_exp_f32 v243, v243
  v_xor_b32 v11, 2, v12
  v_mfma_f32_16x16x32_bf16 v[152:155], a[76:79], a[120:123], v[152:155]
  ds_read_b64_tr_b16 a[88:89], v228 offset:49152
  ds_read_b64_tr_b16 a[90:91], v228 offset:53248
  v_mfma_f32_16x16x32_bf16 v[152:155], a[72:75], a[104:107], v[152:155]
  v_exp_f32 v244, v244
  v_exp_f32 v245, v245
  v_rcp_f32 v249, v249
  v_pk_fma_f32 v[242:243], v[242:243], v[232:233], v[232:233] op_sel:[0,0,0] op_sel_hi:[1,0,0]
  v_pk_fma_f32 v[244:245], v[244:245], v[232:233], v[232:233] op_sel:[0,0,0] op_sel_hi:[1,0,0]
  v_pk_mul_f32 v[76:77], v[76:77], v[246:247]
  v_pk_mul_f32 v[78:79], v[78:79], v[248:249]
  v_pk_mul_f32 v[246:247], v[100:101], v[238:239] op_sel:[0,1] op_sel_hi:[1,1]
  v_pk_mul_f32 v[248:249], v[102:103], v[238:239] op_sel:[0,1] op_sel_hi:[1,1]
  v_pk_mul_f32 v[100:101], v[100:101], v[116:117]
  v_pk_mul_f32 v[102:103], v[102:103], v[118:119]
  v_rcp_f32 v242, v242
  v_mfma_f32_16x16x32_bf16 v[148:151], a[72:75], a[100:103], v[148:151]
  v_rcp_f32 v243, v243
  v_lshl_add_u32 v2, v11, 5, v13
  v_mfma_f32_16x16x32_bf16 v[148:151], a[76:79], a[116:119], v[148:151]
  v_rcp_f32 v244, v244
  v_add_u32 v6, 0x10000, v2
  v_mfma_f32_16x16x32_bf16 v[144:147], a[76:79], a[112:115], v[144:147]
  ds_read_b64_tr_b16 a[92:93], v228 offset:57344
  v_cvt_pk_bf16_f32 v62, v76, v77
  v_mfma_f32_16x16x32_bf16 v[144:147], a[72:75], a[96:99], v[144:147]
  s_waitcnt lgkmcnt(3)
  ds_read_b64_tr_b16 a[94:95], v228 offset:61440
  v_cvt_pk_bf16_f32 v63, v78, v79
  v_mfma_f32_16x16x32_bf16 v[128:131], a[80:83], a[0:3], v[128:131]
  buffer_store_dwordx4 v[60:63], v231, s[4:7], s60 offen sc1
  s_add_u32 s60, s60, 16384
  v_exp_f32 v246, v246
  v_mfma_f32_16x16x32_bf16 v[128:131], a[84:87], a[16:19], v[128:131]
  v_exp_f32 v247, v247
  v_xor_b32 v11, 3, v12
  v_mfma_f32_16x16x32_bf16 v[132:135], a[84:87], a[20:23], v[132:135]
  ds_read_b64_tr_b16 a[64:65], v229 offset:0
  ds_read_b64_tr_b16 a[66:67], v229 offset:4096
  v_mfma_f32_16x16x32_bf16 v[132:135], a[80:83], a[4:7], v[132:135]
  v_exp_f32 v248, v248
  v_exp_f32 v249, v249
  v_rcp_f32 v245, v245
  v_pk_fma_f32 v[246:247], v[246:247], v[232:233], v[232:233] op_sel:[0,1,1] op_sel_hi:[1,1,1]
  v_pk_fma_f32 v[248:249], v[248:249], v[232:233], v[232:233] op_sel:[0,1,1] op_sel_hi:[1,1,1]
  v_pk_mul_f32 v[96:97], v[96:97], v[242:243]
  v_pk_mul_f32 v[98:99], v[98:99], v[244:245]
  v_pk_mul_f32 v[242:243], v[104:105], v[240:241] op_sel:[0,0] op_sel_hi:[1,0]
  v_pk_mul_f32 v[244:245], v[106:107], v[240:241] op_sel:[0,0] op_sel_hi:[1,0]
  v_pk_mul_f32 v[104:105], v[104:105], v[120:121]
  v_pk_mul_f32 v[106:107], v[106:107], v[122:123]
  v_rcp_f32 v246, v246
  v_mfma_f32_16x16x32_bf16 v[136:139], a[80:83], a[8:11], v[136:139]
  buffer_load_dword v10, v251, s[4:7], s64 offen sc1
  v_rcp_f32 v247, v247
  v_mfma_f32_16x16x32_bf16 v[136:139], a[84:87], a[24:27], v[136:139]
  v_rcp_f32 v248, v248
  v_lshl_add_u32 v3, v11, 5, v13
  v_mfma_f32_16x16x32_bf16 v[140:143], a[84:87], a[28:31], v[140:143]
  ds_read_b64_tr_b16 a[68:69], v229 offset:8192
  v_cvt_pk_bf16_f32 v112, v96, v97
  v_mfma_f32_16x16x32_bf16 v[140:143], a[80:83], a[12:15], v[140:143]
  s_waitcnt lgkmcnt(3)
  ds_read_b64_tr_b16 a[70:71], v229 offset:12288
  v_cvt_pk_bf16_f32 v113, v98, v99
  v_mfma_f32_16x16x32_bf16 v[156:159], a[88:91], a[12:15], v[156:159]
  v_exp_f32 v242, v242
  v_add_u32 v7, 0x10000, v3
  v_mfma_f32_16x16x32_bf16 v[156:159], a[92:95], a[28:31], v[156:159]
  v_exp_f32 v243, v243
  v_mfma_f32_16x16x32_bf16 v[152:155], a[92:95], a[24:27], v[152:155]
  ds_read_b64_tr_b16 a[72:73], v229 offset:16384
  ds_read_b64_tr_b16 a[74:75], v229 offset:20480
  v_mfma_f32_16x16x32_bf16 v[152:155], a[88:91], a[8:11], v[152:155]
  v_exp_f32 v244, v244
  v_exp_f32 v245, v245
  v_rcp_f32 v249, v249
  v_pk_fma_f32 v[242:243], v[242:243], v[234:235], v[234:235] op_sel:[0,0,0] op_sel_hi:[1,0,0]
  v_pk_fma_f32 v[244:245], v[244:245], v[234:235], v[234:235] op_sel:[0,0,0] op_sel_hi:[1,0,0]
  v_pk_mul_f32 v[100:101], v[100:101], v[246:247]
  v_pk_mul_f32 v[102:103], v[102:103], v[248:249]
  v_pk_mul_f32 v[246:247], v[108:109], v[240:241] op_sel:[0,1] op_sel_hi:[1,1]
  v_pk_mul_f32 v[248:249], v[110:111], v[240:241] op_sel:[0,1] op_sel_hi:[1,1]
  v_pk_mul_f32 v[108:109], v[108:109], v[124:125]
  v_pk_mul_f32 v[110:111], v[110:111], v[126:127]
  v_rcp_f32 v242, v242
  v_mfma_f32_16x16x32_bf16 v[148:151], a[88:91], a[4:7], v[148:151]
  v_rcp_f32 v243, v243
  v_mfma_f32_16x16x32_bf16 v[148:151], a[92:95], a[20:23], v[148:151]
  v_rcp_f32 v244, v244
  v_mfma_f32_16x16x32_bf16 v[144:147], a[92:95], a[16:19], v[144:147]
  ds_read_b64_tr_b16 a[76:77], v229 offset:24576
  v_cvt_pk_bf16_f32 v116, v100, v101
  v_mfma_f32_16x16x32_bf16 v[144:147], a[88:91], a[0:3], v[144:147]
  s_waitcnt lgkmcnt(3)
  ds_read_b64_tr_b16 a[78:79], v229 offset:28672
  v_cvt_pk_bf16_f32 v117, v102, v103
  v_mfma_f32_16x16x32_bf16 v[160:163], a[64:67], a[96:99], v[160:163]
  v_exp_f32 v246, v246
  v_mfma_f32_16x16x32_bf16 v[160:163], a[68:71], a[112:115], v[160:163]
  v_exp_f32 v247, v247
  v_mfma_f32_16x16x32_bf16 v[164:167], a[68:71], a[116:119], v[164:167]
  ds_read_b64_tr_b16 a[80:81], v229 offset:32768
  ds_read_b64_tr_b16 a[82:83], v229 offset:36864
  v_mfma_f32_16x16x32_bf16 v[164:167], a[64:67], a[100:103], v[164:167]
  v_exp_f32 v248, v248
  v_exp_f32 v249, v249
  v_rcp_f32 v245, v245
  v_pk_fma_f32 v[246:247], v[246:247], v[234:235], v[234:235] op_sel:[0,1,1] op_sel_hi:[1,1,1]
  v_pk_fma_f32 v[248:249], v[248:249], v[234:235], v[234:235] op_sel:[0,1,1] op_sel_hi:[1,1,1]
  v_pk_mul_f32 v[104:105], v[104:105], v[242:243]
  v_pk_mul_f32 v[106:107], v[106:107], v[244:245]
  v_pk_mul_f32 v[242:243], v[128:129], v[238:239] op_sel:[0,0] op_sel_hi:[1,0]
  v_pk_mul_f32 v[244:245], v[130:131], v[238:239] op_sel:[0,0] op_sel_hi:[1,0]
  v_pk_mul_f32 v[128:129], v[128:129], v[144:145]
  v_pk_mul_f32 v[130:131], v[130:131], v[146:147]
  v_rcp_f32 v246, v246
  v_mfma_f32_16x16x32_bf16 v[168:171], a[64:67], a[104:107], v[168:171]
  v_rcp_f32 v247, v247
  v_mfma_f32_16x16x32_bf16 v[168:171], a[68:71], a[120:123], v[168:171]
  v_rcp_f32 v248, v248
  v_mfma_f32_16x16x32_bf16 v[172:175], a[68:71], a[124:127], v[172:175]
  ds_read_b64_tr_b16 a[84:85], v229 offset:40960
  v_cvt_pk_bf16_f32 v120, v104, v105
  v_mfma_f32_16x16x32_bf16 v[172:175], a[64:67], a[108:111], v[172:175]
  s_waitcnt lgkmcnt(3)
  ds_read_b64_tr_b16 a[86:87], v229 offset:45056
  v_cvt_pk_bf16_f32 v121, v106, v107
  v_mfma_f32_16x16x32_bf16 v[188:191], a[72:75], a[108:111], v[188:191]
  v_exp_f32 v242, v242
  v_mfma_f32_16x16x32_bf16 v[188:191], a[76:79], a[124:127], v[188:191]
  v_exp_f32 v243, v243
  v_mfma_f32_16x16x32_bf16 v[184:187], a[76:79], a[120:123], v[184:187]
  ds_read_b64_tr_b16 a[88:89], v229 offset:49152
  ds_read_b64_tr_b16 a[90:91], v229 offset:53248
  v_mfma_f32_16x16x32_bf16 v[184:187], a[72:75], a[104:107], v[184:187]
  v_exp_f32 v244, v244
  v_exp_f32 v245, v245
  v_rcp_f32 v249, v249
  v_pk_fma_f32 v[242:243], v[242:243], v[232:233], v[232:233] op_sel:[0,0,0] op_sel_hi:[1,0,0]
  v_pk_fma_f32 v[244:245], v[244:245], v[232:233], v[232:233] op_sel:[0,0,0] op_sel_hi:[1,0,0]
  v_pk_mul_f32 v[108:109], v[108:109], v[246:247]
  v_pk_mul_f32 v[110:111], v[110:111], v[248:249]
  v_pk_mul_f32 v[246:247], v[132:133], v[238:239] op_sel:[0,1] op_sel_hi:[1,1]
  v_pk_mul_f32 v[248:249], v[134:135], v[238:239] op_sel:[0,1] op_sel_hi:[1,1]
  v_pk_mul_f32 v[132:133], v[132:133], v[148:149]
  v_pk_mul_f32 v[134:135], v[134:135], v[150:151]
  v_rcp_f32 v242, v242
  v_mfma_f32_16x16x32_bf16 v[180:183], a[72:75], a[100:103], v[180:183]
  s_waitcnt vmcnt(1)
  s_barrier
  s_cmp_lg_u32 s40, 0
  s_cbranch_scc1 Lsgf22
  v_mov_b32 v250, 1
  s_mov_b64 exec, 1
  buffer_atomic_add v250, v251, s[4:7], s77 offen sc1
  s_mov_b64 exec, -1
Lsgf22:
  s_add_u32 s77, s77, 4096
  s_waitcnt vmcnt(0)
  v_cmp_gt_u32 vcc, 16, v10
  s_cbranch_vccnz Lp4a_c
Lp4a_r:
  s_add_u32 s64, s64, 4096
  v_rcp_f32 v243, v243
  v_mfma_f32_16x16x32_bf16 v[180:183], a[76:79], a[116:119], v[180:183]
  s_min_u32 s63, s88, 4096
  s_add_u32 s63, s48, s63
  buffer_load_dwordx4 a[128:131], v8, s[4:7], s63 offen offset:0 sc1
  v_rcp_f32 v244, v244
  v_mfma_f32_16x16x32_bf16 v[176:179], a[76:79], a[112:115], v[176:179]
  ds_read_b64_tr_b16 a[92:93], v229 offset:57344
  v_cvt_pk_bf16_f32 v124, v108, v109
  v_mfma_f32_16x16x32_bf16 v[176:179], a[72:75], a[96:99], v[176:179]
  s_waitcnt lgkmcnt(3)
  ds_read_b64_tr_b16 a[94:95], v229 offset:61440
  v_cvt_pk_bf16_f32 v125, v110, v111
  v_mfma_f32_16x16x32_bf16 v[160:163], a[80:83], a[0:3], v[160:163]
  buffer_load_dwordx4 a[132:135], v9, s[4:7], s63 offen offset:0 sc1
  v_exp_f32 v246, v246
  v_mfma_f32_16x16x32_bf16 v[160:163], a[84:87], a[16:19], v[160:163]
  buffer_load_dwordx4 a[136:139], v8, s[4:7], s63 offen offset:1024 sc1
  ds_read_b64_tr_b16 a[64:65], v230 offset:0
  v_exp_f32 v247, v247
  v_mfma_f32_16x16x32_bf16 v[164:167], a[84:87], a[20:23], v[164:167]
  ds_read_b64_tr_b16 a[66:67], v230 offset:4096
  buffer_load_dwordx4 a[140:143], v9, s[4:7], s63 offen offset:1024 sc1
  v_mfma_f32_16x16x32_bf16 v[164:167], a[80:83], a[4:7], v[164:167]
  v_exp_f32 v248, v248
  v_exp_f32 v249, v249
  v_rcp_f32 v245, v245
  v_pk_fma_f32 v[246:247], v[246:247], v[232:233], v[232:233] op_sel:[0,1,1] op_sel_hi:[1,1,1]
  v_pk_fma_f32 v[248:249], v[248:249], v[232:233], v[232:233] op_sel:[0,1,1] op_sel_hi:[1,1,1]
  v_pk_mul_f32 v[128:129], v[128:129], v[242:243]
  v_pk_mul_f32 v[130:131], v[130:131], v[244:245]
  v_pk_mul_f32 v[242:243], v[136:137], v[240:241] op_sel:[0,0] op_sel_hi:[1,0]
  v_pk_mul_f32 v[244:245], v[138:139], v[240:241] op_sel:[0,0] op_sel_hi:[1,0]
  v_pk_mul_f32 v[136:137], v[136:137], v[152:153]
  v_pk_mul_f32 v[138:139], v[138:139], v[154:155]
  v_rcp_f32 v246, v246
  v_mfma_f32_16x16x32_bf16 v[168:171], a[80:83], a[8:11], v[168:171]
  buffer_load_dwordx4 a[144:147], v8, s[4:7], s63 offen offset:2048 sc1
  v_rcp_f32 v247, v247
  v_mfma_f32_16x16x32_bf16 v[168:171], a[84:87], a[24:27], v[168:171]
  buffer_load_dwordx4 a[148:151], v9, s[4:7], s63 offen offset:2048 sc1
  v_rcp_f32 v248, v248
  v_mfma_f32_16x16x32_bf16 v[172:175], a[84:87], a[28:31], v[172:175]
  ds_read_b64_tr_b16 a[68:69], v230 offset:8192
  v_cvt_pk_bf16_f32 v114, v128, v129
  v_mfma_f32_16x16x32_bf16 v[172:175], a[80:83], a[12:15], v[172:175]
  s_waitcnt lgkmcnt(3)
  ds_read_b64_tr_b16 a[70:71], v230 offset:12288
  v_cvt_pk_bf16_f32 v115, v130, v131
  v_mfma_f32_16x16x32_bf16 v[188:191], a[88:91], a[12:15], v[188:191]
  buffer_load_dwordx4 a[152:155], v8, s[4:7], s63 offen offset:3072 sc1
  buffer_store_dwordx4 v[112:115], v231, s[4:7], s57 offen sc1
  s_add_u32 s57, s57, 16384
  v_exp_f32 v242, v242
  v_mfma_f32_16x16x32_bf16 v[188:191], a[92:95], a[28:31], v[188:191]
  buffer_load_dwordx4 a[156:159], v9, s[4:7], s63 offen offset:3072 sc1
  v_exp_f32 v243, v243
  v_mfma_f32_16x16x32_bf16 v[184:187], a[92:95], a[24:27], v[184:187]
  ds_read_b64_tr_b16 a[72:73], v230 offset:16384
  ds_read_b64_tr_b16 a[74:75], v230 offset:20480
  v_mfma_f32_16x16x32_bf16 v[184:187], a[88:91], a[8:11], v[184:187]
  v_exp_f32 v244, v244
  v_exp_f32 v245, v245
  v_rcp_f32 v249, v249
  v_pk_fma_f32 v[242:243], v[242:243], v[234:235], v[234:235] op_sel:[0,0,0] op_sel_hi:[1,0,0]
  v_pk_fma_f32 v[244:245], v[244:245], v[234:235], v[234:235] op_sel:[0,0,0] op_sel_hi:[1,0,0]
  v_pk_mul_f32 v[132:133], v[132:133], v[246:247]
  v_pk_mul_f32 v[134:135], v[134:135], v[248:249]
  v_pk_mul_f32 v[246:247], v[140:141], v[240:241] op_sel:[0,1] op_sel_hi:[1,1]
  v_pk_mul_f32 v[248:249], v[142:143], v[240:241] op_sel:[0,1] op_sel_hi:[1,1]
  v_pk_mul_f32 v[140:141], v[140:141], v[156:157]
  v_pk_mul_f32 v[142:143], v[142:143], v[158:159]
  v_rcp_f32 v242, v242
  v_mfma_f32_16x16x32_bf16 v[180:183], a[88:91], a[4:7], v[180:183]
  s_add_u32 s48, s48, 4096
  s_min_u32 s63, s88, 4096
  s_sub_u32 s63, s48, s63
  buffer_load_dwordx4 a[160:163], v8, s[4:7], s63 offen offset:0 sc1
  v_rcp_f32 v243, v243
  v_mfma_f32_16x16x32_bf16 v[180:183], a[92:95], a[20:23], v[180:183]
  buffer_load_dwordx4 a[164:167], v9, s[4:7], s63 offen offset:0 sc1
  v_rcp_f32 v244, v244
  v_mfma_f32_16x16x32_bf16 v[176:179], a[92:95], a[16:19], v[176:179]
  ds_read_b64_tr_b16 a[76:77], v230 offset:24576
  v_cvt_pk_bf16_f32 v118, v132, v133
  v_mfma_f32_16x16x32_bf16 v[176:179], a[88:91], a[0:3], v[176:179]
  s_waitcnt lgkmcnt(3)
  ds_read_b64_tr_b16 a[78:79], v230 offset:28672
  v_cvt_pk_bf16_f32 v119, v134, v135
  v_mfma_f32_16x16x32_bf16 v[192:195], a[64:67], a[96:99], v[192:195]
  buffer_load_dwordx4 a[168:171], v8, s[4:7], s63 offen offset:1024 sc1
  buffer_store_dwordx4 v[116:119], v231, s[4:7], s58 offen sc1
  s_add_u32 s58, s58, 16384
  v_exp_f32 v246, v246
  v_mfma_f32_16x16x32_bf16 v[192:195], a[68:71], a[112:115], v[192:195]
  buffer_load_dwordx4 a[172:175], v9, s[4:7], s63 offen offset:1024 sc1
  v_exp_f32 v247, v247
  v_mfma_f32_16x16x32_bf16 v[196:199], a[68:71], a[116:119], v[196:199]
  ds_read_b64_tr_b16 a[80:81], v230 offset:32768
  ds_read_b64_tr_b16 a[82:83], v230 offset:36864
  v_mfma_f32_16x16x32_bf16 v[196:199], a[64:67], a[100:103], v[196:199]
  v_exp_f32 v248, v248
  v_exp_f32 v249, v249
  v_rcp_f32 v245, v245
  v_pk_fma_f32 v[246:247], v[246:247], v[234:235], v[234:235] op_sel:[0,1,1] op_sel_hi:[1,1,1]
  v_pk_fma_f32 v[248:249], v[248:249], v[234:235], v[234:235] op_sel:[0,1,1] op_sel_hi:[1,1,1]
  v_pk_mul_f32 v[136:137], v[136:137], v[242:243]
  v_pk_mul_f32 v[138:139], v[138:139], v[244:245]
  v_pk_mul_f32 v[242:243], v[160:161], v[238:239] op_sel:[0,0] op_sel_hi:[1,0]
  v_pk_mul_f32 v[244:245], v[162:163], v[238:239] op_sel:[0,0] op_sel_hi:[1,0]
  v_pk_mul_f32 v[160:161], v[160:161], v[176:177]
  v_pk_mul_f32 v[162:163], v[162:163], v[178:179]
  v_rcp_f32 v246, v246
  v_mfma_f32_16x16x32_bf16 v[200:203], a[64:67], a[104:107], v[200:203]
  buffer_load_dwordx4 a[176:179], v8, s[4:7], s63 offen offset:2048 sc1
  v_rcp_f32 v247, v247
  v_mfma_f32_16x16x32_bf16 v[200:203], a[68:71], a[120:123], v[200:203]
  buffer_load_dwordx4 a[180:183], v9, s[4:7], s63 offen offset:2048 sc1
  v_rcp_f32 v248, v248
  v_mfma_f32_16x16x32_bf16 v[204:207], a[68:71], a[124:127], v[204:207]
  ds_read_b64_tr_b16 a[84:85], v230 offset:40960
  v_cvt_pk_bf16_f32 v122, v136, v137
  v_mfma_f32_16x16x32_bf16 v[204:207], a[64:67], a[108:111], v[204:207]
  s_waitcnt lgkmcnt(3)
  ds_read_b64_tr_b16 a[86:87], v230 offset:45056
  v_cvt_pk_bf16_f32 v123, v138, v139
  v_mfma_f32_16x16x32_bf16 v[220:223], a[72:75], a[108:111], v[220:223]
  buffer_load_dwordx4 a[184:187], v8, s[4:7], s63 offen offset:3072 sc1
  buffer_store_dwordx4 v[120:123], v231, s[4:7], s59 offen sc1
  s_add_u32 s59, s59, 16384
  v_exp_f32 v242, v242
  v_mfma_f32_16x16x32_bf16 v[220:223], a[76:79], a[124:127], v[220:223]
  buffer_load_dwordx4 a[188:191], v9, s[4:7], s63 offen offset:3072 sc1
  v_exp_f32 v243, v243
  v_mfma_f32_16x16x32_bf16 v[216:219], a[76:79], a[120:123], v[216:219]
  ds_read_b64_tr_b16 a[88:89], v230 offset:49152
  ds_read_b64_tr_b16 a[90:91], v230 offset:53248
  v_mfma_f32_16x16x32_bf16 v[216:219], a[72:75], a[104:107], v[216:219]
  v_exp_f32 v244, v244
  v_exp_f32 v245, v245
  v_rcp_f32 v249, v249
  v_pk_fma_f32 v[242:243], v[242:243], v[232:233], v[232:233] op_sel:[0,0,0] op_sel_hi:[1,0,0]
  v_pk_fma_f32 v[244:245], v[244:245], v[232:233], v[232:233] op_sel:[0,0,0] op_sel_hi:[1,0,0]
  v_pk_mul_f32 v[140:141], v[140:141], v[246:247]
  v_pk_mul_f32 v[142:143], v[142:143], v[248:249]
  v_pk_mul_f32 v[246:247], v[164:165], v[238:239] op_sel:[0,1] op_sel_hi:[1,1]
  v_pk_mul_f32 v[248:249], v[166:167], v[238:239] op_sel:[0,1] op_sel_hi:[1,1]
  v_pk_mul_f32 v[164:165], v[164:165], v[180:181]
  v_pk_mul_f32 v[166:167], v[166:167], v[182:183]
  v_rcp_f32 v242, v242
  v_mfma_f32_16x16x32_bf16 v[212:215], a[72:75], a[100:103], v[212:215]
  v_rcp_f32 v243, v243
  v_mfma_f32_16x16x32_bf16 v[212:215], a[76:79], a[116:119], v[212:215]
  v_rcp_f32 v244, v244
  v_mfma_f32_16x16x32_bf16 v[208:211], a[76:79], a[112:115], v[208:211]
  ds_read_b64_tr_b16 a[92:93], v230 offset:57344
  v_cvt_pk_bf16_f32 v126, v140, v141
  v_mfma_f32_16x16x32_bf16 v[208:211], a[72:75], a[96:99], v[208:211]
  s_waitcnt lgkmcnt(3)
  ds_read_b64_tr_b16 a[94:95], v230 offset:61440
  v_cvt_pk_bf16_f32 v127, v142, v143
  v_mfma_f32_16x16x32_bf16 v[192:195], a[80:83], a[0:3], v[192:195]
  buffer_store_dwordx4 v[124:127], v231, s[4:7], s60 offen sc1
  s_add_u32 s60, s60, 16384
  v_mfma_f32_16x16x32_bf16 v[192:195], a[84:87], a[16:19], v[192:195]
  v_exp_f32 v246, v246
  v_mfma_f32_16x16x32_bf16 v[196:199], a[84:87], a[20:23], v[196:199]
  v_exp_f32 v247, v247
  v_mfma_f32_16x16x32_bf16 v[196:199], a[80:83], a[4:7], v[196:199]
  v_exp_f32 v248, v248
  v_exp_f32 v249, v249
  v_rcp_f32 v245, v245
  v_pk_fma_f32 v[246:247], v[246:247], v[232:233], v[232:233] op_sel:[0,1,1] op_sel_hi:[1,1,1]
  v_pk_fma_f32 v[248:249], v[248:249], v[232:233], v[232:233] op_sel:[0,1,1] op_sel_hi:[1,1,1]
  v_pk_mul_f32 v[160:161], v[160:161], v[242:243]
  v_pk_mul_f32 v[162:163], v[162:163], v[244:245]
  v_pk_mul_f32 v[242:243], v[168:169], v[240:241] op_sel:[0,0] op_sel_hi:[1,0]
  v_pk_mul_f32 v[244:245], v[170:171], v[240:241] op_sel:[0,0] op_sel_hi:[1,0]
  v_pk_mul_f32 v[168:169], v[168:169], v[184:185]
  v_pk_mul_f32 v[170:171], v[170:171], v[186:187]
  v_rcp_f32 v246, v246
  v_mfma_f32_16x16x32_bf16 v[200:203], a[80:83], a[8:11], v[200:203]
  s_barrier
  v_rcp_f32 v247, v247
  v_mfma_f32_16x16x32_bf16 v[200:203], a[84:87], a[24:27], v[200:203]
  s_add_u32 m0, s79, 65536
  v_rcp_f32 v248, v248
  v_mfma_f32_16x16x32_bf16 v[204:207], a[84:87], a[28:31], v[204:207]
  s_add_u32 s92, s92, -3407872
  s_sub_u32 s92, s92, s78
  s_add_u32 s93, s92, s88
  v_cvt_pk_bf16_f32 v176, v160, v161
  v_mfma_f32_16x16x32_bf16 v[204:207], a[80:83], a[12:15], v[204:207]
  v_cvt_pk_bf16_f32 v177, v162, v163
  s_waitcnt lgkmcnt(0)
  v_mfma_f32_16x16x32_bf16 v[220:223], a[88:91], a[12:15], v[220:223]
  buffer_load_dwordx4 v252, s[80:83], s93 offen lds
  v_mfma_f32_16x16x32_bf16 v[220:223], a[92:95], a[28:31], v[220:223]
  buffer_load_dwordx4 v252, s[84:87], s93 offen offset:1024 lds
  v_exp_f32 v242, v242
  v_mfma_f32_16x16x32_bf16 v[216:219], a[92:95], a[24:27], v[216:219]
  v_exp_f32 v243, v243
  v_mfma_f32_16x16x32_bf16 v[216:219], a[88:91], a[8:11], v[216:219]
  v_exp_f32 v244, v244
  v_exp_f32 v245, v245
  v_rcp_f32 v249, v249
  v_pk_fma_f32 v[242:243], v[242:243], v[234:235], v[234:235] op_sel:[0,0,0] op_sel_hi:[1,0,0]
  v_pk_fma_f32 v[244:245], v[244:245], v[234:235], v[234:235] op_sel:[0,0,0] op_sel_hi:[1,0,0]
  v_pk_mul_f32 v[164:165], v[164:165], v[246:247]
  v_pk_mul_f32 v[166:167], v[166:167], v[248:249]
  v_pk_mul_f32 v[246:247], v[172:173], v[240:241] op_sel:[0,1] op_sel_hi:[1,1]
  v_pk_mul_f32 v[248:249], v[174:175], v[240:241] op_sel:[0,1] op_sel_hi:[1,1]
  v_pk_mul_f32 v[172:173], v[172:173], v[188:189]
  v_pk_mul_f32 v[174:175], v[174:175], v[190:191]
  v_mfma_f32_16x16x32_bf16 v[212:215], a[88:91], a[4:7], v[212:215]
  v_rcp_f32 v242, v242
  v_mfma_f32_16x16x32_bf16 v[212:215], a[92:95], a[20:23], v[212:215]
  v_mfma_f32_16x16x32_bf16 v[208:211], a[92:95], a[16:19], v[208:211]
  v_mfma_f32_16x16x32_bf16 v[208:211], a[88:91], a[0:3], v[208:211]
  ds_read_b64_tr_b16 a[0:1], v0 offset:0
  ds_read_b64_tr_b16 a[2:3], v0 offset:4096
  ds_read_b64_tr_b16 a[16:17], v0 offset:8192
  ds_read_b64_tr_b16 a[18:19], v0 offset:12288
  ds_read_b64_tr_b16 a[4:5], v1 offset:0
  ds_read_b64_tr_b16 a[6:7], v1 offset:4096
  ds_read_b64_tr_b16 a[20:21], v1 offset:8192
  ds_read_b64_tr_b16 a[22:23], v1 offset:12288
  ds_read_b64_tr_b16 a[8:9], v2 offset:0
  ds_read_b64_tr_b16 a[10:11], v2 offset:4096
  ds_read_b64_tr_b16 a[24:25], v2 offset:8192
  ds_read_b64_tr_b16 a[26:27], v2 offset:12288
  ds_read_b64_tr_b16 a[12:13], v3 offset:0
  ds_read_b64_tr_b16 a[14:15], v3 offset:4096
  ds_read_b64_tr_b16 a[28:29], v3 offset:8192
  ds_read_b64_tr_b16 a[30:31], v3 offset:12288
  buffer_load_dword v10, v251, s[4:7], s64 offen sc1
  s_add_u32 m0, s79, 73728
  s_add_u32 s92, s92, 262144
  s_add_u32 s93, s92, s88
  v_rcp_f32 v243, v243
  v_rcp_f32 v244, v244
  v_cvt_pk_bf16_f32 v180, v164, v165
  v_cvt_pk_bf16_f32 v181, v166, v167
  buffer_load_dwordx4 v252, s[80:83], s93 offen lds
  buffer_load_dwordx4 v252, s[84:87], s93 offen offset:1024 lds
  v_exp_f32 v246, v246
  v_exp_f32 v247, v247
  v_exp_f32 v248, v248
  v_exp_f32 v249, v249
  v_rcp_f32 v245, v245
  v_pk_fma_f32 v[246:247], v[246:247], v[234:235], v[234:235] op_sel:[0,1,1] op_sel_hi:[1,1,1]
  v_pk_fma_f32 v[248:249], v[248:249], v[234:235], v[234:235] op_sel:[0,1,1] op_sel_hi:[1,1,1]
  v_pk_mul_f32 v[168:169], v[168:169], v[242:243]
  v_pk_mul_f32 v[170:171], v[170:171], v[244:245]
  v_pk_mul_f32 v[242:243], v[192:193], v[238:239] op_sel:[0,0] op_sel_hi:[1,0]
  v_pk_mul_f32 v[244:245], v[194:195], v[238:239] op_sel:[0,0] op_sel_hi:[1,0]
  v_pk_mul_f32 v[192:193], v[192:193], v[208:209]
  v_pk_mul_f32 v[194:195], v[194:195], v[210:211]
  v_rcp_f32 v246, v246
  s_add_u32 m0, s79, 81920
  s_add_u32 s92, s92, 196608
  s_add_u32 s93, s92, s88
  v_rcp_f32 v247, v247
  v_rcp_f32 v248, v248
  v_cvt_pk_bf16_f32 v184, v168, v169
  v_cvt_pk_bf16_f32 v185, v170, v171
  buffer_load_dwordx4 v252, s[80:83], s93 offen lds
  buffer_load_dwordx4 v252, s[84:87], s93 offen offset:1024 lds
  v_exp_f32 v242, v242
  v_exp_f32 v243, v243
  v_exp_f32 v244, v244
  v_exp_f32 v245, v245
  v_rcp_f32 v249, v249
  v_pk_fma_f32 v[242:243], v[242:243], v[232:233], v[232:233] op_sel:[0,0,0] op_sel_hi:[1,0,0]
  v_pk_fma_f32 v[244:245], v[244:245], v[232:233], v[232:233] op_sel:[0,0,0] op_sel_hi:[1,0,0]
  v_pk_mul_f32 v[172:173], v[172:173], v[246:247]
  v_pk_mul_f32 v[174:175], v[174:175], v[248:249]
  v_pk_mul_f32 v[246:247], v[196:197], v[238:239] op_sel:[0,1] op_sel_hi:[1,1]
  v_pk_mul_f32 v[248:249], v[198:199], v[238:239] op_sel:[0,1] op_sel_hi:[1,1]
  v_pk_mul_f32 v[196:197], v[196:197], v[212:213]
  v_pk_mul_f32 v[198:199], v[198:199], v[214:215]
  v_rcp_f32 v242, v242
  s_add_u32 m0, s79, 90112
  s_add_u32 s92, s92, 262144
  s_add_u32 s93, s92, s88
  v_rcp_f32 v243, v243
  v_rcp_f32 v244, v244
  v_cvt_pk_bf16_f32 v188, v172, v173
  v_cvt_pk_bf16_f32 v189, v174, v175
  buffer_load_dwordx4 v252, s[80:83], s93 offen lds
  buffer_load_dwordx4 v252, s[84:87], s93 offen offset:1024 lds
  v_exp_f32 v246, v246
  v_exp_f32 v247, v247
  v_exp_f32 v248, v248
  v_exp_f32 v249, v249
  v_rcp_f32 v245, v245
  v_pk_fma_f32 v[246:247], v[246:247], v[232:233], v[232:233] op_sel:[0,1,1] op_sel_hi:[1,1,1]
  v_pk_fma_f32 v[248:249], v[248:249], v[232:233], v[232:233] op_sel:[0,1,1] op_sel_hi:[1,1,1]
  v_pk_mul_f32 v[192:193], v[192:193], v[242:243]
  v_pk_mul_f32 v[194:195], v[194:195], v[244:245]
  v_pk_mul_f32 v[242:243], v[200:201], v[240:241] op_sel:[0,0] op_sel_hi:[1,0]
  v_pk_mul_f32 v[244:245], v[202:203], v[240:241] op_sel:[0,0] op_sel_hi:[1,0]
  v_pk_mul_f32 v[200:201], v[200:201], v[216:217]
  v_pk_mul_f32 v[202:203], v[202:203], v[218:219]
  v_rcp_f32 v246, v246
  v_rcp_f32 v247, v247
  v_rcp_f32 v248, v248
  v_cvt_pk_bf16_f32 v178, v192, v193
  v_cvt_pk_bf16_f32 v179, v194, v195
  buffer_store_dwordx4 v[176:179], v231, s[4:7], s57 offen sc1
  s_add_u32 s57, s57, 16384
  v_exp_f32 v242, v242
  v_exp_f32 v243, v243
  v_exp_f32 v244, v244
  v_exp_f32 v245, v245
  v_rcp_f32 v249, v249
  v_pk_fma_f32 v[242:243], v[242:243], v[234:235], v[234:235] op_sel:[0,0,0] op_sel_hi:[1,0,0]
  v_pk_fma_f32 v[244:245], v[244:245], v[234:235], v[234:235] op_sel:[0,0,0] op_sel_hi:[1,0,0]
  v_pk_mul_f32 v[196:197], v[196:197], v[246:247]
  v_pk_mul_f32 v[198:199], v[198:199], v[248:249]
  v_pk_mul_f32 v[246:247], v[204:205], v[240:241] op_sel:[0,1] op_sel_hi:[1,1]
  v_pk_mul_f32 v[248:249], v[206:207], v[240:241] op_sel:[0,1] op_sel_hi:[1,1]
  v_pk_mul_f32 v[204:205], v[204:205], v[220:221]
  v_pk_mul_f32 v[206:207], v[206:207], v[222:223]
  v_rcp_f32 v242, v242
  v_rcp_f32 v243, v243
  v_rcp_f32 v244, v244
  v_cvt_pk_bf16_f32 v182, v196, v197
  v_cvt_pk_bf16_f32 v183, v198, v199
  buffer_store_dwordx4 v[180:183], v231, s[4:7], s58 offen sc1
  s_add_u32 s58, s58, 16384
  v_exp_f32 v246, v246
  v_exp_f32 v247, v247
  v_exp_f32 v248, v248
  v_exp_f32 v249, v249
  v_rcp_f32 v245, v245
  v_pk_fma_f32 v[246:247], v[246:247], v[234:235], v[234:235] op_sel:[0,1,1] op_sel_hi:[1,1,1]
  v_pk_fma_f32 v[248:249], v[248:249], v[234:235], v[234:235] op_sel:[0,1,1] op_sel_hi:[1,1,1]
  v_pk_mul_f32 v[200:201], v[200:201], v[242:243]
  v_pk_mul_f32 v[202:203], v[202:203], v[244:245]
  v_rcp_f32 v246, v246
  v_rcp_f32 v247, v247
  v_rcp_f32 v248, v248
  v_cvt_pk_bf16_f32 v186, v200, v201
  v_cvt_pk_bf16_f32 v187, v202, v203
  buffer_store_dwordx4 v[184:187], v231, s[4:7], s59 offen sc1
  s_add_u32 s59, s59, 16384
  v_rcp_f32 v249, v249
  s_nop 0
  v_pk_mul_f32 v[204:205], v[204:205], v[246:247]
  v_pk_mul_f32 v[206:207], v[206:207], v[248:249]
  v_cvt_pk_bf16_f32 v190, v204, v205
  v_cvt_pk_bf16_f32 v191, v206, v207
  buffer_store_dwordx4 v[188:191], v231, s[4:7], s60 offen sc1
  s_add_u32 s60, s60, 16384
  v_pk_mul_f32 v[32:33], v[250:251], 0 op_sel:[1,0] op_sel_hi:[1,0]
  v_pk_mul_f32 v[34:35], v[250:251], 0 op_sel:[1,0] op_sel_hi:[1,0]
  v_pk_mul_f32 v[36:37], v[250:251], 0 op_sel:[1,0] op_sel_hi:[1,0]
  v_pk_mul_f32 v[38:39], v[250:251], 0 op_sel:[1,0] op_sel_hi:[1,0]
  v_pk_mul_f32 v[40:41], v[250:251], 0 op_sel:[1,0] op_sel_hi:[1,0]
  v_pk_mul_f32 v[42:43], v[250:251], 0 op_sel:[1,0] op_sel_hi:[1,0]
  v_pk_mul_f32 v[44:45], v[250:251], 0 op_sel:[1,0] op_sel_hi:[1,0]
  v_pk_mul_f32 v[46:47], v[250:251], 0 op_sel:[1,0] op_sel_hi:[1,0]
  v_pk_mul_f32 v[48:49], v[250:251], 0 op_sel:[1,0] op_sel_hi:[1,0]
  v_pk_mul_f32 v[50:51], v[250:251], 0 op_sel:[1,0] op_sel_hi:[1,0]
  v_pk_mul_f32 v[52:53], v[250:251], 0 op_sel:[1,0] op_sel_hi:[1,0]
  v_pk_mul_f32 v[54:55], v[250:251], 0 op_sel:[1,0] op_sel_hi:[1,0]
  v_pk_mul_f32 v[56:57], v[250:251], 0 op_sel:[1,0] op_sel_hi:[1,0]
  v_pk_mul_f32 v[58:59], v[250:251], 0 op_sel:[1,0] op_sel_hi:[1,0]
  v_pk_mul_f32 v[60:61], v[250:251], 0 op_sel:[1,0] op_sel_hi:[1,0]
  v_pk_mul_f32 v[62:63], v[250:251], 0 op_sel:[1,0] op_sel_hi:[1,0]
  v_lshlrev_b32 v64, 16, v16
  v_and_b32 v65, 0xffff0000, v16
  v_lshlrev_b32 v66, 16, v17
  v_and_b32 v67, 0xffff0000, v17
  v_lshlrev_b32 v72, 16, v18
  v_and_b32 v73, 0xffff0000, v18
  v_lshlrev_b32 v74, 16, v19
  v_and_b32 v75, 0xffff0000, v19
  v_lshlrev_b32 v80, 16, v20
  v_and_b32 v81, 0xffff0000, v20
  v_lshlrev_b32 v82, 16, v21
  v_and_b32 v83, 0xffff0000, v21
  v_lshlrev_b32 v88, 16, v22
  v_and_b32 v89, 0xffff0000, v22
  v_lshlrev_b32 v90, 16, v23
  v_and_b32 v91, 0xffff0000, v23
  v_lshlrev_b32 v68, 16, v24
  v_and_b32 v69, 0xffff0000, v24
  v_lshlrev_b32 v70, 16, v25
  v_and_b32 v71, 0xffff0000, v25
  v_lshlrev_b32 v76, 16, v26
  v_and_b32 v77, 0xffff0000, v26
  v_lshlrev_b32 v78, 16, v27
  v_and_b32 v79, 0xffff0000, v27
  v_lshlrev_b32 v84, 16, v28
  v_and_b32 v85, 0xffff0000, v28
  v_lshlrev_b32 v86, 16, v29
  v_and_b32 v87, 0xffff0000, v29
  v_lshlrev_b32 v92, 16, v30
  v_and_b32 v93, 0xffff0000, v30
  v_lshlrev_b32 v94, 16, v31
  v_and_b32 v95, 0xffff0000, v31
  s_mov_b32 s56, 2
.p2align 3
Lp4_loop:
  s_waitcnt vmcnt(25) lgkmcnt(8)
  v_mfma_f32_16x16x32_bf16 v[32:35], a[0:3], a[128:131], v[32:35]
  s_waitcnt vmcnt(27)
  s_barrier
  ds_read_b64_tr_b16 a[32:33], v0 offset:1024
  s_waitcnt vmcnt(10)
  v_cmp_gt_u32 vcc, 16, v10
  s_cbranch_vccnz Lp4b_c
Lp4b_r:
  s_add_u32 s64, s64, 4096
  v_mfma_f32_16x16x32_bf16 v[32:35], a[16:19], a[136:139], v[32:35]
  s_add_u32 m0, s79, 98304
  ds_read_b64_tr_b16 a[34:35], v0 offset:5120
  s_add_u32 s92, s92, 196608
  v_mfma_f32_16x16x32_bf16 v[36:39], a[16:19], a[140:143], v[36:39]
  s_add_u32 s93, s92, s88
  buffer_load_dwordx4 v252, s[80:83], s93 offen lds
  v_mfma_f32_16x16x32_bf16 v[36:39], a[0:3], a[132:135], v[36:39]
  ds_read_b64_tr_b16 a[48:49], v0 offset:9216
  ds_read_b64_tr_b16 a[50:51], v0 offset:13312
  v_mfma_f32_16x16x32_bf16 v[44:47], a[4:7], a[132:135], v[44:47]
  ds_read_b64_tr_b16 a[36:37], v1 offset:1024
  v_mfma_f32_16x16x32_bf16 v[44:47], a[20:23], a[140:143], v[44:47]
  ds_read_b64_tr_b16 a[38:39], v1 offset:5120
  v_mfma_f32_16x16x32_bf16 v[40:43], a[20:23], a[136:139], v[40:43]
  buffer_load_dwordx4 v252, s[84:87], s93 offen offset:1024 lds
  v_mfma_f32_16x16x32_bf16 v[40:43], a[4:7], a[128:131], v[40:43]
  s_waitcnt lgkmcnt(6)
  ds_read_b64_tr_b16 a[52:53], v1 offset:9216
  ds_read_b64_tr_b16 a[54:55], v1 offset:13312
  v_mfma_f32_16x16x32_bf16 v[48:51], a[8:11], a[128:131], v[48:51]
  ds_read_b64_tr_b16 a[40:41], v2 offset:1024
  v_mfma_f32_16x16x32_bf16 v[48:51], a[24:27], a[136:139], v[48:51]
  s_add_u32 s48, s48, 4096
  ds_read_b64_tr_b16 a[42:43], v2 offset:5120
  s_min_u32 s63, s88, 8192
  v_mfma_f32_16x16x32_bf16 v[52:55], a[24:27], a[140:143], v[52:55]
  s_add_u32 s63, s48, s63
  buffer_load_dwordx4 a[192:195], v8, s[4:7], s63 offen offset:0 sc1
  v_mfma_f32_16x16x32_bf16 v[52:55], a[8:11], a[132:135], v[52:55]
  ds_read_b64_tr_b16 a[56:57], v2 offset:9216
  ds_read_b64_tr_b16 a[58:59], v2 offset:13312
  v_mfma_f32_16x16x32_bf16 v[60:63], a[12:15], a[132:135], v[60:63]
  ds_read_b64_tr_b16 a[44:45], v3 offset:1024
  v_mfma_f32_16x16x32_bf16 v[60:63], a[28:31], a[140:143], v[60:63]
  ds_read_b64_tr_b16 a[46:47], v3 offset:5120
  v_mfma_f32_16x16x32_bf16 v[56:59], a[28:31], a[136:139], v[56:59]
  buffer_load_dwordx4 a[196:199], v9, s[4:7], s63 offen offset:0 sc1
  v_mfma_f32_16x16x32_bf16 v[56:59], a[12:15], a[128:131], v[56:59]
  s_waitcnt lgkmcnt(6)
  ds_read_b64_tr_b16 a[60:61], v3 offset:9216
  ds_read_b64_tr_b16 a[62:63], v3 offset:13312
  v_mfma_f32_16x16x32_bf16 v[64:67], a[32:35], a[128:131], v[64:67]
  ds_read_b64_tr_b16 a[0:1], v0 offset:16384
  s_add_u32 m0, s79, 106496
  v_mfma_f32_16x16x32_bf16 v[64:67], a[48:51], a[136:139], v[64:67]
  s_add_u32 s92, s92, 262144
  ds_read_b64_tr_b16 a[2:3], v0 offset:20480
  s_add_u32 s93, s92, s88
  v_mfma_f32_16x16x32_bf16 v[68:71], a[48:51], a[140:143], v[68:71]
  buffer_load_dwordx4 v252, s[80:83], s93 offen lds
  v_mfma_f32_16x16x32_bf16 v[68:71], a[32:35], a[132:135], v[68:71]
  ds_read_b64_tr_b16 a[16:17], v0 offset:24576
  ds_read_b64_tr_b16 a[18:19], v0 offset:28672
  v_mfma_f32_16x16x32_bf16 v[76:79], a[36:39], a[132:135], v[76:79]
  ds_read_b64_tr_b16 a[4:5], v1 offset:16384
  v_mfma_f32_16x16x32_bf16 v[76:79], a[52:55], a[140:143], v[76:79]
  ds_read_b64_tr_b16 a[6:7], v1 offset:20480
  v_mfma_f32_16x16x32_bf16 v[72:75], a[52:55], a[136:139], v[72:75]
  buffer_load_dwordx4 v252, s[84:87], s93 offen offset:1024 lds
  v_mfma_f32_16x16x32_bf16 v[72:75], a[36:39], a[128:131], v[72:75]
  s_waitcnt lgkmcnt(6)
  ds_read_b64_tr_b16 a[20:21], v1 offset:24576
  ds_read_b64_tr_b16 a[22:23], v1 offset:28672
  v_mfma_f32_16x16x32_bf16 v[80:83], a[40:43], a[128:131], v[80:83]
  ds_read_b64_tr_b16 a[8:9], v2 offset:16384
  v_mfma_f32_16x16x32_bf16 v[80:83], a[56:59], a[136:139], v[80:83]
  ds_read_b64_tr_b16 a[10:11], v2 offset:20480
  v_mfma_f32_16x16x32_bf16 v[84:87], a[56:59], a[140:143], v[84:87]
  buffer_load_dwordx4 a[200:203], v8, s[4:7], s63 offen offset:1024 sc1
  v_mfma_f32_16x16x32_bf16 v[84:87], a[40:43], a[132:135], v[84:87]
  ds_read_b64_tr_b16 a[24:25], v2 offset:24576
  ds_read_b64_tr_b16 a[26:27], v2 offset:28672
  v_mfma_f32_16x16x32_bf16 v[92:95], a[44:47], a[132:135], v[92:95]
  ds_read_b64_tr_b16 a[12:13], v3 offset:16384
  v_mfma_f32_16x16x32_bf16 v[92:95], a[60:63], a[140:143], v[92:95]
  ds_read_b64_tr_b16 a[14:15], v3 offset:20480
  v_mfma_f32_16x16x32_bf16 v[88:91], a[60:63], a[136:139], v[88:91]
  buffer_load_dwordx4 a[204:207], v9, s[4:7], s63 offen offset:1024 sc1
  v_mfma_f32_16x16x32_bf16 v[88:91], a[44:47], a[128:131], v[88:91]
  s_waitcnt vmcnt(25) lgkmcnt(6)
  ds_read_b64_tr_b16 a[28:29], v3 offset:24576
  ds_read_b64_tr_b16 a[30:31], v3 offset:28672
  v_mfma_f32_16x16x32_bf16 v[32:35], a[0:3], a[144:147], v[32:35]
  ds_read_b64_tr_b16 a[32:33], v0 offset:17408
  s_add_u32 m0, s79, 114688
  v_mfma_f32_16x16x32_bf16 v[32:35], a[16:19], a[152:155], v[32:35]
  s_add_u32 s92, s92, 196608
  ds_read_b64_tr_b16 a[34:35], v0 offset:21504
  s_add_u32 s93, s92, s88
  v_mfma_f32_16x16x32_bf16 v[36:39], a[16:19], a[156:159], v[36:39]
  buffer_load_dwordx4 v252, s[80:83], s93 offen lds
  v_mfma_f32_16x16x32_bf16 v[36:39], a[0:3], a[148:151], v[36:39]
  ds_read_b64_tr_b16 a[48:49], v0 offset:25600
  ds_read_b64_tr_b16 a[50:51], v0 offset:29696
  v_mfma_f32_16x16x32_bf16 v[44:47], a[4:7], a[148:151], v[44:47]
  ds_read_b64_tr_b16 a[36:37], v1 offset:17408
  v_mfma_f32_16x16x32_bf16 v[44:47], a[20:23], a[156:159], v[44:47]
  ds_read_b64_tr_b16 a[38:39], v1 offset:21504
  v_mfma_f32_16x16x32_bf16 v[40:43], a[20:23], a[152:155], v[40:43]
  buffer_load_dwordx4 v252, s[84:87], s93 offen offset:1024 lds
  v_mfma_f32_16x16x32_bf16 v[40:43], a[4:7], a[144:147], v[40:43]
  s_waitcnt lgkmcnt(6)
  ds_read_b64_tr_b16 a[52:53], v1 offset:25600
  ds_read_b64_tr_b16 a[54:55], v1 offset:29696
  v_mfma_f32_16x16x32_bf16 v[48:51], a[8:11], a[144:147], v[48:51]
  ds_read_b64_tr_b16 a[40:41], v2 offset:17408
  v_mfma_f32_16x16x32_bf16 v[48:51], a[24:27], a[152:155], v[48:51]
  ds_read_b64_tr_b16 a[42:43], v2 offset:21504
  v_mfma_f32_16x16x32_bf16 v[52:55], a[24:27], a[156:159], v[52:55]
  buffer_load_dwordx4 a[208:211], v8, s[4:7], s63 offen offset:2048 sc1
  v_mfma_f32_16x16x32_bf16 v[52:55], a[8:11], a[148:151], v[52:55]
  ds_read_b64_tr_b16 a[56:57], v2 offset:25600
  ds_read_b64_tr_b16 a[58:59], v2 offset:29696
  v_mfma_f32_16x16x32_bf16 v[60:63], a[12:15], a[148:151], v[60:63]
  ds_read_b64_tr_b16 a[44:45], v3 offset:17408
  v_mfma_f32_16x16x32_bf16 v[60:63], a[28:31], a[156:159], v[60:63]
  ds_read_b64_tr_b16 a[46:47], v3 offset:21504
  v_mfma_f32_16x16x32_bf16 v[56:59], a[28:31], a[152:155], v[56:59]
  buffer_load_dwordx4 a[212:215], v9, s[4:7], s63 offen offset:2048 sc1
  v_mfma_f32_16x16x32_bf16 v[56:59], a[12:15], a[144:147], v[56:59]
  s_waitcnt lgkmcnt(6)
  ds_read_b64_tr_b16 a[60:61], v3 offset:25600
  ds_read_b64_tr_b16 a[62:63], v3 offset:29696
  v_mfma_f32_16x16x32_bf16 v[64:67], a[32:35], a[144:147], v[64:67]
  ds_read_b64_tr_b16 a[0:1], v0 offset:32768
  s_add_u32 m0, s79, 122880
  v_mfma_f32_16x16x32_bf16 v[64:67], a[48:51], a[152:155], v[64:67]
  s_add_u32 s92, s92, 262144
  ds_read_b64_tr_b16 a[2:3], v0 offset:36864
  s_add_u32 s93, s92, s88
  v_mfma_f32_16x16x32_bf16 v[68:71], a[48:51], a[156:159], v[68:71]
  buffer_load_dwordx4 v252, s[80:83], s93 offen lds
  v_mfma_f32_16x16x32_bf16 v[68:71], a[32:35], a[148:151], v[68:71]
  ds_read_b64_tr_b16 a[16:17], v0 offset:40960
  ds_read_b64_tr_b16 a[18:19], v0 offset:45056
  v_mfma_f32_16x16x32_bf16 v[76:79], a[36:39], a[148:151], v[76:79]
  ds_read_b64_tr_b16 a[4:5], v1 offset:32768
  v_mfma_f32_16x16x32_bf16 v[76:79], a[52:55], a[156:159], v[76:79]
  ds_read_b64_tr_b16 a[6:7], v1 offset:36864
  v_mfma_f32_16x16x32_bf16 v[72:75], a[52:55], a[152:155], v[72:75]
  buffer_load_dwordx4 v252, s[84:87], s93 offen offset:1024 lds
  v_mfma_f32_16x16x32_bf16 v[72:75], a[36:39], a[144:147], v[72:75]
  s_waitcnt lgkmcnt(6)
  ds_read_b64_tr_b16 a[20:21], v1 offset:40960
  ds_read_b64_tr_b16 a[22:23], v1 offset:45056
  v_mfma_f32_16x16x32_bf16 v[80:83], a[40:43], a[144:147], v[80:83]
  ds_read_b64_tr_b16 a[8:9], v2 offset:32768
  v_mfma_f32_16x16x32_bf16 v[80:83], a[56:59], a[152:155], v[80:83]
  ds_read_b64_tr_b16 a[10:11], v2 offset:36864
  v_mfma_f32_16x16x32_bf16 v[84:87], a[56:59], a[156:159], v[84:87]
  buffer_load_dwordx4 a[216:219], v8, s[4:7], s63 offen offset:3072 sc1
  v_mfma_f32_16x16x32_bf16 v[84:87], a[40:43], a[148:151], v[84:87]
  ds_read_b64_tr_b16 a[24:25], v2 offset:40960
  ds_read_b64_tr_b16 a[26:27], v2 offset:45056
  v_mfma_f32_16x16x32_bf16 v[92:95], a[44:47], a[148:151], v[92:95]
  ds_read_b64_tr_b16 a[12:13], v3 offset:32768
  v_mfma_f32_16x16x32_bf16 v[92:95], a[60:63], a[156:159], v[92:95]
  ds_read_b64_tr_b16 a[14:15], v3 offset:36864
  v_mfma_f32_16x16x32_bf16 v[88:91], a[60:63], a[152:155], v[88:91]
  buffer_load_dwordx4 a[220:223], v9, s[4:7], s63 offen offset:3072 sc1
  v_mfma_f32_16x16x32_bf16 v[88:91], a[44:47], a[144:147], v[88:91]
  s_waitcnt vmcnt(24) lgkmcnt(6)
  ds_read_b64_tr_b16 a[28:29], v3 offset:40960
  ds_read_b64_tr_b16 a[30:31], v3 offset:45056
  v_mfma_f32_16x16x32_bf16 v[32:35], a[0:3], a[160:163], v[32:35]
  s_waitcnt vmcnt(24)
  s_barrier
  ds_read_b64_tr_b16 a[32:33], v0 offset:33792
  v_mfma_f32_16x16x32_bf16 v[32:35], a[16:19], a[168:171], v[32:35]
  s_add_u32 m0, s79, 0
  ds_read_b64_tr_b16 a[34:35], v0 offset:37888
  s_add_u32 s92, s92, 196608
  v_mfma_f32_16x16x32_bf16 v[36:39], a[16:19], a[172:175], v[36:39]
  s_sub_u32 s93, s92, s88
  buffer_load_dwordx4 v252, s[80:83], s93 offen lds
  v_mfma_f32_16x16x32_bf16 v[36:39], a[0:3], a[164:167], v[36:39]
  ds_read_b64_tr_b16 a[48:49], v0 offset:41984
  ds_read_b64_tr_b16 a[50:51], v0 offset:46080
  v_mfma_f32_16x16x32_bf16 v[44:47], a[4:7], a[164:167], v[44:47]
  ds_read_b64_tr_b16 a[36:37], v1 offset:33792
  v_mfma_f32_16x16x32_bf16 v[44:47], a[20:23], a[172:175], v[44:47]
  ds_read_b64_tr_b16 a[38:39], v1 offset:37888
  v_mfma_f32_16x16x32_bf16 v[40:43], a[20:23], a[168:171], v[40:43]
  buffer_load_dwordx4 v252, s[84:87], s93 offen offset:1024 lds
  v_mfma_f32_16x16x32_bf16 v[40:43], a[4:7], a[160:163], v[40:43]
  s_waitcnt lgkmcnt(6)
  ds_read_b64_tr_b16 a[52:53], v1 offset:41984
  ds_read_b64_tr_b16 a[54:55], v1 offset:46080
  v_mfma_f32_16x16x32_bf16 v[48:51], a[8:11], a[160:163], v[48:51]
  ds_read_b64_tr_b16 a[40:41], v2 offset:33792
  v_mfma_f32_16x16x32_bf16 v[48:51], a[24:27], a[168:171], v[48:51]
  s_add_u32 s48, s48, 4096
  ds_read_b64_tr_b16 a[42:43], v2 offset:37888
  s_min_u32 s63, s88, 8192
  v_mfma_f32_16x16x32_bf16 v[52:55], a[24:27], a[172:175], v[52:55]
  s_add_u32 s63, s48, s63
  buffer_load_dwordx4 a[224:227], v8, s[4:7], s63 offen offset:0 sc1
  v_mfma_f32_16x16x32_bf16 v[52:55], a[8:11], a[164:167], v[52:55]
  ds_read_b64_tr_b16 a[56:57], v2 offset:41984
  ds_read_b64_tr_b16 a[58:59], v2 offset:46080
  v_mfma_f32_16x16x32_bf16 v[60:63], a[12:15], a[164:167], v[60:63]
  ds_read_b64_tr_b16 a[44:45], v3 offset:33792
  v_mfma_f32_16x16x32_bf16 v[60:63], a[28:31], a[172:175], v[60:63]
  ds_read_b64_tr_b16 a[46:47], v3 offset:37888
  v_mfma_f32_16x16x32_bf16 v[56:59], a[28:31], a[168:171], v[56:59]
  buffer_load_dwordx4 a[228:231], v9, s[4:7], s63 offen offset:0 sc1
  v_mfma_f32_16x16x32_bf16 v[56:59], a[12:15], a[160:163], v[56:59]
  s_waitcnt lgkmcnt(6)
  ds_read_b64_tr_b16 a[60:61], v3 offset:41984
  ds_read_b64_tr_b16 a[62:63], v3 offset:46080
  v_mfma_f32_16x16x32_bf16 v[64:67], a[32:35], a[160:163], v[64:67]
  ds_read_b64_tr_b16 a[0:1], v0 offset:49152
  s_add_u32 m0, s79, 8192
  v_mfma_f32_16x16x32_bf16 v[64:67], a[48:51], a[168:171], v[64:67]
  s_add_u32 s92, s92, 262144
  ds_read_b64_tr_b16 a[2:3], v0 offset:53248
  s_sub_u32 s93, s92, s88
  v_mfma_f32_16x16x32_bf16 v[68:71], a[48:51], a[172:175], v[68:71]
  buffer_load_dwordx4 v252, s[80:83], s93 offen lds
  v_mfma_f32_16x16x32_bf16 v[68:71], a[32:35], a[164:167], v[68:71]
  ds_read_b64_tr_b16 a[16:17], v0 offset:57344
  ds_read_b64_tr_b16 a[18:19], v0 offset:61440
  v_mfma_f32_16x16x32_bf16 v[76:79], a[36:39], a[164:167], v[76:79]
  ds_read_b64_tr_b16 a[4:5], v1 offset:49152
  v_mfma_f32_16x16x32_bf16 v[76:79], a[52:55], a[172:175], v[76:79]
  ds_read_b64_tr_b16 a[6:7], v1 offset:53248
  v_mfma_f32_16x16x32_bf16 v[72:75], a[52:55], a[168:171], v[72:75]
  buffer_load_dwordx4 v252, s[84:87], s93 offen offset:1024 lds
  v_mfma_f32_16x16x32_bf16 v[72:75], a[36:39], a[160:163], v[72:75]
  s_waitcnt lgkmcnt(6)
  ds_read_b64_tr_b16 a[20:21], v1 offset:57344
  ds_read_b64_tr_b16 a[22:23], v1 offset:61440
  v_mfma_f32_16x16x32_bf16 v[80:83], a[40:43], a[160:163], v[80:83]
  ds_read_b64_tr_b16 a[8:9], v2 offset:49152
  v_mfma_f32_16x16x32_bf16 v[80:83], a[56:59], a[168:171], v[80:83]
  ds_read_b64_tr_b16 a[10:11], v2 offset:53248
  v_mfma_f32_16x16x32_bf16 v[84:87], a[56:59], a[172:175], v[84:87]
  buffer_load_dwordx4 a[232:235], v8, s[4:7], s63 offen offset:1024 sc1
  v_mfma_f32_16x16x32_bf16 v[84:87], a[40:43], a[164:167], v[84:87]
  ds_read_b64_tr_b16 a[24:25], v2 offset:57344
  ds_read_b64_tr_b16 a[26:27], v2 offset:61440
  v_mfma_f32_16x16x32_bf16 v[92:95], a[44:47], a[164:167], v[92:95]
  ds_read_b64_tr_b16 a[12:13], v3 offset:49152
  v_mfma_f32_16x16x32_bf16 v[92:95], a[60:63], a[172:175], v[92:95]
  ds_read_b64_tr_b16 a[14:15], v3 offset:53248
  v_mfma_f32_16x16x32_bf16 v[88:91], a[60:63], a[168:171], v[88:91]
  buffer_load_dwordx4 a[236:239], v9, s[4:7], s63 offen offset:1024 sc1
  v_mfma_f32_16x16x32_bf16 v[88:91], a[44:47], a[160:163], v[88:91]
  s_waitcnt vmcnt(24) lgkmcnt(6)
  ds_read_b64_tr_b16 a[28:29], v3 offset:57344
  ds_read_b64_tr_b16 a[30:31], v3 offset:61440
  v_mfma_f32_16x16x32_bf16 v[32:35], a[0:3], a[176:179], v[32:35]
  ds_read_b64_tr_b16 a[32:33], v0 offset:50176
  s_add_u32 m0, s79, 16384
  v_mfma_f32_16x16x32_bf16 v[32:35], a[16:19], a[184:187], v[32:35]
  s_add_u32 s92, s92, 196608
  ds_read_b64_tr_b16 a[34:35], v0 offset:54272
  s_sub_u32 s93, s92, s88
  v_mfma_f32_16x16x32_bf16 v[36:39], a[16:19], a[188:191], v[36:39]
  buffer_load_dwordx4 v252, s[80:83], s93 offen lds
  v_mfma_f32_16x16x32_bf16 v[36:39], a[0:3], a[180:183], v[36:39]
  ds_read_b64_tr_b16 a[48:49], v0 offset:58368
  ds_read_b64_tr_b16 a[50:51], v0 offset:62464
  v_mfma_f32_16x16x32_bf16 v[44:47], a[4:7], a[180:183], v[44:47]
  ds_read_b64_tr_b16 a[36:37], v1 offset:50176
  v_mfma_f32_16x16x32_bf16 v[44:47], a[20:23], a[188:191], v[44:47]
  ds_read_b64_tr_b16 a[38:39], v1 offset:54272
  v_mfma_f32_16x16x32_bf16 v[40:43], a[20:23], a[184:187], v[40:43]
  buffer_load_dwordx4 v252, s[84:87], s93 offen offset:1024 lds
  v_mfma_f32_16x16x32_bf16 v[40:43], a[4:7], a[176:179], v[40:43]
  s_waitcnt lgkmcnt(6)
  ds_read_b64_tr_b16 a[52:53], v1 offset:58368
  ds_read_b64_tr_b16 a[54:55], v1 offset:62464
  v_mfma_f32_16x16x32_bf16 v[48:51], a[8:11], a[176:179], v[48:51]
  ds_read_b64_tr_b16 a[40:41], v2 offset:50176
  v_mfma_f32_16x16x32_bf16 v[48:51], a[24:27], a[184:187], v[48:51]
  ds_read_b64_tr_b16 a[42:43], v2 offset:54272
  v_mfma_f32_16x16x32_bf16 v[52:55], a[24:27], a[188:191], v[52:55]
  buffer_load_dwordx4 a[240:243], v8, s[4:7], s63 offen offset:2048 sc1
  v_mfma_f32_16x16x32_bf16 v[52:55], a[8:11], a[180:183], v[52:55]
  ds_read_b64_tr_b16 a[56:57], v2 offset:58368
  ds_read_b64_tr_b16 a[58:59], v2 offset:62464
  v_mfma_f32_16x16x32_bf16 v[60:63], a[12:15], a[180:183], v[60:63]
  ds_read_b64_tr_b16 a[44:45], v3 offset:50176
  v_mfma_f32_16x16x32_bf16 v[60:63], a[28:31], a[188:191], v[60:63]
  ds_read_b64_tr_b16 a[46:47], v3 offset:54272
  v_mfma_f32_16x16x32_bf16 v[56:59], a[28:31], a[184:187], v[56:59]
  buffer_load_dwordx4 a[244:247], v9, s[4:7], s63 offen offset:2048 sc1
  v_mfma_f32_16x16x32_bf16 v[56:59], a[12:15], a[176:179], v[56:59]
  s_waitcnt lgkmcnt(6)
  ds_read_b64_tr_b16 a[60:61], v3 offset:58368
  ds_read_b64_tr_b16 a[62:63], v3 offset:62464
  v_mfma_f32_16x16x32_bf16 v[64:67], a[32:35], a[176:179], v[64:67]
  ds_read_b64_tr_b16 a[0:1], v4 offset:0
  s_add_u32 m0, s79, 24576
  v_mfma_f32_16x16x32_bf16 v[64:67], a[48:51], a[184:187], v[64:67]
  s_add_u32 s92, s92, 262144
  ds_read_b64_tr_b16 a[2:3], v4 offset:4096
  s_sub_u32 s93, s92, s88
  v_mfma_f32_16x16x32_bf16 v[68:71], a[48:51], a[188:191], v[68:71]
  buffer_load_dwordx4 v252, s[80:83], s93 offen lds
  v_mfma_f32_16x16x32_bf16 v[68:71], a[32:35], a[180:183], v[68:71]
  ds_read_b64_tr_b16 a[16:17], v4 offset:8192
  ds_read_b64_tr_b16 a[18:19], v4 offset:12288
  v_mfma_f32_16x16x32_bf16 v[76:79], a[36:39], a[180:183], v[76:79]
  ds_read_b64_tr_b16 a[4:5], v5 offset:0
  v_mfma_f32_16x16x32_bf16 v[76:79], a[52:55], a[188:191], v[76:79]
  ds_read_b64_tr_b16 a[6:7], v5 offset:4096
  v_mfma_f32_16x16x32_bf16 v[72:75], a[52:55], a[184:187], v[72:75]
  buffer_load_dwordx4 v252, s[84:87], s93 offen offset:1024 lds
  v_mfma_f32_16x16x32_bf16 v[72:75], a[36:39], a[176:179], v[72:75]
  s_waitcnt lgkmcnt(6)
  ds_read_b64_tr_b16 a[20:21], v5 offset:8192
  ds_read_b64_tr_b16 a[22:23], v5 offset:12288
  v_mfma_f32_16x16x32_bf16 v[80:83], a[40:43], a[176:179], v[80:83]
  ds_read_b64_tr_b16 a[8:9], v6 offset:0
  v_mfma_f32_16x16x32_bf16 v[80:83], a[56:59], a[184:187], v[80:83]
  ds_read_b64_tr_b16 a[10:11], v6 offset:4096
  v_mfma_f32_16x16x32_bf16 v[84:87], a[56:59], a[188:191], v[84:87]
  buffer_load_dwordx4 a[248:251], v8, s[4:7], s63 offen offset:3072 sc1
  v_mfma_f32_16x16x32_bf16 v[84:87], a[40:43], a[180:183], v[84:87]
  ds_read_b64_tr_b16 a[24:25], v6 offset:8192
  ds_read_b64_tr_b16 a[26:27], v6 offset:12288
  v_mfma_f32_16x16x32_bf16 v[92:95], a[44:47], a[180:183], v[92:95]
  ds_read_b64_tr_b16 a[12:13], v7 offset:0
  v_mfma_f32_16x16x32_bf16 v[92:95], a[60:63], a[188:191], v[92:95]
  ds_read_b64_tr_b16 a[14:15], v7 offset:4096
  v_mfma_f32_16x16x32_bf16 v[88:91], a[60:63], a[184:187], v[88:91]
  buffer_load_dwordx4 a[252:255], v9, s[4:7], s63 offen offset:3072 sc1
  v_mfma_f32_16x16x32_bf16 v[88:91], a[44:47], a[176:179], v[88:91]
  s_waitcnt vmcnt(24) lgkmcnt(6)
  ds_read_b64_tr_b16 a[28:29], v7 offset:8192
  ds_read_b64_tr_b16 a[30:31], v7 offset:12288
  v_mfma_f32_16x16x32_bf16 v[32:35], a[0:3], a[192:195], v[32:35]
  s_waitcnt vmcnt(26)
  s_barrier
  s_xor_b32 s43, s56, 2
  s_or_b32 s43, s43, s40
  s_cbranch_scc0 Lp3_sgl_c
Lp3_sgl_r:
  ds_read_b64_tr_b16 a[32:33], v4 offset:1024
  v_mfma_f32_16x16x32_bf16 v[32:35], a[16:19], a[200:203], v[32:35]
  s_add_u32 m0, s79, 32768
  ds_read_b64_tr_b16 a[34:35], v4 offset:5120
  s_add_u32 s92, s92, 196608
  v_mfma_f32_16x16x32_bf16 v[36:39], a[16:19], a[204:207], v[36:39]
  s_sub_u32 s93, s92, s88
  buffer_load_dwordx4 v252, s[80:83], s93 offen lds
  v_mfma_f32_16x16x32_bf16 v[36:39], a[0:3], a[196:199], v[36:39]
  ds_read_b64_tr_b16 a[48:49], v4 offset:9216
  ds_read_b64_tr_b16 a[50:51], v4 offset:13312
  v_mfma_f32_16x16x32_bf16 v[44:47], a[4:7], a[196:199], v[44:47]
  ds_read_b64_tr_b16 a[36:37], v5 offset:1024
  v_mfma_f32_16x16x32_bf16 v[44:47], a[20:23], a[204:207], v[44:47]
  ds_read_b64_tr_b16 a[38:39], v5 offset:5120
  v_mfma_f32_16x16x32_bf16 v[40:43], a[20:23], a[200:203], v[40:43]
  buffer_load_dwordx4 v252, s[84:87], s93 offen offset:1024 lds
  v_mfma_f32_16x16x32_bf16 v[40:43], a[4:7], a[192:195], v[40:43]
  s_waitcnt lgkmcnt(6)
  ds_read_b64_tr_b16 a[52:53], v5 offset:9216
  ds_read_b64_tr_b16 a[54:55], v5 offset:13312
  v_mfma_f32_16x16x32_bf16 v[48:51], a[8:11], a[192:195], v[48:51]
  ds_read_b64_tr_b16 a[40:41], v6 offset:1024
  v_mfma_f32_16x16x32_bf16 v[48:51], a[24:27], a[200:203], v[48:51]
  s_add_u32 s48, s48, 4096
  ds_read_b64_tr_b16 a[42:43], v6 offset:5120
  s_min_u32 s63, s88, 8192
  v_mfma_f32_16x16x32_bf16 v[52:55], a[24:27], a[204:207], v[52:55]
  s_sub_u32 s63, s48, s63
  buffer_load_dwordx4 a[128:131], v8, s[4:7], s63 offen offset:0 sc1
  v_mfma_f32_16x16x32_bf16 v[52:55], a[8:11], a[196:199], v[52:55]
  ds_read_b64_tr_b16 a[56:57], v6 offset:9216
  ds_read_b64_tr_b16 a[58:59], v6 offset:13312
  v_mfma_f32_16x16x32_bf16 v[60:63], a[12:15], a[196:199], v[60:63]
  ds_read_b64_tr_b16 a[44:45], v7 offset:1024
  v_mfma_f32_16x16x32_bf16 v[60:63], a[28:31], a[204:207], v[60:63]
  ds_read_b64_tr_b16 a[46:47], v7 offset:5120
  v_mfma_f32_16x16x32_bf16 v[56:59], a[28:31], a[200:203], v[56:59]
  buffer_load_dwordx4 a[132:135], v9, s[4:7], s63 offen offset:0 sc1
  v_mfma_f32_16x16x32_bf16 v[56:59], a[12:15], a[192:195], v[56:59]
  s_waitcnt lgkmcnt(6)
  ds_read_b64_tr_b16 a[60:61], v7 offset:9216
  ds_read_b64_tr_b16 a[62:63], v7 offset:13312
  v_mfma_f32_16x16x32_bf16 v[64:67], a[32:35], a[192:195], v[64:67]
  ds_read_b64_tr_b16 a[0:1], v4 offset:16384
  s_add_u32 m0, s79, 40960
  v_mfma_f32_16x16x32_bf16 v[64:67], a[48:51], a[200:203], v[64:67]
  s_add_u32 s92, s92, 262144
  ds_read_b64_tr_b16 a[2:3], v4 offset:20480
  s_sub_u32 s93, s92, s88
  v_mfma_f32_16x16x32_bf16 v[68:71], a[48:51], a[204:207], v[68:71]
  buffer_load_dwordx4 v252, s[80:83], s93 offen lds
  v_mfma_f32_16x16x32_bf16 v[68:71], a[32:35], a[196:199], v[68:71]
  ds_read_b64_tr_b16 a[16:17], v4 offset:24576
  ds_read_b64_tr_b16 a[18:19], v4 offset:28672
  v_mfma_f32_16x16x32_bf16 v[76:79], a[36:39], a[196:199], v[76:79]
  ds_read_b64_tr_b16 a[4:5], v5 offset:16384
  v_mfma_f32_16x16x32_bf16 v[76:79], a[52:55], a[204:207], v[76:79]
  ds_read_b64_tr_b16 a[6:7], v5 offset:20480
  v_mfma_f32_16x16x32_bf16 v[72:75], a[52:55], a[200:203], v[72:75]
  buffer_load_dwordx4 v252, s[84:87], s93 offen offset:1024 lds
  v_mfma_f32_16x16x32_bf16 v[72:75], a[36:39], a[192:195], v[72:75]
  s_waitcnt lgkmcnt(6)
  ds_read_b64_tr_b16 a[20:21], v5 offset:24576
  ds_read_b64_tr_b16 a[22:23], v5 offset:28672
  v_mfma_f32_16x16x32_bf16 v[80:83], a[40:43], a[192:195], v[80:83]
  ds_read_b64_tr_b16 a[8:9], v6 offset:16384
  v_mfma_f32_16x16x32_bf16 v[80:83], a[56:59], a[200:203], v[80:83]
  ds_read_b64_tr_b16 a[10:11], v6 offset:20480
  v_mfma_f32_16x16x32_bf16 v[84:87], a[56:59], a[204:207], v[84:87]
  buffer_load_dwordx4 a[136:139], v8, s[4:7], s63 offen offset:1024 sc1
  v_mfma_f32_16x16x32_bf16 v[84:87], a[40:43], a[196:199], v[84:87]
  ds_read_b64_tr_b16 a[24:25], v6 offset:24576
  ds_read_b64_tr_b16 a[26:27], v6 offset:28672
  v_mfma_f32_16x16x32_bf16 v[92:95], a[44:47], a[196:199], v[92:95]
  ds_read_b64_tr_b16 a[12:13], v7 offset:16384
  v_mfma_f32_16x16x32_bf16 v[92:95], a[60:63], a[204:207], v[92:95]
  ds_read_b64_tr_b16 a[14:15], v7 offset:20480
  v_mfma_f32_16x16x32_bf16 v[88:91], a[60:63], a[200:203], v[88:91]
  buffer_load_dwordx4 a[140:143], v9, s[4:7], s63 offen offset:1024 sc1
  v_mfma_f32_16x16x32_bf16 v[88:91], a[44:47], a[192:195], v[88:91]
  s_waitcnt vmcnt(24) lgkmcnt(6)
  ds_read_b64_tr_b16 a[28:29], v7 offset:24576
  ds_read_b64_tr_b16 a[30:31], v7 offset:28672
  v_mfma_f32_16x16x32_bf16 v[32:35], a[0:3], a[208:211], v[32:35]
  ds_read_b64_tr_b16 a[32:33], v4 offset:17408
  s_add_u32 m0, s79, 49152
  v_mfma_f32_16x16x32_bf16 v[32:35], a[16:19], a[216:219], v[32:35]
  s_add_u32 s92, s92, 196608
  ds_read_b64_tr_b16 a[34:35], v4 offset:21504
  s_sub_u32 s93, s92, s88
  v_mfma_f32_16x16x32_bf16 v[36:39], a[16:19], a[220:223], v[36:39]
  buffer_load_dwordx4 v252, s[80:83], s93 offen lds
  v_mfma_f32_16x16x32_bf16 v[36:39], a[0:3], a[212:215], v[36:39]
  ds_read_b64_tr_b16 a[48:49], v4 offset:25600
  ds_read_b64_tr_b16 a[50:51], v4 offset:29696
  v_mfma_f32_16x16x32_bf16 v[44:47], a[4:7], a[212:215], v[44:47]
  ds_read_b64_tr_b16 a[36:37], v5 offset:17408
  v_mfma_f32_16x16x32_bf16 v[44:47], a[20:23], a[220:223], v[44:47]
  ds_read_b64_tr_b16 a[38:39], v5 offset:21504
  v_mfma_f32_16x16x32_bf16 v[40:43], a[20:23], a[216:219], v[40:43]
  buffer_load_dwordx4 v252, s[84:87], s93 offen offset:1024 lds
  v_mfma_f32_16x16x32_bf16 v[40:43], a[4:7], a[208:211], v[40:43]
  s_waitcnt lgkmcnt(6)
  ds_read_b64_tr_b16 a[52:53], v5 offset:25600
  ds_read_b64_tr_b16 a[54:55], v5 offset:29696
  v_mfma_f32_16x16x32_bf16 v[48:51], a[8:11], a[208:211], v[48:51]
  ds_read_b64_tr_b16 a[40:41], v6 offset:17408
  v_mfma_f32_16x16x32_bf16 v[48:51], a[24:27], a[216:219], v[48:51]
  ds_read_b64_tr_b16 a[42:43], v6 offset:21504
  v_mfma_f32_16x16x32_bf16 v[52:55], a[24:27], a[220:223], v[52:55]
  buffer_load_dwordx4 a[144:147], v8, s[4:7], s63 offen offset:2048 sc1
  v_mfma_f32_16x16x32_bf16 v[52:55], a[8:11], a[212:215], v[52:55]
  ds_read_b64_tr_b16 a[56:57], v6 offset:25600
  ds_read_b64_tr_b16 a[58:59], v6 offset:29696
  v_mfma_f32_16x16x32_bf16 v[60:63], a[12:15], a[212:215], v[60:63]
  ds_read_b64_tr_b16 a[44:45], v7 offset:17408
  v_mfma_f32_16x16x32_bf16 v[60:63], a[28:31], a[220:223], v[60:63]
  ds_read_b64_tr_b16 a[46:47], v7 offset:21504
  v_mfma_f32_16x16x32_bf16 v[56:59], a[28:31], a[216:219], v[56:59]
  buffer_load_dwordx4 a[148:151], v9, s[4:7], s63 offen offset:2048 sc1
  v_mfma_f32_16x16x32_bf16 v[56:59], a[12:15], a[208:211], v[56:59]
  s_waitcnt lgkmcnt(6)
  ds_read_b64_tr_b16 a[60:61], v7 offset:25600
  ds_read_b64_tr_b16 a[62:63], v7 offset:29696
  v_mfma_f32_16x16x32_bf16 v[64:67], a[32:35], a[208:211], v[64:67]
  ds_read_b64_tr_b16 a[0:1], v4 offset:32768
  s_add_u32 m0, s79, 57344
  v_mfma_f32_16x16x32_bf16 v[64:67], a[48:51], a[216:219], v[64:67]
  s_add_u32 s92, s92, 262144
  ds_read_b64_tr_b16 a[2:3], v4 offset:36864
  s_sub_u32 s93, s92, s88
  v_mfma_f32_16x16x32_bf16 v[68:71], a[48:51], a[220:223], v[68:71]
  buffer_load_dwordx4 v252, s[80:83], s93 offen lds
  v_mfma_f32_16x16x32_bf16 v[68:71], a[32:35], a[212:215], v[68:71]
  ds_read_b64_tr_b16 a[16:17], v4 offset:40960
  ds_read_b64_tr_b16 a[18:19], v4 offset:45056
  v_mfma_f32_16x16x32_bf16 v[76:79], a[36:39], a[212:215], v[76:79]
  ds_read_b64_tr_b16 a[4:5], v5 offset:32768
  v_mfma_f32_16x16x32_bf16 v[76:79], a[52:55], a[220:223], v[76:79]
  ds_read_b64_tr_b16 a[6:7], v5 offset:36864
  v_mfma_f32_16x16x32_bf16 v[72:75], a[52:55], a[216:219], v[72:75]
  buffer_load_dwordx4 v252, s[84:87], s93 offen offset:1024 lds
  v_mfma_f32_16x16x32_bf16 v[72:75], a[36:39], a[208:211], v[72:75]
  s_waitcnt lgkmcnt(6)
  ds_read_b64_tr_b16 a[20:21], v5 offset:40960
  ds_read_b64_tr_b16 a[22:23], v5 offset:45056
  v_mfma_f32_16x16x32_bf16 v[80:83], a[40:43], a[208:211], v[80:83]
  ds_read_b64_tr_b16 a[8:9], v6 offset:32768
  v_mfma_f32_16x16x32_bf16 v[80:83], a[56:59], a[216:219], v[80:83]
  ds_read_b64_tr_b16 a[10:11], v6 offset:36864
  v_mfma_f32_16x16x32_bf16 v[84:87], a[56:59], a[220:223], v[84:87]
  buffer_load_dwordx4 a[152:155], v8, s[4:7], s63 offen offset:3072 sc1
  v_mfma_f32_16x16x32_bf16 v[84:87], a[40:43], a[212:215], v[84:87]
  ds_read_b64_tr_b16 a[24:25], v6 offset:40960
  ds_read_b64_tr_b16 a[26:27], v6 offset:45056
  v_mfma_f32_16x16x32_bf16 v[92:95], a[44:47], a[212:215], v[92:95]
  ds_read_b64_tr_b16 a[12:13], v7 offset:32768
  v_mfma_f32_16x16x32_bf16 v[92:95], a[60:63], a[220:223], v[92:95]
  ds_read_b64_tr_b16 a[14:15], v7 offset:36864
  v_mfma_f32_16x16x32_bf16 v[88:91], a[60:63], a[216:219], v[88:91]
  buffer_load_dwordx4 a[156:159], v9, s[4:7], s63 offen offset:3072 sc1
  v_mfma_f32_16x16x32_bf16 v[88:91], a[44:47], a[208:211], v[88:91]
  s_waitcnt vmcnt(24) lgkmcnt(6)
  ds_read_b64_tr_b16 a[28:29], v7 offset:40960
  ds_read_b64_tr_b16 a[30:31], v7 offset:45056
  v_mfma_f32_16x16x32_bf16 v[32:35], a[0:3], a[224:227], v[32:35]
  s_waitcnt vmcnt(26)
  s_barrier
  ds_read_b64_tr_b16 a[32:33], v4 offset:33792
  v_mfma_f32_16x16x32_bf16 v[32:35], a[16:19], a[232:235], v[32:35]
  s_add_u32 m0, s79, 65536
  ds_read_b64_tr_b16 a[34:35], v4 offset:37888
  s_add_u32 s92, s92, -3407872
  v_mfma_f32_16x16x32_bf16 v[36:39], a[16:19], a[236:239], v[36:39]
  s_add_u32 s93, s92, s88
  buffer_load_dwordx4 v252, s[80:83], s93 offen lds
  v_mfma_f32_16x16x32_bf16 v[36:39], a[0:3], a[228:231], v[36:39]
  ds_read_b64_tr_b16 a[48:49], v4 offset:41984
  ds_read_b64_tr_b16 a[50:51], v4 offset:46080
  v_mfma_f32_16x16x32_bf16 v[44:47], a[4:7], a[228:231], v[44:47]
  ds_read_b64_tr_b16 a[36:37], v5 offset:33792
  v_mfma_f32_16x16x32_bf16 v[44:47], a[20:23], a[236:239], v[44:47]
  ds_read_b64_tr_b16 a[38:39], v5 offset:37888
  v_mfma_f32_16x16x32_bf16 v[40:43], a[20:23], a[232:235], v[40:43]
  buffer_load_dwordx4 v252, s[84:87], s93 offen offset:1024 lds
  v_mfma_f32_16x16x32_bf16 v[40:43], a[4:7], a[224:227], v[40:43]
  s_waitcnt lgkmcnt(6)
  ds_read_b64_tr_b16 a[52:53], v5 offset:41984
  ds_read_b64_tr_b16 a[54:55], v5 offset:46080
  v_mfma_f32_16x16x32_bf16 v[48:51], a[8:11], a[224:227], v[48:51]
  ds_read_b64_tr_b16 a[40:41], v6 offset:33792
  v_mfma_f32_16x16x32_bf16 v[48:51], a[24:27], a[232:235], v[48:51]
  s_add_u32 s48, s48, 4096
  ds_read_b64_tr_b16 a[42:43], v6 offset:37888
  s_min_u32 s63, s88, 8192
  v_mfma_f32_16x16x32_bf16 v[52:55], a[24:27], a[236:239], v[52:55]
  s_sub_u32 s63, s48, s63
  buffer_load_dwordx4 a[160:163], v8, s[4:7], s63 offen offset:0 sc1
  v_mfma_f32_16x16x32_bf16 v[52:55], a[8:11], a[228:231], v[52:55]
  ds_read_b64_tr_b16 a[56:57], v6 offset:41984
  ds_read_b64_tr_b16 a[58:59], v6 offset:46080
  v_mfma_f32_16x16x32_bf16 v[60:63], a[12:15], a[228:231], v[60:63]
  ds_read_b64_tr_b16 a[44:45], v7 offset:33792
  v_mfma_f32_16x16x32_bf16 v[60:63], a[28:31], a[236:239], v[60:63]
  ds_read_b64_tr_b16 a[46:47], v7 offset:37888
  v_mfma_f32_16x16x32_bf16 v[56:59], a[28:31], a[232:235], v[56:59]
  buffer_load_dwordx4 a[164:167], v9, s[4:7], s63 offen offset:0 sc1
  v_mfma_f32_16x16x32_bf16 v[56:59], a[12:15], a[224:227], v[56:59]
  s_waitcnt lgkmcnt(6)
  ds_read_b64_tr_b16 a[60:61], v7 offset:41984
  ds_read_b64_tr_b16 a[62:63], v7 offset:46080
  v_mfma_f32_16x16x32_bf16 v[64:67], a[32:35], a[224:227], v[64:67]
  s_add_u32 m0, s79, 73728
  ds_read_b64_tr_b16 a[0:1], v4 offset:49152
  buffer_load_dword v10, v251, s[4:7], s64 offen sc1
  v_mfma_f32_16x16x32_bf16 v[64:67], a[48:51], a[232:235], v[64:67]
  s_add_u32 s92, s92, 262144
  ds_read_b64_tr_b16 a[2:3], v4 offset:53248
  s_add_u32 s93, s92, s88
  v_mfma_f32_16x16x32_bf16 v[68:71], a[48:51], a[236:239], v[68:71]
  buffer_load_dwordx4 v252, s[80:83], s93 offen lds
  v_mfma_f32_16x16x32_bf16 v[68:71], a[32:35], a[228:231], v[68:71]
  ds_read_b64_tr_b16 a[16:17], v4 offset:57344
  ds_read_b64_tr_b16 a[18:19], v4 offset:61440
  v_mfma_f32_16x16x32_bf16 v[76:79], a[36:39], a[228:231], v[76:79]
  ds_read_b64_tr_b16 a[4:5], v5 offset:49152
  v_mfma_f32_16x16x32_bf16 v[76:79], a[52:55], a[236:239], v[76:79]
  ds_read_b64_tr_b16 a[6:7], v5 offset:53248
  v_mfma_f32_16x16x32_bf16 v[72:75], a[52:55], a[232:235], v[72:75]
  buffer_load_dwordx4 v252, s[84:87], s93 offen offset:1024 lds
  v_mfma_f32_16x16x32_bf16 v[72:75], a[36:39], a[224:227], v[72:75]
  s_waitcnt lgkmcnt(6)
  ds_read_b64_tr_b16 a[20:21], v5 offset:57344
  ds_read_b64_tr_b16 a[22:23], v5 offset:61440
  v_mfma_f32_16x16x32_bf16 v[80:83], a[40:43], a[224:227], v[80:83]
  ds_read_b64_tr_b16 a[8:9], v6 offset:49152
  v_mfma_f32_16x16x32_bf16 v[80:83], a[56:59], a[232:235], v[80:83]
  ds_read_b64_tr_b16 a[10:11], v6 offset:53248
  v_mfma_f32_16x16x32_bf16 v[84:87], a[56:59], a[236:239], v[84:87]
  buffer_load_dwordx4 a[168:171], v8, s[4:7], s63 offen offset:1024 sc1
  v_mfma_f32_16x16x32_bf16 v[84:87], a[40:43], a[228:231], v[84:87]
  ds_read_b64_tr_b16 a[24:25], v6 offset:57344
  ds_read_b64_tr_b16 a[26:27], v6 offset:61440
  v_mfma_f32_16x16x32_bf16 v[92:95], a[44:47], a[228:231], v[92:95]
  ds_read_b64_tr_b16 a[12:13], v7 offset:49152
  v_mfma_f32_16x16x32_bf16 v[92:95], a[60:63], a[236:239], v[92:95]
  ds_read_b64_tr_b16 a[14:15], v7 offset:53248
  v_mfma_f32_16x16x32_bf16 v[88:91], a[60:63], a[232:235], v[88:91]
  buffer_load_dwordx4 a[172:175], v9, s[4:7], s63 offen offset:1024 sc1
  v_mfma_f32_16x16x32_bf16 v[88:91], a[44:47], a[224:227], v[88:91]
  s_waitcnt vmcnt(25) lgkmcnt(6)
  ds_read_b64_tr_b16 a[28:29], v7 offset:57344
  ds_read_b64_tr_b16 a[30:31], v7 offset:61440
  v_mfma_f32_16x16x32_bf16 v[32:35], a[0:3], a[240:243], v[32:35]
  ds_read_b64_tr_b16 a[32:33], v4 offset:50176
  s_add_u32 m0, s79, 81920
  v_mfma_f32_16x16x32_bf16 v[32:35], a[16:19], a[248:251], v[32:35]
  s_add_u32 s92, s92, 196608
  ds_read_b64_tr_b16 a[34:35], v4 offset:54272
  s_add_u32 s93, s92, s88
  v_mfma_f32_16x16x32_bf16 v[36:39], a[16:19], a[252:255], v[36:39]
  buffer_load_dwordx4 v252, s[80:83], s93 offen lds
  v_mfma_f32_16x16x32_bf16 v[36:39], a[0:3], a[244:247], v[36:39]
  ds_read_b64_tr_b16 a[48:49], v4 offset:58368
  ds_read_b64_tr_b16 a[50:51], v4 offset:62464
  v_mfma_f32_16x16x32_bf16 v[44:47], a[4:7], a[244:247], v[44:47]
  ds_read_b64_tr_b16 a[36:37], v5 offset:50176
  v_mfma_f32_16x16x32_bf16 v[44:47], a[20:23], a[252:255], v[44:47]
  ds_read_b64_tr_b16 a[38:39], v5 offset:54272
  v_mfma_f32_16x16x32_bf16 v[40:43], a[20:23], a[248:251], v[40:43]
  buffer_load_dwordx4 v252, s[84:87], s93 offen offset:1024 lds
  v_mfma_f32_16x16x32_bf16 v[40:43], a[4:7], a[240:243], v[40:43]
  s_waitcnt lgkmcnt(6)
  ds_read_b64_tr_b16 a[52:53], v5 offset:58368
  ds_read_b64_tr_b16 a[54:55], v5 offset:62464
  v_mfma_f32_16x16x32_bf16 v[48:51], a[8:11], a[240:243], v[48:51]
  ds_read_b64_tr_b16 a[40:41], v6 offset:50176
  v_mfma_f32_16x16x32_bf16 v[48:51], a[24:27], a[248:251], v[48:51]
  ds_read_b64_tr_b16 a[42:43], v6 offset:54272
  v_mfma_f32_16x16x32_bf16 v[52:55], a[24:27], a[252:255], v[52:55]
  buffer_load_dwordx4 a[176:179], v8, s[4:7], s63 offen offset:2048 sc1
  v_mfma_f32_16x16x32_bf16 v[52:55], a[8:11], a[244:247], v[52:55]
  ds_read_b64_tr_b16 a[56:57], v6 offset:58368
  ds_read_b64_tr_b16 a[58:59], v6 offset:62464
  v_mfma_f32_16x16x32_bf16 v[60:63], a[12:15], a[244:247], v[60:63]
  ds_read_b64_tr_b16 a[44:45], v7 offset:50176
  v_mfma_f32_16x16x32_bf16 v[60:63], a[28:31], a[252:255], v[60:63]
  ds_read_b64_tr_b16 a[46:47], v7 offset:54272
  v_mfma_f32_16x16x32_bf16 v[56:59], a[28:31], a[248:251], v[56:59]
  buffer_load_dwordx4 a[180:183], v9, s[4:7], s63 offen offset:2048 sc1
  v_mfma_f32_16x16x32_bf16 v[56:59], a[12:15], a[240:243], v[56:59]
  s_waitcnt lgkmcnt(6)
  ds_read_b64_tr_b16 a[60:61], v7 offset:58368
  ds_read_b64_tr_b16 a[62:63], v7 offset:62464
  v_mfma_f32_16x16x32_bf16 v[64:67], a[32:35], a[240:243], v[64:67]
  ds_read_b64_tr_b16 a[0:1], v0 offset:0
  s_add_u32 m0, s79, 90112
  v_mfma_f32_16x16x32_bf16 v[64:67], a[48:51], a[248:251], v[64:67]
  s_add_u32 s92, s92, 262144
  ds_read_b64_tr_b16 a[2:3], v0 offset:4096
  s_add_u32 s93, s92, s88
  v_mfma_f32_16x16x32_bf16 v[68:71], a[48:51], a[252:255], v[68:71]
  buffer_load_dwordx4 v252, s[80:83], s93 offen lds
  v_mfma_f32_16x16x32_bf16 v[68:71], a[32:35], a[244:247], v[68:71]
  ds_read_b64_tr_b16 a[16:17], v0 offset:8192
  ds_read_b64_tr_b16 a[18:19], v0 offset:12288
  v_mfma_f32_16x16x32_bf16 v[76:79], a[36:39], a[244:247], v[76:79]
  ds_read_b64_tr_b16 a[4:5], v1 offset:0
  v_mfma_f32_16x16x32_bf16 v[76:79], a[52:55], a[252:255], v[76:79]
  ds_read_b64_tr_b16 a[6:7], v1 offset:4096
  v_mfma_f32_16x16x32_bf16 v[72:75], a[52:55], a[248:251], v[72:75]
  buffer_load_dwordx4 v252, s[84:87], s93 offen offset:1024 lds
  v_mfma_f32_16x16x32_bf16 v[72:75], a[36:39], a[240:243], v[72:75]
  s_waitcnt lgkmcnt(6)
  ds_read_b64_tr_b16 a[20:21], v1 offset:8192
  ds_read_b64_tr_b16 a[22:23], v1 offset:12288
  v_mfma_f32_16x16x32_bf16 v[80:83], a[40:43], a[240:243], v[80:83]
  ds_read_b64_tr_b16 a[8:9], v2 offset:0
  v_mfma_f32_16x16x32_bf16 v[80:83], a[56:59], a[248:251], v[80:83]
  ds_read_b64_tr_b16 a[10:11], v2 offset:4096
  v_mfma_f32_16x16x32_bf16 v[84:87], a[56:59], a[252:255], v[84:87]
  buffer_load_dwordx4 a[184:187], v8, s[4:7], s63 offen offset:3072 sc1
  v_mfma_f32_16x16x32_bf16 v[84:87], a[40:43], a[244:247], v[84:87]
  ds_read_b64_tr_b16 a[24:25], v2 offset:8192
  ds_read_b64_tr_b16 a[26:27], v2 offset:12288
  v_mfma_f32_16x16x32_bf16 v[92:95], a[44:47], a[244:247], v[92:95]
  ds_read_b64_tr_b16 a[12:13], v3 offset:0
  v_mfma_f32_16x16x32_bf16 v[92:95], a[60:63], a[252:255], v[92:95]
  s_sub_u32 s56, s56, 1
  ds_read_b64_tr_b16 a[14:15], v3 offset:4096
  v_mfma_f32_16x16x32_bf16 v[88:91], a[60:63], a[248:251], v[88:91]
  s_cmp_lg_u32 s56, 0
  buffer_load_dwordx4 a[188:191], v9, s[4:7], s63 offen offset:3072 sc1
  ds_read_b64_tr_b16 a[28:29], v3 offset:8192
  v_mfma_f32_16x16x32_bf16 v[88:91], a[44:47], a[240:243], v[88:91]
  ds_read_b64_tr_b16 a[30:31], v3 offset:12288
  s_cbranch_scc1 Lp4_loop
Lmk_Lp4_loop_tail:
  s_waitcnt vmcnt(25) lgkmcnt(8)
  v_mfma_f32_16x16x32_bf16 v[32:35], a[0:3], a[128:131], v[32:35]
  s_waitcnt vmcnt(27)
  s_barrier
  ds_read_b64_tr_b16 a[32:33], v0 offset:1024
  v_mfma_f32_16x16x32_bf16 v[32:35], a[16:19], a[136:139], v[32:35]
  s_add_u32 m0, s79, 98304
  ds_read_b64_tr_b16 a[34:35], v0 offset:5120
  s_add_u32 s92, s92, 196608
  v_mfma_f32_16x16x32_bf16 v[36:39], a[16:19], a[140:143], v[36:39]
  s_add_u32 s93, s92, s88
  buffer_load_dwordx4 v252, s[80:83], s93 offen lds
  v_mfma_f32_16x16x32_bf16 v[36:39], a[0:3], a[132:135], v[36:39]
  ds_read_b64_tr_b16 a[48:49], v0 offset:9216
  ds_read_b64_tr_b16 a[50:51], v0 offset:13312
  v_mfma_f32_16x16x32_bf16 v[44:47], a[4:7], a[132:135], v[44:47]
  ds_read_b64_tr_b16 a[36:37], v1 offset:1024
  v_mfma_f32_16x16x32_bf16 v[44:47], a[20:23], a[140:143], v[44:47]
  ds_read_b64_tr_b16 a[38:39], v1 offset:5120
  v_mfma_f32_16x16x32_bf16 v[40:43], a[20:23], a[136:139], v[40:43]
  buffer_load_dwordx4 v252, s[84:87], s93 offen offset:1024 lds
  v_mfma_f32_16x16x32_bf16 v[40:43], a[4:7], a[128:131], v[40:43]
  s_waitcnt lgkmcnt(6)
  ds_read_b64_tr_b16 a[52:53], v1 offset:9216
  ds_read_b64_tr_b16 a[54:55], v1 offset:13312
  v_mfma_f32_16x16x32_bf16 v[48:51], a[8:11], a[128:131], v[48:51]
  ds_read_b64_tr_b16 a[40:41], v2 offset:1024
  v_mfma_f32_16x16x32_bf16 v[48:51], a[24:27], a[136:139], v[48:51]
  s_add_u32 s48, s48, 4096
  ds_read_b64_tr_b16 a[42:43], v2 offset:5120
  s_min_u32 s63, s88, 8192
  v_mfma_f32_16x16x32_bf16 v[52:55], a[24:27], a[140:143], v[52:55]
  s_add_u32 s63, s48, s63
  buffer_load_dwordx4 a[192:195], v8, s[4:7], s63 offen offset:0 sc1
  v_mfma_f32_16x16x32_bf16 v[52:55], a[8:11], a[132:135], v[52:55]
  ds_read_b64_tr_b16 a[56:57], v2 offset:9216
  ds_read_b64_tr_b16 a[58:59], v2 offset:13312
  v_mfma_f32_16x16x32_bf16 v[60:63], a[12:15], a[132:135], v[60:63]
  ds_read_b64_tr_b16 a[44:45], v3 offset:1024
  v_mfma_f32_16x16x32_bf16 v[60:63], a[28:31], a[140:143], v[60:63]
  ds_read_b64_tr_b16 a[46:47], v3 offset:5120
  v_mfma_f32_16x16x32_bf16 v[56:59], a[28:31], a[136:139], v[56:59]
  buffer_load_dwordx4 a[196:199], v9, s[4:7], s63 offen offset:0 sc1
  v_mfma_f32_16x16x32_bf16 v[56:59], a[12:15], a[128:131], v[56:59]
  s_waitcnt lgkmcnt(6)
  ds_read_b64_tr_b16 a[60:61], v3 offset:9216
  ds_read_b64_tr_b16 a[62:63], v3 offset:13312
  v_mfma_f32_16x16x32_bf16 v[64:67], a[32:35], a[128:131], v[64:67]
  ds_read_b64_tr_b16 a[0:1], v0 offset:16384
  s_add_u32 m0, s79, 106496
  v_mfma_f32_16x16x32_bf16 v[64:67], a[48:51], a[136:139], v[64:67]
  s_add_u32 s92, s92, 262144
  ds_read_b64_tr_b16 a[2:3], v0 offset:20480
  s_add_u32 s93, s92, s88
  v_mfma_f32_16x16x32_bf16 v[68:71], a[48:51], a[140:143], v[68:71]
  buffer_load_dwordx4 v252, s[80:83], s93 offen lds
  v_mfma_f32_16x16x32_bf16 v[68:71], a[32:35], a[132:135], v[68:71]
  ds_read_b64_tr_b16 a[16:17], v0 offset:24576
  ds_read_b64_tr_b16 a[18:19], v0 offset:28672
  v_mfma_f32_16x16x32_bf16 v[76:79], a[36:39], a[132:135], v[76:79]
  ds_read_b64_tr_b16 a[4:5], v1 offset:16384
  v_mfma_f32_16x16x32_bf16 v[76:79], a[52:55], a[140:143], v[76:79]
  ds_read_b64_tr_b16 a[6:7], v1 offset:20480
  v_mfma_f32_16x16x32_bf16 v[72:75], a[52:55], a[136:139], v[72:75]
  buffer_load_dwordx4 v252, s[84:87], s93 offen offset:1024 lds
  v_mfma_f32_16x16x32_bf16 v[72:75], a[36:39], a[128:131], v[72:75]
  s_waitcnt lgkmcnt(6)
  ds_read_b64_tr_b16 a[20:21], v1 offset:24576
  ds_read_b64_tr_b16 a[22:23], v1 offset:28672
  v_mfma_f32_16x16x32_bf16 v[80:83], a[40:43], a[128:131], v[80:83]
  ds_read_b64_tr_b16 a[8:9], v2 offset:16384
  v_mfma_f32_16x16x32_bf16 v[80:83], a[56:59], a[136:139], v[80:83]
  ds_read_b64_tr_b16 a[10:11], v2 offset:20480
  v_mfma_f32_16x16x32_bf16 v[84:87], a[56:59], a[140:143], v[84:87]
  buffer_load_dwordx4 a[200:203], v8, s[4:7], s63 offen offset:1024 sc1
  v_mfma_f32_16x16x32_bf16 v[84:87], a[40:43], a[132:135], v[84:87]
  ds_read_b64_tr_b16 a[24:25], v2 offset:24576
  ds_read_b64_tr_b16 a[26:27], v2 offset:28672
  v_mfma_f32_16x16x32_bf16 v[92:95], a[44:47], a[132:135], v[92:95]
  ds_read_b64_tr_b16 a[12:13], v3 offset:16384
  v_mfma_f32_16x16x32_bf16 v[92:95], a[60:63], a[140:143], v[92:95]
  ds_read_b64_tr_b16 a[14:15], v3 offset:20480
  v_mfma_f32_16x16x32_bf16 v[88:91], a[60:63], a[136:139], v[88:91]
  buffer_load_dwordx4 a[204:207], v9, s[4:7], s63 offen offset:1024 sc1
  v_mfma_f32_16x16x32_bf16 v[88:91], a[44:47], a[128:131], v[88:91]
  s_waitcnt vmcnt(25) lgkmcnt(6)
  ds_read_b64_tr_b16 a[28:29], v3 offset:24576
  ds_read_b64_tr_b16 a[30:31], v3 offset:28672
  v_mfma_f32_16x16x32_bf16 v[32:35], a[0:3], a[144:147], v[32:35]
  ds_read_b64_tr_b16 a[32:33], v0 offset:17408
  s_add_u32 m0, s79, 114688
  v_mfma_f32_16x16x32_bf16 v[32:35], a[16:19], a[152:155], v[32:35]
  s_add_u32 s92, s92, 196608
  ds_read_b64_tr_b16 a[34:35], v0 offset:21504
  s_add_u32 s93, s92, s88
  v_mfma_f32_16x16x32_bf16 v[36:39], a[16:19], a[156:159], v[36:39]
  buffer_load_dwordx4 v252, s[80:83], s93 offen lds
  v_mfma_f32_16x16x32_bf16 v[36:39], a[0:3], a[148:151], v[36:39]
  ds_read_b64_tr_b16 a[48:49], v0 offset:25600
  ds_read_b64_tr_b16 a[50:51], v0 offset:29696
  v_mfma_f32_16x16x32_bf16 v[44:47], a[4:7], a[148:151], v[44:47]
  ds_read_b64_tr_b16 a[36:37], v1 offset:17408
  v_mfma_f32_16x16x32_bf16 v[44:47], a[20:23], a[156:159], v[44:47]
  ds_read_b64_tr_b16 a[38:39], v1 offset:21504
  v_mfma_f32_16x16x32_bf16 v[40:43], a[20:23], a[152:155], v[40:43]
  buffer_load_dwordx4 v252, s[84:87], s93 offen offset:1024 lds
  v_mfma_f32_16x16x32_bf16 v[40:43], a[4:7], a[144:147], v[40:43]
  s_waitcnt lgkmcnt(6)
  ds_read_b64_tr_b16 a[52:53], v1 offset:25600
  ds_read_b64_tr_b16 a[54:55], v1 offset:29696
  v_mfma_f32_16x16x32_bf16 v[48:51], a[8:11], a[144:147], v[48:51]
  ds_read_b64_tr_b16 a[40:41], v2 offset:17408
  v_mfma_f32_16x16x32_bf16 v[48:51], a[24:27], a[152:155], v[48:51]
  ds_read_b64_tr_b16 a[42:43], v2 offset:21504
  v_mfma_f32_16x16x32_bf16 v[52:55], a[24:27], a[156:159], v[52:55]
  buffer_load_dwordx4 a[208:211], v8, s[4:7], s63 offen offset:2048 sc1
  v_mfma_f32_16x16x32_bf16 v[52:55], a[8:11], a[148:151], v[52:55]
  ds_read_b64_tr_b16 a[56:57], v2 offset:25600
  ds_read_b64_tr_b16 a[58:59], v2 offset:29696
  v_mfma_f32_16x16x32_bf16 v[60:63], a[12:15], a[148:151], v[60:63]
  ds_read_b64_tr_b16 a[44:45], v3 offset:17408
  v_mfma_f32_16x16x32_bf16 v[60:63], a[28:31], a[156:159], v[60:63]
  ds_read_b64_tr_b16 a[46:47], v3 offset:21504
  v_mfma_f32_16x16x32_bf16 v[56:59], a[28:31], a[152:155], v[56:59]
  buffer_load_dwordx4 a[212:215], v9, s[4:7], s63 offen offset:2048 sc1
  v_mfma_f32_16x16x32_bf16 v[56:59], a[12:15], a[144:147], v[56:59]
  s_waitcnt lgkmcnt(6)
  ds_read_b64_tr_b16 a[60:61], v3 offset:25600
  ds_read_b64_tr_b16 a[62:63], v3 offset:29696
  v_mfma_f32_16x16x32_bf16 v[64:67], a[32:35], a[144:147], v[64:67]
  ds_read_b64_tr_b16 a[0:1], v0 offset:32768
  s_add_u32 m0, s79, 122880
  v_mfma_f32_16x16x32_bf16 v[64:67], a[48:51], a[152:155], v[64:67]
  s_add_u32 s92, s92, 262144
  ds_read_b64_tr_b16 a[2:3], v0 offset:36864
  s_add_u32 s93, s92, s88
  v_mfma_f32_16x16x32_bf16 v[68:71], a[48:51], a[156:159], v[68:71]
  buffer_load_dwordx4 v252, s[80:83], s93 offen lds
  v_mfma_f32_16x16x32_bf16 v[68:71], a[32:35], a[148:151], v[68:71]
  ds_read_b64_tr_b16 a[16:17], v0 offset:40960
  ds_read_b64_tr_b16 a[18:19], v0 offset:45056
  v_mfma_f32_16x16x32_bf16 v[76:79], a[36:39], a[148:151], v[76:79]
  ds_read_b64_tr_b16 a[4:5], v1 offset:32768
  v_mfma_f32_16x16x32_bf16 v[76:79], a[52:55], a[156:159], v[76:79]
  ds_read_b64_tr_b16 a[6:7], v1 offset:36864
  v_mfma_f32_16x16x32_bf16 v[72:75], a[52:55], a[152:155], v[72:75]
  buffer_load_dwordx4 v252, s[84:87], s93 offen offset:1024 lds
  v_mfma_f32_16x16x32_bf16 v[72:75], a[36:39], a[144:147], v[72:75]
  s_waitcnt lgkmcnt(6)
  ds_read_b64_tr_b16 a[20:21], v1 offset:40960
  ds_read_b64_tr_b16 a[22:23], v1 offset:45056
  v_mfma_f32_16x16x32_bf16 v[80:83], a[40:43], a[144:147], v[80:83]
  ds_read_b64_tr_b16 a[8:9], v2 offset:32768
  v_mfma_f32_16x16x32_bf16 v[80:83], a[56:59], a[152:155], v[80:83]
  ds_read_b64_tr_b16 a[10:11], v2 offset:36864
  v_mfma_f32_16x16x32_bf16 v[84:87], a[56:59], a[156:159], v[84:87]
  buffer_load_dwordx4 a[216:219], v8, s[4:7], s63 offen offset:3072 sc1
  v_mfma_f32_16x16x32_bf16 v[84:87], a[40:43], a[148:151], v[84:87]
  ds_read_b64_tr_b16 a[24:25], v2 offset:40960
  ds_read_b64_tr_b16 a[26:27], v2 offset:45056
  v_mfma_f32_16x16x32_bf16 v[92:95], a[44:47], a[148:151], v[92:95]
  ds_read_b64_tr_b16 a[12:13], v3 offset:32768
  v_mfma_f32_16x16x32_bf16 v[92:95], a[60:63], a[156:159], v[92:95]
  ds_read_b64_tr_b16 a[14:15], v3 offset:36864
  v_mfma_f32_16x16x32_bf16 v[88:91], a[60:63], a[152:155], v[88:91]
  buffer_load_dwordx4 a[220:223], v9, s[4:7], s63 offen offset:3072 sc1
  v_mfma_f32_16x16x32_bf16 v[88:91], a[44:47], a[144:147], v[88:91]
  s_waitcnt vmcnt(24) lgkmcnt(6)
  ds_read_b64_tr_b16 a[28:29], v3 offset:40960
  ds_read_b64_tr_b16 a[30:31], v3 offset:45056
  v_mfma_f32_16x16x32_bf16 v[32:35], a[0:3], a[160:163], v[32:35]
  s_waitcnt vmcnt(26)
  s_barrier
  ds_read_b64_tr_b16 a[32:33], v0 offset:33792
  v_mfma_f32_16x16x32_bf16 v[32:35], a[16:19], a[168:171], v[32:35]
  s_add_u32 m0, s79, 0
  ds_read_b64_tr_b16 a[34:35], v0 offset:37888
  s_add_u32 s92, s92, 196608
  v_mfma_f32_16x16x32_bf16 v[36:39], a[16:19], a[172:175], v[36:39]
  s_sub_u32 s93, s92, s88
  buffer_load_dwordx4 v252, s[80:83], s93 offen lds
  v_mfma_f32_16x16x32_bf16 v[36:39], a[0:3], a[164:167], v[36:39]
  ds_read_b64_tr_b16 a[48:49], v0 offset:41984
  ds_read_b64_tr_b16 a[50:51], v0 offset:46080
  v_mfma_f32_16x16x32_bf16 v[44:47], a[4:7], a[164:167], v[44:47]
  ds_read_b64_tr_b16 a[36:37], v1 offset:33792
  v_mfma_f32_16x16x32_bf16 v[44:47], a[20:23], a[172:175], v[44:47]
  ds_read_b64_tr_b16 a[38:39], v1 offset:37888
  v_mfma_f32_16x16x32_bf16 v[40:43], a[20:23], a[168:171], v[40:43]
  buffer_load_dwordx4 v252, s[84:87], s93 offen offset:1024 lds
  v_mfma_f32_16x16x32_bf16 v[40:43], a[4:7], a[160:163], v[40:43]
  s_waitcnt lgkmcnt(6)
  ds_read_b64_tr_b16 a[52:53], v1 offset:41984
  ds_read_b64_tr_b16 a[54:55], v1 offset:46080
  v_mfma_f32_16x16x32_bf16 v[48:51], a[8:11], a[160:163], v[48:51]
  ds_read_b64_tr_b16 a[40:41], v2 offset:33792
  v_mfma_f32_16x16x32_bf16 v[48:51], a[24:27], a[168:171], v[48:51]
  s_add_u32 s48, s48, 4096
  ds_read_b64_tr_b16 a[42:43], v2 offset:37888
  s_min_u32 s63, s88, 8192
  v_mfma_f32_16x16x32_bf16 v[52:55], a[24:27], a[172:175], v[52:55]
  s_add_u32 s63, s48, s63
  buffer_load_dwordx4 a[224:227], v8, s[4:7], s63 offen offset:0 sc1
  v_mfma_f32_16x16x32_bf16 v[52:55], a[8:11], a[164:167], v[52:55]
  ds_read_b64_tr_b16 a[56:57], v2 offset:41984
  ds_read_b64_tr_b16 a[58:59], v2 offset:46080
  v_mfma_f32_16x16x32_bf16 v[60:63], a[12:15], a[164:167], v[60:63]
  ds_read_b64_tr_b16 a[44:45], v3 offset:33792
  v_mfma_f32_16x16x32_bf16 v[60:63], a[28:31], a[172:175], v[60:63]
  ds_read_b64_tr_b16 a[46:47], v3 offset:37888
  v_mfma_f32_16x16x32_bf16 v[56:59], a[28:31], a[168:171], v[56:59]
  buffer_load_dwordx4 a[228:231], v9, s[4:7], s63 offen offset:0 sc1
  v_mfma_f32_16x16x32_bf16 v[56:59], a[12:15], a[160:163], v[56:59]
  s_waitcnt lgkmcnt(6)
  ds_read_b64_tr_b16 a[60:61], v3 offset:41984
  ds_read_b64_tr_b16 a[62:63], v3 offset:46080
  v_mfma_f32_16x16x32_bf16 v[64:67], a[32:35], a[160:163], v[64:67]
  ds_read_b64_tr_b16 a[0:1], v0 offset:49152
  s_add_u32 m0, s79, 8192
  v_mfma_f32_16x16x32_bf16 v[64:67], a[48:51], a[168:171], v[64:67]
  s_add_u32 s92, s92, 262144
  ds_read_b64_tr_b16 a[2:3], v0 offset:53248
  s_sub_u32 s93, s92, s88
  v_mfma_f32_16x16x32_bf16 v[68:71], a[48:51], a[172:175], v[68:71]
  buffer_load_dwordx4 v252, s[80:83], s93 offen lds
  v_mfma_f32_16x16x32_bf16 v[68:71], a[32:35], a[164:167], v[68:71]
  ds_read_b64_tr_b16 a[16:17], v0 offset:57344
  ds_read_b64_tr_b16 a[18:19], v0 offset:61440
  v_mfma_f32_16x16x32_bf16 v[76:79], a[36:39], a[164:167], v[76:79]
  ds_read_b64_tr_b16 a[4:5], v1 offset:49152
  v_mfma_f32_16x16x32_bf16 v[76:79], a[52:55], a[172:175], v[76:79]
  ds_read_b64_tr_b16 a[6:7], v1 offset:53248
  v_mfma_f32_16x16x32_bf16 v[72:75], a[52:55], a[168:171], v[72:75]
  buffer_load_dwordx4 v252, s[84:87], s93 offen offset:1024 lds
  v_mfma_f32_16x16x32_bf16 v[72:75], a[36:39], a[160:163], v[72:75]
  s_waitcnt lgkmcnt(6)
  ds_read_b64_tr_b16 a[20:21], v1 offset:57344
  ds_read_b64_tr_b16 a[22:23], v1 offset:61440
  v_mfma_f32_16x16x32_bf16 v[80:83], a[40:43], a[160:163], v[80:83]
  ds_read_b64_tr_b16 a[8:9], v2 offset:49152
  v_mfma_f32_16x16x32_bf16 v[80:83], a[56:59], a[168:171], v[80:83]
  ds_read_b64_tr_b16 a[10:11], v2 offset:53248
  v_mfma_f32_16x16x32_bf16 v[84:87], a[56:59], a[172:175], v[84:87]
  buffer_load_dwordx4 a[232:235], v8, s[4:7], s63 offen offset:1024 sc1
  v_mfma_f32_16x16x32_bf16 v[84:87], a[40:43], a[164:167], v[84:87]
  ds_read_b64_tr_b16 a[24:25], v2 offset:57344
  ds_read_b64_tr_b16 a[26:27], v2 offset:61440
  v_mfma_f32_16x16x32_bf16 v[92:95], a[44:47], a[164:167], v[92:95]
  ds_read_b64_tr_b16 a[12:13], v3 offset:49152
  v_mfma_f32_16x16x32_bf16 v[92:95], a[60:63], a[172:175], v[92:95]
  ds_read_b64_tr_b16 a[14:15], v3 offset:53248
  v_mfma_f32_16x16x32_bf16 v[88:91], a[60:63], a[168:171], v[88:91]
  buffer_load_dwordx4 a[236:239], v9, s[4:7], s63 offen offset:1024 sc1
  v_mfma_f32_16x16x32_bf16 v[88:91], a[44:47], a[160:163], v[88:91]
  s_waitcnt vmcnt(24) lgkmcnt(6)
  ds_read_b64_tr_b16 a[28:29], v3 offset:57344
  ds_read_b64_tr_b16 a[30:31], v3 offset:61440
  v_mfma_f32_16x16x32_bf16 v[32:35], a[0:3], a[176:179], v[32:35]
  ds_read_b64_tr_b16 a[32:33], v0 offset:50176
  s_add_u32 m0, s79, 16384
  v_mfma_f32_16x16x32_bf16 v[32:35], a[16:19], a[184:187], v[32:35]
  s_add_u32 s92, s92, 196608
  ds_read_b64_tr_b16 a[34:35], v0 offset:54272
  s_sub_u32 s93, s92, s88
  v_mfma_f32_16x16x32_bf16 v[36:39], a[16:19], a[188:191], v[36:39]
  buffer_load_dwordx4 v252, s[80:83], s93 offen lds
  v_mfma_f32_16x16x32_bf16 v[36:39], a[0:3], a[180:183], v[36:39]
  ds_read_b64_tr_b16 a[48:49], v0 offset:58368
  ds_read_b64_tr_b16 a[50:51], v0 offset:62464
  v_mfma_f32_16x16x32_bf16 v[44:47], a[4:7], a[180:183], v[44:47]
  ds_read_b64_tr_b16 a[36:37], v1 offset:50176
  v_mfma_f32_16x16x32_bf16 v[44:47], a[20:23], a[188:191], v[44:47]
  ds_read_b64_tr_b16 a[38:39], v1 offset:54272
  v_mfma_f32_16x16x32_bf16 v[40:43], a[20:23], a[184:187], v[40:43]
  buffer_load_dwordx4 v252, s[84:87], s93 offen offset:1024 lds
  v_mfma_f32_16x16x32_bf16 v[40:43], a[4:7], a[176:179], v[40:43]
  s_waitcnt lgkmcnt(6)
  ds_read_b64_tr_b16 a[52:53], v1 offset:58368
  ds_read_b64_tr_b16 a[54:55], v1 offset:62464
  v_mfma_f32_16x16x32_bf16 v[48:51], a[8:11], a[176:179], v[48:51]
  ds_read_b64_tr_b16 a[40:41], v2 offset:50176
  v_mfma_f32_16x16x32_bf16 v[48:51], a[24:27], a[184:187], v[48:51]
  ds_read_b64_tr_b16 a[42:43], v2 offset:54272
  v_mfma_f32_16x16x32_bf16 v[52:55], a[24:27], a[188:191], v[52:55]
  buffer_load_dwordx4 a[240:243], v8, s[4:7], s63 offen offset:2048 sc1
  v_mfma_f32_16x16x32_bf16 v[52:55], a[8:11], a[180:183], v[52:55]
  ds_read_b64_tr_b16 a[56:57], v2 offset:58368
  ds_read_b64_tr_b16 a[58:59], v2 offset:62464
  v_mfma_f32_16x16x32_bf16 v[60:63], a[12:15], a[180:183], v[60:63]
  ds_read_b64_tr_b16 a[44:45], v3 offset:50176
  v_mfma_f32_16x16x32_bf16 v[60:63], a[28:31], a[188:191], v[60:63]
  ds_read_b64_tr_b16 a[46:47], v3 offset:54272
  v_mfma_f32_16x16x32_bf16 v[56:59], a[28:31], a[184:187], v[56:59]
  buffer_load_dwordx4 a[244:247], v9, s[4:7], s63 offen offset:2048 sc1
  v_mfma_f32_16x16x32_bf16 v[56:59], a[12:15], a[176:179], v[56:59]
  s_waitcnt lgkmcnt(6)
  ds_read_b64_tr_b16 a[60:61], v3 offset:58368
  ds_read_b64_tr_b16 a[62:63], v3 offset:62464
  v_mfma_f32_16x16x32_bf16 v[64:67], a[32:35], a[176:179], v[64:67]
  ds_read_b64_tr_b16 a[0:1], v4 offset:0
  s_add_u32 m0, s79, 24576
  v_mfma_f32_16x16x32_bf16 v[64:67], a[48:51], a[184:187], v[64:67]
  s_add_u32 s92, s92, 262144
  ds_read_b64_tr_b16 a[2:3], v4 offset:4096
  s_sub_u32 s93, s92, s88
  v_mfma_f32_16x16x32_bf16 v[68:71], a[48:51], a[188:191], v[68:71]
  buffer_load_dwordx4 v252, s[80:83], s93 offen lds
  v_mfma_f32_16x16x32_bf16 v[68:71], a[32:35], a[180:183], v[68:71]
  ds_read_b64_tr_b16 a[16:17], v4 offset:8192
  ds_read_b64_tr_b16 a[18:19], v4 offset:12288
  v_mfma_f32_16x16x32_bf16 v[76:79], a[36:39], a[180:183], v[76:79]
  ds_read_b64_tr_b16 a[4:5], v5 offset:0
  v_mfma_f32_16x16x32_bf16 v[76:79], a[52:55], a[188:191], v[76:79]
  ds_read_b64_tr_b16 a[6:7], v5 offset:4096
  v_mfma_f32_16x16x32_bf16 v[72:75], a[52:55], a[184:187], v[72:75]
  buffer_load_dwordx4 v252, s[84:87], s93 offen offset:1024 lds
  v_mfma_f32_16x16x32_bf16 v[72:75], a[36:39], a[176:179], v[72:75]
  s_waitcnt lgkmcnt(6)
  ds_read_b64_tr_b16 a[20:21], v5 offset:8192
  ds_read_b64_tr_b16 a[22:23], v5 offset:12288
  v_mfma_f32_16x16x32_bf16 v[80:83], a[40:43], a[176:179], v[80:83]
  ds_read_b64_tr_b16 a[8:9], v6 offset:0
  v_mfma_f32_16x16x32_bf16 v[80:83], a[56:59], a[184:187], v[80:83]
  ds_read_b64_tr_b16 a[10:11], v6 offset:4096
  v_mfma_f32_16x16x32_bf16 v[84:87], a[56:59], a[188:191], v[84:87]
  buffer_load_dwordx4 a[248:251], v8, s[4:7], s63 offen offset:3072 sc1
  v_mfma_f32_16x16x32_bf16 v[84:87], a[40:43], a[180:183], v[84:87]
  ds_read_b64_tr_b16 a[24:25], v6 offset:8192
  ds_read_b64_tr_b16 a[26:27], v6 offset:12288
  v_mfma_f32_16x16x32_bf16 v[92:95], a[44:47], a[180:183], v[92:95]
  ds_read_b64_tr_b16 a[12:13], v7 offset:0
  v_mfma_f32_16x16x32_bf16 v[92:95], a[60:63], a[188:191], v[92:95]
  ds_read_b64_tr_b16 a[14:15], v7 offset:4096
  v_mfma_f32_16x16x32_bf16 v[88:91], a[60:63], a[184:187], v[88:91]
  buffer_load_dwordx4 a[252:255], v9, s[4:7], s63 offen offset:3072 sc1
  v_mfma_f32_16x16x32_bf16 v[88:91], a[44:47], a[176:179], v[88:91]
  s_waitcnt vmcnt(24) lgkmcnt(6)
  ds_read_b64_tr_b16 a[28:29], v7 offset:8192
  ds_read_b64_tr_b16 a[30:31], v7 offset:12288
  v_mfma_f32_16x16x32_bf16 v[32:35], a[0:3], a[192:195], v[32:35]
  s_waitcnt vmcnt(26)
  s_barrier
  ds_read_b64_tr_b16 a[32:33], v4 offset:1024
  v_mfma_f32_16x16x32_bf16 v[32:35], a[16:19], a[200:203], v[32:35]
  s_add_u32 m0, s79, 32768
  ds_read_b64_tr_b16 a[34:35], v4 offset:5120
  s_add_u32 s92, s92, 196608
  v_mfma_f32_16x16x32_bf16 v[36:39], a[16:19], a[204:207], v[36:39]
  s_sub_u32 s93, s92, s88
  buffer_load_dwordx4 v252, s[80:83], s93 offen lds
  v_mfma_f32_16x16x32_bf16 v[36:39], a[0:3], a[196:199], v[36:39]
  ds_read_b64_tr_b16 a[48:49], v4 offset:9216
  ds_read_b64_tr_b16 a[50:51], v4 offset:13312
  v_mfma_f32_16x16x32_bf16 v[44:47], a[4:7], a[196:199], v[44:47]
  ds_read_b64_tr_b16 a[36:37], v5 offset:1024
  v_mfma_f32_16x16x32_bf16 v[44:47], a[20:23], a[204:207], v[44:47]
  ds_read_b64_tr_b16 a[38:39], v5 offset:5120
  v_mfma_f32_16x16x32_bf16 v[40:43], a[20:23], a[200:203], v[40:43]
  buffer_load_dwordx4 v252, s[84:87], s93 offen offset:1024 lds
  v_mfma_f32_16x16x32_bf16 v[40:43], a[4:7], a[192:195], v[40:43]
  s_waitcnt lgkmcnt(6)
  ds_read_b64_tr_b16 a[52:53], v5 offset:9216
  ds_read_b64_tr_b16 a[54:55], v5 offset:13312
  v_mfma_f32_16x16x32_bf16 v[48:51], a[8:11], a[192:195], v[48:51]
  ds_read_b64_tr_b16 a[40:41], v6 offset:1024
  v_mfma_f32_16x16x32_bf16 v[48:51], a[24:27], a[200:203], v[48:51]
  s_add_u32 s48, s48, 4096
  ds_read_b64_tr_b16 a[42:43], v6 offset:5120
  s_min_u32 s63, s88, 8192
  v_mfma_f32_16x16x32_bf16 v[52:55], a[24:27], a[204:207], v[52:55]
  s_sub_u32 s63, s48, s63
  buffer_load_dwordx4 a[128:131], v8, s[4:7], s63 offen offset:0 sc1
  v_mfma_f32_16x16x32_bf16 v[52:55], a[8:11], a[196:199], v[52:55]
  ds_read_b64_tr_b16 a[56:57], v6 offset:9216
  ds_read_b64_tr_b16 a[58:59], v6 offset:13312
  v_mfma_f32_16x16x32_bf16 v[60:63], a[12:15], a[196:199], v[60:63]
  ds_read_b64_tr_b16 a[44:45], v7 offset:1024
  v_mfma_f32_16x16x32_bf16 v[60:63], a[28:31], a[204:207], v[60:63]
  ds_read_b64_tr_b16 a[46:47], v7 offset:5120
  v_mfma_f32_16x16x32_bf16 v[56:59], a[28:31], a[200:203], v[56:59]
  buffer_load_dwordx4 a[132:135], v9, s[4:7], s63 offen offset:0 sc1
  v_mfma_f32_16x16x32_bf16 v[56:59], a[12:15], a[192:195], v[56:59]
  s_waitcnt lgkmcnt(6)
  ds_read_b64_tr_b16 a[60:61], v7 offset:9216
  ds_read_b64_tr_b16 a[62:63], v7 offset:13312
  v_mfma_f32_16x16x32_bf16 v[64:67], a[32:35], a[192:195], v[64:67]
  ds_read_b64_tr_b16 a[0:1], v4 offset:16384
  s_add_u32 m0, s79, 40960
  v_mfma_f32_16x16x32_bf16 v[64:67], a[48:51], a[200:203], v[64:67]
  s_add_u32 s92, s92, 262144
  ds_read_b64_tr_b16 a[2:3], v4 offset:20480
  s_sub_u32 s93, s92, s88
  v_mfma_f32_16x16x32_bf16 v[68:71], a[48:51], a[204:207], v[68:71]
  buffer_load_dwordx4 v252, s[80:83], s93 offen lds
  v_mfma_f32_16x16x32_bf16 v[68:71], a[32:35], a[196:199], v[68:71]
  ds_read_b64_tr_b16 a[16:17], v4 offset:24576
  ds_read_b64_tr_b16 a[18:19], v4 offset:28672
  v_mfma_f32_16x16x32_bf16 v[76:79], a[36:39], a[196:199], v[76:79]
  ds_read_b64_tr_b16 a[4:5], v5 offset:16384
  v_mfma_f32_16x16x32_bf16 v[76:79], a[52:55], a[204:207], v[76:79]
  ds_read_b64_tr_b16 a[6:7], v5 offset:20480
  v_mfma_f32_16x16x32_bf16 v[72:75], a[52:55], a[200:203], v[72:75]
  buffer_load_dwordx4 v252, s[84:87], s93 offen offset:1024 lds
  v_mfma_f32_16x16x32_bf16 v[72:75], a[36:39], a[192:195], v[72:75]
  s_waitcnt lgkmcnt(6)
  ds_read_b64_tr_b16 a[20:21], v5 offset:24576
  ds_read_b64_tr_b16 a[22:23], v5 offset:28672
  v_mfma_f32_16x16x32_bf16 v[80:83], a[40:43], a[192:195], v[80:83]
  ds_read_b64_tr_b16 a[8:9], v6 offset:16384
  v_mfma_f32_16x16x32_bf16 v[80:83], a[56:59], a[200:203], v[80:83]
  ds_read_b64_tr_b16 a[10:11], v6 offset:20480
  v_mfma_f32_16x16x32_bf16 v[84:87], a[56:59], a[204:207], v[84:87]
  buffer_load_dwordx4 a[136:139], v8, s[4:7], s63 offen offset:1024 sc1
  v_mfma_f32_16x16x32_bf16 v[84:87], a[40:43], a[196:199], v[84:87]
  ds_read_b64_tr_b16 a[24:25], v6 offset:24576
  ds_read_b64_tr_b16 a[26:27], v6 offset:28672
  v_mfma_f32_16x16x32_bf16 v[92:95], a[44:47], a[196:199], v[92:95]
  ds_read_b64_tr_b16 a[12:13], v7 offset:16384
  v_mfma_f32_16x16x32_bf16 v[92:95], a[60:63], a[204:207], v[92:95]
  ds_read_b64_tr_b16 a[14:15], v7 offset:20480
  v_mfma_f32_16x16x32_bf16 v[88:91], a[60:63], a[200:203], v[88:91]
  buffer_load_dwordx4 a[140:143], v9, s[4:7], s63 offen offset:1024 sc1
  v_mfma_f32_16x16x32_bf16 v[88:91], a[44:47], a[192:195], v[88:91]
  s_waitcnt vmcnt(24) lgkmcnt(6)
  ds_read_b64_tr_b16 a[28:29], v7 offset:24576
  ds_read_b64_tr_b16 a[30:31], v7 offset:28672
  v_mfma_f32_16x16x32_bf16 v[32:35], a[0:3], a[208:211], v[32:35]
  ds_read_b64_tr_b16 a[32:33], v4 offset:32768
  s_add_u32 m0, s79, 49152
  v_mfma_f32_16x16x32_bf16 v[32:35], a[16:19], a[216:219], v[32:35]
  s_add_u32 s92, s92, 196608
  ds_read_b64_tr_b16 a[34:35], v4 offset:36864
  s_sub_u32 s93, s92, s88
  v_mfma_f32_16x16x32_bf16 v[36:39], a[16:19], a[220:223], v[36:39]
  ds_read_b64_tr_b16 a[48:49], v4 offset:40960
  buffer_load_dwordx4 v252, s[80:83], s93 offen lds
  v_mfma_f32_16x16x32_bf16 v[36:39], a[0:3], a[212:215], v[36:39]
  ds_read_b64_tr_b16 a[50:51], v4 offset:45056
  v_mfma_f32_16x16x32_bf16 v[44:47], a[4:7], a[212:215], v[44:47]
  ds_read_b64_tr_b16 a[36:37], v5 offset:32768
  buffer_load_dwordx4 v252, s[84:87], s93 offen offset:1024 lds
  v_mfma_f32_16x16x32_bf16 v[44:47], a[20:23], a[220:223], v[44:47]
  ds_read_b64_tr_b16 a[38:39], v5 offset:36864
  v_mfma_f32_16x16x32_bf16 v[40:43], a[20:23], a[216:219], v[40:43]
  ds_read_b64_tr_b16 a[52:53], v5 offset:40960
  buffer_load_dwordx4 a[144:147], v8, s[4:7], s63 offen offset:2048 sc1
  v_mfma_f32_16x16x32_bf16 v[40:43], a[4:7], a[208:211], v[40:43]
  ds_read_b64_tr_b16 a[54:55], v5 offset:45056
  s_waitcnt lgkmcnt(8)
  v_mfma_f32_16x16x32_bf16 v[48:51], a[8:11], a[208:211], v[48:51]
  s_add_u32 m0, s79, 57344
  ds_read_b64_tr_b16 a[40:41], v6 offset:32768
  buffer_load_dwordx4 a[148:151], v9, s[4:7], s63 offen offset:2048 sc1
  v_mfma_f32_16x16x32_bf16 v[48:51], a[24:27], a[216:219], v[48:51]
  s_add_u32 s92, s92, 262144
  ds_read_b64_tr_b16 a[42:43], v6 offset:36864
  s_sub_u32 s93, s92, s88
  v_mfma_f32_16x16x32_bf16 v[52:55], a[24:27], a[220:223], v[52:55]
  ds_read_b64_tr_b16 a[56:57], v6 offset:40960
  buffer_load_dwordx4 v252, s[80:83], s93 offen lds
  v_mfma_f32_16x16x32_bf16 v[52:55], a[8:11], a[212:215], v[52:55]
  ds_read_b64_tr_b16 a[58:59], v6 offset:45056
  v_mfma_f32_16x16x32_bf16 v[60:63], a[12:15], a[212:215], v[60:63]
  ds_read_b64_tr_b16 a[44:45], v7 offset:32768
  buffer_load_dwordx4 v252, s[84:87], s93 offen offset:1024 lds
  v_mfma_f32_16x16x32_bf16 v[60:63], a[28:31], a[220:223], v[60:63]
  ds_read_b64_tr_b16 a[46:47], v7 offset:36864
  v_mfma_f32_16x16x32_bf16 v[56:59], a[28:31], a[216:219], v[56:59]
  ds_read_b64_tr_b16 a[60:61], v7 offset:40960
  buffer_load_dwordx4 a[152:155], v8, s[4:7], s63 offen offset:3072 sc1
  v_mfma_f32_16x16x32_bf16 v[56:59], a[12:15], a[208:211], v[56:59]
  s_waitcnt vmcnt(23) lgkmcnt(7)
  ds_read_b64_tr_b16 a[62:63], v7 offset:45056
  buffer_load_dwordx4 a[156:159], v9, s[4:7], s63 offen offset:3072 sc1
  v_mfma_f32_16x16x32_bf16 v[32:35], a[32:35], a[224:227], v[32:35]
  s_waitcnt vmcnt(26)
  s_barrier
  ds_read_b64_tr_b16 a[0:1], v4 offset:49152
  v_mfma_f32_16x16x32_bf16 v[32:35], a[48:51], a[232:235], v[32:35]
  s_add_u32 s48, s48, 4096
  ds_read_b64_tr_b16 a[2:3], v4 offset:53248
  s_min_u32 s63, s88, 8192
  v_mfma_f32_16x16x32_bf16 v[36:39], a[48:51], a[236:239], v[36:39]
  s_sub_u32 s63, s48, s63
  ds_read_b64_tr_b16 a[16:17], v4 offset:57344
  buffer_load_dwordx4 a[160:163], v8, s[4:7], s63 offen offset:0 sc1
  v_mfma_f32_16x16x32_bf16 v[36:39], a[32:35], a[228:231], v[36:39]
  ds_read_b64_tr_b16 a[18:19], v4 offset:61440
  v_mfma_f32_16x16x32_bf16 v[44:47], a[36:39], a[228:231], v[44:47]
  ds_read_b64_tr_b16 a[4:5], v5 offset:49152
  v_mfma_f32_16x16x32_bf16 v[44:47], a[52:55], a[236:239], v[44:47]
  ds_read_b64_tr_b16 a[6:7], v5 offset:53248
  v_mfma_f32_16x16x32_bf16 v[40:43], a[52:55], a[232:235], v[40:43]
  ds_read_b64_tr_b16 a[20:21], v5 offset:57344
  buffer_load_dwordx4 a[164:167], v9, s[4:7], s63 offen offset:0 sc1
  v_mfma_f32_16x16x32_bf16 v[40:43], a[36:39], a[224:227], v[40:43]
  ds_read_b64_tr_b16 a[22:23], v5 offset:61440
  s_waitcnt lgkmcnt(8)
  v_mfma_f32_16x16x32_bf16 v[48:51], a[40:43], a[224:227], v[48:51]
  ds_read_b64_tr_b16 a[8:9], v6 offset:49152
  v_mfma_f32_16x16x32_bf16 v[48:51], a[56:59], a[232:235], v[48:51]
  ds_read_b64_tr_b16 a[10:11], v6 offset:53248
  v_mfma_f32_16x16x32_bf16 v[52:55], a[56:59], a[236:239], v[52:55]
  ds_read_b64_tr_b16 a[24:25], v6 offset:57344
  buffer_load_dwordx4 a[168:171], v8, s[4:7], s63 offen offset:1024 sc1
  v_mfma_f32_16x16x32_bf16 v[52:55], a[40:43], a[228:231], v[52:55]
  ds_read_b64_tr_b16 a[26:27], v6 offset:61440
  v_mfma_f32_16x16x32_bf16 v[60:63], a[44:47], a[228:231], v[60:63]
  ds_read_b64_tr_b16 a[12:13], v7 offset:49152
  v_mfma_f32_16x16x32_bf16 v[60:63], a[60:63], a[236:239], v[60:63]
  ds_read_b64_tr_b16 a[14:15], v7 offset:53248
  v_mfma_f32_16x16x32_bf16 v[56:59], a[60:63], a[232:235], v[56:59]
  ds_read_b64_tr_b16 a[28:29], v7 offset:57344
  buffer_load_dwordx4 a[172:175], v9, s[4:7], s63 offen offset:1024 sc1
  v_mfma_f32_16x16x32_bf16 v[56:59], a[44:47], a[224:227], v[56:59]
  ds_read_b64_tr_b16 a[30:31], v7 offset:61440
  s_waitcnt vmcnt(20) lgkmcnt(8)
  v_mfma_f32_16x16x32_bf16 v[32:35], a[0:3], a[240:243], v[32:35]
  ds_read_b64_tr_b16 a[32:33], v0 offset:0
  v_mfma_f32_16x16x32_bf16 v[32:35], a[16:19], a[248:251], v[32:35]
  ds_read_b64_tr_b16 a[34:35], v0 offset:4096
  v_mfma_f32_16x16x32_bf16 v[36:39], a[16:19], a[252:255], v[36:39]
  ds_read_b64_tr_b16 a[48:49], v0 offset:8192
  buffer_load_dwordx4 a[176:179], v8, s[4:7], s63 offen offset:2048 sc1
  v_mfma_f32_16x16x32_bf16 v[36:39], a[0:3], a[244:247], v[36:39]
  ds_read_b64_tr_b16 a[50:51], v0 offset:12288
  v_mfma_f32_16x16x32_bf16 v[44:47], a[4:7], a[244:247], v[44:47]
  ds_read_b64_tr_b16 a[36:37], v1 offset:0
  v_mfma_f32_16x16x32_bf16 v[44:47], a[20:23], a[252:255], v[44:47]
  ds_read_b64_tr_b16 a[38:39], v1 offset:4096
  v_mfma_f32_16x16x32_bf16 v[40:43], a[20:23], a[248:251], v[40:43]
  ds_read_b64_tr_b16 a[52:53], v1 offset:8192
  buffer_load_dwordx4 a[180:183], v9, s[4:7], s63 offen offset:2048 sc1
  v_mfma_f32_16x16x32_bf16 v[40:43], a[4:7], a[240:243], v[40:43]
  ds_read_b64_tr_b16 a[54:55], v1 offset:12288
  s_waitcnt lgkmcnt(8)
  v_mfma_f32_16x16x32_bf16 v[48:51], a[8:11], a[240:243], v[48:51]
  ds_read_b64_tr_b16 a[40:41], v2 offset:0
  v_mfma_f32_16x16x32_bf16 v[48:51], a[24:27], a[248:251], v[48:51]
  ds_read_b64_tr_b16 a[42:43], v2 offset:4096
  v_mfma_f32_16x16x32_bf16 v[52:55], a[24:27], a[252:255], v[52:55]
  ds_read_b64_tr_b16 a[56:57], v2 offset:8192
  buffer_load_dwordx4 a[184:187], v8, s[4:7], s63 offen offset:3072 sc1
  v_mfma_f32_16x16x32_bf16 v[52:55], a[8:11], a[244:247], v[52:55]
  ds_read_b64_tr_b16 a[58:59], v2 offset:12288
  v_mfma_f32_16x16x32_bf16 v[60:63], a[12:15], a[244:247], v[60:63]
  ds_read_b64_tr_b16 a[44:45], v3 offset:0
  v_mfma_f32_16x16x32_bf16 v[60:63], a[28:31], a[252:255], v[60:63]
  ds_read_b64_tr_b16 a[46:47], v3 offset:4096
  v_mfma_f32_16x16x32_bf16 v[56:59], a[28:31], a[248:251], v[56:59]
  ds_read_b64_tr_b16 a[60:61], v3 offset:8192
  buffer_load_dwordx4 a[188:191], v9, s[4:7], s63 offen offset:3072 sc1
  v_mfma_f32_16x16x32_bf16 v[56:59], a[12:15], a[240:243], v[56:59]
  ds_read_b64_tr_b16 a[62:63], v3 offset:12288
  s_waitcnt vmcnt(16) lgkmcnt(8)
  v_mfma_f32_16x16x32_bf16 v[32:35], a[32:35], a[128:131], v[32:35]
  s_waitcnt vmcnt(18)
  s_barrier
  ds_read_b64_tr_b16 a[0:1], v0 offset:16384
  v_mfma_f32_16x16x32_bf16 v[32:35], a[48:51], a[136:139], v[32:35]
  ds_read_b64_tr_b16 a[2:3], v0 offset:20480
  v_mfma_f32_16x16x32_bf16 v[36:39], a[48:51], a[140:143], v[36:39]
  ds_read_b64_tr_b16 a[16:17], v0 offset:24576
  v_mfma_f32_16x16x32_bf16 v[36:39], a[32:35], a[132:135], v[36:39]
  ds_read_b64_tr_b16 a[18:19], v0 offset:28672
  v_mfma_f32_16x16x32_bf16 v[44:47], a[36:39], a[132:135], v[44:47]
  ds_read_b64_tr_b16 a[4:5], v1 offset:16384
  v_mfma_f32_16x16x32_bf16 v[44:47], a[52:55], a[140:143], v[44:47]
  ds_read_b64_tr_b16 a[6:7], v1 offset:20480
  v_mfma_f32_16x16x32_bf16 v[40:43], a[52:55], a[136:139], v[40:43]
  ds_read_b64_tr_b16 a[20:21], v1 offset:24576
  v_mfma_f32_16x16x32_bf16 v[40:43], a[36:39], a[128:131], v[40:43]
  ds_read_b64_tr_b16 a[22:23], v1 offset:28672
  s_waitcnt lgkmcnt(8)
  v_mfma_f32_16x16x32_bf16 v[48:51], a[40:43], a[128:131], v[48:51]
  ds_read_b64_tr_b16 a[8:9], v2 offset:16384
  v_mfma_f32_16x16x32_bf16 v[48:51], a[56:59], a[136:139], v[48:51]
  ds_read_b64_tr_b16 a[10:11], v2 offset:20480
  v_mfma_f32_16x16x32_bf16 v[52:55], a[56:59], a[140:143], v[52:55]
  ds_read_b64_tr_b16 a[24:25], v2 offset:24576
  v_mfma_f32_16x16x32_bf16 v[52:55], a[40:43], a[132:135], v[52:55]
  ds_read_b64_tr_b16 a[26:27], v2 offset:28672
  v_mfma_f32_16x16x32_bf16 v[60:63], a[44:47], a[132:135], v[60:63]
  ds_read_b64_tr_b16 a[12:13], v3 offset:16384
  v_mfma_f32_16x16x32_bf16 v[60:63], a[60:63], a[140:143], v[60:63]
  ds_read_b64_tr_b16 a[14:15], v3 offset:20480
  v_mfma_f32_16x16x32_bf16 v[56:59], a[60:63], a[136:139], v[56:59]
  ds_read_b64_tr_b16 a[28:29], v3 offset:24576
  v_mfma_f32_16x16x32_bf16 v[56:59], a[44:47], a[128:131], v[56:59]
  ds_read_b64_tr_b16 a[30:31], v3 offset:28672
  s_waitcnt vmcnt(8) lgkmcnt(8)
  v_mfma_f32_16x16x32_bf16 v[32:35], a[0:3], a[144:147], v[32:35]
  ds_read_b64_tr_b16 a[32:33], v0 offset:32768
  v_mfma_f32_16x16x32_bf16 v[32:35], a[16:19], a[152:155], v[32:35]
  ds_read_b64_tr_b16 a[34:35], v0 offset:36864
  v_mfma_f32_16x16x32_bf16 v[36:39], a[16:19], a[156:159], v[36:39]
  ds_read_b64_tr_b16 a[48:49], v0 offset:40960
  v_mfma_f32_16x16x32_bf16 v[36:39], a[0:3], a[148:151], v[36:39]
  ds_read_b64_tr_b16 a[50:51], v0 offset:45056
  v_mfma_f32_16x16x32_bf16 v[44:47], a[4:7], a[148:151], v[44:47]
  ds_read_b64_tr_b16 a[36:37], v1 offset:32768
  v_mfma_f32_16x16x32_bf16 v[44:47], a[20:23], a[156:159], v[44:47]
  ds_read_b64_tr_b16 a[38:39], v1 offset:36864
  v_mfma_f32_16x16x32_bf16 v[40:43], a[20:23], a[152:155], v[40:43]
  ds_read_b64_tr_b16 a[52:53], v1 offset:40960
  v_mfma_f32_16x16x32_bf16 v[40:43], a[4:7], a[144:147], v[40:43]
  ds_read_b64_tr_b16 a[54:55], v1 offset:45056
  s_waitcnt lgkmcnt(8)
  v_mfma_f32_16x16x32_bf16 v[48:51], a[8:11], a[144:147], v[48:51]
  ds_read_b64_tr_b16 a[40:41], v2 offset:32768
  v_mfma_f32_16x16x32_bf16 v[48:51], a[24:27], a[152:155], v[48:51]
  ds_read_b64_tr_b16 a[42:43], v2 offset:36864
  v_mfma_f32_16x16x32_bf16 v[52:55], a[24:27], a[156:159], v[52:55]
  ds_read_b64_tr_b16 a[56:57], v2 offset:40960
  v_mfma_f32_16x16x32_bf16 v[52:55], a[8:11], a[148:151], v[52:55]
  ds_read_b64_tr_b16 a[58:59], v2 offset:45056
  v_mfma_f32_16x16x32_bf16 v[60:63], a[12:15], a[148:151], v[60:63]
  ds_read_b64_tr_b16 a[44:45], v3 offset:32768
  v_mfma_f32_16x16x32_bf16 v[60:63], a[28:31], a[156:159], v[60:63]
  ds_read_b64_tr_b16 a[46:47], v3 offset:36864
  v_mfma_f32_16x16x32_bf16 v[56:59], a[28:31], a[152:155], v[56:59]
  ds_read_b64_tr_b16 a[60:61], v3 offset:40960
  v_mfma_f32_16x16x32_bf16 v[56:59], a[12:15], a[144:147], v[56:59]
  ds_read_b64_tr_b16 a[62:63], v3 offset:45056
  s_waitcnt vmcnt(4) lgkmcnt(8)
  v_mfma_f32_16x16x32_bf16 v[32:35], a[32:35], a[160:163], v[32:35]
  s_waitcnt vmcnt(10)
  s_barrier
  ds_read_b64_tr_b16 a[0:1], v0 offset:49152
  v_mfma_f32_16x16x32_bf16 v[32:35], a[48:51], a[168:171], v[32:35]
  ds_read_b64_tr_b16 a[2:3], v0 offset:53248
  v_mfma_f32_16x16x32_bf16 v[36:39], a[48:51], a[172:175], v[36:39]
  ds_read_b64_tr_b16 a[16:17], v0 offset:57344
  v_mfma_f32_16x16x32_bf16 v[36:39], a[32:35], a[164:167], v[36:39]
  ds_read_b64_tr_b16 a[18:19], v0 offset:61440
  v_mfma_f32_16x16x32_bf16 v[44:47], a[36:39], a[164:167], v[44:47]
  ds_read_b64_tr_b16 a[4:5], v1 offset:49152
  v_mfma_f32_16x16x32_bf16 v[44:47], a[52:55], a[172:175], v[44:47]
  ds_read_b64_tr_b16 a[6:7], v1 offset:53248
  v_mfma_f32_16x16x32_bf16 v[40:43], a[52:55], a[168:171], v[40:43]
  ds_read_b64_tr_b16 a[20:21], v1 offset:57344
  v_mfma_f32_16x16x32_bf16 v[40:43], a[36:39], a[160:163], v[40:43]
  ds_read_b64_tr_b16 a[22:23], v1 offset:61440
  s_waitcnt lgkmcnt(8)
  v_mfma_f32_16x16x32_bf16 v[48:51], a[40:43], a[160:163], v[48:51]
  ds_read_b64_tr_b16 a[8:9], v2 offset:49152
  v_mfma_f32_16x16x32_bf16 v[48:51], a[56:59], a[168:171], v[48:51]
  ds_read_b64_tr_b16 a[10:11], v2 offset:53248
  v_mfma_f32_16x16x32_bf16 v[52:55], a[56:59], a[172:175], v[52:55]
  ds_read_b64_tr_b16 a[24:25], v2 offset:57344
  v_mfma_f32_16x16x32_bf16 v[52:55], a[40:43], a[164:167], v[52:55]
  ds_read_b64_tr_b16 a[26:27], v2 offset:61440
  v_mfma_f32_16x16x32_bf16 v[60:63], a[44:47], a[164:167], v[60:63]
  ds_read_b64_tr_b16 a[12:13], v3 offset:49152
  v_mfma_f32_16x16x32_bf16 v[60:63], a[60:63], a[172:175], v[60:63]
  ds_read_b64_tr_b16 a[14:15], v3 offset:53248
  v_mfma_f32_16x16x32_bf16 v[56:59], a[60:63], a[168:171], v[56:59]
  ds_read_b64_tr_b16 a[28:29], v3 offset:57344
  v_mfma_f32_16x16x32_bf16 v[56:59], a[44:47], a[160:163], v[56:59]
  ds_read_b64_tr_b16 a[30:31], v3 offset:61440
  s_waitcnt vmcnt(0) lgkmcnt(8)
  v_mfma_f32_16x16x32_bf16 v[32:35], a[0:3], a[176:179], v[32:35]
  ds_read_b64_tr_b16 a[32:33], v4 offset:17408
  v_mfma_f32_16x16x32_bf16 v[32:35], a[16:19], a[184:187], v[32:35]
  ds_read_b64_tr_b16 a[34:35], v4 offset:21504
  v_mfma_f32_16x16x32_bf16 v[36:39], a[16:19], a[188:191], v[36:39]
  ds_read_b64_tr_b16 a[48:49], v4 offset:25600
  v_mfma_f32_16x16x32_bf16 v[36:39], a[0:3], a[180:183], v[36:39]
  ds_read_b64_tr_b16 a[50:51], v4 offset:29696
  v_mfma_f32_16x16x32_bf16 v[44:47], a[4:7], a[180:183], v[44:47]
  ds_read_b64_tr_b16 a[36:37], v5 offset:17408
  v_mfma_f32_16x16x32_bf16 v[44:47], a[20:23], a[188:191], v[44:47]
  ds_read_b64_tr_b16 a[38:39], v5 offset:21504
  v_mfma_f32_16x16x32_bf16 v[40:43], a[20:23], a[184:187], v[40:43]
  ds_read_b64_tr_b16 a[52:53], v5 offset:25600
  v_mfma_f32_16x16x32_bf16 v[40:43], a[4:7], a[176:179], v[40:43]
  ds_read_b64_tr_b16 a[54:55], v5 offset:29696
  s_waitcnt lgkmcnt(8)
  v_mfma_f32_16x16x32_bf16 v[48:51], a[8:11], a[176:179], v[48:51]
  ds_read_b64_tr_b16 a[40:41], v6 offset:17408
  v_mfma_f32_16x16x32_bf16 v[48:51], a[24:27], a[184:187], v[48:51]
  ds_read_b64_tr_b16 a[42:43], v6 offset:21504
  v_mfma_f32_16x16x32_bf16 v[52:55], a[24:27], a[188:191], v[52:55]
  ds_read_b64_tr_b16 a[56:57], v6 offset:25600
  v_mfma_f32_16x16x32_bf16 v[52:55], a[8:11], a[180:183], v[52:55]
  ds_read_b64_tr_b16 a[58:59], v6 offset:29696
  v_mfma_f32_16x16x32_bf16 v[60:63], a[12:15], a[180:183], v[60:63]
  ds_read_b64_tr_b16 a[44:45], v7 offset:17408
  v_mfma_f32_16x16x32_bf16 v[60:63], a[28:31], a[188:191], v[60:63]
  ds_read_b64_tr_b16 a[46:47], v7 offset:21504
  v_mfma_f32_16x16x32_bf16 v[56:59], a[28:31], a[184:187], v[56:59]
  ds_read_b64_tr_b16 a[60:61], v7 offset:25600
  v_mfma_f32_16x16x32_bf16 v[56:59], a[12:15], a[176:179], v[56:59]
  ds_read_b64_tr_b16 a[62:63], v7 offset:29696
  s_waitcnt lgkmcnt(8)
  v_mfma_f32_16x16x32_bf16 v[64:67], a[32:35], a[208:211], v[64:67]
  s_lshl_b32 s45, s2, 2
  ds_read_b64_tr_b16 a[0:1], v4 offset:33792
  s_add_u32 s45, s45, s40
  v_mfma_f32_16x16x32_bf16 v[64:67], a[48:51], a[216:219], v[64:67]
  s_lshl_b32 s45, s45, 12
  ds_read_b64_tr_b16 a[2:3], v4 offset:37888
  s_xor_b32 s44, s45, 32768
  v_mfma_f32_16x16x32_bf16 v[68:71], a[48:51], a[220:223], v[68:71]
  s_add_u32 s43, s42, 28311552
  ds_read_b64_tr_b16 a[16:17], v4 offset:41984
  s_add_u32 s44, s44, s43
  v_mfma_f32_16x16x32_bf16 v[68:71], a[32:35], a[212:215], v[68:71]
  s_add_u32 s45, s45, s43
  ds_read_b64_tr_b16 a[18:19], v4 offset:46080
  v_cvt_pk_bf16_f32 v16, v32, v33
  v_mfma_f32_16x16x32_bf16 v[76:79], a[36:39], a[212:215], v[76:79]
  ds_read_b64_tr_b16 a[4:5], v5 offset:33792
  v_cvt_pk_bf16_f32 v17, v34, v35
  v_mfma_f32_16x16x32_bf16 v[76:79], a[52:55], a[220:223], v[76:79]
  ds_read_b64_tr_b16 a[6:7], v5 offset:37888
  v_cvt_pk_bf16_f32 v18, v40, v41
  v_cvt_pk_bf16_f32 v19, v42, v43
  v_mfma_f32_16x16x32_bf16 v[72:75], a[52:55], a[216:219], v[72:75]
  buffer_store_dwordx4 v[16:19], v8, s[4:7], s44 offen offset:0 sc1
  ds_read_b64_tr_b16 a[20:21], v5 offset:41984
  v_cvt_pk_bf16_f32 v24, v36, v37
  v_cvt_pk_bf16_f32 v25, v38, v39
  v_mfma_f32_16x16x32_bf16 v[72:75], a[36:39], a[208:211], v[72:75]
  s_waitcnt lgkmcnt(7)
  ds_read_b64_tr_b16 a[22:23], v5 offset:46080
  v_cvt_pk_bf16_f32 v26, v44, v45
  v_cvt_pk_bf16_f32 v27, v46, v47
  v_mfma_f32_16x16x32_bf16 v[80:83], a[40:43], a[208:211], v[80:83]
  ds_read_b64_tr_b16 a[8:9], v6 offset:33792
  buffer_store_dwordx4 v[24:27], v8, s[4:7], s44 offen offset:2048 sc1
  v_cvt_pk_bf16_f32 v20, v48, v49
  v_mfma_f32_16x16x32_bf16 v[80:83], a[56:59], a[216:219], v[80:83]
  ds_read_b64_tr_b16 a[10:11], v6 offset:37888
  v_cvt_pk_bf16_f32 v21, v50, v51
  v_mfma_f32_16x16x32_bf16 v[84:87], a[56:59], a[220:223], v[84:87]
  ds_read_b64_tr_b16 a[24:25], v6 offset:41984
  v_cvt_pk_bf16_f32 v22, v56, v57
  v_cvt_pk_bf16_f32 v23, v58, v59
  v_mfma_f32_16x16x32_bf16 v[84:87], a[40:43], a[212:215], v[84:87]
  buffer_store_dwordx4 v[20:23], v8, s[4:7], s44 offen offset:1024 sc1
  ds_read_b64_tr_b16 a[26:27], v6 offset:46080
  v_cvt_pk_bf16_f32 v28, v52, v53
  v_cvt_pk_bf16_f32 v29, v54, v55
  v_mfma_f32_16x16x32_bf16 v[92:95], a[44:47], a[212:215], v[92:95]
  ds_read_b64_tr_b16 a[12:13], v7 offset:33792
  v_cvt_pk_bf16_f32 v30, v60, v61
  v_cvt_pk_bf16_f32 v31, v62, v63
  v_mfma_f32_16x16x32_bf16 v[92:95], a[60:63], a[220:223], v[92:95]
  ds_read_b64_tr_b16 a[14:15], v7 offset:37888
  buffer_store_dwordx4 v[28:31], v8, s[4:7], s44 offen offset:3072 sc1
  v_mfma_f32_16x16x32_bf16 v[88:91], a[60:63], a[216:219], v[88:91]
  ds_read_b64_tr_b16 a[28:29], v7 offset:41984
  v_mfma_f32_16x16x32_bf16 v[88:91], a[44:47], a[208:211], v[88:91]
  ds_read_b64_tr_b16 a[30:31], v7 offset:46080
  s_waitcnt lgkmcnt(8)
  v_mfma_f32_16x16x32_bf16 v[64:67], a[0:3], a[224:227], v[64:67]
  ds_read_b64_tr_b16 a[32:33], v4 offset:50176
  v_and_b32 v148, 15, v253
  v_mfma_f32_16x16x32_bf16 v[64:67], a[16:19], a[232:235], v[64:67]
  ds_read_b64_tr_b16 a[34:35], v4 offset:54272
  v_lshrrev_b32 v149, 4, v253
  v_mfma_f32_16x16x32_bf16 v[68:71], a[16:19], a[236:239], v[68:71]
  ds_read_b64_tr_b16 a[48:49], v4 offset:58368
  v_lshrrev_b32 v128, 2, v148
  v_mfma_f32_16x16x32_bf16 v[68:71], a[0:3], a[228:231], v[68:71]
  ds_read_b64_tr_b16 a[50:51], v4 offset:62464
  v_cmp_eq_u32 vcc, v128, v149
  v_mfma_f32_16x16x32_bf16 v[76:79], a[4:7], a[228:231], v[76:79]
  ds_read_b64_tr_b16 a[36:37], v5 offset:50176
  v_and_b32 v128, 3, v148
  v_mfma_f32_16x16x32_bf16 v[76:79], a[20:23], a[236:239], v[76:79]
  ds_read_b64_tr_b16 a[38:39], v5 offset:54272
  v_lshlrev_b32 v148, 3, v148
  v_mfma_f32_16x16x32_bf16 v[72:75], a[20:23], a[232:235], v[72:75]
  ds_read_b64_tr_b16 a[52:53], v5 offset:58368
  v_mov_b32 v149, 0x7ffffff0
  v_mfma_f32_16x16x32_bf16 v[72:75], a[4:7], a[224:227], v[72:75]
  s_waitcnt lgkmcnt(7)
  ds_read_b64_tr_b16 a[54:55], v5 offset:62464
  v_cndmask_b32 v148, v149, v148, vcc
  v_mfma_f32_16x16x32_bf16 v[80:83], a[8:11], a[224:227], v[80:83]
  ds_read_b64_tr_b16 a[40:41], v6 offset:50176
  v_cmp_eq_u32 s[66:67], 1, v128
  v_mfma_f32_16x16x32_bf16 v[80:83], a[24:27], a[232:235], v[80:83]
  ds_read_b64_tr_b16 a[42:43], v6 offset:54272
  v_cmp_eq_u32 s[68:69], 2, v128
  v_mfma_f32_16x16x32_bf16 v[84:87], a[24:27], a[236:239], v[84:87]
  ds_read_b64_tr_b16 a[56:57], v6 offset:58368
  v_cmp_eq_u32 s[70:71], 3, v128
  v_mfma_f32_16x16x32_bf16 v[84:87], a[8:11], a[228:231], v[84:87]
  ds_read_b64_tr_b16 a[58:59], v6 offset:62464
  v_mov_b32 v128, 0x3f803f80
  v_mfma_f32_16x16x32_bf16 v[92:95], a[12:15], a[228:231], v[92:95]
  ds_read_b64_tr_b16 a[44:45], v7 offset:50176
  v_mov_b32 v129, 0x3f803f80
  v_mfma_f32_16x16x32_bf16 v[92:95], a[28:31], a[236:239], v[92:95]
  ds_read_b64_tr_b16 a[46:47], v7 offset:54272
  v_mov_b32 v130, 0x3f803f80
  v_mfma_f32_16x16x32_bf16 v[88:91], a[28:31], a[232:235], v[88:91]
  ds_read_b64_tr_b16 a[60:61], v7 offset:58368
  v_mov_b32 v131, 0x3f803f80
  v_mfma_f32_16x16x32_bf16 v[88:91], a[12:15], a[224:227], v[88:91]
  ds_read_b64_tr_b16 a[62:63], v7 offset:62464
  s_waitcnt lgkmcnt(8)
  v_mfma_f32_16x16x32_bf16 v[64:67], a[32:35], a[240:243], v[64:67]
  ds_read_b64_tr_b16 a[0:1], v0 offset:1024
  v_and_b32 v152, 15, v253
  v_lshrrev_b32 v153, 4, v253
  v_mfma_f32_16x16x32_bf16 v[64:67], a[48:51], a[248:251], v[64:67]
  ds_read_b64_tr_b16 a[2:3], v0 offset:5120
  v_lshrrev_b32 v155, 1, v153
  v_and_b32 v153, 1, v153
  v_mfma_f32_16x16x32_bf16 v[68:71], a[48:51], a[252:255], v[68:71]
  ds_read_b64_tr_b16 a[16:17], v0 offset:9216
  v_lshl_add_u32 v153, v153, 1, v155
  v_and_b32 v155, 7, v253
  v_mfma_f32_16x16x32_bf16 v[68:71], a[32:35], a[244:247], v[68:71]
  ds_read_b64_tr_b16 a[18:19], v0 offset:13312
  v_xor_b32 v153, v153, v155
  v_lshlrev_b32 v153, 4, v153
  v_mfma_f32_16x16x32_bf16 v[76:79], a[36:39], a[244:247], v[76:79]
  s_lshl_b32 s43, s40, 12
  ds_read_b64_tr_b16 a[4:5], v1 offset:1024
  v_lshl_add_u32 v152, v152, 7, v153
  v_mfma_f32_16x16x32_bf16 v[76:79], a[52:55], a[252:255], v[76:79]
  ds_read_b64_tr_b16 a[6:7], v1 offset:5120
  v_add_u32 v152, s43, v152
  v_xor_b32 v153, 64, v152
  v_mfma_f32_16x16x32_bf16 v[72:75], a[52:55], a[248:251], v[72:75]
  ds_read_b64_tr_b16 a[20:21], v1 offset:9216
  v_lshrrev_b32 v156, 3, v253
  v_xor_b32 v154, v156, v155
  v_mfma_f32_16x16x32_bf16 v[72:75], a[36:39], a[240:243], v[72:75]
  s_waitcnt lgkmcnt(7)
  ds_read_b64_tr_b16 a[22:23], v1 offset:13312
  v_lshlrev_b32 v154, 4, v154
  v_lshl_add_u32 v154, v156, 7, v154
  v_mfma_f32_16x16x32_bf16 v[80:83], a[40:43], a[240:243], v[80:83]
  ds_read_b64_tr_b16 a[8:9], v2 offset:1024
  v_add_u32 v154, s43, v154
  v_mfma_f32_16x16x32_bf16 v[80:83], a[56:59], a[248:251], v[80:83]
  ds_read_b64_tr_b16 a[10:11], v2 offset:5120
  v_lshlrev_b32 v155, 4, v155
  v_mfma_f32_16x16x32_bf16 v[84:87], a[56:59], a[252:255], v[84:87]
  ds_read_b64_tr_b16 a[24:25], v2 offset:9216
  v_lshl_add_u32 v155, v156, 12, v155
  v_mfma_f32_16x16x32_bf16 v[84:87], a[40:43], a[244:247], v[84:87]
  ds_read_b64_tr_b16 a[26:27], v2 offset:13312
  v_mfma_f32_16x16x32_bf16 v[92:95], a[44:47], a[244:247], v[92:95]
  ds_read_b64_tr_b16 a[12:13], v3 offset:1024
  v_mfma_f32_16x16x32_bf16 v[92:95], a[60:63], a[252:255], v[92:95]
  ds_read_b64_tr_b16 a[14:15], v3 offset:5120
  v_mfma_f32_16x16x32_bf16 v[88:91], a[60:63], a[248:251], v[88:91]
  ds_read_b64_tr_b16 a[28:29], v3 offset:9216
  v_mfma_f32_16x16x32_bf16 v[88:91], a[44:47], a[240:243], v[88:91]
  ds_read_b64_tr_b16 a[30:31], v3 offset:13312
  s_waitcnt lgkmcnt(8)
  v_mfma_f32_16x16x32_bf16 v[64:67], a[0:3], a[128:131], v[64:67]
  s_add_u32 s46, s76, 41943040
  ds_read_b64_tr_b16 a[32:33], v0 offset:17408
  s_add_u32 s47, s46, 32768
  v_mfma_f32_16x16x32_bf16 v[64:67], a[16:19], a[136:139], v[64:67]
  s_lshl_b32 s48, s49, 11
  ds_read_b64_tr_b16 a[34:35], v0 offset:21504
  s_lshl_b32 s43, s53, 7
  v_mfma_f32_16x16x32_bf16 v[68:71], a[16:19], a[140:143], v[68:71]
  s_add_u32 s48, s48, s43
  ds_read_b64_tr_b16 a[48:49], v0 offset:25600
  s_add_u32 s48, s48, 69206016
  v_mfma_f32_16x16x32_bf16 v[68:71], a[0:3], a[132:135], v[68:71]
  s_and_b32 s57, s49, 63
  ds_read_b64_tr_b16 a[50:51], v0 offset:29696
  s_lshl_b32 s57, s57, 16
  v_mfma_f32_16x16x32_bf16 v[76:79], a[4:7], a[132:135], v[76:79]
  s_add_u32 s57, s57, s43
  ds_read_b64_tr_b16 a[36:37], v1 offset:17408
  s_lshr_b32 s43, s49, 6
  v_mfma_f32_16x16x32_bf16 v[76:79], a[20:23], a[140:143], v[76:79]
  s_lshl_b32 s43, s43, 11
  ds_read_b64_tr_b16 a[38:39], v1 offset:21504
  s_add_u32 s57, s57, s43
  v_mfma_f32_16x16x32_bf16 v[72:75], a[20:23], a[136:139], v[72:75]
  s_and_b32 s43, s53, 0
  ds_read_b64_tr_b16 a[52:53], v1 offset:25600
  s_mul_i32 s77, s52, 1
  v_mfma_f32_16x16x32_bf16 v[72:75], a[4:7], a[128:131], v[72:75]
  s_add_u32 s77, s77, s43
  ds_read_b64_tr_b16 a[54:55], v1 offset:29696
  s_lshl_b32 s77, s77, 7
  s_waitcnt lgkmcnt(8)
  v_mfma_f32_16x16x32_bf16 v[80:83], a[8:11], a[128:131], v[80:83]
  ds_read_b64_tr_b16 a[40:41], v2 offset:17408
  s_add_u32 s77, s77, 27815936
  v_mfma_f32_16x16x32_bf16 v[80:83], a[24:27], a[136:139], v[80:83]
  ds_read_b64_tr_b16 a[42:43], v2 offset:21504
  v_mfma_f32_16x16x32_bf16 v[84:87], a[24:27], a[140:143], v[84:87]
  ds_read_b64_tr_b16 a[56:57], v2 offset:25600
  v_mfma_f32_16x16x32_bf16 v[84:87], a[8:11], a[132:135], v[84:87]
  ds_read_b64_tr_b16 a[58:59], v2 offset:29696
  v_mfma_f32_16x16x32_bf16 v[92:95], a[12:15], a[132:135], v[92:95]
  ds_read_b64_tr_b16 a[44:45], v3 offset:17408
  v_mfma_f32_16x16x32_bf16 v[92:95], a[28:31], a[140:143], v[92:95]
  ds_read_b64_tr_b16 a[46:47], v3 offset:21504
  v_mfma_f32_16x16x32_bf16 v[88:91], a[28:31], a[136:139], v[88:91]
  ds_read_b64_tr_b16 a[60:61], v3 offset:25600
  v_mfma_f32_16x16x32_bf16 v[88:91], a[12:15], a[128:131], v[88:91]
  ds_read_b64_tr_b16 a[62:63], v3 offset:29696
  s_waitcnt lgkmcnt(8)
  v_mfma_f32_16x16x32_bf16 v[64:67], a[32:35], a[144:147], v[64:67]
  ds_read_b64_tr_b16 a[0:1], v0 offset:33792
  v_mfma_f32_16x16x32_bf16 v[64:67], a[48:51], a[152:155], v[64:67]
  ds_read_b64_tr_b16 a[2:3], v0 offset:37888
  v_mfma_f32_16x16x32_bf16 v[68:71], a[48:51], a[156:159], v[68:71]
  ds_read_b64_tr_b16 a[16:17], v0 offset:41984
  v_mfma_f32_16x16x32_bf16 v[68:71], a[32:35], a[148:151], v[68:71]
  ds_read_b64_tr_b16 a[18:19], v0 offset:46080
  v_mfma_f32_16x16x32_bf16 v[76:79], a[36:39], a[148:151], v[76:79]
  ds_read_b64_tr_b16 a[4:5], v1 offset:33792
  buffer_load_dwordx4 v[96:99], v8, s[4:7], s45 offen offset:0 sc1
  v_mfma_f32_16x16x32_bf16 v[76:79], a[52:55], a[156:159], v[76:79]
  buffer_load_dwordx4 v[100:103], v8, s[4:7], s45 offen offset:1024 sc1
  ds_read_b64_tr_b16 a[6:7], v1 offset:37888
  v_mfma_f32_16x16x32_bf16 v[72:75], a[52:55], a[152:155], v[72:75]
  ds_read_b64_tr_b16 a[20:21], v1 offset:41984
  buffer_load_dwordx4 v[104:107], v8, s[4:7], s45 offen offset:2048 sc1
  buffer_load_dwordx4 v[108:111], v8, s[4:7], s45 offen offset:3072 sc1
  v_mfma_f32_16x16x32_bf16 v[72:75], a[36:39], a[144:147], v[72:75]
  ds_read_b64_tr_b16 a[22:23], v1 offset:46080
  s_waitcnt lgkmcnt(8)
  v_mfma_f32_16x16x32_bf16 v[80:83], a[40:43], a[144:147], v[80:83]
  ds_read_b64_tr_b16 a[8:9], v2 offset:33792
  v_mfma_f32_16x16x32_bf16 v[80:83], a[56:59], a[152:155], v[80:83]
  ds_read_b64_tr_b16 a[10:11], v2 offset:37888
  v_mfma_f32_16x16x32_bf16 v[84:87], a[56:59], a[156:159], v[84:87]
  ds_read_b64_tr_b16 a[24:25], v2 offset:41984
  v_mfma_f32_16x16x32_bf16 v[84:87], a[40:43], a[148:151], v[84:87]
  ds_read_b64_tr_b16 a[26:27], v2 offset:46080
  v_mfma_f32_16x16x32_bf16 v[92:95], a[44:47], a[148:151], v[92:95]
  ds_read_b64_tr_b16 a[12:13], v3 offset:33792
  v_mfma_f32_16x16x32_bf16 v[92:95], a[60:63], a[156:159], v[92:95]
  ds_read_b64_tr_b16 a[14:15], v3 offset:37888
  v_mfma_f32_16x16x32_bf16 v[88:91], a[60:63], a[152:155], v[88:91]
  ds_read_b64_tr_b16 a[28:29], v3 offset:41984
  v_mfma_f32_16x16x32_bf16 v[88:91], a[44:47], a[144:147], v[88:91]
  ds_read_b64_tr_b16 a[30:31], v3 offset:46080
  s_waitcnt lgkmcnt(8)
  v_mfma_f32_16x16x32_bf16 v[64:67], a[0:3], a[160:163], v[64:67]
  ds_read_b64_tr_b16 a[32:33], v0 offset:50176
  v_mfma_f32_16x16x32_bf16 v[64:67], a[16:19], a[168:171], v[64:67]
  ds_read_b64_tr_b16 a[34:35], v0 offset:54272
  v_mfma_f32_16x16x32_bf16 v[68:71], a[16:19], a[172:175], v[68:71]
  ds_read_b64_tr_b16 a[48:49], v0 offset:58368
  v_mfma_f32_16x16x32_bf16 v[68:71], a[0:3], a[164:167], v[68:71]
  ds_read_b64_tr_b16 a[50:51], v0 offset:62464
  v_mfma_f32_16x16x32_bf16 v[76:79], a[4:7], a[164:167], v[76:79]
  ds_read_b64_tr_b16 a[36:37], v1 offset:50176
  v_mfma_f32_16x16x32_bf16 v[76:79], a[20:23], a[172:175], v[76:79]
  ds_read_b64_tr_b16 a[38:39], v1 offset:54272
  v_mfma_f32_16x16x32_bf16 v[72:75], a[20:23], a[168:171], v[72:75]
  ds_read_b64_tr_b16 a[52:53], v1 offset:58368
  v_mfma_f32_16x16x32_bf16 v[72:75], a[4:7], a[160:163], v[72:75]
  ds_read_b64_tr_b16 a[54:55], v1 offset:62464
  s_waitcnt lgkmcnt(8)
  v_mfma_f32_16x16x32_bf16 v[80:83], a[8:11], a[160:163], v[80:83]
  ds_read_b64_tr_b16 a[40:41], v2 offset:50176
  v_mfma_f32_16x16x32_bf16 v[80:83], a[24:27], a[168:171], v[80:83]
  ds_read_b64_tr_b16 a[42:43], v2 offset:54272
  v_mfma_f32_16x16x32_bf16 v[84:87], a[24:27], a[172:175], v[84:87]
  ds_read_b64_tr_b16 a[56:57], v2 offset:58368
  v_mfma_f32_16x16x32_bf16 v[84:87], a[8:11], a[164:167], v[84:87]
  ds_read_b64_tr_b16 a[58:59], v2 offset:62464
  v_mfma_f32_16x16x32_bf16 v[92:95], a[12:15], a[164:167], v[92:95]
  ds_read_b64_tr_b16 a[44:45], v3 offset:50176
  v_mfma_f32_16x16x32_bf16 v[92:95], a[28:31], a[172:175], v[92:95]
  ds_read_b64_tr_b16 a[46:47], v3 offset:54272
  v_mfma_f32_16x16x32_bf16 v[88:91], a[28:31], a[168:171], v[88:91]
  ds_read_b64_tr_b16 a[60:61], v3 offset:58368
  v_mfma_f32_16x16x32_bf16 v[88:91], a[12:15], a[160:163], v[88:91]
  s_waitcnt vmcnt(0)
  ds_read_b64_tr_b16 a[62:63], v3 offset:62464
  v_max3_u32 v112, v96, v97, v98
  v_max3_u32 v113, v99, v100, v101
  v_max3_u32 v112, v112, v102, v103
  v_max3_u32 v113, v113, v104, v105
  v_max3_u32 v112, v112, v106, v107
  v_max3_u32 v113, v113, v108, v109
  v_max3_u32 v112, v112, v110, v111
  v_max_u32 v112, v112, v113
  v_cmp_eq_u32 vcc, -1, v112
  s_cbranch_vccnz Lp4_mb_c
Lp4_mb_r:
  s_waitcnt lgkmcnt(8)
  v_mfma_f32_16x16x32_bf16 v[64:67], a[32:35], a[176:179], v[64:67]
  v_lshlrev_b32 v32, 16, v96
  v_and_b32 v33, 0xffff0000, v96
  v_mfma_f32_16x16x32_bf16 v[64:67], a[48:51], a[184:187], v[64:67]
  v_lshlrev_b32 v34, 16, v97
  v_and_b32 v35, 0xffff0000, v97
  v_mfma_f32_16x16x32_bf16 v[68:71], a[48:51], a[188:191], v[68:71]
  v_lshlrev_b32 v40, 16, v98
  v_and_b32 v41, 0xffff0000, v98
  v_mfma_f32_16x16x32_bf16 v[68:71], a[32:35], a[180:183], v[68:71]
  v_lshlrev_b32 v42, 16, v99
  v_and_b32 v43, 0xffff0000, v99
  v_mfma_f32_16x16x32_bf16 v[76:79], a[36:39], a[180:183], v[76:79]
  v_lshlrev_b32 v36, 16, v104
  v_and_b32 v37, 0xffff0000, v104
  v_mfma_f32_16x16x32_bf16 v[76:79], a[52:55], a[188:191], v[76:79]
  v_lshlrev_b32 v38, 16, v105
  v_and_b32 v39, 0xffff0000, v105
  v_mfma_f32_16x16x32_bf16 v[72:75], a[52:55], a[184:187], v[72:75]
  v_lshlrev_b32 v44, 16, v106
  v_and_b32 v45, 0xffff0000, v106
  v_mfma_f32_16x16x32_bf16 v[72:75], a[36:39], a[176:179], v[72:75]
  s_waitcnt lgkmcnt(0)
  v_lshlrev_b32 v46, 16, v107
  v_and_b32 v47, 0xffff0000, v107
  v_mfma_f32_16x16x32_bf16 v[80:83], a[40:43], a[176:179], v[80:83]
  v_lshlrev_b32 v48, 16, v100
  v_and_b32 v49, 0xffff0000, v100
  v_mfma_f32_16x16x32_bf16 v[80:83], a[56:59], a[184:187], v[80:83]
  s_barrier
  v_lshlrev_b32 v50, 16, v101
  v_mfma_f32_16x16x32_bf16 v[84:87], a[56:59], a[188:191], v[84:87]
  v_and_b32 v51, 0xffff0000, v101
  v_lshlrev_b32 v56, 16, v102
  v_mfma_f32_16x16x32_bf16 v[84:87], a[40:43], a[180:183], v[84:87]
  v_and_b32 v57, 0xffff0000, v102
  v_lshlrev_b32 v58, 16, v103
  v_mfma_f32_16x16x32_bf16 v[92:95], a[44:47], a[180:183], v[92:95]
  v_and_b32 v59, 0xffff0000, v103
  v_lshlrev_b32 v52, 16, v108
  v_mfma_f32_16x16x32_bf16 v[92:95], a[60:63], a[188:191], v[92:95]
  v_and_b32 v53, 0xffff0000, v108
  v_lshlrev_b32 v54, 16, v109
  v_mfma_f32_16x16x32_bf16 v[88:91], a[60:63], a[184:187], v[88:91]
  v_and_b32 v55, 0xffff0000, v109
  v_lshlrev_b32 v60, 16, v110
  v_mfma_f32_16x16x32_bf16 v[88:91], a[44:47], a[176:179], v[88:91]
  v_and_b32 v61, 0xffff0000, v110
  v_lshlrev_b32 v62, 16, v111
  v_and_b32 v63, 0xffff0000, v111
  v_pk_add_f32 v[68:69], v[68:69], v[36:37]
  v_pk_add_f32 v[70:71], v[70:71], v[38:39]
  v_pk_add_f32 v[76:77], v[76:77], v[44:45]
  v_pk_add_f32 v[78:79], v[78:79], v[46:47]
  v_cvt_pk_bf16_f32 v24, v68, v69
  v_cvt_pk_bf16_f32 v25, v70, v71
  v_cvt_pk_bf16_f32 v26, v76, v77
  v_cvt_pk_bf16_f32 v27, v78, v79
  v_pk_add_f32 v[64:65], v[64:65], v[32:33]
  v_pk_add_f32 v[66:67], v[66:67], v[34:35]
  v_pk_add_f32 v[72:73], v[72:73], v[40:41]
  v_pk_add_f32 v[74:75], v[74:75], v[42:43]
  v_cvt_pk_bf16_f32 v16, v64, v65
  v_cvt_pk_bf16_f32 v17, v66, v67
  v_cvt_pk_bf16_f32 v18, v72, v73
  v_cvt_pk_bf16_f32 v19, v74, v75
  v_pk_add_f32 v[84:85], v[84:85], v[52:53]
  v_pk_add_f32 v[86:87], v[86:87], v[54:55]
  v_pk_add_f32 v[92:93], v[92:93], v[60:61]
  v_pk_add_f32 v[94:95], v[94:95], v[62:63]
  v_cvt_pk_bf16_f32 v28, v84, v85
  v_cvt_pk_bf16_f32 v29, v86, v87
  v_cvt_pk_bf16_f32 v30, v92, v93
  v_cvt_pk_bf16_f32 v31, v94, v95
  v_pk_add_f32 v[80:81], v[80:81], v[48:49]
  v_pk_add_f32 v[82:83], v[82:83], v[50:51]
  v_pk_add_f32 v[88:89], v[88:89], v[56:57]
  v_pk_add_f32 v[90:91], v[90:91], v[58:59]
  v_cvt_pk_bf16_f32 v20, v80, v81
  v_cvt_pk_bf16_f32 v21, v82, v83
  v_cvt_pk_bf16_f32 v22, v88, v89
  v_cvt_pk_bf16_f32 v23, v90, v91
  s_cmp_eq_u32 s41, 0
  s_cbranch_scc1 Lp4_mid
  v_permlane16_swap_b32 v16, v18
  v_permlane16_swap_b32 v17, v19
  v_permlane16_swap_b32 v20, v22
  v_permlane16_swap_b32 v21, v23
  ds_write_b128 v152, v[16:19] offset:0
  ds_write_b128 v153, v[20:23] offset:0
  ds_read_b128 v[96:99], v154 offset:0
  ds_read_b128 v[100:103], v154 offset:1024
  v_permlane16_swap_b32 v24, v26
  v_permlane16_swap_b32 v25, v27
  v_permlane16_swap_b32 v28, v30
  v_permlane16_swap_b32 v29, v31
  ds_write_b128 v152, v[24:27] offset:2048
  ds_write_b128 v153, v[28:31] offset:2048
  ds_read_b128 v[104:107], v154 offset:2048
  ds_read_b128 v[108:111], v154 offset:3072
  s_waitcnt lgkmcnt(5)
  buffer_store_dwordx4 v[96:99], v155, s[32:35], s57 offen nt
  s_add_u32 s57, s57, 32768
  s_waitcnt lgkmcnt(4)
  buffer_store_dwordx4 v[100:103], v155, s[32:35], s57 offen nt
  s_add_u32 s57, s57, 32768
  s_waitcnt lgkmcnt(1)
  buffer_store_dwordx4 v[104:107], v155, s[32:35], s57 offen nt
  s_add_u32 s57, s57, 32768
  s_waitcnt lgkmcnt(0)
  buffer_store_dwordx4 v[108:111], v155, s[32:35], s57 offen nt
  s_add_u32 s57, s57, 32768
  s_endpgm
Lp4_mid:
  buffer_store_dwordx4 v[16:19], v8, s[4:7], s46 offen offset:0 sc1
  buffer_store_dwordx4 v[24:27], v8, s[4:7], s47 offen offset:0 sc1
  v_mfma_f32_16x16x32_bf16 v[144:147], v[24:27], v[24:27], 0
  v_mfma_f32_16x16x32_bf16 v[140:143], v[128:131], v[24:27], 0
  v_mfma_f32_16x16x32_bf16 v[136:139], v[16:19], v[16:19], 0
  v_mfma_f32_16x16x32_bf16 v[132:135], v[128:131], v[16:19], 0
  buffer_store_dwordx4 v[20:23], v8, s[4:7], s46 offen offset:1024 sc1
  v_mfma_f32_16x16x32_bf16 v[144:147], v[28:31], v[28:31], v[144:147]
  buffer_store_dwordx4 v[28:31], v8, s[4:7], s47 offen offset:1024 sc1
  v_mfma_f32_16x16x32_bf16 v[140:143], v[128:131], v[28:31], v[140:143]
  v_mfma_f32_16x16x32_bf16 v[136:139], v[20:23], v[20:23], v[136:139]
  v_mfma_f32_16x16x32_bf16 v[132:135], v[128:131], v[20:23], v[132:135]
  s_nop 5
  v_cndmask_b32 v141, v144, v145, s[66:67]
  v_cndmask_b32 v141, v141, v146, s[68:69]
  v_cndmask_b32 v141, v141, v147, s[70:71]
  buffer_store_dwordx2 v[140:141], v148, s[4:7], s48 offen offset:2048 sc1
  v_cndmask_b32 v133, v136, v137, s[66:67]
  v_cndmask_b32 v133, v133, v138, s[68:69]
  v_cndmask_b32 v133, v133, v139, s[70:71]
  buffer_store_dwordx2 v[132:133], v148, s[4:7], s48 offen offset:0 sc1
  s_mov_b32 s41, 1
  s_mov_b32 s42, 0x2800000
  s_mov_b32 s28, s4
  s_mov_b32 s29, s5
  s_mov_b32 s30, 0x10000000
  s_lshr_b32 s57, s40, 1
  s_and_b32 s58, s40, 1
  s_lshl_b32 s71, s50, 3
  s_add_u32 s67, s50, s51
  s_and_b32 s67, s67, 0
  s_lshl_b32 s67, s67, 3
  s_lshl_b32 s62, s40, 12
  s_mul_i32 s63, s40, 6144
  s_add_u32 s76, s63, 139264
  s_and_b32 s43, s50, 7
  s_cmp_lg_u32 s43, 0
  s_cselect_b32 s43, 1, 0
  s_sub_u32 s72, s71, s43
  v_lshrrev_b32 v2, 3, v253
  v_bfe_u32 v3, v253, 1, 2
  v_lshrrev_b32 v4, 4, v253
  v_xor_b32 v3, v3, v4
  v_and_b32 v5, 1, v253
  v_mov_b32 v6, v2
  s_lshl_b32 s43, s40, 4
  v_mul_u32_u24 v6, 6144, v6
  v_lshl_add_u32 v6, v3, 5, v6
  v_lshl_add_u32 v124, v5, 4, v6
  v_add_u32 v125, 48128, v124
  s_mul_i32 s43, s43, 6144
  s_lshl_b32 s60, s51, 7
  s_add_u32 s60, s60, s43
  v_and_b32 v3, 7, v253
  s_lshl_b32 s43, s40, 1
  s_add_u32 s43, s43, s71
  v_lshlrev_b32 v120, 4, v253
  v_mov_b32 v121, v120
  v_add_u32 v122, 30720, v120
  v_add_u32 v123, 30720, v120
  v_lshlrev_b32 v5, 8, v2
  v_lshl_add_u32 v5, v3, 4, v5
  v_add_u32 v126, 128, v5
  s_lshl_b32 s43, s43, 15
  s_mov_b32 s44, 41943040
  s_add_u32 s59, s43, s44
  s_lshl_b32 s43, s72, 15
  s_add_u32 s73, s43, s44
  s_movk_i32 s61, 2048
  v_and_b32 v2, 15, v253
  v_lshrrev_b32 v3, 4, v253
  v_and_b32 v4, 7, v253
  v_lshlrev_b32 v6, 4, v253
  v_add_u32 v7, 1024, v6
  v_lshlrev_b32 v5, 7, v3
  v_lshl_add_u32 v8, v4, 4, v5
  v_add_u32 v9, 512, v8
  s_lshl_b32 s43, s57, 13
  s_add_u32 s43, s43, 73728
  v_add_u32 v112, s43, v6
  v_add_u32 v113, s43, v7
  v_add_u32 v114, 122880, v8
  v_add_u32 v115, 122880, v9
  s_lshl_b32 s43, s52, 3
  s_lshl_b32 s44, s40, 1
  s_add_u32 s43, s43, s44
  v_mov_b32 v187, v6
  s_lshl_b32 s43, s43, 15
  s_lshl_b32 s44, s53, 11
  s_add_u32 s43, s43, s44
  s_add_u32 s64, s43, 41943040
  v_lshrrev_b32 v2, 2, v253
  v_bfe_u32 v3, v253, 3, 2
  v_and_b32 v4, 3, v253
  v_lshlrev_b32 v4, 3, v4
  v_lshl_add_u32 v4, v2, 7, v4
  s_lshl_b32 s43, s58, 1
  s_or_b32 s43, s43, s57
  v_xor_b32 v5, s43, v3
  v_lshl_add_u32 v116, v5, 5, v4
  v_xor_b32 v5, 1, v5
  v_lshl_add_u32 v117, v5, 5, v4
  v_add_u32 v118, 49152, v116
  v_add_u32 v119, 49152, v117
  s_mov_b32 s84, s16
  s_mov_b32 s85, s17
  s_mov_b32 s86, 7340032
  s_mov_b32 s87, 0x20000
  s_mov_b32 s3, 0
  s_mov_b32 s88, 63
  s_mov_b32 s100, 0
  v_mov_b32 v238, 0x40000000
  s_waitcnt vmcnt(0)
  s_barrier
  s_cmp_lg_u32 s40, 0
  s_cbranch_scc1 Lsig23
  v_mov_b32 v250, 1
  s_mov_b64 exec, 1
  buffer_atomic_add v250, v251, s[4:7], s77 offen sc1
  s_mov_b64 exec, -1
Lsig23:
  s_add_u32 s44, s67, 0
  s_and_b32 s44, s44, 15
  s_mul_i32 s45, s44, 393216
  s_add_u32 s69, s45, s60
  s_add_u32 s70, s69, 4096
  s_add_u32 m0, s63, 0
  s_nop 0
  buffer_load_dwordx4 v124, s[8:11], s69 offen offset:0  lds
  buffer_load_dwordx4 v125, s[8:11], s69 offen offset:1024  lds
  buffer_load_dwordx4 v124, s[8:11], s69 offen offset:2048  lds
  buffer_load_dwordx4 v125, s[8:11], s69 offen offset:3072  lds
  s_add_u32 m0, s63, 4096
  s_nop 0
  buffer_load_dwordx4 v124, s[8:11], s70 offen offset:0  lds
  buffer_load_dwordx4 v125, s[8:11], s70 offen offset:1024  lds
  s_add_u32 s44, s67, 1
  s_and_b32 s44, s44, 15
  s_mul_i32 s45, s44, 393216
  s_add_u32 s69, s45, s60
  s_add_u32 s70, s69, 4096
  s_add_u32 m0, s63, 24576
  s_nop 0
  buffer_load_dwordx4 v124, s[8:11], s69 offen offset:0  lds
  buffer_load_dwordx4 v125, s[8:11], s69 offen offset:1024  lds
  buffer_load_dwordx4 v124, s[8:11], s69 offen offset:2048  lds
  buffer_load_dwordx4 v125, s[8:11], s69 offen offset:3072  lds
  s_add_u32 m0, s63, 28672
  s_nop 0
  buffer_load_dwordx4 v124, s[8:11], s70 offen offset:0  lds
  buffer_load_dwordx4 v125, s[8:11], s70 offen offset:1024  lds
  v_pk_mul_f32 v[0:1], v[250:251], 0 op_sel:[1,0] op_sel_hi:[1,0]
  v_pk_mul_f32 v[2:3], v[250:251], 0 op_sel:[1,0] op_sel_hi:[1,0]
  v_pk_mul_f32 v[4:5], v[250:251], 0 op_sel:[1,0] op_sel_hi:[1,0]
  v_pk_mul_f32 v[6:7], v[250:251], 0 op_sel:[1,0] op_sel_hi:[1,0]
  v_pk_mul_f32 v[8:9], v[250:251], 0 op_sel:[1,0] op_sel_hi:[1,0]
  v_pk_mul_f32 v[10:11], v[250:251], 0 op_sel:[1,0] op_sel_hi:[1,0]
  v_pk_mul_f32 v[12:13], v[250:251], 0 op_sel:[1,0] op_sel_hi:[1,0]
  v_pk_mul_f32 v[14:15], v[250:251], 0 op_sel:[1,0] op_sel_hi:[1,0]
  v_pk_mul_f32 v[16:17], v[250:251], 0 op_sel:[1,0] op_sel_hi:[1,0]
  v_pk_mul_f32 v[18:19], v[250:251], 0 op_sel:[1,0] op_sel_hi:[1,0]
  v_pk_mul_f32 v[20:21], v[250:251], 0 op_sel:[1,0] op_sel_hi:[1,0]
  v_pk_mul_f32 v[22:23], v[250:251], 0 op_sel:[1,0] op_sel_hi:[1,0]
  v_pk_mul_f32 v[24:25], v[250:251], 0 op_sel:[1,0] op_sel_hi:[1,0]
  v_pk_mul_f32 v[26:27], v[250:251], 0 op_sel:[1,0] op_sel_hi:[1,0]
  v_pk_mul_f32 v[28:29], v[250:251], 0 op_sel:[1,0] op_sel_hi:[1,0]
  v_pk_mul_f32 v[30:31], v[250:251], 0 op_sel:[1,0] op_sel_hi:[1,0]
  v_pk_mul_f32 v[32:33], v[250:251], 0 op_sel:[1,0] op_sel_hi:[1,0]
  v_pk_mul_f32 v[34:35], v[250:251], 0 op_sel:[1,0] op_sel_hi:[1,0]
  v_pk_mul_f32 v[36:37], v[250:251], 0 op_sel:[1,0] op_sel_hi:[1,0]
  v_pk_mul_f32 v[38:39], v[250:251], 0 op_sel:[1,0] op_sel_hi:[1,0]
  v_pk_mul_f32 v[40:41], v[250:251], 0 op_sel:[1,0] op_sel_hi:[1,0]
  v_pk_mul_f32 v[42:43], v[250:251], 0 op_sel:[1,0] op_sel_hi:[1,0]
  v_pk_mul_f32 v[44:45], v[250:251], 0 op_sel:[1,0] op_sel_hi:[1,0]
  v_pk_mul_f32 v[46:47], v[250:251], 0 op_sel:[1,0] op_sel_hi:[1,0]
  v_pk_mul_f32 v[48:49], v[250:251], 0 op_sel:[1,0] op_sel_hi:[1,0]
  v_pk_mul_f32 v[50:51], v[250:251], 0 op_sel:[1,0] op_sel_hi:[1,0]
  v_pk_mul_f32 v[52:53], v[250:251], 0 op_sel:[1,0] op_sel_hi:[1,0]
  v_pk_mul_f32 v[54:55], v[250:251], 0 op_sel:[1,0] op_sel_hi:[1,0]
  v_pk_mul_f32 v[56:57], v[250:251], 0 op_sel:[1,0] op_sel_hi:[1,0]
  v_pk_mul_f32 v[58:59], v[250:251], 0 op_sel:[1,0] op_sel_hi:[1,0]
  v_pk_mul_f32 v[60:61], v[250:251], 0 op_sel:[1,0] op_sel_hi:[1,0]
  v_pk_mul_f32 v[62:63], v[250:251], 0 op_sel:[1,0] op_sel_hi:[1,0]
  v_pk_mul_f32 v[64:65], v[250:251], 0 op_sel:[1,0] op_sel_hi:[1,0]
  v_pk_mul_f32 v[66:67], v[250:251], 0 op_sel:[1,0] op_sel_hi:[1,0]
  v_pk_mul_f32 v[68:69], v[250:251], 0 op_sel:[1,0] op_sel_hi:[1,0]
  v_pk_mul_f32 v[70:71], v[250:251], 0 op_sel:[1,0] op_sel_hi:[1,0]
  v_pk_mul_f32 v[72:73], v[250:251], 0 op_sel:[1,0] op_sel_hi:[1,0]
  v_pk_mul_f32 v[74:75], v[250:251], 0 op_sel:[1,0] op_sel_hi:[1,0]
  v_pk_mul_f32 v[76:77], v[250:251], 0 op_sel:[1,0] op_sel_hi:[1,0]
  v_pk_mul_f32 v[78:79], v[250:251], 0 op_sel:[1,0] op_sel_hi:[1,0]
  v_pk_mul_f32 v[80:81], v[250:251], 0 op_sel:[1,0] op_sel_hi:[1,0]
  v_pk_mul_f32 v[82:83], v[250:251], 0 op_sel:[1,0] op_sel_hi:[1,0]
  v_pk_mul_f32 v[84:85], v[250:251], 0 op_sel:[1,0] op_sel_hi:[1,0]
  v_pk_mul_f32 v[86:87], v[250:251], 0 op_sel:[1,0] op_sel_hi:[1,0]
  v_pk_mul_f32 v[88:89], v[250:251], 0 op_sel:[1,0] op_sel_hi:[1,0]
  v_pk_mul_f32 v[90:91], v[250:251], 0 op_sel:[1,0] op_sel_hi:[1,0]
  v_pk_mul_f32 v[92:93], v[250:251], 0 op_sel:[1,0] op_sel_hi:[1,0]
  v_pk_mul_f32 v[94:95], v[250:251], 0 op_sel:[1,0] op_sel_hi:[1,0]
  v_pk_mul_f32 v[96:97], v[250:251], 0 op_sel:[1,0] op_sel_hi:[1,0]
  v_pk_mul_f32 v[98:99], v[250:251], 0 op_sel:[1,0] op_sel_hi:[1,0]
  v_pk_mul_f32 v[100:101], v[250:251], 0 op_sel:[1,0] op_sel_hi:[1,0]
  v_pk_mul_f32 v[102:103], v[250:251], 0 op_sel:[1,0] op_sel_hi:[1,0]
  s_mul_i32 s77, s50, 128
  s_add_u32 s77, s77, 27815808
  s_and_b32 s43, s50, 7
  s_cmp_eq_u32 s43, 0
  s_cselect_b32 s43, 128, 0
  v_lshlrev_b32 v249, 7, v253
  v_or_b32 v249, s43, v249
  s_cmp_eq_u32 s40, 0
  s_cbranch_scc1 Ln024
  s_add_u32 s44, s67, 2
  s_and_b32 s44, s44, 15
  s_mul_i32 s45, s44, 393216
  s_add_u32 s69, s45, s60
  s_add_u32 s70, s69, 4096
  s_add_u32 m0, s63, 49152
  s_nop 0
  buffer_load_dwordx4 v124, s[8:11], s69 offen offset:0  lds
  buffer_load_dwordx4 v125, s[8:11], s69 offen offset:1024  lds
  buffer_load_dwordx4 v124, s[8:11], s69 offen offset:2048  lds
  buffer_load_dwordx4 v125, s[8:11], s69 offen offset:3072  lds
  s_add_u32 m0, s63, 53248
  s_nop 0
  buffer_load_dwordx4 v124, s[8:11], s70 offen offset:0  lds
  buffer_load_dwordx4 v125, s[8:11], s70 offen offset:1024  lds
Ln024:
  s_branch Llayer
Lend:
  s_endpgm
Lside_sub:
  s_cmp_eq_u32 s90, 1
  s_cbranch_scc0 Lside_l
  s_cmp_lg_u32 s40, 0
  s_cbranch_scc1 Lside_a
  s_and_b32 s43, s2, 1
  s_lshl_b32 s43, s43, 7
  v_mov_b32 v250, 1
  s_mov_b64 exec, 1
  buffer_atomic_add v250, v251, s[36:39], s43 offen sc1
  s_mov_b64 exec, -1
Lside_a:
  s_add_u32 s88, s88, 3
  s_add_u32 s90, s90, 1
  s_setpc_b64 s[78:79]
Lside_l:
  buffer_load_dwordx4 a[240:243], v239, s[12:15], s89 offen
  s_add_u32 s89, s89, 1024
  s_cmp_eq_u32 s90, 0
  s_cbranch_scc0 Lside_b
  buffer_load_dwordx4 a[176:179], v238, s[84:87], s100 offen
  s_add_u32 s100, s100, 57344
  buffer_load_dwordx4 a[180:183], v238, s[84:87], s100 offen
  s_add_u32 s100, s100, 57344
  buffer_load_dwordx4 a[184:187], v238, s[84:87], s100 offen
  s_add_u32 s100, s100, 57344
  buffer_load_dwordx4 a[188:191], v238, s[84:87], s100 offen
  s_add_u32 s100, s100, 57344
  buffer_load_dwordx4 a[192:195], v238, s[84:87], s100 offen
  s_add_u32 s100, s100, 57344
  buffer_load_dwordx4 a[196:199], v238, s[84:87], s100 offen
  s_add_u32 s100, s100, 57344
  buffer_load_dwordx4 a[200:203], v238, s[84:87], s100 offen
  s_add_u32 s100, s100, 57344
  buffer_load_dwordx4 a[204:207], v238, s[84:87], s100 offen
  s_add_u32 s100, s100, 57344
  s_add_u32 s100, s100, 3211264
  s_add_u32 s88, s88, 3
  s_add_u32 s90, s90, 1
  s_setpc_b64 s[78:79]
Lside_b:
  buffer_load_dwordx4 a[208:211], v238, s[84:87], s100 offen
  s_add_u32 s100, s100, 57344
  buffer_load_dwordx4 a[212:215], v238, s[84:87], s100 offen
  s_add_u32 s100, s100, 57344
  buffer_load_dwordx4 a[216:219], v238, s[84:87], s100 offen
  s_add_u32 s100, s100, 57344
  buffer_load_dwordx4 a[220:223], v238, s[84:87], s100 offen
  s_add_u32 s100, s100, 57344
  buffer_load_dwordx4 a[224:227], v238, s[84:87], s100 offen
  s_add_u32 s100, s100, 57344
  buffer_load_dwordx4 a[228:231], v238, s[84:87], s100 offen
  s_add_u32 s100, s100, 57344
  buffer_load_dwordx4 a[232:235], v238, s[84:87], s100 offen
  s_add_u32 s100, s100, 57344
  buffer_load_dwordx4 a[236:239], v238, s[84:87], s100 offen
  s_add_u32 s100, s100, 57344
  s_mov_b32 s88, 63
  s_setpc_b64 s[78:79]
Lside_k9_c:
  s_call_b64 s[78:79], Lside_sub
  s_branch Lside_k9_r
Lside_k0_c:
  s_call_b64 s[78:79], Lside_sub
  s_branch Lside_k0_r
Lside_k1_c:
  s_call_b64 s[78:79], Lside_sub
  s_branch Lside_k1_r
Lside_k2_c:
  s_call_b64 s[78:79], Lside_sub
  s_branch Lside_k2_r
Lside_k3_c:
  s_call_b64 s[78:79], Lside_sub
  s_branch Lside_k3_r
Lside_k4_c:
  s_call_b64 s[78:79], Lside_sub
  s_branch Lside_k4_r
Lside_k5_c:
  s_call_b64 s[78:79], Lside_sub
  s_branch Lside_k5_r
Lchk3_c:
  s_mov_b32 s43, 0x40000
Lchk3_s:
  buffer_load_dword v127, v240, s[36:39], 0 offen sc1
  s_waitcnt vmcnt(0)
  v_cmp_gt_u32 vcc, 128, v127
  s_cbranch_vccz Lchk3_r
  s_sub_u32 s43, s43, 1
  s_cmp_lg_u32 s43, 0
  s_cbranch_scc1 Lchk3_s
  s_branch Lchk3_r
Lc4_c:
  buffer_load_dwordx4 v[200:203], v106, s[4:7], s46 offen sc1
  s_add_u32 s46, s46, 24576
  buffer_load_dwordx4 v[204:207], v106, s[4:7], s46 offen sc1
  s_add_u32 s46, s46, 24576
  s_branch Lc4_r
Lc5_c:
  buffer_load_dwordx4 v[208:211], v106, s[4:7], s46 offen sc1
  s_add_u32 s46, s46, 24576
  buffer_load_dwordx4 v[212:215], v106, s[4:7], s46 offen sc1
  s_add_u32 s46, s46, 24576
  s_branch Lc5_r
Lc6_c:
  buffer_load_dwordx4 v[216:219], v106, s[4:7], s46 offen sc1
  s_add_u32 s46, s46, 24576
  buffer_load_dwordx4 v[220:223], v106, s[4:7], s46 offen sc1
  s_add_u32 s46, s46, 24576
  s_branch Lc6_r
Lc7_c:
  buffer_load_dwordx4 v[224:227], v106, s[4:7], s46 offen sc1
  s_add_u32 s46, s46, 24576
  buffer_load_dwordx4 v[228:231], v106, s[4:7], s46 offen sc1
  s_add_u32 s46, s46, 24576
  s_branch Lc7_r
Lc8_c:
  v_pk_add_f32 v[200:201], v[200:201], v[216:217]
  v_pk_add_f32 v[202:203], v[202:203], v[218:219]
  v_pk_add_f32 v[204:205], v[204:205], v[220:221]
  v_pk_add_f32 v[206:207], v[206:207], v[222:223]
  v_pk_add_f32 v[208:209], v[208:209], v[224:225]
  v_pk_add_f32 v[210:211], v[210:211], v[226:227]
  v_pk_add_f32 v[212:213], v[212:213], v[228:229]
  v_pk_add_f32 v[214:215], v[214:215], v[230:231]
  v_pk_add_f32 v[200:201], v[200:201], v[208:209]
  v_pk_add_f32 v[202:203], v[202:203], v[210:211]
  v_pk_add_f32 v[204:205], v[204:205], v[212:213]
  v_pk_add_f32 v[206:207], v[206:207], v[214:215]
  v_pk_add_f32 v[200:201], v[200:201], v[204:205]
  v_pk_add_f32 v[202:203], v[202:203], v[206:207]
  v_mov_b32 v204, v200
  v_mov_b32 v205, v201
  v_mov_b32 v206, v202
  v_mov_b32 v207, v203
  v_permlane32_swap_b32 v200, v204
  v_permlane32_swap_b32 v201, v205
  v_permlane32_swap_b32 v202, v206
  v_permlane32_swap_b32 v203, v207
  v_add_f32 v200, v200, v204
  v_add_f32 v201, v201, v205
  v_add_f32 v202, v202, v206
  v_add_f32 v203, v203, v207
  ds_write_b128 v126, v[200:203] offset:1024
  s_branch Lc8_r
Lc10_c:
  v_accvgpr_read_b32 v236, a176
  v_accvgpr_read_b32 v237, a177
  v_accvgpr_read_b32 v238, a178
  v_accvgpr_read_b32 v239, a179
  v_lshlrev_b32 v224, 16, v236
  v_and_b32 v225, 0xffff0000, v236
  v_lshlrev_b32 v226, 16, v237
  v_and_b32 v227, 0xffff0000, v237
  v_lshlrev_b32 v228, 16, v238
  v_and_b32 v229, 0xffff0000, v238
  v_lshlrev_b32 v230, 16, v239
  v_and_b32 v231, 0xffff0000, v239
  v_accvgpr_read_b32 v236, a180
  v_accvgpr_read_b32 v237, a181
  v_accvgpr_read_b32 v238, a182
  v_accvgpr_read_b32 v239, a183
  v_lshlrev_b32 v232, 16, v236
  v_and_b32 v233, 0xffff0000, v236
  v_pk_add_f32 v[224:225], v[224:225], v[232:233]
  v_lshlrev_b32 v232, 16, v237
  v_and_b32 v233, 0xffff0000, v237
  v_pk_add_f32 v[226:227], v[226:227], v[232:233]
  v_lshlrev_b32 v232, 16, v238
  v_and_b32 v233, 0xffff0000, v238
  v_pk_add_f32 v[228:229], v[228:229], v[232:233]
  v_lshlrev_b32 v232, 16, v239
  v_and_b32 v233, 0xffff0000, v239
  v_pk_add_f32 v[230:231], v[230:231], v[232:233]
  v_accvgpr_read_b32 v236, a184
  v_accvgpr_read_b32 v237, a185
  v_accvgpr_read_b32 v238, a186
  v_accvgpr_read_b32 v239, a187
  v_lshlrev_b32 v232, 16, v236
  v_and_b32 v233, 0xffff0000, v236
  v_pk_add_f32 v[224:225], v[224:225], v[232:233]
  v_lshlrev_b32 v232, 16, v237
  v_and_b32 v233, 0xffff0000, v237
  v_pk_add_f32 v[226:227], v[226:227], v[232:233]
  v_lshlrev_b32 v232, 16, v238
  v_and_b32 v233, 0xffff0000, v238
  v_pk_add_f32 v[228:229], v[228:229], v[232:233]
  v_lshlrev_b32 v232, 16, v239
  v_and_b32 v233, 0xffff0000, v239
  v_pk_add_f32 v[230:231], v[230:231], v[232:233]
  v_accvgpr_read_b32 v236, a188
  v_accvgpr_read_b32 v237, a189
  v_accvgpr_read_b32 v238, a190
  v_accvgpr_read_b32 v239, a191
  v_lshlrev_b32 v232, 16, v236
  v_and_b32 v233, 0xffff0000, v236
  v_pk_add_f32 v[224:225], v[224:225], v[232:233]
  v_lshlrev_b32 v232, 16, v237
  v_and_b32 v233, 0xffff0000, v237
  v_pk_add_f32 v[226:227], v[226:227], v[232:233]
  v_lshlrev_b32 v232, 16, v238
  v_and_b32 v233, 0xffff0000, v238
  v_pk_add_f32 v[228:229], v[228:229], v[232:233]
  v_lshlrev_b32 v232, 16, v239
  v_and_b32 v233, 0xffff0000, v239
  v_pk_add_f32 v[230:231], v[230:231], v[232:233]
  v_accvgpr_read_b32 v236, a192
  v_accvgpr_read_b32 v237, a193
  v_accvgpr_read_b32 v238, a194
  v_accvgpr_read_b32 v239, a195
  v_lshlrev_b32 v232, 16, v236
  v_and_b32 v233, 0xffff0000, v236
  v_pk_add_f32 v[224:225], v[224:225], v[232:233]
  v_lshlrev_b32 v232, 16, v237
  v_and_b32 v233, 0xffff0000, v237
  v_pk_add_f32 v[226:227], v[226:227], v[232:233]
  v_lshlrev_b32 v232, 16, v238
  v_and_b32 v233, 0xffff0000, v238
  v_pk_add_f32 v[228:229], v[228:229], v[232:233]
  v_lshlrev_b32 v232, 16, v239
  v_and_b32 v233, 0xffff0000, v239
  v_pk_add_f32 v[230:231], v[230:231], v[232:233]
  v_accvgpr_read_b32 v236, a196
  v_accvgpr_read_b32 v237, a197
  v_accvgpr_read_b32 v238, a198
  v_accvgpr_read_b32 v239, a199
  v_lshlrev_b32 v232, 16, v236
  v_and_b32 v233, 0xffff0000, v236
  v_pk_add_f32 v[224:225], v[224:225], v[232:233]
  v_lshlrev_b32 v232, 16, v237
  v_and_b32 v233, 0xffff0000, v237
  v_pk_add_f32 v[226:227], v[226:227], v[232:233]
  v_lshlrev_b32 v232, 16, v238
  v_and_b32 v233, 0xffff0000, v238
  v_pk_add_f32 v[228:229], v[228:229], v[232:233]
  v_lshlrev_b32 v232, 16, v239
  v_and_b32 v233, 0xffff0000, v239
  v_pk_add_f32 v[230:231], v[230:231], v[232:233]
  v_accvgpr_read_b32 v236, a200
  v_accvgpr_read_b32 v237, a201
  v_accvgpr_read_b32 v238, a202
  v_accvgpr_read_b32 v239, a203
  v_lshlrev_b32 v232, 16, v236
  v_and_b32 v233, 0xffff0000, v236
  v_pk_add_f32 v[224:225], v[224:225], v[232:233]
  v_lshlrev_b32 v232, 16, v237
  v_and_b32 v233, 0xffff0000, v237
  v_pk_add_f32 v[226:227], v[226:227], v[232:233]
  v_lshlrev_b32 v232, 16, v238
  v_and_b32 v233, 0xffff0000, v238
  v_pk_add_f32 v[228:229], v[228:229], v[232:233]
  v_lshlrev_b32 v232, 16, v239
  v_and_b32 v233, 0xffff0000, v239
  v_pk_add_f32 v[230:231], v[230:231], v[232:233]
  v_accvgpr_read_b32 v236, a204
  v_accvgpr_read_b32 v237, a205
  v_accvgpr_read_b32 v238, a206
  v_accvgpr_read_b32 v239, a207
  v_lshlrev_b32 v232, 16, v236
  v_and_b32 v233, 0xffff0000, v236
  v_pk_add_f32 v[224:225], v[224:225], v[232:233]
  v_lshlrev_b32 v232, 16, v237
  v_and_b32 v233, 0xffff0000, v237
  v_pk_add_f32 v[226:227], v[226:227], v[232:233]
  v_lshlrev_b32 v232, 16, v238
  v_and_b32 v233, 0xffff0000, v238
  v_pk_add_f32 v[228:229], v[228:229], v[232:233]
  v_lshlrev_b32 v232, 16, v239
  v_and_b32 v233, 0xffff0000, v239
  v_pk_add_f32 v[230:231], v[230:231], v[232:233]
  s_branch Lc10_r
Lc11_c:
  v_accvgpr_read_b32 v236, a208
  v_accvgpr_read_b32 v237, a209
  v_accvgpr_read_b32 v238, a210
  v_accvgpr_read_b32 v239, a211
  v_lshlrev_b32 v232, 16, v236
  v_and_b32 v233, 0xffff0000, v236
  v_pk_add_f32 v[224:225], v[224:225], v[232:233]
  v_lshlrev_b32 v232, 16, v237
  v_and_b32 v233, 0xffff0000, v237
  v_pk_add_f32 v[226:227], v[226:227], v[232:233]
  v_lshlrev_b32 v232, 16, v238
  v_and_b32 v233, 0xffff0000, v238
  v_pk_add_f32 v[228:229], v[228:229], v[232:233]
  v_lshlrev_b32 v232, 16, v239
  v_and_b32 v233, 0xffff0000, v239
  v_pk_add_f32 v[230:231], v[230:231], v[232:233]
  v_accvgpr_read_b32 v236, a212
  v_accvgpr_read_b32 v237, a213
  v_accvgpr_read_b32 v238, a214
  v_accvgpr_read_b32 v239, a215
  v_lshlrev_b32 v232, 16, v236
  v_and_b32 v233, 0xffff0000, v236
  v_pk_add_f32 v[224:225], v[224:225], v[232:233]
  v_lshlrev_b32 v232, 16, v237
  v_and_b32 v233, 0xffff0000, v237
  v_pk_add_f32 v[226:227], v[226:227], v[232:233]
  v_lshlrev_b32 v232, 16, v238
  v_and_b32 v233, 0xffff0000, v238
  v_pk_add_f32 v[228:229], v[228:229], v[232:233]
  v_lshlrev_b32 v232, 16, v239
  v_and_b32 v233, 0xffff0000, v239
  v_pk_add_f32 v[230:231], v[230:231], v[232:233]
  v_accvgpr_read_b32 v236, a216
  v_accvgpr_read_b32 v237, a217
  v_accvgpr_read_b32 v238, a218
  v_accvgpr_read_b32 v239, a219
  v_lshlrev_b32 v232, 16, v236
  v_and_b32 v233, 0xffff0000, v236
  v_pk_add_f32 v[224:225], v[224:225], v[232:233]
  v_lshlrev_b32 v232, 16, v237
  v_and_b32 v233, 0xffff0000, v237
  v_pk_add_f32 v[226:227], v[226:227], v[232:233]
  v_lshlrev_b32 v232, 16, v238
  v_and_b32 v233, 0xffff0000, v238
  v_pk_add_f32 v[228:229], v[228:229], v[232:233]
  v_lshlrev_b32 v232, 16, v239
  v_and_b32 v233, 0xffff0000, v239
  v_pk_add_f32 v[230:231], v[230:231], v[232:233]
  v_accvgpr_read_b32 v236, a220
  v_accvgpr_read_b32 v237, a221
  v_accvgpr_read_b32 v238, a222
  v_accvgpr_read_b32 v239, a223
  v_lshlrev_b32 v232, 16, v236
  v_and_b32 v233, 0xffff0000, v236
  v_pk_add_f32 v[224:225], v[224:225], v[232:233]
  v_lshlrev_b32 v232, 16, v237
  v_and_b32 v233, 0xffff0000, v237
  v_pk_add_f32 v[226:227], v[226:227], v[232:233]
  v_lshlrev_b32 v232, 16, v238
  v_and_b32 v233, 0xffff0000, v238
  v_pk_add_f32 v[228:229], v[228:229], v[232:233]
  v_lshlrev_b32 v232, 16, v239
  v_and_b32 v233, 0xffff0000, v239
  v_pk_add_f32 v[230:231], v[230:231], v[232:233]
  v_accvgpr_read_b32 v236, a224
  v_accvgpr_read_b32 v237, a225
  v_accvgpr_read_b32 v238, a226
  v_accvgpr_read_b32 v239, a227
  v_lshlrev_b32 v232, 16, v236
  v_and_b32 v233, 0xffff0000, v236
  v_pk_add_f32 v[224:225], v[224:225], v[232:233]
  v_lshlrev_b32 v232, 16, v237
  v_and_b32 v233, 0xffff0000, v237
  v_pk_add_f32 v[226:227], v[226:227], v[232:233]
  v_lshlrev_b32 v232, 16, v238
  v_and_b32 v233, 0xffff0000, v238
  v_pk_add_f32 v[228:229], v[228:229], v[232:233]
  v_lshlrev_b32 v232, 16, v239
  v_and_b32 v233, 0xffff0000, v239
  v_pk_add_f32 v[230:231], v[230:231], v[232:233]
  v_accvgpr_read_b32 v236, a228
  v_accvgpr_read_b32 v237, a229
  v_accvgpr_read_b32 v238, a230
  v_accvgpr_read_b32 v239, a231
  v_lshlrev_b32 v232, 16, v236
  v_and_b32 v233, 0xffff0000, v236
  v_pk_add_f32 v[224:225], v[224:225], v[232:233]
  v_lshlrev_b32 v232, 16, v237
  v_and_b32 v233, 0xffff0000, v237
  v_pk_add_f32 v[226:227], v[226:227], v[232:233]
  v_lshlrev_b32 v232, 16, v238
  v_and_b32 v233, 0xffff0000, v238
  v_pk_add_f32 v[228:229], v[228:229], v[232:233]
  v_lshlrev_b32 v232, 16, v239
  v_and_b32 v233, 0xffff0000, v239
  v_pk_add_f32 v[230:231], v[230:231], v[232:233]
  v_accvgpr_read_b32 v236, a232
  v_accvgpr_read_b32 v237, a233
  v_accvgpr_read_b32 v238, a234
  v_accvgpr_read_b32 v239, a235
  v_lshlrev_b32 v232, 16, v236
  v_and_b32 v233, 0xffff0000, v236
  v_pk_add_f32 v[224:225], v[224:225], v[232:233]
  v_lshlrev_b32 v232, 16, v237
  v_and_b32 v233, 0xffff0000, v237
  v_pk_add_f32 v[226:227], v[226:227], v[232:233]
  v_lshlrev_b32 v232, 16, v238
  v_and_b32 v233, 0xffff0000, v238
  v_pk_add_f32 v[228:229], v[228:229], v[232:233]
  v_lshlrev_b32 v232, 16, v239
  v_and_b32 v233, 0xffff0000, v239
  v_pk_add_f32 v[230:231], v[230:231], v[232:233]
  v_accvgpr_read_b32 v236, a236
  v_accvgpr_read_b32 v237, a237
  v_accvgpr_read_b32 v238, a238
  v_accvgpr_read_b32 v239, a239
  v_lshlrev_b32 v232, 16, v236
  v_and_b32 v233, 0xffff0000, v236
  v_pk_add_f32 v[224:225], v[224:225], v[232:233]
  v_lshlrev_b32 v232, 16, v237
  v_and_b32 v233, 0xffff0000, v237
  v_pk_add_f32 v[226:227], v[226:227], v[232:233]
  v_lshlrev_b32 v232, 16, v238
  v_and_b32 v233, 0xffff0000, v238
  v_pk_add_f32 v[228:229], v[228:229], v[232:233]
  v_lshlrev_b32 v232, 16, v239
  v_and_b32 v233, 0xffff0000, v239
  v_pk_add_f32 v[230:231], v[230:231], v[232:233]
  v_mov_b32 v232, v224
  v_mov_b32 v233, v225
  v_mov_b32 v234, v226
  v_mov_b32 v235, v227
  v_mov_b32 v236, v228
  v_mov_b32 v237, v229
  v_mov_b32 v238, v230
  v_mov_b32 v239, v231
  v_permlane32_swap_b32 v224, v232
  v_permlane32_swap_b32 v225, v233
  v_permlane32_swap_b32 v226, v234
  v_permlane32_swap_b32 v227, v235
  v_permlane32_swap_b32 v228, v236
  v_permlane32_swap_b32 v229, v237
  v_permlane32_swap_b32 v230, v238
  v_permlane32_swap_b32 v231, v239
  v_add_f32 v224, v224, v232
  v_add_f32 v225, v225, v233
  v_add_f32 v226, v226, v234
  v_add_f32 v227, v227, v235
  v_add_f32 v228, v228, v236
  v_add_f32 v229, v229, v237
  v_add_f32 v230, v230, v238
  v_add_f32 v231, v231, v239
  v_mov_b32 v232, v224
  v_mov_b32 v233, v225
  v_mov_b32 v234, v226
  v_mov_b32 v235, v227
  v_mov_b32 v236, v228
  v_mov_b32 v237, v229
  v_mov_b32 v238, v230
  v_mov_b32 v239, v231
  v_permlane16_swap_b32 v224, v232
  v_permlane16_swap_b32 v225, v233
  v_permlane16_swap_b32 v226, v234
  v_permlane16_swap_b32 v227, v235
  v_permlane16_swap_b32 v228, v236
  v_permlane16_swap_b32 v229, v237
  v_permlane16_swap_b32 v230, v238
  v_permlane16_swap_b32 v231, v239
  v_add_f32 v224, v224, v232
  v_add_f32 v225, v225, v233
  v_add_f32 v226, v226, v234
  v_add_f32 v227, v227, v235
  v_add_f32 v228, v228, v236
  v_add_f32 v229, v229, v237
  v_add_f32 v230, v230, v238
  v_add_f32 v231, v231, v239
  v_and_b32 v232, 7, v253
  s_lshl_b32 s43, s40, 8
  s_add_u32 s43, s43, 143360
  v_add_f32_dpp v224, v224, v224 row_ror:8 row_mask:0xf bank_mask:0xf
  v_add_f32_dpp v225, v225, v225 row_ror:8 row_mask:0xf bank_mask:0xf
  v_add_f32_dpp v226, v226, v226 row_ror:8 row_mask:0xf bank_mask:0xf
  v_add_f32_dpp v227, v227, v227 row_ror:8 row_mask:0xf bank_mask:0xf
  v_add_f32_dpp v228, v228, v228 row_ror:8 row_mask:0xf bank_mask:0xf
  v_add_f32_dpp v229, v229, v229 row_ror:8 row_mask:0xf bank_mask:0xf
  v_add_f32_dpp v230, v230, v230 row_ror:8 row_mask:0xf bank_mask:0xf
  v_add_f32_dpp v231, v231, v231 row_ror:8 row_mask:0xf bank_mask:0xf
  v_lshl_add_u32 v232, v232, 5, s43
  ds_write_b128 v232, v[224:227]
  ds_write_b128 v232, v[228:231] offset:16
  s_branch Lc11_r
Lc14_c:
  v_lshlrev_b32 v232, 2, v253
  v_add_u32 v233, 143360, v232
  ds_read_b32 v234, v233 offset:0
  ds_read_b32 v235, v233 offset:256
  ds_read_b32 v236, v233 offset:512
  ds_read_b32 v237, v233 offset:768
  s_waitcnt lgkmcnt(0)
  v_add_f32 v234, v234, v235
  v_add_f32 v236, v236, v237
  v_add_f32 v234, v234, v236
  buffer_store_dword v234, v232, s[4:7], s101 offen sc1
  s_branch Lc14_r
Lc16_c:
  s_bfe_u32 s43, s2, 0x20001
  s_lshl_b32 s43, s43, 7
  s_add_u32 s43, s43, 27794432
  v_mov_b32 v250, 1
  s_mov_b64 exec, 1
  buffer_atomic_add v250, v251, s[4:7], s43 offen sc1
  s_mov_b64 exec, -1
  s_branch Lc16_r
Lchk20_c:
  s_mov_b32 s43, 0x40000
Lchk20_s:
  buffer_load_dword v237, v251, s[4:7], s48 offen sc1
  s_waitcnt vmcnt(0)
  v_cmp_gt_u32 vcc, 56, v237
  s_cbranch_vccz Lchk20_r
  s_sub_u32 s43, s43, 1
  s_cmp_lg_u32 s43, 0
  s_cbranch_scc1 Lchk20_s
  s_branch Lchk20_r
Lp4a_c:
  s_mov_b32 s43, 0x40000
Lp4a_s:
  buffer_load_dword v10, v251, s[4:7], s64 offen sc1
  s_waitcnt vmcnt(0)
  v_cmp_gt_u32 vcc, 16, v10
  s_cbranch_vccz Lp4a_r
  s_sub_u32 s43, s43, 1
  s_cmp_lg_u32 s43, 0
  s_cbranch_scc1 Lp4a_s
  s_branch Lp4a_r
Lp4b_c:
  s_mov_b32 s43, 0x40000
Lp4b_s:
  buffer_load_dword v10, v251, s[4:7], s64 offen sc1
  s_waitcnt vmcnt(0)
  v_cmp_gt_u32 vcc, 16, v10
  s_cbranch_vccz Lp4b_r
  s_sub_u32 s43, s43, 1
  s_cmp_lg_u32 s43, 0
  s_cbranch_scc1 Lp4b_s
  s_branch Lp4b_r
Lp3_sgl_c:
  v_mov_b32 v250, 1
  s_mov_b64 exec, 1
  buffer_atomic_add v250, v251, s[4:7], s77 offen sc1
  s_mov_b64 exec, -1
  s_branch Lp3_sgl_r
Lp4_mb_c:
  s_mov_b32 s43, 0x40000
Lp4_mb_s:
  buffer_load_dwordx4 v[96:99], v8, s[4:7], s45 offen offset:0 sc1
  buffer_load_dwordx4 v[100:103], v8, s[4:7], s45 offen offset:1024 sc1
  buffer_load_dwordx4 v[104:107], v8, s[4:7], s45 offen offset:2048 sc1
  buffer_load_dwordx4 v[108:111], v8, s[4:7], s45 offen offset:3072 sc1
  s_waitcnt vmcnt(0)
  v_max3_u32 v112, v96, v97, v98
  v_max3_u32 v113, v99, v100, v101
  v_max3_u32 v112, v112, v102, v103
  v_max3_u32 v113, v113, v104, v105
  v_max3_u32 v112, v112, v106, v107
  v_max3_u32 v113, v113, v108, v109
  v_max3_u32 v112, v112, v110, v111
  v_max_u32 v112, v112, v113
  v_cmp_eq_u32 vcc, -1, v112
  s_cbranch_vccz Lp4_mb_r
  s_sub_u32 s43, s43, 1
  s_cmp_lg_u32 s43, 0
  s_cbranch_scc1 Lp4_mb_s
  s_branch Lp4_mb_r
Lcode_end:
.fill (Lpc0 + 65536 - Lcode_end)/4, 4, 0xbf810000
.section .rodata,"a"
.p2align 6
.amdhsa_kernel interleave_layers__sliding_local_dilated__swiglu_ffn__prompt_kernel
  .amdhsa_next_free_vgpr 512
  .amdhsa_next_free_sgpr 102
  .amdhsa_accum_offset 256
  .amdhsa_group_segment_fixed_size 0
  .amdhsa_kernarg_size 80
  .amdhsa_user_sgpr_count 2
  .amdhsa_user_sgpr_kernarg_segment_ptr 1
  .amdhsa_system_sgpr_workgroup_id_x 1
  .amdhsa_float_denorm_mode_32 3
.end_amdhsa_kernel
```
